```python
import torch

def _softmax(x, axis=-1):
    return torch.softmax(x, dim=axis)
def _gelu(x):
    return torch.nn.functional.gelu(x, approximate="tanh")
def _silu(x):
    return torch.nn.functional.silu(x)
def _sigmoid(x):
    return torch.sigmoid(x)
def _layernorm(x, axis=-1, eps=1e-5):
    m = x.mean(dim=axis, keepdim=True)
    v = x.var(dim=axis, keepdim=True, unbiased=False)
    return (x - m) / torch.sqrt(v + eps)
def _scatter_add(tgt, idx, src, axis=0):
    return tgt.clone().index_add_(axis, idx, src)
def _segment_sum(src, seg, n):
    out = torch.zeros((n,) + src.shape[1:], dtype=src.dtype)
    return out.index_add_(0, seg, src)
def _pad(x, pw):
    flat = tuple(v for pair in reversed(pw) for v in pair)
    return torch.nn.functional.pad(x, flat)

kernel_name = 'standalone__weight_only_int_squeezellm__prompt'

def setup_inputs():

    _w = (lambda a: (lambda t: t.to(torch.bfloat16) if t.is_floating_point() else t)(torch.as_tensor(a)))
    B, S, D, F = 1, 2048, 1024, 3584
    bits = 8 if (2 <= 8 <= 4) else 4
    L = 2 ** bits
    qw = torch.randint(0, L, (D, F)).to(torch.int64)
    lut = (lambda *s: torch.randn(*s, dtype=torch.bfloat16) * 0.05)(L, F)
    return {
        "x": _w((lambda *s: torch.randn(*s, dtype=torch.bfloat16) * 0.05)(B, S, D)),
        "qw": _w(qw),
        "lut": _w(lut),
    }

def reference(x, qw, lut):
    w = (lambda x, i, axis: torch.take_along_dim(x, i, dim=axis))(lut, qw, axis=0)
    w = (lambda x, dt: x.to(dt))(w, x.dtype)
    return torch.einsum('bsd,df->bsf', x, w)
```

```asm
; @launch kernel=dq_kernel grid=(256,1,1) block=(512,1,1) lds=40960
; @launch kernel=mm_kernel grid=(256,1,1) block=(512,1,1) lds=135168
.amdgcn_target "amdgcn-amd-amdhsa--gfx950"
.text
.globl dq_kernel
.p2align 8
.type dq_kernel,@function
dq_kernel:
  s_cmp_ge_u32 s2, 256
  s_cbranch_scc1 L1_done
  s_load_dwordx4 s[4:7], s[0:1], 0
  s_load_dwordx2 s[8:9], s[0:1], 16
  s_load_dwordx2 s[10:11], s[0:1], 40
  s_and_b32 s32, s2, 1
  s_lshl_b32 s32, s32, 3
  s_bfe_u32 s33, s2, 0x30003
  s_add_u32 s30, s32, s33
  s_bfe_u32 s32, s2, 0x20001
  s_lshl_b32 s32, s32, 2
  s_lshr_b32 s33, s2, 6
  s_add_u32 s31, s32, s33
  v_lshrrev_b32 v1, 6, v0
  v_and_b32 v2, 63, v0
  v_readfirstlane_b32 s33, v1
  v_cvt_f32_u32 v3, v0
  v_add_f32 v3, 0.5, v3
  v_mul_f32 v3, 0x3d124925, v3
  v_cvt_u32_f32 v3, v3
  v_mul_u32_u24 v4, 28, v3
  v_sub_u32 v4, v0, v4
  v_mul_u32_u24 v3, 7168, v3
  v_lshl_add_u32 v3, v4, 4, v3
  s_mul_i32 s34, s31, 448
  s_lshl_b32 m0, s33, 10
  s_lshl_b32 s35, s33, 4
  s_add_u32 s35, s35, s30
  s_mul_i32 s36, s35, 114688
  s_mul_i32 s37, s31, 896
  s_add_u32 s36, s36, s37
  v_lshlrev_b32 v5, 4, v2
  v_add_u32 v5, s36, v5
  v_mov_b32 v6, 0x7ff00000
  v_cmp_lt_u32 vcc, 55, v2
  s_nop 0
  s_waitcnt lgkmcnt(0)
  v_cndmask_b32 v5, v5, v6, vcc
  s_mov_b32 s12, s4
  s_mov_b32 s13, s5
  s_mov_b32 s14, 4194304
  s_mov_b32 s15, 0x20000
  s_mov_b32 s16, s6
  s_mov_b32 s17, s7
  s_mov_b32 s18, 14680064
  s_mov_b32 s19, 0x20000
  s_mov_b32 s20, s8
  s_mov_b32 s21, s9
  s_mov_b32 s22, 114688
  s_mov_b32 s23, 0x20000
  s_mov_b32 s24, s10
  s_mov_b32 s25, s11
  s_mov_b32 s26, 7340032
  s_mov_b32 s27, 0x20000
  buffer_load_dwordx4 v3, s[20:23], s34 offen lds
  s_mov_b32 s38, 0
  buffer_load_dwordx4 v[16:19], v5, s[16:19], s38 offen
  s_mov_b32 s38, 14336
  buffer_load_dwordx4 v[20:23], v5, s[16:19], s38 offen
  s_mov_b32 s38, 28672
  buffer_load_dwordx4 v[24:27], v5, s[16:19], s38 offen
  s_mov_b32 s38, 43008
  buffer_load_dwordx4 v[28:31], v5, s[16:19], s38 offen
  s_mov_b32 s38, 57344
  buffer_load_dwordx4 v[32:35], v5, s[16:19], s38 offen
  s_mov_b32 s38, 71680
  buffer_load_dwordx4 v[36:39], v5, s[16:19], s38 offen
  s_mov_b32 s38, 86016
  buffer_load_dwordx4 v[40:43], v5, s[16:19], s38 offen
  s_mov_b32 s38, 100352
  buffer_load_dwordx4 v[44:47], v5, s[16:19], s38 offen
  s_cmp_ge_u32 s33, 2
  s_cbranch_scc1 L1_nt
  s_lshl_b32 s38, s2, 14
  v_lshlrev_b32 v7, 7, v0
  buffer_load_dword v8, v7, s[12:15], s38 offen
  s_waitcnt vmcnt(9)
  s_branch L1_nt2
L1_nt:
  s_waitcnt vmcnt(8)
L1_nt2:
  v_min_u32 v9, 55, v2
  v_lshlrev_b32 v9, 3, v9
  v_cmp_lt_u32 vcc, 27, v2
  v_subrev_u32 v10, 28, v2
  s_nop 0
  v_cndmask_b32 v10, v2, v10, vcc
  v_mov_b32 v12, 28
  v_cndmask_b32 v11, 0, v12, vcc
  v_and_b32 v12, 24, v10
  v_and_b32 v13, 1, v10
  v_lshl_add_u32 v12, v13, 2, v12
  v_bfe_u32 v13, v10, 1, 2
  v_add_u32 v12, v12, v13
  v_cmp_lt_u32 vcc, 23, v10
  s_nop 1
  v_cndmask_b32 v12, v12, v10, vcc
  v_add_u32 v12, v12, v11
  v_cmp_lt_u32 vcc, 55, v2
  s_nop 1
  v_cndmask_b32 v12, v12, v2, vcc
  s_lshl_b32 s38, s33, 12
  s_add_u32 s38, s38, 8192
  v_lshl_add_u32 v12, v12, 6, s38
  v_lshl_add_u32 v13, v2, 4, s38
  s_mul_i32 s36, s31, 458752
  s_mul_i32 s37, s35, 3584
  s_add_u32 s36, s36, s37
  v_lshl_add_u32 v14, v2, 4, s36
  v_mov_b32 v6, 0x7ff00000
  v_cmp_lt_u32 vcc, 31, v2
  s_mov_b32 s39, 448
  s_nop 0
  v_cndmask_b32 v15, v14, v6, vcc
  s_barrier
  s_waitcnt vmcnt(7)
  v_mad_u32_u24 v16, v16, s39, v9
  v_mad_u32_u24 v17, v17, s39, v9
  v_mad_u32_u24 v18, v18, s39, v9
  v_mad_u32_u24 v19, v19, s39, v9
  ds_read_u16 v16, v16 offset:0
  ds_read_u16 v17, v17 offset:2
  ds_read_u16 v18, v18 offset:4
  ds_read_u16 v19, v19 offset:6
  s_waitcnt vmcnt(6)
  v_mad_u32_u24 v20, v20, s39, v9
  v_mad_u32_u24 v21, v21, s39, v9
  v_mad_u32_u24 v22, v22, s39, v9
  v_mad_u32_u24 v23, v23, s39, v9
  ds_read_u16 v20, v20 offset:0
  ds_read_u16 v21, v21 offset:2
  ds_read_u16 v22, v22 offset:4
  ds_read_u16 v23, v23 offset:6
  s_waitcnt vmcnt(5)
  v_mad_u32_u24 v24, v24, s39, v9
  v_mad_u32_u24 v25, v25, s39, v9
  v_mad_u32_u24 v26, v26, s39, v9
  v_mad_u32_u24 v27, v27, s39, v9
  ds_read_u16 v24, v24 offset:0
  ds_read_u16 v25, v25 offset:2
  ds_read_u16 v26, v26 offset:4
  ds_read_u16 v27, v27 offset:6
  s_waitcnt vmcnt(4)
  v_mad_u32_u24 v28, v28, s39, v9
  v_mad_u32_u24 v29, v29, s39, v9
  v_mad_u32_u24 v30, v30, s39, v9
  v_mad_u32_u24 v31, v31, s39, v9
  ds_read_u16 v28, v28 offset:0
  ds_read_u16 v29, v29 offset:2
  ds_read_u16 v30, v30 offset:4
  ds_read_u16 v31, v31 offset:6
  s_waitcnt vmcnt(3)
  v_mad_u32_u24 v32, v32, s39, v9
  v_mad_u32_u24 v33, v33, s39, v9
  v_mad_u32_u24 v34, v34, s39, v9
  v_mad_u32_u24 v35, v35, s39, v9
  ds_read_u16 v32, v32 offset:0
  ds_read_u16 v33, v33 offset:2
  ds_read_u16 v34, v34 offset:4
  ds_read_u16 v35, v35 offset:6
  s_waitcnt vmcnt(2)
  v_mad_u32_u24 v36, v36, s39, v9
  v_mad_u32_u24 v37, v37, s39, v9
  v_mad_u32_u24 v38, v38, s39, v9
  v_mad_u32_u24 v39, v39, s39, v9
  ds_read_u16 v36, v36 offset:0
  ds_read_u16 v37, v37 offset:2
  ds_read_u16 v38, v38 offset:4
  ds_read_u16 v39, v39 offset:6
  s_waitcnt vmcnt(1)
  v_mad_u32_u24 v40, v40, s39, v9
  v_mad_u32_u24 v41, v41, s39, v9
  v_mad_u32_u24 v42, v42, s39, v9
  v_mad_u32_u24 v43, v43, s39, v9
  ds_read_u16 v40, v40 offset:0
  ds_read_u16 v41, v41 offset:2
  ds_read_u16 v42, v42 offset:4
  ds_read_u16 v43, v43 offset:6
  s_waitcnt vmcnt(0)
  v_mad_u32_u24 v44, v44, s39, v9
  v_mad_u32_u24 v45, v45, s39, v9
  v_mad_u32_u24 v46, v46, s39, v9
  v_mad_u32_u24 v47, v47, s39, v9
  ds_read_u16 v44, v44 offset:0
  ds_read_u16 v45, v45 offset:2
  ds_read_u16 v46, v46 offset:4
  ds_read_u16 v47, v47 offset:6
  s_waitcnt lgkmcnt(0)
  v_lshl_or_b32 v48, v20, 16, v16
  v_lshl_or_b32 v49, v28, 16, v24
  v_lshl_or_b32 v50, v36, 16, v32
  v_lshl_or_b32 v51, v44, 16, v40
  ds_write_b128 v12, v[48:51] offset:0
  v_lshl_or_b32 v52, v21, 16, v17
  v_lshl_or_b32 v53, v29, 16, v25
  v_lshl_or_b32 v54, v37, 16, v33
  v_lshl_or_b32 v55, v45, 16, v41
  ds_write_b128 v12, v[52:55] offset:16
  v_lshl_or_b32 v56, v22, 16, v18
  v_lshl_or_b32 v57, v30, 16, v26
  v_lshl_or_b32 v58, v38, 16, v34
  v_lshl_or_b32 v59, v46, 16, v42
  ds_write_b128 v12, v[56:59] offset:32
  v_lshl_or_b32 v60, v23, 16, v19
  v_lshl_or_b32 v61, v31, 16, v27
  v_lshl_or_b32 v62, v39, 16, v35
  v_lshl_or_b32 v63, v47, 16, v43
  ds_write_b128 v12, v[60:63] offset:48
  s_waitcnt lgkmcnt(0)
  ds_read_b128 v[16:19], v13 offset:0
  ds_read_b128 v[20:23], v13 offset:1024
  ds_read_b128 v[24:27], v13 offset:2048
  ds_read_b128 v[28:31], v13 offset:3072
  s_waitcnt lgkmcnt(3)
  buffer_store_dwordx4 v[16:19], v14, s[24:27], 0 offen offset:0
  s_waitcnt lgkmcnt(2)
  buffer_store_dwordx4 v[20:23], v14, s[24:27], 0 offen offset:1024
  s_waitcnt lgkmcnt(1)
  buffer_store_dwordx4 v[24:27], v14, s[24:27], 0 offen offset:2048
  s_waitcnt lgkmcnt(0)
  buffer_store_dwordx4 v[28:31], v15, s[24:27], 0 offen offset:3072
L1_done:
  s_endpgm
.globl mm_kernel
.p2align 8
.type mm_kernel,@function
mm_kernel:
  s_cmp_ge_u32 s2, 256
  s_cbranch_scc1 L2_done
  s_load_dwordx2 s[4:5], s[0:1], 0
  s_load_dwordx2 s[8:9], s[0:1], 24
  s_load_dwordx2 s[10:11], s[0:1], 40
  s_and_b32 s32, s2, 1
  s_lshl_b32 s32, s32, 3
  s_bfe_u32 s33, s2, 0x30003
  s_add_u32 s30, s32, s33
  s_bfe_u32 s32, s2, 0x20001
  s_lshl_b32 s32, s32, 2
  s_lshr_b32 s33, s2, 6
  s_add_u32 s31, s32, s33
  v_lshrrev_b32 v1, 6, v0
  v_and_b32 v2, 63, v0
  v_readfirstlane_b32 s33, v1
  s_cmp_ge_u32 s33, 4
  s_cbranch_scc0 L2_cons
  s_sub_u32 s33, s33, 4
  v_lshrrev_b32 v3, 3, v2
  v_lshlrev_b32 v3, 11, v3
  v_lshrrev_b32 v4, 4, v2
  v_xor_b32 v4, v4, v2
  v_and_b32 v4, 7, v4
  v_lshl_add_u32 v3, v4, 4, v3
  s_lshl_b32 s34, s30, 18
  s_lshl_b32 s35, s33, 16
  s_add_u32 s34, s34, s35
  v_add_u32 v3, s34, v3
  v_xor_b32 v4, 64, v3
  v_add_u32 v5, 30720, v3
  v_add_u32 v6, 46080, v4
  v_add_u32 v4, 15360, v4
  s_mul_i32 s34, s31, 458752
  s_mul_i32 s35, s33, 7168
  s_add_u32 s34, s34, s35
  v_lshl_add_u32 v7, v2, 4, s34
  s_lshl_b32 s40, s33, 12
  s_mul_i32 s41, s33, 7168
  s_add_u32 s41, s41, 16384
  s_mov_b32 s42, 0
  s_mov_b32 s43, 0
  s_mov_b32 s44, 0
  s_waitcnt lgkmcnt(0)
  s_mov_b32 s12, s4
  s_mov_b32 s13, s5
  s_mov_b32 s14, 4194304
  s_mov_b32 s15, 0x20000
  s_mov_b32 s16, s10
  s_mov_b32 s17, s11
  s_mov_b32 s18, 7340032
  s_mov_b32 s19, 0x20000
  s_mov_b32 s20, s8
  s_mov_b32 s21, s9
  s_mov_b32 s22, 14680064
  s_mov_b32 s23, 0x20000
  s_add_u32 m0, s44, s41
  s_add_u32 s45, s43, 4096
  buffer_load_dwordx4 v7, s[16:19], s43 offen offset:0 lds
  buffer_load_dwordx4 v7, s[16:19], s43 offen offset:1024 lds
  buffer_load_dwordx4 v7, s[16:19], s43 offen offset:2048 lds
  buffer_load_dwordx4 v7, s[16:19], s43 offen offset:3072 lds
  s_add_u32 m0, m0, 4096
  s_add_u32 s43, s43, 28672
  buffer_load_dwordx4 v7, s[16:19], s45 offen offset:0 lds
  buffer_load_dwordx4 v7, s[16:19], s45 offen offset:1024 lds
  buffer_load_dwordx4 v7, s[16:19], s45 offen offset:2048 lds
  s_add_u32 m0, s44, s40
  s_nop 0
  buffer_load_dwordx4 v3, s[12:15], s42 offen offset:0 lds
  buffer_load_dwordx4 v4, s[12:15], s42 offen offset:1024 lds
  buffer_load_dwordx4 v5, s[12:15], s42 offen offset:2048 lds
  buffer_load_dwordx4 v6, s[12:15], s42 offen offset:3072 lds
  s_add_u32 s42, s42, 128
  s_add_u32 s44, s44, 45056
  s_cmp_eq_u32 s44, 135168
  s_cselect_b32 s44, 0, s44
  s_add_u32 m0, s44, s41
  s_add_u32 s45, s43, 4096
  buffer_load_dwordx4 v7, s[16:19], s43 offen offset:0 lds
  buffer_load_dwordx4 v7, s[16:19], s43 offen offset:1024 lds
  buffer_load_dwordx4 v7, s[16:19], s43 offen offset:2048 lds
  buffer_load_dwordx4 v7, s[16:19], s43 offen offset:3072 lds
  s_add_u32 m0, m0, 4096
  s_add_u32 s43, s43, 28672
  buffer_load_dwordx4 v7, s[16:19], s45 offen offset:0 lds
  buffer_load_dwordx4 v7, s[16:19], s45 offen offset:1024 lds
  buffer_load_dwordx4 v7, s[16:19], s45 offen offset:2048 lds
  s_add_u32 m0, s44, s40
  s_nop 0
  buffer_load_dwordx4 v3, s[12:15], s42 offen offset:0 lds
  buffer_load_dwordx4 v4, s[12:15], s42 offen offset:1024 lds
  buffer_load_dwordx4 v5, s[12:15], s42 offen offset:2048 lds
  buffer_load_dwordx4 v6, s[12:15], s42 offen offset:3072 lds
  s_add_u32 s42, s42, 128
  s_add_u32 s44, s44, 45056
  s_cmp_eq_u32 s44, 135168
  s_cselect_b32 s44, 0, s44
  s_lshl_b32 s34, s30, 7
  s_lshl_b32 s35, s33, 5
  s_add_u32 s34, s34, s35
  s_mul_i32 s34, s34, 7168
  s_mul_i32 s36, s31, 448
  s_add_u32 s34, s34, s36
  s_mul_i32 s35, s35, 464
  s_add_u32 s35, s35, 45056
  s_mov_b32 s36, 464
  s_mov_b32 s37, 7168
  v_add_u32 v8, 0, v2
  v_cvt_f32_u32 v9, v8
  v_add_f32 v9, 0.5, v9
  v_mul_f32 v9, 0x3d124925, v9
  v_cvt_u32_f32 v9, v9
  v_mul_u32_u24 v10, 28, v9
  v_sub_u32 v10, v8, v10
  v_lshlrev_b32 v10, 4, v10
  v_mad_u32_u24 v16, v9, s36, v10
  v_add_u32 v16, s35, v16
  v_mad_u32_u24 v24, v9, s37, v10
  v_add_u32 v24, s34, v24
  v_add_u32 v8, 64, v2
  v_cvt_f32_u32 v9, v8
  v_add_f32 v9, 0.5, v9
  v_mul_f32 v9, 0x3d124925, v9
  v_cvt_u32_f32 v9, v9
  v_mul_u32_u24 v10, 28, v9
  v_sub_u32 v10, v8, v10
  v_lshlrev_b32 v10, 4, v10
  v_mad_u32_u24 v17, v9, s36, v10
  v_add_u32 v17, s35, v17
  v_mad_u32_u24 v25, v9, s37, v10
  v_add_u32 v25, s34, v25
  v_add_u32 v8, 128, v2
  v_cvt_f32_u32 v9, v8
  v_add_f32 v9, 0.5, v9
  v_mul_f32 v9, 0x3d124925, v9
  v_cvt_u32_f32 v9, v9
  v_mul_u32_u24 v10, 28, v9
  v_sub_u32 v10, v8, v10
  v_lshlrev_b32 v10, 4, v10
  v_mad_u32_u24 v18, v9, s36, v10
  v_add_u32 v18, s35, v18
  v_mad_u32_u24 v26, v9, s37, v10
  v_add_u32 v26, s34, v26
  v_add_u32 v8, 192, v2
  v_cvt_f32_u32 v9, v8
  v_add_f32 v9, 0.5, v9
  v_mul_f32 v9, 0x3d124925, v9
  v_cvt_u32_f32 v9, v9
  v_mul_u32_u24 v10, 28, v9
  v_sub_u32 v10, v8, v10
  v_lshlrev_b32 v10, 4, v10
  v_mad_u32_u24 v19, v9, s36, v10
  v_add_u32 v19, s35, v19
  v_mad_u32_u24 v27, v9, s37, v10
  v_add_u32 v27, s34, v27
  v_add_u32 v8, 256, v2
  v_cvt_f32_u32 v9, v8
  v_add_f32 v9, 0.5, v9
  v_mul_f32 v9, 0x3d124925, v9
  v_cvt_u32_f32 v9, v9
  v_mul_u32_u24 v10, 28, v9
  v_sub_u32 v10, v8, v10
  v_lshlrev_b32 v10, 4, v10
  v_mad_u32_u24 v20, v9, s36, v10
  v_add_u32 v20, s35, v20
  v_mad_u32_u24 v28, v9, s37, v10
  v_add_u32 v28, s34, v28
  v_add_u32 v8, 320, v2
  v_cvt_f32_u32 v9, v8
  v_add_f32 v9, 0.5, v9
  v_mul_f32 v9, 0x3d124925, v9
  v_cvt_u32_f32 v9, v9
  v_mul_u32_u24 v10, 28, v9
  v_sub_u32 v10, v8, v10
  v_lshlrev_b32 v10, 4, v10
  v_mad_u32_u24 v21, v9, s36, v10
  v_add_u32 v21, s35, v21
  v_mad_u32_u24 v29, v9, s37, v10
  v_add_u32 v29, s34, v29
  v_add_u32 v8, 384, v2
  v_cvt_f32_u32 v9, v8
  v_add_f32 v9, 0.5, v9
  v_mul_f32 v9, 0x3d124925, v9
  v_cvt_u32_f32 v9, v9
  v_mul_u32_u24 v10, 28, v9
  v_sub_u32 v10, v8, v10
  v_lshlrev_b32 v10, 4, v10
  v_mad_u32_u24 v22, v9, s36, v10
  v_add_u32 v22, s35, v22
  v_mad_u32_u24 v30, v9, s37, v10
  v_add_u32 v30, s34, v30
  s_waitcnt vmcnt(11)
  s_barrier
  s_mov_b32 s46, 0
L2_ld:
  s_add_u32 m0, s44, s41
  s_add_u32 s45, s43, 4096
  buffer_load_dwordx4 v7, s[16:19], s43 offen offset:0 lds
  buffer_load_dwordx4 v7, s[16:19], s43 offen offset:1024 lds
  buffer_load_dwordx4 v7, s[16:19], s43 offen offset:2048 lds
  buffer_load_dwordx4 v7, s[16:19], s43 offen offset:3072 lds
  s_add_u32 m0, m0, 4096
  s_add_u32 s43, s43, 28672
  buffer_load_dwordx4 v7, s[16:19], s45 offen offset:0 lds
  buffer_load_dwordx4 v7, s[16:19], s45 offen offset:1024 lds
  buffer_load_dwordx4 v7, s[16:19], s45 offen offset:2048 lds
  s_add_u32 m0, s44, s40
  s_nop 0
  buffer_load_dwordx4 v3, s[12:15], s42 offen offset:0 lds
  buffer_load_dwordx4 v4, s[12:15], s42 offen offset:1024 lds
  buffer_load_dwordx4 v5, s[12:15], s42 offen offset:2048 lds
  buffer_load_dwordx4 v6, s[12:15], s42 offen offset:3072 lds
  s_add_u32 s42, s42, 128
  s_add_u32 s44, s44, 45056
  s_cmp_eq_u32 s44, 135168
  s_cselect_b32 s44, 0, s44
  s_add_u32 s46, s46, 1
  s_cmp_lt_u32 s46, 14
  s_waitcnt vmcnt(11)
  s_barrier
  s_cbranch_scc1 L2_ld
  s_waitcnt vmcnt(0)
  s_barrier
  s_mov_b32 s38, 114688
  s_barrier
  ds_read_b128 v[32:35], v16 offset:0
  ds_read_b128 v[36:39], v17 offset:0
  ds_read_b128 v[40:43], v18 offset:0
  ds_read_b128 v[44:47], v19 offset:0
  ds_read_b128 v[48:51], v20 offset:0
  ds_read_b128 v[52:55], v21 offset:0
  ds_read_b128 v[56:59], v22 offset:0
  ds_read_b128 v[60:63], v16 offset:7424
  ds_read_b128 v[64:67], v17 offset:7424
  ds_read_b128 v[68:71], v18 offset:7424
  ds_read_b128 v[72:75], v19 offset:7424
  ds_read_b128 v[76:79], v20 offset:7424
  ds_read_b128 v[80:83], v21 offset:7424
  ds_read_b128 v[84:87], v22 offset:7424
  s_waitcnt lgkmcnt(13)
  buffer_store_dwordx4 v[32:35], v24, s[20:23], 0 offen sc0 sc1
  s_waitcnt lgkmcnt(12)
  buffer_store_dwordx4 v[36:39], v25, s[20:23], 0 offen sc0 sc1
  s_waitcnt lgkmcnt(11)
  buffer_store_dwordx4 v[40:43], v26, s[20:23], 0 offen sc0 sc1
  s_waitcnt lgkmcnt(10)
  buffer_store_dwordx4 v[44:47], v27, s[20:23], 0 offen sc0 sc1
  s_waitcnt lgkmcnt(9)
  buffer_store_dwordx4 v[48:51], v28, s[20:23], 0 offen sc0 sc1
  s_waitcnt lgkmcnt(8)
  buffer_store_dwordx4 v[52:55], v29, s[20:23], 0 offen sc0 sc1
  s_waitcnt lgkmcnt(7)
  buffer_store_dwordx4 v[56:59], v30, s[20:23], 0 offen sc0 sc1
  s_waitcnt lgkmcnt(6)
  buffer_store_dwordx4 v[60:63], v24, s[20:23], s38 offen sc0 sc1
  s_waitcnt lgkmcnt(5)
  buffer_store_dwordx4 v[64:67], v25, s[20:23], s38 offen sc0 sc1
  s_waitcnt lgkmcnt(4)
  buffer_store_dwordx4 v[68:71], v26, s[20:23], s38 offen sc0 sc1
  s_waitcnt lgkmcnt(3)
  buffer_store_dwordx4 v[72:75], v27, s[20:23], s38 offen sc0 sc1
  s_waitcnt lgkmcnt(2)
  buffer_store_dwordx4 v[76:79], v28, s[20:23], s38 offen sc0 sc1
  s_waitcnt lgkmcnt(1)
  buffer_store_dwordx4 v[80:83], v29, s[20:23], s38 offen sc0 sc1
  s_waitcnt lgkmcnt(0)
  buffer_store_dwordx4 v[84:87], v30, s[20:23], s38 offen sc0 sc1
  s_endpgm
L2_cons:
  s_lshr_b32 s34, s33, 1
  s_and_b32 s35, s33, 1
  v_and_b32 v3, 15, v2
  v_lshrrev_b32 v4, 4, v2
  v_lshrrev_b32 v5, 1, v3
  v_xor_b32 v5, v5, v4
  v_lshlrev_b32 v5, 4, v5
  v_lshl_add_u32 v8, v3, 7, v5
  s_lshl_b32 s36, s34, 13
  v_add_u32 v8, s36, v8
  v_xor_b32 v9, 64, v8
  v_mul_u32_u24 v5, 3584, v4
  v_lshl_add_u32 v10, v3, 4, v5
  s_mul_i32 s36, s35, 1792
  s_add_u32 s36, s36, 16384
  v_add_u32 v10, s36, v10
  s_mul_i32 s36, s34, 29696
  s_mul_i32 s37, s35, 224
  s_add_u32 s36, s36, s37
  s_add_u32 s36, s36, 45056
  v_mul_u32_u24 v5, 464, v3
  v_add_u32 v5, s36, v5
  v_lshl_add_u32 v11, v4, 4, v5
  v_lshl_add_u32 v12, v4, 3, v5
  v_mov_b32 v5, v8
  v_mov_b32 v6, v9
  v_mov_b32 v7, v10
  v_mov_b32 v16, 0
  v_mov_b32 v17, 0
  v_mov_b32 v18, 0
  v_mov_b32 v19, 0
  v_mov_b32 v20, 0
  v_mov_b32 v21, 0
  v_mov_b32 v22, 0
  v_mov_b32 v23, 0
  v_mov_b32 v24, 0
  v_mov_b32 v25, 0
  v_mov_b32 v26, 0
  v_mov_b32 v27, 0
  v_mov_b32 v28, 0
  v_mov_b32 v29, 0
  v_mov_b32 v30, 0
  v_mov_b32 v31, 0
  v_mov_b32 v32, 0
  v_mov_b32 v33, 0
  v_mov_b32 v34, 0
  v_mov_b32 v35, 0
  v_mov_b32 v36, 0
  v_mov_b32 v37, 0
  v_mov_b32 v38, 0
  v_mov_b32 v39, 0
  v_mov_b32 v40, 0
  v_mov_b32 v41, 0
  v_mov_b32 v42, 0
  v_mov_b32 v43, 0
  v_mov_b32 v44, 0
  v_mov_b32 v45, 0
  v_mov_b32 v46, 0
  v_mov_b32 v47, 0
  v_mov_b32 v48, 0
  v_mov_b32 v49, 0
  v_mov_b32 v50, 0
  v_mov_b32 v51, 0
  v_mov_b32 v52, 0
  v_mov_b32 v53, 0
  v_mov_b32 v54, 0
  v_mov_b32 v55, 0
  v_mov_b32 v56, 0
  v_mov_b32 v57, 0
  v_mov_b32 v58, 0
  v_mov_b32 v59, 0
  v_mov_b32 v60, 0
  v_mov_b32 v61, 0
  v_mov_b32 v62, 0
  v_mov_b32 v63, 0
  v_mov_b32 v64, 0
  v_mov_b32 v65, 0
  v_mov_b32 v66, 0
  v_mov_b32 v67, 0
  v_mov_b32 v68, 0
  v_mov_b32 v69, 0
  v_mov_b32 v70, 0
  v_mov_b32 v71, 0
  v_mov_b32 v72, 0
  v_mov_b32 v73, 0
  v_mov_b32 v74, 0
  v_mov_b32 v75, 0
  v_mov_b32 v76, 0
  v_mov_b32 v77, 0
  v_mov_b32 v78, 0
  v_mov_b32 v79, 0
  v_mov_b32 v80, 0
  v_mov_b32 v81, 0
  v_mov_b32 v82, 0
  v_mov_b32 v83, 0
  v_mov_b32 v84, 0
  v_mov_b32 v85, 0
  v_mov_b32 v86, 0
  v_mov_b32 v87, 0
  v_mov_b32 v88, 0
  v_mov_b32 v89, 0
  v_mov_b32 v90, 0
  v_mov_b32 v91, 0
  v_mov_b32 v92, 0
  v_mov_b32 v93, 0
  v_mov_b32 v94, 0
  v_mov_b32 v95, 0
  v_mov_b32 v96, 0
  v_mov_b32 v97, 0
  v_mov_b32 v98, 0
  v_mov_b32 v99, 0
  v_mov_b32 v100, 0
  v_mov_b32 v101, 0
  v_mov_b32 v102, 0
  v_mov_b32 v103, 0
  v_mov_b32 v104, 0
  v_mov_b32 v105, 0
  v_mov_b32 v106, 0
  v_mov_b32 v107, 0
  v_mov_b32 v108, 0
  v_mov_b32 v109, 0
  v_mov_b32 v110, 0
  v_mov_b32 v111, 0
  v_mov_b32 v112, 0
  v_mov_b32 v113, 0
  v_mov_b32 v114, 0
  v_mov_b32 v115, 0
  v_mov_b32 v116, 0
  v_mov_b32 v117, 0
  v_mov_b32 v118, 0
  v_mov_b32 v119, 0
  v_mov_b32 v120, 0
  v_mov_b32 v121, 0
  v_mov_b32 v122, 0
  v_mov_b32 v123, 0
  v_mov_b32 v124, 0
  v_mov_b32 v125, 0
  v_mov_b32 v126, 0
  v_mov_b32 v127, 0
  s_mov_b32 s44, 0
  s_mov_b32 s46, 0
  s_barrier
  ds_read_b128 a[16:19], v7 offset:0
  ds_read_b128 a[0:3], v5 offset:0
  ds_read_b128 a[4:7], v5 offset:2048
  ds_read_b128 a[8:11], v5 offset:4096
  ds_read_b128 a[12:15], v5 offset:6144
  ds_read_b128 a[20:23], v7 offset:256
  ds_read_b128 a[24:27], v7 offset:512
  ds_read_b128 a[28:31], v7 offset:768
  ds_read_b128 a[32:35], v7 offset:1024
  ds_read_b128 a[36:39], v7 offset:1280
  ds_read_b128 a[40:43], v7 offset:1536
  s_waitcnt lgkmcnt(0)
.p2align 6
L2_c:
  v_mfma_f32_16x16x32_bf16 v[16:19], a[16:19], a[0:3], v[16:19]
  v_mfma_f32_16x16x32_bf16 v[44:47], a[16:19], a[4:7], v[44:47]
  s_add_u32 s44, s44, 45056
  ds_read_b128 a[60:63], v7 offset:14336
  v_mfma_f32_16x16x32_bf16 v[72:75], a[16:19], a[8:11], v[72:75]
  v_mfma_f32_16x16x32_bf16 v[100:103], a[16:19], a[12:15], v[100:103]
  s_cmp_eq_u32 s44, 135168
  ds_read_b128 a[44:47], v6 offset:0
  v_mfma_f32_16x16x32_bf16 v[20:23], a[20:23], a[0:3], v[20:23]
  v_mfma_f32_16x16x32_bf16 v[48:51], a[20:23], a[4:7], v[48:51]
  s_cselect_b32 s44, 0, s44
  s_add_u32 s46, s46, 1
  ds_read_b128 a[48:51], v6 offset:2048
  v_mfma_f32_16x16x32_bf16 v[76:79], a[20:23], a[8:11], v[76:79]
  v_mfma_f32_16x16x32_bf16 v[104:107], a[20:23], a[12:15], v[104:107]
  ds_read_b128 a[52:55], v6 offset:4096
  v_mfma_f32_16x16x32_bf16 v[24:27], a[24:27], a[0:3], v[24:27]
  v_mfma_f32_16x16x32_bf16 v[52:55], a[24:27], a[4:7], v[52:55]
  ds_read_b128 a[56:59], v6 offset:6144
  v_mfma_f32_16x16x32_bf16 v[80:83], a[24:27], a[8:11], v[80:83]
  v_mfma_f32_16x16x32_bf16 v[108:111], a[24:27], a[12:15], v[108:111]
  ds_read_b128 a[64:67], v7 offset:14592
  v_mfma_f32_16x16x32_bf16 v[28:31], a[28:31], a[0:3], v[28:31]
  v_mfma_f32_16x16x32_bf16 v[56:59], a[28:31], a[4:7], v[56:59]
  ds_read_b128 a[68:71], v7 offset:14848
  v_mfma_f32_16x16x32_bf16 v[84:87], a[28:31], a[8:11], v[84:87]
  v_mfma_f32_16x16x32_bf16 v[112:115], a[28:31], a[12:15], v[112:115]
  ds_read_b128 a[72:75], v7 offset:15104
  v_mfma_f32_16x16x32_bf16 v[32:35], a[32:35], a[0:3], v[32:35]
  v_mfma_f32_16x16x32_bf16 v[60:63], a[32:35], a[4:7], v[60:63]
  ds_read_b128 a[76:79], v7 offset:15360
  v_mfma_f32_16x16x32_bf16 v[88:91], a[32:35], a[8:11], v[88:91]
  v_mfma_f32_16x16x32_bf16 v[116:119], a[32:35], a[12:15], v[116:119]
  ds_read_b128 a[80:83], v7 offset:15616
  v_mfma_f32_16x16x32_bf16 v[36:39], a[36:39], a[0:3], v[36:39]
  v_mfma_f32_16x16x32_bf16 v[64:67], a[36:39], a[4:7], v[64:67]
  ds_read_b128 a[84:87], v7 offset:15872
  v_mfma_f32_16x16x32_bf16 v[92:95], a[36:39], a[8:11], v[92:95]
  v_mfma_f32_16x16x32_bf16 v[120:123], a[36:39], a[12:15], v[120:123]
  v_mfma_f32_16x16x32_bf16 v[40:43], a[40:43], a[0:3], v[40:43]
  v_mfma_f32_16x16x32_bf16 v[68:71], a[40:43], a[4:7], v[68:71]
  v_mfma_f32_16x16x32_bf16 v[96:99], a[40:43], a[8:11], v[96:99]
  v_mfma_f32_16x16x32_bf16 v[124:127], a[40:43], a[12:15], v[124:127]
  s_waitcnt lgkmcnt(0)
  s_barrier
  v_mfma_f32_16x16x32_bf16 v[16:19], a[60:63], a[44:47], v[16:19]
  v_add_u32 v7, s44, v10
  v_add_u32 v5, s44, v8
  v_mfma_f32_16x16x32_bf16 v[44:47], a[60:63], a[48:51], v[44:47]
  ds_read_b128 a[16:19], v7 offset:0
  v_mfma_f32_16x16x32_bf16 v[72:75], a[60:63], a[52:55], v[72:75]
  v_add_u32 v6, s44, v9
  s_cmp_lt_u32 s46, 15
  v_mfma_f32_16x16x32_bf16 v[100:103], a[60:63], a[56:59], v[100:103]
  ds_read_b128 a[0:3], v5 offset:0
  v_mfma_f32_16x16x32_bf16 v[20:23], a[64:67], a[44:47], v[20:23]
  v_mfma_f32_16x16x32_bf16 v[48:51], a[64:67], a[48:51], v[48:51]
  ds_read_b128 a[4:7], v5 offset:2048
  v_mfma_f32_16x16x32_bf16 v[76:79], a[64:67], a[52:55], v[76:79]
  v_mfma_f32_16x16x32_bf16 v[104:107], a[64:67], a[56:59], v[104:107]
  ds_read_b128 a[8:11], v5 offset:4096
  v_mfma_f32_16x16x32_bf16 v[24:27], a[68:71], a[44:47], v[24:27]
  v_mfma_f32_16x16x32_bf16 v[52:55], a[68:71], a[48:51], v[52:55]
  ds_read_b128 a[12:15], v5 offset:6144
  v_mfma_f32_16x16x32_bf16 v[80:83], a[68:71], a[52:55], v[80:83]
  v_mfma_f32_16x16x32_bf16 v[108:111], a[68:71], a[56:59], v[108:111]
  ds_read_b128 a[20:23], v7 offset:256
  v_mfma_f32_16x16x32_bf16 v[28:31], a[72:75], a[44:47], v[28:31]
  v_mfma_f32_16x16x32_bf16 v[56:59], a[72:75], a[48:51], v[56:59]
  ds_read_b128 a[24:27], v7 offset:512
  v_mfma_f32_16x16x32_bf16 v[84:87], a[72:75], a[52:55], v[84:87]
  v_mfma_f32_16x16x32_bf16 v[112:115], a[72:75], a[56:59], v[112:115]
  ds_read_b128 a[28:31], v7 offset:768
  v_mfma_f32_16x16x32_bf16 v[32:35], a[76:79], a[44:47], v[32:35]
  v_mfma_f32_16x16x32_bf16 v[60:63], a[76:79], a[48:51], v[60:63]
  ds_read_b128 a[32:35], v7 offset:1024
  v_mfma_f32_16x16x32_bf16 v[88:91], a[76:79], a[52:55], v[88:91]
  v_mfma_f32_16x16x32_bf16 v[116:119], a[76:79], a[56:59], v[116:119]
  ds_read_b128 a[36:39], v7 offset:1280
  v_mfma_f32_16x16x32_bf16 v[36:39], a[80:83], a[44:47], v[36:39]
  v_mfma_f32_16x16x32_bf16 v[64:67], a[80:83], a[48:51], v[64:67]
  ds_read_b128 a[40:43], v7 offset:1536
  v_mfma_f32_16x16x32_bf16 v[92:95], a[80:83], a[52:55], v[92:95]
  v_mfma_f32_16x16x32_bf16 v[120:123], a[80:83], a[56:59], v[120:123]
  v_mfma_f32_16x16x32_bf16 v[40:43], a[84:87], a[44:47], v[40:43]
  v_mfma_f32_16x16x32_bf16 v[68:71], a[84:87], a[48:51], v[68:71]
  v_mfma_f32_16x16x32_bf16 v[96:99], a[84:87], a[52:55], v[96:99]
  v_mfma_f32_16x16x32_bf16 v[124:127], a[84:87], a[56:59], v[124:127]
  s_waitcnt lgkmcnt(0)
  s_cbranch_scc1 L2_c
  v_mfma_f32_16x16x32_bf16 v[16:19], a[16:19], a[0:3], v[16:19]
  v_mfma_f32_16x16x32_bf16 v[44:47], a[16:19], a[4:7], v[44:47]
  ds_read_b128 a[60:63], v7 offset:14336
  v_mfma_f32_16x16x32_bf16 v[72:75], a[16:19], a[8:11], v[72:75]
  v_mfma_f32_16x16x32_bf16 v[100:103], a[16:19], a[12:15], v[100:103]
  ds_read_b128 a[44:47], v6 offset:0
  v_mfma_f32_16x16x32_bf16 v[20:23], a[20:23], a[0:3], v[20:23]
  v_mfma_f32_16x16x32_bf16 v[48:51], a[20:23], a[4:7], v[48:51]
  ds_read_b128 a[48:51], v6 offset:2048
  v_mfma_f32_16x16x32_bf16 v[76:79], a[20:23], a[8:11], v[76:79]
  v_mfma_f32_16x16x32_bf16 v[104:107], a[20:23], a[12:15], v[104:107]
  ds_read_b128 a[52:55], v6 offset:4096
  v_mfma_f32_16x16x32_bf16 v[24:27], a[24:27], a[0:3], v[24:27]
  v_mfma_f32_16x16x32_bf16 v[52:55], a[24:27], a[4:7], v[52:55]
  ds_read_b128 a[56:59], v6 offset:6144
  v_mfma_f32_16x16x32_bf16 v[80:83], a[24:27], a[8:11], v[80:83]
  v_mfma_f32_16x16x32_bf16 v[108:111], a[24:27], a[12:15], v[108:111]
  ds_read_b128 a[64:67], v7 offset:14592
  v_mfma_f32_16x16x32_bf16 v[28:31], a[28:31], a[0:3], v[28:31]
  v_mfma_f32_16x16x32_bf16 v[56:59], a[28:31], a[4:7], v[56:59]
  ds_read_b128 a[68:71], v7 offset:14848
  v_mfma_f32_16x16x32_bf16 v[84:87], a[28:31], a[8:11], v[84:87]
  v_mfma_f32_16x16x32_bf16 v[112:115], a[28:31], a[12:15], v[112:115]
  ds_read_b128 a[72:75], v7 offset:15104
  v_mfma_f32_16x16x32_bf16 v[32:35], a[32:35], a[0:3], v[32:35]
  v_mfma_f32_16x16x32_bf16 v[60:63], a[32:35], a[4:7], v[60:63]
  ds_read_b128 a[76:79], v7 offset:15360
  v_mfma_f32_16x16x32_bf16 v[88:91], a[32:35], a[8:11], v[88:91]
  v_mfma_f32_16x16x32_bf16 v[116:119], a[32:35], a[12:15], v[116:119]
  ds_read_b128 a[80:83], v7 offset:15616
  v_mfma_f32_16x16x32_bf16 v[36:39], a[36:39], a[0:3], v[36:39]
  v_mfma_f32_16x16x32_bf16 v[64:67], a[36:39], a[4:7], v[64:67]
  ds_read_b128 a[84:87], v7 offset:15872
  v_mfma_f32_16x16x32_bf16 v[92:95], a[36:39], a[8:11], v[92:95]
  v_mfma_f32_16x16x32_bf16 v[120:123], a[36:39], a[12:15], v[120:123]
  v_mfma_f32_16x16x32_bf16 v[40:43], a[40:43], a[0:3], v[40:43]
  v_mfma_f32_16x16x32_bf16 v[68:71], a[40:43], a[4:7], v[68:71]
  v_mfma_f32_16x16x32_bf16 v[96:99], a[40:43], a[8:11], v[96:99]
  v_mfma_f32_16x16x32_bf16 v[124:127], a[40:43], a[12:15], v[124:127]
  s_waitcnt lgkmcnt(0)
  s_nop 0
  v_mfma_f32_16x16x32_bf16 v[16:19], a[60:63], a[44:47], v[16:19]
  v_mfma_f32_16x16x32_bf16 v[44:47], a[60:63], a[48:51], v[44:47]
  v_mfma_f32_16x16x32_bf16 v[72:75], a[60:63], a[52:55], v[72:75]
  v_mfma_f32_16x16x32_bf16 v[100:103], a[60:63], a[56:59], v[100:103]
  v_mfma_f32_16x16x32_bf16 v[20:23], a[64:67], a[44:47], v[20:23]
  v_mfma_f32_16x16x32_bf16 v[48:51], a[64:67], a[48:51], v[48:51]
  v_mfma_f32_16x16x32_bf16 v[76:79], a[64:67], a[52:55], v[76:79]
  v_mfma_f32_16x16x32_bf16 v[104:107], a[64:67], a[56:59], v[104:107]
  v_mfma_f32_16x16x32_bf16 v[24:27], a[68:71], a[44:47], v[24:27]
  v_mfma_f32_16x16x32_bf16 v[52:55], a[68:71], a[48:51], v[52:55]
  v_mfma_f32_16x16x32_bf16 v[80:83], a[68:71], a[52:55], v[80:83]
  v_mfma_f32_16x16x32_bf16 v[108:111], a[68:71], a[56:59], v[108:111]
  v_mfma_f32_16x16x32_bf16 v[28:31], a[72:75], a[44:47], v[28:31]
  v_mfma_f32_16x16x32_bf16 v[56:59], a[72:75], a[48:51], v[56:59]
  v_mfma_f32_16x16x32_bf16 v[84:87], a[72:75], a[52:55], v[84:87]
  v_mfma_f32_16x16x32_bf16 v[112:115], a[72:75], a[56:59], v[112:115]
  v_mfma_f32_16x16x32_bf16 v[32:35], a[76:79], a[44:47], v[32:35]
  v_mfma_f32_16x16x32_bf16 v[60:63], a[76:79], a[48:51], v[60:63]
  v_mfma_f32_16x16x32_bf16 v[88:91], a[76:79], a[52:55], v[88:91]
  v_mfma_f32_16x16x32_bf16 v[116:119], a[76:79], a[56:59], v[116:119]
  v_mfma_f32_16x16x32_bf16 v[36:39], a[80:83], a[44:47], v[36:39]
  v_mfma_f32_16x16x32_bf16 v[64:67], a[80:83], a[48:51], v[64:67]
  v_mfma_f32_16x16x32_bf16 v[92:95], a[80:83], a[52:55], v[92:95]
  v_mfma_f32_16x16x32_bf16 v[120:123], a[80:83], a[56:59], v[120:123]
  v_mfma_f32_16x16x32_bf16 v[40:43], a[84:87], a[44:47], v[40:43]
  v_mfma_f32_16x16x32_bf16 v[68:71], a[84:87], a[48:51], v[68:71]
  v_mfma_f32_16x16x32_bf16 v[96:99], a[84:87], a[52:55], v[96:99]
  v_mfma_f32_16x16x32_bf16 v[124:127], a[84:87], a[56:59], v[124:127]
  s_nop 7
  v_cvt_pk_bf16_f32 v128, v16, v17
  v_cvt_pk_bf16_f32 v129, v18, v19
  v_cvt_pk_bf16_f32 v130, v20, v21
  v_cvt_pk_bf16_f32 v131, v22, v23
  ds_write_b128 v11, v[128:131] offset:0
  v_cvt_pk_bf16_f32 v132, v24, v25
  v_cvt_pk_bf16_f32 v133, v26, v27
  v_cvt_pk_bf16_f32 v134, v28, v29
  v_cvt_pk_bf16_f32 v135, v30, v31
  ds_write_b128 v11, v[132:135] offset:64
  v_cvt_pk_bf16_f32 v136, v32, v33
  v_cvt_pk_bf16_f32 v137, v34, v35
  v_cvt_pk_bf16_f32 v138, v36, v37
  v_cvt_pk_bf16_f32 v139, v38, v39
  ds_write_b128 v11, v[136:139] offset:128
  v_cvt_pk_bf16_f32 v140, v40, v41
  v_cvt_pk_bf16_f32 v141, v42, v43
  ds_write_b64 v12, v[140:141] offset:192
  v_cvt_pk_bf16_f32 v128, v44, v45
  v_cvt_pk_bf16_f32 v129, v46, v47
  v_cvt_pk_bf16_f32 v130, v48, v49
  v_cvt_pk_bf16_f32 v131, v50, v51
  ds_write_b128 v11, v[128:131] offset:7424
  v_cvt_pk_bf16_f32 v132, v52, v53
  v_cvt_pk_bf16_f32 v133, v54, v55
  v_cvt_pk_bf16_f32 v134, v56, v57
  v_cvt_pk_bf16_f32 v135, v58, v59
  ds_write_b128 v11, v[132:135] offset:7488
  v_cvt_pk_bf16_f32 v136, v60, v61
  v_cvt_pk_bf16_f32 v137, v62, v63
  v_cvt_pk_bf16_f32 v138, v64, v65
  v_cvt_pk_bf16_f32 v139, v66, v67
  ds_write_b128 v11, v[136:139] offset:7552
  v_cvt_pk_bf16_f32 v140, v68, v69
  v_cvt_pk_bf16_f32 v141, v70, v71
  ds_write_b64 v12, v[140:141] offset:7616
  v_cvt_pk_bf16_f32 v128, v72, v73
  v_cvt_pk_bf16_f32 v129, v74, v75
  v_cvt_pk_bf16_f32 v130, v76, v77
  v_cvt_pk_bf16_f32 v131, v78, v79
  ds_write_b128 v11, v[128:131] offset:14848
  v_cvt_pk_bf16_f32 v132, v80, v81
  v_cvt_pk_bf16_f32 v133, v82, v83
  v_cvt_pk_bf16_f32 v134, v84, v85
  v_cvt_pk_bf16_f32 v135, v86, v87
  ds_write_b128 v11, v[132:135] offset:14912
  v_cvt_pk_bf16_f32 v136, v88, v89
  v_cvt_pk_bf16_f32 v137, v90, v91
  v_cvt_pk_bf16_f32 v138, v92, v93
  v_cvt_pk_bf16_f32 v139, v94, v95
  ds_write_b128 v11, v[136:139] offset:14976
  v_cvt_pk_bf16_f32 v140, v96, v97
  v_cvt_pk_bf16_f32 v141, v98, v99
  ds_write_b64 v12, v[140:141] offset:15040
  v_cvt_pk_bf16_f32 v128, v100, v101
  v_cvt_pk_bf16_f32 v129, v102, v103
  v_cvt_pk_bf16_f32 v130, v104, v105
  v_cvt_pk_bf16_f32 v131, v106, v107
  ds_write_b128 v11, v[128:131] offset:22272
  v_cvt_pk_bf16_f32 v132, v108, v109
  v_cvt_pk_bf16_f32 v133, v110, v111
  v_cvt_pk_bf16_f32 v134, v112, v113
  v_cvt_pk_bf16_f32 v135, v114, v115
  ds_write_b128 v11, v[132:135] offset:22336
  v_cvt_pk_bf16_f32 v136, v116, v117
  v_cvt_pk_bf16_f32 v137, v118, v119
  v_cvt_pk_bf16_f32 v138, v120, v121
  v_cvt_pk_bf16_f32 v139, v122, v123
  ds_write_b128 v11, v[136:139] offset:22400
  v_cvt_pk_bf16_f32 v140, v124, v125
  v_cvt_pk_bf16_f32 v141, v126, v127
  ds_write_b64 v12, v[140:141] offset:22464
  s_waitcnt lgkmcnt(0)
  s_barrier
L2_done:
  s_endpgm
.section .rodata,"a"
.p2align 6
.amdhsa_kernel dq_kernel
  .amdhsa_next_free_vgpr 64
  .amdhsa_next_free_sgpr 102
  .amdhsa_accum_offset 64
  .amdhsa_group_segment_fixed_size 0
  .amdhsa_kernarg_size 48
  .amdhsa_user_sgpr_count 2
  .amdhsa_user_sgpr_kernarg_segment_ptr 1
  .amdhsa_system_sgpr_workgroup_id_x 1
.end_amdhsa_kernel
.p2align 6
.amdhsa_kernel mm_kernel
  .amdhsa_next_free_vgpr 232
  .amdhsa_next_free_sgpr 102
  .amdhsa_accum_offset 144
  .amdhsa_group_segment_fixed_size 0
  .amdhsa_kernarg_size 48
  .amdhsa_user_sgpr_count 2
  .amdhsa_user_sgpr_kernarg_segment_ptr 1
  .amdhsa_system_sgpr_workgroup_id_x 1
.end_amdhsa_kernel
```

```asm
; @launch grid=(256,1,1) block=(512,1,1) lds=150016
.amdgcn_target "amdgcn-amd-amdhsa--gfx950"
.text
.globl standalone__weight_only_int_squeezellm__prompt_kernel
.p2align 8
.type standalone__weight_only_int_squeezellm__prompt_kernel,@function
standalone__weight_only_int_squeezellm__prompt_kernel:
  s_cmp_ge_u32 s2, 256
  s_cbranch_scc1 L_done
  s_load_dwordx2 s[20:21], s[0:1], 8
  s_load_dwordx2 s[24:25], s[0:1], 16
  s_load_dwordx2 s[28:29], s[0:1], 40
  s_load_dwordx2 s[16:17], s[0:1], 0
  s_load_dwordx2 s[32:33], s[0:1], 24
  s_mov_b32 s18, 4194304
  s_mov_b32 s19, 0x20000
  s_mov_b32 s22, 14680064
  s_mov_b32 s23, 0x20000
  s_mov_b32 s26, 114688
  s_mov_b32 s27, 0x20000
  s_mov_b32 s30, 9441280
  s_mov_b32 s31, 0x20000
  s_mov_b32 s34, 14680064
  s_mov_b32 s35, 0x20000
  s_and_b32 s3, s2, 1
  s_lshr_b32 s15, s2, 5
  s_lshl_b32 s36, s3, 3
  s_add_u32 s36, s36, s15
  s_and_b32 s14, s15, 3
  s_lshl_b32 s14, s14, 1
  s_add_u32 s14, s14, s3
  s_and_b32 s15, s15, 4
  s_lshl_b32 s15, s15, 1
  s_add_u32 s14, s14, s15
  s_bfe_u32 s3, s2, 0x20001
  s_lshl_b32 s3, s3, 2
  s_bfe_u32 s37, s2, 0x20003
  s_add_u32 s37, s37, s3
  v_lshrrev_b32 v1, 6, v0
  v_and_b32 v2, 63, v0
  v_readfirstlane_b32 s38, v1
  s_mov_b32 s41, 14336
  s_mov_b32 s42, 28672
  s_mov_b32 s43, 43008
  s_mov_b32 s44, 57344
  s_mov_b32 s45, 71680
  s_mov_b32 s46, 86016
  s_mov_b32 s47, 100352
  s_and_b32 s39, s38, 3
  v_and_b32 v3, 255, v0
  s_mov_b32 s48, 224
  s_mov_b32 s49, 111
  s_mov_b32 s56, 448
  v_cmp_gt_u32 vcc, s48, v3
  v_mov_b32 v15, 0x7ff00000
  s_mul_i32 s52, s14, 114688
  s_mul_i32 s53, s37, 896
  s_add_u32 s52, s52, s53
  v_lshl_add_u32 v4, v3, 2, s52
  v_cndmask_b32 v4, v15, v4, vcc
  v_lshlrev_b32 v5, 1, v3
  v_add_u32 v5, 135168, v5
  s_lshl_b32 s50, s37, 7
  s_add_u32 s50, s50, 9437184
  s_cmp_ge_u32 s38, 4
  s_cbranch_scc1 L_loader
  s_waitcnt lgkmcnt(0)
  buffer_load_dword v128, v4, s[20:23], 0 offen
  buffer_load_dword v129, v4, s[20:23], s41 offen
  buffer_load_dword v130, v4, s[20:23], s42 offen
  buffer_load_dword v131, v4, s[20:23], s43 offen
  buffer_load_dword v132, v4, s[20:23], s44 offen
  buffer_load_dword v133, v4, s[20:23], s45 offen
  buffer_load_dword v134, v4, s[20:23], s46 offen
  buffer_load_dword v135, v4, s[20:23], s47 offen
  s_add_u32 s10, s28, s50
  s_addc_u32 s11, s29, 0
  s_load_dwordx2 s[6:7], s[10:11], 0
  v_add_u32 v14, 1835008, v4
  buffer_load_dword v136, v14, s[20:23], 0 offen
  buffer_load_dword v137, v14, s[20:23], s41 offen
  buffer_load_dword v138, v14, s[20:23], s42 offen
  buffer_load_dword v139, v14, s[20:23], s43 offen
  buffer_load_dword v140, v14, s[20:23], s44 offen
  buffer_load_dword v141, v14, s[20:23], s45 offen
  buffer_load_dword v142, v14, s[20:23], s46 offen
  buffer_load_dword v143, v14, s[20:23], s47 offen
  v_cmp_lt_u32 s[54:55], s49, v3
  v_subrev_u32 v6, 112, v3
  v_mov_b32 v1, 1792
  v_cndmask_b32 v6, v3, v6, s[54:55]
  v_cndmask_b32 v1, 0, v1, s[54:55]
  v_lshrrev_b32 v7, 2, v6
  v_and_b32 v14, 24, v7
  v_and_b32 v9, 1, v7
  v_lshl_add_u32 v14, v9, 2, v14
  v_bfe_u32 v9, v7, 1, 2
  v_add_u32 v14, v14, v9
  v_cmp_lt_u32 s[54:55], 23, v7
  v_and_b32 v6, 3, v6
  v_cmp_gt_u32 vcc, s48, v3
  v_cndmask_b32 v14, v14, v7, s[54:55]
  v_lshl_add_u32 v14, v14, 2, v6
  s_mul_i32 s52, s37, 458752
  s_mul_i32 s53, s14, 3584
  s_add_u32 s52, s52, s53
  v_add_u32 v1, s52, v1
  v_lshl_add_u32 v6, v14, 4, v1
  v_cndmask_b32 v6, v15, v6, vcc
  s_lshl_b32 s52, s37, 15
  s_add_u32 s52, s52, 7340032
  s_lshr_b32 s53, s14, 1
  s_lshl_b32 s53, s53, 9
  s_add_u32 s53, s53, s52
  s_and_b32 s54, s14, 1
  s_lshl_b32 s54, s54, 2
  s_add_u32 s54, s54, s39
  s_lshl_b32 s54, s54, 3
  s_add_u32 s53, s53, s54
  v_lshl_add_u32 v7, v2, 7, s53
  s_and_b32 s53, s36, 3
  s_lshl_b32 s53, s53, 7
  s_lshl_b32 s54, s39, 9
  s_add_u32 s53, s53, s54
  s_add_u32 s53, s53, s52
  s_add_u32 s4, s28, s53
  s_addc_u32 s5, s29, 0
  s_lshr_b32 s52, s38, 1
  s_and_b32 s53, s38, 1
  v_and_b32 v3, 15, v2
  v_lshrrev_b32 v9, 4, v2
  v_lshrrev_b32 v1, 1, v3
  v_xor_b32 v1, v1, v9
  v_lshlrev_b32 v1, 4, v1
  v_lshl_add_u32 v144, v3, 7, v1
  s_lshl_b32 s54, s52, 13
  v_add_u32 v144, s54, v144
  v_xor_b32 v145, 64, v144
  v_mul_u32_u24 v1, 3584, v9
  v_lshl_add_u32 v146, v3, 4, v1
  s_mul_i32 s54, s53, 1792
  s_add_u32 s54, s54, 16384
  v_add_u32 v146, s54, v146
  s_mul_i32 s55, s53, 224
  v_mul_u32_u24 v1, 464, v3
  v_add_u32 v1, s55, v1
  v_lshl_add_u32 v147, v9, 4, v1
  v_lshl_add_u32 v148, v9, 3, v1

  s_mul_i32 s54, s52, 14848
  s_add_u32 s54, s54, 45056
  s_mul_i32 s55, s52, 60416
  s_add_u32 s55, s55, 74752
  v_add_u32 v149, s55, v147
  v_add_u32 v150, s55, v148
  v_add_u32 v147, s54, v147
  v_add_u32 v148, s54, v148
  s_waitcnt lgkmcnt(0)
  s_mul_i32 s8, s6, 1664525
  s_mul_i32 s9, s7, 22695477
  s_add_u32 s8, s8, 1013904223
  s_add_u32 s9, s9, 1
  v_mov_b32 v10, s8
  v_mov_b32 v11, s9
  s_barrier
  s_waitcnt vmcnt(8)
  v_mad_u32_u24 v128, v128, s56, v5
  v_mad_u32_u24 v129, v129, s56, v5
  v_mad_u32_u24 v130, v130, s56, v5
  v_mad_u32_u24 v131, v131, s56, v5
  v_mad_u32_u24 v132, v132, s56, v5
  v_mad_u32_u24 v133, v133, s56, v5
  v_mad_u32_u24 v134, v134, s56, v5
  v_mad_u32_u24 v135, v135, s56, v5
  ds_read_u16 v128, v128
  ds_read_u16 v129, v129
  ds_read_u16 v130, v130
  ds_read_u16 v131, v131
  ds_read_u16 v132, v132
  ds_read_u16 v133, v133
  ds_read_u16 v134, v134
  ds_read_u16 v135, v135
  s_waitcnt lgkmcnt(6)
  v_lshl_or_b32 v16, v129, 16, v128
  s_waitcnt lgkmcnt(4)
  v_lshl_or_b32 v17, v131, 16, v130
  s_waitcnt lgkmcnt(2)
  v_lshl_or_b32 v18, v133, 16, v132
  s_waitcnt lgkmcnt(0)
  v_lshl_or_b32 v19, v135, 16, v134
  s_mov_b32 s59, 0
  buffer_store_dwordx4 v[16:19], v6, s[28:31], s59 offen sc1
  s_waitcnt vmcnt(1)
  v_mad_u32_u24 v136, v136, s56, v5
  v_mad_u32_u24 v137, v137, s56, v5
  v_mad_u32_u24 v138, v138, s56, v5
  v_mad_u32_u24 v139, v139, s56, v5
  v_mad_u32_u24 v140, v140, s56, v5
  v_mad_u32_u24 v141, v141, s56, v5
  v_mad_u32_u24 v142, v142, s56, v5
  v_mad_u32_u24 v143, v143, s56, v5
  ds_read_u16 v136, v136
  ds_read_u16 v137, v137
  ds_read_u16 v138, v138
  ds_read_u16 v139, v139
  ds_read_u16 v140, v140
  ds_read_u16 v141, v141
  ds_read_u16 v142, v142
  ds_read_u16 v143, v143
  s_waitcnt lgkmcnt(6)
  v_lshl_or_b32 v20, v137, 16, v136
  s_waitcnt lgkmcnt(4)
  v_lshl_or_b32 v21, v139, 16, v138
  s_waitcnt lgkmcnt(2)
  v_lshl_or_b32 v22, v141, 16, v140
  s_waitcnt lgkmcnt(0)
  v_lshl_or_b32 v23, v143, 16, v142
  s_mov_b32 s59, 57344
  buffer_store_dwordx4 v[20:23], v6, s[28:31], s59 offen sc1
  v_add_u32 v14, 3670016, v4
  buffer_load_dword v64, v14, s[20:23], 0 offen
  buffer_load_dword v65, v14, s[20:23], s41 offen
  buffer_load_dword v66, v14, s[20:23], s42 offen
  buffer_load_dword v67, v14, s[20:23], s43 offen
  buffer_load_dword v68, v14, s[20:23], s44 offen
  buffer_load_dword v69, v14, s[20:23], s45 offen
  buffer_load_dword v70, v14, s[20:23], s46 offen
  buffer_load_dword v71, v14, s[20:23], s47 offen
  v_add_u32 v14, 5505024, v4
  buffer_load_dword v72, v14, s[20:23], 0 offen
  buffer_load_dword v73, v14, s[20:23], s41 offen
  buffer_load_dword v74, v14, s[20:23], s42 offen
  buffer_load_dword v75, v14, s[20:23], s43 offen
  buffer_load_dword v76, v14, s[20:23], s44 offen
  buffer_load_dword v77, v14, s[20:23], s45 offen
  buffer_load_dword v78, v14, s[20:23], s46 offen
  buffer_load_dword v79, v14, s[20:23], s47 offen
  s_waitcnt vmcnt(17)
  s_mov_b64 exec, 15
  s_mov_b32 s59, 0
  buffer_store_dwordx2 v[10:11], v7, s[28:31], s59 offen sc1
  s_mov_b64 exec, -1
  s_waitcnt vmcnt(17)
  s_mov_b64 exec, 15
  s_mov_b32 s59, 4096
  buffer_store_dwordx2 v[10:11], v7, s[28:31], s59 offen sc1
  s_mov_b64 exec, -1
  s_waitcnt vmcnt(10)
  v_mad_u32_u24 v64, v64, s56, v5
  v_mad_u32_u24 v65, v65, s56, v5
  v_mad_u32_u24 v66, v66, s56, v5
  v_mad_u32_u24 v67, v67, s56, v5
  v_mad_u32_u24 v68, v68, s56, v5
  v_mad_u32_u24 v69, v69, s56, v5
  v_mad_u32_u24 v70, v70, s56, v5
  v_mad_u32_u24 v71, v71, s56, v5
  ds_read_u16 v64, v64
  ds_read_u16 v65, v65
  ds_read_u16 v66, v66
  ds_read_u16 v67, v67
  ds_read_u16 v68, v68
  ds_read_u16 v69, v69
  ds_read_u16 v70, v70
  ds_read_u16 v71, v71
  s_waitcnt lgkmcnt(6)
  v_lshl_or_b32 v24, v65, 16, v64
  s_waitcnt lgkmcnt(4)
  v_lshl_or_b32 v25, v67, 16, v66
  s_waitcnt lgkmcnt(2)
  v_lshl_or_b32 v26, v69, 16, v68
  s_waitcnt lgkmcnt(0)
  v_lshl_or_b32 v27, v71, 16, v70
  s_mov_b32 s59, 114688
  buffer_store_dwordx4 v[24:27], v6, s[28:31], s59 offen sc1
  s_waitcnt vmcnt(3)
  v_mad_u32_u24 v72, v72, s56, v5
  v_mad_u32_u24 v73, v73, s56, v5
  v_mad_u32_u24 v74, v74, s56, v5
  v_mad_u32_u24 v75, v75, s56, v5
  v_mad_u32_u24 v76, v76, s56, v5
  v_mad_u32_u24 v77, v77, s56, v5
  v_mad_u32_u24 v78, v78, s56, v5
  v_mad_u32_u24 v79, v79, s56, v5
  ds_read_u16 v72, v72
  ds_read_u16 v73, v73
  ds_read_u16 v74, v74
  ds_read_u16 v75, v75
  ds_read_u16 v76, v76
  ds_read_u16 v77, v77
  ds_read_u16 v78, v78
  ds_read_u16 v79, v79
  s_waitcnt lgkmcnt(6)
  v_lshl_or_b32 v28, v73, 16, v72
  s_waitcnt lgkmcnt(4)
  v_lshl_or_b32 v29, v75, 16, v74
  s_waitcnt lgkmcnt(2)
  v_lshl_or_b32 v30, v77, 16, v76
  s_waitcnt lgkmcnt(0)
  v_lshl_or_b32 v31, v79, 16, v78
  s_mov_b32 s59, 172032
  buffer_store_dwordx4 v[28:31], v6, s[28:31], s59 offen sc1
  s_waitcnt vmcnt(1)
  s_mov_b64 exec, 15
  s_mov_b32 s59, 8192
  buffer_store_dwordx2 v[10:11], v7, s[28:31], s59 offen sc1
  s_mov_b64 exec, -1
  s_waitcnt vmcnt(1)
  s_mov_b64 exec, 15
  s_mov_b32 s59, 12288
  buffer_store_dwordx2 v[10:11], v7, s[28:31], s59 offen sc1
  s_mov_b64 exec, -1
  v_mov_b32 v5, v144
  v_mov_b32 v6, v145
  v_mov_b32 v7, v146
  v_mov_b32 v16, 0
  v_mov_b32 v17, 0
  v_mov_b32 v18, 0
  v_mov_b32 v19, 0
  v_mov_b32 v20, 0
  v_mov_b32 v21, 0
  v_mov_b32 v22, 0
  v_mov_b32 v23, 0
  v_mov_b32 v24, 0
  v_mov_b32 v25, 0
  v_mov_b32 v26, 0
  v_mov_b32 v27, 0
  v_mov_b32 v28, 0
  v_mov_b32 v29, 0
  v_mov_b32 v30, 0
  v_mov_b32 v31, 0
  v_mov_b32 v32, 0
  v_mov_b32 v33, 0
  v_mov_b32 v34, 0
  v_mov_b32 v35, 0
  v_mov_b32 v36, 0
  v_mov_b32 v37, 0
  v_mov_b32 v38, 0
  v_mov_b32 v39, 0
  v_mov_b32 v40, 0
  v_mov_b32 v41, 0
  v_mov_b32 v42, 0
  v_mov_b32 v43, 0
  v_mov_b32 v44, 0
  v_mov_b32 v45, 0
  v_mov_b32 v46, 0
  v_mov_b32 v47, 0
  v_mov_b32 v48, 0
  v_mov_b32 v49, 0
  v_mov_b32 v50, 0
  v_mov_b32 v51, 0
  v_mov_b32 v52, 0
  v_mov_b32 v53, 0
  v_mov_b32 v54, 0
  v_mov_b32 v55, 0
  v_mov_b32 v56, 0
  v_mov_b32 v57, 0
  v_mov_b32 v58, 0
  v_mov_b32 v59, 0
  v_mov_b32 v60, 0
  v_mov_b32 v61, 0
  v_mov_b32 v62, 0
  v_mov_b32 v63, 0
  v_mov_b32 v64, 0
  v_mov_b32 v65, 0
  v_mov_b32 v66, 0
  v_mov_b32 v67, 0
  v_mov_b32 v68, 0
  v_mov_b32 v69, 0
  v_mov_b32 v70, 0
  v_mov_b32 v71, 0
  v_mov_b32 v72, 0
  v_mov_b32 v73, 0
  v_mov_b32 v74, 0
  v_mov_b32 v75, 0
  v_mov_b32 v76, 0
  v_mov_b32 v77, 0
  v_mov_b32 v78, 0
  v_mov_b32 v79, 0
  v_mov_b32 v80, 0
  v_mov_b32 v81, 0
  v_mov_b32 v82, 0
  v_mov_b32 v83, 0
  v_mov_b32 v84, 0
  v_mov_b32 v85, 0
  v_mov_b32 v86, 0
  v_mov_b32 v87, 0
  v_mov_b32 v88, 0
  v_mov_b32 v89, 0
  v_mov_b32 v90, 0
  v_mov_b32 v91, 0
  v_mov_b32 v92, 0
  v_mov_b32 v93, 0
  v_mov_b32 v94, 0
  v_mov_b32 v95, 0
  v_mov_b32 v96, 0
  v_mov_b32 v97, 0
  v_mov_b32 v98, 0
  v_mov_b32 v99, 0
  v_mov_b32 v100, 0
  v_mov_b32 v101, 0
  v_mov_b32 v102, 0
  v_mov_b32 v103, 0
  v_mov_b32 v104, 0
  v_mov_b32 v105, 0
  v_mov_b32 v106, 0
  v_mov_b32 v107, 0
  v_mov_b32 v108, 0
  v_mov_b32 v109, 0
  v_mov_b32 v110, 0
  v_mov_b32 v111, 0
  v_mov_b32 v112, 0
  v_mov_b32 v113, 0
  v_mov_b32 v114, 0
  v_mov_b32 v115, 0
  v_mov_b32 v116, 0
  v_mov_b32 v117, 0
  v_mov_b32 v118, 0
  v_mov_b32 v119, 0
  v_mov_b32 v120, 0
  v_mov_b32 v121, 0
  v_mov_b32 v122, 0
  v_mov_b32 v123, 0
  v_mov_b32 v124, 0
  v_mov_b32 v125, 0
  v_mov_b32 v126, 0
  v_mov_b32 v127, 0
  s_mov_b32 s44, 0
  s_mov_b32 s46, 0
  s_barrier
  ds_read_b128 a[16:19], v7 offset:0
  ds_read_b128 a[0:3], v5 offset:0
  ds_read_b128 a[4:7], v5 offset:2048
  ds_read_b128 a[8:11], v5 offset:4096
  ds_read_b128 a[12:15], v5 offset:6144
  ds_read_b128 a[20:23], v7 offset:256
  ds_read_b128 a[24:27], v7 offset:512
  ds_read_b128 a[28:31], v7 offset:768
  ds_read_b128 a[32:35], v7 offset:1024
  ds_read_b128 a[36:39], v7 offset:1280
  ds_read_b128 a[40:43], v7 offset:1536
  s_waitcnt lgkmcnt(0)
.p2align 6
L_c:
  v_mfma_f32_16x16x32_bf16 v[16:19], a[16:19], a[0:3], v[16:19]
  v_mfma_f32_16x16x32_bf16 v[44:47], a[16:19], a[4:7], v[44:47]
  s_add_u32 s44, s44, 45056
  ds_read_b128 a[60:63], v7 offset:14336
  v_mfma_f32_16x16x32_bf16 v[72:75], a[16:19], a[8:11], v[72:75]
  v_mfma_f32_16x16x32_bf16 v[100:103], a[16:19], a[12:15], v[100:103]
  s_cmp_eq_u32 s44, 135168
  ds_read_b128 a[44:47], v6 offset:0
  v_mfma_f32_16x16x32_bf16 v[20:23], a[20:23], a[0:3], v[20:23]
  v_mfma_f32_16x16x32_bf16 v[48:51], a[20:23], a[4:7], v[48:51]
  s_cselect_b32 s44, 0, s44
  s_add_u32 s46, s46, 1
  ds_read_b128 a[48:51], v6 offset:2048
  v_mfma_f32_16x16x32_bf16 v[76:79], a[20:23], a[8:11], v[76:79]
  v_mfma_f32_16x16x32_bf16 v[104:107], a[20:23], a[12:15], v[104:107]
  ds_read_b128 a[52:55], v6 offset:4096
  v_mfma_f32_16x16x32_bf16 v[24:27], a[24:27], a[0:3], v[24:27]
  v_mfma_f32_16x16x32_bf16 v[52:55], a[24:27], a[4:7], v[52:55]
  ds_read_b128 a[56:59], v6 offset:6144
  v_mfma_f32_16x16x32_bf16 v[80:83], a[24:27], a[8:11], v[80:83]
  v_mfma_f32_16x16x32_bf16 v[108:111], a[24:27], a[12:15], v[108:111]
  ds_read_b128 a[64:67], v7 offset:14592
  v_mfma_f32_16x16x32_bf16 v[28:31], a[28:31], a[0:3], v[28:31]
  v_mfma_f32_16x16x32_bf16 v[56:59], a[28:31], a[4:7], v[56:59]
  ds_read_b128 a[68:71], v7 offset:14848
  v_mfma_f32_16x16x32_bf16 v[84:87], a[28:31], a[8:11], v[84:87]
  v_mfma_f32_16x16x32_bf16 v[112:115], a[28:31], a[12:15], v[112:115]
  ds_read_b128 a[72:75], v7 offset:15104
  v_mfma_f32_16x16x32_bf16 v[32:35], a[32:35], a[0:3], v[32:35]
  v_mfma_f32_16x16x32_bf16 v[60:63], a[32:35], a[4:7], v[60:63]
  ds_read_b128 a[76:79], v7 offset:15360
  v_mfma_f32_16x16x32_bf16 v[88:91], a[32:35], a[8:11], v[88:91]
  v_mfma_f32_16x16x32_bf16 v[116:119], a[32:35], a[12:15], v[116:119]
  ds_read_b128 a[80:83], v7 offset:15616
  v_mfma_f32_16x16x32_bf16 v[36:39], a[36:39], a[0:3], v[36:39]
  v_mfma_f32_16x16x32_bf16 v[64:67], a[36:39], a[4:7], v[64:67]
  ds_read_b128 a[84:87], v7 offset:15872
  v_mfma_f32_16x16x32_bf16 v[92:95], a[36:39], a[8:11], v[92:95]
  v_mfma_f32_16x16x32_bf16 v[120:123], a[36:39], a[12:15], v[120:123]
  v_mfma_f32_16x16x32_bf16 v[40:43], a[40:43], a[0:3], v[40:43]
  v_mfma_f32_16x16x32_bf16 v[68:71], a[40:43], a[4:7], v[68:71]
  v_mfma_f32_16x16x32_bf16 v[96:99], a[40:43], a[8:11], v[96:99]
  v_mfma_f32_16x16x32_bf16 v[124:127], a[40:43], a[12:15], v[124:127]
  s_waitcnt lgkmcnt(0)
  s_barrier
  v_mfma_f32_16x16x32_bf16 v[16:19], a[60:63], a[44:47], v[16:19]
  v_add_u32 v7, s44, v146
  v_add_u32 v5, s44, v144
  v_mfma_f32_16x16x32_bf16 v[44:47], a[60:63], a[48:51], v[44:47]
  ds_read_b128 a[16:19], v7 offset:0
  v_mfma_f32_16x16x32_bf16 v[72:75], a[60:63], a[52:55], v[72:75]
  v_add_u32 v6, s44, v145
  s_cmp_lt_u32 s46, 13
  v_mfma_f32_16x16x32_bf16 v[100:103], a[60:63], a[56:59], v[100:103]
  ds_read_b128 a[0:3], v5 offset:0
  v_mfma_f32_16x16x32_bf16 v[20:23], a[64:67], a[44:47], v[20:23]
  v_mfma_f32_16x16x32_bf16 v[48:51], a[64:67], a[48:51], v[48:51]
  ds_read_b128 a[4:7], v5 offset:2048
  v_mfma_f32_16x16x32_bf16 v[76:79], a[64:67], a[52:55], v[76:79]
  v_mfma_f32_16x16x32_bf16 v[104:107], a[64:67], a[56:59], v[104:107]
  ds_read_b128 a[8:11], v5 offset:4096
  v_mfma_f32_16x16x32_bf16 v[24:27], a[68:71], a[44:47], v[24:27]
  v_mfma_f32_16x16x32_bf16 v[52:55], a[68:71], a[48:51], v[52:55]
  ds_read_b128 a[12:15], v5 offset:6144
  v_mfma_f32_16x16x32_bf16 v[80:83], a[68:71], a[52:55], v[80:83]
  v_mfma_f32_16x16x32_bf16 v[108:111], a[68:71], a[56:59], v[108:111]
  ds_read_b128 a[20:23], v7 offset:256
  v_mfma_f32_16x16x32_bf16 v[28:31], a[72:75], a[44:47], v[28:31]
  v_mfma_f32_16x16x32_bf16 v[56:59], a[72:75], a[48:51], v[56:59]
  ds_read_b128 a[24:27], v7 offset:512
  v_mfma_f32_16x16x32_bf16 v[84:87], a[72:75], a[52:55], v[84:87]
  v_mfma_f32_16x16x32_bf16 v[112:115], a[72:75], a[56:59], v[112:115]
  ds_read_b128 a[28:31], v7 offset:768
  v_mfma_f32_16x16x32_bf16 v[32:35], a[76:79], a[44:47], v[32:35]
  v_mfma_f32_16x16x32_bf16 v[60:63], a[76:79], a[48:51], v[60:63]
  ds_read_b128 a[32:35], v7 offset:1024
  v_mfma_f32_16x16x32_bf16 v[88:91], a[76:79], a[52:55], v[88:91]
  v_mfma_f32_16x16x32_bf16 v[116:119], a[76:79], a[56:59], v[116:119]
  ds_read_b128 a[36:39], v7 offset:1280
  v_mfma_f32_16x16x32_bf16 v[36:39], a[80:83], a[44:47], v[36:39]
  v_mfma_f32_16x16x32_bf16 v[64:67], a[80:83], a[48:51], v[64:67]
  ds_read_b128 a[40:43], v7 offset:1536
  v_mfma_f32_16x16x32_bf16 v[92:95], a[80:83], a[52:55], v[92:95]
  v_mfma_f32_16x16x32_bf16 v[120:123], a[80:83], a[56:59], v[120:123]
  v_mfma_f32_16x16x32_bf16 v[40:43], a[84:87], a[44:47], v[40:43]
  v_mfma_f32_16x16x32_bf16 v[68:71], a[84:87], a[48:51], v[68:71]
  v_mfma_f32_16x16x32_bf16 v[96:99], a[84:87], a[52:55], v[96:99]
  v_mfma_f32_16x16x32_bf16 v[124:127], a[84:87], a[56:59], v[124:127]
  s_waitcnt lgkmcnt(0)
  s_cbranch_scc1 L_c
  v_mfma_f32_16x16x32_bf16 v[16:19], a[16:19], a[0:3], v[16:19]
  v_mfma_f32_16x16x32_bf16 v[44:47], a[16:19], a[4:7], v[44:47]
  ds_read_b128 a[60:63], v7 offset:14336
  v_mfma_f32_16x16x32_bf16 v[72:75], a[16:19], a[8:11], v[72:75]
  v_mfma_f32_16x16x32_bf16 v[100:103], a[16:19], a[12:15], v[100:103]
  ds_read_b128 a[44:47], v6 offset:0
  v_mfma_f32_16x16x32_bf16 v[20:23], a[20:23], a[0:3], v[20:23]
  v_mfma_f32_16x16x32_bf16 v[48:51], a[20:23], a[4:7], v[48:51]
  ds_read_b128 a[48:51], v6 offset:2048
  v_mfma_f32_16x16x32_bf16 v[76:79], a[20:23], a[8:11], v[76:79]
  v_mfma_f32_16x16x32_bf16 v[104:107], a[20:23], a[12:15], v[104:107]
  ds_read_b128 a[52:55], v6 offset:4096
  v_mfma_f32_16x16x32_bf16 v[24:27], a[24:27], a[0:3], v[24:27]
  v_mfma_f32_16x16x32_bf16 v[52:55], a[24:27], a[4:7], v[52:55]
  ds_read_b128 a[56:59], v6 offset:6144
  v_mfma_f32_16x16x32_bf16 v[80:83], a[24:27], a[8:11], v[80:83]
  v_mfma_f32_16x16x32_bf16 v[108:111], a[24:27], a[12:15], v[108:111]
  ds_read_b128 a[64:67], v7 offset:14592
  v_mfma_f32_16x16x32_bf16 v[28:31], a[28:31], a[0:3], v[28:31]
  v_mfma_f32_16x16x32_bf16 v[56:59], a[28:31], a[4:7], v[56:59]
  ds_read_b128 a[68:71], v7 offset:14848
  v_mfma_f32_16x16x32_bf16 v[84:87], a[28:31], a[8:11], v[84:87]
  v_mfma_f32_16x16x32_bf16 v[112:115], a[28:31], a[12:15], v[112:115]
  ds_read_b128 a[72:75], v7 offset:15104
  v_mfma_f32_16x16x32_bf16 v[32:35], a[32:35], a[0:3], v[32:35]
  v_mfma_f32_16x16x32_bf16 v[60:63], a[32:35], a[4:7], v[60:63]
  ds_read_b128 a[76:79], v7 offset:15360
  v_mfma_f32_16x16x32_bf16 v[88:91], a[32:35], a[8:11], v[88:91]
  v_mfma_f32_16x16x32_bf16 v[116:119], a[32:35], a[12:15], v[116:119]
  ds_read_b128 a[80:83], v7 offset:15616
  v_mfma_f32_16x16x32_bf16 v[36:39], a[36:39], a[0:3], v[36:39]
  v_mfma_f32_16x16x32_bf16 v[64:67], a[36:39], a[4:7], v[64:67]
  ds_read_b128 a[84:87], v7 offset:15872
  v_mfma_f32_16x16x32_bf16 v[92:95], a[36:39], a[8:11], v[92:95]
  v_mfma_f32_16x16x32_bf16 v[120:123], a[36:39], a[12:15], v[120:123]
  v_mfma_f32_16x16x32_bf16 v[40:43], a[40:43], a[0:3], v[40:43]
  v_mfma_f32_16x16x32_bf16 v[68:71], a[40:43], a[4:7], v[68:71]
  v_mfma_f32_16x16x32_bf16 v[96:99], a[40:43], a[8:11], v[96:99]
  v_mfma_f32_16x16x32_bf16 v[124:127], a[40:43], a[12:15], v[124:127]
  s_waitcnt lgkmcnt(0)
  s_barrier
  v_mfma_f32_16x16x32_bf16 v[16:19], a[60:63], a[44:47], v[16:19]
  v_add_u32 v7, 90112, v146
  v_add_u32 v5, 90112, v144
  v_mfma_f32_16x16x32_bf16 v[44:47], a[60:63], a[48:51], v[44:47]
  v_mfma_f32_16x16x32_bf16 v[72:75], a[60:63], a[52:55], v[72:75]
  v_add_u32 v6, 90112, v145
  v_mfma_f32_16x16x32_bf16 v[100:103], a[60:63], a[56:59], v[100:103]
  ds_read_b128 a[16:19], v7 offset:0
  v_mfma_f32_16x16x32_bf16 v[20:23], a[64:67], a[44:47], v[20:23]
  v_mfma_f32_16x16x32_bf16 v[48:51], a[64:67], a[48:51], v[48:51]
  ds_read_b128 a[0:3], v5 offset:0
  v_mfma_f32_16x16x32_bf16 v[76:79], a[64:67], a[52:55], v[76:79]
  v_mfma_f32_16x16x32_bf16 v[104:107], a[64:67], a[56:59], v[104:107]
  ds_read_b128 a[4:7], v5 offset:2048
  v_mfma_f32_16x16x32_bf16 v[24:27], a[68:71], a[44:47], v[24:27]
  v_mfma_f32_16x16x32_bf16 v[52:55], a[68:71], a[48:51], v[52:55]
  ds_read_b128 a[20:23], v7 offset:256
  v_mfma_f32_16x16x32_bf16 v[80:83], a[68:71], a[52:55], v[80:83]
  v_mfma_f32_16x16x32_bf16 v[108:111], a[68:71], a[56:59], v[108:111]
  ds_read_b128 a[24:27], v7 offset:512
  v_mfma_f32_16x16x32_bf16 v[28:31], a[72:75], a[44:47], v[28:31]
  v_mfma_f32_16x16x32_bf16 v[56:59], a[72:75], a[48:51], v[56:59]
  ds_read_b128 a[28:31], v7 offset:768
  v_mfma_f32_16x16x32_bf16 v[84:87], a[72:75], a[52:55], v[84:87]
  v_mfma_f32_16x16x32_bf16 v[112:115], a[72:75], a[56:59], v[112:115]
  ds_read_b128 a[32:35], v7 offset:1024
  v_mfma_f32_16x16x32_bf16 v[32:35], a[76:79], a[44:47], v[32:35]
  v_mfma_f32_16x16x32_bf16 v[60:63], a[76:79], a[48:51], v[60:63]
  ds_read_b128 a[36:39], v7 offset:1280
  v_mfma_f32_16x16x32_bf16 v[88:91], a[76:79], a[52:55], v[88:91]
  v_mfma_f32_16x16x32_bf16 v[116:119], a[76:79], a[56:59], v[116:119]
  ds_read_b128 a[40:43], v7 offset:1536
  v_mfma_f32_16x16x32_bf16 v[36:39], a[80:83], a[44:47], v[36:39]
  v_mfma_f32_16x16x32_bf16 v[64:67], a[80:83], a[48:51], v[64:67]
  v_mfma_f32_16x16x32_bf16 v[92:95], a[80:83], a[52:55], v[92:95]
  v_mfma_f32_16x16x32_bf16 v[120:123], a[80:83], a[56:59], v[120:123]
  v_mfma_f32_16x16x32_bf16 v[40:43], a[84:87], a[44:47], v[40:43]
  v_mfma_f32_16x16x32_bf16 v[68:71], a[84:87], a[48:51], v[68:71]
  v_mfma_f32_16x16x32_bf16 v[96:99], a[84:87], a[52:55], v[96:99]
  v_mfma_f32_16x16x32_bf16 v[124:127], a[84:87], a[56:59], v[124:127]
  s_waitcnt lgkmcnt(0)
  s_nop 0
  v_mfma_f32_16x16x32_bf16 v[16:19], a[16:19], a[0:3], v[16:19]
  ds_read_b128 a[60:63], v7 offset:14336
  v_mfma_f32_16x16x32_bf16 v[44:47], a[16:19], a[4:7], v[44:47]
  ds_read_b128 a[44:47], v6 offset:0
  v_mfma_f32_16x16x32_bf16 v[20:23], a[20:23], a[0:3], v[20:23]
  ds_read_b128 a[48:51], v6 offset:2048
  v_mfma_f32_16x16x32_bf16 v[48:51], a[20:23], a[4:7], v[48:51]
  ds_read_b128 a[64:67], v7 offset:14592
  v_mfma_f32_16x16x32_bf16 v[24:27], a[24:27], a[0:3], v[24:27]
  ds_read_b128 a[68:71], v7 offset:14848
  v_mfma_f32_16x16x32_bf16 v[52:55], a[24:27], a[4:7], v[52:55]
  ds_read_b128 a[72:75], v7 offset:15104
  v_mfma_f32_16x16x32_bf16 v[28:31], a[28:31], a[0:3], v[28:31]
  ds_read_b128 a[76:79], v7 offset:15360
  v_mfma_f32_16x16x32_bf16 v[56:59], a[28:31], a[4:7], v[56:59]
  ds_read_b128 a[80:83], v7 offset:15616
  v_mfma_f32_16x16x32_bf16 v[32:35], a[32:35], a[0:3], v[32:35]
  ds_read_b128 a[84:87], v7 offset:15872
  v_mfma_f32_16x16x32_bf16 v[60:63], a[32:35], a[4:7], v[60:63]
  v_mfma_f32_16x16x32_bf16 v[36:39], a[36:39], a[0:3], v[36:39]
  v_mfma_f32_16x16x32_bf16 v[64:67], a[36:39], a[4:7], v[64:67]
  v_mfma_f32_16x16x32_bf16 v[40:43], a[40:43], a[0:3], v[40:43]
  v_mfma_f32_16x16x32_bf16 v[68:71], a[40:43], a[4:7], v[68:71]
  s_waitcnt lgkmcnt(0)
  s_barrier
  v_mfma_f32_16x16x32_bf16 v[16:19], a[60:63], a[44:47], v[16:19]
  ds_read_b128 a[16:19], v146 offset:0
  v_mfma_f32_16x16x32_bf16 v[44:47], a[60:63], a[48:51], v[44:47]
  ds_read_b128 a[0:3], v144 offset:0
  v_mfma_f32_16x16x32_bf16 v[20:23], a[64:67], a[44:47], v[20:23]
  ds_read_b128 a[4:7], v144 offset:2048
  v_mfma_f32_16x16x32_bf16 v[48:51], a[64:67], a[48:51], v[48:51]
  ds_read_b128 a[20:23], v146 offset:256
  v_mfma_f32_16x16x32_bf16 v[24:27], a[68:71], a[44:47], v[24:27]
  ds_read_b128 a[24:27], v146 offset:512
  v_mfma_f32_16x16x32_bf16 v[52:55], a[68:71], a[48:51], v[52:55]
  ds_read_b128 a[28:31], v146 offset:768
  v_mfma_f32_16x16x32_bf16 v[28:31], a[72:75], a[44:47], v[28:31]
  ds_read_b128 a[32:35], v146 offset:1024
  v_mfma_f32_16x16x32_bf16 v[56:59], a[72:75], a[48:51], v[56:59]
  ds_read_b128 a[36:39], v146 offset:1280
  v_mfma_f32_16x16x32_bf16 v[32:35], a[76:79], a[44:47], v[32:35]
  ds_read_b128 a[40:43], v146 offset:1536
  v_mfma_f32_16x16x32_bf16 v[60:63], a[76:79], a[48:51], v[60:63]
  v_mfma_f32_16x16x32_bf16 v[36:39], a[80:83], a[44:47], v[36:39]
  v_mfma_f32_16x16x32_bf16 v[64:67], a[80:83], a[48:51], v[64:67]
  v_mfma_f32_16x16x32_bf16 v[40:43], a[84:87], a[44:47], v[40:43]
  v_mfma_f32_16x16x32_bf16 v[68:71], a[84:87], a[48:51], v[68:71]
  s_waitcnt lgkmcnt(0)
  s_nop 0
  v_mfma_f32_16x16x32_bf16 v[16:19], a[16:19], a[0:3], v[16:19]
  ds_read_b128 a[60:63], v146 offset:14336
  v_mfma_f32_16x16x32_bf16 v[44:47], a[16:19], a[4:7], v[44:47]
  ds_read_b128 a[44:47], v145 offset:0
  v_mfma_f32_16x16x32_bf16 v[20:23], a[20:23], a[0:3], v[20:23]
  ds_read_b128 a[48:51], v145 offset:2048
  v_mfma_f32_16x16x32_bf16 v[48:51], a[20:23], a[4:7], v[48:51]
  ds_read_b128 a[64:67], v146 offset:14592
  v_mfma_f32_16x16x32_bf16 v[24:27], a[24:27], a[0:3], v[24:27]
  ds_read_b128 a[68:71], v146 offset:14848
  v_mfma_f32_16x16x32_bf16 v[52:55], a[24:27], a[4:7], v[52:55]
  ds_read_b128 a[72:75], v146 offset:15104
  v_mfma_f32_16x16x32_bf16 v[28:31], a[28:31], a[0:3], v[28:31]
  ds_read_b128 a[76:79], v146 offset:15360
  v_mfma_f32_16x16x32_bf16 v[56:59], a[28:31], a[4:7], v[56:59]
  ds_read_b128 a[80:83], v146 offset:15616
  v_mfma_f32_16x16x32_bf16 v[32:35], a[32:35], a[0:3], v[32:35]
  ds_read_b128 a[84:87], v146 offset:15872
  v_mfma_f32_16x16x32_bf16 v[60:63], a[32:35], a[4:7], v[60:63]
  v_mfma_f32_16x16x32_bf16 v[36:39], a[36:39], a[0:3], v[36:39]
  v_mfma_f32_16x16x32_bf16 v[64:67], a[36:39], a[4:7], v[64:67]
  v_mfma_f32_16x16x32_bf16 v[40:43], a[40:43], a[0:3], v[40:43]
  v_mfma_f32_16x16x32_bf16 v[68:71], a[40:43], a[4:7], v[68:71]
  s_waitcnt lgkmcnt(0)
  s_nop 0
  v_mfma_f32_16x16x32_bf16 v[16:19], a[60:63], a[44:47], v[16:19]
  ds_read_b128 a[16:19], v7 offset:0
  v_mfma_f32_16x16x32_bf16 v[20:23], a[64:67], a[44:47], v[20:23]
  ds_read_b128 a[8:11], v5 offset:4096
  v_mfma_f32_16x16x32_bf16 v[24:27], a[68:71], a[44:47], v[24:27]
  ds_read_b128 a[12:15], v5 offset:6144
  v_mfma_f32_16x16x32_bf16 v[28:31], a[72:75], a[44:47], v[28:31]
  ds_read_b128 a[20:23], v7 offset:256
  v_mfma_f32_16x16x32_bf16 v[32:35], a[76:79], a[44:47], v[32:35]
  ds_read_b128 a[24:27], v7 offset:512
  v_mfma_f32_16x16x32_bf16 v[36:39], a[80:83], a[44:47], v[36:39]
  ds_read_b128 a[28:31], v7 offset:768
  v_mfma_f32_16x16x32_bf16 v[40:43], a[84:87], a[44:47], v[40:43]
  ds_read_b128 a[32:35], v7 offset:1024
  v_mfma_f32_16x16x32_bf16 v[44:47], a[60:63], a[48:51], v[44:47]
  ds_read_b128 a[36:39], v7 offset:1280
  v_mfma_f32_16x16x32_bf16 v[48:51], a[64:67], a[48:51], v[48:51]
  ds_read_b128 a[40:43], v7 offset:1536
  v_mfma_f32_16x16x32_bf16 v[52:55], a[68:71], a[48:51], v[52:55]
  v_mfma_f32_16x16x32_bf16 v[56:59], a[72:75], a[48:51], v[56:59]
  v_mfma_f32_16x16x32_bf16 v[60:63], a[76:79], a[48:51], v[60:63]
  v_mfma_f32_16x16x32_bf16 v[64:67], a[80:83], a[48:51], v[64:67]
  v_mfma_f32_16x16x32_bf16 v[68:71], a[84:87], a[48:51], v[68:71]
  s_waitcnt lgkmcnt(0)
  s_nop 0
  v_mfma_f32_16x16x32_bf16 v[72:75], a[16:19], a[8:11], v[72:75]
  ds_read_b128 a[60:63], v7 offset:14336
  v_cvt_pk_bf16_f32 v128, v16, v17
  v_cvt_pk_bf16_f32 v129, v18, v19
  v_mfma_f32_16x16x32_bf16 v[100:103], a[16:19], a[12:15], v[100:103]
  ds_read_b128 a[52:55], v6 offset:4096
  v_cvt_pk_bf16_f32 v130, v20, v21
  v_mfma_f32_16x16x32_bf16 v[76:79], a[20:23], a[8:11], v[76:79]
  ds_read_b128 a[56:59], v6 offset:6144
  v_cvt_pk_bf16_f32 v131, v22, v23
  ds_write_b128 v147, v[128:131] offset:0
  v_mfma_f32_16x16x32_bf16 v[104:107], a[20:23], a[12:15], v[104:107]
  ds_read_b128 a[64:67], v7 offset:14592
  v_cvt_pk_bf16_f32 v132, v24, v25
  v_mfma_f32_16x16x32_bf16 v[80:83], a[24:27], a[8:11], v[80:83]
  ds_read_b128 a[68:71], v7 offset:14848
  v_cvt_pk_bf16_f32 v133, v26, v27
  v_cvt_pk_bf16_f32 v134, v28, v29
  v_mfma_f32_16x16x32_bf16 v[108:111], a[24:27], a[12:15], v[108:111]
  ds_read_b128 a[72:75], v7 offset:15104
  v_cvt_pk_bf16_f32 v135, v30, v31
  v_mfma_f32_16x16x32_bf16 v[84:87], a[28:31], a[8:11], v[84:87]
  ds_read_b128 a[76:79], v7 offset:15360
  ds_write_b128 v147, v[132:135] offset:64
  v_mfma_f32_16x16x32_bf16 v[112:115], a[28:31], a[12:15], v[112:115]
  ds_read_b128 a[80:83], v7 offset:15616
  v_cvt_pk_bf16_f32 v128, v32, v33
  v_cvt_pk_bf16_f32 v129, v34, v35
  v_mfma_f32_16x16x32_bf16 v[88:91], a[32:35], a[8:11], v[88:91]
  ds_read_b128 a[84:87], v7 offset:15872
  v_cvt_pk_bf16_f32 v130, v36, v37
  v_mfma_f32_16x16x32_bf16 v[116:119], a[32:35], a[12:15], v[116:119]
  v_cvt_pk_bf16_f32 v131, v38, v39
  ds_write_b128 v147, v[128:131] offset:128
  v_mfma_f32_16x16x32_bf16 v[92:95], a[36:39], a[8:11], v[92:95]
  v_cvt_pk_bf16_f32 v132, v40, v41
  v_mfma_f32_16x16x32_bf16 v[120:123], a[36:39], a[12:15], v[120:123]
  v_cvt_pk_bf16_f32 v133, v42, v43
  ds_write_b64 v148, v[132:133] offset:192
  v_mfma_f32_16x16x32_bf16 v[96:99], a[40:43], a[8:11], v[96:99]
  v_cvt_pk_bf16_f32 v136, v44, v45
  v_mfma_f32_16x16x32_bf16 v[124:127], a[40:43], a[12:15], v[124:127]
  v_cvt_pk_bf16_f32 v137, v46, v47
  s_waitcnt lgkmcnt(0)
  s_nop 0
  v_mfma_f32_16x16x32_bf16 v[72:75], a[60:63], a[52:55], v[72:75]
  ds_read_b128 a[16:19], v146 offset:0
  v_cvt_pk_bf16_f32 v138, v48, v49
  v_cvt_pk_bf16_f32 v139, v50, v51
  v_mfma_f32_16x16x32_bf16 v[100:103], a[60:63], a[56:59], v[100:103]
  ds_read_b128 a[8:11], v144 offset:4096
  ds_write_b128 v147, v[136:139] offset:7424
  v_mfma_f32_16x16x32_bf16 v[76:79], a[64:67], a[52:55], v[76:79]
  ds_read_b128 a[12:15], v144 offset:6144
  v_cvt_pk_bf16_f32 v140, v52, v53
  v_cvt_pk_bf16_f32 v141, v54, v55
  v_mfma_f32_16x16x32_bf16 v[104:107], a[64:67], a[56:59], v[104:107]
  ds_read_b128 a[20:23], v146 offset:256
  v_cvt_pk_bf16_f32 v142, v56, v57
  v_mfma_f32_16x16x32_bf16 v[80:83], a[68:71], a[52:55], v[80:83]
  ds_read_b128 a[24:27], v146 offset:512
  v_cvt_pk_bf16_f32 v143, v58, v59
  ds_write_b128 v147, v[140:143] offset:7488
  v_mfma_f32_16x16x32_bf16 v[108:111], a[68:71], a[56:59], v[108:111]
  ds_read_b128 a[28:31], v146 offset:768
  v_cvt_pk_bf16_f32 v136, v60, v61
  v_mfma_f32_16x16x32_bf16 v[84:87], a[72:75], a[52:55], v[84:87]
  ds_read_b128 a[32:35], v146 offset:1024
  v_cvt_pk_bf16_f32 v137, v62, v63
  v_cvt_pk_bf16_f32 v138, v64, v65
  v_mfma_f32_16x16x32_bf16 v[112:115], a[72:75], a[56:59], v[112:115]
  ds_read_b128 a[36:39], v146 offset:1280
  v_cvt_pk_bf16_f32 v139, v66, v67
  v_mfma_f32_16x16x32_bf16 v[88:91], a[76:79], a[52:55], v[88:91]
  ds_read_b128 a[40:43], v146 offset:1536
  ds_write_b128 v147, v[136:139] offset:7552
  v_cvt_pk_bf16_f32 v140, v68, v69
  v_mfma_f32_16x16x32_bf16 v[116:119], a[76:79], a[56:59], v[116:119]
  v_cvt_pk_bf16_f32 v141, v70, v71
  v_mfma_f32_16x16x32_bf16 v[92:95], a[80:83], a[52:55], v[92:95]
  ds_write_b64 v148, v[140:141] offset:7616
  v_mfma_f32_16x16x32_bf16 v[120:123], a[80:83], a[56:59], v[120:123]
  v_mfma_f32_16x16x32_bf16 v[96:99], a[84:87], a[52:55], v[96:99]
  v_mfma_f32_16x16x32_bf16 v[124:127], a[84:87], a[56:59], v[124:127]
  s_waitcnt lgkmcnt(0)
  s_barrier
  v_mfma_f32_16x16x32_bf16 v[72:75], a[16:19], a[8:11], v[72:75]
  ds_read_b128 a[60:63], v146 offset:14336
  v_mfma_f32_16x16x32_bf16 v[100:103], a[16:19], a[12:15], v[100:103]
  ds_read_b128 a[52:55], v145 offset:4096
  v_mfma_f32_16x16x32_bf16 v[76:79], a[20:23], a[8:11], v[76:79]
  ds_read_b128 a[56:59], v145 offset:6144
  v_mfma_f32_16x16x32_bf16 v[104:107], a[20:23], a[12:15], v[104:107]
  ds_read_b128 a[64:67], v146 offset:14592
  v_mfma_f32_16x16x32_bf16 v[80:83], a[24:27], a[8:11], v[80:83]
  ds_read_b128 a[68:71], v146 offset:14848
  v_mfma_f32_16x16x32_bf16 v[108:111], a[24:27], a[12:15], v[108:111]
  ds_read_b128 a[72:75], v146 offset:15104
  v_mfma_f32_16x16x32_bf16 v[84:87], a[28:31], a[8:11], v[84:87]
  ds_read_b128 a[76:79], v146 offset:15360
  v_mfma_f32_16x16x32_bf16 v[112:115], a[28:31], a[12:15], v[112:115]
  ds_read_b128 a[80:83], v146 offset:15616
  v_mfma_f32_16x16x32_bf16 v[88:91], a[32:35], a[8:11], v[88:91]
  ds_read_b128 a[84:87], v146 offset:15872
  v_mfma_f32_16x16x32_bf16 v[116:119], a[32:35], a[12:15], v[116:119]
  v_mfma_f32_16x16x32_bf16 v[92:95], a[36:39], a[8:11], v[92:95]
  v_mfma_f32_16x16x32_bf16 v[120:123], a[36:39], a[12:15], v[120:123]
  v_mfma_f32_16x16x32_bf16 v[96:99], a[40:43], a[8:11], v[96:99]
  v_mfma_f32_16x16x32_bf16 v[124:127], a[40:43], a[12:15], v[124:127]
  s_waitcnt lgkmcnt(0)
  s_nop 0
  v_mfma_f32_16x16x32_bf16 v[72:75], a[60:63], a[52:55], v[72:75]
  v_mfma_f32_16x16x32_bf16 v[76:79], a[64:67], a[52:55], v[76:79]
  v_mfma_f32_16x16x32_bf16 v[80:83], a[68:71], a[52:55], v[80:83]
  v_mfma_f32_16x16x32_bf16 v[84:87], a[72:75], a[52:55], v[84:87]
  v_mfma_f32_16x16x32_bf16 v[88:91], a[76:79], a[52:55], v[88:91]
  v_mfma_f32_16x16x32_bf16 v[92:95], a[80:83], a[52:55], v[92:95]
  v_mfma_f32_16x16x32_bf16 v[96:99], a[84:87], a[52:55], v[96:99]
  v_mfma_f32_16x16x32_bf16 v[100:103], a[60:63], a[56:59], v[100:103]
  v_mfma_f32_16x16x32_bf16 v[104:107], a[64:67], a[56:59], v[104:107]
  v_mfma_f32_16x16x32_bf16 v[108:111], a[68:71], a[56:59], v[108:111]
  v_mfma_f32_16x16x32_bf16 v[112:115], a[72:75], a[56:59], v[112:115]
  v_cvt_pk_bf16_f32 v128, v72, v73
  v_cvt_pk_bf16_f32 v129, v74, v75
  v_cvt_pk_bf16_f32 v130, v76, v77
  v_cvt_pk_bf16_f32 v131, v78, v79
  ds_write_b128 v149, v[128:131] offset:0
  v_cvt_pk_bf16_f32 v132, v80, v81
  v_cvt_pk_bf16_f32 v133, v82, v83
  v_cvt_pk_bf16_f32 v134, v84, v85
  v_mfma_f32_16x16x32_bf16 v[116:119], a[76:79], a[56:59], v[116:119]
  v_mfma_f32_16x16x32_bf16 v[120:123], a[80:83], a[56:59], v[120:123]
  v_mfma_f32_16x16x32_bf16 v[124:127], a[84:87], a[56:59], v[124:127]
  v_cvt_pk_bf16_f32 v135, v86, v87
  ds_write_b128 v149, v[132:135] offset:64
  v_cvt_pk_bf16_f32 v128, v88, v89
  v_cvt_pk_bf16_f32 v129, v90, v91
  v_cvt_pk_bf16_f32 v130, v92, v93
  v_cvt_pk_bf16_f32 v131, v94, v95
  ds_write_b128 v149, v[128:131] offset:128
  v_cvt_pk_bf16_f32 v132, v96, v97
  v_cvt_pk_bf16_f32 v133, v98, v99
  ds_write_b64 v150, v[132:133] offset:192
  v_cvt_pk_bf16_f32 v136, v100, v101
  v_cvt_pk_bf16_f32 v137, v102, v103
  v_cvt_pk_bf16_f32 v138, v104, v105
  v_cvt_pk_bf16_f32 v139, v106, v107
  ds_write_b128 v149, v[136:139] offset:7424
  v_cvt_pk_bf16_f32 v140, v108, v109
  v_cvt_pk_bf16_f32 v141, v110, v111
  v_cvt_pk_bf16_f32 v142, v112, v113
  v_cvt_pk_bf16_f32 v143, v114, v115
  ds_write_b128 v149, v[140:143] offset:7488
  v_cvt_pk_bf16_f32 v136, v116, v117
  v_cvt_pk_bf16_f32 v137, v118, v119
  v_cvt_pk_bf16_f32 v138, v120, v121
  v_cvt_pk_bf16_f32 v139, v122, v123
  ds_write_b128 v149, v[136:139] offset:7552
  v_cvt_pk_bf16_f32 v140, v124, v125
  v_cvt_pk_bf16_f32 v141, v126, v127
  ds_write_b64 v150, v[140:141] offset:7616
  s_waitcnt lgkmcnt(0)
  s_barrier
  s_endpgm
L_loader:
  s_lshl_b32 s52, s39, 7
  v_add_u32 v16, s52, v2
  s_mul_i32 s51, s37, 448
  s_lshl_b32 s54, s39, 11
  s_add_u32 m0, s54, 135168
  v_cvt_f32_u32 v19, v16
  v_add_f32 v19, 0.5, v19
  v_mul_f32 v19, 0x3d124925, v19
  v_cvt_u32_f32 v19, v19
  v_mul_u32_u24 v20, 28, v19
  v_sub_u32 v20, v16, v20
  v_mul_u32_u24 v19, 7168, v19
  v_lshl_add_u32 v22, v20, 4, v19
  v_add_u32 v16, 64, v16
  v_cvt_f32_u32 v19, v16
  v_add_f32 v19, 0.5, v19
  v_mul_f32 v19, 0x3d124925, v19
  v_cvt_u32_f32 v19, v19
  v_mul_u32_u24 v20, 28, v19
  v_sub_u32 v20, v16, v20
  v_mul_u32_u24 v19, 7168, v19
  v_lshl_add_u32 v23, v20, 4, v19
  v_lshrrev_b32 v20, 3, v2
  v_lshlrev_b32 v20, 11, v20
  v_lshrrev_b32 v1, 4, v2
  v_xor_b32 v1, v1, v2
  v_and_b32 v1, 7, v1
  v_lshl_add_u32 v20, v1, 4, v20
  s_lshl_b32 s52, s36, 18
  s_lshl_b32 s53, s39, 16
  s_add_u32 s53, s52, s53
  v_add_u32 v16, s53, v20
  v_xor_b32 v17, 64, v16
  v_add_u32 v18, 30720, v16
  v_add_u32 v19, 46080, v17
  v_add_u32 v17, 15360, v17
  s_lshl_b32 s60, s39, 12
  s_waitcnt lgkmcnt(0)
  buffer_load_dwordx4 v22, s[24:27], s51 offen lds
  s_add_u32 m0, m0, 1024
  s_nop 0
  buffer_load_dwordx4 v23, s[24:27], s51 offen lds
  s_add_u32 m0, s60, 0
  s_mov_b32 s62, 0
  buffer_load_dwordx4 v16, s[16:19], s62 offen offset:0 lds
  buffer_load_dwordx4 v17, s[16:19], s62 offen offset:1024 lds
  buffer_load_dwordx4 v18, s[16:19], s62 offen offset:2048 lds
  buffer_load_dwordx4 v19, s[16:19], s62 offen offset:3072 lds
  s_add_u32 s10, s28, s50
  s_addc_u32 s11, s29, 0
  s_load_dwordx2 s[6:7], s[10:11], 0
  s_mul_i32 s53, s37, 458752
  s_mul_i32 s54, s39, 7168
  s_add_u32 s53, s53, s54
  v_lshl_add_u32 v20, v2, 4, s53
  s_add_u32 s61, s54, 16384
  s_lshl_b32 s53, s37, 14
  s_add_u32 s52, s52, s53
  s_lshl_b32 s53, s39, 12
  s_add_u32 s52, s52, s53
  v_cmp_gt_u32 vcc, 32, v2
  v_lshl_add_u32 v21, v2, 7, s52
  v_mov_b32 v8, s50
  v_cndmask_b32 v21, v15, v21, vcc
  v_cmp_lt_u32 s[54:55], s49, v3
  v_subrev_u32 v6, 112, v3
  v_mov_b32 v1, 1792
  v_cndmask_b32 v6, v3, v6, s[54:55]
  v_cndmask_b32 v1, 0, v1, s[54:55]
  v_lshrrev_b32 v7, 2, v6
  v_and_b32 v14, 24, v7
  v_and_b32 v9, 1, v7
  v_lshl_add_u32 v14, v9, 2, v14
  v_bfe_u32 v9, v7, 1, 2
  v_add_u32 v14, v14, v9
  v_cmp_lt_u32 s[54:55], 23, v7
  v_and_b32 v6, 3, v6
  v_cmp_gt_u32 vcc, s48, v3
  v_cndmask_b32 v14, v14, v7, s[54:55]
  v_lshl_add_u32 v14, v14, 2, v6
  s_mul_i32 s52, s37, 458752
  s_mul_i32 s53, s14, 3584
  s_add_u32 s52, s52, s53
  v_add_u32 v1, s52, v1
  v_lshl_add_u32 v6, v14, 4, v1
  v_cndmask_b32 v6, v15, v6, vcc
  s_lshl_b32 s52, s37, 15
  s_add_u32 s52, s52, 7340032
  s_lshr_b32 s53, s14, 1
  s_lshl_b32 s53, s53, 9
  s_add_u32 s53, s53, s52
  s_and_b32 s54, s14, 1
  s_lshl_b32 s54, s54, 2
  s_add_u32 s54, s54, s39
  s_lshl_b32 s54, s54, 3
  s_add_u32 s53, s53, s54
  v_lshl_add_u32 v7, v2, 7, s53
  s_and_b32 s53, s36, 3
  s_lshl_b32 s53, s53, 7
  s_lshl_b32 s54, s39, 9
  s_add_u32 s53, s53, s54
  s_add_u32 s53, s53, s52
  s_add_u32 s4, s28, s53
  s_addc_u32 s5, s29, 0
  s_waitcnt lgkmcnt(0)
  s_mul_i32 s8, s6, 1664525
  s_mul_i32 s9, s7, 22695477
  s_add_u32 s8, s8, 1013904223
  s_add_u32 s9, s9, 1
  v_mov_b32 v10, s8
  v_mov_b32 v11, s9
  v_mov_b32 v12, s6
  v_mov_b32 v13, s7
  s_waitcnt vmcnt(4)
  s_barrier
  s_lshr_b32 s54, s39, 1
  s_and_b32 s55, s39, 1
  s_lshl_b32 s52, s36, 7
  s_lshl_b32 s53, s54, 6
  s_add_u32 s52, s52, s53
  s_lshl_b32 s53, s55, 4
  s_add_u32 s52, s52, s53
  s_mul_i32 s52, s52, 7168
  s_mul_i32 s53, s37, 448
  s_add_u32 s52, s52, s53
  s_mul_i32 s53, s54, 14848
  s_mul_i32 s57, s54, 45568
  s_mul_i32 s55, s55, 7424
  s_add_u32 s53, s53, s55
  s_add_u32 s53, s53, 45056
  s_add_u32 s57, s57, 29696
  s_mov_b32 s54, 464
  s_mov_b32 s55, 7168
  v_add_u32 v40, 0, v2
  v_cvt_f32_u32 v41, v40
  v_add_f32 v41, 0.5, v41
  v_mul_f32 v41, 0x3d124925, v41
  v_cvt_u32_f32 v41, v41
  v_mul_u32_u24 v42, 28, v41
  v_sub_u32 v42, v40, v42
  v_lshlrev_b32 v42, 4, v42
  v_mad_u32_u24 v24, v41, s54, v42
  v_add_u32 v24, s53, v24
  v_mad_u32_u24 v32, v41, s55, v42
  v_add_u32 v32, s52, v32
  v_add_u32 v40, 64, v2
  v_cvt_f32_u32 v41, v40
  v_add_f32 v41, 0.5, v41
  v_mul_f32 v41, 0x3d124925, v41
  v_cvt_u32_f32 v41, v41
  v_mul_u32_u24 v42, 28, v41
  v_sub_u32 v42, v40, v42
  v_lshlrev_b32 v42, 4, v42
  v_mad_u32_u24 v25, v41, s54, v42
  v_add_u32 v25, s53, v25
  v_mad_u32_u24 v33, v41, s55, v42
  v_add_u32 v33, s52, v33
  v_add_u32 v40, 128, v2
  v_cvt_f32_u32 v41, v40
  v_add_f32 v41, 0.5, v41
  v_mul_f32 v41, 0x3d124925, v41
  v_cvt_u32_f32 v41, v41
  v_mul_u32_u24 v42, 28, v41
  v_sub_u32 v42, v40, v42
  v_lshlrev_b32 v42, 4, v42
  v_mad_u32_u24 v26, v41, s54, v42
  v_add_u32 v26, s53, v26
  v_mad_u32_u24 v34, v41, s55, v42
  v_add_u32 v34, s52, v34
  v_add_u32 v40, 192, v2
  v_cvt_f32_u32 v41, v40
  v_add_f32 v41, 0.5, v41
  v_mul_f32 v41, 0x3d124925, v41
  v_cvt_u32_f32 v41, v41
  v_mul_u32_u24 v42, 28, v41
  v_sub_u32 v42, v40, v42
  v_lshlrev_b32 v42, 4, v42
  v_mad_u32_u24 v27, v41, s54, v42
  v_add_u32 v27, s53, v27
  v_mad_u32_u24 v35, v41, s55, v42
  v_add_u32 v35, s52, v35
  v_add_u32 v40, 256, v2
  v_cvt_f32_u32 v41, v40
  v_add_f32 v41, 0.5, v41
  v_mul_f32 v41, 0x3d124925, v41
  v_cvt_u32_f32 v41, v41
  v_mul_u32_u24 v42, 28, v41
  v_sub_u32 v42, v40, v42
  v_lshlrev_b32 v42, 4, v42
  v_mad_u32_u24 v28, v41, s54, v42
  v_add_u32 v28, s53, v28
  v_mad_u32_u24 v36, v41, s55, v42
  v_add_u32 v36, s52, v36
  v_add_u32 v40, 320, v2
  v_cvt_f32_u32 v41, v40
  v_add_f32 v41, 0.5, v41
  v_mul_f32 v41, 0x3d124925, v41
  v_cvt_u32_f32 v41, v41
  v_mul_u32_u24 v42, 28, v41
  v_sub_u32 v42, v40, v42
  v_lshlrev_b32 v42, 4, v42
  v_mad_u32_u24 v29, v41, s54, v42
  v_add_u32 v29, s53, v29
  v_mad_u32_u24 v37, v41, s55, v42
  v_add_u32 v37, s52, v37
  v_add_u32 v40, 384, v2
  v_cvt_f32_u32 v41, v40
  v_add_f32 v41, 0.5, v41
  v_mul_f32 v41, 0x3d124925, v41
  v_cvt_u32_f32 v41, v41
  v_mul_u32_u24 v42, 28, v41
  v_sub_u32 v42, v40, v42
  v_lshlrev_b32 v42, 4, v42
  v_mad_u32_u24 v30, v41, s54, v42
  v_add_u32 v30, s53, v30
  v_mad_u32_u24 v38, v41, s55, v42
  v_add_u32 v38, s52, v38
  s_load_dwordx16 s[64:79], s[4:5], 0 glc
  s_mov_b32 s63, 0
L_sp0:
  s_waitcnt lgkmcnt(0)
  s_xor_b64 s[10:11], s[64:65], s[8:9]
  s_xor_b64 s[12:13], s[66:67], s[8:9]
  s_or_b64 s[10:11], s[10:11], s[12:13]
  s_xor_b64 s[12:13], s[68:69], s[8:9]
  s_or_b64 s[10:11], s[10:11], s[12:13]
  s_xor_b64 s[12:13], s[70:71], s[8:9]
  s_or_b64 s[10:11], s[10:11], s[12:13]
  s_xor_b64 s[12:13], s[72:73], s[8:9]
  s_or_b64 s[10:11], s[10:11], s[12:13]
  s_xor_b64 s[12:13], s[74:75], s[8:9]
  s_or_b64 s[10:11], s[10:11], s[12:13]
  s_xor_b64 s[12:13], s[76:77], s[8:9]
  s_or_b64 s[10:11], s[10:11], s[12:13]
  s_xor_b64 s[12:13], s[78:79], s[8:9]
  s_or_b64 s[10:11], s[10:11], s[12:13]
  s_cbranch_scc0 L_ok0
  s_load_dwordx16 s[64:79], s[4:5], 0 glc
  s_add_u32 s63, s63, 1
  s_cmp_lt_u32 s63, 20000
  s_cbranch_scc1 L_sp0
  s_waitcnt lgkmcnt(0)
L_ok0:
  s_add_u32 m0, s61, 0
  s_mov_b32 s62, 0
  buffer_load_dwordx4 v20, s[28:31], s62 offen offset:0 sc1 lds
  buffer_load_dwordx4 v20, s[28:31], s62 offen offset:1024 sc1 lds
  buffer_load_dwordx4 v20, s[28:31], s62 offen offset:2048 sc1 lds
  buffer_load_dwordx4 v20, s[28:31], s62 offen offset:3072 sc1 lds
  s_add_u32 m0, m0, 4096
  s_add_u32 s62, s62, 4096
  buffer_load_dwordx4 v20, s[28:31], s62 offen offset:0 sc1 lds
  buffer_load_dwordx4 v20, s[28:31], s62 offen offset:1024 sc1 lds
  buffer_load_dwordx4 v20, s[28:31], s62 offen offset:2048 sc1 lds
  s_load_dwordx16 s[64:79], s[4:5], 2048 glc
  s_add_u32 m0, s60, 45056
  s_mov_b32 s62, 128
  buffer_load_dwordx4 v16, s[16:19], s62 offen offset:0 lds
  buffer_load_dwordx4 v17, s[16:19], s62 offen offset:1024 lds
  buffer_load_dwordx4 v18, s[16:19], s62 offen offset:2048 lds
  buffer_load_dwordx4 v19, s[16:19], s62 offen offset:3072 lds
  s_mov_b32 s63, 0
L_sp1:
  s_waitcnt lgkmcnt(0)
  s_xor_b64 s[10:11], s[64:65], s[8:9]
  s_xor_b64 s[12:13], s[66:67], s[8:9]
  s_or_b64 s[10:11], s[10:11], s[12:13]
  s_xor_b64 s[12:13], s[68:69], s[8:9]
  s_or_b64 s[10:11], s[10:11], s[12:13]
  s_xor_b64 s[12:13], s[70:71], s[8:9]
  s_or_b64 s[10:11], s[10:11], s[12:13]
  s_xor_b64 s[12:13], s[72:73], s[8:9]
  s_or_b64 s[10:11], s[10:11], s[12:13]
  s_xor_b64 s[12:13], s[74:75], s[8:9]
  s_or_b64 s[10:11], s[10:11], s[12:13]
  s_xor_b64 s[12:13], s[76:77], s[8:9]
  s_or_b64 s[10:11], s[10:11], s[12:13]
  s_xor_b64 s[12:13], s[78:79], s[8:9]
  s_or_b64 s[10:11], s[10:11], s[12:13]
  s_cbranch_scc0 L_ok1
  s_load_dwordx16 s[64:79], s[4:5], 2048 glc
  s_add_u32 s63, s63, 1
  s_cmp_lt_u32 s63, 20000
  s_cbranch_scc1 L_sp1
  s_waitcnt lgkmcnt(0)
L_ok1:
  s_add_u32 m0, s61, 45056
  s_mov_b32 s62, 28672
  buffer_load_dwordx4 v20, s[28:31], s62 offen offset:0 sc1 lds
  buffer_load_dwordx4 v20, s[28:31], s62 offen offset:1024 sc1 lds
  buffer_load_dwordx4 v20, s[28:31], s62 offen offset:2048 sc1 lds
  buffer_load_dwordx4 v20, s[28:31], s62 offen offset:3072 sc1 lds
  s_add_u32 m0, m0, 4096
  s_add_u32 s62, s62, 4096
  buffer_load_dwordx4 v20, s[28:31], s62 offen offset:0 sc1 lds
  buffer_load_dwordx4 v20, s[28:31], s62 offen offset:1024 sc1 lds
  buffer_load_dwordx4 v20, s[28:31], s62 offen offset:2048 sc1 lds
  buffer_load_dword v43, v21, s[16:19], 0 offen
  s_load_dwordx16 s[64:79], s[4:5], 4096 glc
  s_waitcnt vmcnt(12)
  s_barrier
  s_mov_b32 s63, 0
L_sp2:
  s_waitcnt lgkmcnt(0)
  s_xor_b64 s[10:11], s[64:65], s[8:9]
  s_xor_b64 s[12:13], s[66:67], s[8:9]
  s_or_b64 s[10:11], s[10:11], s[12:13]
  s_xor_b64 s[12:13], s[68:69], s[8:9]
  s_or_b64 s[10:11], s[10:11], s[12:13]
  s_xor_b64 s[12:13], s[70:71], s[8:9]
  s_or_b64 s[10:11], s[10:11], s[12:13]
  s_xor_b64 s[12:13], s[72:73], s[8:9]
  s_or_b64 s[10:11], s[10:11], s[12:13]
  s_xor_b64 s[12:13], s[74:75], s[8:9]
  s_or_b64 s[10:11], s[10:11], s[12:13]
  s_xor_b64 s[12:13], s[76:77], s[8:9]
  s_or_b64 s[10:11], s[10:11], s[12:13]
  s_xor_b64 s[12:13], s[78:79], s[8:9]
  s_or_b64 s[10:11], s[10:11], s[12:13]
  s_cbranch_scc0 L_ok2
  s_load_dwordx16 s[64:79], s[4:5], 4096 glc
  s_add_u32 s63, s63, 1
  s_cmp_lt_u32 s63, 20000
  s_cbranch_scc1 L_sp2
  s_waitcnt lgkmcnt(0)
L_ok2:
  s_load_dwordx16 s[64:79], s[4:5], 6144 glc
  s_add_u32 m0, s61, 90112
  s_mov_b32 s62, 57344
  buffer_load_dwordx4 v20, s[28:31], s62 offen offset:0 sc1 lds
  buffer_load_dwordx4 v20, s[28:31], s62 offen offset:1024 sc1 lds
  buffer_load_dwordx4 v20, s[28:31], s62 offen offset:2048 sc1 lds
  buffer_load_dwordx4 v20, s[28:31], s62 offen offset:3072 sc1 lds
  s_add_u32 m0, m0, 4096
  s_add_u32 s62, s62, 4096
  buffer_load_dwordx4 v20, s[28:31], s62 offen offset:0 sc1 lds
  buffer_load_dwordx4 v20, s[28:31], s62 offen offset:1024 sc1 lds
  buffer_load_dwordx4 v20, s[28:31], s62 offen offset:2048 sc1 lds
  s_add_u32 m0, s60, 90112
  s_mov_b32 s62, 256
  buffer_load_dwordx4 v16, s[16:19], s62 offen offset:0 lds
  buffer_load_dwordx4 v17, s[16:19], s62 offen offset:1024 lds
  buffer_load_dwordx4 v18, s[16:19], s62 offen offset:2048 lds
  buffer_load_dwordx4 v19, s[16:19], s62 offen offset:3072 lds
  v_add_u32 v14, 7340032, v4
  buffer_load_dword v64, v14, s[20:23], 0 offen
  buffer_load_dword v65, v14, s[20:23], s41 offen
  buffer_load_dword v66, v14, s[20:23], s42 offen
  buffer_load_dword v67, v14, s[20:23], s43 offen
  buffer_load_dword v68, v14, s[20:23], s44 offen
  buffer_load_dword v69, v14, s[20:23], s45 offen
  buffer_load_dword v70, v14, s[20:23], s46 offen
  buffer_load_dword v71, v14, s[20:23], s47 offen
  s_waitcnt vmcnt(20)
  s_barrier
  s_mov_b32 s63, 0
L_sp3:
  s_waitcnt lgkmcnt(0)
  s_xor_b64 s[10:11], s[64:65], s[8:9]
  s_xor_b64 s[12:13], s[66:67], s[8:9]
  s_or_b64 s[10:11], s[10:11], s[12:13]
  s_xor_b64 s[12:13], s[68:69], s[8:9]
  s_or_b64 s[10:11], s[10:11], s[12:13]
  s_xor_b64 s[12:13], s[70:71], s[8:9]
  s_or_b64 s[10:11], s[10:11], s[12:13]
  s_xor_b64 s[12:13], s[72:73], s[8:9]
  s_or_b64 s[10:11], s[10:11], s[12:13]
  s_xor_b64 s[12:13], s[74:75], s[8:9]
  s_or_b64 s[10:11], s[10:11], s[12:13]
  s_xor_b64 s[12:13], s[76:77], s[8:9]
  s_or_b64 s[10:11], s[10:11], s[12:13]
  s_xor_b64 s[12:13], s[78:79], s[8:9]
  s_or_b64 s[10:11], s[10:11], s[12:13]
  s_cbranch_scc0 L_ok3
  s_load_dwordx16 s[64:79], s[4:5], 6144 glc
  s_add_u32 s63, s63, 1
  s_cmp_lt_u32 s63, 20000
  s_cbranch_scc1 L_sp3
  s_waitcnt lgkmcnt(0)
L_ok3:
  s_load_dwordx16 s[64:79], s[4:5], 8192 glc
  s_add_u32 m0, s61, 0
  s_mov_b32 s62, 86016
  buffer_load_dwordx4 v20, s[28:31], s62 offen offset:0 sc1 lds
  buffer_load_dwordx4 v20, s[28:31], s62 offen offset:1024 sc1 lds
  buffer_load_dwordx4 v20, s[28:31], s62 offen offset:2048 sc1 lds
  buffer_load_dwordx4 v20, s[28:31], s62 offen offset:3072 sc1 lds
  s_add_u32 m0, m0, 4096
  s_add_u32 s62, s62, 4096
  buffer_load_dwordx4 v20, s[28:31], s62 offen offset:0 sc1 lds
  buffer_load_dwordx4 v20, s[28:31], s62 offen offset:1024 sc1 lds
  buffer_load_dwordx4 v20, s[28:31], s62 offen offset:2048 sc1 lds
  s_add_u32 m0, s60, 0
  s_mov_b32 s62, 384
  buffer_load_dwordx4 v16, s[16:19], s62 offen offset:0 lds
  buffer_load_dwordx4 v17, s[16:19], s62 offen offset:1024 lds
  buffer_load_dwordx4 v18, s[16:19], s62 offen offset:2048 lds
  buffer_load_dwordx4 v19, s[16:19], s62 offen offset:3072 lds
  s_waitcnt vmcnt(11)
  v_mad_u32_u24 v64, v64, s56, v5
  v_mad_u32_u24 v65, v65, s56, v5
  v_mad_u32_u24 v66, v66, s56, v5
  v_mad_u32_u24 v67, v67, s56, v5
  v_mad_u32_u24 v68, v68, s56, v5
  v_mad_u32_u24 v69, v69, s56, v5
  v_mad_u32_u24 v70, v70, s56, v5
  v_mad_u32_u24 v71, v71, s56, v5
  ds_read_u16 v64, v64
  ds_read_u16 v65, v65
  ds_read_u16 v66, v66
  ds_read_u16 v67, v67
  ds_read_u16 v68, v68
  ds_read_u16 v69, v69
  ds_read_u16 v70, v70
  ds_read_u16 v71, v71
  s_waitcnt lgkmcnt(6)
  v_lshl_or_b32 v96, v65, 16, v64
  s_waitcnt lgkmcnt(4)
  v_lshl_or_b32 v97, v67, 16, v66
  s_waitcnt lgkmcnt(2)
  v_lshl_or_b32 v98, v69, 16, v68
  s_waitcnt lgkmcnt(0)
  v_lshl_or_b32 v99, v71, 16, v70
  s_mov_b32 s59, 229376
  buffer_store_dwordx4 v[96:99], v6, s[28:31], s59 offen sc1
  s_waitcnt vmcnt(20)
  s_barrier
  s_mov_b32 s63, 0
L_sp4:
  s_waitcnt lgkmcnt(0)
  s_xor_b64 s[10:11], s[64:65], s[8:9]
  s_xor_b64 s[12:13], s[66:67], s[8:9]
  s_or_b64 s[10:11], s[10:11], s[12:13]
  s_xor_b64 s[12:13], s[68:69], s[8:9]
  s_or_b64 s[10:11], s[10:11], s[12:13]
  s_xor_b64 s[12:13], s[70:71], s[8:9]
  s_or_b64 s[10:11], s[10:11], s[12:13]
  s_xor_b64 s[12:13], s[72:73], s[8:9]
  s_or_b64 s[10:11], s[10:11], s[12:13]
  s_xor_b64 s[12:13], s[74:75], s[8:9]
  s_or_b64 s[10:11], s[10:11], s[12:13]
  s_xor_b64 s[12:13], s[76:77], s[8:9]
  s_or_b64 s[10:11], s[10:11], s[12:13]
  s_xor_b64 s[12:13], s[78:79], s[8:9]
  s_or_b64 s[10:11], s[10:11], s[12:13]
  s_cbranch_scc0 L_ok4
  s_load_dwordx16 s[64:79], s[4:5], 8192 glc
  s_add_u32 s63, s63, 1
  s_cmp_lt_u32 s63, 20000
  s_cbranch_scc1 L_sp4
  s_waitcnt lgkmcnt(0)
L_ok4:
  s_load_dwordx16 s[64:79], s[4:5], 10240 glc
  s_add_u32 m0, s61, 45056
  s_mov_b32 s62, 114688
  buffer_load_dwordx4 v20, s[28:31], s62 offen offset:0 sc1 lds
  buffer_load_dwordx4 v20, s[28:31], s62 offen offset:1024 sc1 lds
  buffer_load_dwordx4 v20, s[28:31], s62 offen offset:2048 sc1 lds
  buffer_load_dwordx4 v20, s[28:31], s62 offen offset:3072 sc1 lds
  s_add_u32 m0, m0, 4096
  s_add_u32 s62, s62, 4096
  buffer_load_dwordx4 v20, s[28:31], s62 offen offset:0 sc1 lds
  buffer_load_dwordx4 v20, s[28:31], s62 offen offset:1024 sc1 lds
  buffer_load_dwordx4 v20, s[28:31], s62 offen offset:2048 sc1 lds
  s_add_u32 m0, s60, 45056
  s_mov_b32 s62, 512
  buffer_load_dwordx4 v16, s[16:19], s62 offen offset:0 lds
  buffer_load_dwordx4 v17, s[16:19], s62 offen offset:1024 lds
  buffer_load_dwordx4 v18, s[16:19], s62 offen offset:2048 lds
  buffer_load_dwordx4 v19, s[16:19], s62 offen offset:3072 lds
  s_waitcnt vmcnt(11)
  s_mov_b64 exec, 15
  s_mov_b32 s59, 16384
  buffer_store_dwordx2 v[10:11], v7, s[28:31], s59 offen sc1
  s_mov_b64 exec, -1
  v_add_u32 v14, 9175040, v4
  buffer_load_dword v72, v14, s[20:23], 0 offen
  buffer_load_dword v73, v14, s[20:23], s41 offen
  buffer_load_dword v74, v14, s[20:23], s42 offen
  buffer_load_dword v75, v14, s[20:23], s43 offen
  buffer_load_dword v76, v14, s[20:23], s44 offen
  buffer_load_dword v77, v14, s[20:23], s45 offen
  buffer_load_dword v78, v14, s[20:23], s46 offen
  buffer_load_dword v79, v14, s[20:23], s47 offen
  s_waitcnt vmcnt(21)
  s_barrier
  s_mov_b32 s63, 0
L_sp5:
  s_waitcnt lgkmcnt(0)
  s_xor_b64 s[10:11], s[64:65], s[8:9]
  s_xor_b64 s[12:13], s[66:67], s[8:9]
  s_or_b64 s[10:11], s[10:11], s[12:13]
  s_xor_b64 s[12:13], s[68:69], s[8:9]
  s_or_b64 s[10:11], s[10:11], s[12:13]
  s_xor_b64 s[12:13], s[70:71], s[8:9]
  s_or_b64 s[10:11], s[10:11], s[12:13]
  s_xor_b64 s[12:13], s[72:73], s[8:9]
  s_or_b64 s[10:11], s[10:11], s[12:13]
  s_xor_b64 s[12:13], s[74:75], s[8:9]
  s_or_b64 s[10:11], s[10:11], s[12:13]
  s_xor_b64 s[12:13], s[76:77], s[8:9]
  s_or_b64 s[10:11], s[10:11], s[12:13]
  s_xor_b64 s[12:13], s[78:79], s[8:9]
  s_or_b64 s[10:11], s[10:11], s[12:13]
  s_cbranch_scc0 L_ok5
  s_load_dwordx16 s[64:79], s[4:5], 10240 glc
  s_add_u32 s63, s63, 1
  s_cmp_lt_u32 s63, 20000
  s_cbranch_scc1 L_sp5
  s_waitcnt lgkmcnt(0)
L_ok5:
  s_load_dwordx16 s[64:79], s[4:5], 12288 glc
  s_add_u32 m0, s61, 90112
  s_mov_b32 s62, 143360
  buffer_load_dwordx4 v20, s[28:31], s62 offen offset:0 sc1 lds
  buffer_load_dwordx4 v20, s[28:31], s62 offen offset:1024 sc1 lds
  buffer_load_dwordx4 v20, s[28:31], s62 offen offset:2048 sc1 lds
  buffer_load_dwordx4 v20, s[28:31], s62 offen offset:3072 sc1 lds
  s_add_u32 m0, m0, 4096
  s_add_u32 s62, s62, 4096
  buffer_load_dwordx4 v20, s[28:31], s62 offen offset:0 sc1 lds
  buffer_load_dwordx4 v20, s[28:31], s62 offen offset:1024 sc1 lds
  buffer_load_dwordx4 v20, s[28:31], s62 offen offset:2048 sc1 lds
  s_add_u32 m0, s60, 90112
  s_mov_b32 s62, 640
  buffer_load_dwordx4 v16, s[16:19], s62 offen offset:0 lds
  buffer_load_dwordx4 v17, s[16:19], s62 offen offset:1024 lds
  buffer_load_dwordx4 v18, s[16:19], s62 offen offset:2048 lds
  buffer_load_dwordx4 v19, s[16:19], s62 offen offset:3072 lds
  s_waitcnt vmcnt(11)
  v_mad_u32_u24 v72, v72, s56, v5
  v_mad_u32_u24 v73, v73, s56, v5
  v_mad_u32_u24 v74, v74, s56, v5
  v_mad_u32_u24 v75, v75, s56, v5
  v_mad_u32_u24 v76, v76, s56, v5
  v_mad_u32_u24 v77, v77, s56, v5
  v_mad_u32_u24 v78, v78, s56, v5
  v_mad_u32_u24 v79, v79, s56, v5
  ds_read_u16 v72, v72
  ds_read_u16 v73, v73
  ds_read_u16 v74, v74
  ds_read_u16 v75, v75
  ds_read_u16 v76, v76
  ds_read_u16 v77, v77
  ds_read_u16 v78, v78
  ds_read_u16 v79, v79
  s_waitcnt lgkmcnt(6)
  v_lshl_or_b32 v100, v73, 16, v72
  s_waitcnt lgkmcnt(4)
  v_lshl_or_b32 v101, v75, 16, v74
  s_waitcnt lgkmcnt(2)
  v_lshl_or_b32 v102, v77, 16, v76
  s_waitcnt lgkmcnt(0)
  v_lshl_or_b32 v103, v79, 16, v78
  s_mov_b32 s59, 286720
  buffer_store_dwordx4 v[100:103], v6, s[28:31], s59 offen sc1
  s_waitcnt vmcnt(21)
  s_barrier
  s_mov_b32 s63, 0
L_sp6:
  s_waitcnt lgkmcnt(0)
  s_xor_b64 s[10:11], s[64:65], s[8:9]
  s_xor_b64 s[12:13], s[66:67], s[8:9]
  s_or_b64 s[10:11], s[10:11], s[12:13]
  s_xor_b64 s[12:13], s[68:69], s[8:9]
  s_or_b64 s[10:11], s[10:11], s[12:13]
  s_xor_b64 s[12:13], s[70:71], s[8:9]
  s_or_b64 s[10:11], s[10:11], s[12:13]
  s_xor_b64 s[12:13], s[72:73], s[8:9]
  s_or_b64 s[10:11], s[10:11], s[12:13]
  s_xor_b64 s[12:13], s[74:75], s[8:9]
  s_or_b64 s[10:11], s[10:11], s[12:13]
  s_xor_b64 s[12:13], s[76:77], s[8:9]
  s_or_b64 s[10:11], s[10:11], s[12:13]
  s_xor_b64 s[12:13], s[78:79], s[8:9]
  s_or_b64 s[10:11], s[10:11], s[12:13]
  s_cbranch_scc0 L_ok6
  s_load_dwordx16 s[64:79], s[4:5], 12288 glc
  s_add_u32 s63, s63, 1
  s_cmp_lt_u32 s63, 20000
  s_cbranch_scc1 L_sp6
  s_waitcnt lgkmcnt(0)
L_ok6:
  s_load_dwordx16 s[64:79], s[4:5], 14336 glc
  s_add_u32 m0, s61, 0
  s_mov_b32 s62, 172032
  buffer_load_dwordx4 v20, s[28:31], s62 offen offset:0 sc1 lds
  buffer_load_dwordx4 v20, s[28:31], s62 offen offset:1024 sc1 lds
  buffer_load_dwordx4 v20, s[28:31], s62 offen offset:2048 sc1 lds
  buffer_load_dwordx4 v20, s[28:31], s62 offen offset:3072 sc1 lds
  s_add_u32 m0, m0, 4096
  s_add_u32 s62, s62, 4096
  buffer_load_dwordx4 v20, s[28:31], s62 offen offset:0 sc1 lds
  buffer_load_dwordx4 v20, s[28:31], s62 offen offset:1024 sc1 lds
  buffer_load_dwordx4 v20, s[28:31], s62 offen offset:2048 sc1 lds
  s_add_u32 m0, s60, 0
  s_mov_b32 s62, 768
  buffer_load_dwordx4 v16, s[16:19], s62 offen offset:0 lds
  buffer_load_dwordx4 v17, s[16:19], s62 offen offset:1024 lds
  buffer_load_dwordx4 v18, s[16:19], s62 offen offset:2048 lds
  buffer_load_dwordx4 v19, s[16:19], s62 offen offset:3072 lds
  s_waitcnt vmcnt(11)
  s_mov_b64 exec, 15
  s_mov_b32 s59, 20480
  buffer_store_dwordx2 v[10:11], v7, s[28:31], s59 offen sc1
  s_mov_b64 exec, -1
  v_add_u32 v14, 11010048, v4
  buffer_load_dword v64, v14, s[20:23], 0 offen
  buffer_load_dword v65, v14, s[20:23], s41 offen
  buffer_load_dword v66, v14, s[20:23], s42 offen
  buffer_load_dword v67, v14, s[20:23], s43 offen
  buffer_load_dword v68, v14, s[20:23], s44 offen
  buffer_load_dword v69, v14, s[20:23], s45 offen
  buffer_load_dword v70, v14, s[20:23], s46 offen
  buffer_load_dword v71, v14, s[20:23], s47 offen
  s_waitcnt vmcnt(21)
  s_barrier
  s_mov_b32 s63, 0
L_sp7:
  s_waitcnt lgkmcnt(0)
  s_xor_b64 s[10:11], s[64:65], s[8:9]
  s_xor_b64 s[12:13], s[66:67], s[8:9]
  s_or_b64 s[10:11], s[10:11], s[12:13]
  s_xor_b64 s[12:13], s[68:69], s[8:9]
  s_or_b64 s[10:11], s[10:11], s[12:13]
  s_xor_b64 s[12:13], s[70:71], s[8:9]
  s_or_b64 s[10:11], s[10:11], s[12:13]
  s_xor_b64 s[12:13], s[72:73], s[8:9]
  s_or_b64 s[10:11], s[10:11], s[12:13]
  s_xor_b64 s[12:13], s[74:75], s[8:9]
  s_or_b64 s[10:11], s[10:11], s[12:13]
  s_xor_b64 s[12:13], s[76:77], s[8:9]
  s_or_b64 s[10:11], s[10:11], s[12:13]
  s_xor_b64 s[12:13], s[78:79], s[8:9]
  s_or_b64 s[10:11], s[10:11], s[12:13]
  s_cbranch_scc0 L_ok7
  s_load_dwordx16 s[64:79], s[4:5], 14336 glc
  s_add_u32 s63, s63, 1
  s_cmp_lt_u32 s63, 20000
  s_cbranch_scc1 L_sp7
  s_waitcnt lgkmcnt(0)
L_ok7:
  s_load_dwordx16 s[64:79], s[4:5], 16384 glc
  s_add_u32 m0, s61, 45056
  s_mov_b32 s62, 200704
  buffer_load_dwordx4 v20, s[28:31], s62 offen offset:0 sc1 lds
  buffer_load_dwordx4 v20, s[28:31], s62 offen offset:1024 sc1 lds
  buffer_load_dwordx4 v20, s[28:31], s62 offen offset:2048 sc1 lds
  buffer_load_dwordx4 v20, s[28:31], s62 offen offset:3072 sc1 lds
  s_add_u32 m0, m0, 4096
  s_add_u32 s62, s62, 4096
  buffer_load_dwordx4 v20, s[28:31], s62 offen offset:0 sc1 lds
  buffer_load_dwordx4 v20, s[28:31], s62 offen offset:1024 sc1 lds
  buffer_load_dwordx4 v20, s[28:31], s62 offen offset:2048 sc1 lds
  s_add_u32 m0, s60, 45056
  s_mov_b32 s62, 896
  buffer_load_dwordx4 v16, s[16:19], s62 offen offset:0 lds
  buffer_load_dwordx4 v17, s[16:19], s62 offen offset:1024 lds
  buffer_load_dwordx4 v18, s[16:19], s62 offen offset:2048 lds
  buffer_load_dwordx4 v19, s[16:19], s62 offen offset:3072 lds
  s_waitcnt vmcnt(11)
  v_mad_u32_u24 v64, v64, s56, v5
  v_mad_u32_u24 v65, v65, s56, v5
  v_mad_u32_u24 v66, v66, s56, v5
  v_mad_u32_u24 v67, v67, s56, v5
  v_mad_u32_u24 v68, v68, s56, v5
  v_mad_u32_u24 v69, v69, s56, v5
  v_mad_u32_u24 v70, v70, s56, v5
  v_mad_u32_u24 v71, v71, s56, v5
  ds_read_u16 v64, v64
  ds_read_u16 v65, v65
  ds_read_u16 v66, v66
  ds_read_u16 v67, v67
  ds_read_u16 v68, v68
  ds_read_u16 v69, v69
  ds_read_u16 v70, v70
  ds_read_u16 v71, v71
  s_waitcnt lgkmcnt(6)
  v_lshl_or_b32 v96, v65, 16, v64
  s_waitcnt lgkmcnt(4)
  v_lshl_or_b32 v97, v67, 16, v66
  s_waitcnt lgkmcnt(2)
  v_lshl_or_b32 v98, v69, 16, v68
  s_waitcnt lgkmcnt(0)
  v_lshl_or_b32 v99, v71, 16, v70
  s_mov_b32 s59, 344064
  buffer_store_dwordx4 v[96:99], v6, s[28:31], s59 offen sc1
  s_waitcnt vmcnt(21)
  s_barrier
  s_mov_b32 s63, 0
L_sp8:
  s_waitcnt lgkmcnt(0)
  s_xor_b64 s[10:11], s[64:65], s[8:9]
  s_xor_b64 s[12:13], s[66:67], s[8:9]
  s_or_b64 s[10:11], s[10:11], s[12:13]
  s_xor_b64 s[12:13], s[68:69], s[8:9]
  s_or_b64 s[10:11], s[10:11], s[12:13]
  s_xor_b64 s[12:13], s[70:71], s[8:9]
  s_or_b64 s[10:11], s[10:11], s[12:13]
  s_xor_b64 s[12:13], s[72:73], s[8:9]
  s_or_b64 s[10:11], s[10:11], s[12:13]
  s_xor_b64 s[12:13], s[74:75], s[8:9]
  s_or_b64 s[10:11], s[10:11], s[12:13]
  s_xor_b64 s[12:13], s[76:77], s[8:9]
  s_or_b64 s[10:11], s[10:11], s[12:13]
  s_xor_b64 s[12:13], s[78:79], s[8:9]
  s_or_b64 s[10:11], s[10:11], s[12:13]
  s_cbranch_scc0 L_ok8
  s_load_dwordx16 s[64:79], s[4:5], 16384 glc
  s_add_u32 s63, s63, 1
  s_cmp_lt_u32 s63, 20000
  s_cbranch_scc1 L_sp8
  s_waitcnt lgkmcnt(0)
L_ok8:
  s_load_dwordx16 s[64:79], s[4:5], 18432 glc
  s_add_u32 m0, s61, 90112
  s_mov_b32 s62, 229376
  buffer_load_dwordx4 v20, s[28:31], s62 offen offset:0 sc1 lds
  buffer_load_dwordx4 v20, s[28:31], s62 offen offset:1024 sc1 lds
  buffer_load_dwordx4 v20, s[28:31], s62 offen offset:2048 sc1 lds
  buffer_load_dwordx4 v20, s[28:31], s62 offen offset:3072 sc1 lds
  s_add_u32 m0, m0, 4096
  s_add_u32 s62, s62, 4096
  buffer_load_dwordx4 v20, s[28:31], s62 offen offset:0 sc1 lds
  buffer_load_dwordx4 v20, s[28:31], s62 offen offset:1024 sc1 lds
  buffer_load_dwordx4 v20, s[28:31], s62 offen offset:2048 sc1 lds
  s_add_u32 m0, s60, 90112
  s_mov_b32 s62, 1024
  buffer_load_dwordx4 v16, s[16:19], s62 offen offset:0 lds
  buffer_load_dwordx4 v17, s[16:19], s62 offen offset:1024 lds
  buffer_load_dwordx4 v18, s[16:19], s62 offen offset:2048 lds
  buffer_load_dwordx4 v19, s[16:19], s62 offen offset:3072 lds
  s_waitcnt vmcnt(11)
  s_mov_b64 exec, 15
  s_mov_b32 s59, 24576
  buffer_store_dwordx2 v[10:11], v7, s[28:31], s59 offen sc1
  s_mov_b64 exec, -1
  v_add_u32 v14, 12845056, v4
  buffer_load_dword v72, v14, s[20:23], 0 offen
  buffer_load_dword v73, v14, s[20:23], s41 offen
  buffer_load_dword v74, v14, s[20:23], s42 offen
  buffer_load_dword v75, v14, s[20:23], s43 offen
  buffer_load_dword v76, v14, s[20:23], s44 offen
  buffer_load_dword v77, v14, s[20:23], s45 offen
  buffer_load_dword v78, v14, s[20:23], s46 offen
  buffer_load_dword v79, v14, s[20:23], s47 offen
  s_waitcnt vmcnt(21)
  s_barrier
  s_mov_b32 s63, 0
L_sp9:
  s_waitcnt lgkmcnt(0)
  s_xor_b64 s[10:11], s[64:65], s[8:9]
  s_xor_b64 s[12:13], s[66:67], s[8:9]
  s_or_b64 s[10:11], s[10:11], s[12:13]
  s_xor_b64 s[12:13], s[68:69], s[8:9]
  s_or_b64 s[10:11], s[10:11], s[12:13]
  s_xor_b64 s[12:13], s[70:71], s[8:9]
  s_or_b64 s[10:11], s[10:11], s[12:13]
  s_xor_b64 s[12:13], s[72:73], s[8:9]
  s_or_b64 s[10:11], s[10:11], s[12:13]
  s_xor_b64 s[12:13], s[74:75], s[8:9]
  s_or_b64 s[10:11], s[10:11], s[12:13]
  s_xor_b64 s[12:13], s[76:77], s[8:9]
  s_or_b64 s[10:11], s[10:11], s[12:13]
  s_xor_b64 s[12:13], s[78:79], s[8:9]
  s_or_b64 s[10:11], s[10:11], s[12:13]
  s_cbranch_scc0 L_ok9
  s_load_dwordx16 s[64:79], s[4:5], 18432 glc
  s_add_u32 s63, s63, 1
  s_cmp_lt_u32 s63, 20000
  s_cbranch_scc1 L_sp9
  s_waitcnt lgkmcnt(0)
L_ok9:
  s_load_dwordx16 s[64:79], s[4:5], 20480 glc
  s_add_u32 m0, s61, 0
  s_mov_b32 s62, 258048
  buffer_load_dwordx4 v20, s[28:31], s62 offen offset:0 sc1 lds
  buffer_load_dwordx4 v20, s[28:31], s62 offen offset:1024 sc1 lds
  buffer_load_dwordx4 v20, s[28:31], s62 offen offset:2048 sc1 lds
  buffer_load_dwordx4 v20, s[28:31], s62 offen offset:3072 sc1 lds
  s_add_u32 m0, m0, 4096
  s_add_u32 s62, s62, 4096
  buffer_load_dwordx4 v20, s[28:31], s62 offen offset:0 sc1 lds
  buffer_load_dwordx4 v20, s[28:31], s62 offen offset:1024 sc1 lds
  buffer_load_dwordx4 v20, s[28:31], s62 offen offset:2048 sc1 lds
  s_add_u32 m0, s60, 0
  s_mov_b32 s62, 1152
  buffer_load_dwordx4 v16, s[16:19], s62 offen offset:0 lds
  buffer_load_dwordx4 v17, s[16:19], s62 offen offset:1024 lds
  buffer_load_dwordx4 v18, s[16:19], s62 offen offset:2048 lds
  buffer_load_dwordx4 v19, s[16:19], s62 offen offset:3072 lds
  s_waitcnt vmcnt(11)
  v_mad_u32_u24 v72, v72, s56, v5
  v_mad_u32_u24 v73, v73, s56, v5
  v_mad_u32_u24 v74, v74, s56, v5
  v_mad_u32_u24 v75, v75, s56, v5
  v_mad_u32_u24 v76, v76, s56, v5
  v_mad_u32_u24 v77, v77, s56, v5
  v_mad_u32_u24 v78, v78, s56, v5
  v_mad_u32_u24 v79, v79, s56, v5
  ds_read_u16 v72, v72
  ds_read_u16 v73, v73
  ds_read_u16 v74, v74
  ds_read_u16 v75, v75
  ds_read_u16 v76, v76
  ds_read_u16 v77, v77
  ds_read_u16 v78, v78
  ds_read_u16 v79, v79
  s_waitcnt lgkmcnt(6)
  v_lshl_or_b32 v100, v73, 16, v72
  s_waitcnt lgkmcnt(4)
  v_lshl_or_b32 v101, v75, 16, v74
  s_waitcnt lgkmcnt(2)
  v_lshl_or_b32 v102, v77, 16, v76
  s_waitcnt lgkmcnt(0)
  v_lshl_or_b32 v103, v79, 16, v78
  s_mov_b32 s59, 401408
  buffer_store_dwordx4 v[100:103], v6, s[28:31], s59 offen sc1
  s_waitcnt vmcnt(21)
  s_barrier
  s_mov_b32 s63, 0
L_sp10:
  s_waitcnt lgkmcnt(0)
  s_xor_b64 s[10:11], s[64:65], s[8:9]
  s_xor_b64 s[12:13], s[66:67], s[8:9]
  s_or_b64 s[10:11], s[10:11], s[12:13]
  s_xor_b64 s[12:13], s[68:69], s[8:9]
  s_or_b64 s[10:11], s[10:11], s[12:13]
  s_xor_b64 s[12:13], s[70:71], s[8:9]
  s_or_b64 s[10:11], s[10:11], s[12:13]
  s_xor_b64 s[12:13], s[72:73], s[8:9]
  s_or_b64 s[10:11], s[10:11], s[12:13]
  s_xor_b64 s[12:13], s[74:75], s[8:9]
  s_or_b64 s[10:11], s[10:11], s[12:13]
  s_xor_b64 s[12:13], s[76:77], s[8:9]
  s_or_b64 s[10:11], s[10:11], s[12:13]
  s_xor_b64 s[12:13], s[78:79], s[8:9]
  s_or_b64 s[10:11], s[10:11], s[12:13]
  s_cbranch_scc0 L_ok10
  s_load_dwordx16 s[64:79], s[4:5], 20480 glc
  s_add_u32 s63, s63, 1
  s_cmp_lt_u32 s63, 20000
  s_cbranch_scc1 L_sp10
  s_waitcnt lgkmcnt(0)
L_ok10:
  s_load_dwordx16 s[64:79], s[4:5], 22528 glc
  s_add_u32 m0, s61, 45056
  s_mov_b32 s62, 286720
  buffer_load_dwordx4 v20, s[28:31], s62 offen offset:0 sc1 lds
  buffer_load_dwordx4 v20, s[28:31], s62 offen offset:1024 sc1 lds
  buffer_load_dwordx4 v20, s[28:31], s62 offen offset:2048 sc1 lds
  buffer_load_dwordx4 v20, s[28:31], s62 offen offset:3072 sc1 lds
  s_add_u32 m0, m0, 4096
  s_add_u32 s62, s62, 4096
  buffer_load_dwordx4 v20, s[28:31], s62 offen offset:0 sc1 lds
  buffer_load_dwordx4 v20, s[28:31], s62 offen offset:1024 sc1 lds
  buffer_load_dwordx4 v20, s[28:31], s62 offen offset:2048 sc1 lds
  s_add_u32 m0, s60, 45056
  s_mov_b32 s62, 1280
  buffer_load_dwordx4 v16, s[16:19], s62 offen offset:0 lds
  buffer_load_dwordx4 v17, s[16:19], s62 offen offset:1024 lds
  buffer_load_dwordx4 v18, s[16:19], s62 offen offset:2048 lds
  buffer_load_dwordx4 v19, s[16:19], s62 offen offset:3072 lds
  s_waitcnt vmcnt(11)
  s_mov_b64 exec, 15
  s_mov_b32 s59, 28672
  buffer_store_dwordx2 v[10:11], v7, s[28:31], s59 offen sc1
  s_mov_b64 exec, -1
  s_waitcnt vmcnt(13)
  s_barrier
  s_mov_b32 s63, 0
L_sp11:
  s_waitcnt lgkmcnt(0)
  s_xor_b64 s[10:11], s[64:65], s[8:9]
  s_xor_b64 s[12:13], s[66:67], s[8:9]
  s_or_b64 s[10:11], s[10:11], s[12:13]
  s_xor_b64 s[12:13], s[68:69], s[8:9]
  s_or_b64 s[10:11], s[10:11], s[12:13]
  s_xor_b64 s[12:13], s[70:71], s[8:9]
  s_or_b64 s[10:11], s[10:11], s[12:13]
  s_xor_b64 s[12:13], s[72:73], s[8:9]
  s_or_b64 s[10:11], s[10:11], s[12:13]
  s_xor_b64 s[12:13], s[74:75], s[8:9]
  s_or_b64 s[10:11], s[10:11], s[12:13]
  s_xor_b64 s[12:13], s[76:77], s[8:9]
  s_or_b64 s[10:11], s[10:11], s[12:13]
  s_xor_b64 s[12:13], s[78:79], s[8:9]
  s_or_b64 s[10:11], s[10:11], s[12:13]
  s_cbranch_scc0 L_ok11
  s_load_dwordx16 s[64:79], s[4:5], 22528 glc
  s_add_u32 s63, s63, 1
  s_cmp_lt_u32 s63, 20000
  s_cbranch_scc1 L_sp11
  s_waitcnt lgkmcnt(0)
L_ok11:
  s_load_dwordx16 s[64:79], s[4:5], 24576 glc
  s_add_u32 m0, s61, 90112
  s_mov_b32 s62, 315392
  buffer_load_dwordx4 v20, s[28:31], s62 offen offset:0 sc1 lds
  buffer_load_dwordx4 v20, s[28:31], s62 offen offset:1024 sc1 lds
  buffer_load_dwordx4 v20, s[28:31], s62 offen offset:2048 sc1 lds
  buffer_load_dwordx4 v20, s[28:31], s62 offen offset:3072 sc1 lds
  s_add_u32 m0, m0, 4096
  s_add_u32 s62, s62, 4096
  buffer_load_dwordx4 v20, s[28:31], s62 offen offset:0 sc1 lds
  buffer_load_dwordx4 v20, s[28:31], s62 offen offset:1024 sc1 lds
  buffer_load_dwordx4 v20, s[28:31], s62 offen offset:2048 sc1 lds
  s_add_u32 m0, s60, 90112
  s_mov_b32 s62, 1408
  buffer_load_dwordx4 v16, s[16:19], s62 offen offset:0 lds
  buffer_load_dwordx4 v17, s[16:19], s62 offen offset:1024 lds
  buffer_load_dwordx4 v18, s[16:19], s62 offen offset:2048 lds
  buffer_load_dwordx4 v19, s[16:19], s62 offen offset:3072 lds
  s_waitcnt vmcnt(12)
  s_barrier
  s_mov_b32 s63, 0
L_sp12:
  s_waitcnt lgkmcnt(0)
  s_xor_b64 s[10:11], s[64:65], s[8:9]
  s_xor_b64 s[12:13], s[66:67], s[8:9]
  s_or_b64 s[10:11], s[10:11], s[12:13]
  s_xor_b64 s[12:13], s[68:69], s[8:9]
  s_or_b64 s[10:11], s[10:11], s[12:13]
  s_xor_b64 s[12:13], s[70:71], s[8:9]
  s_or_b64 s[10:11], s[10:11], s[12:13]
  s_xor_b64 s[12:13], s[72:73], s[8:9]
  s_or_b64 s[10:11], s[10:11], s[12:13]
  s_xor_b64 s[12:13], s[74:75], s[8:9]
  s_or_b64 s[10:11], s[10:11], s[12:13]
  s_xor_b64 s[12:13], s[76:77], s[8:9]
  s_or_b64 s[10:11], s[10:11], s[12:13]
  s_xor_b64 s[12:13], s[78:79], s[8:9]
  s_or_b64 s[10:11], s[10:11], s[12:13]
  s_cbranch_scc0 L_ok12
  s_load_dwordx16 s[64:79], s[4:5], 24576 glc
  s_add_u32 s63, s63, 1
  s_cmp_lt_u32 s63, 20000
  s_cbranch_scc1 L_sp12
  s_waitcnt lgkmcnt(0)
L_ok12:
  s_load_dwordx16 s[64:79], s[4:5], 26624 glc
  s_add_u32 m0, s61, 0
  s_mov_b32 s62, 344064
  buffer_load_dwordx4 v20, s[28:31], s62 offen offset:0 sc1 lds
  buffer_load_dwordx4 v20, s[28:31], s62 offen offset:1024 sc1 lds
  buffer_load_dwordx4 v20, s[28:31], s62 offen offset:2048 sc1 lds
  buffer_load_dwordx4 v20, s[28:31], s62 offen offset:3072 sc1 lds
  s_add_u32 m0, m0, 4096
  s_add_u32 s62, s62, 4096
  buffer_load_dwordx4 v20, s[28:31], s62 offen offset:0 sc1 lds
  buffer_load_dwordx4 v20, s[28:31], s62 offen offset:1024 sc1 lds
  buffer_load_dwordx4 v20, s[28:31], s62 offen offset:2048 sc1 lds
  s_add_u32 m0, s60, 0
  s_mov_b32 s62, 1536
  buffer_load_dwordx4 v16, s[16:19], s62 offen offset:0 lds
  buffer_load_dwordx4 v17, s[16:19], s62 offen offset:1024 lds
  buffer_load_dwordx4 v18, s[16:19], s62 offen offset:2048 lds
  buffer_load_dwordx4 v19, s[16:19], s62 offen offset:3072 lds
  s_waitcnt vmcnt(11)
  s_barrier
  s_mov_b32 s63, 0
L_sp13:
  s_waitcnt lgkmcnt(0)
  s_xor_b64 s[10:11], s[64:65], s[8:9]
  s_xor_b64 s[12:13], s[66:67], s[8:9]
  s_or_b64 s[10:11], s[10:11], s[12:13]
  s_xor_b64 s[12:13], s[68:69], s[8:9]
  s_or_b64 s[10:11], s[10:11], s[12:13]
  s_xor_b64 s[12:13], s[70:71], s[8:9]
  s_or_b64 s[10:11], s[10:11], s[12:13]
  s_xor_b64 s[12:13], s[72:73], s[8:9]
  s_or_b64 s[10:11], s[10:11], s[12:13]
  s_xor_b64 s[12:13], s[74:75], s[8:9]
  s_or_b64 s[10:11], s[10:11], s[12:13]
  s_xor_b64 s[12:13], s[76:77], s[8:9]
  s_or_b64 s[10:11], s[10:11], s[12:13]
  s_xor_b64 s[12:13], s[78:79], s[8:9]
  s_or_b64 s[10:11], s[10:11], s[12:13]
  s_cbranch_scc0 L_ok13
  s_load_dwordx16 s[64:79], s[4:5], 26624 glc
  s_add_u32 s63, s63, 1
  s_cmp_lt_u32 s63, 20000
  s_cbranch_scc1 L_sp13
  s_waitcnt lgkmcnt(0)
L_ok13:
  s_load_dwordx16 s[64:79], s[4:5], 28672 glc
  s_add_u32 m0, s61, 45056
  s_mov_b32 s62, 372736
  buffer_load_dwordx4 v20, s[28:31], s62 offen offset:0 sc1 lds
  buffer_load_dwordx4 v20, s[28:31], s62 offen offset:1024 sc1 lds
  buffer_load_dwordx4 v20, s[28:31], s62 offen offset:2048 sc1 lds
  buffer_load_dwordx4 v20, s[28:31], s62 offen offset:3072 sc1 lds
  s_add_u32 m0, m0, 4096
  s_add_u32 s62, s62, 4096
  buffer_load_dwordx4 v20, s[28:31], s62 offen offset:0 sc1 lds
  buffer_load_dwordx4 v20, s[28:31], s62 offen offset:1024 sc1 lds
  buffer_load_dwordx4 v20, s[28:31], s62 offen offset:2048 sc1 lds
  s_add_u32 m0, s60, 45056
  s_mov_b32 s62, 1664
  buffer_load_dwordx4 v16, s[16:19], s62 offen offset:0 lds
  buffer_load_dwordx4 v17, s[16:19], s62 offen offset:1024 lds
  buffer_load_dwordx4 v18, s[16:19], s62 offen offset:2048 lds
  buffer_load_dwordx4 v19, s[16:19], s62 offen offset:3072 lds
  s_waitcnt vmcnt(11)
  s_barrier
  s_mov_b32 s63, 0
L_sp14:
  s_waitcnt lgkmcnt(0)
  s_xor_b64 s[10:11], s[64:65], s[8:9]
  s_xor_b64 s[12:13], s[66:67], s[8:9]
  s_or_b64 s[10:11], s[10:11], s[12:13]
  s_xor_b64 s[12:13], s[68:69], s[8:9]
  s_or_b64 s[10:11], s[10:11], s[12:13]
  s_xor_b64 s[12:13], s[70:71], s[8:9]
  s_or_b64 s[10:11], s[10:11], s[12:13]
  s_xor_b64 s[12:13], s[72:73], s[8:9]
  s_or_b64 s[10:11], s[10:11], s[12:13]
  s_xor_b64 s[12:13], s[74:75], s[8:9]
  s_or_b64 s[10:11], s[10:11], s[12:13]
  s_xor_b64 s[12:13], s[76:77], s[8:9]
  s_or_b64 s[10:11], s[10:11], s[12:13]
  s_xor_b64 s[12:13], s[78:79], s[8:9]
  s_or_b64 s[10:11], s[10:11], s[12:13]
  s_cbranch_scc0 L_ok14
  s_load_dwordx16 s[64:79], s[4:5], 28672 glc
  s_add_u32 s63, s63, 1
  s_cmp_lt_u32 s63, 20000
  s_cbranch_scc1 L_sp14
  s_waitcnt lgkmcnt(0)
L_ok14:
  s_load_dwordx16 s[64:79], s[4:5], 30720 glc
  s_add_u32 m0, s61, 90112
  s_mov_b32 s62, 401408
  buffer_load_dwordx4 v20, s[28:31], s62 offen offset:0 sc1 lds
  buffer_load_dwordx4 v20, s[28:31], s62 offen offset:1024 sc1 lds
  buffer_load_dwordx4 v20, s[28:31], s62 offen offset:2048 sc1 lds
  buffer_load_dwordx4 v20, s[28:31], s62 offen offset:3072 sc1 lds
  s_add_u32 m0, m0, 4096
  s_add_u32 s62, s62, 4096
  buffer_load_dwordx4 v20, s[28:31], s62 offen offset:0 sc1 lds
  buffer_load_dwordx4 v20, s[28:31], s62 offen offset:1024 sc1 lds
  buffer_load_dwordx4 v20, s[28:31], s62 offen offset:2048 sc1 lds
  s_add_u32 m0, s60, 90112
  s_mov_b32 s62, 1792
  buffer_load_dwordx4 v16, s[16:19], s62 offen offset:0 lds
  buffer_load_dwordx4 v17, s[16:19], s62 offen offset:1024 lds
  buffer_load_dwordx4 v18, s[16:19], s62 offen offset:2048 lds
  buffer_load_dwordx4 v19, s[16:19], s62 offen offset:3072 lds
  s_waitcnt vmcnt(11)
  s_barrier
  s_mov_b32 s63, 0
L_sp15:
  s_waitcnt lgkmcnt(0)
  s_xor_b64 s[10:11], s[64:65], s[8:9]
  s_xor_b64 s[12:13], s[66:67], s[8:9]
  s_or_b64 s[10:11], s[10:11], s[12:13]
  s_xor_b64 s[12:13], s[68:69], s[8:9]
  s_or_b64 s[10:11], s[10:11], s[12:13]
  s_xor_b64 s[12:13], s[70:71], s[8:9]
  s_or_b64 s[10:11], s[10:11], s[12:13]
  s_xor_b64 s[12:13], s[72:73], s[8:9]
  s_or_b64 s[10:11], s[10:11], s[12:13]
  s_xor_b64 s[12:13], s[74:75], s[8:9]
  s_or_b64 s[10:11], s[10:11], s[12:13]
  s_xor_b64 s[12:13], s[76:77], s[8:9]
  s_or_b64 s[10:11], s[10:11], s[12:13]
  s_xor_b64 s[12:13], s[78:79], s[8:9]
  s_or_b64 s[10:11], s[10:11], s[12:13]
  s_cbranch_scc0 L_ok15
  s_load_dwordx16 s[64:79], s[4:5], 30720 glc
  s_add_u32 s63, s63, 1
  s_cmp_lt_u32 s63, 20000
  s_cbranch_scc1 L_sp15
  s_waitcnt lgkmcnt(0)
L_ok15:
  s_add_u32 m0, s61, 0
  s_mov_b32 s62, 430080
  buffer_load_dwordx4 v20, s[28:31], s62 offen offset:0 sc1 lds
  buffer_load_dwordx4 v20, s[28:31], s62 offen offset:1024 sc1 lds
  buffer_load_dwordx4 v20, s[28:31], s62 offen offset:2048 sc1 lds
  buffer_load_dwordx4 v20, s[28:31], s62 offen offset:3072 sc1 lds
  s_add_u32 m0, m0, 4096
  s_add_u32 s62, s62, 4096
  buffer_load_dwordx4 v20, s[28:31], s62 offen offset:0 sc1 lds
  buffer_load_dwordx4 v20, s[28:31], s62 offen offset:1024 sc1 lds
  buffer_load_dwordx4 v20, s[28:31], s62 offen offset:2048 sc1 lds
  s_add_u32 m0, s60, 0
  s_mov_b32 s62, 1920
  buffer_load_dwordx4 v16, s[16:19], s62 offen offset:0 lds
  buffer_load_dwordx4 v17, s[16:19], s62 offen offset:1024 lds
  buffer_load_dwordx4 v18, s[16:19], s62 offen offset:2048 lds
  buffer_load_dwordx4 v19, s[16:19], s62 offen offset:3072 lds
  s_waitcnt vmcnt(11)
  s_barrier
  s_waitcnt vmcnt(0)
  s_barrier
  s_cmp_eq_u32 s39, 0
  s_cbranch_scc0 L_noe
  s_mov_b64 exec, 1
  buffer_atomic_cmpswap_x2 v[10:13], v8, s[28:31], 0 offen sc1
  s_mov_b64 exec, -1
L_noe:
  s_mov_b32 s62, 229376
  v_add_u32 v104, s57, v24
  v_add_u32 v105, s57, v25
  v_add_u32 v106, s57, v26
  v_add_u32 v107, s57, v27
  v_add_u32 v108, s57, v28
  v_add_u32 v109, s57, v29
  v_add_u32 v110, s57, v30
  s_barrier
  ds_read_b128 v[40:43], v24
  ds_read_b128 v[44:47], v25
  ds_read_b128 v[48:51], v26
  ds_read_b128 v[52:55], v27
  ds_read_b128 v[56:59], v28
  ds_read_b128 v[60:63], v29
  ds_read_b128 v[64:67], v30
  s_waitcnt lgkmcnt(6)
  buffer_store_dwordx4 v[40:43], v32, s[32:35], 0 offen sc0 sc1
  s_waitcnt lgkmcnt(5)
  buffer_store_dwordx4 v[44:47], v33, s[32:35], 0 offen sc0 sc1
  s_waitcnt lgkmcnt(4)
  buffer_store_dwordx4 v[48:51], v34, s[32:35], 0 offen sc0 sc1
  s_waitcnt lgkmcnt(3)
  buffer_store_dwordx4 v[52:55], v35, s[32:35], 0 offen sc0 sc1
  s_waitcnt lgkmcnt(2)
  buffer_store_dwordx4 v[56:59], v36, s[32:35], 0 offen sc0 sc1
  s_waitcnt lgkmcnt(1)
  buffer_store_dwordx4 v[60:63], v37, s[32:35], 0 offen sc0 sc1
  s_waitcnt lgkmcnt(0)
  buffer_store_dwordx4 v[64:67], v38, s[32:35], 0 offen sc0 sc1
  s_barrier
  ds_read_b128 v[68:71], v104
  ds_read_b128 v[72:75], v105
  ds_read_b128 v[76:79], v106
  ds_read_b128 v[80:83], v107
  ds_read_b128 v[84:87], v108
  ds_read_b128 v[88:91], v109
  ds_read_b128 v[92:95], v110
  s_waitcnt lgkmcnt(6)
  buffer_store_dwordx4 v[68:71], v32, s[32:35], s62 offen sc0 sc1
  s_waitcnt lgkmcnt(5)
  buffer_store_dwordx4 v[72:75], v33, s[32:35], s62 offen sc0 sc1
  s_waitcnt lgkmcnt(4)
  buffer_store_dwordx4 v[76:79], v34, s[32:35], s62 offen sc0 sc1
  s_waitcnt lgkmcnt(3)
  buffer_store_dwordx4 v[80:83], v35, s[32:35], s62 offen sc0 sc1
  s_waitcnt lgkmcnt(2)
  buffer_store_dwordx4 v[84:87], v36, s[32:35], s62 offen sc0 sc1
  s_waitcnt lgkmcnt(1)
  buffer_store_dwordx4 v[88:91], v37, s[32:35], s62 offen sc0 sc1
  s_waitcnt lgkmcnt(0)
  buffer_store_dwordx4 v[92:95], v38, s[32:35], s62 offen sc0 sc1
L_done:
  s_endpgm
.section .rodata,"a"
.p2align 6
.amdhsa_kernel standalone__weight_only_int_squeezellm__prompt_kernel
  .amdhsa_next_free_vgpr 240
  .amdhsa_next_free_sgpr 102
  .amdhsa_accum_offset 152
  .amdhsa_group_segment_fixed_size 0
  .amdhsa_kernarg_size 48
  .amdhsa_user_sgpr_count 2
  .amdhsa_user_sgpr_kernarg_segment_ptr 1
  .amdhsa_system_sgpr_workgroup_id_x 1
.end_amdhsa_kernel
```

```asm
; @launch grid=(256,1,1) block=(512,1,1) lds=159744
.amdgcn_target "amdgcn-amd-amdhsa--gfx950"
.text
.globl standalone__weight_only_int_squeezellm__prompt_kernel
.p2align 8
.type standalone__weight_only_int_squeezellm__prompt_kernel,@function
standalone__weight_only_int_squeezellm__prompt_kernel:
  s_cmp_ge_u32 s2, 256
  s_cbranch_scc1 L_done
  s_load_dwordx2 s[20:21], s[0:1], 8
  s_load_dwordx2 s[24:25], s[0:1], 16
  s_load_dwordx2 s[28:29], s[0:1], 40
  s_load_dwordx2 s[16:17], s[0:1], 0
  s_load_dwordx2 s[32:33], s[0:1], 24
  s_mov_b32 s18, 4194304
  s_mov_b32 s19, 0x20000
  s_mov_b32 s22, 14680064
  s_mov_b32 s23, 0x20000
  s_mov_b32 s26, 114688
  s_mov_b32 s27, 0x20000
  s_mov_b32 s30, 9457664
  s_mov_b32 s31, 0x20000
  s_mov_b32 s34, 14680064
  s_mov_b32 s35, 0x20000
  v_lshrrev_b32 v1, 6, v0
  v_and_b32 v2, 63, v0
  v_readfirstlane_b32 s38, v1
  v_and_b32 v3, 31, v0
  v_bfe_u32 v9, v0, 5, 1
  s_mov_b32 s45, 14336
  s_mov_b32 s46, 28672
  s_mov_b32 s47, 43008
  v_mul_u32_u24 v1, 57344, v9
  v_lshl_add_u32 v4, v3, 4, v1
  v_lshlrev_b32 v1, 3, v3
  v_lshl_add_u32 v16, v9, 2, v1
  v_lshlrev_b32 v5, 2, v3
  s_cmp_lt_u32 s2, 32
  s_cbranch_scc1 L_prod
  s_and_b32 s3, s2, 1
  s_lshl_b32 s3, s3, 2
  s_bfe_u32 s36, s2, 0x20003
  s_add_u32 s36, s36, s3
  s_bfe_u32 s3, s2, 0x20001
  s_mul_i32 s3, s3, 7
  s_lshr_b32 s37, s2, 5
  s_add_u32 s37, s37, s3
  s_sub_u32 s37, s37, 1
  s_and_b32 s39, s38, 3
  s_cmp_ge_u32 s38, 4
  s_cbranch_scc1 L_loader
  s_lshl_b32 s52, s36, 2
  s_add_u32 s52, s52, s38
  s_mul_i32 s53, s52, 114688
  s_lshl_b32 s54, s37, 9
  s_add_u32 s53, s53, s54
  v_add_u32 v4, s53, v4
  s_waitcnt lgkmcnt(0)
  buffer_load_dwordx4 v[32:35], v4, s[20:23], 0 offen
  buffer_load_dwordx4 v[36:39], v4, s[20:23], s45 offen
  buffer_load_dwordx4 v[40:43], v4, s[20:23], s46 offen
  buffer_load_dwordx4 v[44:47], v4, s[20:23], s47 offen
  s_add_u32 s10, s28, 9437184
  s_addc_u32 s11, s29, 0
  s_load_dwordx2 s[6:7], s[10:11], 0
  v_add_u32 v5, 147456, v5
  s_lshl_b32 s53, s38, 11
  s_add_u32 s53, s53, 151552
  v_and_b32 v1, 1, v3
  v_lshlrev_b32 v1, 10, v1
  v_lshl_add_u32 v1, v9, 3, v1
  v_lshrrev_b32 v6, 1, v3
  v_lshl_add_u32 v6, v6, 4, v1
  v_add_u32 v6, s53, v6
  v_lshl_add_u32 v7, v2, 4, s53
  s_lshl_b32 s53, s37, 18
  s_lshl_b32 s54, s52, 11
  s_add_u32 s53, s53, s54
  v_lshl_add_u32 v8, v2, 4, s53
  s_lshl_b32 s53, s37, 6
  s_lshr_b32 s54, s52, 1
  s_add_u32 s53, s53, s54
  s_lshl_b32 s53, s53, 8
  s_and_b32 s54, s52, 1
  s_lshl_b32 s54, s54, 3
  s_add_u32 s53, s53, s54
  s_add_u32 s53, s53, 7340032
  v_lshl_add_u32 v14, v2, 7, s53
  v_and_b32 v3, 15, v2
  v_lshrrev_b32 v9, 4, v2
  v_lshrrev_b32 v1, 1, v3
  v_xor_b32 v1, v1, v9
  v_lshlrev_b32 v1, 4, v1
  v_lshl_add_u32 v144, v3, 7, v1
  s_lshl_b32 s54, s38, 13
  v_add_u32 v144, s54, v144
  v_xor_b32 v145, 64, v144
  v_lshlrev_b32 v1, 11, v9
  v_lshl_add_u32 v146, v3, 4, v1
  v_add_u32 v146, 32768, v146
  s_lshl_b32 s52, s36, 8
  s_lshl_b32 s53, s38, 6
  s_add_u32 s52, s52, s53
  s_mul_i32 s52, s52, 7168
  s_lshl_b32 s53, s37, 8
  s_add_u32 s52, s52, s53
  v_mul_u32_u24 v1, 28672, v9
  v_lshl_add_u32 v1, v3, 4, v1
  v_add_u32 v147, s52, v1
  s_waitcnt lgkmcnt(0)
  s_mul_i32 s8, s6, 1664525
  s_mul_i32 s9, s7, 22695477
  s_add_u32 s8, s8, 1013904223
  s_add_u32 s9, s9, 1
  v_mov_b32 v10, s8
  v_mov_b32 v11, s9
  s_barrier
  s_waitcnt vmcnt(3)
  v_lshl_add_u32 v32, v32, 8, v5
  v_lshl_add_u32 v33, v33, 8, v5
  v_lshl_add_u32 v34, v34, 8, v5
  v_lshl_add_u32 v35, v35, 8, v5
  ds_read_u16 v96, v32 offset:0
  ds_read_u16 v97, v33 offset:2
  ds_read_u16 v98, v34 offset:128
  ds_read_u16 v99, v35 offset:130
  s_waitcnt vmcnt(2)
  v_lshl_add_u32 v36, v36, 8, v5
  v_lshl_add_u32 v37, v37, 8, v5
  v_lshl_add_u32 v38, v38, 8, v5
  v_lshl_add_u32 v39, v39, 8, v5
  ds_read_u16 v100, v36 offset:0
  ds_read_u16 v101, v37 offset:2
  ds_read_u16 v102, v38 offset:128
  ds_read_u16 v103, v39 offset:130
  s_waitcnt vmcnt(1)
  v_lshl_add_u32 v40, v40, 8, v5
  v_lshl_add_u32 v41, v41, 8, v5
  v_lshl_add_u32 v42, v42, 8, v5
  v_lshl_add_u32 v43, v43, 8, v5
  ds_read_u16 v104, v40 offset:0
  ds_read_u16 v105, v41 offset:2
  ds_read_u16 v106, v42 offset:128
  ds_read_u16 v107, v43 offset:130
  s_waitcnt vmcnt(0)
  v_lshl_add_u32 v44, v44, 8, v5
  v_lshl_add_u32 v45, v45, 8, v5
  v_lshl_add_u32 v46, v46, 8, v5
  v_lshl_add_u32 v47, v47, 8, v5
  ds_read_u16 v108, v44 offset:0
  ds_read_u16 v109, v45 offset:2
  ds_read_u16 v110, v46 offset:128
  ds_read_u16 v111, v47 offset:130
  s_waitcnt lgkmcnt(8)
  v_lshl_or_b32 v112, v100, 16, v96
  v_lshl_or_b32 v114, v101, 16, v97
  v_lshl_or_b32 v116, v102, 16, v98
  v_lshl_or_b32 v118, v103, 16, v99
  s_waitcnt lgkmcnt(3)
  v_lshl_or_b32 v113, v108, 16, v104
  ds_write_b64 v6, v[112:113] offset:0
  s_waitcnt lgkmcnt(3)
  v_lshl_or_b32 v115, v109, 16, v105
  ds_write_b64 v6, v[114:115] offset:256
  s_waitcnt lgkmcnt(3)
  v_lshl_or_b32 v117, v110, 16, v106
  ds_write_b64 v6, v[116:117] offset:512
  s_waitcnt lgkmcnt(3)
  v_lshl_or_b32 v119, v111, 16, v107
  ds_write_b64 v6, v[118:119] offset:768
  s_waitcnt lgkmcnt(0)
  ds_read_b128 v[148:151], v7 offset:0
  ds_read_b128 v[152:155], v7 offset:1024
  s_waitcnt lgkmcnt(1)
  buffer_store_dwordx4 v[148:151], v8, s[28:31], 0 offen offset:0 sc1
  s_waitcnt lgkmcnt(0)
  buffer_store_dwordx4 v[152:155], v8, s[28:31], 0 offen offset:1024 sc1
  s_mov_b32 s44, 0
  s_mov_b32 s45, 7168
  s_mov_b32 s46, 14336
  s_mov_b32 s47, 21504
  s_mov_b32 s48, 114688
  s_mov_b32 s49, 121856
  s_mov_b32 s50, 129024
  s_mov_b32 s51, 136192
  s_mov_b32 s52, 229376
  s_mov_b32 s53, 236544
  s_mov_b32 s54, 243712
  s_mov_b32 s55, 250880
  s_mov_b32 s56, 344064
  s_mov_b32 s57, 351232
  s_mov_b32 s58, 358400
  s_mov_b32 s59, 365568
  v_mov_b32 v5, v144
  v_mov_b32 v6, v145
  v_mov_b32 v7, v146
  v_mov_b32 v16, 0
  v_mov_b32 v17, 0
  v_mov_b32 v18, 0
  v_mov_b32 v19, 0
  v_mov_b32 v20, 0
  v_mov_b32 v21, 0
  v_mov_b32 v22, 0
  v_mov_b32 v23, 0
  v_mov_b32 v24, 0
  v_mov_b32 v25, 0
  v_mov_b32 v26, 0
  v_mov_b32 v27, 0
  v_mov_b32 v28, 0
  v_mov_b32 v29, 0
  v_mov_b32 v30, 0
  v_mov_b32 v31, 0
  v_mov_b32 v32, 0
  v_mov_b32 v33, 0
  v_mov_b32 v34, 0
  v_mov_b32 v35, 0
  v_mov_b32 v36, 0
  v_mov_b32 v37, 0
  v_mov_b32 v38, 0
  v_mov_b32 v39, 0
  v_mov_b32 v40, 0
  v_mov_b32 v41, 0
  v_mov_b32 v42, 0
  v_mov_b32 v43, 0
  v_mov_b32 v44, 0
  v_mov_b32 v45, 0
  v_mov_b32 v46, 0
  v_mov_b32 v47, 0
  v_mov_b32 v48, 0
  v_mov_b32 v49, 0
  v_mov_b32 v50, 0
  v_mov_b32 v51, 0
  v_mov_b32 v52, 0
  v_mov_b32 v53, 0
  v_mov_b32 v54, 0
  v_mov_b32 v55, 0
  v_mov_b32 v56, 0
  v_mov_b32 v57, 0
  v_mov_b32 v58, 0
  v_mov_b32 v59, 0
  v_mov_b32 v60, 0
  v_mov_b32 v61, 0
  v_mov_b32 v62, 0
  v_mov_b32 v63, 0
  v_mov_b32 v64, 0
  v_mov_b32 v65, 0
  v_mov_b32 v66, 0
  v_mov_b32 v67, 0
  v_mov_b32 v68, 0
  v_mov_b32 v69, 0
  v_mov_b32 v70, 0
  v_mov_b32 v71, 0
  v_mov_b32 v72, 0
  v_mov_b32 v73, 0
  v_mov_b32 v74, 0
  v_mov_b32 v75, 0
  v_mov_b32 v76, 0
  v_mov_b32 v77, 0
  v_mov_b32 v78, 0
  v_mov_b32 v79, 0
  v_mov_b32 v80, 0
  v_mov_b32 v81, 0
  v_mov_b32 v82, 0
  v_mov_b32 v83, 0
  v_mov_b32 v84, 0
  v_mov_b32 v85, 0
  v_mov_b32 v86, 0
  v_mov_b32 v87, 0
  v_mov_b32 v88, 0
  v_mov_b32 v89, 0
  v_mov_b32 v90, 0
  v_mov_b32 v91, 0
  v_mov_b32 v92, 0
  v_mov_b32 v93, 0
  v_mov_b32 v94, 0
  v_mov_b32 v95, 0
  v_mov_b32 v96, 0
  v_mov_b32 v97, 0
  v_mov_b32 v98, 0
  v_mov_b32 v99, 0
  v_mov_b32 v100, 0
  v_mov_b32 v101, 0
  v_mov_b32 v102, 0
  v_mov_b32 v103, 0
  v_mov_b32 v104, 0
  v_mov_b32 v105, 0
  v_mov_b32 v106, 0
  v_mov_b32 v107, 0
  v_mov_b32 v108, 0
  v_mov_b32 v109, 0
  v_mov_b32 v110, 0
  v_mov_b32 v111, 0
  v_mov_b32 v112, 0
  v_mov_b32 v113, 0
  v_mov_b32 v114, 0
  v_mov_b32 v115, 0
  v_mov_b32 v116, 0
  v_mov_b32 v117, 0
  v_mov_b32 v118, 0
  v_mov_b32 v119, 0
  v_mov_b32 v120, 0
  v_mov_b32 v121, 0
  v_mov_b32 v122, 0
  v_mov_b32 v123, 0
  v_mov_b32 v124, 0
  v_mov_b32 v125, 0
  v_mov_b32 v126, 0
  v_mov_b32 v127, 0
  v_mov_b32 v128, 0
  v_mov_b32 v129, 0
  v_mov_b32 v130, 0
  v_mov_b32 v131, 0
  v_mov_b32 v132, 0
  v_mov_b32 v133, 0
  v_mov_b32 v134, 0
  v_mov_b32 v135, 0
  v_mov_b32 v136, 0
  v_mov_b32 v137, 0
  v_mov_b32 v138, 0
  v_mov_b32 v139, 0
  v_mov_b32 v140, 0
  v_mov_b32 v141, 0
  v_mov_b32 v142, 0
  v_mov_b32 v143, 0
  s_waitcnt vmcnt(0)
  s_mov_b64 exec, 3
  buffer_store_dwordx2 v[10:11], v14, s[28:31], 0 offen sc1
  s_mov_b64 exec, -1
  s_mov_b32 s60, 0
  s_mov_b32 s61, 0
  s_barrier
  ds_read_b128 a[16:19], v7 offset:0
  ds_read_b128 a[0:3], v5 offset:0
  ds_read_b128 a[4:7], v5 offset:2048
  ds_read_b128 a[8:11], v5 offset:4096
  ds_read_b128 a[12:15], v5 offset:6144
  ds_read_b128 a[20:23], v7 offset:256
  ds_read_b128 a[24:27], v7 offset:512
  ds_read_b128 a[28:31], v7 offset:768
  ds_read_b128 a[32:35], v7 offset:1024
  ds_read_b128 a[36:39], v7 offset:1280
  ds_read_b128 a[40:43], v7 offset:1536
  ds_read_b128 a[44:47], v7 offset:1792
  s_cmp_eq_u32 s38, 0
  s_cbranch_scc0 L_c0
  s_lshl_b32 s3, s2, 6
  s_add_u32 s3, s3, 9441280
  v_mov_b32 v12, s3
  s_mov_b64 exec, 1
  buffer_store_dwordx2 v[10:11], v12, s[28:31], 0 offen sc1
  s_mov_b64 exec, -1
L_c0:
  s_waitcnt lgkmcnt(0)
.p2align 6
L_c:
  v_mfma_f32_16x16x32_bf16 v[16:19], a[0:3], a[16:19], v[16:19]
  v_mfma_f32_16x16x32_bf16 v[48:51], a[4:7], a[16:19], v[48:51]
  s_add_u32 s60, s60, 49152
  ds_read_b128 a[64:67], v7 offset:8192
  v_mfma_f32_16x16x32_bf16 v[80:83], a[8:11], a[16:19], v[80:83]
  v_mfma_f32_16x16x32_bf16 v[112:115], a[12:15], a[16:19], v[112:115]
  s_cmp_eq_u32 s60, 147456
  ds_read_b128 a[48:51], v6 offset:0
  v_mfma_f32_16x16x32_bf16 v[20:23], a[0:3], a[20:23], v[20:23]
  v_mfma_f32_16x16x32_bf16 v[52:55], a[4:7], a[20:23], v[52:55]
  s_cselect_b32 s60, 0, s60
  s_add_u32 s61, s61, 1
  ds_read_b128 a[52:55], v6 offset:2048
  v_mfma_f32_16x16x32_bf16 v[84:87], a[8:11], a[20:23], v[84:87]
  v_mfma_f32_16x16x32_bf16 v[116:119], a[12:15], a[20:23], v[116:119]
  ds_read_b128 a[56:59], v6 offset:4096
  v_mfma_f32_16x16x32_bf16 v[24:27], a[0:3], a[24:27], v[24:27]
  v_mfma_f32_16x16x32_bf16 v[56:59], a[4:7], a[24:27], v[56:59]
  ds_read_b128 a[60:63], v6 offset:6144
  v_mfma_f32_16x16x32_bf16 v[88:91], a[8:11], a[24:27], v[88:91]
  v_mfma_f32_16x16x32_bf16 v[120:123], a[12:15], a[24:27], v[120:123]
  ds_read_b128 a[68:71], v7 offset:8448
  v_mfma_f32_16x16x32_bf16 v[28:31], a[0:3], a[28:31], v[28:31]
  v_mfma_f32_16x16x32_bf16 v[60:63], a[4:7], a[28:31], v[60:63]
  ds_read_b128 a[72:75], v7 offset:8704
  v_mfma_f32_16x16x32_bf16 v[92:95], a[8:11], a[28:31], v[92:95]
  v_mfma_f32_16x16x32_bf16 v[124:127], a[12:15], a[28:31], v[124:127]
  ds_read_b128 a[76:79], v7 offset:8960
  v_mfma_f32_16x16x32_bf16 v[32:35], a[0:3], a[32:35], v[32:35]
  v_mfma_f32_16x16x32_bf16 v[64:67], a[4:7], a[32:35], v[64:67]
  ds_read_b128 a[80:83], v7 offset:9216
  v_mfma_f32_16x16x32_bf16 v[96:99], a[8:11], a[32:35], v[96:99]
  v_mfma_f32_16x16x32_bf16 v[128:131], a[12:15], a[32:35], v[128:131]
  ds_read_b128 a[84:87], v7 offset:9472
  v_mfma_f32_16x16x32_bf16 v[36:39], a[0:3], a[36:39], v[36:39]
  v_mfma_f32_16x16x32_bf16 v[68:71], a[4:7], a[36:39], v[68:71]
  ds_read_b128 a[88:91], v7 offset:9728
  v_mfma_f32_16x16x32_bf16 v[100:103], a[8:11], a[36:39], v[100:103]
  v_mfma_f32_16x16x32_bf16 v[132:135], a[12:15], a[36:39], v[132:135]
  ds_read_b128 a[92:95], v7 offset:9984
  v_mfma_f32_16x16x32_bf16 v[40:43], a[0:3], a[40:43], v[40:43]
  v_mfma_f32_16x16x32_bf16 v[72:75], a[4:7], a[40:43], v[72:75]
  v_mfma_f32_16x16x32_bf16 v[104:107], a[8:11], a[40:43], v[104:107]
  v_mfma_f32_16x16x32_bf16 v[136:139], a[12:15], a[40:43], v[136:139]
  v_mfma_f32_16x16x32_bf16 v[44:47], a[0:3], a[44:47], v[44:47]
  v_mfma_f32_16x16x32_bf16 v[76:79], a[4:7], a[44:47], v[76:79]
  v_mfma_f32_16x16x32_bf16 v[108:111], a[8:11], a[44:47], v[108:111]
  v_mfma_f32_16x16x32_bf16 v[140:143], a[12:15], a[44:47], v[140:143]
  s_waitcnt lgkmcnt(0)
  s_barrier
  v_mfma_f32_16x16x32_bf16 v[16:19], a[48:51], a[64:67], v[16:19]
  v_add_u32 v7, s60, v146
  v_add_u32 v5, s60, v144
  v_mfma_f32_16x16x32_bf16 v[48:51], a[52:55], a[64:67], v[48:51]
  ds_read_b128 a[16:19], v7 offset:0
  v_mfma_f32_16x16x32_bf16 v[80:83], a[56:59], a[64:67], v[80:83]
  v_add_u32 v6, s60, v145
  s_cmp_lt_u32 s61, 12
  v_mfma_f32_16x16x32_bf16 v[112:115], a[60:63], a[64:67], v[112:115]
  ds_read_b128 a[0:3], v5 offset:0
  v_mfma_f32_16x16x32_bf16 v[20:23], a[48:51], a[68:71], v[20:23]
  v_mfma_f32_16x16x32_bf16 v[52:55], a[52:55], a[68:71], v[52:55]
  ds_read_b128 a[4:7], v5 offset:2048
  v_mfma_f32_16x16x32_bf16 v[84:87], a[56:59], a[68:71], v[84:87]
  v_mfma_f32_16x16x32_bf16 v[116:119], a[60:63], a[68:71], v[116:119]
  ds_read_b128 a[8:11], v5 offset:4096
  v_mfma_f32_16x16x32_bf16 v[24:27], a[48:51], a[72:75], v[24:27]
  v_mfma_f32_16x16x32_bf16 v[56:59], a[52:55], a[72:75], v[56:59]
  ds_read_b128 a[12:15], v5 offset:6144
  v_mfma_f32_16x16x32_bf16 v[88:91], a[56:59], a[72:75], v[88:91]
  v_mfma_f32_16x16x32_bf16 v[120:123], a[60:63], a[72:75], v[120:123]
  ds_read_b128 a[20:23], v7 offset:256
  v_mfma_f32_16x16x32_bf16 v[28:31], a[48:51], a[76:79], v[28:31]
  v_mfma_f32_16x16x32_bf16 v[60:63], a[52:55], a[76:79], v[60:63]
  ds_read_b128 a[24:27], v7 offset:512
  v_mfma_f32_16x16x32_bf16 v[92:95], a[56:59], a[76:79], v[92:95]
  v_mfma_f32_16x16x32_bf16 v[124:127], a[60:63], a[76:79], v[124:127]
  ds_read_b128 a[28:31], v7 offset:768
  v_mfma_f32_16x16x32_bf16 v[32:35], a[48:51], a[80:83], v[32:35]
  v_mfma_f32_16x16x32_bf16 v[64:67], a[52:55], a[80:83], v[64:67]
  ds_read_b128 a[32:35], v7 offset:1024
  v_mfma_f32_16x16x32_bf16 v[96:99], a[56:59], a[80:83], v[96:99]
  v_mfma_f32_16x16x32_bf16 v[128:131], a[60:63], a[80:83], v[128:131]
  ds_read_b128 a[36:39], v7 offset:1280
  v_mfma_f32_16x16x32_bf16 v[36:39], a[48:51], a[84:87], v[36:39]
  v_mfma_f32_16x16x32_bf16 v[68:71], a[52:55], a[84:87], v[68:71]
  ds_read_b128 a[40:43], v7 offset:1536
  v_mfma_f32_16x16x32_bf16 v[100:103], a[56:59], a[84:87], v[100:103]
  v_mfma_f32_16x16x32_bf16 v[132:135], a[60:63], a[84:87], v[132:135]
  ds_read_b128 a[44:47], v7 offset:1792
  v_mfma_f32_16x16x32_bf16 v[40:43], a[48:51], a[88:91], v[40:43]
  v_mfma_f32_16x16x32_bf16 v[72:75], a[52:55], a[88:91], v[72:75]
  v_mfma_f32_16x16x32_bf16 v[104:107], a[56:59], a[88:91], v[104:107]
  v_mfma_f32_16x16x32_bf16 v[136:139], a[60:63], a[88:91], v[136:139]
  v_mfma_f32_16x16x32_bf16 v[44:47], a[48:51], a[92:95], v[44:47]
  v_mfma_f32_16x16x32_bf16 v[76:79], a[52:55], a[92:95], v[76:79]
  v_mfma_f32_16x16x32_bf16 v[108:111], a[56:59], a[92:95], v[108:111]
  v_mfma_f32_16x16x32_bf16 v[140:143], a[60:63], a[92:95], v[140:143]
  s_waitcnt lgkmcnt(0)
  s_cbranch_scc1 L_c
  v_mfma_f32_16x16x32_bf16 v[16:19], a[0:3], a[16:19], v[16:19]
  v_mfma_f32_16x16x32_bf16 v[48:51], a[4:7], a[16:19], v[48:51]
  ds_read_b128 a[64:67], v7 offset:8192
  v_mfma_f32_16x16x32_bf16 v[80:83], a[8:11], a[16:19], v[80:83]
  v_add_u32 v8, 49152, v144
  v_mfma_f32_16x16x32_bf16 v[112:115], a[12:15], a[16:19], v[112:115]
  ds_read_b128 a[48:51], v6 offset:0
  v_mfma_f32_16x16x32_bf16 v[20:23], a[0:3], a[20:23], v[20:23]
  v_add_u32 v9, 49152, v145
  v_mfma_f32_16x16x32_bf16 v[52:55], a[4:7], a[20:23], v[52:55]
  ds_read_b128 a[52:55], v6 offset:2048
  v_mfma_f32_16x16x32_bf16 v[84:87], a[8:11], a[20:23], v[84:87]
  v_add_u32 v10, 49152, v146
  v_mfma_f32_16x16x32_bf16 v[116:119], a[12:15], a[20:23], v[116:119]
  ds_read_b128 a[56:59], v6 offset:4096
  v_mfma_f32_16x16x32_bf16 v[24:27], a[0:3], a[24:27], v[24:27]
  v_add_u32 v11, 98304, v144
  v_mfma_f32_16x16x32_bf16 v[56:59], a[4:7], a[24:27], v[56:59]
  ds_read_b128 a[60:63], v6 offset:6144
  v_mfma_f32_16x16x32_bf16 v[88:91], a[8:11], a[24:27], v[88:91]
  v_add_u32 v12, 98304, v145
  v_mfma_f32_16x16x32_bf16 v[120:123], a[12:15], a[24:27], v[120:123]
  ds_read_b128 a[68:71], v7 offset:8448
  v_mfma_f32_16x16x32_bf16 v[28:31], a[0:3], a[28:31], v[28:31]
  v_add_u32 v13, 98304, v146
  v_mfma_f32_16x16x32_bf16 v[60:63], a[4:7], a[28:31], v[60:63]
  ds_read_b128 a[72:75], v7 offset:8704
  v_mfma_f32_16x16x32_bf16 v[92:95], a[8:11], a[28:31], v[92:95]
  v_mfma_f32_16x16x32_bf16 v[124:127], a[12:15], a[28:31], v[124:127]
  ds_read_b128 a[76:79], v7 offset:8960
  v_mfma_f32_16x16x32_bf16 v[32:35], a[0:3], a[32:35], v[32:35]
  v_mfma_f32_16x16x32_bf16 v[64:67], a[4:7], a[32:35], v[64:67]
  ds_read_b128 a[80:83], v7 offset:9216
  v_mfma_f32_16x16x32_bf16 v[96:99], a[8:11], a[32:35], v[96:99]
  v_mfma_f32_16x16x32_bf16 v[128:131], a[12:15], a[32:35], v[128:131]
  ds_read_b128 a[84:87], v7 offset:9472
  v_mfma_f32_16x16x32_bf16 v[36:39], a[0:3], a[36:39], v[36:39]
  v_mfma_f32_16x16x32_bf16 v[68:71], a[4:7], a[36:39], v[68:71]
  ds_read_b128 a[88:91], v7 offset:9728
  v_mfma_f32_16x16x32_bf16 v[100:103], a[8:11], a[36:39], v[100:103]
  v_mfma_f32_16x16x32_bf16 v[132:135], a[12:15], a[36:39], v[132:135]
  ds_read_b128 a[92:95], v7 offset:9984
  v_mfma_f32_16x16x32_bf16 v[40:43], a[0:3], a[40:43], v[40:43]
  v_mfma_f32_16x16x32_bf16 v[72:75], a[4:7], a[40:43], v[72:75]
  v_mfma_f32_16x16x32_bf16 v[104:107], a[8:11], a[40:43], v[104:107]
  v_mfma_f32_16x16x32_bf16 v[136:139], a[12:15], a[40:43], v[136:139]
  v_mfma_f32_16x16x32_bf16 v[44:47], a[0:3], a[44:47], v[44:47]
  v_mfma_f32_16x16x32_bf16 v[76:79], a[4:7], a[44:47], v[76:79]
  v_mfma_f32_16x16x32_bf16 v[108:111], a[8:11], a[44:47], v[108:111]
  v_mfma_f32_16x16x32_bf16 v[140:143], a[12:15], a[44:47], v[140:143]
  s_waitcnt lgkmcnt(0)
  s_barrier
  v_mfma_f32_16x16x32_bf16 v[16:19], a[48:51], a[64:67], v[16:19]
  v_mfma_f32_16x16x32_bf16 v[48:51], a[52:55], a[64:67], v[48:51]
  ds_read_b128 a[16:19], v10 offset:0
  v_mfma_f32_16x16x32_bf16 v[80:83], a[56:59], a[64:67], v[80:83]
  v_mfma_f32_16x16x32_bf16 v[112:115], a[60:63], a[64:67], v[112:115]
  ds_read_b128 a[0:3], v8 offset:0
  v_mfma_f32_16x16x32_bf16 v[20:23], a[48:51], a[68:71], v[20:23]
  v_mfma_f32_16x16x32_bf16 v[52:55], a[52:55], a[68:71], v[52:55]
  ds_read_b128 a[4:7], v8 offset:2048
  v_mfma_f32_16x16x32_bf16 v[84:87], a[56:59], a[68:71], v[84:87]
  v_mfma_f32_16x16x32_bf16 v[116:119], a[60:63], a[68:71], v[116:119]
  ds_read_b128 a[20:23], v10 offset:256
  v_mfma_f32_16x16x32_bf16 v[24:27], a[48:51], a[72:75], v[24:27]
  v_mfma_f32_16x16x32_bf16 v[56:59], a[52:55], a[72:75], v[56:59]
  ds_read_b128 a[24:27], v10 offset:512
  v_mfma_f32_16x16x32_bf16 v[88:91], a[56:59], a[72:75], v[88:91]
  v_mfma_f32_16x16x32_bf16 v[120:123], a[60:63], a[72:75], v[120:123]
  ds_read_b128 a[28:31], v10 offset:768
  v_mfma_f32_16x16x32_bf16 v[28:31], a[48:51], a[76:79], v[28:31]
  v_mfma_f32_16x16x32_bf16 v[60:63], a[52:55], a[76:79], v[60:63]
  ds_read_b128 a[32:35], v10 offset:1024
  v_mfma_f32_16x16x32_bf16 v[92:95], a[56:59], a[76:79], v[92:95]
  v_mfma_f32_16x16x32_bf16 v[124:127], a[60:63], a[76:79], v[124:127]
  ds_read_b128 a[36:39], v10 offset:1280
  v_mfma_f32_16x16x32_bf16 v[32:35], a[48:51], a[80:83], v[32:35]
  v_mfma_f32_16x16x32_bf16 v[64:67], a[52:55], a[80:83], v[64:67]
  ds_read_b128 a[40:43], v10 offset:1536
  v_mfma_f32_16x16x32_bf16 v[96:99], a[56:59], a[80:83], v[96:99]
  v_mfma_f32_16x16x32_bf16 v[128:131], a[60:63], a[80:83], v[128:131]
  ds_read_b128 a[44:47], v10 offset:1792
  v_mfma_f32_16x16x32_bf16 v[36:39], a[48:51], a[84:87], v[36:39]
  v_mfma_f32_16x16x32_bf16 v[68:71], a[52:55], a[84:87], v[68:71]
  v_mfma_f32_16x16x32_bf16 v[100:103], a[56:59], a[84:87], v[100:103]
  v_mfma_f32_16x16x32_bf16 v[132:135], a[60:63], a[84:87], v[132:135]
  v_mfma_f32_16x16x32_bf16 v[40:43], a[48:51], a[88:91], v[40:43]
  v_mfma_f32_16x16x32_bf16 v[72:75], a[52:55], a[88:91], v[72:75]
  v_mfma_f32_16x16x32_bf16 v[104:107], a[56:59], a[88:91], v[104:107]
  v_mfma_f32_16x16x32_bf16 v[136:139], a[60:63], a[88:91], v[136:139]
  v_mfma_f32_16x16x32_bf16 v[44:47], a[48:51], a[92:95], v[44:47]
  v_mfma_f32_16x16x32_bf16 v[76:79], a[52:55], a[92:95], v[76:79]
  v_mfma_f32_16x16x32_bf16 v[108:111], a[56:59], a[92:95], v[108:111]
  v_mfma_f32_16x16x32_bf16 v[140:143], a[60:63], a[92:95], v[140:143]
  s_waitcnt lgkmcnt(0)
  s_nop 0
  v_mfma_f32_16x16x32_bf16 v[16:19], a[0:3], a[16:19], v[16:19]
  ds_read_b128 a[64:67], v10 offset:8192
  v_mfma_f32_16x16x32_bf16 v[48:51], a[4:7], a[16:19], v[48:51]
  ds_read_b128 a[48:51], v9 offset:0
  v_mfma_f32_16x16x32_bf16 v[20:23], a[0:3], a[20:23], v[20:23]
  ds_read_b128 a[52:55], v9 offset:2048
  v_mfma_f32_16x16x32_bf16 v[52:55], a[4:7], a[20:23], v[52:55]
  ds_read_b128 a[68:71], v10 offset:8448
  v_mfma_f32_16x16x32_bf16 v[24:27], a[0:3], a[24:27], v[24:27]
  ds_read_b128 a[72:75], v10 offset:8704
  v_mfma_f32_16x16x32_bf16 v[56:59], a[4:7], a[24:27], v[56:59]
  ds_read_b128 a[76:79], v10 offset:8960
  v_mfma_f32_16x16x32_bf16 v[28:31], a[0:3], a[28:31], v[28:31]
  ds_read_b128 a[80:83], v10 offset:9216
  v_mfma_f32_16x16x32_bf16 v[60:63], a[4:7], a[28:31], v[60:63]
  ds_read_b128 a[84:87], v10 offset:9472
  v_mfma_f32_16x16x32_bf16 v[32:35], a[0:3], a[32:35], v[32:35]
  ds_read_b128 a[88:91], v10 offset:9728
  v_mfma_f32_16x16x32_bf16 v[64:67], a[4:7], a[32:35], v[64:67]
  ds_read_b128 a[92:95], v10 offset:9984
  v_mfma_f32_16x16x32_bf16 v[36:39], a[0:3], a[36:39], v[36:39]
  v_mfma_f32_16x16x32_bf16 v[68:71], a[4:7], a[36:39], v[68:71]
  v_mfma_f32_16x16x32_bf16 v[40:43], a[0:3], a[40:43], v[40:43]
  v_mfma_f32_16x16x32_bf16 v[72:75], a[4:7], a[40:43], v[72:75]
  v_mfma_f32_16x16x32_bf16 v[44:47], a[0:3], a[44:47], v[44:47]
  v_mfma_f32_16x16x32_bf16 v[76:79], a[4:7], a[44:47], v[76:79]
  s_waitcnt lgkmcnt(0)
  s_barrier
  v_mfma_f32_16x16x32_bf16 v[16:19], a[48:51], a[64:67], v[16:19]
  ds_read_b128 a[16:19], v13 offset:0
  v_mfma_f32_16x16x32_bf16 v[48:51], a[52:55], a[64:67], v[48:51]
  ds_read_b128 a[0:3], v11 offset:0
  v_mfma_f32_16x16x32_bf16 v[20:23], a[48:51], a[68:71], v[20:23]
  ds_read_b128 a[4:7], v11 offset:2048
  v_mfma_f32_16x16x32_bf16 v[52:55], a[52:55], a[68:71], v[52:55]
  ds_read_b128 a[20:23], v13 offset:256
  v_mfma_f32_16x16x32_bf16 v[24:27], a[48:51], a[72:75], v[24:27]
  ds_read_b128 a[24:27], v13 offset:512
  v_mfma_f32_16x16x32_bf16 v[56:59], a[52:55], a[72:75], v[56:59]
  ds_read_b128 a[28:31], v13 offset:768
  v_mfma_f32_16x16x32_bf16 v[28:31], a[48:51], a[76:79], v[28:31]
  ds_read_b128 a[32:35], v13 offset:1024
  v_mfma_f32_16x16x32_bf16 v[60:63], a[52:55], a[76:79], v[60:63]
  ds_read_b128 a[36:39], v13 offset:1280
  v_mfma_f32_16x16x32_bf16 v[32:35], a[48:51], a[80:83], v[32:35]
  ds_read_b128 a[40:43], v13 offset:1536
  v_mfma_f32_16x16x32_bf16 v[64:67], a[52:55], a[80:83], v[64:67]
  ds_read_b128 a[44:47], v13 offset:1792
  v_mfma_f32_16x16x32_bf16 v[36:39], a[48:51], a[84:87], v[36:39]
  v_mfma_f32_16x16x32_bf16 v[68:71], a[52:55], a[84:87], v[68:71]
  v_mfma_f32_16x16x32_bf16 v[40:43], a[48:51], a[88:91], v[40:43]
  v_mfma_f32_16x16x32_bf16 v[72:75], a[52:55], a[88:91], v[72:75]
  v_mfma_f32_16x16x32_bf16 v[44:47], a[48:51], a[92:95], v[44:47]
  v_mfma_f32_16x16x32_bf16 v[76:79], a[52:55], a[92:95], v[76:79]
  s_waitcnt lgkmcnt(0)
  s_nop 0
  v_mfma_f32_16x16x32_bf16 v[16:19], a[0:3], a[16:19], v[16:19]
  ds_read_b128 a[64:67], v13 offset:8192
  v_mfma_f32_16x16x32_bf16 v[48:51], a[4:7], a[16:19], v[48:51]
  ds_read_b128 a[48:51], v12 offset:0
  v_mfma_f32_16x16x32_bf16 v[20:23], a[0:3], a[20:23], v[20:23]
  ds_read_b128 a[52:55], v12 offset:2048
  v_mfma_f32_16x16x32_bf16 v[52:55], a[4:7], a[20:23], v[52:55]
  ds_read_b128 a[68:71], v13 offset:8448
  v_mfma_f32_16x16x32_bf16 v[24:27], a[0:3], a[24:27], v[24:27]
  ds_read_b128 a[72:75], v13 offset:8704
  v_mfma_f32_16x16x32_bf16 v[56:59], a[4:7], a[24:27], v[56:59]
  ds_read_b128 a[76:79], v13 offset:8960
  v_mfma_f32_16x16x32_bf16 v[28:31], a[0:3], a[28:31], v[28:31]
  ds_read_b128 a[80:83], v13 offset:9216
  v_mfma_f32_16x16x32_bf16 v[60:63], a[4:7], a[28:31], v[60:63]
  ds_read_b128 a[84:87], v13 offset:9472
  v_mfma_f32_16x16x32_bf16 v[32:35], a[0:3], a[32:35], v[32:35]
  ds_read_b128 a[88:91], v13 offset:9728
  v_mfma_f32_16x16x32_bf16 v[64:67], a[4:7], a[32:35], v[64:67]
  ds_read_b128 a[92:95], v13 offset:9984
  v_mfma_f32_16x16x32_bf16 v[36:39], a[0:3], a[36:39], v[36:39]
  v_mfma_f32_16x16x32_bf16 v[68:71], a[4:7], a[36:39], v[68:71]
  v_mfma_f32_16x16x32_bf16 v[40:43], a[0:3], a[40:43], v[40:43]
  v_mfma_f32_16x16x32_bf16 v[72:75], a[4:7], a[40:43], v[72:75]
  v_mfma_f32_16x16x32_bf16 v[44:47], a[0:3], a[44:47], v[44:47]
  v_mfma_f32_16x16x32_bf16 v[76:79], a[4:7], a[44:47], v[76:79]
  s_waitcnt lgkmcnt(0)
  s_barrier
  v_mfma_f32_16x16x32_bf16 v[16:19], a[48:51], a[64:67], v[16:19]
  ds_read_b128 a[16:19], v146 offset:0
  v_mfma_f32_16x16x32_bf16 v[48:51], a[52:55], a[64:67], v[48:51]
  ds_read_b128 a[0:3], v144 offset:0
  v_mfma_f32_16x16x32_bf16 v[20:23], a[48:51], a[68:71], v[20:23]
  ds_read_b128 a[4:7], v144 offset:2048
  v_mfma_f32_16x16x32_bf16 v[52:55], a[52:55], a[68:71], v[52:55]
  ds_read_b128 a[20:23], v146 offset:256
  v_mfma_f32_16x16x32_bf16 v[24:27], a[48:51], a[72:75], v[24:27]
  ds_read_b128 a[24:27], v146 offset:512
  v_mfma_f32_16x16x32_bf16 v[56:59], a[52:55], a[72:75], v[56:59]
  ds_read_b128 a[28:31], v146 offset:768
  v_mfma_f32_16x16x32_bf16 v[28:31], a[48:51], a[76:79], v[28:31]
  ds_read_b128 a[32:35], v146 offset:1024
  v_mfma_f32_16x16x32_bf16 v[60:63], a[52:55], a[76:79], v[60:63]
  ds_read_b128 a[36:39], v146 offset:1280
  v_mfma_f32_16x16x32_bf16 v[32:35], a[48:51], a[80:83], v[32:35]
  ds_read_b128 a[40:43], v146 offset:1536
  v_mfma_f32_16x16x32_bf16 v[64:67], a[52:55], a[80:83], v[64:67]
  ds_read_b128 a[44:47], v146 offset:1792
  v_mfma_f32_16x16x32_bf16 v[36:39], a[48:51], a[84:87], v[36:39]
  v_mfma_f32_16x16x32_bf16 v[68:71], a[52:55], a[84:87], v[68:71]
  v_mfma_f32_16x16x32_bf16 v[40:43], a[48:51], a[88:91], v[40:43]
  v_mfma_f32_16x16x32_bf16 v[72:75], a[52:55], a[88:91], v[72:75]
  v_mfma_f32_16x16x32_bf16 v[44:47], a[48:51], a[92:95], v[44:47]
  v_mfma_f32_16x16x32_bf16 v[76:79], a[52:55], a[92:95], v[76:79]
  s_waitcnt lgkmcnt(0)
  s_nop 0
  v_mfma_f32_16x16x32_bf16 v[16:19], a[0:3], a[16:19], v[16:19]
  ds_read_b128 a[64:67], v146 offset:8192
  v_mfma_f32_16x16x32_bf16 v[48:51], a[4:7], a[16:19], v[48:51]
  ds_read_b128 a[48:51], v145 offset:0
  v_mfma_f32_16x16x32_bf16 v[20:23], a[0:3], a[20:23], v[20:23]
  ds_read_b128 a[52:55], v145 offset:2048
  v_mfma_f32_16x16x32_bf16 v[52:55], a[4:7], a[20:23], v[52:55]
  ds_read_b128 a[68:71], v146 offset:8448
  v_mfma_f32_16x16x32_bf16 v[24:27], a[0:3], a[24:27], v[24:27]
  ds_read_b128 a[72:75], v146 offset:8704
  v_mfma_f32_16x16x32_bf16 v[56:59], a[4:7], a[24:27], v[56:59]
  ds_read_b128 a[76:79], v146 offset:8960
  v_mfma_f32_16x16x32_bf16 v[28:31], a[0:3], a[28:31], v[28:31]
  ds_read_b128 a[80:83], v146 offset:9216
  v_mfma_f32_16x16x32_bf16 v[60:63], a[4:7], a[28:31], v[60:63]
  ds_read_b128 a[84:87], v146 offset:9472
  v_mfma_f32_16x16x32_bf16 v[32:35], a[0:3], a[32:35], v[32:35]
  ds_read_b128 a[88:91], v146 offset:9728
  v_mfma_f32_16x16x32_bf16 v[64:67], a[4:7], a[32:35], v[64:67]
  ds_read_b128 a[92:95], v146 offset:9984
  v_mfma_f32_16x16x32_bf16 v[36:39], a[0:3], a[36:39], v[36:39]
  v_mfma_f32_16x16x32_bf16 v[68:71], a[4:7], a[36:39], v[68:71]
  v_mfma_f32_16x16x32_bf16 v[40:43], a[0:3], a[40:43], v[40:43]
  v_mfma_f32_16x16x32_bf16 v[72:75], a[4:7], a[40:43], v[72:75]
  v_mfma_f32_16x16x32_bf16 v[44:47], a[0:3], a[44:47], v[44:47]
  v_mfma_f32_16x16x32_bf16 v[76:79], a[4:7], a[44:47], v[76:79]
  s_waitcnt lgkmcnt(0)
  s_nop 0
  v_mfma_f32_16x16x32_bf16 v[16:19], a[48:51], a[64:67], v[16:19]
  ds_read_b128 a[16:19], v10 offset:0
  v_mfma_f32_16x16x32_bf16 v[20:23], a[48:51], a[68:71], v[20:23]
  ds_read_b128 a[8:11], v8 offset:4096
  v_mfma_f32_16x16x32_bf16 v[24:27], a[48:51], a[72:75], v[24:27]
  ds_read_b128 a[12:15], v8 offset:6144
  v_mfma_f32_16x16x32_bf16 v[28:31], a[48:51], a[76:79], v[28:31]
  ds_read_b128 a[20:23], v10 offset:256
  v_mfma_f32_16x16x32_bf16 v[32:35], a[48:51], a[80:83], v[32:35]
  ds_read_b128 a[24:27], v10 offset:512
  v_mfma_f32_16x16x32_bf16 v[36:39], a[48:51], a[84:87], v[36:39]
  ds_read_b128 a[28:31], v10 offset:768
  v_mfma_f32_16x16x32_bf16 v[40:43], a[48:51], a[88:91], v[40:43]
  ds_read_b128 a[32:35], v10 offset:1024
  v_mfma_f32_16x16x32_bf16 v[44:47], a[48:51], a[92:95], v[44:47]
  ds_read_b128 a[36:39], v10 offset:1280
  v_mfma_f32_16x16x32_bf16 v[48:51], a[52:55], a[64:67], v[48:51]
  ds_read_b128 a[40:43], v10 offset:1536
  v_mfma_f32_16x16x32_bf16 v[52:55], a[52:55], a[68:71], v[52:55]
  ds_read_b128 a[44:47], v10 offset:1792
  v_mfma_f32_16x16x32_bf16 v[56:59], a[52:55], a[72:75], v[56:59]
  v_mfma_f32_16x16x32_bf16 v[60:63], a[52:55], a[76:79], v[60:63]
  v_mfma_f32_16x16x32_bf16 v[64:67], a[52:55], a[80:83], v[64:67]
  v_mfma_f32_16x16x32_bf16 v[68:71], a[52:55], a[84:87], v[68:71]
  v_mfma_f32_16x16x32_bf16 v[72:75], a[52:55], a[88:91], v[72:75]
  v_mfma_f32_16x16x32_bf16 v[76:79], a[52:55], a[92:95], v[76:79]
  s_waitcnt lgkmcnt(0)
  s_nop 0
  v_mfma_f32_16x16x32_bf16 v[80:83], a[8:11], a[16:19], v[80:83]
  ds_read_b128 a[64:67], v10 offset:8192
  v_mfma_f32_16x16x32_bf16 v[112:115], a[12:15], a[16:19], v[112:115]
  ds_read_b128 a[56:59], v9 offset:4096
  v_mfma_f32_16x16x32_bf16 v[84:87], a[8:11], a[20:23], v[84:87]
  ds_read_b128 a[60:63], v9 offset:6144
  v_cvt_pk_bf16_f32 v148, v16, v20
  v_mfma_f32_16x16x32_bf16 v[116:119], a[12:15], a[20:23], v[116:119]
  ds_read_b128 a[68:71], v10 offset:8448
  v_cvt_pk_bf16_f32 v149, v24, v28
  v_mfma_f32_16x16x32_bf16 v[88:91], a[8:11], a[24:27], v[88:91]
  ds_read_b128 a[72:75], v10 offset:8704
  v_cvt_pk_bf16_f32 v150, v32, v36
  v_mfma_f32_16x16x32_bf16 v[120:123], a[12:15], a[24:27], v[120:123]
  ds_read_b128 a[76:79], v10 offset:8960
  v_cvt_pk_bf16_f32 v151, v40, v44
  v_mfma_f32_16x16x32_bf16 v[92:95], a[8:11], a[28:31], v[92:95]
  ds_read_b128 a[80:83], v10 offset:9216
  v_mfma_f32_16x16x32_bf16 v[124:127], a[12:15], a[28:31], v[124:127]
  ds_read_b128 a[84:87], v10 offset:9472
  buffer_store_dwordx4 v[148:151], v147, s[32:35], s44 offen sc0 sc1
  v_mfma_f32_16x16x32_bf16 v[96:99], a[8:11], a[32:35], v[96:99]
  ds_read_b128 a[88:91], v10 offset:9728
  v_cvt_pk_bf16_f32 v152, v17, v21
  v_mfma_f32_16x16x32_bf16 v[128:131], a[12:15], a[32:35], v[128:131]
  ds_read_b128 a[92:95], v10 offset:9984
  v_cvt_pk_bf16_f32 v153, v25, v29
  v_mfma_f32_16x16x32_bf16 v[100:103], a[8:11], a[36:39], v[100:103]
  v_mfma_f32_16x16x32_bf16 v[132:135], a[12:15], a[36:39], v[132:135]
  v_cvt_pk_bf16_f32 v154, v33, v37
  v_mfma_f32_16x16x32_bf16 v[104:107], a[8:11], a[40:43], v[104:107]
  v_cvt_pk_bf16_f32 v155, v41, v45
  v_mfma_f32_16x16x32_bf16 v[136:139], a[12:15], a[40:43], v[136:139]
  buffer_store_dwordx4 v[152:155], v147, s[32:35], s45 offen sc0 sc1
  v_mfma_f32_16x16x32_bf16 v[108:111], a[8:11], a[44:47], v[108:111]
  v_mfma_f32_16x16x32_bf16 v[140:143], a[12:15], a[44:47], v[140:143]
  s_waitcnt lgkmcnt(0)
  s_nop 0
  v_mfma_f32_16x16x32_bf16 v[80:83], a[56:59], a[64:67], v[80:83]
  ds_read_b128 a[16:19], v13 offset:0
  v_mfma_f32_16x16x32_bf16 v[112:115], a[60:63], a[64:67], v[112:115]
  ds_read_b128 a[8:11], v11 offset:4096
  v_cvt_pk_bf16_f32 v156, v18, v22
  v_mfma_f32_16x16x32_bf16 v[84:87], a[56:59], a[68:71], v[84:87]
  ds_read_b128 a[12:15], v11 offset:6144
  v_cvt_pk_bf16_f32 v157, v26, v30
  v_mfma_f32_16x16x32_bf16 v[116:119], a[60:63], a[68:71], v[116:119]
  ds_read_b128 a[20:23], v13 offset:256
  v_mfma_f32_16x16x32_bf16 v[88:91], a[56:59], a[72:75], v[88:91]
  ds_read_b128 a[24:27], v13 offset:512
  v_cvt_pk_bf16_f32 v158, v34, v38
  v_mfma_f32_16x16x32_bf16 v[120:123], a[60:63], a[72:75], v[120:123]
  ds_read_b128 a[28:31], v13 offset:768
  v_cvt_pk_bf16_f32 v159, v42, v46
  v_mfma_f32_16x16x32_bf16 v[92:95], a[56:59], a[76:79], v[92:95]
  ds_read_b128 a[32:35], v13 offset:1024
  v_mfma_f32_16x16x32_bf16 v[124:127], a[60:63], a[76:79], v[124:127]
  ds_read_b128 a[36:39], v13 offset:1280
  buffer_store_dwordx4 v[156:159], v147, s[32:35], s46 offen sc0 sc1
  v_mfma_f32_16x16x32_bf16 v[96:99], a[56:59], a[80:83], v[96:99]
  ds_read_b128 a[40:43], v13 offset:1536
  v_cvt_pk_bf16_f32 v148, v19, v23
  v_mfma_f32_16x16x32_bf16 v[128:131], a[60:63], a[80:83], v[128:131]
  ds_read_b128 a[44:47], v13 offset:1792
  v_mfma_f32_16x16x32_bf16 v[100:103], a[56:59], a[84:87], v[100:103]
  v_cvt_pk_bf16_f32 v149, v27, v31
  v_mfma_f32_16x16x32_bf16 v[132:135], a[60:63], a[84:87], v[132:135]
  v_cvt_pk_bf16_f32 v150, v35, v39
  v_mfma_f32_16x16x32_bf16 v[104:107], a[56:59], a[88:91], v[104:107]
  v_mfma_f32_16x16x32_bf16 v[136:139], a[60:63], a[88:91], v[136:139]
  v_cvt_pk_bf16_f32 v151, v43, v47
  v_mfma_f32_16x16x32_bf16 v[108:111], a[56:59], a[92:95], v[108:111]
  buffer_store_dwordx4 v[148:151], v147, s[32:35], s47 offen sc0 sc1
  v_mfma_f32_16x16x32_bf16 v[140:143], a[60:63], a[92:95], v[140:143]
  s_waitcnt lgkmcnt(0)
  s_nop 0
  v_mfma_f32_16x16x32_bf16 v[80:83], a[8:11], a[16:19], v[80:83]
  ds_read_b128 a[64:67], v13 offset:8192
  v_mfma_f32_16x16x32_bf16 v[112:115], a[12:15], a[16:19], v[112:115]
  ds_read_b128 a[56:59], v12 offset:4096
  v_cvt_pk_bf16_f32 v152, v48, v52
  v_mfma_f32_16x16x32_bf16 v[84:87], a[8:11], a[20:23], v[84:87]
  ds_read_b128 a[60:63], v12 offset:6144
  v_cvt_pk_bf16_f32 v153, v56, v60
  v_mfma_f32_16x16x32_bf16 v[116:119], a[12:15], a[20:23], v[116:119]
  ds_read_b128 a[68:71], v13 offset:8448
  v_mfma_f32_16x16x32_bf16 v[88:91], a[8:11], a[24:27], v[88:91]
  ds_read_b128 a[72:75], v13 offset:8704
  v_cvt_pk_bf16_f32 v154, v64, v68
  v_mfma_f32_16x16x32_bf16 v[120:123], a[12:15], a[24:27], v[120:123]
  ds_read_b128 a[76:79], v13 offset:8960
  v_cvt_pk_bf16_f32 v155, v72, v76
  v_mfma_f32_16x16x32_bf16 v[92:95], a[8:11], a[28:31], v[92:95]
  ds_read_b128 a[80:83], v13 offset:9216
  v_mfma_f32_16x16x32_bf16 v[124:127], a[12:15], a[28:31], v[124:127]
  ds_read_b128 a[84:87], v13 offset:9472
  buffer_store_dwordx4 v[152:155], v147, s[32:35], s48 offen sc0 sc1
  v_mfma_f32_16x16x32_bf16 v[96:99], a[8:11], a[32:35], v[96:99]
  ds_read_b128 a[88:91], v13 offset:9728
  v_cvt_pk_bf16_f32 v156, v49, v53
  v_mfma_f32_16x16x32_bf16 v[128:131], a[12:15], a[32:35], v[128:131]
  ds_read_b128 a[92:95], v13 offset:9984
  v_mfma_f32_16x16x32_bf16 v[100:103], a[8:11], a[36:39], v[100:103]
  v_cvt_pk_bf16_f32 v157, v57, v61
  v_mfma_f32_16x16x32_bf16 v[132:135], a[12:15], a[36:39], v[132:135]
  v_cvt_pk_bf16_f32 v158, v65, v69
  v_mfma_f32_16x16x32_bf16 v[104:107], a[8:11], a[40:43], v[104:107]
  v_mfma_f32_16x16x32_bf16 v[136:139], a[12:15], a[40:43], v[136:139]
  v_cvt_pk_bf16_f32 v159, v73, v77
  v_mfma_f32_16x16x32_bf16 v[108:111], a[8:11], a[44:47], v[108:111]
  buffer_store_dwordx4 v[156:159], v147, s[32:35], s49 offen sc0 sc1
  v_mfma_f32_16x16x32_bf16 v[140:143], a[12:15], a[44:47], v[140:143]
  s_waitcnt lgkmcnt(0)
  s_nop 0
  v_mfma_f32_16x16x32_bf16 v[80:83], a[56:59], a[64:67], v[80:83]
  ds_read_b128 a[16:19], v146 offset:0
  v_mfma_f32_16x16x32_bf16 v[112:115], a[60:63], a[64:67], v[112:115]
  ds_read_b128 a[8:11], v144 offset:4096
  v_cvt_pk_bf16_f32 v148, v50, v54
  v_mfma_f32_16x16x32_bf16 v[84:87], a[56:59], a[68:71], v[84:87]
  ds_read_b128 a[12:15], v144 offset:6144
  v_cvt_pk_bf16_f32 v149, v58, v62
  v_mfma_f32_16x16x32_bf16 v[116:119], a[60:63], a[68:71], v[116:119]
  ds_read_b128 a[20:23], v146 offset:256
  v_mfma_f32_16x16x32_bf16 v[88:91], a[56:59], a[72:75], v[88:91]
  ds_read_b128 a[24:27], v146 offset:512
  v_cvt_pk_bf16_f32 v150, v66, v70
  v_mfma_f32_16x16x32_bf16 v[120:123], a[60:63], a[72:75], v[120:123]
  ds_read_b128 a[28:31], v146 offset:768
  v_cvt_pk_bf16_f32 v151, v74, v78
  v_mfma_f32_16x16x32_bf16 v[92:95], a[56:59], a[76:79], v[92:95]
  ds_read_b128 a[32:35], v146 offset:1024
  v_mfma_f32_16x16x32_bf16 v[124:127], a[60:63], a[76:79], v[124:127]
  ds_read_b128 a[36:39], v146 offset:1280
  buffer_store_dwordx4 v[148:151], v147, s[32:35], s50 offen sc0 sc1
  v_mfma_f32_16x16x32_bf16 v[96:99], a[56:59], a[80:83], v[96:99]
  ds_read_b128 a[40:43], v146 offset:1536
  v_cvt_pk_bf16_f32 v152, v51, v55
  v_mfma_f32_16x16x32_bf16 v[128:131], a[60:63], a[80:83], v[128:131]
  ds_read_b128 a[44:47], v146 offset:1792
  v_mfma_f32_16x16x32_bf16 v[100:103], a[56:59], a[84:87], v[100:103]
  v_cvt_pk_bf16_f32 v153, v59, v63
  v_mfma_f32_16x16x32_bf16 v[132:135], a[60:63], a[84:87], v[132:135]
  v_cvt_pk_bf16_f32 v154, v67, v71
  v_mfma_f32_16x16x32_bf16 v[104:107], a[56:59], a[88:91], v[104:107]
  v_mfma_f32_16x16x32_bf16 v[136:139], a[60:63], a[88:91], v[136:139]
  v_cvt_pk_bf16_f32 v155, v75, v79
  v_mfma_f32_16x16x32_bf16 v[108:111], a[56:59], a[92:95], v[108:111]
  buffer_store_dwordx4 v[152:155], v147, s[32:35], s51 offen sc0 sc1
  v_mfma_f32_16x16x32_bf16 v[140:143], a[60:63], a[92:95], v[140:143]
  s_waitcnt lgkmcnt(0)
  s_nop 0
  v_mfma_f32_16x16x32_bf16 v[80:83], a[8:11], a[16:19], v[80:83]
  ds_read_b128 a[64:67], v146 offset:8192
  v_mfma_f32_16x16x32_bf16 v[112:115], a[12:15], a[16:19], v[112:115]
  ds_read_b128 a[56:59], v145 offset:4096
  v_mfma_f32_16x16x32_bf16 v[84:87], a[8:11], a[20:23], v[84:87]
  ds_read_b128 a[60:63], v145 offset:6144
  v_mfma_f32_16x16x32_bf16 v[116:119], a[12:15], a[20:23], v[116:119]
  ds_read_b128 a[68:71], v146 offset:8448
  v_mfma_f32_16x16x32_bf16 v[88:91], a[8:11], a[24:27], v[88:91]
  ds_read_b128 a[72:75], v146 offset:8704
  v_mfma_f32_16x16x32_bf16 v[120:123], a[12:15], a[24:27], v[120:123]
  ds_read_b128 a[76:79], v146 offset:8960
  v_mfma_f32_16x16x32_bf16 v[92:95], a[8:11], a[28:31], v[92:95]
  ds_read_b128 a[80:83], v146 offset:9216
  v_mfma_f32_16x16x32_bf16 v[124:127], a[12:15], a[28:31], v[124:127]
  ds_read_b128 a[84:87], v146 offset:9472
  v_mfma_f32_16x16x32_bf16 v[96:99], a[8:11], a[32:35], v[96:99]
  ds_read_b128 a[88:91], v146 offset:9728
  v_mfma_f32_16x16x32_bf16 v[128:131], a[12:15], a[32:35], v[128:131]
  ds_read_b128 a[92:95], v146 offset:9984
  v_mfma_f32_16x16x32_bf16 v[100:103], a[8:11], a[36:39], v[100:103]
  v_mfma_f32_16x16x32_bf16 v[132:135], a[12:15], a[36:39], v[132:135]
  v_mfma_f32_16x16x32_bf16 v[104:107], a[8:11], a[40:43], v[104:107]
  v_mfma_f32_16x16x32_bf16 v[136:139], a[12:15], a[40:43], v[136:139]
  v_mfma_f32_16x16x32_bf16 v[108:111], a[8:11], a[44:47], v[108:111]
  v_mfma_f32_16x16x32_bf16 v[140:143], a[12:15], a[44:47], v[140:143]
  s_waitcnt lgkmcnt(0)
  s_nop 0
  v_mfma_f32_16x16x32_bf16 v[80:83], a[56:59], a[64:67], v[80:83]
  v_mfma_f32_16x16x32_bf16 v[84:87], a[56:59], a[68:71], v[84:87]
  v_mfma_f32_16x16x32_bf16 v[88:91], a[56:59], a[72:75], v[88:91]
  v_mfma_f32_16x16x32_bf16 v[92:95], a[56:59], a[76:79], v[92:95]
  v_mfma_f32_16x16x32_bf16 v[96:99], a[56:59], a[80:83], v[96:99]
  v_mfma_f32_16x16x32_bf16 v[100:103], a[56:59], a[84:87], v[100:103]
  v_mfma_f32_16x16x32_bf16 v[104:107], a[56:59], a[88:91], v[104:107]
  v_mfma_f32_16x16x32_bf16 v[108:111], a[56:59], a[92:95], v[108:111]
  v_mfma_f32_16x16x32_bf16 v[112:115], a[60:63], a[64:67], v[112:115]
  v_mfma_f32_16x16x32_bf16 v[116:119], a[60:63], a[68:71], v[116:119]
  v_mfma_f32_16x16x32_bf16 v[120:123], a[60:63], a[72:75], v[120:123]
  v_mfma_f32_16x16x32_bf16 v[124:127], a[60:63], a[76:79], v[124:127]
  v_mfma_f32_16x16x32_bf16 v[128:131], a[60:63], a[80:83], v[128:131]
  v_mfma_f32_16x16x32_bf16 v[132:135], a[60:63], a[84:87], v[132:135]
  v_mfma_f32_16x16x32_bf16 v[136:139], a[60:63], a[88:91], v[136:139]
  v_mfma_f32_16x16x32_bf16 v[140:143], a[60:63], a[92:95], v[140:143]
  v_cvt_pk_bf16_f32 v156, v80, v84
  v_cvt_pk_bf16_f32 v157, v88, v92
  v_cvt_pk_bf16_f32 v158, v96, v100
  v_cvt_pk_bf16_f32 v159, v104, v108
  buffer_store_dwordx4 v[156:159], v147, s[32:35], s52 offen sc0 sc1
  v_cvt_pk_bf16_f32 v148, v81, v85
  v_cvt_pk_bf16_f32 v149, v89, v93
  v_cvt_pk_bf16_f32 v150, v97, v101
  v_cvt_pk_bf16_f32 v151, v105, v109
  buffer_store_dwordx4 v[148:151], v147, s[32:35], s53 offen sc0 sc1
  v_cvt_pk_bf16_f32 v152, v82, v86
  v_cvt_pk_bf16_f32 v153, v90, v94
  v_cvt_pk_bf16_f32 v154, v98, v102
  v_cvt_pk_bf16_f32 v155, v106, v110
  buffer_store_dwordx4 v[152:155], v147, s[32:35], s54 offen sc0 sc1
  v_cvt_pk_bf16_f32 v156, v83, v87
  v_cvt_pk_bf16_f32 v157, v91, v95
  v_cvt_pk_bf16_f32 v158, v99, v103
  v_cvt_pk_bf16_f32 v159, v107, v111
  buffer_store_dwordx4 v[156:159], v147, s[32:35], s55 offen sc0 sc1
  v_cvt_pk_bf16_f32 v148, v112, v116
  v_cvt_pk_bf16_f32 v149, v120, v124
  v_cvt_pk_bf16_f32 v150, v128, v132
  v_cvt_pk_bf16_f32 v151, v136, v140
  buffer_store_dwordx4 v[148:151], v147, s[32:35], s56 offen sc0 sc1
  v_cvt_pk_bf16_f32 v152, v113, v117
  v_cvt_pk_bf16_f32 v153, v121, v125
  v_cvt_pk_bf16_f32 v154, v129, v133
  v_cvt_pk_bf16_f32 v155, v137, v141
  buffer_store_dwordx4 v[152:155], v147, s[32:35], s57 offen sc0 sc1
  v_cvt_pk_bf16_f32 v156, v114, v118
  v_cvt_pk_bf16_f32 v157, v122, v126
  v_cvt_pk_bf16_f32 v158, v130, v134
  v_cvt_pk_bf16_f32 v159, v138, v142
  buffer_store_dwordx4 v[156:159], v147, s[32:35], s58 offen sc0 sc1
  v_cvt_pk_bf16_f32 v148, v115, v119
  v_cvt_pk_bf16_f32 v149, v123, v127
  v_cvt_pk_bf16_f32 v150, v131, v135
  v_cvt_pk_bf16_f32 v151, v139, v143
  buffer_store_dwordx4 v[148:151], v147, s[32:35], s59 offen sc0 sc1
  s_endpgm
L_loader:
  s_mul_i32 s53, s39, 28672
  s_lshl_b32 s54, s37, 8
  s_add_u32 s53, s53, s54
  v_add_u32 v21, s53, v16
  s_lshl_b32 s54, s39, 10
  s_add_u32 m0, s54, 147456
  v_lshrrev_b32 v20, 3, v2
  v_lshlrev_b32 v20, 11, v20
  v_lshrrev_b32 v1, 4, v2
  v_xor_b32 v1, v1, v2
  v_and_b32 v1, 7, v1
  v_lshl_add_u32 v20, v1, 4, v20
  s_lshl_b32 s52, s36, 19
  s_lshl_b32 s53, s39, 17
  s_add_u32 s53, s52, s53
  v_add_u32 v16, s53, v20
  v_xor_b32 v17, 64, v16
  v_add_u32 v18, 30720, v16
  v_add_u32 v19, 46080, v17
  v_add_u32 v17, 15360, v17
  s_lshl_b32 s60, s39, 13
  s_mov_b32 s45, 6912
  s_mov_b32 s46, 13824
  s_mov_b32 s47, 20736
  s_waitcnt lgkmcnt(0)
  buffer_load_dword v21, s[24:27], 0 offen offset:0 lds
  buffer_load_dword v21, s[24:27], s45 offen offset:256 lds
  buffer_load_dword v21, s[24:27], s46 offen offset:512 lds
  buffer_load_dword v21, s[24:27], s47 offen offset:768 lds
  s_add_u32 s10, s28, 9437184
  s_addc_u32 s11, s29, 0
  s_load_dwordx2 s[6:7], s[10:11], 0
  s_lshl_b32 s53, s37, 18
  s_lshl_b32 s54, s39, 12
  s_add_u32 s53, s53, s54
  v_lshl_add_u32 v20, v2, 4, s53
  s_add_u32 s61, s54, 32768
  s_lshl_b32 s53, s37, 2
  s_add_u32 s53, s53, s39
  s_mul_i32 s53, s53, 3
  s_min_u32 s53, s53, 253
  s_lshl_b32 s53, s53, 11
  s_add_u32 s53, s53, s52
  s_add_u32 s12, s16, s53
  s_addc_u32 s13, s17, 0
  s_lshl_b32 s53, s37, 14
  s_lshl_b32 s54, s39, 8
  s_add_u32 s53, s53, s54
  s_and_b32 s54, s36, 1
  s_lshl_b32 s54, s54, 7
  s_add_u32 s53, s53, s54
  s_add_u32 s53, s53, 7340032
  s_add_u32 s4, s28, s53
  s_addc_u32 s5, s29, 0
  s_waitcnt lgkmcnt(0)
  s_mul_i32 s8, s6, 1664525
  s_mul_i32 s9, s7, 22695477
  s_add_u32 s8, s8, 1013904223
  s_add_u32 s9, s9, 1
  v_mov_b32 v10, s8
  v_mov_b32 v11, s9
  s_load_dword s68, s[12:13], 128
  s_load_dword s69, s[12:13], 192
  s_load_dword s70, s[12:13], 2176
  s_load_dword s71, s[12:13], 2240
  s_load_dword s72, s[12:13], 4224
  s_load_dword s73, s[12:13], 4288
  s_load_dword s68, s[12:13], 256
  s_load_dword s69, s[12:13], 320
  s_load_dword s70, s[12:13], 2304
  s_load_dword s71, s[12:13], 2368
  s_load_dword s72, s[12:13], 4352
  s_load_dword s73, s[12:13], 4416
  s_lshr_b32 s53, s36, 1
  s_mul_i32 s53, s53, 24
  s_and_b32 s54, s36, 1
  s_lshl_b32 s54, s54, 2
  s_add_u32 s53, s53, s54
  s_add_u32 s53, s53, s39
  s_add_u32 s52, s53, 48
  s_mul_i32 s53, s52, 114688
  s_lshl_b32 s54, s37, 9
  s_add_u32 s53, s53, s54
  v_add_u32 v4, s53, v4
  v_add_u32 v5, 147456, v5
  s_lshl_b32 s53, s39, 11
  s_add_u32 s53, s53, 151552
  v_and_b32 v1, 1, v3
  v_lshlrev_b32 v1, 10, v1
  v_lshl_add_u32 v1, v9, 3, v1
  v_lshrrev_b32 v6, 1, v3
  v_lshl_add_u32 v6, v6, 4, v1
  v_add_u32 v6, s53, v6
  v_lshl_add_u32 v7, v2, 4, s53
  s_lshl_b32 s53, s37, 18
  s_lshl_b32 s54, s52, 11
  s_add_u32 s53, s53, s54
  v_lshl_add_u32 v8, v2, 4, s53
  s_lshl_b32 s53, s37, 6
  s_lshr_b32 s54, s52, 1
  s_add_u32 s53, s53, s54
  s_lshl_b32 s53, s53, 8
  s_and_b32 s54, s52, 1
  s_lshl_b32 s54, s54, 3
  s_add_u32 s53, s53, s54
  s_add_u32 s53, s53, 7340032
  v_lshl_add_u32 v14, v2, 7, s53
  s_mov_b32 s45, 14336
  s_mov_b32 s46, 28672
  s_mov_b32 s47, 43008
  s_waitcnt vmcnt(0)
  s_barrier
  s_add_u32 m0, s60, 0
  s_mov_b32 s62, 0
  buffer_load_dwordx4 v16, s[16:19], s62 offen offset:0 lds
  buffer_load_dwordx4 v17, s[16:19], s62 offen offset:1024 lds
  buffer_load_dwordx4 v18, s[16:19], s62 offen offset:2048 lds
  buffer_load_dwordx4 v19, s[16:19], s62 offen offset:3072 lds
  s_add_u32 m0, s60, 4096
  s_mov_b32 s62, 65536
  buffer_load_dwordx4 v16, s[16:19], s62 offen offset:0 lds
  buffer_load_dwordx4 v17, s[16:19], s62 offen offset:1024 lds
  buffer_load_dwordx4 v18, s[16:19], s62 offen offset:2048 lds
  buffer_load_dwordx4 v19, s[16:19], s62 offen offset:3072 lds
  s_load_dword s68, s[12:13], 384
  s_load_dword s69, s[12:13], 448
  s_load_dword s70, s[12:13], 2432
  s_load_dword s71, s[12:13], 2496
  s_load_dword s72, s[12:13], 4480
  s_load_dword s73, s[12:13], 4544
  s_load_dword s68, s[12:13], 512
  s_load_dword s69, s[12:13], 576
  s_load_dword s70, s[12:13], 2560
  s_load_dword s71, s[12:13], 2624
  s_load_dword s72, s[12:13], 4608
  s_load_dword s73, s[12:13], 4672
  s_waitcnt lgkmcnt(0)
  s_add_u32 m0, s60, 49152
  s_mov_b32 s62, 128
  buffer_load_dwordx4 v16, s[16:19], s62 offen offset:0 lds
  buffer_load_dwordx4 v17, s[16:19], s62 offen offset:1024 lds
  buffer_load_dwordx4 v18, s[16:19], s62 offen offset:2048 lds
  buffer_load_dwordx4 v19, s[16:19], s62 offen offset:3072 lds
  s_add_u32 m0, s60, 53248
  s_mov_b32 s62, 65664
  buffer_load_dwordx4 v16, s[16:19], s62 offen offset:0 lds
  buffer_load_dwordx4 v17, s[16:19], s62 offen offset:1024 lds
  buffer_load_dwordx4 v18, s[16:19], s62 offen offset:2048 lds
  buffer_load_dwordx4 v19, s[16:19], s62 offen offset:3072 lds
  s_load_dwordx4 s[64:67], s[4:5], 0 glc
  s_mov_b32 s63, 0
L_sp0:
  s_waitcnt lgkmcnt(0)
  s_xor_b64 s[10:11], s[64:65], s[8:9]
  s_xor_b64 s[14:15], s[66:67], s[8:9]
  s_or_b64 s[10:11], s[10:11], s[14:15]
  s_cbranch_scc0 L_ok0
  s_load_dwordx4 s[64:67], s[4:5], 0 glc
  s_add_u32 s63, s63, 1
  s_cmp_lt_u32 s63, 20000
  s_cbranch_scc1 L_sp0
  s_waitcnt lgkmcnt(0)
L_ok0:
  s_add_u32 m0, s61, 0
  s_mov_b32 s62, 0
  buffer_load_dwordx4 v20, s[28:31], s62 offen offset:0 sc1 lds
  buffer_load_dwordx4 v20, s[28:31], s62 offen offset:1024 sc1 lds
  buffer_load_dwordx4 v20, s[28:31], s62 offen offset:2048 sc1 lds
  buffer_load_dwordx4 v20, s[28:31], s62 offen offset:3072 sc1 lds
  s_load_dwordx4 s[64:67], s[4:5], 1024 glc
  s_mov_b32 s63, 0
L_sp1:
  s_waitcnt lgkmcnt(0)
  s_xor_b64 s[10:11], s[64:65], s[8:9]
  s_xor_b64 s[14:15], s[66:67], s[8:9]
  s_or_b64 s[10:11], s[10:11], s[14:15]
  s_cbranch_scc0 L_ok1
  s_load_dwordx4 s[64:67], s[4:5], 1024 glc
  s_add_u32 s63, s63, 1
  s_cmp_lt_u32 s63, 20000
  s_cbranch_scc1 L_sp1
  s_waitcnt lgkmcnt(0)
L_ok1:
  s_add_u32 m0, s61, 49152
  s_mov_b32 s62, 16384
  buffer_load_dwordx4 v20, s[28:31], s62 offen offset:0 sc1 lds
  buffer_load_dwordx4 v20, s[28:31], s62 offen offset:1024 sc1 lds
  buffer_load_dwordx4 v20, s[28:31], s62 offen offset:2048 sc1 lds
  buffer_load_dwordx4 v20, s[28:31], s62 offen offset:3072 sc1 lds
  s_load_dwordx4 s[64:67], s[4:5], 2048 glc
  s_waitcnt vmcnt(4)
  s_barrier
  s_add_u32 m0, s60, 98304
  s_mov_b32 s62, 256
  buffer_load_dwordx4 v16, s[16:19], s62 offen offset:0 lds
  buffer_load_dwordx4 v17, s[16:19], s62 offen offset:1024 lds
  buffer_load_dwordx4 v18, s[16:19], s62 offen offset:2048 lds
  buffer_load_dwordx4 v19, s[16:19], s62 offen offset:3072 lds
  s_add_u32 m0, s60, 102400
  s_mov_b32 s62, 65792
  buffer_load_dwordx4 v16, s[16:19], s62 offen offset:0 lds
  buffer_load_dwordx4 v17, s[16:19], s62 offen offset:1024 lds
  buffer_load_dwordx4 v18, s[16:19], s62 offen offset:2048 lds
  buffer_load_dwordx4 v19, s[16:19], s62 offen offset:3072 lds
  s_mov_b32 s63, 0
L_sp2:
  s_waitcnt lgkmcnt(0)
  s_xor_b64 s[10:11], s[64:65], s[8:9]
  s_xor_b64 s[14:15], s[66:67], s[8:9]
  s_or_b64 s[10:11], s[10:11], s[14:15]
  s_cbranch_scc0 L_ok2
  s_load_dwordx4 s[64:67], s[4:5], 2048 glc
  s_add_u32 s63, s63, 1
  s_cmp_lt_u32 s63, 20000
  s_cbranch_scc1 L_sp2
  s_waitcnt lgkmcnt(0)
L_ok2:
  s_load_dwordx4 s[64:67], s[4:5], 3072 glc
  s_add_u32 m0, s61, 98304
  s_mov_b32 s62, 32768
  buffer_load_dwordx4 v20, s[28:31], s62 offen offset:0 sc1 lds
  buffer_load_dwordx4 v20, s[28:31], s62 offen offset:1024 sc1 lds
  buffer_load_dwordx4 v20, s[28:31], s62 offen offset:2048 sc1 lds
  buffer_load_dwordx4 v20, s[28:31], s62 offen offset:3072 sc1 lds
  buffer_load_dwordx4 v[32:35], v4, s[20:23], 0 offen
  buffer_load_dwordx4 v[36:39], v4, s[20:23], s45 offen
  buffer_load_dwordx4 v[40:43], v4, s[20:23], s46 offen
  buffer_load_dwordx4 v[44:47], v4, s[20:23], s47 offen
  s_load_dword s68, s[12:13], 640
  s_load_dword s69, s[12:13], 704
  s_load_dword s70, s[12:13], 2688
  s_load_dword s71, s[12:13], 2752
  s_load_dword s72, s[12:13], 4736
  s_load_dword s73, s[12:13], 4800
  s_waitcnt vmcnt(12)
  s_barrier
  s_add_u32 m0, s60, 0
  s_mov_b32 s62, 384
  buffer_load_dwordx4 v16, s[16:19], s62 offen offset:0 lds
  buffer_load_dwordx4 v17, s[16:19], s62 offen offset:1024 lds
  buffer_load_dwordx4 v18, s[16:19], s62 offen offset:2048 lds
  buffer_load_dwordx4 v19, s[16:19], s62 offen offset:3072 lds
  s_add_u32 m0, s60, 4096
  s_mov_b32 s62, 65920
  buffer_load_dwordx4 v16, s[16:19], s62 offen offset:0 lds
  buffer_load_dwordx4 v17, s[16:19], s62 offen offset:1024 lds
  buffer_load_dwordx4 v18, s[16:19], s62 offen offset:2048 lds
  buffer_load_dwordx4 v19, s[16:19], s62 offen offset:3072 lds
  s_mov_b32 s63, 0
L_sp3:
  s_waitcnt lgkmcnt(0)
  s_xor_b64 s[10:11], s[64:65], s[8:9]
  s_xor_b64 s[14:15], s[66:67], s[8:9]
  s_or_b64 s[10:11], s[10:11], s[14:15]
  s_cbranch_scc0 L_ok3
  s_load_dwordx4 s[64:67], s[4:5], 3072 glc
  s_add_u32 s63, s63, 1
  s_cmp_lt_u32 s63, 20000
  s_cbranch_scc1 L_sp3
  s_waitcnt lgkmcnt(0)
L_ok3:
  s_load_dwordx4 s[64:67], s[4:5], 4096 glc
  s_add_u32 m0, s61, 0
  s_mov_b32 s62, 49152
  buffer_load_dwordx4 v20, s[28:31], s62 offen offset:0 sc1 lds
  buffer_load_dwordx4 v20, s[28:31], s62 offen offset:1024 sc1 lds
  buffer_load_dwordx4 v20, s[28:31], s62 offen offset:2048 sc1 lds
  buffer_load_dwordx4 v20, s[28:31], s62 offen offset:3072 sc1 lds
  s_waitcnt vmcnt(15)
  v_lshl_add_u32 v32, v32, 8, v5
  v_lshl_add_u32 v33, v33, 8, v5
  v_lshl_add_u32 v34, v34, 8, v5
  v_lshl_add_u32 v35, v35, 8, v5
  ds_read_u16 v96, v32 offset:0
  ds_read_u16 v97, v33 offset:2
  ds_read_u16 v98, v34 offset:128
  ds_read_u16 v99, v35 offset:130
  s_waitcnt vmcnt(14)
  v_lshl_add_u32 v36, v36, 8, v5
  v_lshl_add_u32 v37, v37, 8, v5
  v_lshl_add_u32 v38, v38, 8, v5
  v_lshl_add_u32 v39, v39, 8, v5
  ds_read_u16 v100, v36 offset:0
  ds_read_u16 v101, v37 offset:2
  ds_read_u16 v102, v38 offset:128
  ds_read_u16 v103, v39 offset:130
  s_waitcnt vmcnt(13)
  v_lshl_add_u32 v40, v40, 8, v5
  v_lshl_add_u32 v41, v41, 8, v5
  v_lshl_add_u32 v42, v42, 8, v5
  v_lshl_add_u32 v43, v43, 8, v5
  ds_read_u16 v104, v40 offset:0
  ds_read_u16 v105, v41 offset:2
  ds_read_u16 v106, v42 offset:128
  ds_read_u16 v107, v43 offset:130
  s_waitcnt vmcnt(12)
  v_lshl_add_u32 v44, v44, 8, v5
  v_lshl_add_u32 v45, v45, 8, v5
  v_lshl_add_u32 v46, v46, 8, v5
  v_lshl_add_u32 v47, v47, 8, v5
  ds_read_u16 v108, v44 offset:0
  ds_read_u16 v109, v45 offset:2
  ds_read_u16 v110, v46 offset:128
  ds_read_u16 v111, v47 offset:130
  s_waitcnt lgkmcnt(8)
  v_lshl_or_b32 v112, v100, 16, v96
  v_lshl_or_b32 v114, v101, 16, v97
  v_lshl_or_b32 v116, v102, 16, v98
  v_lshl_or_b32 v118, v103, 16, v99
  s_waitcnt lgkmcnt(3)
  v_lshl_or_b32 v113, v108, 16, v104
  ds_write_b64 v6, v[112:113] offset:0
  s_waitcnt lgkmcnt(3)
  v_lshl_or_b32 v115, v109, 16, v105
  ds_write_b64 v6, v[114:115] offset:256
  s_waitcnt lgkmcnt(3)
  v_lshl_or_b32 v117, v110, 16, v106
  ds_write_b64 v6, v[116:117] offset:512
  s_waitcnt lgkmcnt(3)
  v_lshl_or_b32 v119, v111, 16, v107
  ds_write_b64 v6, v[118:119] offset:768
  s_waitcnt lgkmcnt(0)
  ds_read_b128 v[120:123], v7 offset:0
  ds_read_b128 v[124:127], v7 offset:1024
  s_waitcnt lgkmcnt(1)
  buffer_store_dwordx4 v[120:123], v8, s[28:31], 0 offen offset:0 sc1
  s_waitcnt lgkmcnt(0)
  buffer_store_dwordx4 v[124:127], v8, s[28:31], 0 offen offset:1024 sc1
  s_load_dword s68, s[12:13], 768
  s_load_dword s69, s[12:13], 832
  s_load_dword s70, s[12:13], 2816
  s_load_dword s71, s[12:13], 2880
  s_load_dword s72, s[12:13], 4864
  s_load_dword s73, s[12:13], 4928
  s_waitcnt vmcnt(12)
  s_barrier
  s_add_u32 m0, s60, 49152
  s_mov_b32 s62, 512
  buffer_load_dwordx4 v16, s[16:19], s62 offen offset:0 lds
  buffer_load_dwordx4 v17, s[16:19], s62 offen offset:1024 lds
  buffer_load_dwordx4 v18, s[16:19], s62 offen offset:2048 lds
  buffer_load_dwordx4 v19, s[16:19], s62 offen offset:3072 lds
  s_add_u32 m0, s60, 53248
  s_mov_b32 s62, 66048
  buffer_load_dwordx4 v16, s[16:19], s62 offen offset:0 lds
  buffer_load_dwordx4 v17, s[16:19], s62 offen offset:1024 lds
  buffer_load_dwordx4 v18, s[16:19], s62 offen offset:2048 lds
  buffer_load_dwordx4 v19, s[16:19], s62 offen offset:3072 lds
  s_mov_b32 s63, 0
L_sp4:
  s_waitcnt lgkmcnt(0)
  s_xor_b64 s[10:11], s[64:65], s[8:9]
  s_xor_b64 s[14:15], s[66:67], s[8:9]
  s_or_b64 s[10:11], s[10:11], s[14:15]
  s_cbranch_scc0 L_ok4
  s_load_dwordx4 s[64:67], s[4:5], 4096 glc
  s_add_u32 s63, s63, 1
  s_cmp_lt_u32 s63, 20000
  s_cbranch_scc1 L_sp4
  s_waitcnt lgkmcnt(0)
L_ok4:
  s_load_dwordx4 s[64:67], s[4:5], 5120 glc
  s_add_u32 m0, s61, 49152
  s_mov_b32 s62, 65536
  buffer_load_dwordx4 v20, s[28:31], s62 offen offset:0 sc1 lds
  buffer_load_dwordx4 v20, s[28:31], s62 offen offset:1024 sc1 lds
  buffer_load_dwordx4 v20, s[28:31], s62 offen offset:2048 sc1 lds
  buffer_load_dwordx4 v20, s[28:31], s62 offen offset:3072 sc1 lds
  s_waitcnt vmcnt(12)
  s_mov_b64 exec, 3
  buffer_store_dwordx2 v[10:11], v14, s[28:31], 0 offen sc1
  s_mov_b64 exec, -1
  s_load_dword s68, s[12:13], 896
  s_load_dword s69, s[12:13], 960
  s_load_dword s70, s[12:13], 2944
  s_load_dword s71, s[12:13], 3008
  s_load_dword s72, s[12:13], 4992
  s_load_dword s73, s[12:13], 5056
  s_waitcnt vmcnt(12)
  s_barrier
  s_add_u32 m0, s60, 98304
  s_mov_b32 s62, 640
  buffer_load_dwordx4 v16, s[16:19], s62 offen offset:0 lds
  buffer_load_dwordx4 v17, s[16:19], s62 offen offset:1024 lds
  buffer_load_dwordx4 v18, s[16:19], s62 offen offset:2048 lds
  buffer_load_dwordx4 v19, s[16:19], s62 offen offset:3072 lds
  s_add_u32 m0, s60, 102400
  s_mov_b32 s62, 66176
  buffer_load_dwordx4 v16, s[16:19], s62 offen offset:0 lds
  buffer_load_dwordx4 v17, s[16:19], s62 offen offset:1024 lds
  buffer_load_dwordx4 v18, s[16:19], s62 offen offset:2048 lds
  buffer_load_dwordx4 v19, s[16:19], s62 offen offset:3072 lds
  s_mov_b32 s63, 0
L_sp5:
  s_waitcnt lgkmcnt(0)
  s_xor_b64 s[10:11], s[64:65], s[8:9]
  s_xor_b64 s[14:15], s[66:67], s[8:9]
  s_or_b64 s[10:11], s[10:11], s[14:15]
  s_cbranch_scc0 L_ok5
  s_load_dwordx4 s[64:67], s[4:5], 5120 glc
  s_add_u32 s63, s63, 1
  s_cmp_lt_u32 s63, 20000
  s_cbranch_scc1 L_sp5
  s_waitcnt lgkmcnt(0)
L_ok5:
  s_load_dwordx4 s[64:67], s[4:5], 6144 glc
  s_add_u32 m0, s61, 98304
  s_mov_b32 s62, 81920
  buffer_load_dwordx4 v20, s[28:31], s62 offen offset:0 sc1 lds
  buffer_load_dwordx4 v20, s[28:31], s62 offen offset:1024 sc1 lds
  buffer_load_dwordx4 v20, s[28:31], s62 offen offset:2048 sc1 lds
  buffer_load_dwordx4 v20, s[28:31], s62 offen offset:3072 sc1 lds
  s_load_dword s68, s[12:13], 1024
  s_load_dword s69, s[12:13], 1088
  s_load_dword s70, s[12:13], 3072
  s_load_dword s71, s[12:13], 3136
  s_load_dword s72, s[12:13], 5120
  s_load_dword s73, s[12:13], 5184
  s_waitcnt vmcnt(12)
  s_barrier
  s_add_u32 m0, s60, 0
  s_mov_b32 s62, 768
  buffer_load_dwordx4 v16, s[16:19], s62 offen offset:0 lds
  buffer_load_dwordx4 v17, s[16:19], s62 offen offset:1024 lds
  buffer_load_dwordx4 v18, s[16:19], s62 offen offset:2048 lds
  buffer_load_dwordx4 v19, s[16:19], s62 offen offset:3072 lds
  s_add_u32 m0, s60, 4096
  s_mov_b32 s62, 66304
  buffer_load_dwordx4 v16, s[16:19], s62 offen offset:0 lds
  buffer_load_dwordx4 v17, s[16:19], s62 offen offset:1024 lds
  buffer_load_dwordx4 v18, s[16:19], s62 offen offset:2048 lds
  buffer_load_dwordx4 v19, s[16:19], s62 offen offset:3072 lds
  s_mov_b32 s63, 0
L_sp6:
  s_waitcnt lgkmcnt(0)
  s_xor_b64 s[10:11], s[64:65], s[8:9]
  s_xor_b64 s[14:15], s[66:67], s[8:9]
  s_or_b64 s[10:11], s[10:11], s[14:15]
  s_cbranch_scc0 L_ok6
  s_load_dwordx4 s[64:67], s[4:5], 6144 glc
  s_add_u32 s63, s63, 1
  s_cmp_lt_u32 s63, 20000
  s_cbranch_scc1 L_sp6
  s_waitcnt lgkmcnt(0)
L_ok6:
  s_load_dwordx4 s[64:67], s[4:5], 7168 glc
  s_add_u32 m0, s61, 0
  s_mov_b32 s62, 98304
  buffer_load_dwordx4 v20, s[28:31], s62 offen offset:0 sc1 lds
  buffer_load_dwordx4 v20, s[28:31], s62 offen offset:1024 sc1 lds
  buffer_load_dwordx4 v20, s[28:31], s62 offen offset:2048 sc1 lds
  buffer_load_dwordx4 v20, s[28:31], s62 offen offset:3072 sc1 lds
  s_load_dword s68, s[12:13], 1152
  s_load_dword s69, s[12:13], 1216
  s_load_dword s70, s[12:13], 3200
  s_load_dword s71, s[12:13], 3264
  s_load_dword s72, s[12:13], 5248
  s_load_dword s73, s[12:13], 5312
  s_waitcnt vmcnt(12)
  s_barrier
  s_add_u32 m0, s60, 49152
  s_mov_b32 s62, 896
  buffer_load_dwordx4 v16, s[16:19], s62 offen offset:0 lds
  buffer_load_dwordx4 v17, s[16:19], s62 offen offset:1024 lds
  buffer_load_dwordx4 v18, s[16:19], s62 offen offset:2048 lds
  buffer_load_dwordx4 v19, s[16:19], s62 offen offset:3072 lds
  s_add_u32 m0, s60, 53248
  s_mov_b32 s62, 66432
  buffer_load_dwordx4 v16, s[16:19], s62 offen offset:0 lds
  buffer_load_dwordx4 v17, s[16:19], s62 offen offset:1024 lds
  buffer_load_dwordx4 v18, s[16:19], s62 offen offset:2048 lds
  buffer_load_dwordx4 v19, s[16:19], s62 offen offset:3072 lds
  s_mov_b32 s63, 0
L_sp7:
  s_waitcnt lgkmcnt(0)
  s_xor_b64 s[10:11], s[64:65], s[8:9]
  s_xor_b64 s[14:15], s[66:67], s[8:9]
  s_or_b64 s[10:11], s[10:11], s[14:15]
  s_cbranch_scc0 L_ok7
  s_load_dwordx4 s[64:67], s[4:5], 7168 glc
  s_add_u32 s63, s63, 1
  s_cmp_lt_u32 s63, 20000
  s_cbranch_scc1 L_sp7
  s_waitcnt lgkmcnt(0)
L_ok7:
  s_load_dwordx4 s[64:67], s[4:5], 8192 glc
  s_add_u32 m0, s61, 49152
  s_mov_b32 s62, 114688
  buffer_load_dwordx4 v20, s[28:31], s62 offen offset:0 sc1 lds
  buffer_load_dwordx4 v20, s[28:31], s62 offen offset:1024 sc1 lds
  buffer_load_dwordx4 v20, s[28:31], s62 offen offset:2048 sc1 lds
  buffer_load_dwordx4 v20, s[28:31], s62 offen offset:3072 sc1 lds
  s_load_dword s68, s[12:13], 1280
  s_load_dword s69, s[12:13], 1344
  s_load_dword s70, s[12:13], 3328
  s_load_dword s71, s[12:13], 3392
  s_load_dword s72, s[12:13], 5376
  s_load_dword s73, s[12:13], 5440
  s_waitcnt vmcnt(12)
  s_barrier
  s_add_u32 m0, s60, 98304
  s_mov_b32 s62, 1024
  buffer_load_dwordx4 v16, s[16:19], s62 offen offset:0 lds
  buffer_load_dwordx4 v17, s[16:19], s62 offen offset:1024 lds
  buffer_load_dwordx4 v18, s[16:19], s62 offen offset:2048 lds
  buffer_load_dwordx4 v19, s[16:19], s62 offen offset:3072 lds
  s_add_u32 m0, s60, 102400
  s_mov_b32 s62, 66560
  buffer_load_dwordx4 v16, s[16:19], s62 offen offset:0 lds
  buffer_load_dwordx4 v17, s[16:19], s62 offen offset:1024 lds
  buffer_load_dwordx4 v18, s[16:19], s62 offen offset:2048 lds
  buffer_load_dwordx4 v19, s[16:19], s62 offen offset:3072 lds
  s_mov_b32 s63, 0
L_sp8:
  s_waitcnt lgkmcnt(0)
  s_xor_b64 s[10:11], s[64:65], s[8:9]
  s_xor_b64 s[14:15], s[66:67], s[8:9]
  s_or_b64 s[10:11], s[10:11], s[14:15]
  s_cbranch_scc0 L_ok8
  s_load_dwordx4 s[64:67], s[4:5], 8192 glc
  s_add_u32 s63, s63, 1
  s_cmp_lt_u32 s63, 20000
  s_cbranch_scc1 L_sp8
  s_waitcnt lgkmcnt(0)
L_ok8:
  s_load_dwordx4 s[64:67], s[4:5], 9216 glc
  s_add_u32 m0, s61, 98304
  s_mov_b32 s62, 131072
  buffer_load_dwordx4 v20, s[28:31], s62 offen offset:0 sc1 lds
  buffer_load_dwordx4 v20, s[28:31], s62 offen offset:1024 sc1 lds
  buffer_load_dwordx4 v20, s[28:31], s62 offen offset:2048 sc1 lds
  buffer_load_dwordx4 v20, s[28:31], s62 offen offset:3072 sc1 lds
  s_load_dword s68, s[12:13], 1408
  s_load_dword s69, s[12:13], 1472
  s_load_dword s70, s[12:13], 3456
  s_load_dword s71, s[12:13], 3520
  s_load_dword s72, s[12:13], 5504
  s_load_dword s73, s[12:13], 5568
  s_waitcnt vmcnt(12)
  s_barrier
  s_add_u32 m0, s60, 0
  s_mov_b32 s62, 1152
  buffer_load_dwordx4 v16, s[16:19], s62 offen offset:0 lds
  buffer_load_dwordx4 v17, s[16:19], s62 offen offset:1024 lds
  buffer_load_dwordx4 v18, s[16:19], s62 offen offset:2048 lds
  buffer_load_dwordx4 v19, s[16:19], s62 offen offset:3072 lds
  s_add_u32 m0, s60, 4096
  s_mov_b32 s62, 66688
  buffer_load_dwordx4 v16, s[16:19], s62 offen offset:0 lds
  buffer_load_dwordx4 v17, s[16:19], s62 offen offset:1024 lds
  buffer_load_dwordx4 v18, s[16:19], s62 offen offset:2048 lds
  buffer_load_dwordx4 v19, s[16:19], s62 offen offset:3072 lds
  s_mov_b32 s63, 0
L_sp9:
  s_waitcnt lgkmcnt(0)
  s_xor_b64 s[10:11], s[64:65], s[8:9]
  s_xor_b64 s[14:15], s[66:67], s[8:9]
  s_or_b64 s[10:11], s[10:11], s[14:15]
  s_cbranch_scc0 L_ok9
  s_load_dwordx4 s[64:67], s[4:5], 9216 glc
  s_add_u32 s63, s63, 1
  s_cmp_lt_u32 s63, 20000
  s_cbranch_scc1 L_sp9
  s_waitcnt lgkmcnt(0)
L_ok9:
  s_load_dwordx4 s[64:67], s[4:5], 10240 glc
  s_add_u32 m0, s61, 0
  s_mov_b32 s62, 147456
  buffer_load_dwordx4 v20, s[28:31], s62 offen offset:0 sc1 lds
  buffer_load_dwordx4 v20, s[28:31], s62 offen offset:1024 sc1 lds
  buffer_load_dwordx4 v20, s[28:31], s62 offen offset:2048 sc1 lds
  buffer_load_dwordx4 v20, s[28:31], s62 offen offset:3072 sc1 lds
  s_load_dword s68, s[12:13], 1536
  s_load_dword s69, s[12:13], 1600
  s_load_dword s70, s[12:13], 3584
  s_load_dword s71, s[12:13], 3648
  s_load_dword s72, s[12:13], 5632
  s_load_dword s73, s[12:13], 5696
  s_waitcnt vmcnt(12)
  s_barrier
  s_add_u32 m0, s60, 49152
  s_mov_b32 s62, 1280
  buffer_load_dwordx4 v16, s[16:19], s62 offen offset:0 lds
  buffer_load_dwordx4 v17, s[16:19], s62 offen offset:1024 lds
  buffer_load_dwordx4 v18, s[16:19], s62 offen offset:2048 lds
  buffer_load_dwordx4 v19, s[16:19], s62 offen offset:3072 lds
  s_add_u32 m0, s60, 53248
  s_mov_b32 s62, 66816
  buffer_load_dwordx4 v16, s[16:19], s62 offen offset:0 lds
  buffer_load_dwordx4 v17, s[16:19], s62 offen offset:1024 lds
  buffer_load_dwordx4 v18, s[16:19], s62 offen offset:2048 lds
  buffer_load_dwordx4 v19, s[16:19], s62 offen offset:3072 lds
  s_mov_b32 s63, 0
L_sp10:
  s_waitcnt lgkmcnt(0)
  s_xor_b64 s[10:11], s[64:65], s[8:9]
  s_xor_b64 s[14:15], s[66:67], s[8:9]
  s_or_b64 s[10:11], s[10:11], s[14:15]
  s_cbranch_scc0 L_ok10
  s_load_dwordx4 s[64:67], s[4:5], 10240 glc
  s_add_u32 s63, s63, 1
  s_cmp_lt_u32 s63, 20000
  s_cbranch_scc1 L_sp10
  s_waitcnt lgkmcnt(0)
L_ok10:
  s_load_dwordx4 s[64:67], s[4:5], 11264 glc
  s_add_u32 m0, s61, 49152
  s_mov_b32 s62, 163840
  buffer_load_dwordx4 v20, s[28:31], s62 offen offset:0 sc1 lds
  buffer_load_dwordx4 v20, s[28:31], s62 offen offset:1024 sc1 lds
  buffer_load_dwordx4 v20, s[28:31], s62 offen offset:2048 sc1 lds
  buffer_load_dwordx4 v20, s[28:31], s62 offen offset:3072 sc1 lds
  s_load_dword s68, s[12:13], 1664
  s_load_dword s69, s[12:13], 1728
  s_load_dword s70, s[12:13], 3712
  s_load_dword s71, s[12:13], 3776
  s_load_dword s72, s[12:13], 5760
  s_load_dword s73, s[12:13], 5824
  s_waitcnt vmcnt(12)
  s_barrier
  s_add_u32 m0, s60, 98304
  s_mov_b32 s62, 1408
  buffer_load_dwordx4 v16, s[16:19], s62 offen offset:0 lds
  buffer_load_dwordx4 v17, s[16:19], s62 offen offset:1024 lds
  buffer_load_dwordx4 v18, s[16:19], s62 offen offset:2048 lds
  buffer_load_dwordx4 v19, s[16:19], s62 offen offset:3072 lds
  s_add_u32 m0, s60, 102400
  s_mov_b32 s62, 66944
  buffer_load_dwordx4 v16, s[16:19], s62 offen offset:0 lds
  buffer_load_dwordx4 v17, s[16:19], s62 offen offset:1024 lds
  buffer_load_dwordx4 v18, s[16:19], s62 offen offset:2048 lds
  buffer_load_dwordx4 v19, s[16:19], s62 offen offset:3072 lds
  s_mov_b32 s63, 0
L_sp11:
  s_waitcnt lgkmcnt(0)
  s_xor_b64 s[10:11], s[64:65], s[8:9]
  s_xor_b64 s[14:15], s[66:67], s[8:9]
  s_or_b64 s[10:11], s[10:11], s[14:15]
  s_cbranch_scc0 L_ok11
  s_load_dwordx4 s[64:67], s[4:5], 11264 glc
  s_add_u32 s63, s63, 1
  s_cmp_lt_u32 s63, 20000
  s_cbranch_scc1 L_sp11
  s_waitcnt lgkmcnt(0)
L_ok11:
  s_load_dwordx4 s[64:67], s[4:5], 12288 glc
  s_add_u32 m0, s61, 98304
  s_mov_b32 s62, 180224
  buffer_load_dwordx4 v20, s[28:31], s62 offen offset:0 sc1 lds
  buffer_load_dwordx4 v20, s[28:31], s62 offen offset:1024 sc1 lds
  buffer_load_dwordx4 v20, s[28:31], s62 offen offset:2048 sc1 lds
  buffer_load_dwordx4 v20, s[28:31], s62 offen offset:3072 sc1 lds
  s_load_dword s68, s[12:13], 1792
  s_load_dword s69, s[12:13], 1856
  s_load_dword s70, s[12:13], 3840
  s_load_dword s71, s[12:13], 3904
  s_load_dword s72, s[12:13], 5888
  s_load_dword s73, s[12:13], 5952
  s_waitcnt vmcnt(12)
  s_barrier
  s_add_u32 m0, s60, 0
  s_mov_b32 s62, 1536
  buffer_load_dwordx4 v16, s[16:19], s62 offen offset:0 lds
  buffer_load_dwordx4 v17, s[16:19], s62 offen offset:1024 lds
  buffer_load_dwordx4 v18, s[16:19], s62 offen offset:2048 lds
  buffer_load_dwordx4 v19, s[16:19], s62 offen offset:3072 lds
  s_add_u32 m0, s60, 4096
  s_mov_b32 s62, 67072
  buffer_load_dwordx4 v16, s[16:19], s62 offen offset:0 lds
  buffer_load_dwordx4 v17, s[16:19], s62 offen offset:1024 lds
  buffer_load_dwordx4 v18, s[16:19], s62 offen offset:2048 lds
  buffer_load_dwordx4 v19, s[16:19], s62 offen offset:3072 lds
  s_mov_b32 s63, 0
L_sp12:
  s_waitcnt lgkmcnt(0)
  s_xor_b64 s[10:11], s[64:65], s[8:9]
  s_xor_b64 s[14:15], s[66:67], s[8:9]
  s_or_b64 s[10:11], s[10:11], s[14:15]
  s_cbranch_scc0 L_ok12
  s_load_dwordx4 s[64:67], s[4:5], 12288 glc
  s_add_u32 s63, s63, 1
  s_cmp_lt_u32 s63, 20000
  s_cbranch_scc1 L_sp12
  s_waitcnt lgkmcnt(0)
L_ok12:
  s_load_dwordx4 s[64:67], s[4:5], 13312 glc
  s_add_u32 m0, s61, 0
  s_mov_b32 s62, 196608
  buffer_load_dwordx4 v20, s[28:31], s62 offen offset:0 sc1 lds
  buffer_load_dwordx4 v20, s[28:31], s62 offen offset:1024 sc1 lds
  buffer_load_dwordx4 v20, s[28:31], s62 offen offset:2048 sc1 lds
  buffer_load_dwordx4 v20, s[28:31], s62 offen offset:3072 sc1 lds
  s_load_dword s68, s[12:13], 1920
  s_load_dword s69, s[12:13], 1984
  s_load_dword s70, s[12:13], 3968
  s_load_dword s71, s[12:13], 4032
  s_load_dword s72, s[12:13], 6016
  s_load_dword s73, s[12:13], 6080
  s_waitcnt vmcnt(12)
  s_barrier
  s_add_u32 m0, s60, 49152
  s_mov_b32 s62, 1664
  buffer_load_dwordx4 v16, s[16:19], s62 offen offset:0 lds
  buffer_load_dwordx4 v17, s[16:19], s62 offen offset:1024 lds
  buffer_load_dwordx4 v18, s[16:19], s62 offen offset:2048 lds
  buffer_load_dwordx4 v19, s[16:19], s62 offen offset:3072 lds
  s_add_u32 m0, s60, 53248
  s_mov_b32 s62, 67200
  buffer_load_dwordx4 v16, s[16:19], s62 offen offset:0 lds
  buffer_load_dwordx4 v17, s[16:19], s62 offen offset:1024 lds
  buffer_load_dwordx4 v18, s[16:19], s62 offen offset:2048 lds
  buffer_load_dwordx4 v19, s[16:19], s62 offen offset:3072 lds
  s_mov_b32 s63, 0
L_sp13:
  s_waitcnt lgkmcnt(0)
  s_xor_b64 s[10:11], s[64:65], s[8:9]
  s_xor_b64 s[14:15], s[66:67], s[8:9]
  s_or_b64 s[10:11], s[10:11], s[14:15]
  s_cbranch_scc0 L_ok13
  s_load_dwordx4 s[64:67], s[4:5], 13312 glc
  s_add_u32 s63, s63, 1
  s_cmp_lt_u32 s63, 20000
  s_cbranch_scc1 L_sp13
  s_waitcnt lgkmcnt(0)
L_ok13:
  s_load_dwordx4 s[64:67], s[4:5], 14336 glc
  s_add_u32 m0, s61, 49152
  s_mov_b32 s62, 212992
  buffer_load_dwordx4 v20, s[28:31], s62 offen offset:0 sc1 lds
  buffer_load_dwordx4 v20, s[28:31], s62 offen offset:1024 sc1 lds
  buffer_load_dwordx4 v20, s[28:31], s62 offen offset:2048 sc1 lds
  buffer_load_dwordx4 v20, s[28:31], s62 offen offset:3072 sc1 lds
  s_waitcnt vmcnt(12)
  s_barrier
  s_add_u32 m0, s60, 98304
  s_mov_b32 s62, 1792
  buffer_load_dwordx4 v16, s[16:19], s62 offen offset:0 lds
  buffer_load_dwordx4 v17, s[16:19], s62 offen offset:1024 lds
  buffer_load_dwordx4 v18, s[16:19], s62 offen offset:2048 lds
  buffer_load_dwordx4 v19, s[16:19], s62 offen offset:3072 lds
  s_add_u32 m0, s60, 102400
  s_mov_b32 s62, 67328
  buffer_load_dwordx4 v16, s[16:19], s62 offen offset:0 lds
  buffer_load_dwordx4 v17, s[16:19], s62 offen offset:1024 lds
  buffer_load_dwordx4 v18, s[16:19], s62 offen offset:2048 lds
  buffer_load_dwordx4 v19, s[16:19], s62 offen offset:3072 lds
  s_mov_b32 s63, 0
L_sp14:
  s_waitcnt lgkmcnt(0)
  s_xor_b64 s[10:11], s[64:65], s[8:9]
  s_xor_b64 s[14:15], s[66:67], s[8:9]
  s_or_b64 s[10:11], s[10:11], s[14:15]
  s_cbranch_scc0 L_ok14
  s_load_dwordx4 s[64:67], s[4:5], 14336 glc
  s_add_u32 s63, s63, 1
  s_cmp_lt_u32 s63, 20000
  s_cbranch_scc1 L_sp14
  s_waitcnt lgkmcnt(0)
L_ok14:
  s_load_dwordx4 s[64:67], s[4:5], 15360 glc
  s_add_u32 m0, s61, 98304
  s_mov_b32 s62, 229376
  buffer_load_dwordx4 v20, s[28:31], s62 offen offset:0 sc1 lds
  buffer_load_dwordx4 v20, s[28:31], s62 offen offset:1024 sc1 lds
  buffer_load_dwordx4 v20, s[28:31], s62 offen offset:2048 sc1 lds
  buffer_load_dwordx4 v20, s[28:31], s62 offen offset:3072 sc1 lds
  s_waitcnt vmcnt(12)
  s_barrier
  s_add_u32 m0, s60, 0
  s_mov_b32 s62, 1920
  buffer_load_dwordx4 v16, s[16:19], s62 offen offset:0 lds
  buffer_load_dwordx4 v17, s[16:19], s62 offen offset:1024 lds
  buffer_load_dwordx4 v18, s[16:19], s62 offen offset:2048 lds
  buffer_load_dwordx4 v19, s[16:19], s62 offen offset:3072 lds
  s_add_u32 m0, s60, 4096
  s_mov_b32 s62, 67456
  buffer_load_dwordx4 v16, s[16:19], s62 offen offset:0 lds
  buffer_load_dwordx4 v17, s[16:19], s62 offen offset:1024 lds
  buffer_load_dwordx4 v18, s[16:19], s62 offen offset:2048 lds
  buffer_load_dwordx4 v19, s[16:19], s62 offen offset:3072 lds
  s_mov_b32 s63, 0
L_sp15:
  s_waitcnt lgkmcnt(0)
  s_xor_b64 s[10:11], s[64:65], s[8:9]
  s_xor_b64 s[14:15], s[66:67], s[8:9]
  s_or_b64 s[10:11], s[10:11], s[14:15]
  s_cbranch_scc0 L_ok15
  s_load_dwordx4 s[64:67], s[4:5], 15360 glc
  s_add_u32 s63, s63, 1
  s_cmp_lt_u32 s63, 20000
  s_cbranch_scc1 L_sp15
  s_waitcnt lgkmcnt(0)
L_ok15:
  s_add_u32 m0, s61, 0
  s_mov_b32 s62, 245760
  buffer_load_dwordx4 v20, s[28:31], s62 offen offset:0 sc1 lds
  buffer_load_dwordx4 v20, s[28:31], s62 offen offset:1024 sc1 lds
  buffer_load_dwordx4 v20, s[28:31], s62 offen offset:2048 sc1 lds
  buffer_load_dwordx4 v20, s[28:31], s62 offen offset:3072 sc1 lds
  s_waitcnt vmcnt(12)
  s_barrier
  s_waitcnt vmcnt(0)
  s_barrier
  s_endpgm
L_prod:
  s_cmp_ge_u32 s2, 28
  s_cbranch_scc1 L_done
  s_mov_b32 s36, s2
  s_mov_b32 s37, 4
  s_mov_b32 s56, 917504
  s_mov_b32 s57, 16384
  s_mov_b32 s58, 1024
  s_mov_b32 s59, 0
  s_mov_b32 s55, 8
  s_mov_b32 s51, 1
  s_lshl_b32 s52, s37, 3
  s_add_u32 s52, s52, s38
  s_mul_i32 s53, s52, 114688
  s_lshl_b32 s54, s36, 9
  s_add_u32 s53, s53, s54
  v_add_u32 v4, s53, v4
  s_mul_i32 s53, s38, 14336
  s_lshl_b32 s54, s36, 8
  s_add_u32 s53, s53, s54
  v_add_u32 v16, s53, v16
  s_lshl_b32 m0, s38, 9
  s_mov_b32 s50, 6912
  v_mov_b32 v15, 0x7ff00000
  s_waitcnt lgkmcnt(0)
L_pl:
  buffer_load_dword v16, s[24:27], 0 offen lds
  buffer_load_dword v16, s[24:27], s50 offen offset:256 lds
  s_add_u32 m0, m0, 4096
  v_add_u32 v16, 256, v16
  s_sub_u32 s51, s51, 1
  s_cmp_lg_u32 s51, 0
  s_cbranch_scc1 L_pl
  buffer_load_dwordx4 v[32:35], v4, s[20:23], 0 offen
  buffer_load_dwordx4 v[36:39], v4, s[20:23], s45 offen
  buffer_load_dwordx4 v[40:43], v4, s[20:23], s46 offen
  buffer_load_dwordx4 v[44:47], v4, s[20:23], s47 offen
  v_add_u32 v4, s56, v4
  buffer_load_dword v17, v15, s[20:23], 0 offen
  buffer_load_dword v17, v15, s[20:23], 0 offen
  buffer_load_dwordx4 v[48:51], v4, s[20:23], 0 offen
  buffer_load_dwordx4 v[52:55], v4, s[20:23], s45 offen
  buffer_load_dwordx4 v[56:59], v4, s[20:23], s46 offen
  buffer_load_dwordx4 v[60:63], v4, s[20:23], s47 offen
  v_add_u32 v4, s56, v4
  v_add_u32 v4, s56, v4
  s_add_u32 s10, s28, 9437184
  s_addc_u32 s11, s29, 0
  s_load_dwordx2 s[6:7], s[10:11], 0
  s_lshl_b32 s53, s38, 11
  s_add_u32 s53, s53, 32768
  v_and_b32 v1, 1, v3
  v_lshlrev_b32 v1, 10, v1
  v_lshl_add_u32 v1, v9, 3, v1
  v_lshrrev_b32 v6, 1, v3
  v_lshl_add_u32 v6, v6, 4, v1
  v_add_u32 v6, s53, v6
  v_lshl_add_u32 v7, v2, 4, s53
  s_lshl_b32 s53, s36, 18
  s_lshl_b32 s54, s52, 11
  s_add_u32 s53, s53, s54
  v_lshl_add_u32 v8, v2, 4, s53
  s_lshl_b32 s53, s36, 6
  s_lshr_b32 s54, s52, 1
  s_add_u32 s53, s53, s54
  s_lshl_b32 s53, s53, 8
  s_and_b32 s54, s52, 1
  s_lshl_b32 s54, s54, 3
  s_add_u32 s53, s53, s54
  s_add_u32 s53, s53, 7340032
  v_lshl_add_u32 v14, v2, 7, s53
  s_waitcnt lgkmcnt(0)
  s_mul_i32 s8, s6, 1664525
  s_mul_i32 s9, s7, 22695477
  s_add_u32 s8, s8, 1013904223
  s_add_u32 s9, s9, 1
  v_mov_b32 v10, s8
  v_mov_b32 v11, s9
  s_mov_b32 s60, 0
  s_mov_b32 s61, 0
  s_mov_b32 s62, 0
  s_waitcnt vmcnt(10)
  s_barrier
L_p:
  s_waitcnt vmcnt(9)
  v_lshl_add_u32 v32, v32, 8, v5
  v_lshl_add_u32 v33, v33, 8, v5
  v_lshl_add_u32 v34, v34, 8, v5
  v_lshl_add_u32 v35, v35, 8, v5
  ds_read_u16 v96, v32 offset:0
  ds_read_u16 v97, v33 offset:2
  ds_read_u16 v98, v34 offset:128
  ds_read_u16 v99, v35 offset:130
  s_waitcnt vmcnt(8)
  v_lshl_add_u32 v36, v36, 8, v5
  v_lshl_add_u32 v37, v37, 8, v5
  v_lshl_add_u32 v38, v38, 8, v5
  v_lshl_add_u32 v39, v39, 8, v5
  ds_read_u16 v100, v36 offset:0
  ds_read_u16 v101, v37 offset:2
  ds_read_u16 v102, v38 offset:128
  ds_read_u16 v103, v39 offset:130
  s_waitcnt vmcnt(7)
  v_lshl_add_u32 v40, v40, 8, v5
  v_lshl_add_u32 v41, v41, 8, v5
  v_lshl_add_u32 v42, v42, 8, v5
  v_lshl_add_u32 v43, v43, 8, v5
  ds_read_u16 v104, v40 offset:0
  ds_read_u16 v105, v41 offset:2
  ds_read_u16 v106, v42 offset:128
  ds_read_u16 v107, v43 offset:130
  s_waitcnt vmcnt(6)
  v_lshl_add_u32 v44, v44, 8, v5
  v_lshl_add_u32 v45, v45, 8, v5
  v_lshl_add_u32 v46, v46, 8, v5
  v_lshl_add_u32 v47, v47, 8, v5
  ds_read_u16 v108, v44 offset:0
  ds_read_u16 v109, v45 offset:2
  ds_read_u16 v110, v46 offset:128
  ds_read_u16 v111, v47 offset:130
  s_waitcnt lgkmcnt(8)
  v_lshl_or_b32 v112, v100, 16, v96
  v_lshl_or_b32 v114, v101, 16, v97
  v_lshl_or_b32 v116, v102, 16, v98
  v_lshl_or_b32 v118, v103, 16, v99
  s_waitcnt lgkmcnt(3)
  v_lshl_or_b32 v113, v108, 16, v104
  ds_write_b64 v6, v[112:113] offset:0
  s_waitcnt lgkmcnt(3)
  v_lshl_or_b32 v115, v109, 16, v105
  ds_write_b64 v6, v[114:115] offset:256
  s_waitcnt lgkmcnt(3)
  v_lshl_or_b32 v117, v110, 16, v106
  ds_write_b64 v6, v[116:117] offset:512
  s_waitcnt lgkmcnt(3)
  v_lshl_or_b32 v119, v111, 16, v107
  ds_write_b64 v6, v[118:119] offset:768
  s_waitcnt lgkmcnt(0)
  ds_read_b128 v[120:123], v7 offset:0
  ds_read_b128 v[124:127], v7 offset:1024
  s_cmp_eq_u32 s62, 0
  s_cbranch_scc1 L_pa0
  s_waitcnt vmcnt(4)
  s_mov_b64 exec, 3
  buffer_store_dwordx2 v[10:11], v14, s[28:31], s61 offen sc1
  s_mov_b64 exec, -1
  s_add_u32 s61, s61, s58
  s_add_u32 s61, s61, s58
L_pa0:
  s_waitcnt lgkmcnt(1)
  buffer_store_dwordx4 v[120:123], v8, s[28:31], s60 offen offset:0 sc1
  s_waitcnt lgkmcnt(0)
  buffer_store_dwordx4 v[124:127], v8, s[28:31], s60 offen offset:1024 sc1
  buffer_load_dwordx4 v[32:35], v4, s[20:23], 0 offen
  buffer_load_dwordx4 v[36:39], v4, s[20:23], s45 offen
  buffer_load_dwordx4 v[40:43], v4, s[20:23], s46 offen
  buffer_load_dwordx4 v[44:47], v4, s[20:23], s47 offen
  v_add_u32 v4, s56, v4
  v_add_u32 v5, s59, v5
  s_add_u32 s62, s62, 1
  s_add_u32 s60, s60, s57
  s_cmp_lt_u32 s62, s55
  s_cbranch_scc0 L_pe
  s_waitcnt vmcnt(9)
  v_lshl_add_u32 v48, v48, 8, v5
  v_lshl_add_u32 v49, v49, 8, v5
  v_lshl_add_u32 v50, v50, 8, v5
  v_lshl_add_u32 v51, v51, 8, v5
  ds_read_u16 v96, v48 offset:0
  ds_read_u16 v97, v49 offset:2
  ds_read_u16 v98, v50 offset:128
  ds_read_u16 v99, v51 offset:130
  s_waitcnt vmcnt(8)
  v_lshl_add_u32 v52, v52, 8, v5
  v_lshl_add_u32 v53, v53, 8, v5
  v_lshl_add_u32 v54, v54, 8, v5
  v_lshl_add_u32 v55, v55, 8, v5
  ds_read_u16 v100, v52 offset:0
  ds_read_u16 v101, v53 offset:2
  ds_read_u16 v102, v54 offset:128
  ds_read_u16 v103, v55 offset:130
  s_waitcnt vmcnt(7)
  v_lshl_add_u32 v56, v56, 8, v5
  v_lshl_add_u32 v57, v57, 8, v5
  v_lshl_add_u32 v58, v58, 8, v5
  v_lshl_add_u32 v59, v59, 8, v5
  ds_read_u16 v104, v56 offset:0
  ds_read_u16 v105, v57 offset:2
  ds_read_u16 v106, v58 offset:128
  ds_read_u16 v107, v59 offset:130
  s_waitcnt vmcnt(6)
  v_lshl_add_u32 v60, v60, 8, v5
  v_lshl_add_u32 v61, v61, 8, v5
  v_lshl_add_u32 v62, v62, 8, v5
  v_lshl_add_u32 v63, v63, 8, v5
  ds_read_u16 v108, v60 offset:0
  ds_read_u16 v109, v61 offset:2
  ds_read_u16 v110, v62 offset:128
  ds_read_u16 v111, v63 offset:130
  s_waitcnt lgkmcnt(8)
  v_lshl_or_b32 v112, v100, 16, v96
  v_lshl_or_b32 v114, v101, 16, v97
  v_lshl_or_b32 v116, v102, 16, v98
  v_lshl_or_b32 v118, v103, 16, v99
  s_waitcnt lgkmcnt(3)
  v_lshl_or_b32 v113, v108, 16, v104
  ds_write_b64 v6, v[112:113] offset:0
  s_waitcnt lgkmcnt(3)
  v_lshl_or_b32 v115, v109, 16, v105
  ds_write_b64 v6, v[114:115] offset:256
  s_waitcnt lgkmcnt(3)
  v_lshl_or_b32 v117, v110, 16, v106
  ds_write_b64 v6, v[116:117] offset:512
  s_waitcnt lgkmcnt(3)
  v_lshl_or_b32 v119, v111, 16, v107
  ds_write_b64 v6, v[118:119] offset:768
  s_waitcnt lgkmcnt(0)
  ds_read_b128 v[128:131], v7 offset:0
  ds_read_b128 v[132:135], v7 offset:1024
  s_cmp_eq_u32 s62, 0
  s_cbranch_scc1 L_pa1
  s_waitcnt vmcnt(4)
  s_mov_b64 exec, 3
  buffer_store_dwordx2 v[10:11], v14, s[28:31], s61 offen sc1
  s_mov_b64 exec, -1
  s_add_u32 s61, s61, s58
L_pa1:
  s_waitcnt lgkmcnt(1)
  buffer_store_dwordx4 v[128:131], v8, s[28:31], s60 offen offset:0 sc1
  s_waitcnt lgkmcnt(0)
  buffer_store_dwordx4 v[132:135], v8, s[28:31], s60 offen offset:1024 sc1
  buffer_load_dwordx4 v[48:51], v4, s[20:23], 0 offen
  buffer_load_dwordx4 v[52:55], v4, s[20:23], s45 offen
  buffer_load_dwordx4 v[56:59], v4, s[20:23], s46 offen
  buffer_load_dwordx4 v[60:63], v4, s[20:23], s47 offen
  v_add_u32 v4, s56, v4
  v_add_u32 v5, s59, v5
  s_add_u32 s62, s62, 1
  s_add_u32 s60, s60, s57
  v_add_u32 v4, s56, v4
  s_add_u32 s60, s60, s57
  s_cmp_lt_u32 s62, s55
  s_cbranch_scc1 L_p
L_pe:
  s_waitcnt vmcnt(4)
  s_mov_b64 exec, 3
  buffer_store_dwordx2 v[10:11], v14, s[28:31], s61 offen sc1
  s_mov_b64 exec, -1
  s_cmp_eq_u32 s38, 0
  s_cbranch_scc0 L_pz
  s_lshl_b32 s3, s2, 6
  s_add_u32 s3, s3, 9441280
  v_mov_b32 v12, s3
  s_mov_b64 exec, 1
  buffer_store_dwordx2 v[10:11], v12, s[28:31], 0 offen sc1
  s_mov_b64 exec, -1
  s_cmp_eq_u32 s2, 0
  s_cbranch_scc0 L_pz
  s_mov_b32 s63, 0
  v_lshlrev_b32 v12, 6, v2
  v_add_u32 v12, 9441280, v12
L_pw:
  v_mov_b32 v13, 28
  v_max_u32 v13, v13, v2
  s_mov_b32 s53, 0
  buffer_load_dwordx2 v[20:21], v12, s[28:31], s53 offen sc1
  s_mov_b32 s53, 4096
  buffer_load_dwordx2 v[22:23], v12, s[28:31], s53 offen sc1
  s_mov_b32 s53, 8192
  buffer_load_dwordx2 v[24:25], v12, s[28:31], s53 offen sc1
  s_mov_b32 s53, 12288
  buffer_load_dwordx2 v[26:27], v12, s[28:31], s53 offen sc1
  s_add_u32 s63, s63, 1
  s_waitcnt vmcnt(0)
  v_cmp_ne_u64 s[52:53], v[20:21], v[10:11]
  s_and_b32 s52, s52, 0x0fffffff
  v_cmp_ne_u64 vcc, v[22:23], v[10:11]
  s_or_b64 s[52:53], s[52:53], vcc
  v_cmp_ne_u64 vcc, v[24:25], v[10:11]
  s_or_b64 s[52:53], s[52:53], vcc
  v_cmp_ne_u64 vcc, v[26:27], v[10:11]
  s_or_b64 s[52:53], s[52:53], vcc
  s_cbranch_scc0 L_pv
  s_cmp_lt_u32 s63, 20000
  s_cbranch_scc1 L_pw
L_pv:
  v_mov_b32 v12, 9437184
  s_mov_b64 exec, 1
  buffer_store_dwordx2 v[10:11], v12, s[28:31], 0 offen sc1
  s_mov_b64 exec, -1
L_pz:
L_done:
  s_endpgm
.section .rodata,"a"
.p2align 6
.amdhsa_kernel standalone__weight_only_int_squeezellm__prompt_kernel
  .amdhsa_next_free_vgpr 256
  .amdhsa_next_free_sgpr 102
  .amdhsa_accum_offset 160
  .amdhsa_group_segment_fixed_size 0
  .amdhsa_kernarg_size 48
  .amdhsa_user_sgpr_count 2
  .amdhsa_user_sgpr_kernarg_segment_ptr 1
  .amdhsa_system_sgpr_workgroup_id_x 1
.end_amdhsa_kernel
```

```asm
; @launch grid=(256,1,1) block=(512,1,1) lds=151552
.amdgcn_target "amdgcn-amd-amdhsa--gfx950"
.text
.globl standalone__weight_only_int_squeezellm__prompt_kernel
.p2align 8
.type standalone__weight_only_int_squeezellm__prompt_kernel,@function
standalone__weight_only_int_squeezellm__prompt_kernel:
  s_cmp_ge_u32 s2, 256
  s_cbranch_scc1 L_done
  s_load_dwordx2 s[24:25], s[0:1], 16
  s_load_dwordx2 s[20:21], s[0:1], 8
  s_load_dwordx2 s[28:29], s[0:1], 40
  s_load_dwordx2 s[16:17], s[0:1], 0
  s_load_dwordx2 s[32:33], s[0:1], 24
  s_sub_u32 s3, s2, 28
  s_cmp_lt_u32 s3, 4
  s_cbranch_scc1 L_done
  s_mov_b32 s18, 4194304
  s_mov_b32 s19, 0x20000
  s_mov_b32 s22, 14680064
  s_mov_b32 s23, 0x20000
  s_mov_b32 s26, 114688
  s_mov_b32 s27, 0x20000
  s_mov_b32 s30, 9457664
  s_mov_b32 s31, 0x20000
  s_mov_b32 s34, 14680064
  s_mov_b32 s35, 0x20000
  v_lshrrev_b32 v1, 6, v0
  v_and_b32 v2, 63, v0
  v_readfirstlane_b32 s38, v1
  v_and_b32 v3, 31, v0
  v_bfe_u32 v9, v0, 5, 1
  s_mov_b32 s45, 14336
  s_mov_b32 s46, 28672
  s_mov_b32 s47, 43008
  v_mul_u32_u24 v1, 57344, v9
  v_lshl_add_u32 v4, v3, 4, v1
  v_lshlrev_b32 v1, 3, v3
  v_lshl_add_u32 v16, v9, 2, v1
  v_lshlrev_b32 v5, 2, v3
  s_and_b32 s3, s2, 1
  s_lshl_b32 s3, s3, 2
  s_bfe_u32 s36, s2, 0x20003
  s_add_u32 s36, s36, s3
  s_bfe_u32 s3, s2, 0x20001
  s_mul_i32 s3, s3, 7
  s_lshr_b32 s37, s2, 5
  s_add_u32 s37, s37, s3
  s_sub_u32 s37, s37, 1
  s_cmp_lt_u32 s2, 32
  s_cselect_b32 s36, 8, s36
  s_cselect_b32 s37, s2, s37
  s_cselect_b32 s51, 0, 147456
  s_lshl_b32 s52, s36, 3
  s_add_u32 s52, s52, s38
  s_mul_i32 s53, s52, 114688
  s_lshl_b32 s54, s37, 9
  s_add_u32 s53, s53, s54
  v_add_u32 v4, s53, v4
  s_mul_i32 s53, s38, 14336
  s_lshl_b32 s54, s37, 8
  s_add_u32 s53, s53, s54
  v_add_u32 v16, s53, v16
  s_lshl_b32 s53, s38, 9
  s_add_u32 m0, s53, s51
  s_mov_b32 s50, 6912
  v_add_u32 v5, s51, v5
  s_and_b32 s39, s38, 3
  s_cmp_lt_u32 s2, 32
  s_waitcnt lgkmcnt(0)
  buffer_load_dword v16, s[24:27], 0 offen lds
  buffer_load_dword v16, s[24:27], s50 offen offset:256 lds
  s_cbranch_scc1 L_prod
  buffer_load_dwordx4 v[32:35], v4, s[20:23], 0 offen
  buffer_load_dwordx4 v[36:39], v4, s[20:23], s45 offen
  buffer_load_dwordx4 v[40:43], v4, s[20:23], s46 offen
  buffer_load_dwordx4 v[44:47], v4, s[20:23], s47 offen
  s_add_u32 s10, s28, 9437184
  s_addc_u32 s11, s29, 0
  s_load_dwordx2 s[6:7], s[10:11], 0
  s_lshl_b32 s53, s38, 11
  s_add_u32 s53, s53, 32768
  v_and_b32 v1, 1, v3
  v_lshlrev_b32 v1, 10, v1
  v_lshl_add_u32 v1, v9, 3, v1
  v_lshrrev_b32 v6, 1, v3
  v_lshl_add_u32 v6, v6, 4, v1
  v_add_u32 v6, s53, v6
  v_lshl_add_u32 v7, v2, 4, s53
  s_lshl_b32 s53, s37, 18
  s_lshl_b32 s54, s52, 11
  s_add_u32 s53, s53, s54
  v_lshl_add_u32 v8, v2, 4, s53
  s_lshl_b32 s53, s37, 6
  s_lshr_b32 s54, s52, 1
  s_add_u32 s53, s53, s54
  s_lshl_b32 s53, s53, 8
  s_and_b32 s54, s52, 1
  s_lshl_b32 s54, s54, 3
  s_add_u32 s53, s53, s54
  s_add_u32 s53, s53, 7340032
  v_lshl_add_u32 v14, v2, 7, s53
  s_lshl_b32 s53, s37, 2
  s_add_u32 s53, s53, s39
  s_mul_i32 s53, s53, 3
  s_min_u32 s53, s53, 253
  s_lshl_b32 s54, s36, 8
  s_add_u32 s53, s53, s54
  s_lshl_b32 s53, s53, 11
  s_add_u32 s12, s16, s53
  s_addc_u32 s13, s17, 0
  s_andn2_b32 s40, 4, s36
  v_and_b32 v3, 15, v2
  v_lshrrev_b32 v9, 4, v2
  v_lshrrev_b32 v1, 1, v3
  v_xor_b32 v1, v1, v9
  v_lshlrev_b32 v1, 4, v1
  v_lshl_add_u32 v144, v3, 7, v1
  s_lshl_b32 s54, s38, 13
  v_add_u32 v144, s54, v144
  v_xor_b32 v145, 64, v144
  v_lshlrev_b32 v1, 11, v9
  v_lshl_add_u32 v146, v3, 4, v1
  v_add_u32 v146, 32768, v146
  s_lshl_b32 s52, s36, 8
  s_lshl_b32 s53, s38, 6
  s_add_u32 s52, s52, s53
  s_mul_i32 s52, s52, 7168
  s_lshl_b32 s53, s37, 8
  s_add_u32 s52, s52, s53
  v_mul_u32_u24 v1, 28672, v9
  v_lshl_add_u32 v1, v3, 4, v1
  v_add_u32 v147, s52, v1
  v_lshrrev_b32 v20, 3, v2
  v_lshlrev_b32 v20, 11, v20
  v_lshrrev_b32 v1, 4, v2
  v_xor_b32 v1, v1, v2
  v_and_b32 v1, 7, v1
  v_lshl_add_u32 v20, v1, 4, v20
  s_lshl_b32 s52, s36, 19
  s_lshl_b32 s53, s39, 17
  s_add_u32 s53, s52, s53
  v_add_u32 v16, s53, v20
  v_xor_b32 v17, 64, v16
  v_add_u32 v18, 30720, v16
  v_add_u32 v19, 46080, v17
  v_add_u32 v17, 15360, v17
  s_lshl_b32 s60, s39, 13
  s_lshl_b32 s53, s37, 18
  s_lshl_b32 s54, s39, 12
  s_add_u32 s53, s53, s54
  v_lshl_add_u32 v20, v2, 4, s53
  s_add_u32 s61, s54, 32768
  s_lshl_b32 s53, s37, 14
  s_lshl_b32 s54, s39, 8
  s_add_u32 s53, s53, s54
  s_and_b32 s54, s36, 1
  s_lshl_b32 s54, s54, 7
  s_add_u32 s53, s53, s54
  s_add_u32 s53, s53, 7340032
  s_add_u32 s4, s28, s53
  s_addc_u32 s5, s29, 0
  s_lshl_b32 s41, s36, 7
  s_lshr_b32 s53, s38, 2
  s_lshl_b32 s54, s53, 16
  s_add_u32 s41, s41, s54
  s_lshl_b32 s53, s53, 12
  s_add_u32 m0, s60, s53
  s_waitcnt lgkmcnt(0)
  s_mul_i32 s8, s6, 1664525
  s_mul_i32 s9, s7, 22695477
  s_add_u32 s8, s8, 1013904223
  s_add_u32 s9, s9, 1
  v_mov_b32 v10, s8
  v_mov_b32 v11, s9
  s_waitcnt vmcnt(4)
  s_barrier
  s_waitcnt vmcnt(3)
  v_lshl_add_u32 v32, v32, 8, v5
  v_lshl_add_u32 v33, v33, 8, v5
  v_lshl_add_u32 v34, v34, 8, v5
  v_lshl_add_u32 v35, v35, 8, v5
  ds_read_u16 v96, v32 offset:0
  ds_read_u16 v97, v33 offset:2
  ds_read_u16 v98, v34 offset:128
  ds_read_u16 v99, v35 offset:130
  buffer_load_dwordx4 v16, s[16:19], s41 offen offset:0 lds
  s_waitcnt vmcnt(3)
  v_lshl_add_u32 v36, v36, 8, v5
  v_lshl_add_u32 v37, v37, 8, v5
  v_lshl_add_u32 v38, v38, 8, v5
  v_lshl_add_u32 v39, v39, 8, v5
  ds_read_u16 v100, v36 offset:0
  ds_read_u16 v101, v37 offset:2
  ds_read_u16 v102, v38 offset:128
  ds_read_u16 v103, v39 offset:130
  buffer_load_dwordx4 v17, s[16:19], s41 offen offset:1024 lds
  s_waitcnt vmcnt(3)
  v_lshl_add_u32 v40, v40, 8, v5
  v_lshl_add_u32 v41, v41, 8, v5
  v_lshl_add_u32 v42, v42, 8, v5
  v_lshl_add_u32 v43, v43, 8, v5
  ds_read_u16 v104, v40 offset:0
  ds_read_u16 v105, v41 offset:2
  ds_read_u16 v106, v42 offset:128
  ds_read_u16 v107, v43 offset:130
  buffer_load_dwordx4 v18, s[16:19], s41 offen offset:2048 lds
  s_waitcnt vmcnt(3)
  v_lshl_add_u32 v44, v44, 8, v5
  v_lshl_add_u32 v45, v45, 8, v5
  v_lshl_add_u32 v46, v46, 8, v5
  v_lshl_add_u32 v47, v47, 8, v5
  ds_read_u16 v108, v44 offset:0
  ds_read_u16 v109, v45 offset:2
  ds_read_u16 v110, v46 offset:128
  ds_read_u16 v111, v47 offset:130
  buffer_load_dwordx4 v19, s[16:19], s41 offen offset:3072 lds
  s_waitcnt lgkmcnt(8)
  v_lshl_or_b32 v112, v100, 16, v96
  v_lshl_or_b32 v114, v101, 16, v97
  v_lshl_or_b32 v116, v102, 16, v98
  v_lshl_or_b32 v118, v103, 16, v99
  s_waitcnt lgkmcnt(3)
  v_lshl_or_b32 v113, v108, 16, v104
  ds_write_b64 v6, v[112:113] offset:0
  s_waitcnt lgkmcnt(3)
  v_lshl_or_b32 v115, v109, 16, v105
  ds_write_b64 v6, v[114:115] offset:256
  s_waitcnt lgkmcnt(3)
  v_lshl_or_b32 v117, v110, 16, v106
  ds_write_b64 v6, v[116:117] offset:512
  s_waitcnt lgkmcnt(3)
  v_lshl_or_b32 v119, v111, 16, v107
  ds_write_b64 v6, v[118:119] offset:768
  s_waitcnt lgkmcnt(0)
  ds_read_b128 v[148:151], v7 offset:0
  ds_read_b128 v[152:155], v7 offset:1024
  s_waitcnt lgkmcnt(1)
  buffer_store_dwordx4 v[148:151], v8, s[28:31], 0 offen offset:0 sc1
  s_waitcnt lgkmcnt(0)
  buffer_store_dwordx4 v[152:155], v8, s[28:31], 0 offen offset:1024 sc1
  s_cmp_ge_u32 s38, 4
  s_cbranch_scc1 L_loader
  s_add_u32 s58, s40, 0
  s_lshl_b32 s58, s58, 7
  s_load_dword s92, s[12:13], s58 offset:0
  s_load_dword s93, s[12:13], s58 offset:64
  s_load_dword s94, s[12:13], s58 offset:2048
  s_load_dword s95, s[12:13], s58 offset:2112
  s_load_dword s96, s[12:13], s58 offset:4096
  s_load_dword s97, s[12:13], s58 offset:4160
  s_add_u32 s58, s40, 1
  s_lshl_b32 s58, s58, 7
  s_load_dword s92, s[12:13], s58 offset:0
  s_load_dword s93, s[12:13], s58 offset:64
  s_load_dword s94, s[12:13], s58 offset:2048
  s_load_dword s95, s[12:13], s58 offset:2112
  s_load_dword s96, s[12:13], s58 offset:4096
  s_load_dword s97, s[12:13], s58 offset:4160
  v_mov_b32 v5, v144
  v_mov_b32 v6, v145
  v_mov_b32 v7, v146
  v_mov_b32 v16, 0
  v_mov_b32 v17, 0
  v_mov_b32 v18, 0
  v_mov_b32 v19, 0
  v_mov_b32 v20, 0
  v_mov_b32 v21, 0
  v_mov_b32 v22, 0
  v_mov_b32 v23, 0
  v_mov_b32 v24, 0
  v_mov_b32 v25, 0
  v_mov_b32 v26, 0
  v_mov_b32 v27, 0
  v_mov_b32 v28, 0
  v_mov_b32 v29, 0
  v_mov_b32 v30, 0
  v_mov_b32 v31, 0
  v_mov_b32 v32, 0
  v_mov_b32 v33, 0
  v_mov_b32 v34, 0
  v_mov_b32 v35, 0
  v_mov_b32 v36, 0
  v_mov_b32 v37, 0
  v_mov_b32 v38, 0
  v_mov_b32 v39, 0
  v_mov_b32 v40, 0
  v_mov_b32 v41, 0
  v_mov_b32 v42, 0
  v_mov_b32 v43, 0
  v_mov_b32 v44, 0
  v_mov_b32 v45, 0
  v_mov_b32 v46, 0
  v_mov_b32 v47, 0
  v_mov_b32 v48, 0
  v_mov_b32 v49, 0
  v_mov_b32 v50, 0
  v_mov_b32 v51, 0
  v_mov_b32 v52, 0
  v_mov_b32 v53, 0
  v_mov_b32 v54, 0
  v_mov_b32 v55, 0
  v_mov_b32 v56, 0
  v_mov_b32 v57, 0
  v_mov_b32 v58, 0
  v_mov_b32 v59, 0
  v_mov_b32 v60, 0
  v_mov_b32 v61, 0
  v_mov_b32 v62, 0
  v_mov_b32 v63, 0
  v_mov_b32 v64, 0
  v_mov_b32 v65, 0
  v_mov_b32 v66, 0
  v_mov_b32 v67, 0
  v_mov_b32 v68, 0
  v_mov_b32 v69, 0
  v_mov_b32 v70, 0
  v_mov_b32 v71, 0
  v_mov_b32 v72, 0
  v_mov_b32 v73, 0
  v_mov_b32 v74, 0
  v_mov_b32 v75, 0
  v_mov_b32 v76, 0
  v_mov_b32 v77, 0
  v_mov_b32 v78, 0
  v_mov_b32 v79, 0
  v_mov_b32 v80, 0
  v_mov_b32 v81, 0
  v_mov_b32 v82, 0
  v_mov_b32 v83, 0
  v_mov_b32 v84, 0
  v_mov_b32 v85, 0
  v_mov_b32 v86, 0
  v_mov_b32 v87, 0
  v_mov_b32 v88, 0
  v_mov_b32 v89, 0
  v_mov_b32 v90, 0
  v_mov_b32 v91, 0
  v_mov_b32 v92, 0
  v_mov_b32 v93, 0
  v_mov_b32 v94, 0
  v_mov_b32 v95, 0
  v_mov_b32 v96, 0
  v_mov_b32 v97, 0
  v_mov_b32 v98, 0
  v_mov_b32 v99, 0
  v_mov_b32 v100, 0
  v_mov_b32 v101, 0
  v_mov_b32 v102, 0
  v_mov_b32 v103, 0
  v_mov_b32 v104, 0
  v_mov_b32 v105, 0
  v_mov_b32 v106, 0
  v_mov_b32 v107, 0
  v_mov_b32 v108, 0
  v_mov_b32 v109, 0
  v_mov_b32 v110, 0
  v_mov_b32 v111, 0
  v_mov_b32 v112, 0
  v_mov_b32 v113, 0
  v_mov_b32 v114, 0
  v_mov_b32 v115, 0
  v_mov_b32 v116, 0
  v_mov_b32 v117, 0
  v_mov_b32 v118, 0
  v_mov_b32 v119, 0
  v_mov_b32 v120, 0
  v_mov_b32 v121, 0
  v_mov_b32 v122, 0
  v_mov_b32 v123, 0
  v_mov_b32 v124, 0
  v_mov_b32 v125, 0
  v_mov_b32 v126, 0
  v_mov_b32 v127, 0
  v_mov_b32 v128, 0
  v_mov_b32 v129, 0
  v_mov_b32 v130, 0
  v_mov_b32 v131, 0
  v_mov_b32 v132, 0
  v_mov_b32 v133, 0
  v_mov_b32 v134, 0
  v_mov_b32 v135, 0
  v_mov_b32 v136, 0
  v_mov_b32 v137, 0
  v_mov_b32 v138, 0
  v_mov_b32 v139, 0
  v_mov_b32 v140, 0
  v_mov_b32 v141, 0
  v_mov_b32 v142, 0
  v_mov_b32 v143, 0
  s_waitcnt vmcnt(0)
  s_mov_b64 exec, 3
  buffer_store_dwordx2 v[10:11], v14, s[28:31], 0 offen sc1
  s_mov_b64 exec, -1
  s_mov_b32 s44, 0
  s_mov_b32 s45, 7168
  s_mov_b32 s46, 14336
  s_mov_b32 s47, 21504
  s_mov_b32 s48, 114688
  s_mov_b32 s49, 121856
  s_mov_b32 s50, 129024
  s_mov_b32 s51, 136192
  s_mov_b32 s52, 229376
  s_mov_b32 s53, 236544
  s_mov_b32 s54, 243712
  s_mov_b32 s55, 250880
  s_mov_b32 s56, 344064
  s_mov_b32 s57, 351232
  s_mov_b32 s58, 358400
  s_mov_b32 s59, 365568
  s_mov_b32 s60, 0
  s_mov_b32 s61, 0
  s_barrier
  ds_read_b128 a[16:19], v7 offset:0
  ds_read_b128 a[0:3], v5 offset:0
  ds_read_b128 a[4:7], v5 offset:2048
  ds_read_b128 a[8:11], v5 offset:4096
  ds_read_b128 a[12:15], v5 offset:6144
  ds_read_b128 a[20:23], v7 offset:256
  ds_read_b128 a[24:27], v7 offset:512
  ds_read_b128 a[28:31], v7 offset:768
  ds_read_b128 a[32:35], v7 offset:1024
  ds_read_b128 a[36:39], v7 offset:1280
  ds_read_b128 a[40:43], v7 offset:1536
  ds_read_b128 a[44:47], v7 offset:1792
  s_cmp_eq_u32 s38, 0
  s_cbranch_scc0 L_c0
  s_lshl_b32 s3, s2, 6
  s_add_u32 s3, s3, 9441280
  v_mov_b32 v12, s3
  s_mov_b64 exec, 1
  buffer_store_dwordx2 v[10:11], v12, s[28:31], 0 offen sc1
  s_mov_b64 exec, -1
L_c0:
  s_waitcnt lgkmcnt(0)
.p2align 6
L_c:
  v_mfma_f32_16x16x32_bf16 v[16:19], a[0:3], a[16:19], v[16:19]
  v_mfma_f32_16x16x32_bf16 v[48:51], a[4:7], a[16:19], v[48:51]
  s_add_u32 s60, s60, 49152
  ds_read_b128 a[64:67], v7 offset:8192
  v_mfma_f32_16x16x32_bf16 v[80:83], a[8:11], a[16:19], v[80:83]
  v_mfma_f32_16x16x32_bf16 v[112:115], a[12:15], a[16:19], v[112:115]
  s_cmp_eq_u32 s60, 147456
  ds_read_b128 a[48:51], v6 offset:0
  v_mfma_f32_16x16x32_bf16 v[20:23], a[0:3], a[20:23], v[20:23]
  v_mfma_f32_16x16x32_bf16 v[52:55], a[4:7], a[20:23], v[52:55]
  s_cselect_b32 s60, 0, s60
  s_add_u32 s61, s61, 1
  ds_read_b128 a[52:55], v6 offset:2048
  v_mfma_f32_16x16x32_bf16 v[84:87], a[8:11], a[20:23], v[84:87]
  v_mfma_f32_16x16x32_bf16 v[116:119], a[12:15], a[20:23], v[116:119]
  ds_read_b128 a[56:59], v6 offset:4096
  v_mfma_f32_16x16x32_bf16 v[24:27], a[0:3], a[24:27], v[24:27]
  v_mfma_f32_16x16x32_bf16 v[56:59], a[4:7], a[24:27], v[56:59]
  ds_read_b128 a[60:63], v6 offset:6144
  v_mfma_f32_16x16x32_bf16 v[88:91], a[8:11], a[24:27], v[88:91]
  v_mfma_f32_16x16x32_bf16 v[120:123], a[12:15], a[24:27], v[120:123]
  ds_read_b128 a[68:71], v7 offset:8448
  v_mfma_f32_16x16x32_bf16 v[28:31], a[0:3], a[28:31], v[28:31]
  v_mfma_f32_16x16x32_bf16 v[60:63], a[4:7], a[28:31], v[60:63]
  ds_read_b128 a[72:75], v7 offset:8704
  v_mfma_f32_16x16x32_bf16 v[92:95], a[8:11], a[28:31], v[92:95]
  v_mfma_f32_16x16x32_bf16 v[124:127], a[12:15], a[28:31], v[124:127]
  ds_read_b128 a[76:79], v7 offset:8960
  v_mfma_f32_16x16x32_bf16 v[32:35], a[0:3], a[32:35], v[32:35]
  v_mfma_f32_16x16x32_bf16 v[64:67], a[4:7], a[32:35], v[64:67]
  ds_read_b128 a[80:83], v7 offset:9216
  v_mfma_f32_16x16x32_bf16 v[96:99], a[8:11], a[32:35], v[96:99]
  v_mfma_f32_16x16x32_bf16 v[128:131], a[12:15], a[32:35], v[128:131]
  ds_read_b128 a[84:87], v7 offset:9472
  v_mfma_f32_16x16x32_bf16 v[36:39], a[0:3], a[36:39], v[36:39]
  v_mfma_f32_16x16x32_bf16 v[68:71], a[4:7], a[36:39], v[68:71]
  ds_read_b128 a[88:91], v7 offset:9728
  v_mfma_f32_16x16x32_bf16 v[100:103], a[8:11], a[36:39], v[100:103]
  v_mfma_f32_16x16x32_bf16 v[132:135], a[12:15], a[36:39], v[132:135]
  ds_read_b128 a[92:95], v7 offset:9984
  v_mfma_f32_16x16x32_bf16 v[40:43], a[0:3], a[40:43], v[40:43]
  v_mfma_f32_16x16x32_bf16 v[72:75], a[4:7], a[40:43], v[72:75]
  v_mfma_f32_16x16x32_bf16 v[104:107], a[8:11], a[40:43], v[104:107]
  v_mfma_f32_16x16x32_bf16 v[136:139], a[12:15], a[40:43], v[136:139]
  v_mfma_f32_16x16x32_bf16 v[44:47], a[0:3], a[44:47], v[44:47]
  v_mfma_f32_16x16x32_bf16 v[76:79], a[4:7], a[44:47], v[76:79]
  v_mfma_f32_16x16x32_bf16 v[108:111], a[8:11], a[44:47], v[108:111]
  v_mfma_f32_16x16x32_bf16 v[140:143], a[12:15], a[44:47], v[140:143]
  s_waitcnt lgkmcnt(0)
  s_barrier
  v_mfma_f32_16x16x32_bf16 v[16:19], a[48:51], a[64:67], v[16:19]
  v_add_u32 v7, s60, v146
  v_add_u32 v5, s60, v144
  v_mfma_f32_16x16x32_bf16 v[48:51], a[52:55], a[64:67], v[48:51]
  ds_read_b128 a[16:19], v7 offset:0
  v_mfma_f32_16x16x32_bf16 v[80:83], a[56:59], a[64:67], v[80:83]
  v_add_u32 v6, s60, v145
  s_cmp_lt_u32 s61, 12
  v_mfma_f32_16x16x32_bf16 v[112:115], a[60:63], a[64:67], v[112:115]
  ds_read_b128 a[0:3], v5 offset:0
  v_mfma_f32_16x16x32_bf16 v[20:23], a[48:51], a[68:71], v[20:23]
  v_mfma_f32_16x16x32_bf16 v[52:55], a[52:55], a[68:71], v[52:55]
  ds_read_b128 a[4:7], v5 offset:2048
  v_mfma_f32_16x16x32_bf16 v[84:87], a[56:59], a[68:71], v[84:87]
  v_mfma_f32_16x16x32_bf16 v[116:119], a[60:63], a[68:71], v[116:119]
  ds_read_b128 a[8:11], v5 offset:4096
  v_mfma_f32_16x16x32_bf16 v[24:27], a[48:51], a[72:75], v[24:27]
  v_mfma_f32_16x16x32_bf16 v[56:59], a[52:55], a[72:75], v[56:59]
  ds_read_b128 a[12:15], v5 offset:6144
  v_mfma_f32_16x16x32_bf16 v[88:91], a[56:59], a[72:75], v[88:91]
  v_mfma_f32_16x16x32_bf16 v[120:123], a[60:63], a[72:75], v[120:123]
  ds_read_b128 a[20:23], v7 offset:256
  v_mfma_f32_16x16x32_bf16 v[28:31], a[48:51], a[76:79], v[28:31]
  v_mfma_f32_16x16x32_bf16 v[60:63], a[52:55], a[76:79], v[60:63]
  ds_read_b128 a[24:27], v7 offset:512
  v_mfma_f32_16x16x32_bf16 v[92:95], a[56:59], a[76:79], v[92:95]
  v_mfma_f32_16x16x32_bf16 v[124:127], a[60:63], a[76:79], v[124:127]
  ds_read_b128 a[28:31], v7 offset:768
  v_mfma_f32_16x16x32_bf16 v[32:35], a[48:51], a[80:83], v[32:35]
  v_mfma_f32_16x16x32_bf16 v[64:67], a[52:55], a[80:83], v[64:67]
  ds_read_b128 a[32:35], v7 offset:1024
  v_mfma_f32_16x16x32_bf16 v[96:99], a[56:59], a[80:83], v[96:99]
  v_mfma_f32_16x16x32_bf16 v[128:131], a[60:63], a[80:83], v[128:131]
  ds_read_b128 a[36:39], v7 offset:1280
  v_mfma_f32_16x16x32_bf16 v[36:39], a[48:51], a[84:87], v[36:39]
  v_mfma_f32_16x16x32_bf16 v[68:71], a[52:55], a[84:87], v[68:71]
  ds_read_b128 a[40:43], v7 offset:1536
  v_mfma_f32_16x16x32_bf16 v[100:103], a[56:59], a[84:87], v[100:103]
  v_mfma_f32_16x16x32_bf16 v[132:135], a[60:63], a[84:87], v[132:135]
  ds_read_b128 a[44:47], v7 offset:1792
  v_mfma_f32_16x16x32_bf16 v[40:43], a[48:51], a[88:91], v[40:43]
  v_mfma_f32_16x16x32_bf16 v[72:75], a[52:55], a[88:91], v[72:75]
  v_mfma_f32_16x16x32_bf16 v[104:107], a[56:59], a[88:91], v[104:107]
  v_mfma_f32_16x16x32_bf16 v[136:139], a[60:63], a[88:91], v[136:139]
  v_mfma_f32_16x16x32_bf16 v[44:47], a[48:51], a[92:95], v[44:47]
  v_mfma_f32_16x16x32_bf16 v[76:79], a[52:55], a[92:95], v[76:79]
  v_mfma_f32_16x16x32_bf16 v[108:111], a[56:59], a[92:95], v[108:111]
  v_mfma_f32_16x16x32_bf16 v[140:143], a[60:63], a[92:95], v[140:143]
  s_waitcnt lgkmcnt(0)
  s_cbranch_scc1 L_c
  v_mfma_f32_16x16x32_bf16 v[16:19], a[0:3], a[16:19], v[16:19]
  v_mfma_f32_16x16x32_bf16 v[48:51], a[4:7], a[16:19], v[48:51]
  ds_read_b128 a[64:67], v7 offset:8192
  v_mfma_f32_16x16x32_bf16 v[80:83], a[8:11], a[16:19], v[80:83]
  v_add_u32 v8, 49152, v144
  v_mfma_f32_16x16x32_bf16 v[112:115], a[12:15], a[16:19], v[112:115]
  ds_read_b128 a[48:51], v6 offset:0
  v_mfma_f32_16x16x32_bf16 v[20:23], a[0:3], a[20:23], v[20:23]
  v_add_u32 v9, 49152, v145
  v_mfma_f32_16x16x32_bf16 v[52:55], a[4:7], a[20:23], v[52:55]
  ds_read_b128 a[52:55], v6 offset:2048
  v_mfma_f32_16x16x32_bf16 v[84:87], a[8:11], a[20:23], v[84:87]
  v_add_u32 v10, 49152, v146
  v_mfma_f32_16x16x32_bf16 v[116:119], a[12:15], a[20:23], v[116:119]
  ds_read_b128 a[56:59], v6 offset:4096
  v_mfma_f32_16x16x32_bf16 v[24:27], a[0:3], a[24:27], v[24:27]
  v_add_u32 v11, 98304, v144
  v_mfma_f32_16x16x32_bf16 v[56:59], a[4:7], a[24:27], v[56:59]
  ds_read_b128 a[60:63], v6 offset:6144
  v_mfma_f32_16x16x32_bf16 v[88:91], a[8:11], a[24:27], v[88:91]
  v_add_u32 v12, 98304, v145
  v_mfma_f32_16x16x32_bf16 v[120:123], a[12:15], a[24:27], v[120:123]
  ds_read_b128 a[68:71], v7 offset:8448
  v_mfma_f32_16x16x32_bf16 v[28:31], a[0:3], a[28:31], v[28:31]
  v_add_u32 v13, 98304, v146
  v_mfma_f32_16x16x32_bf16 v[60:63], a[4:7], a[28:31], v[60:63]
  ds_read_b128 a[72:75], v7 offset:8704
  v_mfma_f32_16x16x32_bf16 v[92:95], a[8:11], a[28:31], v[92:95]
  v_mfma_f32_16x16x32_bf16 v[124:127], a[12:15], a[28:31], v[124:127]
  ds_read_b128 a[76:79], v7 offset:8960
  v_mfma_f32_16x16x32_bf16 v[32:35], a[0:3], a[32:35], v[32:35]
  v_mfma_f32_16x16x32_bf16 v[64:67], a[4:7], a[32:35], v[64:67]
  ds_read_b128 a[80:83], v7 offset:9216
  v_mfma_f32_16x16x32_bf16 v[96:99], a[8:11], a[32:35], v[96:99]
  v_mfma_f32_16x16x32_bf16 v[128:131], a[12:15], a[32:35], v[128:131]
  ds_read_b128 a[84:87], v7 offset:9472
  v_mfma_f32_16x16x32_bf16 v[36:39], a[0:3], a[36:39], v[36:39]
  v_mfma_f32_16x16x32_bf16 v[68:71], a[4:7], a[36:39], v[68:71]
  ds_read_b128 a[88:91], v7 offset:9728
  v_mfma_f32_16x16x32_bf16 v[100:103], a[8:11], a[36:39], v[100:103]
  v_mfma_f32_16x16x32_bf16 v[132:135], a[12:15], a[36:39], v[132:135]
  ds_read_b128 a[92:95], v7 offset:9984
  v_mfma_f32_16x16x32_bf16 v[40:43], a[0:3], a[40:43], v[40:43]
  v_mfma_f32_16x16x32_bf16 v[72:75], a[4:7], a[40:43], v[72:75]
  v_mfma_f32_16x16x32_bf16 v[104:107], a[8:11], a[40:43], v[104:107]
  v_mfma_f32_16x16x32_bf16 v[136:139], a[12:15], a[40:43], v[136:139]
  v_mfma_f32_16x16x32_bf16 v[44:47], a[0:3], a[44:47], v[44:47]
  v_mfma_f32_16x16x32_bf16 v[76:79], a[4:7], a[44:47], v[76:79]
  v_mfma_f32_16x16x32_bf16 v[108:111], a[8:11], a[44:47], v[108:111]
  v_mfma_f32_16x16x32_bf16 v[140:143], a[12:15], a[44:47], v[140:143]
  s_waitcnt lgkmcnt(0)
  s_barrier
  v_mfma_f32_16x16x32_bf16 v[16:19], a[48:51], a[64:67], v[16:19]
  v_mfma_f32_16x16x32_bf16 v[48:51], a[52:55], a[64:67], v[48:51]
  ds_read_b128 a[16:19], v10 offset:0
  v_mfma_f32_16x16x32_bf16 v[80:83], a[56:59], a[64:67], v[80:83]
  v_mfma_f32_16x16x32_bf16 v[112:115], a[60:63], a[64:67], v[112:115]
  ds_read_b128 a[0:3], v8 offset:0
  v_mfma_f32_16x16x32_bf16 v[20:23], a[48:51], a[68:71], v[20:23]
  v_mfma_f32_16x16x32_bf16 v[52:55], a[52:55], a[68:71], v[52:55]
  ds_read_b128 a[4:7], v8 offset:2048
  v_mfma_f32_16x16x32_bf16 v[84:87], a[56:59], a[68:71], v[84:87]
  v_mfma_f32_16x16x32_bf16 v[116:119], a[60:63], a[68:71], v[116:119]
  ds_read_b128 a[20:23], v10 offset:256
  v_mfma_f32_16x16x32_bf16 v[24:27], a[48:51], a[72:75], v[24:27]
  v_mfma_f32_16x16x32_bf16 v[56:59], a[52:55], a[72:75], v[56:59]
  ds_read_b128 a[24:27], v10 offset:512
  v_mfma_f32_16x16x32_bf16 v[88:91], a[56:59], a[72:75], v[88:91]
  v_mfma_f32_16x16x32_bf16 v[120:123], a[60:63], a[72:75], v[120:123]
  ds_read_b128 a[28:31], v10 offset:768
  v_mfma_f32_16x16x32_bf16 v[28:31], a[48:51], a[76:79], v[28:31]
  v_mfma_f32_16x16x32_bf16 v[60:63], a[52:55], a[76:79], v[60:63]
  ds_read_b128 a[32:35], v10 offset:1024
  v_mfma_f32_16x16x32_bf16 v[92:95], a[56:59], a[76:79], v[92:95]
  v_mfma_f32_16x16x32_bf16 v[124:127], a[60:63], a[76:79], v[124:127]
  ds_read_b128 a[36:39], v10 offset:1280
  v_mfma_f32_16x16x32_bf16 v[32:35], a[48:51], a[80:83], v[32:35]
  v_mfma_f32_16x16x32_bf16 v[64:67], a[52:55], a[80:83], v[64:67]
  ds_read_b128 a[40:43], v10 offset:1536
  v_mfma_f32_16x16x32_bf16 v[96:99], a[56:59], a[80:83], v[96:99]
  v_mfma_f32_16x16x32_bf16 v[128:131], a[60:63], a[80:83], v[128:131]
  ds_read_b128 a[44:47], v10 offset:1792
  v_mfma_f32_16x16x32_bf16 v[36:39], a[48:51], a[84:87], v[36:39]
  v_mfma_f32_16x16x32_bf16 v[68:71], a[52:55], a[84:87], v[68:71]
  v_mfma_f32_16x16x32_bf16 v[100:103], a[56:59], a[84:87], v[100:103]
  v_mfma_f32_16x16x32_bf16 v[132:135], a[60:63], a[84:87], v[132:135]
  v_mfma_f32_16x16x32_bf16 v[40:43], a[48:51], a[88:91], v[40:43]
  v_mfma_f32_16x16x32_bf16 v[72:75], a[52:55], a[88:91], v[72:75]
  v_mfma_f32_16x16x32_bf16 v[104:107], a[56:59], a[88:91], v[104:107]
  v_mfma_f32_16x16x32_bf16 v[136:139], a[60:63], a[88:91], v[136:139]
  v_mfma_f32_16x16x32_bf16 v[44:47], a[48:51], a[92:95], v[44:47]
  v_mfma_f32_16x16x32_bf16 v[76:79], a[52:55], a[92:95], v[76:79]
  v_mfma_f32_16x16x32_bf16 v[108:111], a[56:59], a[92:95], v[108:111]
  v_mfma_f32_16x16x32_bf16 v[140:143], a[60:63], a[92:95], v[140:143]
  s_waitcnt lgkmcnt(0)
  s_nop 0
  v_mfma_f32_16x16x32_bf16 v[16:19], a[0:3], a[16:19], v[16:19]
  ds_read_b128 a[64:67], v10 offset:8192
  v_mfma_f32_16x16x32_bf16 v[48:51], a[4:7], a[16:19], v[48:51]
  ds_read_b128 a[48:51], v9 offset:0
  v_mfma_f32_16x16x32_bf16 v[20:23], a[0:3], a[20:23], v[20:23]
  ds_read_b128 a[52:55], v9 offset:2048
  v_mfma_f32_16x16x32_bf16 v[52:55], a[4:7], a[20:23], v[52:55]
  ds_read_b128 a[68:71], v10 offset:8448
  v_mfma_f32_16x16x32_bf16 v[24:27], a[0:3], a[24:27], v[24:27]
  ds_read_b128 a[72:75], v10 offset:8704
  v_mfma_f32_16x16x32_bf16 v[56:59], a[4:7], a[24:27], v[56:59]
  ds_read_b128 a[76:79], v10 offset:8960
  v_mfma_f32_16x16x32_bf16 v[28:31], a[0:3], a[28:31], v[28:31]
  ds_read_b128 a[80:83], v10 offset:9216
  v_mfma_f32_16x16x32_bf16 v[60:63], a[4:7], a[28:31], v[60:63]
  ds_read_b128 a[84:87], v10 offset:9472
  v_mfma_f32_16x16x32_bf16 v[32:35], a[0:3], a[32:35], v[32:35]
  ds_read_b128 a[88:91], v10 offset:9728
  v_mfma_f32_16x16x32_bf16 v[64:67], a[4:7], a[32:35], v[64:67]
  ds_read_b128 a[92:95], v10 offset:9984
  v_mfma_f32_16x16x32_bf16 v[36:39], a[0:3], a[36:39], v[36:39]
  v_mfma_f32_16x16x32_bf16 v[68:71], a[4:7], a[36:39], v[68:71]
  v_mfma_f32_16x16x32_bf16 v[40:43], a[0:3], a[40:43], v[40:43]
  v_mfma_f32_16x16x32_bf16 v[72:75], a[4:7], a[40:43], v[72:75]
  v_mfma_f32_16x16x32_bf16 v[44:47], a[0:3], a[44:47], v[44:47]
  v_mfma_f32_16x16x32_bf16 v[76:79], a[4:7], a[44:47], v[76:79]
  s_waitcnt lgkmcnt(0)
  s_barrier
  v_mfma_f32_16x16x32_bf16 v[16:19], a[48:51], a[64:67], v[16:19]
  ds_read_b128 a[16:19], v13 offset:0
  v_mfma_f32_16x16x32_bf16 v[48:51], a[52:55], a[64:67], v[48:51]
  ds_read_b128 a[0:3], v11 offset:0
  v_mfma_f32_16x16x32_bf16 v[20:23], a[48:51], a[68:71], v[20:23]
  ds_read_b128 a[4:7], v11 offset:2048
  v_mfma_f32_16x16x32_bf16 v[52:55], a[52:55], a[68:71], v[52:55]
  ds_read_b128 a[20:23], v13 offset:256
  v_mfma_f32_16x16x32_bf16 v[24:27], a[48:51], a[72:75], v[24:27]
  ds_read_b128 a[24:27], v13 offset:512
  v_mfma_f32_16x16x32_bf16 v[56:59], a[52:55], a[72:75], v[56:59]
  ds_read_b128 a[28:31], v13 offset:768
  v_mfma_f32_16x16x32_bf16 v[28:31], a[48:51], a[76:79], v[28:31]
  ds_read_b128 a[32:35], v13 offset:1024
  v_mfma_f32_16x16x32_bf16 v[60:63], a[52:55], a[76:79], v[60:63]
  ds_read_b128 a[36:39], v13 offset:1280
  v_mfma_f32_16x16x32_bf16 v[32:35], a[48:51], a[80:83], v[32:35]
  ds_read_b128 a[40:43], v13 offset:1536
  v_mfma_f32_16x16x32_bf16 v[64:67], a[52:55], a[80:83], v[64:67]
  ds_read_b128 a[44:47], v13 offset:1792
  v_mfma_f32_16x16x32_bf16 v[36:39], a[48:51], a[84:87], v[36:39]
  v_mfma_f32_16x16x32_bf16 v[68:71], a[52:55], a[84:87], v[68:71]
  v_mfma_f32_16x16x32_bf16 v[40:43], a[48:51], a[88:91], v[40:43]
  v_mfma_f32_16x16x32_bf16 v[72:75], a[52:55], a[88:91], v[72:75]
  v_mfma_f32_16x16x32_bf16 v[44:47], a[48:51], a[92:95], v[44:47]
  v_mfma_f32_16x16x32_bf16 v[76:79], a[52:55], a[92:95], v[76:79]
  s_waitcnt lgkmcnt(0)
  s_nop 0
  v_mfma_f32_16x16x32_bf16 v[16:19], a[0:3], a[16:19], v[16:19]
  ds_read_b128 a[64:67], v13 offset:8192
  v_mfma_f32_16x16x32_bf16 v[48:51], a[4:7], a[16:19], v[48:51]
  ds_read_b128 a[48:51], v12 offset:0
  v_mfma_f32_16x16x32_bf16 v[20:23], a[0:3], a[20:23], v[20:23]
  ds_read_b128 a[52:55], v12 offset:2048
  v_mfma_f32_16x16x32_bf16 v[52:55], a[4:7], a[20:23], v[52:55]
  ds_read_b128 a[68:71], v13 offset:8448
  v_mfma_f32_16x16x32_bf16 v[24:27], a[0:3], a[24:27], v[24:27]
  ds_read_b128 a[72:75], v13 offset:8704
  v_mfma_f32_16x16x32_bf16 v[56:59], a[4:7], a[24:27], v[56:59]
  ds_read_b128 a[76:79], v13 offset:8960
  v_mfma_f32_16x16x32_bf16 v[28:31], a[0:3], a[28:31], v[28:31]
  ds_read_b128 a[80:83], v13 offset:9216
  v_mfma_f32_16x16x32_bf16 v[60:63], a[4:7], a[28:31], v[60:63]
  ds_read_b128 a[84:87], v13 offset:9472
  v_mfma_f32_16x16x32_bf16 v[32:35], a[0:3], a[32:35], v[32:35]
  ds_read_b128 a[88:91], v13 offset:9728
  v_mfma_f32_16x16x32_bf16 v[64:67], a[4:7], a[32:35], v[64:67]
  ds_read_b128 a[92:95], v13 offset:9984
  v_mfma_f32_16x16x32_bf16 v[36:39], a[0:3], a[36:39], v[36:39]
  v_mfma_f32_16x16x32_bf16 v[68:71], a[4:7], a[36:39], v[68:71]
  v_mfma_f32_16x16x32_bf16 v[40:43], a[0:3], a[40:43], v[40:43]
  v_mfma_f32_16x16x32_bf16 v[72:75], a[4:7], a[40:43], v[72:75]
  v_mfma_f32_16x16x32_bf16 v[44:47], a[0:3], a[44:47], v[44:47]
  v_mfma_f32_16x16x32_bf16 v[76:79], a[4:7], a[44:47], v[76:79]
  s_waitcnt lgkmcnt(0)
  s_barrier
  v_mfma_f32_16x16x32_bf16 v[16:19], a[48:51], a[64:67], v[16:19]
  ds_read_b128 a[16:19], v146 offset:0
  v_mfma_f32_16x16x32_bf16 v[48:51], a[52:55], a[64:67], v[48:51]
  ds_read_b128 a[0:3], v144 offset:0
  v_mfma_f32_16x16x32_bf16 v[20:23], a[48:51], a[68:71], v[20:23]
  ds_read_b128 a[4:7], v144 offset:2048
  v_mfma_f32_16x16x32_bf16 v[52:55], a[52:55], a[68:71], v[52:55]
  ds_read_b128 a[20:23], v146 offset:256
  v_mfma_f32_16x16x32_bf16 v[24:27], a[48:51], a[72:75], v[24:27]
  ds_read_b128 a[24:27], v146 offset:512
  v_mfma_f32_16x16x32_bf16 v[56:59], a[52:55], a[72:75], v[56:59]
  ds_read_b128 a[28:31], v146 offset:768
  v_mfma_f32_16x16x32_bf16 v[28:31], a[48:51], a[76:79], v[28:31]
  ds_read_b128 a[32:35], v146 offset:1024
  v_mfma_f32_16x16x32_bf16 v[60:63], a[52:55], a[76:79], v[60:63]
  ds_read_b128 a[36:39], v146 offset:1280
  v_mfma_f32_16x16x32_bf16 v[32:35], a[48:51], a[80:83], v[32:35]
  ds_read_b128 a[40:43], v146 offset:1536
  v_mfma_f32_16x16x32_bf16 v[64:67], a[52:55], a[80:83], v[64:67]
  ds_read_b128 a[44:47], v146 offset:1792
  v_mfma_f32_16x16x32_bf16 v[36:39], a[48:51], a[84:87], v[36:39]
  v_mfma_f32_16x16x32_bf16 v[68:71], a[52:55], a[84:87], v[68:71]
  v_mfma_f32_16x16x32_bf16 v[40:43], a[48:51], a[88:91], v[40:43]
  v_mfma_f32_16x16x32_bf16 v[72:75], a[52:55], a[88:91], v[72:75]
  v_mfma_f32_16x16x32_bf16 v[44:47], a[48:51], a[92:95], v[44:47]
  v_mfma_f32_16x16x32_bf16 v[76:79], a[52:55], a[92:95], v[76:79]
  s_waitcnt lgkmcnt(0)
  s_nop 0
  v_mfma_f32_16x16x32_bf16 v[16:19], a[0:3], a[16:19], v[16:19]
  ds_read_b128 a[64:67], v146 offset:8192
  v_mfma_f32_16x16x32_bf16 v[48:51], a[4:7], a[16:19], v[48:51]
  ds_read_b128 a[48:51], v145 offset:0
  v_mfma_f32_16x16x32_bf16 v[20:23], a[0:3], a[20:23], v[20:23]
  ds_read_b128 a[52:55], v145 offset:2048
  v_mfma_f32_16x16x32_bf16 v[52:55], a[4:7], a[20:23], v[52:55]
  ds_read_b128 a[68:71], v146 offset:8448
  v_mfma_f32_16x16x32_bf16 v[24:27], a[0:3], a[24:27], v[24:27]
  ds_read_b128 a[72:75], v146 offset:8704
  v_mfma_f32_16x16x32_bf16 v[56:59], a[4:7], a[24:27], v[56:59]
  ds_read_b128 a[76:79], v146 offset:8960
  v_mfma_f32_16x16x32_bf16 v[28:31], a[0:3], a[28:31], v[28:31]
  ds_read_b128 a[80:83], v146 offset:9216
  v_mfma_f32_16x16x32_bf16 v[60:63], a[4:7], a[28:31], v[60:63]
  ds_read_b128 a[84:87], v146 offset:9472
  v_mfma_f32_16x16x32_bf16 v[32:35], a[0:3], a[32:35], v[32:35]
  ds_read_b128 a[88:91], v146 offset:9728
  v_mfma_f32_16x16x32_bf16 v[64:67], a[4:7], a[32:35], v[64:67]
  ds_read_b128 a[92:95], v146 offset:9984
  v_mfma_f32_16x16x32_bf16 v[36:39], a[0:3], a[36:39], v[36:39]
  v_mfma_f32_16x16x32_bf16 v[68:71], a[4:7], a[36:39], v[68:71]
  v_mfma_f32_16x16x32_bf16 v[40:43], a[0:3], a[40:43], v[40:43]
  v_mfma_f32_16x16x32_bf16 v[72:75], a[4:7], a[40:43], v[72:75]
  v_mfma_f32_16x16x32_bf16 v[44:47], a[0:3], a[44:47], v[44:47]
  v_mfma_f32_16x16x32_bf16 v[76:79], a[4:7], a[44:47], v[76:79]
  s_waitcnt lgkmcnt(0)
  s_nop 0
  v_mfma_f32_16x16x32_bf16 v[16:19], a[48:51], a[64:67], v[16:19]
  ds_read_b128 a[16:19], v10 offset:0
  v_mfma_f32_16x16x32_bf16 v[20:23], a[48:51], a[68:71], v[20:23]
  ds_read_b128 a[8:11], v8 offset:4096
  v_mfma_f32_16x16x32_bf16 v[24:27], a[48:51], a[72:75], v[24:27]
  ds_read_b128 a[12:15], v8 offset:6144
  v_mfma_f32_16x16x32_bf16 v[28:31], a[48:51], a[76:79], v[28:31]
  ds_read_b128 a[20:23], v10 offset:256
  v_mfma_f32_16x16x32_bf16 v[32:35], a[48:51], a[80:83], v[32:35]
  ds_read_b128 a[24:27], v10 offset:512
  v_mfma_f32_16x16x32_bf16 v[36:39], a[48:51], a[84:87], v[36:39]
  ds_read_b128 a[28:31], v10 offset:768
  v_mfma_f32_16x16x32_bf16 v[40:43], a[48:51], a[88:91], v[40:43]
  ds_read_b128 a[32:35], v10 offset:1024
  v_mfma_f32_16x16x32_bf16 v[44:47], a[48:51], a[92:95], v[44:47]
  ds_read_b128 a[36:39], v10 offset:1280
  v_mfma_f32_16x16x32_bf16 v[48:51], a[52:55], a[64:67], v[48:51]
  ds_read_b128 a[40:43], v10 offset:1536
  v_mfma_f32_16x16x32_bf16 v[52:55], a[52:55], a[68:71], v[52:55]
  ds_read_b128 a[44:47], v10 offset:1792
  v_mfma_f32_16x16x32_bf16 v[56:59], a[52:55], a[72:75], v[56:59]
  v_mfma_f32_16x16x32_bf16 v[60:63], a[52:55], a[76:79], v[60:63]
  v_mfma_f32_16x16x32_bf16 v[64:67], a[52:55], a[80:83], v[64:67]
  v_mfma_f32_16x16x32_bf16 v[68:71], a[52:55], a[84:87], v[68:71]
  v_mfma_f32_16x16x32_bf16 v[72:75], a[52:55], a[88:91], v[72:75]
  v_mfma_f32_16x16x32_bf16 v[76:79], a[52:55], a[92:95], v[76:79]
  s_waitcnt lgkmcnt(0)
  s_nop 0
  v_mfma_f32_16x16x32_bf16 v[80:83], a[8:11], a[16:19], v[80:83]
  ds_read_b128 a[64:67], v10 offset:8192
  v_mfma_f32_16x16x32_bf16 v[112:115], a[12:15], a[16:19], v[112:115]
  ds_read_b128 a[56:59], v9 offset:4096
  v_mfma_f32_16x16x32_bf16 v[84:87], a[8:11], a[20:23], v[84:87]
  ds_read_b128 a[60:63], v9 offset:6144
  v_cvt_pk_bf16_f32 v148, v16, v20
  v_mfma_f32_16x16x32_bf16 v[116:119], a[12:15], a[20:23], v[116:119]
  ds_read_b128 a[68:71], v10 offset:8448
  v_cvt_pk_bf16_f32 v149, v24, v28
  v_mfma_f32_16x16x32_bf16 v[88:91], a[8:11], a[24:27], v[88:91]
  ds_read_b128 a[72:75], v10 offset:8704
  v_cvt_pk_bf16_f32 v150, v32, v36
  v_mfma_f32_16x16x32_bf16 v[120:123], a[12:15], a[24:27], v[120:123]
  ds_read_b128 a[76:79], v10 offset:8960
  v_cvt_pk_bf16_f32 v151, v40, v44
  v_mfma_f32_16x16x32_bf16 v[92:95], a[8:11], a[28:31], v[92:95]
  ds_read_b128 a[80:83], v10 offset:9216
  v_mfma_f32_16x16x32_bf16 v[124:127], a[12:15], a[28:31], v[124:127]
  ds_read_b128 a[84:87], v10 offset:9472
  buffer_store_dwordx4 v[148:151], v147, s[32:35], s44 offen sc0 sc1
  v_mfma_f32_16x16x32_bf16 v[96:99], a[8:11], a[32:35], v[96:99]
  ds_read_b128 a[88:91], v10 offset:9728
  v_cvt_pk_bf16_f32 v152, v17, v21
  v_mfma_f32_16x16x32_bf16 v[128:131], a[12:15], a[32:35], v[128:131]
  ds_read_b128 a[92:95], v10 offset:9984
  v_cvt_pk_bf16_f32 v153, v25, v29
  v_mfma_f32_16x16x32_bf16 v[100:103], a[8:11], a[36:39], v[100:103]
  v_mfma_f32_16x16x32_bf16 v[132:135], a[12:15], a[36:39], v[132:135]
  v_cvt_pk_bf16_f32 v154, v33, v37
  v_mfma_f32_16x16x32_bf16 v[104:107], a[8:11], a[40:43], v[104:107]
  v_cvt_pk_bf16_f32 v155, v41, v45
  v_mfma_f32_16x16x32_bf16 v[136:139], a[12:15], a[40:43], v[136:139]
  buffer_store_dwordx4 v[152:155], v147, s[32:35], s45 offen sc0 sc1
  v_mfma_f32_16x16x32_bf16 v[108:111], a[8:11], a[44:47], v[108:111]
  v_mfma_f32_16x16x32_bf16 v[140:143], a[12:15], a[44:47], v[140:143]
  s_waitcnt lgkmcnt(0)
  s_nop 0
  v_mfma_f32_16x16x32_bf16 v[80:83], a[56:59], a[64:67], v[80:83]
  ds_read_b128 a[16:19], v13 offset:0
  v_mfma_f32_16x16x32_bf16 v[112:115], a[60:63], a[64:67], v[112:115]
  ds_read_b128 a[8:11], v11 offset:4096
  v_cvt_pk_bf16_f32 v156, v18, v22
  v_mfma_f32_16x16x32_bf16 v[84:87], a[56:59], a[68:71], v[84:87]
  ds_read_b128 a[12:15], v11 offset:6144
  v_cvt_pk_bf16_f32 v157, v26, v30
  v_mfma_f32_16x16x32_bf16 v[116:119], a[60:63], a[68:71], v[116:119]
  ds_read_b128 a[20:23], v13 offset:256
  v_mfma_f32_16x16x32_bf16 v[88:91], a[56:59], a[72:75], v[88:91]
  ds_read_b128 a[24:27], v13 offset:512
  v_cvt_pk_bf16_f32 v158, v34, v38
  v_mfma_f32_16x16x32_bf16 v[120:123], a[60:63], a[72:75], v[120:123]
  ds_read_b128 a[28:31], v13 offset:768
  v_cvt_pk_bf16_f32 v159, v42, v46
  v_mfma_f32_16x16x32_bf16 v[92:95], a[56:59], a[76:79], v[92:95]
  ds_read_b128 a[32:35], v13 offset:1024
  v_mfma_f32_16x16x32_bf16 v[124:127], a[60:63], a[76:79], v[124:127]
  ds_read_b128 a[36:39], v13 offset:1280
  buffer_store_dwordx4 v[156:159], v147, s[32:35], s46 offen sc0 sc1
  v_mfma_f32_16x16x32_bf16 v[96:99], a[56:59], a[80:83], v[96:99]
  ds_read_b128 a[40:43], v13 offset:1536
  v_cvt_pk_bf16_f32 v148, v19, v23
  v_mfma_f32_16x16x32_bf16 v[128:131], a[60:63], a[80:83], v[128:131]
  ds_read_b128 a[44:47], v13 offset:1792
  v_mfma_f32_16x16x32_bf16 v[100:103], a[56:59], a[84:87], v[100:103]
  v_cvt_pk_bf16_f32 v149, v27, v31
  v_mfma_f32_16x16x32_bf16 v[132:135], a[60:63], a[84:87], v[132:135]
  v_cvt_pk_bf16_f32 v150, v35, v39
  v_mfma_f32_16x16x32_bf16 v[104:107], a[56:59], a[88:91], v[104:107]
  v_mfma_f32_16x16x32_bf16 v[136:139], a[60:63], a[88:91], v[136:139]
  v_cvt_pk_bf16_f32 v151, v43, v47
  v_mfma_f32_16x16x32_bf16 v[108:111], a[56:59], a[92:95], v[108:111]
  buffer_store_dwordx4 v[148:151], v147, s[32:35], s47 offen sc0 sc1
  v_mfma_f32_16x16x32_bf16 v[140:143], a[60:63], a[92:95], v[140:143]
  s_waitcnt lgkmcnt(0)
  s_nop 0
  v_mfma_f32_16x16x32_bf16 v[80:83], a[8:11], a[16:19], v[80:83]
  ds_read_b128 a[64:67], v13 offset:8192
  v_mfma_f32_16x16x32_bf16 v[112:115], a[12:15], a[16:19], v[112:115]
  ds_read_b128 a[56:59], v12 offset:4096
  v_cvt_pk_bf16_f32 v152, v48, v52
  v_mfma_f32_16x16x32_bf16 v[84:87], a[8:11], a[20:23], v[84:87]
  ds_read_b128 a[60:63], v12 offset:6144
  v_cvt_pk_bf16_f32 v153, v56, v60
  v_mfma_f32_16x16x32_bf16 v[116:119], a[12:15], a[20:23], v[116:119]
  ds_read_b128 a[68:71], v13 offset:8448
  v_mfma_f32_16x16x32_bf16 v[88:91], a[8:11], a[24:27], v[88:91]
  ds_read_b128 a[72:75], v13 offset:8704
  v_cvt_pk_bf16_f32 v154, v64, v68
  v_mfma_f32_16x16x32_bf16 v[120:123], a[12:15], a[24:27], v[120:123]
  ds_read_b128 a[76:79], v13 offset:8960
  v_cvt_pk_bf16_f32 v155, v72, v76
  v_mfma_f32_16x16x32_bf16 v[92:95], a[8:11], a[28:31], v[92:95]
  ds_read_b128 a[80:83], v13 offset:9216
  v_mfma_f32_16x16x32_bf16 v[124:127], a[12:15], a[28:31], v[124:127]
  ds_read_b128 a[84:87], v13 offset:9472
  buffer_store_dwordx4 v[152:155], v147, s[32:35], s48 offen sc0 sc1
  v_mfma_f32_16x16x32_bf16 v[96:99], a[8:11], a[32:35], v[96:99]
  ds_read_b128 a[88:91], v13 offset:9728
  v_cvt_pk_bf16_f32 v156, v49, v53
  v_mfma_f32_16x16x32_bf16 v[128:131], a[12:15], a[32:35], v[128:131]
  ds_read_b128 a[92:95], v13 offset:9984
  v_mfma_f32_16x16x32_bf16 v[100:103], a[8:11], a[36:39], v[100:103]
  v_cvt_pk_bf16_f32 v157, v57, v61
  v_mfma_f32_16x16x32_bf16 v[132:135], a[12:15], a[36:39], v[132:135]
  v_cvt_pk_bf16_f32 v158, v65, v69
  v_mfma_f32_16x16x32_bf16 v[104:107], a[8:11], a[40:43], v[104:107]
  v_mfma_f32_16x16x32_bf16 v[136:139], a[12:15], a[40:43], v[136:139]
  v_cvt_pk_bf16_f32 v159, v73, v77
  v_mfma_f32_16x16x32_bf16 v[108:111], a[8:11], a[44:47], v[108:111]
  buffer_store_dwordx4 v[156:159], v147, s[32:35], s49 offen sc0 sc1
  v_mfma_f32_16x16x32_bf16 v[140:143], a[12:15], a[44:47], v[140:143]
  s_waitcnt lgkmcnt(0)
  s_nop 0
  v_mfma_f32_16x16x32_bf16 v[80:83], a[56:59], a[64:67], v[80:83]
  ds_read_b128 a[16:19], v146 offset:0
  v_mfma_f32_16x16x32_bf16 v[112:115], a[60:63], a[64:67], v[112:115]
  ds_read_b128 a[8:11], v144 offset:4096
  v_cvt_pk_bf16_f32 v148, v50, v54
  v_mfma_f32_16x16x32_bf16 v[84:87], a[56:59], a[68:71], v[84:87]
  ds_read_b128 a[12:15], v144 offset:6144
  v_cvt_pk_bf16_f32 v149, v58, v62
  v_mfma_f32_16x16x32_bf16 v[116:119], a[60:63], a[68:71], v[116:119]
  ds_read_b128 a[20:23], v146 offset:256
  v_mfma_f32_16x16x32_bf16 v[88:91], a[56:59], a[72:75], v[88:91]
  ds_read_b128 a[24:27], v146 offset:512
  v_cvt_pk_bf16_f32 v150, v66, v70
  v_mfma_f32_16x16x32_bf16 v[120:123], a[60:63], a[72:75], v[120:123]
  ds_read_b128 a[28:31], v146 offset:768
  v_cvt_pk_bf16_f32 v151, v74, v78
  v_mfma_f32_16x16x32_bf16 v[92:95], a[56:59], a[76:79], v[92:95]
  ds_read_b128 a[32:35], v146 offset:1024
  v_mfma_f32_16x16x32_bf16 v[124:127], a[60:63], a[76:79], v[124:127]
  ds_read_b128 a[36:39], v146 offset:1280
  buffer_store_dwordx4 v[148:151], v147, s[32:35], s50 offen sc0 sc1
  v_mfma_f32_16x16x32_bf16 v[96:99], a[56:59], a[80:83], v[96:99]
  ds_read_b128 a[40:43], v146 offset:1536
  v_cvt_pk_bf16_f32 v152, v51, v55
  v_mfma_f32_16x16x32_bf16 v[128:131], a[60:63], a[80:83], v[128:131]
  ds_read_b128 a[44:47], v146 offset:1792
  v_mfma_f32_16x16x32_bf16 v[100:103], a[56:59], a[84:87], v[100:103]
  v_cvt_pk_bf16_f32 v153, v59, v63
  v_mfma_f32_16x16x32_bf16 v[132:135], a[60:63], a[84:87], v[132:135]
  v_cvt_pk_bf16_f32 v154, v67, v71
  v_mfma_f32_16x16x32_bf16 v[104:107], a[56:59], a[88:91], v[104:107]
  v_mfma_f32_16x16x32_bf16 v[136:139], a[60:63], a[88:91], v[136:139]
  v_cvt_pk_bf16_f32 v155, v75, v79
  v_mfma_f32_16x16x32_bf16 v[108:111], a[56:59], a[92:95], v[108:111]
  buffer_store_dwordx4 v[152:155], v147, s[32:35], s51 offen sc0 sc1
  v_mfma_f32_16x16x32_bf16 v[140:143], a[60:63], a[92:95], v[140:143]
  s_waitcnt lgkmcnt(0)
  s_nop 0
  v_mfma_f32_16x16x32_bf16 v[80:83], a[8:11], a[16:19], v[80:83]
  ds_read_b128 a[64:67], v146 offset:8192
  v_mfma_f32_16x16x32_bf16 v[112:115], a[12:15], a[16:19], v[112:115]
  ds_read_b128 a[56:59], v145 offset:4096
  v_mfma_f32_16x16x32_bf16 v[84:87], a[8:11], a[20:23], v[84:87]
  ds_read_b128 a[60:63], v145 offset:6144
  v_mfma_f32_16x16x32_bf16 v[116:119], a[12:15], a[20:23], v[116:119]
  ds_read_b128 a[68:71], v146 offset:8448
  v_mfma_f32_16x16x32_bf16 v[88:91], a[8:11], a[24:27], v[88:91]
  ds_read_b128 a[72:75], v146 offset:8704
  v_mfma_f32_16x16x32_bf16 v[120:123], a[12:15], a[24:27], v[120:123]
  ds_read_b128 a[76:79], v146 offset:8960
  v_mfma_f32_16x16x32_bf16 v[92:95], a[8:11], a[28:31], v[92:95]
  ds_read_b128 a[80:83], v146 offset:9216
  v_mfma_f32_16x16x32_bf16 v[124:127], a[12:15], a[28:31], v[124:127]
  ds_read_b128 a[84:87], v146 offset:9472
  v_mfma_f32_16x16x32_bf16 v[96:99], a[8:11], a[32:35], v[96:99]
  ds_read_b128 a[88:91], v146 offset:9728
  v_mfma_f32_16x16x32_bf16 v[128:131], a[12:15], a[32:35], v[128:131]
  ds_read_b128 a[92:95], v146 offset:9984
  v_mfma_f32_16x16x32_bf16 v[100:103], a[8:11], a[36:39], v[100:103]
  v_mfma_f32_16x16x32_bf16 v[132:135], a[12:15], a[36:39], v[132:135]
  v_mfma_f32_16x16x32_bf16 v[104:107], a[8:11], a[40:43], v[104:107]
  v_mfma_f32_16x16x32_bf16 v[136:139], a[12:15], a[40:43], v[136:139]
  v_mfma_f32_16x16x32_bf16 v[108:111], a[8:11], a[44:47], v[108:111]
  v_mfma_f32_16x16x32_bf16 v[140:143], a[12:15], a[44:47], v[140:143]
  s_waitcnt lgkmcnt(0)
  s_nop 0
  v_mfma_f32_16x16x32_bf16 v[80:83], a[56:59], a[64:67], v[80:83]
  v_mfma_f32_16x16x32_bf16 v[84:87], a[56:59], a[68:71], v[84:87]
  v_mfma_f32_16x16x32_bf16 v[88:91], a[56:59], a[72:75], v[88:91]
  v_mfma_f32_16x16x32_bf16 v[92:95], a[56:59], a[76:79], v[92:95]
  v_mfma_f32_16x16x32_bf16 v[96:99], a[56:59], a[80:83], v[96:99]
  v_mfma_f32_16x16x32_bf16 v[100:103], a[56:59], a[84:87], v[100:103]
  v_mfma_f32_16x16x32_bf16 v[104:107], a[56:59], a[88:91], v[104:107]
  v_mfma_f32_16x16x32_bf16 v[108:111], a[56:59], a[92:95], v[108:111]
  v_mfma_f32_16x16x32_bf16 v[112:115], a[60:63], a[64:67], v[112:115]
  v_mfma_f32_16x16x32_bf16 v[116:119], a[60:63], a[68:71], v[116:119]
  v_mfma_f32_16x16x32_bf16 v[120:123], a[60:63], a[72:75], v[120:123]
  v_mfma_f32_16x16x32_bf16 v[124:127], a[60:63], a[76:79], v[124:127]
  v_mfma_f32_16x16x32_bf16 v[128:131], a[60:63], a[80:83], v[128:131]
  v_mfma_f32_16x16x32_bf16 v[132:135], a[60:63], a[84:87], v[132:135]
  v_mfma_f32_16x16x32_bf16 v[136:139], a[60:63], a[88:91], v[136:139]
  v_mfma_f32_16x16x32_bf16 v[140:143], a[60:63], a[92:95], v[140:143]
  v_cvt_pk_bf16_f32 v156, v80, v84
  v_cvt_pk_bf16_f32 v157, v88, v92
  v_cvt_pk_bf16_f32 v158, v96, v100
  v_cvt_pk_bf16_f32 v159, v104, v108
  buffer_store_dwordx4 v[156:159], v147, s[32:35], s52 offen sc0 sc1
  v_cvt_pk_bf16_f32 v148, v81, v85
  v_cvt_pk_bf16_f32 v149, v89, v93
  v_cvt_pk_bf16_f32 v150, v97, v101
  v_cvt_pk_bf16_f32 v151, v105, v109
  buffer_store_dwordx4 v[148:151], v147, s[32:35], s53 offen sc0 sc1
  v_cvt_pk_bf16_f32 v152, v82, v86
  v_cvt_pk_bf16_f32 v153, v90, v94
  v_cvt_pk_bf16_f32 v154, v98, v102
  v_cvt_pk_bf16_f32 v155, v106, v110
  buffer_store_dwordx4 v[152:155], v147, s[32:35], s54 offen sc0 sc1
  v_cvt_pk_bf16_f32 v156, v83, v87
  v_cvt_pk_bf16_f32 v157, v91, v95
  v_cvt_pk_bf16_f32 v158, v99, v103
  v_cvt_pk_bf16_f32 v159, v107, v111
  buffer_store_dwordx4 v[156:159], v147, s[32:35], s55 offen sc0 sc1
  v_cvt_pk_bf16_f32 v148, v112, v116
  v_cvt_pk_bf16_f32 v149, v120, v124
  v_cvt_pk_bf16_f32 v150, v128, v132
  v_cvt_pk_bf16_f32 v151, v136, v140
  buffer_store_dwordx4 v[148:151], v147, s[32:35], s56 offen sc0 sc1
  v_cvt_pk_bf16_f32 v152, v113, v117
  v_cvt_pk_bf16_f32 v153, v121, v125
  v_cvt_pk_bf16_f32 v154, v129, v133
  v_cvt_pk_bf16_f32 v155, v137, v141
  buffer_store_dwordx4 v[152:155], v147, s[32:35], s57 offen sc0 sc1
  v_cvt_pk_bf16_f32 v156, v114, v118
  v_cvt_pk_bf16_f32 v157, v122, v126
  v_cvt_pk_bf16_f32 v158, v130, v134
  v_cvt_pk_bf16_f32 v159, v138, v142
  buffer_store_dwordx4 v[156:159], v147, s[32:35], s58 offen sc0 sc1
  v_cvt_pk_bf16_f32 v148, v115, v119
  v_cvt_pk_bf16_f32 v149, v123, v127
  v_cvt_pk_bf16_f32 v150, v131, v135
  v_cvt_pk_bf16_f32 v151, v139, v143
  buffer_store_dwordx4 v[148:151], v147, s[32:35], s59 offen sc0 sc1
  s_endpgm
L_loader:
  s_waitcnt vmcnt(0)
  s_mov_b64 exec, 3
  buffer_store_dwordx2 v[10:11], v14, s[28:31], 0 offen sc1
  s_mov_b64 exec, -1
  s_add_u32 s58, s40, 2
  s_lshl_b32 s58, s58, 7
  s_load_dword s68, s[12:13], s58 offset:0
  s_load_dword s69, s[12:13], s58 offset:64
  s_load_dword s70, s[12:13], s58 offset:2048
  s_load_dword s71, s[12:13], s58 offset:2112
  s_load_dword s72, s[12:13], s58 offset:4096
  s_load_dword s73, s[12:13], s58 offset:4160
  s_add_u32 s58, s40, 3
  s_lshl_b32 s58, s58, 7
  s_load_dword s68, s[12:13], s58 offset:0
  s_load_dword s69, s[12:13], s58 offset:64
  s_load_dword s70, s[12:13], s58 offset:2048
  s_load_dword s71, s[12:13], s58 offset:2112
  s_load_dword s72, s[12:13], s58 offset:4096
  s_load_dword s73, s[12:13], s58 offset:4160
  s_barrier
  s_add_u32 s43, s40, 0
  s_lshl_b32 s43, s43, 10
  s_load_dwordx4 s[64:67], s[4:5], s43 glc
  s_add_u32 s41, s40, 0
  s_lshl_b32 s41, s41, 7
  s_add_u32 m0, s60, 49152
  s_nop 0
  buffer_load_dwordx4 v16, s[16:19], s41 offen offset:0 lds
  buffer_load_dwordx4 v17, s[16:19], s41 offen offset:1024 lds
  buffer_load_dwordx4 v18, s[16:19], s41 offen offset:2048 lds
  buffer_load_dwordx4 v19, s[16:19], s41 offen offset:3072 lds
  s_add_u32 m0, s60, 53248
  s_add_u32 s41, s41, 65536
  buffer_load_dwordx4 v16, s[16:19], s41 offen offset:0 lds
  buffer_load_dwordx4 v17, s[16:19], s41 offen offset:1024 lds
  buffer_load_dwordx4 v18, s[16:19], s41 offen offset:2048 lds
  buffer_load_dwordx4 v19, s[16:19], s41 offen offset:3072 lds
  s_mov_b32 s63, 0
L_sp1:
  s_waitcnt lgkmcnt(0)
  s_xor_b64 s[10:11], s[64:65], s[8:9]
  s_xor_b64 s[14:15], s[66:67], s[8:9]
  s_or_b64 s[10:11], s[10:11], s[14:15]
  s_cbranch_scc0 L_ok1
  s_load_dwordx4 s[64:67], s[4:5], s43 glc
  s_add_u32 s63, s63, 1
  s_cmp_lt_u32 s63, 20000
  s_cbranch_scc1 L_sp1
  s_waitcnt lgkmcnt(0)
L_ok1:
  s_add_u32 s43, s40, 1
  s_lshl_b32 s43, s43, 10
  s_load_dwordx4 s[64:67], s[4:5], s43 glc
  s_add_u32 m0, s61, 49152
  s_add_u32 s62, s40, 0
  s_lshl_b32 s62, s62, 14
  buffer_load_dwordx4 v20, s[28:31], s62 offen offset:0 sc1 lds
  buffer_load_dwordx4 v20, s[28:31], s62 offen offset:1024 sc1 lds
  buffer_load_dwordx4 v20, s[28:31], s62 offen offset:2048 sc1 lds
  buffer_load_dwordx4 v20, s[28:31], s62 offen offset:3072 sc1 lds
  s_add_u32 s41, s40, 1
  s_lshl_b32 s41, s41, 7
  s_add_u32 m0, s60, 98304
  s_nop 0
  buffer_load_dwordx4 v16, s[16:19], s41 offen offset:0 lds
  buffer_load_dwordx4 v17, s[16:19], s41 offen offset:1024 lds
  buffer_load_dwordx4 v18, s[16:19], s41 offen offset:2048 lds
  buffer_load_dwordx4 v19, s[16:19], s41 offen offset:3072 lds
  s_add_u32 m0, s60, 102400
  s_add_u32 s41, s41, 65536
  buffer_load_dwordx4 v16, s[16:19], s41 offen offset:0 lds
  buffer_load_dwordx4 v17, s[16:19], s41 offen offset:1024 lds
  buffer_load_dwordx4 v18, s[16:19], s41 offen offset:2048 lds
  buffer_load_dwordx4 v19, s[16:19], s41 offen offset:3072 lds
  s_mov_b32 s63, 0
L_sp2:
  s_waitcnt lgkmcnt(0)
  s_xor_b64 s[10:11], s[64:65], s[8:9]
  s_xor_b64 s[14:15], s[66:67], s[8:9]
  s_or_b64 s[10:11], s[10:11], s[14:15]
  s_cbranch_scc0 L_ok2
  s_load_dwordx4 s[64:67], s[4:5], s43 glc
  s_add_u32 s63, s63, 1
  s_cmp_lt_u32 s63, 20000
  s_cbranch_scc1 L_sp2
  s_waitcnt lgkmcnt(0)
L_ok2:
  s_add_u32 s43, s40, 2
  s_lshl_b32 s43, s43, 10
  s_load_dwordx4 s[64:67], s[4:5], s43 glc
  s_add_u32 m0, s61, 98304
  s_add_u32 s62, s40, 1
  s_lshl_b32 s62, s62, 14
  buffer_load_dwordx4 v20, s[28:31], s62 offen offset:0 sc1 lds
  buffer_load_dwordx4 v20, s[28:31], s62 offen offset:1024 sc1 lds
  buffer_load_dwordx4 v20, s[28:31], s62 offen offset:2048 sc1 lds
  buffer_load_dwordx4 v20, s[28:31], s62 offen offset:3072 sc1 lds
  s_xor_b32 s58, s40, 4
  s_cmp_ge_u32 s58, s36
  s_addc_u32 s58, s58, 0
  s_lshl_b32 s58, s58, 7
  s_load_dword s68, s[12:13], s58 offset:0
  s_load_dword s69, s[12:13], s58 offset:64
  s_load_dword s70, s[12:13], s58 offset:2048
  s_load_dword s71, s[12:13], s58 offset:2112
  s_load_dword s72, s[12:13], s58 offset:4096
  s_load_dword s73, s[12:13], s58 offset:4160
  s_waitcnt vmcnt(12)
  s_barrier
  s_add_u32 s41, s40, 2
  s_lshl_b32 s41, s41, 7
  s_add_u32 m0, s60, 0
  s_nop 0
  buffer_load_dwordx4 v16, s[16:19], s41 offen offset:0 lds
  buffer_load_dwordx4 v17, s[16:19], s41 offen offset:1024 lds
  buffer_load_dwordx4 v18, s[16:19], s41 offen offset:2048 lds
  buffer_load_dwordx4 v19, s[16:19], s41 offen offset:3072 lds
  s_add_u32 m0, s60, 4096
  s_add_u32 s41, s41, 65536
  buffer_load_dwordx4 v16, s[16:19], s41 offen offset:0 lds
  buffer_load_dwordx4 v17, s[16:19], s41 offen offset:1024 lds
  buffer_load_dwordx4 v18, s[16:19], s41 offen offset:2048 lds
  buffer_load_dwordx4 v19, s[16:19], s41 offen offset:3072 lds
  s_mov_b32 s63, 0
L_sp3:
  s_waitcnt lgkmcnt(0)
  s_xor_b64 s[10:11], s[64:65], s[8:9]
  s_xor_b64 s[14:15], s[66:67], s[8:9]
  s_or_b64 s[10:11], s[10:11], s[14:15]
  s_cbranch_scc0 L_ok3
  s_load_dwordx4 s[64:67], s[4:5], s43 glc
  s_add_u32 s63, s63, 1
  s_cmp_lt_u32 s63, 20000
  s_cbranch_scc1 L_sp3
  s_waitcnt lgkmcnt(0)
L_ok3:
  s_add_u32 s43, s40, 3
  s_lshl_b32 s43, s43, 10
  s_load_dwordx4 s[64:67], s[4:5], s43 glc
  s_add_u32 m0, s61, 0
  s_add_u32 s62, s40, 2
  s_lshl_b32 s62, s62, 14
  buffer_load_dwordx4 v20, s[28:31], s62 offen offset:0 sc1 lds
  buffer_load_dwordx4 v20, s[28:31], s62 offen offset:1024 sc1 lds
  buffer_load_dwordx4 v20, s[28:31], s62 offen offset:2048 sc1 lds
  buffer_load_dwordx4 v20, s[28:31], s62 offen offset:3072 sc1 lds
  s_xor_b32 s58, s40, 5
  s_cmp_ge_u32 s58, s36
  s_addc_u32 s58, s58, 0
  s_lshl_b32 s58, s58, 7
  s_load_dword s68, s[12:13], s58 offset:0
  s_load_dword s69, s[12:13], s58 offset:64
  s_load_dword s70, s[12:13], s58 offset:2048
  s_load_dword s71, s[12:13], s58 offset:2112
  s_load_dword s72, s[12:13], s58 offset:4096
  s_load_dword s73, s[12:13], s58 offset:4160
  s_waitcnt vmcnt(12)
  s_barrier
  s_add_u32 s41, s40, 3
  s_lshl_b32 s41, s41, 7
  s_add_u32 m0, s60, 49152
  s_nop 0
  buffer_load_dwordx4 v16, s[16:19], s41 offen offset:0 lds
  buffer_load_dwordx4 v17, s[16:19], s41 offen offset:1024 lds
  buffer_load_dwordx4 v18, s[16:19], s41 offen offset:2048 lds
  buffer_load_dwordx4 v19, s[16:19], s41 offen offset:3072 lds
  s_add_u32 m0, s60, 53248
  s_add_u32 s41, s41, 65536
  buffer_load_dwordx4 v16, s[16:19], s41 offen offset:0 lds
  buffer_load_dwordx4 v17, s[16:19], s41 offen offset:1024 lds
  buffer_load_dwordx4 v18, s[16:19], s41 offen offset:2048 lds
  buffer_load_dwordx4 v19, s[16:19], s41 offen offset:3072 lds
  s_mov_b32 s63, 0
L_sp4:
  s_waitcnt lgkmcnt(0)
  s_xor_b64 s[10:11], s[64:65], s[8:9]
  s_xor_b64 s[14:15], s[66:67], s[8:9]
  s_or_b64 s[10:11], s[10:11], s[14:15]
  s_cbranch_scc0 L_ok4
  s_load_dwordx4 s[64:67], s[4:5], s43 glc
  s_add_u32 s63, s63, 1
  s_cmp_lt_u32 s63, 20000
  s_cbranch_scc1 L_sp4
  s_waitcnt lgkmcnt(0)
L_ok4:
  s_xor_b32 s43, s40, 4
  s_cmp_ge_u32 s43, s36
  s_addc_u32 s43, s43, 0
  s_lshl_b32 s43, s43, 10
  s_load_dwordx4 s[64:67], s[4:5], s43 glc
  s_add_u32 m0, s61, 49152
  s_add_u32 s62, s40, 3
  s_lshl_b32 s62, s62, 14
  buffer_load_dwordx4 v20, s[28:31], s62 offen offset:0 sc1 lds
  buffer_load_dwordx4 v20, s[28:31], s62 offen offset:1024 sc1 lds
  buffer_load_dwordx4 v20, s[28:31], s62 offen offset:2048 sc1 lds
  buffer_load_dwordx4 v20, s[28:31], s62 offen offset:3072 sc1 lds
  s_xor_b32 s58, s40, 6
  s_cmp_ge_u32 s58, s36
  s_addc_u32 s58, s58, 0
  s_lshl_b32 s58, s58, 7
  s_load_dword s68, s[12:13], s58 offset:0
  s_load_dword s69, s[12:13], s58 offset:64
  s_load_dword s70, s[12:13], s58 offset:2048
  s_load_dword s71, s[12:13], s58 offset:2112
  s_load_dword s72, s[12:13], s58 offset:4096
  s_load_dword s73, s[12:13], s58 offset:4160
  s_waitcnt vmcnt(12)
  s_barrier
  s_xor_b32 s41, s40, 4
  s_cmp_ge_u32 s41, s36
  s_addc_u32 s41, s41, 0
  s_lshl_b32 s41, s41, 7
  s_add_u32 m0, s60, 98304
  s_nop 0
  buffer_load_dwordx4 v16, s[16:19], s41 offen offset:0 lds
  buffer_load_dwordx4 v17, s[16:19], s41 offen offset:1024 lds
  buffer_load_dwordx4 v18, s[16:19], s41 offen offset:2048 lds
  buffer_load_dwordx4 v19, s[16:19], s41 offen offset:3072 lds
  s_add_u32 m0, s60, 102400
  s_add_u32 s41, s41, 65536
  buffer_load_dwordx4 v16, s[16:19], s41 offen offset:0 lds
  buffer_load_dwordx4 v17, s[16:19], s41 offen offset:1024 lds
  buffer_load_dwordx4 v18, s[16:19], s41 offen offset:2048 lds
  buffer_load_dwordx4 v19, s[16:19], s41 offen offset:3072 lds
  s_mov_b32 s63, 0
L_sp5:
  s_waitcnt lgkmcnt(0)
  s_xor_b64 s[10:11], s[64:65], s[8:9]
  s_xor_b64 s[14:15], s[66:67], s[8:9]
  s_or_b64 s[10:11], s[10:11], s[14:15]
  s_cbranch_scc0 L_ok5
  s_load_dwordx4 s[64:67], s[4:5], s43 glc
  s_add_u32 s63, s63, 1
  s_cmp_lt_u32 s63, 20000
  s_cbranch_scc1 L_sp5
  s_waitcnt lgkmcnt(0)
L_ok5:
  s_xor_b32 s43, s40, 5
  s_cmp_ge_u32 s43, s36
  s_addc_u32 s43, s43, 0
  s_lshl_b32 s43, s43, 10
  s_load_dwordx4 s[64:67], s[4:5], s43 glc
  s_add_u32 m0, s61, 98304
  s_xor_b32 s62, s40, 4
  s_cmp_ge_u32 s62, s36
  s_addc_u32 s62, s62, 0
  s_lshl_b32 s62, s62, 14
  buffer_load_dwordx4 v20, s[28:31], s62 offen offset:0 sc1 lds
  buffer_load_dwordx4 v20, s[28:31], s62 offen offset:1024 sc1 lds
  buffer_load_dwordx4 v20, s[28:31], s62 offen offset:2048 sc1 lds
  buffer_load_dwordx4 v20, s[28:31], s62 offen offset:3072 sc1 lds
  s_mov_b32 s58, 1024
  s_load_dword s68, s[12:13], s58 offset:0
  s_load_dword s69, s[12:13], s58 offset:64
  s_load_dword s70, s[12:13], s58 offset:2048
  s_load_dword s71, s[12:13], s58 offset:2112
  s_load_dword s72, s[12:13], s58 offset:4096
  s_load_dword s73, s[12:13], s58 offset:4160
  s_waitcnt vmcnt(12)
  s_barrier
  s_xor_b32 s41, s40, 5
  s_cmp_ge_u32 s41, s36
  s_addc_u32 s41, s41, 0
  s_lshl_b32 s41, s41, 7
  s_add_u32 m0, s60, 0
  s_nop 0
  buffer_load_dwordx4 v16, s[16:19], s41 offen offset:0 lds
  buffer_load_dwordx4 v17, s[16:19], s41 offen offset:1024 lds
  buffer_load_dwordx4 v18, s[16:19], s41 offen offset:2048 lds
  buffer_load_dwordx4 v19, s[16:19], s41 offen offset:3072 lds
  s_add_u32 m0, s60, 4096
  s_add_u32 s41, s41, 65536
  buffer_load_dwordx4 v16, s[16:19], s41 offen offset:0 lds
  buffer_load_dwordx4 v17, s[16:19], s41 offen offset:1024 lds
  buffer_load_dwordx4 v18, s[16:19], s41 offen offset:2048 lds
  buffer_load_dwordx4 v19, s[16:19], s41 offen offset:3072 lds
  s_mov_b32 s63, 0
L_sp6:
  s_waitcnt lgkmcnt(0)
  s_xor_b64 s[10:11], s[64:65], s[8:9]
  s_xor_b64 s[14:15], s[66:67], s[8:9]
  s_or_b64 s[10:11], s[10:11], s[14:15]
  s_cbranch_scc0 L_ok6
  s_load_dwordx4 s[64:67], s[4:5], s43 glc
  s_add_u32 s63, s63, 1
  s_cmp_lt_u32 s63, 20000
  s_cbranch_scc1 L_sp6
  s_waitcnt lgkmcnt(0)
L_ok6:
  s_xor_b32 s43, s40, 6
  s_cmp_ge_u32 s43, s36
  s_addc_u32 s43, s43, 0
  s_lshl_b32 s43, s43, 10
  s_load_dwordx4 s[64:67], s[4:5], s43 glc
  s_add_u32 m0, s61, 0
  s_xor_b32 s62, s40, 5
  s_cmp_ge_u32 s62, s36
  s_addc_u32 s62, s62, 0
  s_lshl_b32 s62, s62, 14
  buffer_load_dwordx4 v20, s[28:31], s62 offen offset:0 sc1 lds
  buffer_load_dwordx4 v20, s[28:31], s62 offen offset:1024 sc1 lds
  buffer_load_dwordx4 v20, s[28:31], s62 offen offset:2048 sc1 lds
  buffer_load_dwordx4 v20, s[28:31], s62 offen offset:3072 sc1 lds
  s_mov_b32 s58, 1152
  s_load_dword s68, s[12:13], s58 offset:0
  s_load_dword s69, s[12:13], s58 offset:64
  s_load_dword s70, s[12:13], s58 offset:2048
  s_load_dword s71, s[12:13], s58 offset:2112
  s_load_dword s72, s[12:13], s58 offset:4096
  s_load_dword s73, s[12:13], s58 offset:4160
  s_waitcnt vmcnt(12)
  s_barrier
  s_xor_b32 s41, s40, 6
  s_cmp_ge_u32 s41, s36
  s_addc_u32 s41, s41, 0
  s_lshl_b32 s41, s41, 7
  s_add_u32 m0, s60, 49152
  s_nop 0
  buffer_load_dwordx4 v16, s[16:19], s41 offen offset:0 lds
  buffer_load_dwordx4 v17, s[16:19], s41 offen offset:1024 lds
  buffer_load_dwordx4 v18, s[16:19], s41 offen offset:2048 lds
  buffer_load_dwordx4 v19, s[16:19], s41 offen offset:3072 lds
  s_add_u32 m0, s60, 53248
  s_add_u32 s41, s41, 65536
  buffer_load_dwordx4 v16, s[16:19], s41 offen offset:0 lds
  buffer_load_dwordx4 v17, s[16:19], s41 offen offset:1024 lds
  buffer_load_dwordx4 v18, s[16:19], s41 offen offset:2048 lds
  buffer_load_dwordx4 v19, s[16:19], s41 offen offset:3072 lds
  s_mov_b32 s63, 0
L_sp7:
  s_waitcnt lgkmcnt(0)
  s_xor_b64 s[10:11], s[64:65], s[8:9]
  s_xor_b64 s[14:15], s[66:67], s[8:9]
  s_or_b64 s[10:11], s[10:11], s[14:15]
  s_cbranch_scc0 L_ok7
  s_load_dwordx4 s[64:67], s[4:5], s43 glc
  s_add_u32 s63, s63, 1
  s_cmp_lt_u32 s63, 20000
  s_cbranch_scc1 L_sp7
  s_waitcnt lgkmcnt(0)
L_ok7:
  s_mov_b32 s43, 8192
  s_load_dwordx4 s[64:67], s[4:5], s43 glc
  s_add_u32 m0, s61, 49152
  s_xor_b32 s62, s40, 6
  s_cmp_ge_u32 s62, s36
  s_addc_u32 s62, s62, 0
  s_lshl_b32 s62, s62, 14
  buffer_load_dwordx4 v20, s[28:31], s62 offen offset:0 sc1 lds
  buffer_load_dwordx4 v20, s[28:31], s62 offen offset:1024 sc1 lds
  buffer_load_dwordx4 v20, s[28:31], s62 offen offset:2048 sc1 lds
  buffer_load_dwordx4 v20, s[28:31], s62 offen offset:3072 sc1 lds
  s_mov_b32 s58, 1280
  s_load_dword s68, s[12:13], s58 offset:0
  s_load_dword s69, s[12:13], s58 offset:64
  s_load_dword s70, s[12:13], s58 offset:2048
  s_load_dword s71, s[12:13], s58 offset:2112
  s_load_dword s72, s[12:13], s58 offset:4096
  s_load_dword s73, s[12:13], s58 offset:4160
  s_waitcnt vmcnt(12)
  s_barrier
  s_mov_b32 s41, 1024
  s_add_u32 m0, s60, 98304
  s_nop 0
  buffer_load_dwordx4 v16, s[16:19], s41 offen offset:0 lds
  buffer_load_dwordx4 v17, s[16:19], s41 offen offset:1024 lds
  buffer_load_dwordx4 v18, s[16:19], s41 offen offset:2048 lds
  buffer_load_dwordx4 v19, s[16:19], s41 offen offset:3072 lds
  s_add_u32 m0, s60, 102400
  s_add_u32 s41, s41, 65536
  buffer_load_dwordx4 v16, s[16:19], s41 offen offset:0 lds
  buffer_load_dwordx4 v17, s[16:19], s41 offen offset:1024 lds
  buffer_load_dwordx4 v18, s[16:19], s41 offen offset:2048 lds
  buffer_load_dwordx4 v19, s[16:19], s41 offen offset:3072 lds
  s_mov_b32 s63, 0
L_sp8:
  s_waitcnt lgkmcnt(0)
  s_xor_b64 s[10:11], s[64:65], s[8:9]
  s_xor_b64 s[14:15], s[66:67], s[8:9]
  s_or_b64 s[10:11], s[10:11], s[14:15]
  s_cbranch_scc0 L_ok8
  s_load_dwordx4 s[64:67], s[4:5], s43 glc
  s_add_u32 s63, s63, 1
  s_cmp_lt_u32 s63, 20000
  s_cbranch_scc1 L_sp8
  s_waitcnt lgkmcnt(0)
L_ok8:
  s_mov_b32 s43, 9216
  s_load_dwordx4 s[64:67], s[4:5], s43 glc
  s_add_u32 m0, s61, 98304
  s_mov_b32 s62, 131072
  buffer_load_dwordx4 v20, s[28:31], s62 offen offset:0 sc1 lds
  buffer_load_dwordx4 v20, s[28:31], s62 offen offset:1024 sc1 lds
  buffer_load_dwordx4 v20, s[28:31], s62 offen offset:2048 sc1 lds
  buffer_load_dwordx4 v20, s[28:31], s62 offen offset:3072 sc1 lds
  s_mov_b32 s58, 1408
  s_load_dword s68, s[12:13], s58 offset:0
  s_load_dword s69, s[12:13], s58 offset:64
  s_load_dword s70, s[12:13], s58 offset:2048
  s_load_dword s71, s[12:13], s58 offset:2112
  s_load_dword s72, s[12:13], s58 offset:4096
  s_load_dword s73, s[12:13], s58 offset:4160
  s_waitcnt vmcnt(12)
  s_barrier
  s_mov_b32 s41, 1152
  s_add_u32 m0, s60, 0
  s_nop 0
  buffer_load_dwordx4 v16, s[16:19], s41 offen offset:0 lds
  buffer_load_dwordx4 v17, s[16:19], s41 offen offset:1024 lds
  buffer_load_dwordx4 v18, s[16:19], s41 offen offset:2048 lds
  buffer_load_dwordx4 v19, s[16:19], s41 offen offset:3072 lds
  s_add_u32 m0, s60, 4096
  s_add_u32 s41, s41, 65536
  buffer_load_dwordx4 v16, s[16:19], s41 offen offset:0 lds
  buffer_load_dwordx4 v17, s[16:19], s41 offen offset:1024 lds
  buffer_load_dwordx4 v18, s[16:19], s41 offen offset:2048 lds
  buffer_load_dwordx4 v19, s[16:19], s41 offen offset:3072 lds
  s_mov_b32 s63, 0
L_sp9:
  s_waitcnt lgkmcnt(0)
  s_xor_b64 s[10:11], s[64:65], s[8:9]
  s_xor_b64 s[14:15], s[66:67], s[8:9]
  s_or_b64 s[10:11], s[10:11], s[14:15]
  s_cbranch_scc0 L_ok9
  s_load_dwordx4 s[64:67], s[4:5], s43 glc
  s_add_u32 s63, s63, 1
  s_cmp_lt_u32 s63, 20000
  s_cbranch_scc1 L_sp9
  s_waitcnt lgkmcnt(0)
L_ok9:
  s_mov_b32 s43, 10240
  s_load_dwordx4 s[64:67], s[4:5], s43 glc
  s_add_u32 m0, s61, 0
  s_mov_b32 s62, 147456
  buffer_load_dwordx4 v20, s[28:31], s62 offen offset:0 sc1 lds
  buffer_load_dwordx4 v20, s[28:31], s62 offen offset:1024 sc1 lds
  buffer_load_dwordx4 v20, s[28:31], s62 offen offset:2048 sc1 lds
  buffer_load_dwordx4 v20, s[28:31], s62 offen offset:3072 sc1 lds
  s_mov_b32 s58, 1536
  s_load_dword s68, s[12:13], s58 offset:0
  s_load_dword s69, s[12:13], s58 offset:64
  s_load_dword s70, s[12:13], s58 offset:2048
  s_load_dword s71, s[12:13], s58 offset:2112
  s_load_dword s72, s[12:13], s58 offset:4096
  s_load_dword s73, s[12:13], s58 offset:4160
  s_waitcnt vmcnt(12)
  s_barrier
  s_mov_b32 s41, 1280
  s_add_u32 m0, s60, 49152
  s_nop 0
  buffer_load_dwordx4 v16, s[16:19], s41 offen offset:0 lds
  buffer_load_dwordx4 v17, s[16:19], s41 offen offset:1024 lds
  buffer_load_dwordx4 v18, s[16:19], s41 offen offset:2048 lds
  buffer_load_dwordx4 v19, s[16:19], s41 offen offset:3072 lds
  s_add_u32 m0, s60, 53248
  s_add_u32 s41, s41, 65536
  buffer_load_dwordx4 v16, s[16:19], s41 offen offset:0 lds
  buffer_load_dwordx4 v17, s[16:19], s41 offen offset:1024 lds
  buffer_load_dwordx4 v18, s[16:19], s41 offen offset:2048 lds
  buffer_load_dwordx4 v19, s[16:19], s41 offen offset:3072 lds
  s_mov_b32 s63, 0
L_sp10:
  s_waitcnt lgkmcnt(0)
  s_xor_b64 s[10:11], s[64:65], s[8:9]
  s_xor_b64 s[14:15], s[66:67], s[8:9]
  s_or_b64 s[10:11], s[10:11], s[14:15]
  s_cbranch_scc0 L_ok10
  s_load_dwordx4 s[64:67], s[4:5], s43 glc
  s_add_u32 s63, s63, 1
  s_cmp_lt_u32 s63, 20000
  s_cbranch_scc1 L_sp10
  s_waitcnt lgkmcnt(0)
L_ok10:
  s_mov_b32 s43, 11264
  s_load_dwordx4 s[64:67], s[4:5], s43 glc
  s_add_u32 m0, s61, 49152
  s_mov_b32 s62, 163840
  buffer_load_dwordx4 v20, s[28:31], s62 offen offset:0 sc1 lds
  buffer_load_dwordx4 v20, s[28:31], s62 offen offset:1024 sc1 lds
  buffer_load_dwordx4 v20, s[28:31], s62 offen offset:2048 sc1 lds
  buffer_load_dwordx4 v20, s[28:31], s62 offen offset:3072 sc1 lds
  s_mov_b32 s58, 1664
  s_load_dword s68, s[12:13], s58 offset:0
  s_load_dword s69, s[12:13], s58 offset:64
  s_load_dword s70, s[12:13], s58 offset:2048
  s_load_dword s71, s[12:13], s58 offset:2112
  s_load_dword s72, s[12:13], s58 offset:4096
  s_load_dword s73, s[12:13], s58 offset:4160
  s_waitcnt vmcnt(12)
  s_barrier
  s_mov_b32 s41, 1408
  s_add_u32 m0, s60, 98304
  s_nop 0
  buffer_load_dwordx4 v16, s[16:19], s41 offen offset:0 lds
  buffer_load_dwordx4 v17, s[16:19], s41 offen offset:1024 lds
  buffer_load_dwordx4 v18, s[16:19], s41 offen offset:2048 lds
  buffer_load_dwordx4 v19, s[16:19], s41 offen offset:3072 lds
  s_add_u32 m0, s60, 102400
  s_add_u32 s41, s41, 65536
  buffer_load_dwordx4 v16, s[16:19], s41 offen offset:0 lds
  buffer_load_dwordx4 v17, s[16:19], s41 offen offset:1024 lds
  buffer_load_dwordx4 v18, s[16:19], s41 offen offset:2048 lds
  buffer_load_dwordx4 v19, s[16:19], s41 offen offset:3072 lds
  s_mov_b32 s63, 0
L_sp11:
  s_waitcnt lgkmcnt(0)
  s_xor_b64 s[10:11], s[64:65], s[8:9]
  s_xor_b64 s[14:15], s[66:67], s[8:9]
  s_or_b64 s[10:11], s[10:11], s[14:15]
  s_cbranch_scc0 L_ok11
  s_load_dwordx4 s[64:67], s[4:5], s43 glc
  s_add_u32 s63, s63, 1
  s_cmp_lt_u32 s63, 20000
  s_cbranch_scc1 L_sp11
  s_waitcnt lgkmcnt(0)
L_ok11:
  s_mov_b32 s43, 12288
  s_load_dwordx4 s[64:67], s[4:5], s43 glc
  s_add_u32 m0, s61, 98304
  s_mov_b32 s62, 180224
  buffer_load_dwordx4 v20, s[28:31], s62 offen offset:0 sc1 lds
  buffer_load_dwordx4 v20, s[28:31], s62 offen offset:1024 sc1 lds
  buffer_load_dwordx4 v20, s[28:31], s62 offen offset:2048 sc1 lds
  buffer_load_dwordx4 v20, s[28:31], s62 offen offset:3072 sc1 lds
  s_mov_b32 s58, 1792
  s_load_dword s68, s[12:13], s58 offset:0
  s_load_dword s69, s[12:13], s58 offset:64
  s_load_dword s70, s[12:13], s58 offset:2048
  s_load_dword s71, s[12:13], s58 offset:2112
  s_load_dword s72, s[12:13], s58 offset:4096
  s_load_dword s73, s[12:13], s58 offset:4160
  s_waitcnt vmcnt(12)
  s_barrier
  s_mov_b32 s41, 1536
  s_add_u32 m0, s60, 0
  s_nop 0
  buffer_load_dwordx4 v16, s[16:19], s41 offen offset:0 lds
  buffer_load_dwordx4 v17, s[16:19], s41 offen offset:1024 lds
  buffer_load_dwordx4 v18, s[16:19], s41 offen offset:2048 lds
  buffer_load_dwordx4 v19, s[16:19], s41 offen offset:3072 lds
  s_add_u32 m0, s60, 4096
  s_add_u32 s41, s41, 65536
  buffer_load_dwordx4 v16, s[16:19], s41 offen offset:0 lds
  buffer_load_dwordx4 v17, s[16:19], s41 offen offset:1024 lds
  buffer_load_dwordx4 v18, s[16:19], s41 offen offset:2048 lds
  buffer_load_dwordx4 v19, s[16:19], s41 offen offset:3072 lds
  s_mov_b32 s63, 0
L_sp12:
  s_waitcnt lgkmcnt(0)
  s_xor_b64 s[10:11], s[64:65], s[8:9]
  s_xor_b64 s[14:15], s[66:67], s[8:9]
  s_or_b64 s[10:11], s[10:11], s[14:15]
  s_cbranch_scc0 L_ok12
  s_load_dwordx4 s[64:67], s[4:5], s43 glc
  s_add_u32 s63, s63, 1
  s_cmp_lt_u32 s63, 20000
  s_cbranch_scc1 L_sp12
  s_waitcnt lgkmcnt(0)
L_ok12:
  s_mov_b32 s43, 13312
  s_load_dwordx4 s[64:67], s[4:5], s43 glc
  s_add_u32 m0, s61, 0
  s_mov_b32 s62, 196608
  buffer_load_dwordx4 v20, s[28:31], s62 offen offset:0 sc1 lds
  buffer_load_dwordx4 v20, s[28:31], s62 offen offset:1024 sc1 lds
  buffer_load_dwordx4 v20, s[28:31], s62 offen offset:2048 sc1 lds
  buffer_load_dwordx4 v20, s[28:31], s62 offen offset:3072 sc1 lds
  s_mov_b32 s58, 1920
  s_load_dword s68, s[12:13], s58 offset:0
  s_load_dword s69, s[12:13], s58 offset:64
  s_load_dword s70, s[12:13], s58 offset:2048
  s_load_dword s71, s[12:13], s58 offset:2112
  s_load_dword s72, s[12:13], s58 offset:4096
  s_load_dword s73, s[12:13], s58 offset:4160
  s_waitcnt vmcnt(12)
  s_barrier
  s_mov_b32 s41, 1664
  s_add_u32 m0, s60, 49152
  s_nop 0
  buffer_load_dwordx4 v16, s[16:19], s41 offen offset:0 lds
  buffer_load_dwordx4 v17, s[16:19], s41 offen offset:1024 lds
  buffer_load_dwordx4 v18, s[16:19], s41 offen offset:2048 lds
  buffer_load_dwordx4 v19, s[16:19], s41 offen offset:3072 lds
  s_add_u32 m0, s60, 53248
  s_add_u32 s41, s41, 65536
  buffer_load_dwordx4 v16, s[16:19], s41 offen offset:0 lds
  buffer_load_dwordx4 v17, s[16:19], s41 offen offset:1024 lds
  buffer_load_dwordx4 v18, s[16:19], s41 offen offset:2048 lds
  buffer_load_dwordx4 v19, s[16:19], s41 offen offset:3072 lds
  s_mov_b32 s63, 0
L_sp13:
  s_waitcnt lgkmcnt(0)
  s_xor_b64 s[10:11], s[64:65], s[8:9]
  s_xor_b64 s[14:15], s[66:67], s[8:9]
  s_or_b64 s[10:11], s[10:11], s[14:15]
  s_cbranch_scc0 L_ok13
  s_load_dwordx4 s[64:67], s[4:5], s43 glc
  s_add_u32 s63, s63, 1
  s_cmp_lt_u32 s63, 20000
  s_cbranch_scc1 L_sp13
  s_waitcnt lgkmcnt(0)
L_ok13:
  s_mov_b32 s43, 14336
  s_load_dwordx4 s[64:67], s[4:5], s43 glc
  s_add_u32 m0, s61, 49152
  s_mov_b32 s62, 212992
  buffer_load_dwordx4 v20, s[28:31], s62 offen offset:0 sc1 lds
  buffer_load_dwordx4 v20, s[28:31], s62 offen offset:1024 sc1 lds
  buffer_load_dwordx4 v20, s[28:31], s62 offen offset:2048 sc1 lds
  buffer_load_dwordx4 v20, s[28:31], s62 offen offset:3072 sc1 lds
  s_waitcnt vmcnt(12)
  s_barrier
  s_mov_b32 s41, 1792
  s_add_u32 m0, s60, 98304
  s_nop 0
  buffer_load_dwordx4 v16, s[16:19], s41 offen offset:0 lds
  buffer_load_dwordx4 v17, s[16:19], s41 offen offset:1024 lds
  buffer_load_dwordx4 v18, s[16:19], s41 offen offset:2048 lds
  buffer_load_dwordx4 v19, s[16:19], s41 offen offset:3072 lds
  s_add_u32 m0, s60, 102400
  s_add_u32 s41, s41, 65536
  buffer_load_dwordx4 v16, s[16:19], s41 offen offset:0 lds
  buffer_load_dwordx4 v17, s[16:19], s41 offen offset:1024 lds
  buffer_load_dwordx4 v18, s[16:19], s41 offen offset:2048 lds
  buffer_load_dwordx4 v19, s[16:19], s41 offen offset:3072 lds
  s_mov_b32 s63, 0
L_sp14:
  s_waitcnt lgkmcnt(0)
  s_xor_b64 s[10:11], s[64:65], s[8:9]
  s_xor_b64 s[14:15], s[66:67], s[8:9]
  s_or_b64 s[10:11], s[10:11], s[14:15]
  s_cbranch_scc0 L_ok14
  s_load_dwordx4 s[64:67], s[4:5], s43 glc
  s_add_u32 s63, s63, 1
  s_cmp_lt_u32 s63, 20000
  s_cbranch_scc1 L_sp14
  s_waitcnt lgkmcnt(0)
L_ok14:
  s_mov_b32 s43, 15360
  s_load_dwordx4 s[64:67], s[4:5], s43 glc
  s_add_u32 m0, s61, 98304
  s_mov_b32 s62, 229376
  buffer_load_dwordx4 v20, s[28:31], s62 offen offset:0 sc1 lds
  buffer_load_dwordx4 v20, s[28:31], s62 offen offset:1024 sc1 lds
  buffer_load_dwordx4 v20, s[28:31], s62 offen offset:2048 sc1 lds
  buffer_load_dwordx4 v20, s[28:31], s62 offen offset:3072 sc1 lds
  s_waitcnt vmcnt(12)
  s_barrier
  s_mov_b32 s41, 1920
  s_add_u32 m0, s60, 0
  s_nop 0
  buffer_load_dwordx4 v16, s[16:19], s41 offen offset:0 lds
  buffer_load_dwordx4 v17, s[16:19], s41 offen offset:1024 lds
  buffer_load_dwordx4 v18, s[16:19], s41 offen offset:2048 lds
  buffer_load_dwordx4 v19, s[16:19], s41 offen offset:3072 lds
  s_add_u32 m0, s60, 4096
  s_add_u32 s41, s41, 65536
  buffer_load_dwordx4 v16, s[16:19], s41 offen offset:0 lds
  buffer_load_dwordx4 v17, s[16:19], s41 offen offset:1024 lds
  buffer_load_dwordx4 v18, s[16:19], s41 offen offset:2048 lds
  buffer_load_dwordx4 v19, s[16:19], s41 offen offset:3072 lds
  s_mov_b32 s63, 0
L_sp15:
  s_waitcnt lgkmcnt(0)
  s_xor_b64 s[10:11], s[64:65], s[8:9]
  s_xor_b64 s[14:15], s[66:67], s[8:9]
  s_or_b64 s[10:11], s[10:11], s[14:15]
  s_cbranch_scc0 L_ok15
  s_load_dwordx4 s[64:67], s[4:5], s43 glc
  s_add_u32 s63, s63, 1
  s_cmp_lt_u32 s63, 20000
  s_cbranch_scc1 L_sp15
  s_waitcnt lgkmcnt(0)
L_ok15:
  s_add_u32 m0, s61, 0
  s_mov_b32 s62, 245760
  buffer_load_dwordx4 v20, s[28:31], s62 offen offset:0 sc1 lds
  buffer_load_dwordx4 v20, s[28:31], s62 offen offset:1024 sc1 lds
  buffer_load_dwordx4 v20, s[28:31], s62 offen offset:2048 sc1 lds
  buffer_load_dwordx4 v20, s[28:31], s62 offen offset:3072 sc1 lds
  s_waitcnt vmcnt(12)
  s_barrier
  s_waitcnt vmcnt(0)
  s_barrier
  s_endpgm
L_prod:
  s_mov_b32 s56, 917504
  s_mov_b32 s57, 16384
  s_mov_b32 s58, 1024
  s_mov_b32 s59, 0
  s_mov_b32 s55, 8
  v_mov_b32 v15, 0x7ff00000
  s_add_u32 s10, s28, 9437184
  s_addc_u32 s11, s29, 0
  s_load_dwordx2 s[6:7], s[10:11], 0
  s_lshl_b32 s53, s38, 11
  s_add_u32 s53, s53, 32768
  v_and_b32 v1, 1, v3
  v_lshlrev_b32 v1, 10, v1
  v_lshl_add_u32 v1, v9, 3, v1
  v_lshrrev_b32 v6, 1, v3
  v_lshl_add_u32 v6, v6, 4, v1
  v_add_u32 v6, s53, v6
  v_lshl_add_u32 v7, v2, 4, s53
  s_lshl_b32 s53, s37, 18
  s_lshl_b32 s54, s52, 11
  s_add_u32 s53, s53, s54
  v_lshl_add_u32 v8, v2, 4, s53
  s_lshl_b32 s53, s37, 6
  s_lshr_b32 s54, s52, 1
  s_add_u32 s53, s53, s54
  s_lshl_b32 s53, s53, 8
  s_and_b32 s54, s52, 1
  s_lshl_b32 s54, s54, 3
  s_add_u32 s53, s53, s54
  s_add_u32 s53, s53, 7340032
  v_lshl_add_u32 v14, v2, 7, s53
  s_waitcnt vmcnt(0)
  buffer_load_dwordx4 v[32:35], v4, s[20:23], 0 offen
  buffer_load_dwordx4 v[36:39], v4, s[20:23], s45 offen
  buffer_load_dwordx4 v[40:43], v4, s[20:23], s46 offen
  buffer_load_dwordx4 v[44:47], v4, s[20:23], s47 offen
  v_add_u32 v4, s56, v4
  buffer_load_dword v17, v15, s[20:23], 0 offen
  buffer_load_dword v17, v15, s[20:23], 0 offen
  buffer_load_dwordx4 v[48:51], v4, s[20:23], 0 offen
  buffer_load_dwordx4 v[52:55], v4, s[20:23], s45 offen
  buffer_load_dwordx4 v[56:59], v4, s[20:23], s46 offen
  buffer_load_dwordx4 v[60:63], v4, s[20:23], s47 offen
  v_add_u32 v4, s56, v4
  s_waitcnt lgkmcnt(0)
  s_mul_i32 s8, s6, 1664525
  s_mul_i32 s9, s7, 22695477
  s_add_u32 s8, s8, 1013904223
  s_add_u32 s9, s9, 1
  v_mov_b32 v10, s8
  v_mov_b32 v11, s9
  s_mov_b32 s60, 0
  s_mov_b32 s61, 0
  s_mov_b32 s62, 0
  s_waitcnt vmcnt(10)
  s_barrier
L_p:
  s_waitcnt vmcnt(9)
  v_lshl_add_u32 v32, v32, 8, v5
  v_lshl_add_u32 v33, v33, 8, v5
  v_lshl_add_u32 v34, v34, 8, v5
  v_lshl_add_u32 v35, v35, 8, v5
  ds_read_u16 v96, v32 offset:0
  ds_read_u16 v97, v33 offset:2
  ds_read_u16 v98, v34 offset:128
  ds_read_u16 v99, v35 offset:130
  s_waitcnt vmcnt(8)
  v_lshl_add_u32 v36, v36, 8, v5
  v_lshl_add_u32 v37, v37, 8, v5
  v_lshl_add_u32 v38, v38, 8, v5
  v_lshl_add_u32 v39, v39, 8, v5
  ds_read_u16 v100, v36 offset:0
  ds_read_u16 v101, v37 offset:2
  ds_read_u16 v102, v38 offset:128
  ds_read_u16 v103, v39 offset:130
  s_waitcnt vmcnt(7)
  v_lshl_add_u32 v40, v40, 8, v5
  v_lshl_add_u32 v41, v41, 8, v5
  v_lshl_add_u32 v42, v42, 8, v5
  v_lshl_add_u32 v43, v43, 8, v5
  ds_read_u16 v104, v40 offset:0
  ds_read_u16 v105, v41 offset:2
  ds_read_u16 v106, v42 offset:128
  ds_read_u16 v107, v43 offset:130
  s_waitcnt vmcnt(6)
  v_lshl_add_u32 v44, v44, 8, v5
  v_lshl_add_u32 v45, v45, 8, v5
  v_lshl_add_u32 v46, v46, 8, v5
  v_lshl_add_u32 v47, v47, 8, v5
  ds_read_u16 v108, v44 offset:0
  ds_read_u16 v109, v45 offset:2
  ds_read_u16 v110, v46 offset:128
  ds_read_u16 v111, v47 offset:130
  s_waitcnt lgkmcnt(8)
  v_lshl_or_b32 v112, v100, 16, v96
  v_lshl_or_b32 v114, v101, 16, v97
  v_lshl_or_b32 v116, v102, 16, v98
  v_lshl_or_b32 v118, v103, 16, v99
  s_waitcnt lgkmcnt(3)
  v_lshl_or_b32 v113, v108, 16, v104
  ds_write_b64 v6, v[112:113] offset:0
  s_waitcnt lgkmcnt(3)
  v_lshl_or_b32 v115, v109, 16, v105
  ds_write_b64 v6, v[114:115] offset:256
  s_waitcnt lgkmcnt(3)
  v_lshl_or_b32 v117, v110, 16, v106
  ds_write_b64 v6, v[116:117] offset:512
  s_waitcnt lgkmcnt(3)
  v_lshl_or_b32 v119, v111, 16, v107
  ds_write_b64 v6, v[118:119] offset:768
  s_waitcnt lgkmcnt(0)
  ds_read_b128 v[120:123], v7 offset:0
  ds_read_b128 v[124:127], v7 offset:1024
  s_cmp_eq_u32 s62, 0
  s_cbranch_scc1 L_pa0
  s_waitcnt vmcnt(4)
  s_mov_b64 exec, 3
  buffer_store_dwordx2 v[10:11], v14, s[28:31], s61 offen sc1
  s_mov_b64 exec, -1
  s_add_u32 s61, s61, s58
L_pa0:
  s_waitcnt lgkmcnt(1)
  buffer_store_dwordx4 v[120:123], v8, s[28:31], s60 offen offset:0 sc1
  s_waitcnt lgkmcnt(0)
  buffer_store_dwordx4 v[124:127], v8, s[28:31], s60 offen offset:1024 sc1
  buffer_load_dwordx4 v[32:35], v4, s[20:23], 0 offen
  buffer_load_dwordx4 v[36:39], v4, s[20:23], s45 offen
  buffer_load_dwordx4 v[40:43], v4, s[20:23], s46 offen
  buffer_load_dwordx4 v[44:47], v4, s[20:23], s47 offen
  v_add_u32 v4, s56, v4
  v_add_u32 v5, s59, v5
  s_add_u32 s62, s62, 1
  s_add_u32 s60, s60, s57
  s_cmp_lt_u32 s62, s55
  s_cbranch_scc0 L_pe
  s_waitcnt vmcnt(9)
  v_lshl_add_u32 v48, v48, 8, v5
  v_lshl_add_u32 v49, v49, 8, v5
  v_lshl_add_u32 v50, v50, 8, v5
  v_lshl_add_u32 v51, v51, 8, v5
  ds_read_u16 v96, v48 offset:0
  ds_read_u16 v97, v49 offset:2
  ds_read_u16 v98, v50 offset:128
  ds_read_u16 v99, v51 offset:130
  s_waitcnt vmcnt(8)
  v_lshl_add_u32 v52, v52, 8, v5
  v_lshl_add_u32 v53, v53, 8, v5
  v_lshl_add_u32 v54, v54, 8, v5
  v_lshl_add_u32 v55, v55, 8, v5
  ds_read_u16 v100, v52 offset:0
  ds_read_u16 v101, v53 offset:2
  ds_read_u16 v102, v54 offset:128
  ds_read_u16 v103, v55 offset:130
  s_waitcnt vmcnt(7)
  v_lshl_add_u32 v56, v56, 8, v5
  v_lshl_add_u32 v57, v57, 8, v5
  v_lshl_add_u32 v58, v58, 8, v5
  v_lshl_add_u32 v59, v59, 8, v5
  ds_read_u16 v104, v56 offset:0
  ds_read_u16 v105, v57 offset:2
  ds_read_u16 v106, v58 offset:128
  ds_read_u16 v107, v59 offset:130
  s_waitcnt vmcnt(6)
  v_lshl_add_u32 v60, v60, 8, v5
  v_lshl_add_u32 v61, v61, 8, v5
  v_lshl_add_u32 v62, v62, 8, v5
  v_lshl_add_u32 v63, v63, 8, v5
  ds_read_u16 v108, v60 offset:0
  ds_read_u16 v109, v61 offset:2
  ds_read_u16 v110, v62 offset:128
  ds_read_u16 v111, v63 offset:130
  s_waitcnt lgkmcnt(8)
  v_lshl_or_b32 v112, v100, 16, v96
  v_lshl_or_b32 v114, v101, 16, v97
  v_lshl_or_b32 v116, v102, 16, v98
  v_lshl_or_b32 v118, v103, 16, v99
  s_waitcnt lgkmcnt(3)
  v_lshl_or_b32 v113, v108, 16, v104
  ds_write_b64 v6, v[112:113] offset:0
  s_waitcnt lgkmcnt(3)
  v_lshl_or_b32 v115, v109, 16, v105
  ds_write_b64 v6, v[114:115] offset:256
  s_waitcnt lgkmcnt(3)
  v_lshl_or_b32 v117, v110, 16, v106
  ds_write_b64 v6, v[116:117] offset:512
  s_waitcnt lgkmcnt(3)
  v_lshl_or_b32 v119, v111, 16, v107
  ds_write_b64 v6, v[118:119] offset:768
  s_waitcnt lgkmcnt(0)
  ds_read_b128 v[128:131], v7 offset:0
  ds_read_b128 v[132:135], v7 offset:1024
  s_cmp_eq_u32 s62, 0
  s_cbranch_scc1 L_pa1
  s_waitcnt vmcnt(4)
  s_mov_b64 exec, 3
  buffer_store_dwordx2 v[10:11], v14, s[28:31], s61 offen sc1
  s_mov_b64 exec, -1
  s_add_u32 s61, s61, s58
L_pa1:
  s_waitcnt lgkmcnt(1)
  buffer_store_dwordx4 v[128:131], v8, s[28:31], s60 offen offset:0 sc1
  s_waitcnt lgkmcnt(0)
  buffer_store_dwordx4 v[132:135], v8, s[28:31], s60 offen offset:1024 sc1
  buffer_load_dwordx4 v[48:51], v4, s[20:23], 0 offen
  buffer_load_dwordx4 v[52:55], v4, s[20:23], s45 offen
  buffer_load_dwordx4 v[56:59], v4, s[20:23], s46 offen
  buffer_load_dwordx4 v[60:63], v4, s[20:23], s47 offen
  v_add_u32 v4, s56, v4
  v_add_u32 v5, s59, v5
  s_add_u32 s62, s62, 1
  s_add_u32 s60, s60, s57
  s_cmp_lt_u32 s62, s55
  s_cbranch_scc1 L_p
L_pe:
  s_waitcnt vmcnt(4)
  s_mov_b64 exec, 3
  buffer_store_dwordx2 v[10:11], v14, s[28:31], s61 offen sc1
  s_mov_b64 exec, -1
  s_cmp_eq_u32 s38, 0
  s_cbranch_scc0 L_pz
  s_lshl_b32 s3, s2, 6
  s_add_u32 s3, s3, 9441280
  v_mov_b32 v12, s3
  s_mov_b64 exec, 1
  buffer_store_dwordx2 v[10:11], v12, s[28:31], 0 offen sc1
  s_mov_b64 exec, -1
  s_cmp_eq_u32 s2, 0
  s_cbranch_scc0 L_pz
  s_mov_b32 s63, 0
  v_lshlrev_b32 v12, 6, v2
  v_add_u32 v12, 9441280, v12
L_pw:
  v_mov_b32 v13, 28
  v_max_u32 v13, v13, v2
  s_mov_b32 s53, 0
  buffer_load_dwordx2 v[20:21], v12, s[28:31], s53 offen sc1
  s_mov_b32 s53, 4096
  buffer_load_dwordx2 v[22:23], v12, s[28:31], s53 offen sc1
  s_mov_b32 s53, 8192
  buffer_load_dwordx2 v[24:25], v12, s[28:31], s53 offen sc1
  s_mov_b32 s53, 12288
  buffer_load_dwordx2 v[26:27], v12, s[28:31], s53 offen sc1
  s_add_u32 s63, s63, 1
  s_waitcnt vmcnt(0)
  v_cmp_ne_u64 s[52:53], v[20:21], v[10:11]
  s_and_b32 s52, s52, 0x0fffffff
  v_cmp_ne_u64 vcc, v[22:23], v[10:11]
  s_or_b64 s[52:53], s[52:53], vcc
  v_cmp_ne_u64 vcc, v[24:25], v[10:11]
  s_or_b64 s[52:53], s[52:53], vcc
  v_cmp_ne_u64 vcc, v[26:27], v[10:11]
  s_or_b64 s[52:53], s[52:53], vcc
  s_cbranch_scc0 L_pv
  s_cmp_lt_u32 s63, 20000
  s_cbranch_scc1 L_pw
L_pv:
  v_mov_b32 v12, 9437184
  s_mov_b64 exec, 1
  buffer_store_dwordx2 v[10:11], v12, s[28:31], 0 offen sc1
  s_mov_b64 exec, -1
L_pz:
L_drain:
  s_waitcnt vmcnt(0)
L_done:
  s_endpgm
.section .rodata,"a"
.p2align 6
.amdhsa_kernel standalone__weight_only_int_squeezellm__prompt_kernel
  .amdhsa_next_free_vgpr 256
  .amdhsa_next_free_sgpr 102
  .amdhsa_accum_offset 160
  .amdhsa_group_segment_fixed_size 0
  .amdhsa_kernarg_size 48
  .amdhsa_user_sgpr_count 2
  .amdhsa_user_sgpr_kernarg_segment_ptr 1
  .amdhsa_system_sgpr_workgroup_id_x 1
.end_amdhsa_kernel
```

```asm
; @launch grid=(256,1,1) block=(512,1,1) lds=151552
.amdgcn_target "amdgcn-amd-amdhsa--gfx950"
.text
.globl standalone__weight_only_int_squeezellm__prompt_kernel
.p2align 8
.type standalone__weight_only_int_squeezellm__prompt_kernel,@function
standalone__weight_only_int_squeezellm__prompt_kernel:
  s_cmp_ge_u32 s2, 256
  s_cbranch_scc1 L_done
  s_load_dwordx2 s[24:25], s[0:1], 16
  s_load_dwordx2 s[20:21], s[0:1], 8
  s_load_dwordx2 s[28:29], s[0:1], 40
  s_load_dwordx2 s[16:17], s[0:1], 0
  s_load_dwordx2 s[32:33], s[0:1], 24
  s_mov_b32 s18, 4194304
  s_mov_b32 s19, 0x20000
  s_mov_b32 s22, 14680064
  s_mov_b32 s23, 0x20000
  s_mov_b32 s26, 114688
  s_mov_b32 s27, 0x20000
  s_mov_b32 s30, 9457664
  s_mov_b32 s31, 0x20000
  s_mov_b32 s34, 14680064
  s_mov_b32 s35, 0x20000
  v_lshrrev_b32 v1, 6, v0
  v_and_b32 v2, 63, v0
  v_readfirstlane_b32 s38, v1
  v_and_b32 v3, 31, v0
  v_bfe_u32 v9, v0, 5, 1
  s_mov_b32 s45, 14336
  s_mov_b32 s46, 28672
  s_mov_b32 s47, 43008
  v_mul_u32_u24 v1, 57344, v9
  v_lshl_add_u32 v4, v3, 4, v1
  v_lshlrev_b32 v1, 3, v3
  v_lshl_add_u32 v16, v9, 2, v1
  v_lshlrev_b32 v5, 2, v3
  s_and_b32 s3, s2, 1
  s_lshl_b32 s3, s3, 2
  s_bfe_u32 s36, s2, 0x20003
  s_add_u32 s36, s36, s3
  s_bfe_u32 s3, s2, 0x20001
  s_mul_i32 s3, s3, 7
  s_lshr_b32 s37, s2, 5
  s_add_u32 s37, s37, s3
  s_sub_u32 s37, s37, 1
  s_cmp_lt_u32 s2, 32
  s_cselect_b32 s36, 8, s36
  s_cselect_b32 s37, s2, s37
  s_cselect_b32 s51, 0, 147456
  s_sub_u32 s3, s2, 28
  s_mul_i32 s53, s3, 7
  s_cmp_lt_u32 s3, 4
  s_cselect_b32 s36, 15, s36
  s_cselect_b32 s37, s53, s37
  s_lshl_b32 s52, s36, 3
  s_add_u32 s52, s52, s38
  s_mul_i32 s53, s52, 114688
  s_lshl_b32 s54, s37, 9
  s_add_u32 s53, s53, s54
  v_add_u32 v4, s53, v4
  s_mul_i32 s53, s38, 14336
  s_lshl_b32 s54, s37, 8
  s_add_u32 s53, s53, s54
  v_add_u32 v16, s53, v16
  s_lshl_b32 s53, s38, 9
  s_add_u32 m0, s53, s51
  s_mov_b32 s50, 6912
  v_add_u32 v5, s51, v5
  s_and_b32 s39, s38, 3
  s_cmp_lt_u32 s2, 32
  s_waitcnt lgkmcnt(0)
  buffer_load_dword v16, s[24:27], 0 offen lds
  buffer_load_dword v16, s[24:27], s50 offen offset:256 lds
  s_cbranch_scc1 L_prod
  buffer_load_dwordx4 v[32:35], v4, s[20:23], 0 offen
  buffer_load_dwordx4 v[36:39], v4, s[20:23], s45 offen
  buffer_load_dwordx4 v[40:43], v4, s[20:23], s46 offen
  buffer_load_dwordx4 v[44:47], v4, s[20:23], s47 offen
  s_add_u32 s10, s28, 9437184
  s_addc_u32 s11, s29, 0
  s_load_dwordx2 s[6:7], s[10:11], 0
  s_lshl_b32 s53, s38, 11
  s_add_u32 s53, s53, 32768
  v_and_b32 v1, 1, v3
  v_lshlrev_b32 v1, 10, v1
  v_lshl_add_u32 v1, v9, 3, v1
  v_lshrrev_b32 v6, 1, v3
  v_lshl_add_u32 v6, v6, 4, v1
  v_add_u32 v6, s53, v6
  v_lshl_add_u32 v7, v2, 4, s53
  s_lshl_b32 s53, s37, 18
  s_lshl_b32 s54, s52, 11
  s_add_u32 s53, s53, s54
  v_lshl_add_u32 v8, v2, 4, s53
  s_lshl_b32 s53, s37, 6
  s_lshr_b32 s54, s52, 1
  s_add_u32 s53, s53, s54
  s_lshl_b32 s53, s53, 8
  s_and_b32 s54, s52, 1
  s_lshl_b32 s54, s54, 3
  s_add_u32 s53, s53, s54
  s_add_u32 s53, s53, 7340032
  v_lshl_add_u32 v14, v2, 7, s53
  s_lshl_b32 s53, s37, 2
  s_add_u32 s53, s53, s39
  s_mul_i32 s53, s53, 3
  s_min_u32 s53, s53, 253
  s_lshl_b32 s54, s36, 8
  s_add_u32 s53, s53, s54
  s_lshl_b32 s53, s53, 11
  s_add_u32 s12, s16, s53
  s_addc_u32 s13, s17, 0
  s_andn2_b32 s40, 4, s36
  v_and_b32 v3, 15, v2
  v_lshrrev_b32 v9, 4, v2
  v_lshrrev_b32 v1, 1, v3
  v_xor_b32 v1, v1, v9
  v_lshlrev_b32 v1, 4, v1
  v_lshl_add_u32 v144, v3, 7, v1
  s_lshl_b32 s54, s38, 13
  v_add_u32 v144, s54, v144
  v_xor_b32 v145, 64, v144
  v_lshlrev_b32 v1, 11, v9
  v_lshl_add_u32 v146, v3, 4, v1
  v_add_u32 v146, 32768, v146
  s_lshl_b32 s52, s36, 8
  s_lshl_b32 s53, s38, 6
  s_add_u32 s52, s52, s53
  s_mul_i32 s52, s52, 7168
  s_lshl_b32 s53, s37, 8
  s_add_u32 s52, s52, s53
  v_mul_u32_u24 v1, 28672, v9
  v_lshl_add_u32 v1, v3, 4, v1
  v_add_u32 v147, s52, v1
  v_lshrrev_b32 v20, 3, v2
  v_lshlrev_b32 v20, 11, v20
  v_lshrrev_b32 v1, 4, v2
  v_xor_b32 v1, v1, v2
  v_and_b32 v1, 7, v1
  v_lshl_add_u32 v20, v1, 4, v20
  s_lshl_b32 s52, s36, 19
  s_lshl_b32 s53, s39, 17
  s_add_u32 s53, s52, s53
  v_add_u32 v16, s53, v20
  v_xor_b32 v17, 64, v16
  v_add_u32 v18, 30720, v16
  v_add_u32 v19, 46080, v17
  v_add_u32 v17, 15360, v17
  s_lshl_b32 s60, s39, 13
  s_lshl_b32 s53, s37, 18
  s_lshl_b32 s54, s39, 12
  s_add_u32 s53, s53, s54
  v_lshl_add_u32 v20, v2, 4, s53
  s_add_u32 s61, s54, 32768
  s_lshl_b32 s53, s37, 14
  s_lshl_b32 s54, s39, 8
  s_add_u32 s53, s53, s54
  s_and_b32 s54, s36, 1
  s_lshl_b32 s54, s54, 7
  s_add_u32 s53, s53, s54
  s_add_u32 s53, s53, 7340032
  s_add_u32 s4, s28, s53
  s_addc_u32 s5, s29, 0
  s_lshl_b32 s41, s36, 7
  s_lshr_b32 s53, s38, 2
  s_lshl_b32 s54, s53, 16
  s_add_u32 s41, s41, s54
  s_lshl_b32 s53, s53, 12
  s_add_u32 m0, s60, s53
  s_waitcnt lgkmcnt(0)
  s_mul_i32 s8, s6, 1664525
  s_mul_i32 s9, s7, 22695477
  s_add_u32 s8, s8, 1013904223
  s_add_u32 s9, s9, 1
  v_mov_b32 v10, s8
  v_mov_b32 v11, s9
  s_waitcnt vmcnt(4)
  s_barrier
  s_waitcnt vmcnt(3)
  v_lshl_add_u32 v32, v32, 8, v5
  v_lshl_add_u32 v33, v33, 8, v5
  v_lshl_add_u32 v34, v34, 8, v5
  v_lshl_add_u32 v35, v35, 8, v5
  ds_read_u16 v96, v32 offset:0
  ds_read_u16 v97, v33 offset:2
  ds_read_u16 v98, v34 offset:128
  ds_read_u16 v99, v35 offset:130
  buffer_load_dwordx4 v16, s[16:19], s41 offen offset:0 lds
  s_waitcnt vmcnt(3)
  v_lshl_add_u32 v36, v36, 8, v5
  v_lshl_add_u32 v37, v37, 8, v5
  v_lshl_add_u32 v38, v38, 8, v5
  v_lshl_add_u32 v39, v39, 8, v5
  ds_read_u16 v100, v36 offset:0
  ds_read_u16 v101, v37 offset:2
  ds_read_u16 v102, v38 offset:128
  ds_read_u16 v103, v39 offset:130
  buffer_load_dwordx4 v17, s[16:19], s41 offen offset:1024 lds
  s_waitcnt vmcnt(3)
  v_lshl_add_u32 v40, v40, 8, v5
  v_lshl_add_u32 v41, v41, 8, v5
  v_lshl_add_u32 v42, v42, 8, v5
  v_lshl_add_u32 v43, v43, 8, v5
  ds_read_u16 v104, v40 offset:0
  ds_read_u16 v105, v41 offset:2
  ds_read_u16 v106, v42 offset:128
  ds_read_u16 v107, v43 offset:130
  buffer_load_dwordx4 v18, s[16:19], s41 offen offset:2048 lds
  s_waitcnt vmcnt(3)
  v_lshl_add_u32 v44, v44, 8, v5
  v_lshl_add_u32 v45, v45, 8, v5
  v_lshl_add_u32 v46, v46, 8, v5
  v_lshl_add_u32 v47, v47, 8, v5
  ds_read_u16 v108, v44 offset:0
  ds_read_u16 v109, v45 offset:2
  ds_read_u16 v110, v46 offset:128
  ds_read_u16 v111, v47 offset:130
  buffer_load_dwordx4 v19, s[16:19], s41 offen offset:3072 lds
  s_waitcnt lgkmcnt(8)
  v_lshl_or_b32 v112, v100, 16, v96
  v_lshl_or_b32 v114, v101, 16, v97
  v_lshl_or_b32 v116, v102, 16, v98
  v_lshl_or_b32 v118, v103, 16, v99
  s_waitcnt lgkmcnt(3)
  v_lshl_or_b32 v113, v108, 16, v104
  ds_write_b64 v6, v[112:113] offset:0
  s_waitcnt lgkmcnt(3)
  v_lshl_or_b32 v115, v109, 16, v105
  ds_write_b64 v6, v[114:115] offset:256
  s_waitcnt lgkmcnt(3)
  v_lshl_or_b32 v117, v110, 16, v106
  ds_write_b64 v6, v[116:117] offset:512
  s_waitcnt lgkmcnt(3)
  v_lshl_or_b32 v119, v111, 16, v107
  ds_write_b64 v6, v[118:119] offset:768
  s_waitcnt lgkmcnt(0)
  ds_read_b128 v[148:151], v7 offset:0
  ds_read_b128 v[152:155], v7 offset:1024
  s_waitcnt lgkmcnt(1)
  buffer_store_dwordx4 v[148:151], v8, s[28:31], 0 offen offset:0 sc1
  s_waitcnt lgkmcnt(0)
  buffer_store_dwordx4 v[152:155], v8, s[28:31], 0 offen offset:1024 sc1
  s_cmp_ge_u32 s38, 4
  s_cbranch_scc1 L_loader
  s_add_u32 s58, s40, 0
  s_lshl_b32 s58, s58, 7
  s_load_dword s92, s[12:13], s58 offset:0
  s_load_dword s93, s[12:13], s58 offset:64
  s_load_dword s94, s[12:13], s58 offset:2048
  s_load_dword s95, s[12:13], s58 offset:2112
  s_load_dword s96, s[12:13], s58 offset:4096
  s_load_dword s97, s[12:13], s58 offset:4160
  s_add_u32 s58, s40, 1
  s_lshl_b32 s58, s58, 7
  s_load_dword s92, s[12:13], s58 offset:0
  s_load_dword s93, s[12:13], s58 offset:64
  s_load_dword s94, s[12:13], s58 offset:2048
  s_load_dword s95, s[12:13], s58 offset:2112
  s_load_dword s96, s[12:13], s58 offset:4096
  s_load_dword s97, s[12:13], s58 offset:4160
  v_mov_b32 v5, v144
  v_mov_b32 v6, v145
  v_mov_b32 v7, v146
  v_mov_b32 v16, 0
  v_mov_b32 v17, 0
  v_mov_b32 v18, 0
  v_mov_b32 v19, 0
  v_mov_b32 v20, 0
  v_mov_b32 v21, 0
  v_mov_b32 v22, 0
  v_mov_b32 v23, 0
  v_mov_b32 v24, 0
  v_mov_b32 v25, 0
  v_mov_b32 v26, 0
  v_mov_b32 v27, 0
  v_mov_b32 v28, 0
  v_mov_b32 v29, 0
  v_mov_b32 v30, 0
  v_mov_b32 v31, 0
  v_mov_b32 v32, 0
  v_mov_b32 v33, 0
  v_mov_b32 v34, 0
  v_mov_b32 v35, 0
  v_mov_b32 v36, 0
  v_mov_b32 v37, 0
  v_mov_b32 v38, 0
  v_mov_b32 v39, 0
  v_mov_b32 v40, 0
  v_mov_b32 v41, 0
  v_mov_b32 v42, 0
  v_mov_b32 v43, 0
  v_mov_b32 v44, 0
  v_mov_b32 v45, 0
  v_mov_b32 v46, 0
  v_mov_b32 v47, 0
  v_mov_b32 v48, 0
  v_mov_b32 v49, 0
  v_mov_b32 v50, 0
  v_mov_b32 v51, 0
  v_mov_b32 v52, 0
  v_mov_b32 v53, 0
  v_mov_b32 v54, 0
  v_mov_b32 v55, 0
  v_mov_b32 v56, 0
  v_mov_b32 v57, 0
  v_mov_b32 v58, 0
  v_mov_b32 v59, 0
  v_mov_b32 v60, 0
  v_mov_b32 v61, 0
  v_mov_b32 v62, 0
  v_mov_b32 v63, 0
  v_mov_b32 v64, 0
  v_mov_b32 v65, 0
  v_mov_b32 v66, 0
  v_mov_b32 v67, 0
  v_mov_b32 v68, 0
  v_mov_b32 v69, 0
  v_mov_b32 v70, 0
  v_mov_b32 v71, 0
  v_mov_b32 v72, 0
  v_mov_b32 v73, 0
  v_mov_b32 v74, 0
  v_mov_b32 v75, 0
  v_mov_b32 v76, 0
  v_mov_b32 v77, 0
  v_mov_b32 v78, 0
  v_mov_b32 v79, 0
  v_mov_b32 v80, 0
  v_mov_b32 v81, 0
  v_mov_b32 v82, 0
  v_mov_b32 v83, 0
  v_mov_b32 v84, 0
  v_mov_b32 v85, 0
  v_mov_b32 v86, 0
  v_mov_b32 v87, 0
  v_mov_b32 v88, 0
  v_mov_b32 v89, 0
  v_mov_b32 v90, 0
  v_mov_b32 v91, 0
  v_mov_b32 v92, 0
  v_mov_b32 v93, 0
  v_mov_b32 v94, 0
  v_mov_b32 v95, 0
  v_mov_b32 v96, 0
  v_mov_b32 v97, 0
  v_mov_b32 v98, 0
  v_mov_b32 v99, 0
  v_mov_b32 v100, 0
  v_mov_b32 v101, 0
  v_mov_b32 v102, 0
  v_mov_b32 v103, 0
  v_mov_b32 v104, 0
  v_mov_b32 v105, 0
  v_mov_b32 v106, 0
  v_mov_b32 v107, 0
  v_mov_b32 v108, 0
  v_mov_b32 v109, 0
  v_mov_b32 v110, 0
  v_mov_b32 v111, 0
  v_mov_b32 v112, 0
  v_mov_b32 v113, 0
  v_mov_b32 v114, 0
  v_mov_b32 v115, 0
  v_mov_b32 v116, 0
  v_mov_b32 v117, 0
  v_mov_b32 v118, 0
  v_mov_b32 v119, 0
  v_mov_b32 v120, 0
  v_mov_b32 v121, 0
  v_mov_b32 v122, 0
  v_mov_b32 v123, 0
  v_mov_b32 v124, 0
  v_mov_b32 v125, 0
  v_mov_b32 v126, 0
  v_mov_b32 v127, 0
  v_mov_b32 v128, 0
  v_mov_b32 v129, 0
  v_mov_b32 v130, 0
  v_mov_b32 v131, 0
  v_mov_b32 v132, 0
  v_mov_b32 v133, 0
  v_mov_b32 v134, 0
  v_mov_b32 v135, 0
  v_mov_b32 v136, 0
  v_mov_b32 v137, 0
  v_mov_b32 v138, 0
  v_mov_b32 v139, 0
  v_mov_b32 v140, 0
  v_mov_b32 v141, 0
  v_mov_b32 v142, 0
  v_mov_b32 v143, 0
  s_waitcnt vmcnt(0)
  s_mov_b64 exec, 3
  buffer_store_dwordx2 v[10:11], v14, s[28:31], 0 offen sc1
  s_mov_b64 exec, -1
  s_mov_b32 s44, 0
  s_mov_b32 s45, 7168
  s_mov_b32 s46, 14336
  s_mov_b32 s47, 21504
  s_mov_b32 s48, 114688
  s_mov_b32 s49, 121856
  s_mov_b32 s50, 129024
  s_mov_b32 s51, 136192
  s_mov_b32 s52, 229376
  s_mov_b32 s53, 236544
  s_mov_b32 s54, 243712
  s_mov_b32 s55, 250880
  s_mov_b32 s56, 344064
  s_mov_b32 s57, 351232
  s_mov_b32 s58, 358400
  s_mov_b32 s59, 365568
  s_mov_b32 s60, 0
  s_mov_b32 s61, 0
  s_mov_b32 s60, 49152
  s_mov_b32 s61, 5
  s_mov_b32 s62, 49152
  s_barrier
  ds_read_b128 a[64:67], v7 offset:0
  ds_read_b128 a[68:71], v7 offset:8192
  ds_read_b128 a[0:3], v5 offset:0
  ds_read_b128 a[4:7], v6 offset:0
  ds_read_b128 a[8:11], v5 offset:2048
  ds_read_b128 a[12:15], v6 offset:2048
  ds_read_b128 a[16:19], v5 offset:4096
  ds_read_b128 a[72:75], v7 offset:256
  ds_read_b128 a[76:79], v7 offset:8448
  ds_read_b128 a[20:23], v6 offset:4096
  ds_read_b128 a[24:27], v5 offset:6144
  ds_read_b128 a[28:31], v6 offset:6144
  ds_read_b128 a[80:83], v7 offset:512
  ds_read_b128 a[84:87], v7 offset:8704
  s_cmp_eq_u32 s38, 0
  s_cbranch_scc0 L_c0
  s_lshl_b32 s3, s2, 6
  s_add_u32 s3, s3, 9441280
  v_mov_b32 v12, s3
  s_mov_b64 exec, 1
  buffer_store_dwordx2 v[10:11], v12, s[28:31], 0 offen sc1
  s_mov_b64 exec, -1
L_c0:
  s_waitcnt lgkmcnt(0)
.p2align 6
L_c:
  v_mfma_f32_16x16x32_bf16 v[16:19], a[0:3], a[64:67], v[16:19]
  v_mfma_f32_16x16x32_bf16 v[16:19], a[4:7], a[68:71], v[16:19]
  ds_read_b128 a[88:91], v7 offset:768
  ds_read_b128 a[92:95], v7 offset:8960
  v_mfma_f32_16x16x32_bf16 v[48:51], a[8:11], a[64:67], v[48:51]
  v_mfma_f32_16x16x32_bf16 v[48:51], a[12:15], a[68:71], v[48:51]
  s_cmp_eq_u32 s60, 147456
  v_mfma_f32_16x16x32_bf16 v[80:83], a[16:19], a[64:67], v[80:83]
  v_mfma_f32_16x16x32_bf16 v[80:83], a[20:23], a[68:71], v[80:83]
  s_cselect_b32 s60, 0, s60
  v_add_u32 v1, s60, v146
  v_mfma_f32_16x16x32_bf16 v[112:115], a[24:27], a[64:67], v[112:115]
  v_mfma_f32_16x16x32_bf16 v[112:115], a[28:31], a[68:71], v[112:115]
  v_mfma_f32_16x16x32_bf16 v[20:23], a[0:3], a[72:75], v[20:23]
  v_mfma_f32_16x16x32_bf16 v[20:23], a[4:7], a[76:79], v[20:23]
  ds_read_b128 a[64:67], v7 offset:1024
  ds_read_b128 a[68:71], v7 offset:9216
  v_mfma_f32_16x16x32_bf16 v[52:55], a[8:11], a[72:75], v[52:55]
  v_mfma_f32_16x16x32_bf16 v[52:55], a[12:15], a[76:79], v[52:55]
  v_mfma_f32_16x16x32_bf16 v[84:87], a[16:19], a[72:75], v[84:87]
  v_mfma_f32_16x16x32_bf16 v[84:87], a[20:23], a[76:79], v[84:87]
  v_mfma_f32_16x16x32_bf16 v[116:119], a[24:27], a[72:75], v[116:119]
  v_mfma_f32_16x16x32_bf16 v[116:119], a[28:31], a[76:79], v[116:119]
  v_mfma_f32_16x16x32_bf16 v[24:27], a[0:3], a[80:83], v[24:27]
  v_mfma_f32_16x16x32_bf16 v[24:27], a[4:7], a[84:87], v[24:27]
  ds_read_b128 a[72:75], v7 offset:1280
  ds_read_b128 a[76:79], v7 offset:9472
  v_mfma_f32_16x16x32_bf16 v[56:59], a[8:11], a[80:83], v[56:59]
  v_mfma_f32_16x16x32_bf16 v[56:59], a[12:15], a[84:87], v[56:59]
  v_mfma_f32_16x16x32_bf16 v[88:91], a[16:19], a[80:83], v[88:91]
  v_mfma_f32_16x16x32_bf16 v[88:91], a[20:23], a[84:87], v[88:91]
  v_mfma_f32_16x16x32_bf16 v[120:123], a[24:27], a[80:83], v[120:123]
  v_mfma_f32_16x16x32_bf16 v[120:123], a[28:31], a[84:87], v[120:123]
  v_add_u32 v3, s60, v144
  s_waitcnt lgkmcnt(0)
  v_mfma_f32_16x16x32_bf16 v[28:31], a[0:3], a[88:91], v[28:31]
  v_mfma_f32_16x16x32_bf16 v[28:31], a[4:7], a[92:95], v[28:31]
  ds_read_b128 a[80:83], v7 offset:1536
  ds_read_b128 a[84:87], v7 offset:9728
  v_mfma_f32_16x16x32_bf16 v[60:63], a[8:11], a[88:91], v[60:63]
  v_mfma_f32_16x16x32_bf16 v[60:63], a[12:15], a[92:95], v[60:63]
  v_add_u32_e64 v4, s60, v145
  v_mfma_f32_16x16x32_bf16 v[92:95], a[16:19], a[88:91], v[92:95]
  v_mfma_f32_16x16x32_bf16 v[92:95], a[20:23], a[92:95], v[92:95]
  v_mfma_f32_16x16x32_bf16 v[124:127], a[24:27], a[88:91], v[124:127]
  v_mfma_f32_16x16x32_bf16 v[124:127], a[28:31], a[92:95], v[124:127]
  v_mfma_f32_16x16x32_bf16 v[32:35], a[0:3], a[64:67], v[32:35]
  v_mfma_f32_16x16x32_bf16 v[32:35], a[4:7], a[68:71], v[32:35]
  ds_read_b128 a[88:91], v7 offset:1792
  ds_read_b128 a[92:95], v7 offset:9984
  v_mfma_f32_16x16x32_bf16 v[64:67], a[8:11], a[64:67], v[64:67]
  v_mfma_f32_16x16x32_bf16 v[64:67], a[12:15], a[68:71], v[64:67]
  v_mfma_f32_16x16x32_bf16 v[96:99], a[16:19], a[64:67], v[96:99]
  v_mfma_f32_16x16x32_bf16 v[96:99], a[20:23], a[68:71], v[96:99]
  v_mfma_f32_16x16x32_bf16 v[128:131], a[24:27], a[64:67], v[128:131]
  v_mfma_f32_16x16x32_bf16 v[128:131], a[28:31], a[68:71], v[128:131]
  s_waitcnt lgkmcnt(0)
  s_barrier
  v_mfma_f32_16x16x32_bf16 v[36:39], a[0:3], a[72:75], v[36:39]
  v_mfma_f32_16x16x32_bf16 v[36:39], a[4:7], a[76:79], v[36:39]
  ds_read_b128 a[64:67], v1 offset:0
  ds_read_b128 a[68:71], v1 offset:8192
  v_mfma_f32_16x16x32_bf16 v[68:71], a[8:11], a[72:75], v[68:71]
  v_mfma_f32_16x16x32_bf16 v[68:71], a[12:15], a[76:79], v[68:71]
  ds_read_b128 a[32:35], v3 offset:0
  ds_read_b128 a[36:39], v4 offset:0
  v_mfma_f32_16x16x32_bf16 v[100:103], a[16:19], a[72:75], v[100:103]
  v_mfma_f32_16x16x32_bf16 v[100:103], a[20:23], a[76:79], v[100:103]
  ds_read_b128 a[40:43], v3 offset:2048
  ds_read_b128 a[44:47], v4 offset:2048
  v_mfma_f32_16x16x32_bf16 v[132:135], a[24:27], a[72:75], v[132:135]
  v_mfma_f32_16x16x32_bf16 v[132:135], a[28:31], a[76:79], v[132:135]
  ds_read_b128 a[48:51], v3 offset:4096
  v_mfma_f32_16x16x32_bf16 v[40:43], a[0:3], a[80:83], v[40:43]
  v_mfma_f32_16x16x32_bf16 v[40:43], a[4:7], a[84:87], v[40:43]
  ds_read_b128 a[72:75], v1 offset:256
  ds_read_b128 a[76:79], v1 offset:8448
  v_mfma_f32_16x16x32_bf16 v[72:75], a[8:11], a[80:83], v[72:75]
  v_mfma_f32_16x16x32_bf16 v[72:75], a[12:15], a[84:87], v[72:75]
  ds_read_b128 a[52:55], v4 offset:4096
  v_mfma_f32_16x16x32_bf16 v[104:107], a[16:19], a[80:83], v[104:107]
  v_mfma_f32_16x16x32_bf16 v[104:107], a[20:23], a[84:87], v[104:107]
  ds_read_b128 a[56:59], v3 offset:6144
  v_mfma_f32_16x16x32_bf16 v[136:139], a[24:27], a[80:83], v[136:139]
  v_mfma_f32_16x16x32_bf16 v[136:139], a[28:31], a[84:87], v[136:139]
  ds_read_b128 a[60:63], v4 offset:6144
  v_mfma_f32_16x16x32_bf16 v[44:47], a[0:3], a[88:91], v[44:47]
  v_mfma_f32_16x16x32_bf16 v[44:47], a[4:7], a[92:95], v[44:47]
  ds_read_b128 a[80:83], v1 offset:512
  ds_read_b128 a[84:87], v1 offset:8704
  v_mfma_f32_16x16x32_bf16 v[76:79], a[8:11], a[88:91], v[76:79]
  v_mfma_f32_16x16x32_bf16 v[76:79], a[12:15], a[92:95], v[76:79]
  v_mfma_f32_16x16x32_bf16 v[108:111], a[16:19], a[88:91], v[108:111]
  v_mfma_f32_16x16x32_bf16 v[108:111], a[20:23], a[92:95], v[108:111]
  v_mfma_f32_16x16x32_bf16 v[140:143], a[24:27], a[88:91], v[140:143]
  v_mfma_f32_16x16x32_bf16 v[140:143], a[28:31], a[92:95], v[140:143]
  s_add_u32 s60, s60, s62
  s_waitcnt lgkmcnt(0)
  v_mfma_f32_16x16x32_bf16 v[16:19], a[32:35], a[64:67], v[16:19]
  v_mfma_f32_16x16x32_bf16 v[16:19], a[36:39], a[68:71], v[16:19]
  ds_read_b128 a[88:91], v1 offset:768
  ds_read_b128 a[92:95], v1 offset:8960
  v_mfma_f32_16x16x32_bf16 v[48:51], a[40:43], a[64:67], v[48:51]
  v_mfma_f32_16x16x32_bf16 v[48:51], a[44:47], a[68:71], v[48:51]
  s_cmp_eq_u32 s60, 147456
  v_mfma_f32_16x16x32_bf16 v[80:83], a[48:51], a[64:67], v[80:83]
  v_mfma_f32_16x16x32_bf16 v[80:83], a[52:55], a[68:71], v[80:83]
  s_cselect_b32 s60, 0, s60
  v_add_u32 v7, s60, v146
  v_mfma_f32_16x16x32_bf16 v[112:115], a[56:59], a[64:67], v[112:115]
  v_mfma_f32_16x16x32_bf16 v[112:115], a[60:63], a[68:71], v[112:115]
  v_mfma_f32_16x16x32_bf16 v[20:23], a[32:35], a[72:75], v[20:23]
  v_mfma_f32_16x16x32_bf16 v[20:23], a[36:39], a[76:79], v[20:23]
  ds_read_b128 a[64:67], v1 offset:1024
  ds_read_b128 a[68:71], v1 offset:9216
  v_mfma_f32_16x16x32_bf16 v[52:55], a[40:43], a[72:75], v[52:55]
  v_mfma_f32_16x16x32_bf16 v[52:55], a[44:47], a[76:79], v[52:55]
  v_mfma_f32_16x16x32_bf16 v[84:87], a[48:51], a[72:75], v[84:87]
  v_mfma_f32_16x16x32_bf16 v[84:87], a[52:55], a[76:79], v[84:87]
  v_mfma_f32_16x16x32_bf16 v[116:119], a[56:59], a[72:75], v[116:119]
  v_mfma_f32_16x16x32_bf16 v[116:119], a[60:63], a[76:79], v[116:119]
  v_mfma_f32_16x16x32_bf16 v[24:27], a[32:35], a[80:83], v[24:27]
  v_mfma_f32_16x16x32_bf16 v[24:27], a[36:39], a[84:87], v[24:27]
  ds_read_b128 a[72:75], v1 offset:1280
  ds_read_b128 a[76:79], v1 offset:9472
  v_mfma_f32_16x16x32_bf16 v[56:59], a[40:43], a[80:83], v[56:59]
  v_mfma_f32_16x16x32_bf16 v[56:59], a[44:47], a[84:87], v[56:59]
  v_mfma_f32_16x16x32_bf16 v[88:91], a[48:51], a[80:83], v[88:91]
  v_mfma_f32_16x16x32_bf16 v[88:91], a[52:55], a[84:87], v[88:91]
  v_mfma_f32_16x16x32_bf16 v[120:123], a[56:59], a[80:83], v[120:123]
  v_mfma_f32_16x16x32_bf16 v[120:123], a[60:63], a[84:87], v[120:123]
  v_add_u32 v5, s60, v144
  s_waitcnt lgkmcnt(0)
  v_mfma_f32_16x16x32_bf16 v[28:31], a[32:35], a[88:91], v[28:31]
  v_mfma_f32_16x16x32_bf16 v[28:31], a[36:39], a[92:95], v[28:31]
  ds_read_b128 a[80:83], v1 offset:1536
  ds_read_b128 a[84:87], v1 offset:9728
  v_mfma_f32_16x16x32_bf16 v[60:63], a[40:43], a[88:91], v[60:63]
  v_mfma_f32_16x16x32_bf16 v[60:63], a[44:47], a[92:95], v[60:63]
  v_add_u32_e64 v6, s60, v145
  v_mfma_f32_16x16x32_bf16 v[92:95], a[48:51], a[88:91], v[92:95]
  v_mfma_f32_16x16x32_bf16 v[92:95], a[52:55], a[92:95], v[92:95]
  v_mfma_f32_16x16x32_bf16 v[124:127], a[56:59], a[88:91], v[124:127]
  v_mfma_f32_16x16x32_bf16 v[124:127], a[60:63], a[92:95], v[124:127]
  v_mfma_f32_16x16x32_bf16 v[32:35], a[32:35], a[64:67], v[32:35]
  v_mfma_f32_16x16x32_bf16 v[32:35], a[36:39], a[68:71], v[32:35]
  ds_read_b128 a[88:91], v1 offset:1792
  ds_read_b128 a[92:95], v1 offset:9984
  v_mfma_f32_16x16x32_bf16 v[64:67], a[40:43], a[64:67], v[64:67]
  v_mfma_f32_16x16x32_bf16 v[64:67], a[44:47], a[68:71], v[64:67]
  v_mfma_f32_16x16x32_bf16 v[96:99], a[48:51], a[64:67], v[96:99]
  v_mfma_f32_16x16x32_bf16 v[96:99], a[52:55], a[68:71], v[96:99]
  v_mfma_f32_16x16x32_bf16 v[128:131], a[56:59], a[64:67], v[128:131]
  v_mfma_f32_16x16x32_bf16 v[128:131], a[60:63], a[68:71], v[128:131]
  s_waitcnt lgkmcnt(0)
  s_barrier
  v_mfma_f32_16x16x32_bf16 v[36:39], a[32:35], a[72:75], v[36:39]
  v_mfma_f32_16x16x32_bf16 v[36:39], a[36:39], a[76:79], v[36:39]
  ds_read_b128 a[64:67], v7 offset:0
  ds_read_b128 a[68:71], v7 offset:8192
  v_mfma_f32_16x16x32_bf16 v[68:71], a[40:43], a[72:75], v[68:71]
  v_mfma_f32_16x16x32_bf16 v[68:71], a[44:47], a[76:79], v[68:71]
  ds_read_b128 a[0:3], v5 offset:0
  ds_read_b128 a[4:7], v6 offset:0
  v_mfma_f32_16x16x32_bf16 v[100:103], a[48:51], a[72:75], v[100:103]
  v_mfma_f32_16x16x32_bf16 v[100:103], a[52:55], a[76:79], v[100:103]
  ds_read_b128 a[8:11], v5 offset:2048
  ds_read_b128 a[12:15], v6 offset:2048
  v_mfma_f32_16x16x32_bf16 v[132:135], a[56:59], a[72:75], v[132:135]
  v_mfma_f32_16x16x32_bf16 v[132:135], a[60:63], a[76:79], v[132:135]
  ds_read_b128 a[16:19], v5 offset:4096
  v_mfma_f32_16x16x32_bf16 v[40:43], a[32:35], a[80:83], v[40:43]
  v_mfma_f32_16x16x32_bf16 v[40:43], a[36:39], a[84:87], v[40:43]
  ds_read_b128 a[72:75], v7 offset:256
  ds_read_b128 a[76:79], v7 offset:8448
  v_mfma_f32_16x16x32_bf16 v[72:75], a[40:43], a[80:83], v[72:75]
  v_mfma_f32_16x16x32_bf16 v[72:75], a[44:47], a[84:87], v[72:75]
  ds_read_b128 a[20:23], v6 offset:4096
  v_mfma_f32_16x16x32_bf16 v[104:107], a[48:51], a[80:83], v[104:107]
  v_mfma_f32_16x16x32_bf16 v[104:107], a[52:55], a[84:87], v[104:107]
  ds_read_b128 a[24:27], v5 offset:6144
  v_mfma_f32_16x16x32_bf16 v[136:139], a[56:59], a[80:83], v[136:139]
  v_mfma_f32_16x16x32_bf16 v[136:139], a[60:63], a[84:87], v[136:139]
  ds_read_b128 a[28:31], v6 offset:6144
  v_mfma_f32_16x16x32_bf16 v[44:47], a[32:35], a[88:91], v[44:47]
  v_mfma_f32_16x16x32_bf16 v[44:47], a[36:39], a[92:95], v[44:47]
  ds_read_b128 a[80:83], v7 offset:512
  ds_read_b128 a[84:87], v7 offset:8704
  v_mfma_f32_16x16x32_bf16 v[76:79], a[40:43], a[88:91], v[76:79]
  v_mfma_f32_16x16x32_bf16 v[76:79], a[44:47], a[92:95], v[76:79]
  v_mfma_f32_16x16x32_bf16 v[108:111], a[48:51], a[88:91], v[108:111]
  v_mfma_f32_16x16x32_bf16 v[108:111], a[52:55], a[92:95], v[108:111]
  v_mfma_f32_16x16x32_bf16 v[140:143], a[56:59], a[88:91], v[140:143]
  v_mfma_f32_16x16x32_bf16 v[140:143], a[60:63], a[92:95], v[140:143]
  s_add_u32 s60, s60, s62
  s_sub_u32 s61, s61, 1
  s_waitcnt lgkmcnt(0)
  s_cbranch_scc0 L_c
  v_mfma_f32_16x16x32_bf16 v[16:19], a[0:3], a[64:67], v[16:19]
  v_mfma_f32_16x16x32_bf16 v[16:19], a[4:7], a[68:71], v[16:19]
  ds_read_b128 a[88:91], v7 offset:768
  ds_read_b128 a[92:95], v7 offset:8960
  v_mfma_f32_16x16x32_bf16 v[48:51], a[8:11], a[64:67], v[48:51]
  v_mfma_f32_16x16x32_bf16 v[48:51], a[12:15], a[68:71], v[48:51]
  v_mfma_f32_16x16x32_bf16 v[80:83], a[16:19], a[64:67], v[80:83]
  v_mfma_f32_16x16x32_bf16 v[80:83], a[20:23], a[68:71], v[80:83]
  v_add_u32 v8, 49152, v144
  v_mfma_f32_16x16x32_bf16 v[112:115], a[24:27], a[64:67], v[112:115]
  v_mfma_f32_16x16x32_bf16 v[112:115], a[28:31], a[68:71], v[112:115]
  v_add_u32 v9, 49152, v145
  v_mfma_f32_16x16x32_bf16 v[20:23], a[0:3], a[72:75], v[20:23]
  v_mfma_f32_16x16x32_bf16 v[20:23], a[4:7], a[76:79], v[20:23]
  ds_read_b128 a[64:67], v7 offset:1024
  ds_read_b128 a[68:71], v7 offset:9216
  v_mfma_f32_16x16x32_bf16 v[52:55], a[8:11], a[72:75], v[52:55]
  v_mfma_f32_16x16x32_bf16 v[52:55], a[12:15], a[76:79], v[52:55]
  v_mfma_f32_16x16x32_bf16 v[84:87], a[16:19], a[72:75], v[84:87]
  v_mfma_f32_16x16x32_bf16 v[84:87], a[20:23], a[76:79], v[84:87]
  v_add_u32 v10, 49152, v146
  v_mfma_f32_16x16x32_bf16 v[116:119], a[24:27], a[72:75], v[116:119]
  v_mfma_f32_16x16x32_bf16 v[116:119], a[28:31], a[76:79], v[116:119]
  v_mfma_f32_16x16x32_bf16 v[24:27], a[0:3], a[80:83], v[24:27]
  v_mfma_f32_16x16x32_bf16 v[24:27], a[4:7], a[84:87], v[24:27]
  v_add_u32 v11, 98304, v144
  ds_read_b128 a[72:75], v7 offset:1280
  ds_read_b128 a[76:79], v7 offset:9472
  v_mfma_f32_16x16x32_bf16 v[56:59], a[8:11], a[80:83], v[56:59]
  v_mfma_f32_16x16x32_bf16 v[56:59], a[12:15], a[84:87], v[56:59]
  v_add_u32 v12, 98304, v145
  v_mfma_f32_16x16x32_bf16 v[88:91], a[16:19], a[80:83], v[88:91]
  v_mfma_f32_16x16x32_bf16 v[88:91], a[20:23], a[84:87], v[88:91]
  v_mfma_f32_16x16x32_bf16 v[120:123], a[24:27], a[80:83], v[120:123]
  v_mfma_f32_16x16x32_bf16 v[120:123], a[28:31], a[84:87], v[120:123]
  s_waitcnt lgkmcnt(0)
  s_nop 0
  v_mfma_f32_16x16x32_bf16 v[28:31], a[0:3], a[88:91], v[28:31]
  v_mfma_f32_16x16x32_bf16 v[28:31], a[4:7], a[92:95], v[28:31]
  v_add_u32 v13, 98304, v146
  ds_read_b128 a[80:83], v7 offset:1536
  ds_read_b128 a[84:87], v7 offset:9728
  v_mfma_f32_16x16x32_bf16 v[60:63], a[8:11], a[88:91], v[60:63]
  v_mfma_f32_16x16x32_bf16 v[60:63], a[12:15], a[92:95], v[60:63]
  v_mfma_f32_16x16x32_bf16 v[92:95], a[16:19], a[88:91], v[92:95]
  v_mfma_f32_16x16x32_bf16 v[92:95], a[20:23], a[92:95], v[92:95]
  v_mfma_f32_16x16x32_bf16 v[124:127], a[24:27], a[88:91], v[124:127]
  v_mfma_f32_16x16x32_bf16 v[124:127], a[28:31], a[92:95], v[124:127]
  v_mfma_f32_16x16x32_bf16 v[32:35], a[0:3], a[64:67], v[32:35]
  v_mfma_f32_16x16x32_bf16 v[32:35], a[4:7], a[68:71], v[32:35]
  ds_read_b128 a[88:91], v7 offset:1792
  ds_read_b128 a[92:95], v7 offset:9984
  v_mfma_f32_16x16x32_bf16 v[64:67], a[8:11], a[64:67], v[64:67]
  v_mfma_f32_16x16x32_bf16 v[64:67], a[12:15], a[68:71], v[64:67]
  v_mfma_f32_16x16x32_bf16 v[96:99], a[16:19], a[64:67], v[96:99]
  v_mfma_f32_16x16x32_bf16 v[96:99], a[20:23], a[68:71], v[96:99]
  v_mfma_f32_16x16x32_bf16 v[128:131], a[24:27], a[64:67], v[128:131]
  v_mfma_f32_16x16x32_bf16 v[128:131], a[28:31], a[68:71], v[128:131]
  s_waitcnt lgkmcnt(0)
  s_barrier
  v_mfma_f32_16x16x32_bf16 v[36:39], a[0:3], a[72:75], v[36:39]
  v_mfma_f32_16x16x32_bf16 v[36:39], a[4:7], a[76:79], v[36:39]
  v_mfma_f32_16x16x32_bf16 v[68:71], a[8:11], a[72:75], v[68:71]
  v_mfma_f32_16x16x32_bf16 v[68:71], a[12:15], a[76:79], v[68:71]
  v_mfma_f32_16x16x32_bf16 v[100:103], a[16:19], a[72:75], v[100:103]
  v_mfma_f32_16x16x32_bf16 v[100:103], a[20:23], a[76:79], v[100:103]
  v_mfma_f32_16x16x32_bf16 v[132:135], a[24:27], a[72:75], v[132:135]
  v_mfma_f32_16x16x32_bf16 v[132:135], a[28:31], a[76:79], v[132:135]
  v_mfma_f32_16x16x32_bf16 v[40:43], a[0:3], a[80:83], v[40:43]
  v_mfma_f32_16x16x32_bf16 v[40:43], a[4:7], a[84:87], v[40:43]
  ds_read_b128 a[32:35], v10 offset:0
  ds_read_b128 a[36:39], v8 offset:0
  v_mfma_f32_16x16x32_bf16 v[72:75], a[8:11], a[80:83], v[72:75]
  v_mfma_f32_16x16x32_bf16 v[72:75], a[12:15], a[84:87], v[72:75]
  ds_read_b128 a[40:43], v8 offset:2048
  ds_read_b128 a[44:47], v10 offset:256
  v_mfma_f32_16x16x32_bf16 v[104:107], a[16:19], a[80:83], v[104:107]
  v_mfma_f32_16x16x32_bf16 v[104:107], a[20:23], a[84:87], v[104:107]
  ds_read_b128 a[48:51], v10 offset:512
  ds_read_b128 a[52:55], v10 offset:768
  v_mfma_f32_16x16x32_bf16 v[136:139], a[24:27], a[80:83], v[136:139]
  v_mfma_f32_16x16x32_bf16 v[136:139], a[28:31], a[84:87], v[136:139]
  ds_read_b128 a[56:59], v10 offset:1024
  ds_read_b128 a[60:63], v10 offset:1280
  v_mfma_f32_16x16x32_bf16 v[44:47], a[0:3], a[88:91], v[44:47]
  v_mfma_f32_16x16x32_bf16 v[44:47], a[4:7], a[92:95], v[44:47]
  ds_read_b128 a[64:67], v10 offset:1536
  ds_read_b128 a[68:71], v10 offset:1792
  v_mfma_f32_16x16x32_bf16 v[76:79], a[8:11], a[88:91], v[76:79]
  v_mfma_f32_16x16x32_bf16 v[76:79], a[12:15], a[92:95], v[76:79]
  v_mfma_f32_16x16x32_bf16 v[108:111], a[16:19], a[88:91], v[108:111]
  v_mfma_f32_16x16x32_bf16 v[108:111], a[20:23], a[92:95], v[108:111]
  v_mfma_f32_16x16x32_bf16 v[140:143], a[24:27], a[88:91], v[140:143]
  v_mfma_f32_16x16x32_bf16 v[140:143], a[28:31], a[92:95], v[140:143]
  s_waitcnt lgkmcnt(0)
  s_nop 0
  v_mfma_f32_16x16x32_bf16 v[16:19], a[36:39], a[32:35], v[16:19]
  ds_read_b128 a[72:75], v10 offset:8192
  v_mfma_f32_16x16x32_bf16 v[48:51], a[40:43], a[32:35], v[48:51]
  ds_read_b128 a[76:79], v9 offset:0
  v_mfma_f32_16x16x32_bf16 v[20:23], a[36:39], a[44:47], v[20:23]
  ds_read_b128 a[80:83], v9 offset:2048
  v_mfma_f32_16x16x32_bf16 v[52:55], a[40:43], a[44:47], v[52:55]
  ds_read_b128 a[84:87], v10 offset:8448
  v_mfma_f32_16x16x32_bf16 v[24:27], a[36:39], a[48:51], v[24:27]
  ds_read_b128 a[0:3], v10 offset:8704
  v_mfma_f32_16x16x32_bf16 v[56:59], a[40:43], a[48:51], v[56:59]
  ds_read_b128 a[4:7], v10 offset:8960
  v_mfma_f32_16x16x32_bf16 v[28:31], a[36:39], a[52:55], v[28:31]
  ds_read_b128 a[8:11], v10 offset:9216
  v_mfma_f32_16x16x32_bf16 v[60:63], a[40:43], a[52:55], v[60:63]
  ds_read_b128 a[12:15], v10 offset:9472
  v_mfma_f32_16x16x32_bf16 v[32:35], a[36:39], a[56:59], v[32:35]
  ds_read_b128 a[16:19], v10 offset:9728
  v_mfma_f32_16x16x32_bf16 v[64:67], a[40:43], a[56:59], v[64:67]
  ds_read_b128 a[20:23], v10 offset:9984
  v_mfma_f32_16x16x32_bf16 v[36:39], a[36:39], a[60:63], v[36:39]
  v_mfma_f32_16x16x32_bf16 v[68:71], a[40:43], a[60:63], v[68:71]
  v_mfma_f32_16x16x32_bf16 v[40:43], a[36:39], a[64:67], v[40:43]
  v_mfma_f32_16x16x32_bf16 v[72:75], a[40:43], a[64:67], v[72:75]
  v_mfma_f32_16x16x32_bf16 v[44:47], a[36:39], a[68:71], v[44:47]
  v_mfma_f32_16x16x32_bf16 v[76:79], a[40:43], a[68:71], v[76:79]
  s_waitcnt lgkmcnt(0)
  s_nop 0
  v_mfma_f32_16x16x32_bf16 v[16:19], a[76:79], a[72:75], v[16:19]
  s_barrier
  ds_read_b128 a[24:27], v13 offset:0
  s_nop 0
  v_mfma_f32_16x16x32_bf16 v[48:51], a[80:83], a[72:75], v[48:51]
  ds_read_b128 a[28:31], v11 offset:0
  v_mfma_f32_16x16x32_bf16 v[20:23], a[76:79], a[84:87], v[20:23]
  ds_read_b128 a[88:91], v11 offset:2048
  v_mfma_f32_16x16x32_bf16 v[52:55], a[80:83], a[84:87], v[52:55]
  ds_read_b128 a[92:95], v13 offset:256
  v_mfma_f32_16x16x32_bf16 v[24:27], a[76:79], a[0:3], v[24:27]
  ds_read_b128 a[32:35], v13 offset:512
  v_mfma_f32_16x16x32_bf16 v[56:59], a[80:83], a[0:3], v[56:59]
  ds_read_b128 a[44:47], v13 offset:768
  v_mfma_f32_16x16x32_bf16 v[28:31], a[76:79], a[4:7], v[28:31]
  ds_read_b128 a[48:51], v13 offset:1024
  v_mfma_f32_16x16x32_bf16 v[60:63], a[80:83], a[4:7], v[60:63]
  ds_read_b128 a[52:55], v13 offset:1280
  v_mfma_f32_16x16x32_bf16 v[32:35], a[76:79], a[8:11], v[32:35]
  ds_read_b128 a[56:59], v13 offset:1536
  v_mfma_f32_16x16x32_bf16 v[64:67], a[80:83], a[8:11], v[64:67]
  ds_read_b128 a[60:63], v13 offset:1792
  v_mfma_f32_16x16x32_bf16 v[36:39], a[76:79], a[12:15], v[36:39]
  v_mfma_f32_16x16x32_bf16 v[68:71], a[80:83], a[12:15], v[68:71]
  v_mfma_f32_16x16x32_bf16 v[40:43], a[76:79], a[16:19], v[40:43]
  v_mfma_f32_16x16x32_bf16 v[72:75], a[80:83], a[16:19], v[72:75]
  v_mfma_f32_16x16x32_bf16 v[44:47], a[76:79], a[20:23], v[44:47]
  v_mfma_f32_16x16x32_bf16 v[76:79], a[80:83], a[20:23], v[76:79]
  s_waitcnt lgkmcnt(0)
  s_nop 0
  v_mfma_f32_16x16x32_bf16 v[16:19], a[28:31], a[24:27], v[16:19]
  ds_read_b128 a[64:67], v13 offset:8192
  v_mfma_f32_16x16x32_bf16 v[48:51], a[88:91], a[24:27], v[48:51]
  ds_read_b128 a[36:39], v12 offset:0
  v_mfma_f32_16x16x32_bf16 v[20:23], a[28:31], a[92:95], v[20:23]
  ds_read_b128 a[40:43], v12 offset:2048
  v_mfma_f32_16x16x32_bf16 v[52:55], a[88:91], a[92:95], v[52:55]
  ds_read_b128 a[68:71], v13 offset:8448
  v_mfma_f32_16x16x32_bf16 v[24:27], a[28:31], a[32:35], v[24:27]
  ds_read_b128 a[72:75], v13 offset:8704
  v_mfma_f32_16x16x32_bf16 v[56:59], a[88:91], a[32:35], v[56:59]
  ds_read_b128 a[84:87], v13 offset:8960
  v_mfma_f32_16x16x32_bf16 v[28:31], a[28:31], a[44:47], v[28:31]
  ds_read_b128 a[0:3], v13 offset:9216
  v_mfma_f32_16x16x32_bf16 v[60:63], a[88:91], a[44:47], v[60:63]
  ds_read_b128 a[4:7], v13 offset:9472
  v_mfma_f32_16x16x32_bf16 v[32:35], a[28:31], a[48:51], v[32:35]
  ds_read_b128 a[8:11], v13 offset:9728
  v_mfma_f32_16x16x32_bf16 v[64:67], a[88:91], a[48:51], v[64:67]
  ds_read_b128 a[12:15], v13 offset:9984
  v_mfma_f32_16x16x32_bf16 v[36:39], a[28:31], a[52:55], v[36:39]
  v_mfma_f32_16x16x32_bf16 v[68:71], a[88:91], a[52:55], v[68:71]
  v_mfma_f32_16x16x32_bf16 v[40:43], a[28:31], a[56:59], v[40:43]
  v_mfma_f32_16x16x32_bf16 v[72:75], a[88:91], a[56:59], v[72:75]
  v_mfma_f32_16x16x32_bf16 v[44:47], a[28:31], a[60:63], v[44:47]
  v_mfma_f32_16x16x32_bf16 v[76:79], a[88:91], a[60:63], v[76:79]
  s_waitcnt lgkmcnt(0)
  s_nop 0
  v_mfma_f32_16x16x32_bf16 v[16:19], a[36:39], a[64:67], v[16:19]
  s_barrier
  ds_read_b128 a[16:19], v146 offset:0
  s_nop 0
  v_mfma_f32_16x16x32_bf16 v[48:51], a[40:43], a[64:67], v[48:51]
  ds_read_b128 a[76:79], v144 offset:0
  v_mfma_f32_16x16x32_bf16 v[20:23], a[36:39], a[68:71], v[20:23]
  ds_read_b128 a[20:23], v144 offset:2048
  v_mfma_f32_16x16x32_bf16 v[52:55], a[40:43], a[68:71], v[52:55]
  ds_read_b128 a[80:83], v146 offset:256
  v_mfma_f32_16x16x32_bf16 v[24:27], a[36:39], a[72:75], v[24:27]
  ds_read_b128 a[24:27], v146 offset:512
  v_mfma_f32_16x16x32_bf16 v[56:59], a[40:43], a[72:75], v[56:59]
  ds_read_b128 a[92:95], v146 offset:768
  v_mfma_f32_16x16x32_bf16 v[28:31], a[36:39], a[84:87], v[28:31]
  ds_read_b128 a[32:35], v146 offset:1024
  v_mfma_f32_16x16x32_bf16 v[60:63], a[40:43], a[84:87], v[60:63]
  ds_read_b128 a[44:47], v146 offset:1280
  v_mfma_f32_16x16x32_bf16 v[32:35], a[36:39], a[0:3], v[32:35]
  ds_read_b128 a[48:51], v146 offset:1536
  v_mfma_f32_16x16x32_bf16 v[64:67], a[40:43], a[0:3], v[64:67]
  ds_read_b128 a[52:55], v146 offset:1792
  v_mfma_f32_16x16x32_bf16 v[36:39], a[36:39], a[4:7], v[36:39]
  v_mfma_f32_16x16x32_bf16 v[68:71], a[40:43], a[4:7], v[68:71]
  v_mfma_f32_16x16x32_bf16 v[40:43], a[36:39], a[8:11], v[40:43]
  v_mfma_f32_16x16x32_bf16 v[72:75], a[40:43], a[8:11], v[72:75]
  v_mfma_f32_16x16x32_bf16 v[44:47], a[36:39], a[12:15], v[44:47]
  v_mfma_f32_16x16x32_bf16 v[76:79], a[40:43], a[12:15], v[76:79]
  s_waitcnt lgkmcnt(0)
  s_nop 0
  v_mfma_f32_16x16x32_bf16 v[16:19], a[76:79], a[16:19], v[16:19]
  ds_read_b128 a[56:59], v146 offset:8192
  v_mfma_f32_16x16x32_bf16 v[48:51], a[20:23], a[16:19], v[48:51]
  ds_read_b128 a[28:31], v145 offset:0
  v_mfma_f32_16x16x32_bf16 v[20:23], a[76:79], a[80:83], v[20:23]
  ds_read_b128 a[60:63], v145 offset:2048
  v_mfma_f32_16x16x32_bf16 v[52:55], a[20:23], a[80:83], v[52:55]
  ds_read_b128 a[88:91], v146 offset:8448
  v_mfma_f32_16x16x32_bf16 v[24:27], a[76:79], a[24:27], v[24:27]
  ds_read_b128 a[64:67], v146 offset:8704
  v_mfma_f32_16x16x32_bf16 v[56:59], a[20:23], a[24:27], v[56:59]
  ds_read_b128 a[68:71], v146 offset:8960
  v_mfma_f32_16x16x32_bf16 v[28:31], a[76:79], a[92:95], v[28:31]
  ds_read_b128 a[72:75], v146 offset:9216
  v_mfma_f32_16x16x32_bf16 v[60:63], a[20:23], a[92:95], v[60:63]
  ds_read_b128 a[84:87], v146 offset:9472
  v_mfma_f32_16x16x32_bf16 v[32:35], a[76:79], a[32:35], v[32:35]
  ds_read_b128 a[0:3], v146 offset:9728
  v_mfma_f32_16x16x32_bf16 v[64:67], a[20:23], a[32:35], v[64:67]
  ds_read_b128 a[4:7], v146 offset:9984
  v_mfma_f32_16x16x32_bf16 v[36:39], a[76:79], a[44:47], v[36:39]
  v_mfma_f32_16x16x32_bf16 v[68:71], a[20:23], a[44:47], v[68:71]
  v_mfma_f32_16x16x32_bf16 v[40:43], a[76:79], a[48:51], v[40:43]
  v_mfma_f32_16x16x32_bf16 v[72:75], a[20:23], a[48:51], v[72:75]
  v_mfma_f32_16x16x32_bf16 v[44:47], a[76:79], a[52:55], v[44:47]
  v_mfma_f32_16x16x32_bf16 v[76:79], a[20:23], a[52:55], v[76:79]
  s_waitcnt lgkmcnt(0)
  s_nop 0
  v_mfma_f32_16x16x32_bf16 v[16:19], a[28:31], a[56:59], v[16:19]
  ds_read_b128 a[8:11], v10 offset:0
  v_mfma_f32_16x16x32_bf16 v[48:51], a[60:63], a[56:59], v[48:51]
  ds_read_b128 a[36:39], v8 offset:4096
  v_mfma_f32_16x16x32_bf16 v[20:23], a[28:31], a[88:91], v[20:23]
  ds_read_b128 a[12:15], v8 offset:6144
  v_mfma_f32_16x16x32_bf16 v[52:55], a[60:63], a[88:91], v[52:55]
  ds_read_b128 a[40:43], v10 offset:256
  v_mfma_f32_16x16x32_bf16 v[24:27], a[28:31], a[64:67], v[24:27]
  ds_read_b128 a[16:19], v10 offset:512
  v_mfma_f32_16x16x32_bf16 v[56:59], a[60:63], a[64:67], v[56:59]
  ds_read_b128 a[80:83], v10 offset:768
  v_mfma_f32_16x16x32_bf16 v[28:31], a[28:31], a[68:71], v[28:31]
  ds_read_b128 a[24:27], v10 offset:1024
  v_mfma_f32_16x16x32_bf16 v[60:63], a[60:63], a[68:71], v[60:63]
  ds_read_b128 a[92:95], v10 offset:1280
  v_mfma_f32_16x16x32_bf16 v[32:35], a[28:31], a[72:75], v[32:35]
  ds_read_b128 a[32:35], v10 offset:1536
  v_mfma_f32_16x16x32_bf16 v[64:67], a[60:63], a[72:75], v[64:67]
  ds_read_b128 a[44:47], v10 offset:1792
  v_mfma_f32_16x16x32_bf16 v[36:39], a[28:31], a[84:87], v[36:39]
  v_mfma_f32_16x16x32_bf16 v[68:71], a[60:63], a[84:87], v[68:71]
  v_mfma_f32_16x16x32_bf16 v[40:43], a[28:31], a[0:3], v[40:43]
  v_mfma_f32_16x16x32_bf16 v[72:75], a[60:63], a[0:3], v[72:75]
  v_mfma_f32_16x16x32_bf16 v[44:47], a[28:31], a[4:7], v[44:47]
  v_mfma_f32_16x16x32_bf16 v[76:79], a[60:63], a[4:7], v[76:79]
  s_waitcnt lgkmcnt(0)
  s_nop 0
  v_mfma_f32_16x16x32_bf16 v[80:83], a[36:39], a[8:11], v[80:83]
  ds_read_b128 a[48:51], v10 offset:8192
  v_mfma_f32_16x16x32_bf16 v[112:115], a[12:15], a[8:11], v[112:115]
  ds_read_b128 a[76:79], v9 offset:4096
  v_mfma_f32_16x16x32_bf16 v[84:87], a[36:39], a[40:43], v[84:87]
  v_cvt_pk_bf16_f32 v148, v16, v20
  ds_read_b128 a[20:23], v9 offset:6144
  v_mfma_f32_16x16x32_bf16 v[116:119], a[12:15], a[40:43], v[116:119]
  v_cvt_pk_bf16_f32 v149, v24, v28
  ds_read_b128 a[52:55], v10 offset:8448
  v_mfma_f32_16x16x32_bf16 v[88:91], a[36:39], a[16:19], v[88:91]
  ds_read_b128 a[56:59], v10 offset:8704
  v_mfma_f32_16x16x32_bf16 v[120:123], a[12:15], a[16:19], v[120:123]
  v_cvt_pk_bf16_f32 v150, v32, v36
  ds_read_b128 a[88:91], v10 offset:8960
  v_mfma_f32_16x16x32_bf16 v[92:95], a[36:39], a[80:83], v[92:95]
  v_cvt_pk_bf16_f32 v151, v40, v44
  ds_read_b128 a[64:67], v10 offset:9216
  v_mfma_f32_16x16x32_bf16 v[124:127], a[12:15], a[80:83], v[124:127]
  ds_read_b128 a[68:71], v10 offset:9472
  v_mfma_f32_16x16x32_bf16 v[96:99], a[36:39], a[24:27], v[96:99]
  buffer_store_dwordx4 v[148:151], v147, s[32:35], s44 offen sc0 sc1
  ds_read_b128 a[72:75], v10 offset:9728
  v_mfma_f32_16x16x32_bf16 v[128:131], a[12:15], a[24:27], v[128:131]
  v_cvt_pk_bf16_f32 v152, v17, v21
  ds_read_b128 a[84:87], v10 offset:9984
  v_mfma_f32_16x16x32_bf16 v[100:103], a[36:39], a[92:95], v[100:103]
  v_mfma_f32_16x16x32_bf16 v[132:135], a[12:15], a[92:95], v[132:135]
  v_cvt_pk_bf16_f32 v153, v25, v29
  v_mfma_f32_16x16x32_bf16 v[104:107], a[36:39], a[32:35], v[104:107]
  v_cvt_pk_bf16_f32 v154, v33, v37
  v_mfma_f32_16x16x32_bf16 v[136:139], a[12:15], a[32:35], v[136:139]
  v_mfma_f32_16x16x32_bf16 v[108:111], a[36:39], a[44:47], v[108:111]
  v_cvt_pk_bf16_f32 v155, v41, v45
  v_mfma_f32_16x16x32_bf16 v[140:143], a[12:15], a[44:47], v[140:143]
  buffer_store_dwordx4 v[152:155], v147, s[32:35], s45 offen sc0 sc1
  s_waitcnt lgkmcnt(0)
  s_nop 0
  v_mfma_f32_16x16x32_bf16 v[80:83], a[76:79], a[48:51], v[80:83]
  ds_read_b128 a[0:3], v13 offset:0
  v_mfma_f32_16x16x32_bf16 v[112:115], a[20:23], a[48:51], v[112:115]
  v_cvt_pk_bf16_f32 v156, v18, v22
  ds_read_b128 a[28:31], v11 offset:4096
  v_mfma_f32_16x16x32_bf16 v[84:87], a[76:79], a[52:55], v[84:87]
  v_cvt_pk_bf16_f32 v157, v26, v30
  ds_read_b128 a[4:7], v11 offset:6144
  v_mfma_f32_16x16x32_bf16 v[116:119], a[20:23], a[52:55], v[116:119]
  ds_read_b128 a[60:63], v13 offset:256
  v_mfma_f32_16x16x32_bf16 v[88:91], a[76:79], a[56:59], v[88:91]
  v_cvt_pk_bf16_f32 v158, v34, v38
  ds_read_b128 a[8:11], v13 offset:512
  v_mfma_f32_16x16x32_bf16 v[120:123], a[20:23], a[56:59], v[120:123]
  v_cvt_pk_bf16_f32 v159, v42, v46
  ds_read_b128 a[40:43], v13 offset:768
  v_mfma_f32_16x16x32_bf16 v[92:95], a[76:79], a[88:91], v[92:95]
  ds_read_b128 a[16:19], v13 offset:1024
  v_mfma_f32_16x16x32_bf16 v[124:127], a[20:23], a[88:91], v[124:127]
  buffer_store_dwordx4 v[156:159], v147, s[32:35], s46 offen sc0 sc1
  ds_read_b128 a[80:83], v13 offset:1280
  v_mfma_f32_16x16x32_bf16 v[96:99], a[76:79], a[64:67], v[96:99]
  v_cvt_pk_bf16_f32 v148, v19, v23
  ds_read_b128 a[24:27], v13 offset:1536
  v_mfma_f32_16x16x32_bf16 v[128:131], a[20:23], a[64:67], v[128:131]
  ds_read_b128 a[92:95], v13 offset:1792
  v_mfma_f32_16x16x32_bf16 v[100:103], a[76:79], a[68:71], v[100:103]
  v_cvt_pk_bf16_f32 v149, v27, v31
  v_mfma_f32_16x16x32_bf16 v[132:135], a[20:23], a[68:71], v[132:135]
  v_cvt_pk_bf16_f32 v150, v35, v39
  v_mfma_f32_16x16x32_bf16 v[104:107], a[76:79], a[72:75], v[104:107]
  v_mfma_f32_16x16x32_bf16 v[136:139], a[20:23], a[72:75], v[136:139]
  v_cvt_pk_bf16_f32 v151, v43, v47
  v_mfma_f32_16x16x32_bf16 v[108:111], a[76:79], a[84:87], v[108:111]
  buffer_store_dwordx4 v[148:151], v147, s[32:35], s47 offen sc0 sc1
  v_mfma_f32_16x16x32_bf16 v[140:143], a[20:23], a[84:87], v[140:143]
  s_waitcnt lgkmcnt(0)
  s_nop 0
  v_mfma_f32_16x16x32_bf16 v[80:83], a[28:31], a[0:3], v[80:83]
  v_cvt_pk_bf16_f32 v152, v48, v52
  ds_read_b128 a[32:35], v13 offset:8192
  v_mfma_f32_16x16x32_bf16 v[112:115], a[4:7], a[0:3], v[112:115]
  ds_read_b128 a[36:39], v12 offset:4096
  v_mfma_f32_16x16x32_bf16 v[84:87], a[28:31], a[60:63], v[84:87]
  v_cvt_pk_bf16_f32 v153, v56, v60
  ds_read_b128 a[12:15], v12 offset:6144
  v_mfma_f32_16x16x32_bf16 v[116:119], a[4:7], a[60:63], v[116:119]
  v_cvt_pk_bf16_f32 v154, v64, v68
  ds_read_b128 a[44:47], v13 offset:8448
  v_mfma_f32_16x16x32_bf16 v[88:91], a[28:31], a[8:11], v[88:91]
  ds_read_b128 a[48:51], v13 offset:8704
  v_mfma_f32_16x16x32_bf16 v[120:123], a[4:7], a[8:11], v[120:123]
  v_cvt_pk_bf16_f32 v155, v72, v76
  ds_read_b128 a[52:55], v13 offset:8960
  v_mfma_f32_16x16x32_bf16 v[92:95], a[28:31], a[40:43], v[92:95]
  buffer_store_dwordx4 v[152:155], v147, s[32:35], s48 offen sc0 sc1
  ds_read_b128 a[56:59], v13 offset:9216
  v_mfma_f32_16x16x32_bf16 v[124:127], a[4:7], a[40:43], v[124:127]
  ds_read_b128 a[88:91], v13 offset:9472
  v_mfma_f32_16x16x32_bf16 v[96:99], a[28:31], a[16:19], v[96:99]
  v_cvt_pk_bf16_f32 v156, v49, v53
  ds_read_b128 a[64:67], v13 offset:9728
  v_mfma_f32_16x16x32_bf16 v[128:131], a[4:7], a[16:19], v[128:131]
  v_cvt_pk_bf16_f32 v157, v57, v61
  ds_read_b128 a[68:71], v13 offset:9984
  v_mfma_f32_16x16x32_bf16 v[100:103], a[28:31], a[80:83], v[100:103]
  v_mfma_f32_16x16x32_bf16 v[132:135], a[4:7], a[80:83], v[132:135]
  v_cvt_pk_bf16_f32 v158, v65, v69
  v_mfma_f32_16x16x32_bf16 v[104:107], a[28:31], a[24:27], v[104:107]
  v_cvt_pk_bf16_f32 v159, v73, v77
  v_mfma_f32_16x16x32_bf16 v[136:139], a[4:7], a[24:27], v[136:139]
  v_mfma_f32_16x16x32_bf16 v[108:111], a[28:31], a[92:95], v[108:111]
  buffer_store_dwordx4 v[156:159], v147, s[32:35], s49 offen sc0 sc1
  v_mfma_f32_16x16x32_bf16 v[140:143], a[4:7], a[92:95], v[140:143]
  v_cvt_pk_bf16_f32 v148, v50, v54
  s_waitcnt lgkmcnt(0)
  s_nop 0
  v_mfma_f32_16x16x32_bf16 v[80:83], a[36:39], a[32:35], v[80:83]
  ds_read_b128 a[72:75], v146 offset:0
  v_mfma_f32_16x16x32_bf16 v[112:115], a[12:15], a[32:35], v[112:115]
  v_cvt_pk_bf16_f32 v149, v58, v62
  s_barrier
  ds_read_b128 a[76:79], v144 offset:4096
  s_nop 0
  v_mfma_f32_16x16x32_bf16 v[84:87], a[36:39], a[44:47], v[84:87]
  v_cvt_pk_bf16_f32 v150, v66, v70
  ds_read_b128 a[20:23], v144 offset:6144
  v_mfma_f32_16x16x32_bf16 v[116:119], a[12:15], a[44:47], v[116:119]
  ds_read_b128 a[84:87], v146 offset:256
  v_mfma_f32_16x16x32_bf16 v[88:91], a[36:39], a[48:51], v[88:91]
  v_cvt_pk_bf16_f32 v151, v74, v78
  ds_read_b128 a[0:3], v146 offset:512
  v_mfma_f32_16x16x32_bf16 v[120:123], a[12:15], a[48:51], v[120:123]
  buffer_store_dwordx4 v[148:151], v147, s[32:35], s50 offen sc0 sc1
  ds_read_b128 a[60:63], v146 offset:768
  v_mfma_f32_16x16x32_bf16 v[92:95], a[36:39], a[52:55], v[92:95]
  ds_read_b128 a[8:11], v146 offset:1024
  v_mfma_f32_16x16x32_bf16 v[124:127], a[12:15], a[52:55], v[124:127]
  v_cvt_pk_bf16_f32 v152, v51, v55
  ds_read_b128 a[40:43], v146 offset:1280
  v_mfma_f32_16x16x32_bf16 v[96:99], a[36:39], a[56:59], v[96:99]
  v_cvt_pk_bf16_f32 v153, v59, v63
  ds_read_b128 a[16:19], v146 offset:1536
  v_mfma_f32_16x16x32_bf16 v[128:131], a[12:15], a[56:59], v[128:131]
  ds_read_b128 a[80:83], v146 offset:1792
  v_mfma_f32_16x16x32_bf16 v[100:103], a[36:39], a[88:91], v[100:103]
  v_cvt_pk_bf16_f32 v154, v67, v71
  v_mfma_f32_16x16x32_bf16 v[132:135], a[12:15], a[88:91], v[132:135]
  v_cvt_pk_bf16_f32 v155, v75, v79
  v_mfma_f32_16x16x32_bf16 v[104:107], a[36:39], a[64:67], v[104:107]
  v_mfma_f32_16x16x32_bf16 v[136:139], a[12:15], a[64:67], v[136:139]
  buffer_store_dwordx4 v[152:155], v147, s[32:35], s51 offen sc0 sc1
  v_mfma_f32_16x16x32_bf16 v[108:111], a[36:39], a[68:71], v[108:111]
  v_mfma_f32_16x16x32_bf16 v[140:143], a[12:15], a[68:71], v[140:143]
  s_waitcnt lgkmcnt(0)
  s_nop 0
  v_mfma_f32_16x16x32_bf16 v[80:83], a[76:79], a[72:75], v[80:83]
  ds_read_b128 a[24:27], v146 offset:8192
  v_mfma_f32_16x16x32_bf16 v[112:115], a[20:23], a[72:75], v[112:115]
  ds_read_b128 a[28:31], v145 offset:4096
  v_mfma_f32_16x16x32_bf16 v[84:87], a[76:79], a[84:87], v[84:87]
  ds_read_b128 a[4:7], v145 offset:6144
  v_mfma_f32_16x16x32_bf16 v[116:119], a[20:23], a[84:87], v[116:119]
  ds_read_b128 a[92:95], v146 offset:8448
  v_mfma_f32_16x16x32_bf16 v[88:91], a[76:79], a[0:3], v[88:91]
  ds_read_b128 a[32:35], v146 offset:8704
  v_mfma_f32_16x16x32_bf16 v[120:123], a[20:23], a[0:3], v[120:123]
  ds_read_b128 a[44:47], v146 offset:8960
  v_mfma_f32_16x16x32_bf16 v[92:95], a[76:79], a[60:63], v[92:95]
  ds_read_b128 a[48:51], v146 offset:9216
  v_mfma_f32_16x16x32_bf16 v[124:127], a[20:23], a[60:63], v[124:127]
  ds_read_b128 a[52:55], v146 offset:9472
  v_mfma_f32_16x16x32_bf16 v[96:99], a[76:79], a[8:11], v[96:99]
  ds_read_b128 a[56:59], v146 offset:9728
  v_mfma_f32_16x16x32_bf16 v[128:131], a[20:23], a[8:11], v[128:131]
  ds_read_b128 a[88:91], v146 offset:9984
  v_mfma_f32_16x16x32_bf16 v[100:103], a[76:79], a[40:43], v[100:103]
  v_mfma_f32_16x16x32_bf16 v[132:135], a[20:23], a[40:43], v[132:135]
  v_mfma_f32_16x16x32_bf16 v[104:107], a[76:79], a[16:19], v[104:107]
  v_mfma_f32_16x16x32_bf16 v[136:139], a[20:23], a[16:19], v[136:139]
  v_mfma_f32_16x16x32_bf16 v[108:111], a[76:79], a[80:83], v[108:111]
  v_mfma_f32_16x16x32_bf16 v[140:143], a[20:23], a[80:83], v[140:143]
  s_waitcnt lgkmcnt(0)
  s_nop 0
  v_mfma_f32_16x16x32_bf16 v[80:83], a[28:31], a[24:27], v[80:83]
  v_mfma_f32_16x16x32_bf16 v[84:87], a[28:31], a[92:95], v[84:87]
  v_mfma_f32_16x16x32_bf16 v[88:91], a[28:31], a[32:35], v[88:91]
  v_mfma_f32_16x16x32_bf16 v[92:95], a[28:31], a[44:47], v[92:95]
  v_mfma_f32_16x16x32_bf16 v[96:99], a[28:31], a[48:51], v[96:99]
  v_mfma_f32_16x16x32_bf16 v[100:103], a[28:31], a[52:55], v[100:103]
  v_mfma_f32_16x16x32_bf16 v[104:107], a[28:31], a[56:59], v[104:107]
  v_mfma_f32_16x16x32_bf16 v[108:111], a[28:31], a[88:91], v[108:111]
  v_mfma_f32_16x16x32_bf16 v[112:115], a[4:7], a[24:27], v[112:115]
  v_mfma_f32_16x16x32_bf16 v[116:119], a[4:7], a[92:95], v[116:119]
  v_mfma_f32_16x16x32_bf16 v[120:123], a[4:7], a[32:35], v[120:123]
  v_mfma_f32_16x16x32_bf16 v[124:127], a[4:7], a[44:47], v[124:127]
  v_mfma_f32_16x16x32_bf16 v[128:131], a[4:7], a[48:51], v[128:131]
  v_mfma_f32_16x16x32_bf16 v[132:135], a[4:7], a[52:55], v[132:135]
  v_mfma_f32_16x16x32_bf16 v[136:139], a[4:7], a[56:59], v[136:139]
  v_mfma_f32_16x16x32_bf16 v[140:143], a[4:7], a[88:91], v[140:143]
  v_cvt_pk_bf16_f32 v156, v80, v84
  v_cvt_pk_bf16_f32 v157, v88, v92
  v_cvt_pk_bf16_f32 v158, v96, v100
  v_cvt_pk_bf16_f32 v159, v104, v108
  buffer_store_dwordx4 v[156:159], v147, s[32:35], s52 offen sc0 sc1
  v_cvt_pk_bf16_f32 v148, v81, v85
  v_cvt_pk_bf16_f32 v149, v89, v93
  v_cvt_pk_bf16_f32 v150, v97, v101
  v_cvt_pk_bf16_f32 v151, v105, v109
  buffer_store_dwordx4 v[148:151], v147, s[32:35], s53 offen sc0 sc1
  v_cvt_pk_bf16_f32 v152, v82, v86
  v_cvt_pk_bf16_f32 v153, v90, v94
  v_cvt_pk_bf16_f32 v154, v98, v102
  v_cvt_pk_bf16_f32 v155, v106, v110
  buffer_store_dwordx4 v[152:155], v147, s[32:35], s54 offen sc0 sc1
  v_cvt_pk_bf16_f32 v156, v83, v87
  v_cvt_pk_bf16_f32 v157, v91, v95
  v_cvt_pk_bf16_f32 v158, v99, v103
  v_cvt_pk_bf16_f32 v159, v107, v111
  buffer_store_dwordx4 v[156:159], v147, s[32:35], s55 offen sc0 sc1
  v_cvt_pk_bf16_f32 v148, v112, v116
  v_cvt_pk_bf16_f32 v149, v120, v124
  v_cvt_pk_bf16_f32 v150, v128, v132
  v_cvt_pk_bf16_f32 v151, v136, v140
  buffer_store_dwordx4 v[148:151], v147, s[32:35], s56 offen sc0 sc1
  v_cvt_pk_bf16_f32 v152, v113, v117
  v_cvt_pk_bf16_f32 v153, v121, v125
  v_cvt_pk_bf16_f32 v154, v129, v133
  v_cvt_pk_bf16_f32 v155, v137, v141
  buffer_store_dwordx4 v[152:155], v147, s[32:35], s57 offen sc0 sc1
  v_cvt_pk_bf16_f32 v156, v114, v118
  v_cvt_pk_bf16_f32 v157, v122, v126
  v_cvt_pk_bf16_f32 v158, v130, v134
  v_cvt_pk_bf16_f32 v159, v138, v142
  buffer_store_dwordx4 v[156:159], v147, s[32:35], s58 offen sc0 sc1
  v_cvt_pk_bf16_f32 v148, v115, v119
  v_cvt_pk_bf16_f32 v149, v123, v127
  v_cvt_pk_bf16_f32 v150, v131, v135
  v_cvt_pk_bf16_f32 v151, v139, v143
  buffer_store_dwordx4 v[148:151], v147, s[32:35], s59 offen sc0 sc1
  s_endpgm
L_loader:
  s_waitcnt vmcnt(0)
  s_mov_b64 exec, 3
  buffer_store_dwordx2 v[10:11], v14, s[28:31], 0 offen sc1
  s_mov_b64 exec, -1
  s_barrier
  s_add_u32 s43, s40, 0
  s_lshl_b32 s43, s43, 10
  s_load_dwordx4 s[64:67], s[4:5], s43 glc
  s_add_u32 s41, s40, 0
  s_lshl_b32 s41, s41, 7
  s_add_u32 m0, s60, 49152
  s_nop 0
  buffer_load_dwordx4 v16, s[16:19], s41 offen offset:0 lds
  buffer_load_dwordx4 v17, s[16:19], s41 offen offset:1024 lds
  buffer_load_dwordx4 v18, s[16:19], s41 offen offset:2048 lds
  buffer_load_dwordx4 v19, s[16:19], s41 offen offset:3072 lds
  s_add_u32 m0, s60, 53248
  s_add_u32 s41, s41, 65536
  buffer_load_dwordx4 v16, s[16:19], s41 offen offset:0 lds
  buffer_load_dwordx4 v17, s[16:19], s41 offen offset:1024 lds
  buffer_load_dwordx4 v18, s[16:19], s41 offen offset:2048 lds
  buffer_load_dwordx4 v19, s[16:19], s41 offen offset:3072 lds
  s_mov_b32 s63, 0
L_sp1:
  s_waitcnt lgkmcnt(0)
  s_xor_b64 s[10:11], s[64:65], s[8:9]
  s_xor_b64 s[14:15], s[66:67], s[8:9]
  s_or_b64 s[10:11], s[10:11], s[14:15]
  s_cbranch_scc0 L_ok1
  s_load_dwordx4 s[64:67], s[4:5], s43 glc
  s_add_u32 s63, s63, 1
  s_cmp_lt_u32 s63, 20000
  s_cbranch_scc1 L_sp1
  s_waitcnt lgkmcnt(0)
L_ok1:
  s_add_u32 s43, s40, 1
  s_lshl_b32 s43, s43, 10
  s_load_dwordx4 s[64:67], s[4:5], s43 glc
  s_add_u32 m0, s61, 49152
  s_add_u32 s62, s40, 0
  s_lshl_b32 s62, s62, 14
  buffer_load_dwordx4 v20, s[28:31], s62 offen offset:0 sc1 lds
  buffer_load_dwordx4 v20, s[28:31], s62 offen offset:1024 sc1 lds
  buffer_load_dwordx4 v20, s[28:31], s62 offen offset:2048 sc1 lds
  buffer_load_dwordx4 v20, s[28:31], s62 offen offset:3072 sc1 lds
  s_add_u32 s41, s40, 1
  s_lshl_b32 s41, s41, 7
  s_add_u32 m0, s60, 98304
  s_nop 0
  buffer_load_dwordx4 v16, s[16:19], s41 offen offset:0 lds
  buffer_load_dwordx4 v17, s[16:19], s41 offen offset:1024 lds
  buffer_load_dwordx4 v18, s[16:19], s41 offen offset:2048 lds
  buffer_load_dwordx4 v19, s[16:19], s41 offen offset:3072 lds
  s_add_u32 m0, s60, 102400
  s_add_u32 s41, s41, 65536
  buffer_load_dwordx4 v16, s[16:19], s41 offen offset:0 lds
  buffer_load_dwordx4 v17, s[16:19], s41 offen offset:1024 lds
  buffer_load_dwordx4 v18, s[16:19], s41 offen offset:2048 lds
  buffer_load_dwordx4 v19, s[16:19], s41 offen offset:3072 lds
  s_mov_b32 s63, 0
L_sp2:
  s_waitcnt lgkmcnt(0)
  s_xor_b64 s[10:11], s[64:65], s[8:9]
  s_xor_b64 s[14:15], s[66:67], s[8:9]
  s_or_b64 s[10:11], s[10:11], s[14:15]
  s_cbranch_scc0 L_ok2
  s_load_dwordx4 s[64:67], s[4:5], s43 glc
  s_add_u32 s63, s63, 1
  s_cmp_lt_u32 s63, 20000
  s_cbranch_scc1 L_sp2
  s_waitcnt lgkmcnt(0)
L_ok2:
  s_add_u32 s43, s40, 2
  s_lshl_b32 s43, s43, 10
  s_load_dwordx4 s[64:67], s[4:5], s43 glc
  s_add_u32 m0, s61, 98304
  s_add_u32 s62, s40, 1
  s_lshl_b32 s62, s62, 14
  buffer_load_dwordx4 v20, s[28:31], s62 offen offset:0 sc1 lds
  buffer_load_dwordx4 v20, s[28:31], s62 offen offset:1024 sc1 lds
  buffer_load_dwordx4 v20, s[28:31], s62 offen offset:2048 sc1 lds
  buffer_load_dwordx4 v20, s[28:31], s62 offen offset:3072 sc1 lds
  s_add_u32 s58, s40, 3
  s_lshl_b32 s58, s58, 7
  s_load_dword s68, s[12:13], s58 offset:0
  s_load_dword s69, s[12:13], s58 offset:64
  s_load_dword s70, s[12:13], s58 offset:2048
  s_load_dword s71, s[12:13], s58 offset:2112
  s_load_dword s72, s[12:13], s58 offset:4096
  s_load_dword s73, s[12:13], s58 offset:4160
  s_xor_b32 s58, s40, 4
  s_cmp_ge_u32 s58, s36
  s_addc_u32 s58, s58, 0
  s_lshl_b32 s58, s58, 7
  s_load_dword s68, s[12:13], s58 offset:0
  s_load_dword s69, s[12:13], s58 offset:64
  s_load_dword s70, s[12:13], s58 offset:2048
  s_load_dword s71, s[12:13], s58 offset:2112
  s_load_dword s72, s[12:13], s58 offset:4096
  s_load_dword s73, s[12:13], s58 offset:4160
  s_waitcnt vmcnt(12)
  s_barrier
  s_add_u32 s41, s40, 2
  s_lshl_b32 s41, s41, 7
  s_add_u32 m0, s60, 0
  s_nop 0
  buffer_load_dwordx4 v16, s[16:19], s41 offen offset:0 lds
  buffer_load_dwordx4 v17, s[16:19], s41 offen offset:1024 lds
  buffer_load_dwordx4 v18, s[16:19], s41 offen offset:2048 lds
  buffer_load_dwordx4 v19, s[16:19], s41 offen offset:3072 lds
  s_add_u32 m0, s60, 4096
  s_add_u32 s41, s41, 65536
  buffer_load_dwordx4 v16, s[16:19], s41 offen offset:0 lds
  buffer_load_dwordx4 v17, s[16:19], s41 offen offset:1024 lds
  buffer_load_dwordx4 v18, s[16:19], s41 offen offset:2048 lds
  buffer_load_dwordx4 v19, s[16:19], s41 offen offset:3072 lds
  s_mov_b32 s63, 0
L_sp3:
  s_waitcnt lgkmcnt(0)
  s_xor_b64 s[10:11], s[64:65], s[8:9]
  s_xor_b64 s[14:15], s[66:67], s[8:9]
  s_or_b64 s[10:11], s[10:11], s[14:15]
  s_cbranch_scc0 L_ok3
  s_load_dwordx4 s[64:67], s[4:5], s43 glc
  s_add_u32 s63, s63, 1
  s_cmp_lt_u32 s63, 20000
  s_cbranch_scc1 L_sp3
  s_waitcnt lgkmcnt(0)
L_ok3:
  s_add_u32 s43, s40, 3
  s_lshl_b32 s43, s43, 10
  s_load_dwordx4 s[64:67], s[4:5], s43 glc
  s_add_u32 m0, s61, 0
  s_add_u32 s62, s40, 2
  s_lshl_b32 s62, s62, 14
  buffer_load_dwordx4 v20, s[28:31], s62 offen offset:0 sc1 lds
  buffer_load_dwordx4 v20, s[28:31], s62 offen offset:1024 sc1 lds
  buffer_load_dwordx4 v20, s[28:31], s62 offen offset:2048 sc1 lds
  buffer_load_dwordx4 v20, s[28:31], s62 offen offset:3072 sc1 lds
  s_xor_b32 s58, s40, 5
  s_cmp_ge_u32 s58, s36
  s_addc_u32 s58, s58, 0
  s_lshl_b32 s58, s58, 7
  s_load_dword s68, s[12:13], s58 offset:0
  s_load_dword s69, s[12:13], s58 offset:64
  s_load_dword s70, s[12:13], s58 offset:2048
  s_load_dword s71, s[12:13], s58 offset:2112
  s_load_dword s72, s[12:13], s58 offset:4096
  s_load_dword s73, s[12:13], s58 offset:4160
  s_waitcnt vmcnt(12)
  s_barrier
  s_add_u32 s41, s40, 3
  s_lshl_b32 s41, s41, 7
  s_add_u32 m0, s60, 49152
  s_nop 0
  buffer_load_dwordx4 v16, s[16:19], s41 offen offset:0 lds
  buffer_load_dwordx4 v17, s[16:19], s41 offen offset:1024 lds
  buffer_load_dwordx4 v18, s[16:19], s41 offen offset:2048 lds
  buffer_load_dwordx4 v19, s[16:19], s41 offen offset:3072 lds
  s_add_u32 m0, s60, 53248
  s_add_u32 s41, s41, 65536
  buffer_load_dwordx4 v16, s[16:19], s41 offen offset:0 lds
  buffer_load_dwordx4 v17, s[16:19], s41 offen offset:1024 lds
  buffer_load_dwordx4 v18, s[16:19], s41 offen offset:2048 lds
  buffer_load_dwordx4 v19, s[16:19], s41 offen offset:3072 lds
  s_mov_b32 s63, 0
L_sp4:
  s_waitcnt lgkmcnt(0)
  s_xor_b64 s[10:11], s[64:65], s[8:9]
  s_xor_b64 s[14:15], s[66:67], s[8:9]
  s_or_b64 s[10:11], s[10:11], s[14:15]
  s_cbranch_scc0 L_ok4
  s_load_dwordx4 s[64:67], s[4:5], s43 glc
  s_add_u32 s63, s63, 1
  s_cmp_lt_u32 s63, 20000
  s_cbranch_scc1 L_sp4
  s_waitcnt lgkmcnt(0)
L_ok4:
  s_xor_b32 s43, s40, 4
  s_cmp_ge_u32 s43, s36
  s_addc_u32 s43, s43, 0
  s_lshl_b32 s43, s43, 10
  s_load_dwordx4 s[64:67], s[4:5], s43 glc
  s_add_u32 m0, s61, 49152
  s_add_u32 s62, s40, 3
  s_lshl_b32 s62, s62, 14
  buffer_load_dwordx4 v20, s[28:31], s62 offen offset:0 sc1 lds
  buffer_load_dwordx4 v20, s[28:31], s62 offen offset:1024 sc1 lds
  buffer_load_dwordx4 v20, s[28:31], s62 offen offset:2048 sc1 lds
  buffer_load_dwordx4 v20, s[28:31], s62 offen offset:3072 sc1 lds
  s_xor_b32 s58, s40, 6
  s_cmp_ge_u32 s58, s36
  s_addc_u32 s58, s58, 0
  s_lshl_b32 s58, s58, 7
  s_load_dword s68, s[12:13], s58 offset:0
  s_load_dword s69, s[12:13], s58 offset:64
  s_load_dword s70, s[12:13], s58 offset:2048
  s_load_dword s71, s[12:13], s58 offset:2112
  s_load_dword s72, s[12:13], s58 offset:4096
  s_load_dword s73, s[12:13], s58 offset:4160
  s_waitcnt vmcnt(12)
  s_barrier
  s_xor_b32 s41, s40, 4
  s_cmp_ge_u32 s41, s36
  s_addc_u32 s41, s41, 0
  s_lshl_b32 s41, s41, 7
  s_add_u32 m0, s60, 98304
  s_nop 0
  buffer_load_dwordx4 v16, s[16:19], s41 offen offset:0 lds
  buffer_load_dwordx4 v17, s[16:19], s41 offen offset:1024 lds
  buffer_load_dwordx4 v18, s[16:19], s41 offen offset:2048 lds
  buffer_load_dwordx4 v19, s[16:19], s41 offen offset:3072 lds
  s_add_u32 m0, s60, 102400
  s_add_u32 s41, s41, 65536
  buffer_load_dwordx4 v16, s[16:19], s41 offen offset:0 lds
  buffer_load_dwordx4 v17, s[16:19], s41 offen offset:1024 lds
  buffer_load_dwordx4 v18, s[16:19], s41 offen offset:2048 lds
  buffer_load_dwordx4 v19, s[16:19], s41 offen offset:3072 lds
  s_mov_b32 s63, 0
L_sp5:
  s_waitcnt lgkmcnt(0)
  s_xor_b64 s[10:11], s[64:65], s[8:9]
  s_xor_b64 s[14:15], s[66:67], s[8:9]
  s_or_b64 s[10:11], s[10:11], s[14:15]
  s_cbranch_scc0 L_ok5
  s_load_dwordx4 s[64:67], s[4:5], s43 glc
  s_add_u32 s63, s63, 1
  s_cmp_lt_u32 s63, 20000
  s_cbranch_scc1 L_sp5
  s_waitcnt lgkmcnt(0)
L_ok5:
  s_xor_b32 s43, s40, 5
  s_cmp_ge_u32 s43, s36
  s_addc_u32 s43, s43, 0
  s_lshl_b32 s43, s43, 10
  s_load_dwordx4 s[64:67], s[4:5], s43 glc
  s_add_u32 m0, s61, 98304
  s_xor_b32 s62, s40, 4
  s_cmp_ge_u32 s62, s36
  s_addc_u32 s62, s62, 0
  s_lshl_b32 s62, s62, 14
  buffer_load_dwordx4 v20, s[28:31], s62 offen offset:0 sc1 lds
  buffer_load_dwordx4 v20, s[28:31], s62 offen offset:1024 sc1 lds
  buffer_load_dwordx4 v20, s[28:31], s62 offen offset:2048 sc1 lds
  buffer_load_dwordx4 v20, s[28:31], s62 offen offset:3072 sc1 lds
  s_mov_b32 s58, 1024
  s_load_dword s68, s[12:13], s58 offset:0
  s_load_dword s69, s[12:13], s58 offset:64
  s_load_dword s70, s[12:13], s58 offset:2048
  s_load_dword s71, s[12:13], s58 offset:2112
  s_load_dword s72, s[12:13], s58 offset:4096
  s_load_dword s73, s[12:13], s58 offset:4160
  s_waitcnt vmcnt(12)
  s_barrier
  s_xor_b32 s41, s40, 5
  s_cmp_ge_u32 s41, s36
  s_addc_u32 s41, s41, 0
  s_lshl_b32 s41, s41, 7
  s_add_u32 m0, s60, 0
  s_nop 0
  buffer_load_dwordx4 v16, s[16:19], s41 offen offset:0 lds
  buffer_load_dwordx4 v17, s[16:19], s41 offen offset:1024 lds
  buffer_load_dwordx4 v18, s[16:19], s41 offen offset:2048 lds
  buffer_load_dwordx4 v19, s[16:19], s41 offen offset:3072 lds
  s_add_u32 m0, s60, 4096
  s_add_u32 s41, s41, 65536
  buffer_load_dwordx4 v16, s[16:19], s41 offen offset:0 lds
  buffer_load_dwordx4 v17, s[16:19], s41 offen offset:1024 lds
  buffer_load_dwordx4 v18, s[16:19], s41 offen offset:2048 lds
  buffer_load_dwordx4 v19, s[16:19], s41 offen offset:3072 lds
  s_mov_b32 s63, 0
L_sp6:
  s_waitcnt lgkmcnt(0)
  s_xor_b64 s[10:11], s[64:65], s[8:9]
  s_xor_b64 s[14:15], s[66:67], s[8:9]
  s_or_b64 s[10:11], s[10:11], s[14:15]
  s_cbranch_scc0 L_ok6
  s_load_dwordx4 s[64:67], s[4:5], s43 glc
  s_add_u32 s63, s63, 1
  s_cmp_lt_u32 s63, 20000
  s_cbranch_scc1 L_sp6
  s_waitcnt lgkmcnt(0)
L_ok6:
  s_xor_b32 s43, s40, 6
  s_cmp_ge_u32 s43, s36
  s_addc_u32 s43, s43, 0
  s_lshl_b32 s43, s43, 10
  s_load_dwordx4 s[64:67], s[4:5], s43 glc
  s_add_u32 m0, s61, 0
  s_xor_b32 s62, s40, 5
  s_cmp_ge_u32 s62, s36
  s_addc_u32 s62, s62, 0
  s_lshl_b32 s62, s62, 14
  buffer_load_dwordx4 v20, s[28:31], s62 offen offset:0 sc1 lds
  buffer_load_dwordx4 v20, s[28:31], s62 offen offset:1024 sc1 lds
  buffer_load_dwordx4 v20, s[28:31], s62 offen offset:2048 sc1 lds
  buffer_load_dwordx4 v20, s[28:31], s62 offen offset:3072 sc1 lds
  s_mov_b32 s58, 1152
  s_load_dword s68, s[12:13], s58 offset:0
  s_load_dword s69, s[12:13], s58 offset:64
  s_load_dword s70, s[12:13], s58 offset:2048
  s_load_dword s71, s[12:13], s58 offset:2112
  s_load_dword s72, s[12:13], s58 offset:4096
  s_load_dword s73, s[12:13], s58 offset:4160
  s_waitcnt vmcnt(12)
  s_barrier
  s_xor_b32 s41, s40, 6
  s_cmp_ge_u32 s41, s36
  s_addc_u32 s41, s41, 0
  s_lshl_b32 s41, s41, 7
  s_add_u32 m0, s60, 49152
  s_nop 0
  buffer_load_dwordx4 v16, s[16:19], s41 offen offset:0 lds
  buffer_load_dwordx4 v17, s[16:19], s41 offen offset:1024 lds
  buffer_load_dwordx4 v18, s[16:19], s41 offen offset:2048 lds
  buffer_load_dwordx4 v19, s[16:19], s41 offen offset:3072 lds
  s_add_u32 m0, s60, 53248
  s_add_u32 s41, s41, 65536
  buffer_load_dwordx4 v16, s[16:19], s41 offen offset:0 lds
  buffer_load_dwordx4 v17, s[16:19], s41 offen offset:1024 lds
  buffer_load_dwordx4 v18, s[16:19], s41 offen offset:2048 lds
  buffer_load_dwordx4 v19, s[16:19], s41 offen offset:3072 lds
  s_mov_b32 s63, 0
L_sp7:
  s_waitcnt lgkmcnt(0)
  s_xor_b64 s[10:11], s[64:65], s[8:9]
  s_xor_b64 s[14:15], s[66:67], s[8:9]
  s_or_b64 s[10:11], s[10:11], s[14:15]
  s_cbranch_scc0 L_ok7
  s_load_dwordx4 s[64:67], s[4:5], s43 glc
  s_add_u32 s63, s63, 1
  s_cmp_lt_u32 s63, 20000
  s_cbranch_scc1 L_sp7
  s_waitcnt lgkmcnt(0)
L_ok7:
  s_mov_b32 s43, 8192
  s_load_dwordx4 s[64:67], s[4:5], s43 glc
  s_add_u32 m0, s61, 49152
  s_xor_b32 s62, s40, 6
  s_cmp_ge_u32 s62, s36
  s_addc_u32 s62, s62, 0
  s_lshl_b32 s62, s62, 14
  buffer_load_dwordx4 v20, s[28:31], s62 offen offset:0 sc1 lds
  buffer_load_dwordx4 v20, s[28:31], s62 offen offset:1024 sc1 lds
  buffer_load_dwordx4 v20, s[28:31], s62 offen offset:2048 sc1 lds
  buffer_load_dwordx4 v20, s[28:31], s62 offen offset:3072 sc1 lds
  s_mov_b32 s58, 1280
  s_load_dword s68, s[12:13], s58 offset:0
  s_load_dword s69, s[12:13], s58 offset:64
  s_load_dword s70, s[12:13], s58 offset:2048
  s_load_dword s71, s[12:13], s58 offset:2112
  s_load_dword s72, s[12:13], s58 offset:4096
  s_load_dword s73, s[12:13], s58 offset:4160
  s_waitcnt vmcnt(12)
  s_barrier
  s_mov_b32 s41, 1024
  s_add_u32 m0, s60, 98304
  s_nop 0
  buffer_load_dwordx4 v16, s[16:19], s41 offen offset:0 lds
  buffer_load_dwordx4 v17, s[16:19], s41 offen offset:1024 lds
  buffer_load_dwordx4 v18, s[16:19], s41 offen offset:2048 lds
  buffer_load_dwordx4 v19, s[16:19], s41 offen offset:3072 lds
  s_add_u32 m0, s60, 102400
  s_add_u32 s41, s41, 65536
  buffer_load_dwordx4 v16, s[16:19], s41 offen offset:0 lds
  buffer_load_dwordx4 v17, s[16:19], s41 offen offset:1024 lds
  buffer_load_dwordx4 v18, s[16:19], s41 offen offset:2048 lds
  buffer_load_dwordx4 v19, s[16:19], s41 offen offset:3072 lds
  s_mov_b32 s63, 0
L_sp8:
  s_waitcnt lgkmcnt(0)
  s_xor_b64 s[10:11], s[64:65], s[8:9]
  s_xor_b64 s[14:15], s[66:67], s[8:9]
  s_or_b64 s[10:11], s[10:11], s[14:15]
  s_cbranch_scc0 L_ok8
  s_load_dwordx4 s[64:67], s[4:5], s43 glc
  s_add_u32 s63, s63, 1
  s_cmp_lt_u32 s63, 20000
  s_cbranch_scc1 L_sp8
  s_waitcnt lgkmcnt(0)
L_ok8:
  s_mov_b32 s43, 9216
  s_load_dwordx4 s[64:67], s[4:5], s43 glc
  s_add_u32 m0, s61, 98304
  s_mov_b32 s62, 131072
  buffer_load_dwordx4 v20, s[28:31], s62 offen offset:0 sc1 lds
  buffer_load_dwordx4 v20, s[28:31], s62 offen offset:1024 sc1 lds
  buffer_load_dwordx4 v20, s[28:31], s62 offen offset:2048 sc1 lds
  buffer_load_dwordx4 v20, s[28:31], s62 offen offset:3072 sc1 lds
  s_mov_b32 s58, 1408
  s_load_dword s68, s[12:13], s58 offset:0
  s_load_dword s69, s[12:13], s58 offset:64
  s_load_dword s70, s[12:13], s58 offset:2048
  s_load_dword s71, s[12:13], s58 offset:2112
  s_load_dword s72, s[12:13], s58 offset:4096
  s_load_dword s73, s[12:13], s58 offset:4160
  s_waitcnt vmcnt(12)
  s_barrier
  s_mov_b32 s41, 1152
  s_add_u32 m0, s60, 0
  s_nop 0
  buffer_load_dwordx4 v16, s[16:19], s41 offen offset:0 lds
  buffer_load_dwordx4 v17, s[16:19], s41 offen offset:1024 lds
  buffer_load_dwordx4 v18, s[16:19], s41 offen offset:2048 lds
  buffer_load_dwordx4 v19, s[16:19], s41 offen offset:3072 lds
  s_add_u32 m0, s60, 4096
  s_add_u32 s41, s41, 65536
  buffer_load_dwordx4 v16, s[16:19], s41 offen offset:0 lds
  buffer_load_dwordx4 v17, s[16:19], s41 offen offset:1024 lds
  buffer_load_dwordx4 v18, s[16:19], s41 offen offset:2048 lds
  buffer_load_dwordx4 v19, s[16:19], s41 offen offset:3072 lds
  s_mov_b32 s63, 0
L_sp9:
  s_waitcnt lgkmcnt(0)
  s_xor_b64 s[10:11], s[64:65], s[8:9]
  s_xor_b64 s[14:15], s[66:67], s[8:9]
  s_or_b64 s[10:11], s[10:11], s[14:15]
  s_cbranch_scc0 L_ok9
  s_load_dwordx4 s[64:67], s[4:5], s43 glc
  s_add_u32 s63, s63, 1
  s_cmp_lt_u32 s63, 20000
  s_cbranch_scc1 L_sp9
  s_waitcnt lgkmcnt(0)
L_ok9:
  s_mov_b32 s43, 10240
  s_load_dwordx4 s[64:67], s[4:5], s43 glc
  s_add_u32 m0, s61, 0
  s_mov_b32 s62, 147456
  buffer_load_dwordx4 v20, s[28:31], s62 offen offset:0 sc1 lds
  buffer_load_dwordx4 v20, s[28:31], s62 offen offset:1024 sc1 lds
  buffer_load_dwordx4 v20, s[28:31], s62 offen offset:2048 sc1 lds
  buffer_load_dwordx4 v20, s[28:31], s62 offen offset:3072 sc1 lds
  s_mov_b32 s58, 1536
  s_load_dword s68, s[12:13], s58 offset:0
  s_load_dword s69, s[12:13], s58 offset:64
  s_load_dword s70, s[12:13], s58 offset:2048
  s_load_dword s71, s[12:13], s58 offset:2112
  s_load_dword s72, s[12:13], s58 offset:4096
  s_load_dword s73, s[12:13], s58 offset:4160
  s_waitcnt vmcnt(12)
  s_barrier
  s_mov_b32 s41, 1280
  s_add_u32 m0, s60, 49152
  s_nop 0
  buffer_load_dwordx4 v16, s[16:19], s41 offen offset:0 lds
  buffer_load_dwordx4 v17, s[16:19], s41 offen offset:1024 lds
  buffer_load_dwordx4 v18, s[16:19], s41 offen offset:2048 lds
  buffer_load_dwordx4 v19, s[16:19], s41 offen offset:3072 lds
  s_add_u32 m0, s60, 53248
  s_add_u32 s41, s41, 65536
  buffer_load_dwordx4 v16, s[16:19], s41 offen offset:0 lds
  buffer_load_dwordx4 v17, s[16:19], s41 offen offset:1024 lds
  buffer_load_dwordx4 v18, s[16:19], s41 offen offset:2048 lds
  buffer_load_dwordx4 v19, s[16:19], s41 offen offset:3072 lds
  s_mov_b32 s63, 0
L_sp10:
  s_waitcnt lgkmcnt(0)
  s_xor_b64 s[10:11], s[64:65], s[8:9]
  s_xor_b64 s[14:15], s[66:67], s[8:9]
  s_or_b64 s[10:11], s[10:11], s[14:15]
  s_cbranch_scc0 L_ok10
  s_load_dwordx4 s[64:67], s[4:5], s43 glc
  s_add_u32 s63, s63, 1
  s_cmp_lt_u32 s63, 20000
  s_cbranch_scc1 L_sp10
  s_waitcnt lgkmcnt(0)
L_ok10:
  s_mov_b32 s43, 11264
  s_load_dwordx4 s[64:67], s[4:5], s43 glc
  s_add_u32 m0, s61, 49152
  s_mov_b32 s62, 163840
  buffer_load_dwordx4 v20, s[28:31], s62 offen offset:0 sc1 lds
  buffer_load_dwordx4 v20, s[28:31], s62 offen offset:1024 sc1 lds
  buffer_load_dwordx4 v20, s[28:31], s62 offen offset:2048 sc1 lds
  buffer_load_dwordx4 v20, s[28:31], s62 offen offset:3072 sc1 lds
  s_mov_b32 s58, 1664
  s_load_dword s68, s[12:13], s58 offset:0
  s_load_dword s69, s[12:13], s58 offset:64
  s_load_dword s70, s[12:13], s58 offset:2048
  s_load_dword s71, s[12:13], s58 offset:2112
  s_load_dword s72, s[12:13], s58 offset:4096
  s_load_dword s73, s[12:13], s58 offset:4160
  s_waitcnt vmcnt(12)
  s_barrier
  s_mov_b32 s41, 1408
  s_add_u32 m0, s60, 98304
  s_nop 0
  buffer_load_dwordx4 v16, s[16:19], s41 offen offset:0 lds
  buffer_load_dwordx4 v17, s[16:19], s41 offen offset:1024 lds
  buffer_load_dwordx4 v18, s[16:19], s41 offen offset:2048 lds
  buffer_load_dwordx4 v19, s[16:19], s41 offen offset:3072 lds
  s_add_u32 m0, s60, 102400
  s_add_u32 s41, s41, 65536
  buffer_load_dwordx4 v16, s[16:19], s41 offen offset:0 lds
  buffer_load_dwordx4 v17, s[16:19], s41 offen offset:1024 lds
  buffer_load_dwordx4 v18, s[16:19], s41 offen offset:2048 lds
  buffer_load_dwordx4 v19, s[16:19], s41 offen offset:3072 lds
  s_mov_b32 s63, 0
L_sp11:
  s_waitcnt lgkmcnt(0)
  s_xor_b64 s[10:11], s[64:65], s[8:9]
  s_xor_b64 s[14:15], s[66:67], s[8:9]
  s_or_b64 s[10:11], s[10:11], s[14:15]
  s_cbranch_scc0 L_ok11
  s_load_dwordx4 s[64:67], s[4:5], s43 glc
  s_add_u32 s63, s63, 1
  s_cmp_lt_u32 s63, 20000
  s_cbranch_scc1 L_sp11
  s_waitcnt lgkmcnt(0)
L_ok11:
  s_mov_b32 s43, 12288
  s_load_dwordx4 s[64:67], s[4:5], s43 glc
  s_add_u32 m0, s61, 98304
  s_mov_b32 s62, 180224
  buffer_load_dwordx4 v20, s[28:31], s62 offen offset:0 sc1 lds
  buffer_load_dwordx4 v20, s[28:31], s62 offen offset:1024 sc1 lds
  buffer_load_dwordx4 v20, s[28:31], s62 offen offset:2048 sc1 lds
  buffer_load_dwordx4 v20, s[28:31], s62 offen offset:3072 sc1 lds
  s_mov_b32 s58, 1792
  s_load_dword s68, s[12:13], s58 offset:0
  s_load_dword s69, s[12:13], s58 offset:64
  s_load_dword s70, s[12:13], s58 offset:2048
  s_load_dword s71, s[12:13], s58 offset:2112
  s_load_dword s72, s[12:13], s58 offset:4096
  s_load_dword s73, s[12:13], s58 offset:4160
  s_waitcnt vmcnt(12)
  s_barrier
  s_mov_b32 s41, 1536
  s_add_u32 m0, s60, 0
  s_nop 0
  buffer_load_dwordx4 v16, s[16:19], s41 offen offset:0 lds
  buffer_load_dwordx4 v17, s[16:19], s41 offen offset:1024 lds
  buffer_load_dwordx4 v18, s[16:19], s41 offen offset:2048 lds
  buffer_load_dwordx4 v19, s[16:19], s41 offen offset:3072 lds
  s_add_u32 m0, s60, 4096
  s_add_u32 s41, s41, 65536
  buffer_load_dwordx4 v16, s[16:19], s41 offen offset:0 lds
  buffer_load_dwordx4 v17, s[16:19], s41 offen offset:1024 lds
  buffer_load_dwordx4 v18, s[16:19], s41 offen offset:2048 lds
  buffer_load_dwordx4 v19, s[16:19], s41 offen offset:3072 lds
  s_mov_b32 s63, 0
L_sp12:
  s_waitcnt lgkmcnt(0)
  s_xor_b64 s[10:11], s[64:65], s[8:9]
  s_xor_b64 s[14:15], s[66:67], s[8:9]
  s_or_b64 s[10:11], s[10:11], s[14:15]
  s_cbranch_scc0 L_ok12
  s_load_dwordx4 s[64:67], s[4:5], s43 glc
  s_add_u32 s63, s63, 1
  s_cmp_lt_u32 s63, 20000
  s_cbranch_scc1 L_sp12
  s_waitcnt lgkmcnt(0)
L_ok12:
  s_mov_b32 s43, 13312
  s_load_dwordx4 s[64:67], s[4:5], s43 glc
  s_add_u32 m0, s61, 0
  s_mov_b32 s62, 196608
  buffer_load_dwordx4 v20, s[28:31], s62 offen offset:0 sc1 lds
  buffer_load_dwordx4 v20, s[28:31], s62 offen offset:1024 sc1 lds
  buffer_load_dwordx4 v20, s[28:31], s62 offen offset:2048 sc1 lds
  buffer_load_dwordx4 v20, s[28:31], s62 offen offset:3072 sc1 lds
  s_mov_b32 s58, 1920
  s_load_dword s68, s[12:13], s58 offset:0
  s_load_dword s69, s[12:13], s58 offset:64
  s_load_dword s70, s[12:13], s58 offset:2048
  s_load_dword s71, s[12:13], s58 offset:2112
  s_load_dword s72, s[12:13], s58 offset:4096
  s_load_dword s73, s[12:13], s58 offset:4160
  s_waitcnt vmcnt(12)
  s_barrier
  s_mov_b32 s41, 1664
  s_add_u32 m0, s60, 49152
  s_nop 0
  buffer_load_dwordx4 v16, s[16:19], s41 offen offset:0 lds
  buffer_load_dwordx4 v17, s[16:19], s41 offen offset:1024 lds
  buffer_load_dwordx4 v18, s[16:19], s41 offen offset:2048 lds
  buffer_load_dwordx4 v19, s[16:19], s41 offen offset:3072 lds
  s_add_u32 m0, s60, 53248
  s_add_u32 s41, s41, 65536
  buffer_load_dwordx4 v16, s[16:19], s41 offen offset:0 lds
  buffer_load_dwordx4 v17, s[16:19], s41 offen offset:1024 lds
  buffer_load_dwordx4 v18, s[16:19], s41 offen offset:2048 lds
  buffer_load_dwordx4 v19, s[16:19], s41 offen offset:3072 lds
  s_mov_b32 s63, 0
L_sp13:
  s_waitcnt lgkmcnt(0)
  s_xor_b64 s[10:11], s[64:65], s[8:9]
  s_xor_b64 s[14:15], s[66:67], s[8:9]
  s_or_b64 s[10:11], s[10:11], s[14:15]
  s_cbranch_scc0 L_ok13
  s_load_dwordx4 s[64:67], s[4:5], s43 glc
  s_add_u32 s63, s63, 1
  s_cmp_lt_u32 s63, 20000
  s_cbranch_scc1 L_sp13
  s_waitcnt lgkmcnt(0)
L_ok13:
  s_mov_b32 s43, 14336
  s_load_dwordx4 s[64:67], s[4:5], s43 glc
  s_add_u32 m0, s61, 49152
  s_mov_b32 s62, 212992
  buffer_load_dwordx4 v20, s[28:31], s62 offen offset:0 sc1 lds
  buffer_load_dwordx4 v20, s[28:31], s62 offen offset:1024 sc1 lds
  buffer_load_dwordx4 v20, s[28:31], s62 offen offset:2048 sc1 lds
  buffer_load_dwordx4 v20, s[28:31], s62 offen offset:3072 sc1 lds
  s_waitcnt vmcnt(12)
  s_barrier
  s_mov_b32 s41, 1792
  s_add_u32 m0, s60, 98304
  s_nop 0
  buffer_load_dwordx4 v16, s[16:19], s41 offen offset:0 lds
  buffer_load_dwordx4 v17, s[16:19], s41 offen offset:1024 lds
  buffer_load_dwordx4 v18, s[16:19], s41 offen offset:2048 lds
  buffer_load_dwordx4 v19, s[16:19], s41 offen offset:3072 lds
  s_add_u32 m0, s60, 102400
  s_add_u32 s41, s41, 65536
  buffer_load_dwordx4 v16, s[16:19], s41 offen offset:0 lds
  buffer_load_dwordx4 v17, s[16:19], s41 offen offset:1024 lds
  buffer_load_dwordx4 v18, s[16:19], s41 offen offset:2048 lds
  buffer_load_dwordx4 v19, s[16:19], s41 offen offset:3072 lds
  s_mov_b32 s63, 0
L_sp14:
  s_waitcnt lgkmcnt(0)
  s_xor_b64 s[10:11], s[64:65], s[8:9]
  s_xor_b64 s[14:15], s[66:67], s[8:9]
  s_or_b64 s[10:11], s[10:11], s[14:15]
  s_cbranch_scc0 L_ok14
  s_load_dwordx4 s[64:67], s[4:5], s43 glc
  s_add_u32 s63, s63, 1
  s_cmp_lt_u32 s63, 20000
  s_cbranch_scc1 L_sp14
  s_waitcnt lgkmcnt(0)
L_ok14:
  s_mov_b32 s43, 15360
  s_load_dwordx4 s[64:67], s[4:5], s43 glc
  s_add_u32 m0, s61, 98304
  s_mov_b32 s62, 229376
  buffer_load_dwordx4 v20, s[28:31], s62 offen offset:0 sc1 lds
  buffer_load_dwordx4 v20, s[28:31], s62 offen offset:1024 sc1 lds
  buffer_load_dwordx4 v20, s[28:31], s62 offen offset:2048 sc1 lds
  buffer_load_dwordx4 v20, s[28:31], s62 offen offset:3072 sc1 lds
  s_waitcnt vmcnt(12)
  s_barrier
  s_mov_b32 s63, 0
L_sp15:
  s_waitcnt lgkmcnt(0)
  s_xor_b64 s[10:11], s[64:65], s[8:9]
  s_xor_b64 s[14:15], s[66:67], s[8:9]
  s_or_b64 s[10:11], s[10:11], s[14:15]
  s_cbranch_scc0 L_ok15
  s_load_dwordx4 s[64:67], s[4:5], s43 glc
  s_add_u32 s63, s63, 1
  s_cmp_lt_u32 s63, 20000
  s_cbranch_scc1 L_sp15
  s_waitcnt lgkmcnt(0)
L_ok15:
  s_add_u32 m0, s61, 0
  s_mov_b32 s62, 245760
  buffer_load_dwordx4 v20, s[28:31], s62 offen offset:0 sc1 lds
  buffer_load_dwordx4 v20, s[28:31], s62 offen offset:1024 sc1 lds
  buffer_load_dwordx4 v20, s[28:31], s62 offen offset:2048 sc1 lds
  buffer_load_dwordx4 v20, s[28:31], s62 offen offset:3072 sc1 lds
  s_mov_b32 s41, 1920
  s_add_u32 m0, s60, 0
  s_nop 0
  buffer_load_dwordx4 v16, s[16:19], s41 offen offset:0 lds
  buffer_load_dwordx4 v17, s[16:19], s41 offen offset:1024 lds
  buffer_load_dwordx4 v18, s[16:19], s41 offen offset:2048 lds
  buffer_load_dwordx4 v19, s[16:19], s41 offen offset:3072 lds
  s_waitcnt vmcnt(8)
  s_barrier
  s_add_u32 m0, s60, 4096
  s_add_u32 s41, s41, 65536
  buffer_load_dwordx4 v16, s[16:19], s41 offen offset:0 lds
  buffer_load_dwordx4 v17, s[16:19], s41 offen offset:1024 lds
  buffer_load_dwordx4 v18, s[16:19], s41 offen offset:2048 lds
  buffer_load_dwordx4 v19, s[16:19], s41 offen offset:3072 lds
  s_waitcnt vmcnt(4)
  s_barrier
  s_waitcnt vmcnt(0)
  s_barrier
  s_endpgm
L_prod:
  s_mov_b32 s56, 917504
  s_mov_b32 s57, 16384
  s_mov_b32 s58, 1024
  s_mov_b32 s59, 0
  s_mov_b32 s55, 7
  v_mov_b32 v15, 0x7ff00000
  s_cmp_lt_u32 s2, 28
  s_cbranch_scc1 L_pp
  s_mov_b32 s56, 512
  s_mov_b32 s57, 262144
  s_mov_b32 s58, 16384
  s_mov_b32 s59, 4096
  s_mov_b32 s51, 6
L_pl:
  s_add_u32 m0, m0, 4096
  v_add_u32 v16, 256, v16
  s_sub_u32 s51, s51, 1
  buffer_load_dword v16, s[24:27], 0 offen lds
  buffer_load_dword v16, s[24:27], s50 offen offset:256 lds
  s_cmp_lg_u32 s51, 0
  s_cbranch_scc1 L_pl
  s_branch L_pq
L_pp:
  s_mov_b32 s22, 13762560
L_pq:
  s_add_u32 s10, s28, 9437184
  s_addc_u32 s11, s29, 0
  s_load_dwordx2 s[6:7], s[10:11], 0
  s_lshl_b32 s53, s38, 11
  s_add_u32 s53, s53, 32768
  v_and_b32 v1, 1, v3
  v_lshlrev_b32 v1, 10, v1
  v_lshl_add_u32 v1, v9, 3, v1
  v_lshrrev_b32 v6, 1, v3
  v_lshl_add_u32 v6, v6, 4, v1
  v_add_u32 v6, s53, v6
  v_lshl_add_u32 v7, v2, 4, s53
  s_lshl_b32 s53, s37, 18
  s_lshl_b32 s54, s52, 11
  s_add_u32 s53, s53, s54
  v_lshl_add_u32 v8, v2, 4, s53
  s_lshl_b32 s53, s37, 6
  s_lshr_b32 s54, s52, 1
  s_add_u32 s53, s53, s54
  s_lshl_b32 s53, s53, 8
  s_and_b32 s54, s52, 1
  s_lshl_b32 s54, s54, 3
  s_add_u32 s53, s53, s54
  s_add_u32 s53, s53, 7340032
  v_lshl_add_u32 v14, v2, 7, s53
  s_waitcnt vmcnt(0)
  buffer_load_dwordx4 v[32:35], v4, s[20:23], 0 offen
  buffer_load_dwordx4 v[36:39], v4, s[20:23], s45 offen
  buffer_load_dwordx4 v[40:43], v4, s[20:23], s46 offen
  buffer_load_dwordx4 v[44:47], v4, s[20:23], s47 offen
  v_add_u32 v4, s56, v4
  buffer_load_dword v17, v15, s[20:23], 0 offen
  buffer_load_dword v17, v15, s[20:23], 0 offen
  buffer_load_dwordx4 v[48:51], v4, s[20:23], 0 offen
  buffer_load_dwordx4 v[52:55], v4, s[20:23], s45 offen
  buffer_load_dwordx4 v[56:59], v4, s[20:23], s46 offen
  buffer_load_dwordx4 v[60:63], v4, s[20:23], s47 offen
  v_add_u32 v4, s56, v4
  s_waitcnt lgkmcnt(0)
  s_mul_i32 s8, s6, 1664525
  s_mul_i32 s9, s7, 22695477
  s_add_u32 s8, s8, 1013904223
  s_add_u32 s9, s9, 1
  v_mov_b32 v10, s8
  v_mov_b32 v11, s9
  s_mov_b32 s60, 0
  s_mov_b32 s61, 0
  s_mov_b32 s62, 0
  s_waitcnt vmcnt(10)
  s_barrier
L_p:
  s_waitcnt vmcnt(9)
  v_lshl_add_u32 v32, v32, 8, v5
  v_lshl_add_u32 v33, v33, 8, v5
  v_lshl_add_u32 v34, v34, 8, v5
  v_lshl_add_u32 v35, v35, 8, v5
  ds_read_u16 v96, v32 offset:0
  ds_read_u16 v97, v33 offset:2
  ds_read_u16 v98, v34 offset:128
  ds_read_u16 v99, v35 offset:130
  s_waitcnt vmcnt(8)
  v_lshl_add_u32 v36, v36, 8, v5
  v_lshl_add_u32 v37, v37, 8, v5
  v_lshl_add_u32 v38, v38, 8, v5
  v_lshl_add_u32 v39, v39, 8, v5
  ds_read_u16 v100, v36 offset:0
  ds_read_u16 v101, v37 offset:2
  ds_read_u16 v102, v38 offset:128
  ds_read_u16 v103, v39 offset:130
  s_waitcnt vmcnt(7)
  v_lshl_add_u32 v40, v40, 8, v5
  v_lshl_add_u32 v41, v41, 8, v5
  v_lshl_add_u32 v42, v42, 8, v5
  v_lshl_add_u32 v43, v43, 8, v5
  ds_read_u16 v104, v40 offset:0
  ds_read_u16 v105, v41 offset:2
  ds_read_u16 v106, v42 offset:128
  ds_read_u16 v107, v43 offset:130
  s_waitcnt vmcnt(6)
  v_lshl_add_u32 v44, v44, 8, v5
  v_lshl_add_u32 v45, v45, 8, v5
  v_lshl_add_u32 v46, v46, 8, v5
  v_lshl_add_u32 v47, v47, 8, v5
  ds_read_u16 v108, v44 offset:0
  ds_read_u16 v109, v45 offset:2
  ds_read_u16 v110, v46 offset:128
  ds_read_u16 v111, v47 offset:130
  s_waitcnt lgkmcnt(8)
  v_lshl_or_b32 v112, v100, 16, v96
  v_lshl_or_b32 v114, v101, 16, v97
  v_lshl_or_b32 v116, v102, 16, v98
  v_lshl_or_b32 v118, v103, 16, v99
  s_waitcnt lgkmcnt(3)
  v_lshl_or_b32 v113, v108, 16, v104
  ds_write_b64 v6, v[112:113] offset:0
  s_waitcnt lgkmcnt(3)
  v_lshl_or_b32 v115, v109, 16, v105
  ds_write_b64 v6, v[114:115] offset:256
  s_waitcnt lgkmcnt(3)
  v_lshl_or_b32 v117, v110, 16, v106
  ds_write_b64 v6, v[116:117] offset:512
  s_waitcnt lgkmcnt(3)
  v_lshl_or_b32 v119, v111, 16, v107
  ds_write_b64 v6, v[118:119] offset:768
  s_waitcnt lgkmcnt(0)
  ds_read_b128 v[120:123], v7 offset:0
  ds_read_b128 v[124:127], v7 offset:1024
  s_cmp_eq_u32 s62, 0
  s_cbranch_scc1 L_pa0
  s_waitcnt vmcnt(4)
  s_mov_b64 exec, 3
  buffer_store_dwordx2 v[10:11], v14, s[28:31], s61 offen sc1
  s_mov_b64 exec, -1
  s_add_u32 s61, s61, s58
L_pa0:
  s_waitcnt lgkmcnt(1)
  buffer_store_dwordx4 v[120:123], v8, s[28:31], s60 offen offset:0 sc1
  s_waitcnt lgkmcnt(0)
  buffer_store_dwordx4 v[124:127], v8, s[28:31], s60 offen offset:1024 sc1
  buffer_load_dwordx4 v[32:35], v4, s[20:23], 0 offen
  buffer_load_dwordx4 v[36:39], v4, s[20:23], s45 offen
  buffer_load_dwordx4 v[40:43], v4, s[20:23], s46 offen
  buffer_load_dwordx4 v[44:47], v4, s[20:23], s47 offen
  v_add_u32 v4, s56, v4
  v_add_u32 v5, s59, v5
  s_add_u32 s62, s62, 1
  s_add_u32 s60, s60, s57
  s_cmp_lt_u32 s62, s55
  s_cbranch_scc0 L_pe
  s_waitcnt vmcnt(9)
  v_lshl_add_u32 v48, v48, 8, v5
  v_lshl_add_u32 v49, v49, 8, v5
  v_lshl_add_u32 v50, v50, 8, v5
  v_lshl_add_u32 v51, v51, 8, v5
  ds_read_u16 v96, v48 offset:0
  ds_read_u16 v97, v49 offset:2
  ds_read_u16 v98, v50 offset:128
  ds_read_u16 v99, v51 offset:130
  s_waitcnt vmcnt(8)
  v_lshl_add_u32 v52, v52, 8, v5
  v_lshl_add_u32 v53, v53, 8, v5
  v_lshl_add_u32 v54, v54, 8, v5
  v_lshl_add_u32 v55, v55, 8, v5
  ds_read_u16 v100, v52 offset:0
  ds_read_u16 v101, v53 offset:2
  ds_read_u16 v102, v54 offset:128
  ds_read_u16 v103, v55 offset:130
  s_waitcnt vmcnt(7)
  v_lshl_add_u32 v56, v56, 8, v5
  v_lshl_add_u32 v57, v57, 8, v5
  v_lshl_add_u32 v58, v58, 8, v5
  v_lshl_add_u32 v59, v59, 8, v5
  ds_read_u16 v104, v56 offset:0
  ds_read_u16 v105, v57 offset:2
  ds_read_u16 v106, v58 offset:128
  ds_read_u16 v107, v59 offset:130
  s_waitcnt vmcnt(6)
  v_lshl_add_u32 v60, v60, 8, v5
  v_lshl_add_u32 v61, v61, 8, v5
  v_lshl_add_u32 v62, v62, 8, v5
  v_lshl_add_u32 v63, v63, 8, v5
  ds_read_u16 v108, v60 offset:0
  ds_read_u16 v109, v61 offset:2
  ds_read_u16 v110, v62 offset:128
  ds_read_u16 v111, v63 offset:130
  s_waitcnt lgkmcnt(8)
  v_lshl_or_b32 v112, v100, 16, v96
  v_lshl_or_b32 v114, v101, 16, v97
  v_lshl_or_b32 v116, v102, 16, v98
  v_lshl_or_b32 v118, v103, 16, v99
  s_waitcnt lgkmcnt(3)
  v_lshl_or_b32 v113, v108, 16, v104
  ds_write_b64 v6, v[112:113] offset:0
  s_waitcnt lgkmcnt(3)
  v_lshl_or_b32 v115, v109, 16, v105
  ds_write_b64 v6, v[114:115] offset:256
  s_waitcnt lgkmcnt(3)
  v_lshl_or_b32 v117, v110, 16, v106
  ds_write_b64 v6, v[116:117] offset:512
  s_waitcnt lgkmcnt(3)
  v_lshl_or_b32 v119, v111, 16, v107
  ds_write_b64 v6, v[118:119] offset:768
  s_waitcnt lgkmcnt(0)
  ds_read_b128 v[128:131], v7 offset:0
  ds_read_b128 v[132:135], v7 offset:1024
  s_cmp_eq_u32 s62, 0
  s_cbranch_scc1 L_pa1
  s_waitcnt vmcnt(4)
  s_mov_b64 exec, 3
  buffer_store_dwordx2 v[10:11], v14, s[28:31], s61 offen sc1
  s_mov_b64 exec, -1
  s_add_u32 s61, s61, s58
L_pa1:
  s_waitcnt lgkmcnt(1)
  buffer_store_dwordx4 v[128:131], v8, s[28:31], s60 offen offset:0 sc1
  s_waitcnt lgkmcnt(0)
  buffer_store_dwordx4 v[132:135], v8, s[28:31], s60 offen offset:1024 sc1
  buffer_load_dwordx4 v[48:51], v4, s[20:23], 0 offen
  buffer_load_dwordx4 v[52:55], v4, s[20:23], s45 offen
  buffer_load_dwordx4 v[56:59], v4, s[20:23], s46 offen
  buffer_load_dwordx4 v[60:63], v4, s[20:23], s47 offen
  v_add_u32 v4, s56, v4
  v_add_u32 v5, s59, v5
  s_add_u32 s62, s62, 1
  s_add_u32 s60, s60, s57
  s_cmp_lt_u32 s62, s55
  s_cbranch_scc1 L_p
L_pe:
  s_waitcnt vmcnt(4)
  s_mov_b64 exec, 3
  buffer_store_dwordx2 v[10:11], v14, s[28:31], s61 offen sc1
  s_mov_b64 exec, -1
  s_cmp_eq_u32 s38, 0
  s_cbranch_scc0 L_pz
  s_lshl_b32 s3, s2, 6
  s_add_u32 s3, s3, 9441280
  v_mov_b32 v12, s3
  s_mov_b64 exec, 1
  buffer_store_dwordx2 v[10:11], v12, s[28:31], 0 offen sc1
  s_mov_b64 exec, -1
  s_cmp_eq_u32 s2, 0
  s_cbranch_scc0 L_pz
  s_mov_b32 s63, 0
  v_lshlrev_b32 v12, 6, v2
  v_add_u32 v12, 9441280, v12
L_pw:
  s_mov_b32 s53, 0
  buffer_load_dwordx2 v[20:21], v12, s[28:31], s53 offen sc1
  s_mov_b32 s53, 4096
  buffer_load_dwordx2 v[22:23], v12, s[28:31], s53 offen sc1
  s_mov_b32 s53, 8192
  buffer_load_dwordx2 v[24:25], v12, s[28:31], s53 offen sc1
  s_mov_b32 s53, 12288
  buffer_load_dwordx2 v[26:27], v12, s[28:31], s53 offen sc1
  s_add_u32 s63, s63, 1
  s_waitcnt vmcnt(0)
  v_cmp_ne_u64 s[52:53], v[20:21], v[10:11]
  v_cmp_ne_u64 vcc, v[22:23], v[10:11]
  s_or_b64 s[52:53], s[52:53], vcc
  v_cmp_ne_u64 vcc, v[24:25], v[10:11]
  s_or_b64 s[52:53], s[52:53], vcc
  v_cmp_ne_u64 vcc, v[26:27], v[10:11]
  s_or_b64 s[52:53], s[52:53], vcc
  s_cbranch_scc0 L_pv
  s_cmp_lt_u32 s63, 20000
  s_cbranch_scc1 L_pw
L_pv:
  v_mov_b32 v12, 9437184
  s_mov_b64 exec, 1
  buffer_store_dwordx2 v[10:11], v12, s[28:31], 0 offen sc1
  s_mov_b64 exec, -1
L_pz:
L_drain:
  s_waitcnt vmcnt(0)
L_done:
  s_endpgm
.section .rodata,"a"
.p2align 6
.amdhsa_kernel standalone__weight_only_int_squeezellm__prompt_kernel
  .amdhsa_next_free_vgpr 256
  .amdhsa_next_free_sgpr 102
  .amdhsa_accum_offset 160
  .amdhsa_group_segment_fixed_size 0
  .amdhsa_kernarg_size 48
  .amdhsa_user_sgpr_count 2
  .amdhsa_user_sgpr_kernarg_segment_ptr 1
  .amdhsa_system_sgpr_workgroup_id_x 1
.end_amdhsa_kernel
```

```asm
; @launch grid=(256,1,1) block=(512,1,1) lds=151552
.amdgcn_target "amdgcn-amd-amdhsa--gfx950"
.text
.globl standalone__weight_only_int_squeezellm__prompt_kernel
.p2align 8
.type standalone__weight_only_int_squeezellm__prompt_kernel,@function
standalone__weight_only_int_squeezellm__prompt_kernel:
  s_cmp_ge_u32 s2, 256
  s_cbranch_scc1 L_done
  s_load_dwordx2 s[24:25], s[0:1], 16
  s_load_dwordx2 s[20:21], s[0:1], 8
  s_load_dwordx2 s[28:29], s[0:1], 40
  s_load_dwordx2 s[16:17], s[0:1], 0
  s_load_dwordx2 s[32:33], s[0:1], 24
  s_and_b32 s3, s2, 1
  s_bfe_u32 s36, s2, 0x20003
  s_lshl2_add_u32 s36, s3, s36
  s_bfe_u32 s3, s2, 0x20001
  s_mul_i32 s3, s3, 7
  s_lshr_b32 s37, s2, 5
  s_add_u32 s37, s37, s3
  s_sub_u32 s37, s37, 1
  s_sub_u32 s3, s2, 28
  s_mul_i32 s53, s3, 7
  s_cmp_lt_u32 s3, 4
  s_cselect_b32 s51, 15, 8
  s_cselect_b32 s53, s53, s2
  s_cmp_lt_u32 s2, 32
  s_cselect_b32 s36, s51, s36
  s_cselect_b32 s37, s53, s37
  s_cselect_b32 s51, 0, 147456
  v_lshrrev_b32 v1, 6, v0
  v_and_b32 v3, 31, v0
  v_readfirstlane_b32 s38, v1
  v_bfe_u32 v9, v0, 5, 1
  s_mov_b32 s26, 114688
  s_mov_b32 s27, 0x20000
  s_mov_b32 s22, 14680064
  s_mov_b32 s23, 0x20000
  v_mul_u32_u24 v1, 57344, v9
  v_lshl_add_u32 v4, v3, 4, v1
  v_lshlrev_b32 v1, 3, v3
  v_lshl_add_u32 v16, v9, 2, v1
  s_mul_i32 s53, s38, 14336
  s_lshl_b32 s54, s37, 8
  s_add_u32 s53, s53, s54
  v_add_u32 v16, s53, v16
  s_lshl_b32 s53, s38, 9
  s_add_u32 m0, s53, s51
  s_movk_i32 s50, 6912
  s_lshl3_add_u32 s52, s36, s38
  s_mul_i32 s53, s52, 114688
  s_lshl1_add_u32 s53, s54, s53
  v_add_u32 v4, s53, v4
  s_movk_i32 s45, 14336
  s_movk_i32 s46, 28672
  s_mov_b32 s47, 43008
  s_mov_b32 s30, 9457664
  s_mov_b32 s31, 0x20000
  s_mov_b32 s18, 4194304
  s_mov_b32 s19, 0x20000
  s_mov_b32 s34, 14680064
  s_mov_b32 s35, 0x20000
  s_cmp_lt_u32 s2, 32
  s_waitcnt lgkmcnt(0)
  buffer_load_dword v16, s[24:27], 0 offen lds
  buffer_load_dword v16, s[24:27], s50 offen offset:256 lds
  s_cbranch_scc0 L_ng
  v_and_b32 v20, 63, v0
  v_lshlrev_b32 v20, 20, v20
  buffer_load_dword v64, v20, s[20:23], 0 offen
  buffer_load_dword v65, v20, s[28:31], 0 offen
  buffer_load_dword v66, v20, s[16:19], 0 offen
  buffer_load_dword v67, v20, s[32:35], 0 offen
  s_getpc_b64 s[14:15]
L_pc:
  s_lshr_b32 s53, s2, 3
  s_lshl3_add_u32 s53, s53, s38
  s_mul_i32 s53, s53, 512
  s_min_u32 s53, s53, L_end-standalone__weight_only_int_squeezellm__prompt_kernel-512
  s_sub_u32 s14, s14, L_pc-standalone__weight_only_int_squeezellm__prompt_kernel
  s_subb_u32 s15, s15, 0
  s_load_dword s68, s[14:15], s53 offset:0
  s_load_dword s69, s[14:15], s53 offset:64
  s_load_dword s70, s[14:15], s53 offset:128
  s_load_dword s71, s[14:15], s53 offset:192
  s_load_dword s72, s[14:15], s53 offset:256
  s_load_dword s73, s[14:15], s53 offset:320
  s_load_dword s74, s[14:15], s53 offset:384
  s_load_dword s75, s[14:15], s53 offset:448
  s_branch L_prod
L_ng:
  buffer_load_dwordx4 v[32:35], v4, s[20:23], 0 offen nt
  buffer_load_dwordx4 v[36:39], v4, s[20:23], s45 offen nt
  buffer_load_dwordx4 v[40:43], v4, s[20:23], s46 offen nt
  buffer_load_dwordx4 v[44:47], v4, s[20:23], s47 offen nt
  s_add_u32 s10, s28, 9437184
  s_addc_u32 s11, s29, 0
  s_load_dwordx2 s[6:7], s[10:11], 0
  v_and_b32 v2, 63, v0
  v_lshlrev_b32 v5, 2, v3
  s_and_b32 s39, s38, 3
  v_add_u32 v5, 147456, v5
  s_lshl_b32 s53, s38, 11
  s_add_u32 s53, s53, 32768
  v_and_b32 v1, 1, v3
  v_lshlrev_b32 v1, 10, v1
  v_lshl_add_u32 v1, v9, 3, v1
  v_lshrrev_b32 v6, 1, v3
  v_lshl_add_u32 v6, v6, 4, v1
  v_add_u32 v6, s53, v6
  v_lshl_add_u32 v7, v2, 4, s53
  s_lshl_b32 s53, s37, 18
  s_lshl_b32 s54, s52, 11
  s_add_u32 s53, s53, s54
  v_lshl_add_u32 v8, v2, 4, s53
  s_lshl_b32 s53, s37, 6
  s_lshr_b32 s54, s52, 1
  s_add_u32 s53, s53, s54
  s_lshl_b32 s53, s53, 7
  s_and_b32 s54, s52, 1
  s_lshl_b32 s54, s54, 3
  s_add_u32 s53, s53, s54
  s_add_u32 s53, s53, 7340032
  v_lshl_add_u32 v14, v2, 7, s53
  s_lshl_b32 s53, s37, 2
  s_add_u32 s53, s53, s39
  s_mul_i32 s53, s53, 3
  s_min_u32 s53, s53, 253
  s_lshl_b32 s54, s36, 8
  s_add_u32 s53, s53, s54
  s_lshl_b32 s53, s53, 11
  s_add_u32 s12, s16, s53
  s_addc_u32 s13, s17, 0
  s_andn2_b32 s40, 4, s36
  v_and_b32 v3, 15, v2
  v_lshrrev_b32 v9, 4, v2
  v_lshrrev_b32 v1, 1, v3
  v_xor_b32 v1, v1, v9
  v_lshlrev_b32 v1, 4, v1
  v_lshl_add_u32 v144, v3, 7, v1
  s_lshl_b32 s54, s38, 13
  v_add_u32 v144, s54, v144
  v_xor_b32 v145, 64, v144
  v_lshlrev_b32 v1, 11, v9
  v_lshl_add_u32 v146, v3, 4, v1
  v_add_u32 v146, 32768, v146
  s_lshl_b32 s52, s36, 8
  s_lshl_b32 s53, s38, 6
  s_add_u32 s52, s52, s53
  s_mul_i32 s52, s52, 7168
  s_lshl_b32 s53, s37, 8
  s_add_u32 s52, s52, s53
  v_mul_u32_u24 v1, 28672, v9
  v_lshl_add_u32 v1, v3, 4, v1
  v_add_u32 v147, s52, v1
  v_lshrrev_b32 v20, 3, v2
  v_lshlrev_b32 v20, 11, v20
  v_lshrrev_b32 v1, 4, v2
  v_xor_b32 v1, v1, v2
  v_and_b32 v1, 7, v1
  v_lshl_add_u32 v20, v1, 4, v20
  s_lshl_b32 s52, s36, 19
  s_lshl_b32 s53, s39, 17
  s_add_u32 s53, s52, s53
  v_add_u32 v16, s53, v20
  v_xor_b32 v17, 64, v16
  v_add_u32 v18, 30720, v16
  v_add_u32 v19, 46080, v17
  v_add_u32 v17, 15360, v17
  s_lshl_b32 s60, s39, 13
  s_lshl_b32 s53, s37, 18
  s_lshl_b32 s54, s39, 12
  s_add_u32 s53, s53, s54
  v_lshl_add_u32 v20, v2, 4, s53
  s_add_u32 s61, s54, 32768
  s_lshl_b32 s53, s37, 13
  s_lshl_b32 s54, s39, 7
  s_add_u32 s53, s53, s54
  s_and_b32 s54, s36, 0
  s_lshl_b32 s54, s54, 7
  s_add_u32 s53, s53, s54
  s_add_u32 s53, s53, 7340032
  s_add_u32 s4, s28, s53
  s_addc_u32 s5, s29, 0
  s_lshl_b32 s41, s36, 7
  s_lshr_b32 s53, s38, 2
  s_lshl_b32 s54, s53, 16
  s_add_u32 s41, s41, s54
  s_lshl_b32 s53, s53, 12
  s_add_u32 m0, s60, s53
  s_waitcnt lgkmcnt(0)
  s_mul_i32 s8, s6, 1664525
  s_mul_i32 s9, s7, 22695477
  s_add_u32 s8, s8, 1013904223
  s_add_u32 s9, s9, 1
  v_mov_b32 v10, s8
  v_mov_b32 v11, s9
  s_waitcnt vmcnt(4)
  s_barrier
  s_waitcnt vmcnt(3)
  v_lshl_add_u32 v32, v32, 8, v5
  v_lshl_add_u32 v33, v33, 8, v5
  v_lshl_add_u32 v34, v34, 8, v5
  v_lshl_add_u32 v35, v35, 8, v5
  ds_read_u16 v96, v32 offset:0
  ds_read_u16 v97, v33 offset:2
  ds_read_u16 v98, v34 offset:128
  ds_read_u16 v99, v35 offset:130
  buffer_load_dwordx4 v16, s[16:19], s41 offen offset:0 lds
  s_waitcnt vmcnt(3)
  v_lshl_add_u32 v36, v36, 8, v5
  v_lshl_add_u32 v37, v37, 8, v5
  v_lshl_add_u32 v38, v38, 8, v5
  v_lshl_add_u32 v39, v39, 8, v5
  ds_read_u16 v100, v36 offset:0
  ds_read_u16 v101, v37 offset:2
  ds_read_u16 v102, v38 offset:128
  ds_read_u16 v103, v39 offset:130
  buffer_load_dwordx4 v17, s[16:19], s41 offen offset:1024 lds
  s_waitcnt vmcnt(3)
  v_lshl_add_u32 v40, v40, 8, v5
  v_lshl_add_u32 v41, v41, 8, v5
  v_lshl_add_u32 v42, v42, 8, v5
  v_lshl_add_u32 v43, v43, 8, v5
  ds_read_u16 v104, v40 offset:0
  ds_read_u16 v105, v41 offset:2
  ds_read_u16 v106, v42 offset:128
  ds_read_u16 v107, v43 offset:130
  buffer_load_dwordx4 v18, s[16:19], s41 offen offset:2048 lds
  s_waitcnt vmcnt(3)
  v_lshl_add_u32 v44, v44, 8, v5
  v_lshl_add_u32 v45, v45, 8, v5
  v_lshl_add_u32 v46, v46, 8, v5
  v_lshl_add_u32 v47, v47, 8, v5
  ds_read_u16 v108, v44 offset:0
  ds_read_u16 v109, v45 offset:2
  ds_read_u16 v110, v46 offset:128
  ds_read_u16 v111, v47 offset:130
  buffer_load_dwordx4 v19, s[16:19], s41 offen offset:3072 lds
  s_waitcnt lgkmcnt(8)
  v_lshl_or_b32 v112, v100, 16, v96
  v_lshl_or_b32 v114, v101, 16, v97
  v_lshl_or_b32 v116, v102, 16, v98
  v_lshl_or_b32 v118, v103, 16, v99
  s_waitcnt lgkmcnt(3)
  v_lshl_or_b32 v113, v108, 16, v104
  ds_write_b64 v6, v[112:113] offset:0
  s_waitcnt lgkmcnt(3)
  v_lshl_or_b32 v115, v109, 16, v105
  ds_write_b64 v6, v[114:115] offset:256
  s_waitcnt lgkmcnt(3)
  v_lshl_or_b32 v117, v110, 16, v106
  ds_write_b64 v6, v[116:117] offset:512
  s_waitcnt lgkmcnt(3)
  v_lshl_or_b32 v119, v111, 16, v107
  ds_write_b64 v6, v[118:119] offset:768
  s_waitcnt lgkmcnt(0)
  ds_read_b128 v[148:151], v7 offset:0
  ds_read_b128 v[152:155], v7 offset:1024
  s_waitcnt lgkmcnt(1)
  buffer_store_dwordx4 v[148:151], v8, s[28:31], 0 offen offset:0 sc1
  s_waitcnt lgkmcnt(0)
  buffer_store_dwordx4 v[152:155], v8, s[28:31], 0 offen offset:1024 sc1
  s_cmp_ge_u32 s38, 4
  s_cbranch_scc1 L_loader
  s_add_u32 s58, s40, 0
  s_lshl_b32 s58, s58, 7
  s_load_dword s92, s[12:13], s58 offset:0
  s_load_dword s93, s[12:13], s58 offset:64
  s_load_dword s94, s[12:13], s58 offset:2048
  s_load_dword s95, s[12:13], s58 offset:2112
  s_load_dword s96, s[12:13], s58 offset:4096
  s_load_dword s97, s[12:13], s58 offset:4160
  s_add_u32 s58, s40, 1
  s_lshl_b32 s58, s58, 7
  s_load_dword s92, s[12:13], s58 offset:0
  s_load_dword s93, s[12:13], s58 offset:64
  s_load_dword s94, s[12:13], s58 offset:2048
  s_load_dword s95, s[12:13], s58 offset:2112
  s_load_dword s96, s[12:13], s58 offset:4096
  s_load_dword s97, s[12:13], s58 offset:4160
  v_mov_b32 v5, v144
  v_mov_b32 v6, v145
  v_mov_b32 v7, v146
  v_mov_b32 v16, 0
  v_mov_b32 v17, 0
  v_mov_b32 v18, 0
  v_mov_b32 v19, 0
  v_mov_b32 v20, 0
  v_mov_b32 v21, 0
  v_mov_b32 v22, 0
  v_mov_b32 v23, 0
  v_mov_b32 v24, 0
  v_mov_b32 v25, 0
  v_mov_b32 v26, 0
  v_mov_b32 v27, 0
  v_mov_b32 v28, 0
  v_mov_b32 v29, 0
  v_mov_b32 v30, 0
  v_mov_b32 v31, 0
  v_mov_b32 v32, 0
  v_mov_b32 v33, 0
  v_mov_b32 v34, 0
  v_mov_b32 v35, 0
  v_mov_b32 v36, 0
  v_mov_b32 v37, 0
  v_mov_b32 v38, 0
  v_mov_b32 v39, 0
  v_mov_b32 v40, 0
  v_mov_b32 v41, 0
  v_mov_b32 v42, 0
  v_mov_b32 v43, 0
  v_mov_b32 v44, 0
  v_mov_b32 v45, 0
  v_mov_b32 v46, 0
  v_mov_b32 v47, 0
  v_mov_b32 v48, 0
  v_mov_b32 v49, 0
  v_mov_b32 v50, 0
  v_mov_b32 v51, 0
  v_mov_b32 v52, 0
  v_mov_b32 v53, 0
  v_mov_b32 v54, 0
  v_mov_b32 v55, 0
  v_mov_b32 v56, 0
  v_mov_b32 v57, 0
  v_mov_b32 v58, 0
  v_mov_b32 v59, 0
  v_mov_b32 v60, 0
  v_mov_b32 v61, 0
  v_mov_b32 v62, 0
  v_mov_b32 v63, 0
  v_mov_b32 v64, 0
  v_mov_b32 v65, 0
  v_mov_b32 v66, 0
  v_mov_b32 v67, 0
  v_mov_b32 v68, 0
  v_mov_b32 v69, 0
  v_mov_b32 v70, 0
  v_mov_b32 v71, 0
  v_mov_b32 v72, 0
  v_mov_b32 v73, 0
  v_mov_b32 v74, 0
  v_mov_b32 v75, 0
  v_mov_b32 v76, 0
  v_mov_b32 v77, 0
  v_mov_b32 v78, 0
  v_mov_b32 v79, 0
  v_mov_b32 v80, 0
  v_mov_b32 v81, 0
  v_mov_b32 v82, 0
  v_mov_b32 v83, 0
  v_mov_b32 v84, 0
  v_mov_b32 v85, 0
  v_mov_b32 v86, 0
  v_mov_b32 v87, 0
  v_mov_b32 v88, 0
  v_mov_b32 v89, 0
  v_mov_b32 v90, 0
  v_mov_b32 v91, 0
  v_mov_b32 v92, 0
  v_mov_b32 v93, 0
  v_mov_b32 v94, 0
  v_mov_b32 v95, 0
  v_mov_b32 v96, 0
  v_mov_b32 v97, 0
  v_mov_b32 v98, 0
  v_mov_b32 v99, 0
  v_mov_b32 v100, 0
  v_mov_b32 v101, 0
  v_mov_b32 v102, 0
  v_mov_b32 v103, 0
  v_mov_b32 v104, 0
  v_mov_b32 v105, 0
  v_mov_b32 v106, 0
  v_mov_b32 v107, 0
  v_mov_b32 v108, 0
  v_mov_b32 v109, 0
  v_mov_b32 v110, 0
  v_mov_b32 v111, 0
  v_mov_b32 v112, 0
  v_mov_b32 v113, 0
  v_mov_b32 v114, 0
  v_mov_b32 v115, 0
  v_mov_b32 v116, 0
  v_mov_b32 v117, 0
  v_mov_b32 v118, 0
  v_mov_b32 v119, 0
  v_mov_b32 v120, 0
  v_mov_b32 v121, 0
  v_mov_b32 v122, 0
  v_mov_b32 v123, 0
  v_mov_b32 v124, 0
  v_mov_b32 v125, 0
  v_mov_b32 v126, 0
  v_mov_b32 v127, 0
  v_mov_b32 v128, 0
  v_mov_b32 v129, 0
  v_mov_b32 v130, 0
  v_mov_b32 v131, 0
  v_mov_b32 v132, 0
  v_mov_b32 v133, 0
  v_mov_b32 v134, 0
  v_mov_b32 v135, 0
  v_mov_b32 v136, 0
  v_mov_b32 v137, 0
  v_mov_b32 v138, 0
  v_mov_b32 v139, 0
  v_mov_b32 v140, 0
  v_mov_b32 v141, 0
  v_mov_b32 v142, 0
  v_mov_b32 v143, 0
  s_waitcnt vmcnt(0)
  s_mov_b64 exec, 1
  buffer_store_dwordx2 v[10:11], v14, s[28:31], 0 offen sc1
  s_mov_b64 exec, -1
  s_mov_b32 s44, 0
  s_mov_b32 s45, 7168
  s_mov_b32 s46, 14336
  s_mov_b32 s47, 21504
  s_mov_b32 s48, 114688
  s_mov_b32 s49, 121856
  s_mov_b32 s50, 129024
  s_mov_b32 s51, 136192
  s_mov_b32 s52, 229376
  s_mov_b32 s53, 236544
  s_mov_b32 s54, 243712
  s_mov_b32 s55, 250880
  s_mov_b32 s56, 344064
  s_mov_b32 s57, 351232
  s_mov_b32 s58, 358400
  s_mov_b32 s59, 365568
  s_mov_b32 s60, 0
  s_mov_b32 s61, 0
  s_mov_b32 s60, 49152
  s_mov_b32 s61, 5
  s_mov_b32 s62, 49152
  s_barrier
  ds_read_b128 a[64:67], v7 offset:0
  ds_read_b128 a[68:71], v7 offset:8192
  ds_read_b128 a[0:3], v5 offset:0
  ds_read_b128 a[4:7], v6 offset:0
  ds_read_b128 a[8:11], v5 offset:2048
  ds_read_b128 a[12:15], v6 offset:2048
  ds_read_b128 a[16:19], v5 offset:4096
  ds_read_b128 a[72:75], v7 offset:256
  ds_read_b128 a[76:79], v7 offset:8448
  ds_read_b128 a[20:23], v6 offset:4096
  ds_read_b128 a[24:27], v5 offset:6144
  ds_read_b128 a[28:31], v6 offset:6144
  ds_read_b128 a[80:83], v7 offset:512
  ds_read_b128 a[84:87], v7 offset:8704
  s_cmp_eq_u32 s38, 0
  s_cbranch_scc0 L_c0
  s_lshl_b32 s3, s2, 6
  s_add_u32 s3, s3, 9441280
  v_mov_b32 v12, s3
  s_mov_b64 exec, 1
  buffer_store_dwordx2 v[10:11], v12, s[28:31], 0 offen sc1
  s_mov_b64 exec, -1
L_c0:
  s_waitcnt lgkmcnt(0)
.p2align 6
L_c:
  v_mfma_f32_16x16x32_bf16 v[16:19], a[0:3], a[64:67], v[16:19]
  v_mfma_f32_16x16x32_bf16 v[16:19], a[4:7], a[68:71], v[16:19]
  ds_read_b128 a[88:91], v7 offset:768
  ds_read_b128 a[92:95], v7 offset:8960
  v_mfma_f32_16x16x32_bf16 v[48:51], a[8:11], a[64:67], v[48:51]
  v_mfma_f32_16x16x32_bf16 v[48:51], a[12:15], a[68:71], v[48:51]
  s_cmp_eq_u32 s60, 147456
  v_mfma_f32_16x16x32_bf16 v[80:83], a[16:19], a[64:67], v[80:83]
  v_mfma_f32_16x16x32_bf16 v[80:83], a[20:23], a[68:71], v[80:83]
  s_cselect_b32 s60, 0, s60
  v_add_u32 v1, s60, v146
  v_mfma_f32_16x16x32_bf16 v[112:115], a[24:27], a[64:67], v[112:115]
  v_mfma_f32_16x16x32_bf16 v[112:115], a[28:31], a[68:71], v[112:115]
  v_mfma_f32_16x16x32_bf16 v[20:23], a[0:3], a[72:75], v[20:23]
  v_mfma_f32_16x16x32_bf16 v[20:23], a[4:7], a[76:79], v[20:23]
  ds_read_b128 a[64:67], v7 offset:1024
  ds_read_b128 a[68:71], v7 offset:9216
  v_mfma_f32_16x16x32_bf16 v[52:55], a[8:11], a[72:75], v[52:55]
  v_mfma_f32_16x16x32_bf16 v[52:55], a[12:15], a[76:79], v[52:55]
  v_mfma_f32_16x16x32_bf16 v[84:87], a[16:19], a[72:75], v[84:87]
  v_mfma_f32_16x16x32_bf16 v[84:87], a[20:23], a[76:79], v[84:87]
  v_mfma_f32_16x16x32_bf16 v[116:119], a[24:27], a[72:75], v[116:119]
  v_mfma_f32_16x16x32_bf16 v[116:119], a[28:31], a[76:79], v[116:119]
  v_mfma_f32_16x16x32_bf16 v[24:27], a[0:3], a[80:83], v[24:27]
  v_mfma_f32_16x16x32_bf16 v[24:27], a[4:7], a[84:87], v[24:27]
  ds_read_b128 a[72:75], v7 offset:1280
  ds_read_b128 a[76:79], v7 offset:9472
  v_mfma_f32_16x16x32_bf16 v[56:59], a[8:11], a[80:83], v[56:59]
  v_mfma_f32_16x16x32_bf16 v[56:59], a[12:15], a[84:87], v[56:59]
  v_mfma_f32_16x16x32_bf16 v[88:91], a[16:19], a[80:83], v[88:91]
  v_mfma_f32_16x16x32_bf16 v[88:91], a[20:23], a[84:87], v[88:91]
  v_mfma_f32_16x16x32_bf16 v[120:123], a[24:27], a[80:83], v[120:123]
  v_mfma_f32_16x16x32_bf16 v[120:123], a[28:31], a[84:87], v[120:123]
  v_add_u32 v3, s60, v144
  s_waitcnt lgkmcnt(0)
  v_mfma_f32_16x16x32_bf16 v[28:31], a[0:3], a[88:91], v[28:31]
  v_mfma_f32_16x16x32_bf16 v[28:31], a[4:7], a[92:95], v[28:31]
  ds_read_b128 a[80:83], v7 offset:1536
  ds_read_b128 a[84:87], v7 offset:9728
  v_mfma_f32_16x16x32_bf16 v[60:63], a[8:11], a[88:91], v[60:63]
  v_mfma_f32_16x16x32_bf16 v[60:63], a[12:15], a[92:95], v[60:63]
  v_add_u32_e64 v4, s60, v145
  v_mfma_f32_16x16x32_bf16 v[92:95], a[16:19], a[88:91], v[92:95]
  v_mfma_f32_16x16x32_bf16 v[92:95], a[20:23], a[92:95], v[92:95]
  v_mfma_f32_16x16x32_bf16 v[124:127], a[24:27], a[88:91], v[124:127]
  v_mfma_f32_16x16x32_bf16 v[124:127], a[28:31], a[92:95], v[124:127]
  v_mfma_f32_16x16x32_bf16 v[32:35], a[0:3], a[64:67], v[32:35]
  v_mfma_f32_16x16x32_bf16 v[32:35], a[4:7], a[68:71], v[32:35]
  ds_read_b128 a[88:91], v7 offset:1792
  ds_read_b128 a[92:95], v7 offset:9984
  v_mfma_f32_16x16x32_bf16 v[64:67], a[8:11], a[64:67], v[64:67]
  v_mfma_f32_16x16x32_bf16 v[64:67], a[12:15], a[68:71], v[64:67]
  v_mfma_f32_16x16x32_bf16 v[96:99], a[16:19], a[64:67], v[96:99]
  v_mfma_f32_16x16x32_bf16 v[96:99], a[20:23], a[68:71], v[96:99]
  v_mfma_f32_16x16x32_bf16 v[128:131], a[24:27], a[64:67], v[128:131]
  v_mfma_f32_16x16x32_bf16 v[128:131], a[28:31], a[68:71], v[128:131]
  s_waitcnt lgkmcnt(0)
  s_barrier
  v_mfma_f32_16x16x32_bf16 v[36:39], a[0:3], a[72:75], v[36:39]
  v_mfma_f32_16x16x32_bf16 v[36:39], a[4:7], a[76:79], v[36:39]
  ds_read_b128 a[64:67], v1 offset:0
  ds_read_b128 a[68:71], v1 offset:8192
  v_mfma_f32_16x16x32_bf16 v[68:71], a[8:11], a[72:75], v[68:71]
  v_mfma_f32_16x16x32_bf16 v[68:71], a[12:15], a[76:79], v[68:71]
  ds_read_b128 a[32:35], v3 offset:0
  ds_read_b128 a[36:39], v4 offset:0
  v_mfma_f32_16x16x32_bf16 v[100:103], a[16:19], a[72:75], v[100:103]
  v_mfma_f32_16x16x32_bf16 v[100:103], a[20:23], a[76:79], v[100:103]
  ds_read_b128 a[40:43], v3 offset:2048
  ds_read_b128 a[44:47], v4 offset:2048
  v_mfma_f32_16x16x32_bf16 v[132:135], a[24:27], a[72:75], v[132:135]
  v_mfma_f32_16x16x32_bf16 v[132:135], a[28:31], a[76:79], v[132:135]
  ds_read_b128 a[48:51], v3 offset:4096
  v_mfma_f32_16x16x32_bf16 v[40:43], a[0:3], a[80:83], v[40:43]
  v_mfma_f32_16x16x32_bf16 v[40:43], a[4:7], a[84:87], v[40:43]
  ds_read_b128 a[72:75], v1 offset:256
  ds_read_b128 a[76:79], v1 offset:8448
  v_mfma_f32_16x16x32_bf16 v[72:75], a[8:11], a[80:83], v[72:75]
  v_mfma_f32_16x16x32_bf16 v[72:75], a[12:15], a[84:87], v[72:75]
  ds_read_b128 a[52:55], v4 offset:4096
  v_mfma_f32_16x16x32_bf16 v[104:107], a[16:19], a[80:83], v[104:107]
  v_mfma_f32_16x16x32_bf16 v[104:107], a[20:23], a[84:87], v[104:107]
  ds_read_b128 a[56:59], v3 offset:6144
  v_mfma_f32_16x16x32_bf16 v[136:139], a[24:27], a[80:83], v[136:139]
  v_mfma_f32_16x16x32_bf16 v[136:139], a[28:31], a[84:87], v[136:139]
  ds_read_b128 a[60:63], v4 offset:6144
  v_mfma_f32_16x16x32_bf16 v[44:47], a[0:3], a[88:91], v[44:47]
  v_mfma_f32_16x16x32_bf16 v[44:47], a[4:7], a[92:95], v[44:47]
  ds_read_b128 a[80:83], v1 offset:512
  ds_read_b128 a[84:87], v1 offset:8704
  v_mfma_f32_16x16x32_bf16 v[76:79], a[8:11], a[88:91], v[76:79]
  v_mfma_f32_16x16x32_bf16 v[76:79], a[12:15], a[92:95], v[76:79]
  v_mfma_f32_16x16x32_bf16 v[108:111], a[16:19], a[88:91], v[108:111]
  v_mfma_f32_16x16x32_bf16 v[108:111], a[20:23], a[92:95], v[108:111]
  v_mfma_f32_16x16x32_bf16 v[140:143], a[24:27], a[88:91], v[140:143]
  v_mfma_f32_16x16x32_bf16 v[140:143], a[28:31], a[92:95], v[140:143]
  s_add_u32 s60, s60, s62
  s_waitcnt lgkmcnt(0)
  v_mfma_f32_16x16x32_bf16 v[16:19], a[32:35], a[64:67], v[16:19]
  v_mfma_f32_16x16x32_bf16 v[16:19], a[36:39], a[68:71], v[16:19]
  ds_read_b128 a[88:91], v1 offset:768
  ds_read_b128 a[92:95], v1 offset:8960
  v_mfma_f32_16x16x32_bf16 v[48:51], a[40:43], a[64:67], v[48:51]
  v_mfma_f32_16x16x32_bf16 v[48:51], a[44:47], a[68:71], v[48:51]
  s_cmp_eq_u32 s60, 147456
  v_mfma_f32_16x16x32_bf16 v[80:83], a[48:51], a[64:67], v[80:83]
  v_mfma_f32_16x16x32_bf16 v[80:83], a[52:55], a[68:71], v[80:83]
  s_cselect_b32 s60, 0, s60
  v_add_u32 v7, s60, v146
  v_mfma_f32_16x16x32_bf16 v[112:115], a[56:59], a[64:67], v[112:115]
  v_mfma_f32_16x16x32_bf16 v[112:115], a[60:63], a[68:71], v[112:115]
  v_mfma_f32_16x16x32_bf16 v[20:23], a[32:35], a[72:75], v[20:23]
  v_mfma_f32_16x16x32_bf16 v[20:23], a[36:39], a[76:79], v[20:23]
  ds_read_b128 a[64:67], v1 offset:1024
  ds_read_b128 a[68:71], v1 offset:9216
  v_mfma_f32_16x16x32_bf16 v[52:55], a[40:43], a[72:75], v[52:55]
  v_mfma_f32_16x16x32_bf16 v[52:55], a[44:47], a[76:79], v[52:55]
  v_mfma_f32_16x16x32_bf16 v[84:87], a[48:51], a[72:75], v[84:87]
  v_mfma_f32_16x16x32_bf16 v[84:87], a[52:55], a[76:79], v[84:87]
  v_mfma_f32_16x16x32_bf16 v[116:119], a[56:59], a[72:75], v[116:119]
  v_mfma_f32_16x16x32_bf16 v[116:119], a[60:63], a[76:79], v[116:119]
  v_mfma_f32_16x16x32_bf16 v[24:27], a[32:35], a[80:83], v[24:27]
  v_mfma_f32_16x16x32_bf16 v[24:27], a[36:39], a[84:87], v[24:27]
  ds_read_b128 a[72:75], v1 offset:1280
  ds_read_b128 a[76:79], v1 offset:9472
  v_mfma_f32_16x16x32_bf16 v[56:59], a[40:43], a[80:83], v[56:59]
  v_mfma_f32_16x16x32_bf16 v[56:59], a[44:47], a[84:87], v[56:59]
  v_mfma_f32_16x16x32_bf16 v[88:91], a[48:51], a[80:83], v[88:91]
  v_mfma_f32_16x16x32_bf16 v[88:91], a[52:55], a[84:87], v[88:91]
  v_mfma_f32_16x16x32_bf16 v[120:123], a[56:59], a[80:83], v[120:123]
  v_mfma_f32_16x16x32_bf16 v[120:123], a[60:63], a[84:87], v[120:123]
  v_add_u32 v5, s60, v144
  s_waitcnt lgkmcnt(0)
  v_mfma_f32_16x16x32_bf16 v[28:31], a[32:35], a[88:91], v[28:31]
  v_mfma_f32_16x16x32_bf16 v[28:31], a[36:39], a[92:95], v[28:31]
  ds_read_b128 a[80:83], v1 offset:1536
  ds_read_b128 a[84:87], v1 offset:9728
  v_mfma_f32_16x16x32_bf16 v[60:63], a[40:43], a[88:91], v[60:63]
  v_mfma_f32_16x16x32_bf16 v[60:63], a[44:47], a[92:95], v[60:63]
  v_add_u32_e64 v6, s60, v145
  v_mfma_f32_16x16x32_bf16 v[92:95], a[48:51], a[88:91], v[92:95]
  v_mfma_f32_16x16x32_bf16 v[92:95], a[52:55], a[92:95], v[92:95]
  v_mfma_f32_16x16x32_bf16 v[124:127], a[56:59], a[88:91], v[124:127]
  v_mfma_f32_16x16x32_bf16 v[124:127], a[60:63], a[92:95], v[124:127]
  v_mfma_f32_16x16x32_bf16 v[32:35], a[32:35], a[64:67], v[32:35]
  v_mfma_f32_16x16x32_bf16 v[32:35], a[36:39], a[68:71], v[32:35]
  ds_read_b128 a[88:91], v1 offset:1792
  ds_read_b128 a[92:95], v1 offset:9984
  v_mfma_f32_16x16x32_bf16 v[64:67], a[40:43], a[64:67], v[64:67]
  v_mfma_f32_16x16x32_bf16 v[64:67], a[44:47], a[68:71], v[64:67]
  v_mfma_f32_16x16x32_bf16 v[96:99], a[48:51], a[64:67], v[96:99]
  v_mfma_f32_16x16x32_bf16 v[96:99], a[52:55], a[68:71], v[96:99]
  v_mfma_f32_16x16x32_bf16 v[128:131], a[56:59], a[64:67], v[128:131]
  v_mfma_f32_16x16x32_bf16 v[128:131], a[60:63], a[68:71], v[128:131]
  s_waitcnt lgkmcnt(0)
  s_barrier
  v_mfma_f32_16x16x32_bf16 v[36:39], a[32:35], a[72:75], v[36:39]
  v_mfma_f32_16x16x32_bf16 v[36:39], a[36:39], a[76:79], v[36:39]
  ds_read_b128 a[64:67], v7 offset:0
  ds_read_b128 a[68:71], v7 offset:8192
  v_mfma_f32_16x16x32_bf16 v[68:71], a[40:43], a[72:75], v[68:71]
  v_mfma_f32_16x16x32_bf16 v[68:71], a[44:47], a[76:79], v[68:71]
  ds_read_b128 a[0:3], v5 offset:0
  ds_read_b128 a[4:7], v6 offset:0
  v_mfma_f32_16x16x32_bf16 v[100:103], a[48:51], a[72:75], v[100:103]
  v_mfma_f32_16x16x32_bf16 v[100:103], a[52:55], a[76:79], v[100:103]
  ds_read_b128 a[8:11], v5 offset:2048
  ds_read_b128 a[12:15], v6 offset:2048
  v_mfma_f32_16x16x32_bf16 v[132:135], a[56:59], a[72:75], v[132:135]
  v_mfma_f32_16x16x32_bf16 v[132:135], a[60:63], a[76:79], v[132:135]
  ds_read_b128 a[16:19], v5 offset:4096
  v_mfma_f32_16x16x32_bf16 v[40:43], a[32:35], a[80:83], v[40:43]
  v_mfma_f32_16x16x32_bf16 v[40:43], a[36:39], a[84:87], v[40:43]
  ds_read_b128 a[72:75], v7 offset:256
  ds_read_b128 a[76:79], v7 offset:8448
  v_mfma_f32_16x16x32_bf16 v[72:75], a[40:43], a[80:83], v[72:75]
  v_mfma_f32_16x16x32_bf16 v[72:75], a[44:47], a[84:87], v[72:75]
  ds_read_b128 a[20:23], v6 offset:4096
  v_mfma_f32_16x16x32_bf16 v[104:107], a[48:51], a[80:83], v[104:107]
  v_mfma_f32_16x16x32_bf16 v[104:107], a[52:55], a[84:87], v[104:107]
  ds_read_b128 a[24:27], v5 offset:6144
  v_mfma_f32_16x16x32_bf16 v[136:139], a[56:59], a[80:83], v[136:139]
  v_mfma_f32_16x16x32_bf16 v[136:139], a[60:63], a[84:87], v[136:139]
  ds_read_b128 a[28:31], v6 offset:6144
  v_mfma_f32_16x16x32_bf16 v[44:47], a[32:35], a[88:91], v[44:47]
  v_mfma_f32_16x16x32_bf16 v[44:47], a[36:39], a[92:95], v[44:47]
  ds_read_b128 a[80:83], v7 offset:512
  ds_read_b128 a[84:87], v7 offset:8704
  v_mfma_f32_16x16x32_bf16 v[76:79], a[40:43], a[88:91], v[76:79]
  v_mfma_f32_16x16x32_bf16 v[76:79], a[44:47], a[92:95], v[76:79]
  v_mfma_f32_16x16x32_bf16 v[108:111], a[48:51], a[88:91], v[108:111]
  v_mfma_f32_16x16x32_bf16 v[108:111], a[52:55], a[92:95], v[108:111]
  v_mfma_f32_16x16x32_bf16 v[140:143], a[56:59], a[88:91], v[140:143]
  v_mfma_f32_16x16x32_bf16 v[140:143], a[60:63], a[92:95], v[140:143]
  s_add_u32 s60, s60, s62
  s_sub_u32 s61, s61, 1
  s_waitcnt lgkmcnt(0)
  s_cbranch_scc0 L_c
  v_mfma_f32_16x16x32_bf16 v[16:19], a[0:3], a[64:67], v[16:19]
  v_mfma_f32_16x16x32_bf16 v[16:19], a[4:7], a[68:71], v[16:19]
  ds_read_b128 a[88:91], v7 offset:768
  ds_read_b128 a[92:95], v7 offset:8960
  v_mfma_f32_16x16x32_bf16 v[48:51], a[8:11], a[64:67], v[48:51]
  v_mfma_f32_16x16x32_bf16 v[48:51], a[12:15], a[68:71], v[48:51]
  v_mfma_f32_16x16x32_bf16 v[80:83], a[16:19], a[64:67], v[80:83]
  v_mfma_f32_16x16x32_bf16 v[80:83], a[20:23], a[68:71], v[80:83]
  v_add_u32 v8, 49152, v144
  v_mfma_f32_16x16x32_bf16 v[112:115], a[24:27], a[64:67], v[112:115]
  v_mfma_f32_16x16x32_bf16 v[112:115], a[28:31], a[68:71], v[112:115]
  v_add_u32 v9, 49152, v145
  v_mfma_f32_16x16x32_bf16 v[20:23], a[0:3], a[72:75], v[20:23]
  v_mfma_f32_16x16x32_bf16 v[20:23], a[4:7], a[76:79], v[20:23]
  ds_read_b128 a[64:67], v7 offset:1024
  ds_read_b128 a[68:71], v7 offset:9216
  v_mfma_f32_16x16x32_bf16 v[52:55], a[8:11], a[72:75], v[52:55]
  v_mfma_f32_16x16x32_bf16 v[52:55], a[12:15], a[76:79], v[52:55]
  v_mfma_f32_16x16x32_bf16 v[84:87], a[16:19], a[72:75], v[84:87]
  v_mfma_f32_16x16x32_bf16 v[84:87], a[20:23], a[76:79], v[84:87]
  v_add_u32 v10, 49152, v146
  v_mfma_f32_16x16x32_bf16 v[116:119], a[24:27], a[72:75], v[116:119]
  v_mfma_f32_16x16x32_bf16 v[116:119], a[28:31], a[76:79], v[116:119]
  v_mfma_f32_16x16x32_bf16 v[24:27], a[0:3], a[80:83], v[24:27]
  v_mfma_f32_16x16x32_bf16 v[24:27], a[4:7], a[84:87], v[24:27]
  v_add_u32 v11, 98304, v144
  ds_read_b128 a[72:75], v7 offset:1280
  ds_read_b128 a[76:79], v7 offset:9472
  v_mfma_f32_16x16x32_bf16 v[56:59], a[8:11], a[80:83], v[56:59]
  v_mfma_f32_16x16x32_bf16 v[56:59], a[12:15], a[84:87], v[56:59]
  v_add_u32 v12, 98304, v145
  v_mfma_f32_16x16x32_bf16 v[88:91], a[16:19], a[80:83], v[88:91]
  v_mfma_f32_16x16x32_bf16 v[88:91], a[20:23], a[84:87], v[88:91]
  v_mfma_f32_16x16x32_bf16 v[120:123], a[24:27], a[80:83], v[120:123]
  v_mfma_f32_16x16x32_bf16 v[120:123], a[28:31], a[84:87], v[120:123]
  s_waitcnt lgkmcnt(0)
  s_nop 0
  v_mfma_f32_16x16x32_bf16 v[28:31], a[0:3], a[88:91], v[28:31]
  v_mfma_f32_16x16x32_bf16 v[28:31], a[4:7], a[92:95], v[28:31]
  v_add_u32 v13, 98304, v146
  ds_read_b128 a[80:83], v7 offset:1536
  ds_read_b128 a[84:87], v7 offset:9728
  v_mfma_f32_16x16x32_bf16 v[60:63], a[8:11], a[88:91], v[60:63]
  v_mfma_f32_16x16x32_bf16 v[60:63], a[12:15], a[92:95], v[60:63]
  v_mfma_f32_16x16x32_bf16 v[92:95], a[16:19], a[88:91], v[92:95]
  v_mfma_f32_16x16x32_bf16 v[92:95], a[20:23], a[92:95], v[92:95]
  v_mfma_f32_16x16x32_bf16 v[124:127], a[24:27], a[88:91], v[124:127]
  v_mfma_f32_16x16x32_bf16 v[124:127], a[28:31], a[92:95], v[124:127]
  v_mfma_f32_16x16x32_bf16 v[32:35], a[0:3], a[64:67], v[32:35]
  v_mfma_f32_16x16x32_bf16 v[32:35], a[4:7], a[68:71], v[32:35]
  ds_read_b128 a[88:91], v7 offset:1792
  ds_read_b128 a[92:95], v7 offset:9984
  v_mfma_f32_16x16x32_bf16 v[64:67], a[8:11], a[64:67], v[64:67]
  v_mfma_f32_16x16x32_bf16 v[64:67], a[12:15], a[68:71], v[64:67]
  v_mfma_f32_16x16x32_bf16 v[96:99], a[16:19], a[64:67], v[96:99]
  v_mfma_f32_16x16x32_bf16 v[96:99], a[20:23], a[68:71], v[96:99]
  v_mfma_f32_16x16x32_bf16 v[128:131], a[24:27], a[64:67], v[128:131]
  v_mfma_f32_16x16x32_bf16 v[128:131], a[28:31], a[68:71], v[128:131]
  s_waitcnt lgkmcnt(0)
  s_barrier
  v_mfma_f32_16x16x32_bf16 v[36:39], a[0:3], a[72:75], v[36:39]
  v_mfma_f32_16x16x32_bf16 v[36:39], a[4:7], a[76:79], v[36:39]
  v_mfma_f32_16x16x32_bf16 v[68:71], a[8:11], a[72:75], v[68:71]
  v_mfma_f32_16x16x32_bf16 v[68:71], a[12:15], a[76:79], v[68:71]
  v_mfma_f32_16x16x32_bf16 v[100:103], a[16:19], a[72:75], v[100:103]
  v_mfma_f32_16x16x32_bf16 v[100:103], a[20:23], a[76:79], v[100:103]
  v_mfma_f32_16x16x32_bf16 v[132:135], a[24:27], a[72:75], v[132:135]
  v_mfma_f32_16x16x32_bf16 v[132:135], a[28:31], a[76:79], v[132:135]
  v_mfma_f32_16x16x32_bf16 v[40:43], a[0:3], a[80:83], v[40:43]
  v_mfma_f32_16x16x32_bf16 v[40:43], a[4:7], a[84:87], v[40:43]
  ds_read_b128 a[32:35], v10 offset:0
  ds_read_b128 a[36:39], v8 offset:0
  v_mfma_f32_16x16x32_bf16 v[72:75], a[8:11], a[80:83], v[72:75]
  v_mfma_f32_16x16x32_bf16 v[72:75], a[12:15], a[84:87], v[72:75]
  ds_read_b128 a[40:43], v8 offset:2048
  ds_read_b128 a[44:47], v10 offset:256
  v_mfma_f32_16x16x32_bf16 v[104:107], a[16:19], a[80:83], v[104:107]
  v_mfma_f32_16x16x32_bf16 v[104:107], a[20:23], a[84:87], v[104:107]
  ds_read_b128 a[48:51], v10 offset:512
  ds_read_b128 a[52:55], v10 offset:768
  v_mfma_f32_16x16x32_bf16 v[136:139], a[24:27], a[80:83], v[136:139]
  v_mfma_f32_16x16x32_bf16 v[136:139], a[28:31], a[84:87], v[136:139]
  ds_read_b128 a[56:59], v10 offset:1024
  ds_read_b128 a[60:63], v10 offset:1280
  v_mfma_f32_16x16x32_bf16 v[44:47], a[0:3], a[88:91], v[44:47]
  v_mfma_f32_16x16x32_bf16 v[44:47], a[4:7], a[92:95], v[44:47]
  ds_read_b128 a[64:67], v10 offset:1536
  ds_read_b128 a[68:71], v10 offset:1792
  v_mfma_f32_16x16x32_bf16 v[76:79], a[8:11], a[88:91], v[76:79]
  v_mfma_f32_16x16x32_bf16 v[76:79], a[12:15], a[92:95], v[76:79]
  v_mfma_f32_16x16x32_bf16 v[108:111], a[16:19], a[88:91], v[108:111]
  v_mfma_f32_16x16x32_bf16 v[108:111], a[20:23], a[92:95], v[108:111]
  v_mfma_f32_16x16x32_bf16 v[140:143], a[24:27], a[88:91], v[140:143]
  v_mfma_f32_16x16x32_bf16 v[140:143], a[28:31], a[92:95], v[140:143]
  s_waitcnt lgkmcnt(0)
  s_nop 0
  v_mfma_f32_16x16x32_bf16 v[16:19], a[36:39], a[32:35], v[16:19]
  ds_read_b128 a[72:75], v10 offset:8192
  v_mfma_f32_16x16x32_bf16 v[48:51], a[40:43], a[32:35], v[48:51]
  ds_read_b128 a[76:79], v9 offset:0
  v_mfma_f32_16x16x32_bf16 v[20:23], a[36:39], a[44:47], v[20:23]
  ds_read_b128 a[80:83], v9 offset:2048
  v_mfma_f32_16x16x32_bf16 v[52:55], a[40:43], a[44:47], v[52:55]
  ds_read_b128 a[84:87], v10 offset:8448
  v_mfma_f32_16x16x32_bf16 v[24:27], a[36:39], a[48:51], v[24:27]
  ds_read_b128 a[0:3], v10 offset:8704
  v_mfma_f32_16x16x32_bf16 v[56:59], a[40:43], a[48:51], v[56:59]
  ds_read_b128 a[4:7], v10 offset:8960
  v_mfma_f32_16x16x32_bf16 v[28:31], a[36:39], a[52:55], v[28:31]
  ds_read_b128 a[8:11], v10 offset:9216
  v_mfma_f32_16x16x32_bf16 v[60:63], a[40:43], a[52:55], v[60:63]
  ds_read_b128 a[12:15], v10 offset:9472
  v_mfma_f32_16x16x32_bf16 v[32:35], a[36:39], a[56:59], v[32:35]
  ds_read_b128 a[16:19], v10 offset:9728
  v_mfma_f32_16x16x32_bf16 v[64:67], a[40:43], a[56:59], v[64:67]
  ds_read_b128 a[20:23], v10 offset:9984
  v_mfma_f32_16x16x32_bf16 v[36:39], a[36:39], a[60:63], v[36:39]
  v_mfma_f32_16x16x32_bf16 v[68:71], a[40:43], a[60:63], v[68:71]
  v_mfma_f32_16x16x32_bf16 v[40:43], a[36:39], a[64:67], v[40:43]
  v_mfma_f32_16x16x32_bf16 v[72:75], a[40:43], a[64:67], v[72:75]
  v_mfma_f32_16x16x32_bf16 v[44:47], a[36:39], a[68:71], v[44:47]
  v_mfma_f32_16x16x32_bf16 v[76:79], a[40:43], a[68:71], v[76:79]
  s_waitcnt lgkmcnt(0)
  s_nop 0
  v_mfma_f32_16x16x32_bf16 v[16:19], a[76:79], a[72:75], v[16:19]
  s_barrier
  ds_read_b128 a[24:27], v13 offset:0
  s_nop 0
  v_mfma_f32_16x16x32_bf16 v[48:51], a[80:83], a[72:75], v[48:51]
  ds_read_b128 a[28:31], v11 offset:0
  v_mfma_f32_16x16x32_bf16 v[20:23], a[76:79], a[84:87], v[20:23]
  ds_read_b128 a[88:91], v11 offset:2048
  v_mfma_f32_16x16x32_bf16 v[52:55], a[80:83], a[84:87], v[52:55]
  ds_read_b128 a[92:95], v13 offset:256
  v_mfma_f32_16x16x32_bf16 v[24:27], a[76:79], a[0:3], v[24:27]
  ds_read_b128 a[32:35], v13 offset:512
  v_mfma_f32_16x16x32_bf16 v[56:59], a[80:83], a[0:3], v[56:59]
  ds_read_b128 a[44:47], v13 offset:768
  v_mfma_f32_16x16x32_bf16 v[28:31], a[76:79], a[4:7], v[28:31]
  ds_read_b128 a[48:51], v13 offset:1024
  v_mfma_f32_16x16x32_bf16 v[60:63], a[80:83], a[4:7], v[60:63]
  ds_read_b128 a[52:55], v13 offset:1280
  v_mfma_f32_16x16x32_bf16 v[32:35], a[76:79], a[8:11], v[32:35]
  ds_read_b128 a[56:59], v13 offset:1536
  v_mfma_f32_16x16x32_bf16 v[64:67], a[80:83], a[8:11], v[64:67]
  ds_read_b128 a[60:63], v13 offset:1792
  v_mfma_f32_16x16x32_bf16 v[36:39], a[76:79], a[12:15], v[36:39]
  v_mfma_f32_16x16x32_bf16 v[68:71], a[80:83], a[12:15], v[68:71]
  v_mfma_f32_16x16x32_bf16 v[40:43], a[76:79], a[16:19], v[40:43]
  v_mfma_f32_16x16x32_bf16 v[72:75], a[80:83], a[16:19], v[72:75]
  v_mfma_f32_16x16x32_bf16 v[44:47], a[76:79], a[20:23], v[44:47]
  v_mfma_f32_16x16x32_bf16 v[76:79], a[80:83], a[20:23], v[76:79]
  s_waitcnt lgkmcnt(0)
  s_nop 0
  v_mfma_f32_16x16x32_bf16 v[16:19], a[28:31], a[24:27], v[16:19]
  ds_read_b128 a[64:67], v13 offset:8192
  v_mfma_f32_16x16x32_bf16 v[48:51], a[88:91], a[24:27], v[48:51]
  ds_read_b128 a[36:39], v12 offset:0
  v_mfma_f32_16x16x32_bf16 v[20:23], a[28:31], a[92:95], v[20:23]
  ds_read_b128 a[40:43], v12 offset:2048
  v_mfma_f32_16x16x32_bf16 v[52:55], a[88:91], a[92:95], v[52:55]
  ds_read_b128 a[68:71], v13 offset:8448
  v_mfma_f32_16x16x32_bf16 v[24:27], a[28:31], a[32:35], v[24:27]
  ds_read_b128 a[72:75], v13 offset:8704
  v_mfma_f32_16x16x32_bf16 v[56:59], a[88:91], a[32:35], v[56:59]
  ds_read_b128 a[84:87], v13 offset:8960
  v_mfma_f32_16x16x32_bf16 v[28:31], a[28:31], a[44:47], v[28:31]
  ds_read_b128 a[0:3], v13 offset:9216
  v_mfma_f32_16x16x32_bf16 v[60:63], a[88:91], a[44:47], v[60:63]
  ds_read_b128 a[4:7], v13 offset:9472
  v_mfma_f32_16x16x32_bf16 v[32:35], a[28:31], a[48:51], v[32:35]
  ds_read_b128 a[8:11], v13 offset:9728
  v_mfma_f32_16x16x32_bf16 v[64:67], a[88:91], a[48:51], v[64:67]
  ds_read_b128 a[12:15], v13 offset:9984
  v_mfma_f32_16x16x32_bf16 v[36:39], a[28:31], a[52:55], v[36:39]
  v_mfma_f32_16x16x32_bf16 v[68:71], a[88:91], a[52:55], v[68:71]
  v_mfma_f32_16x16x32_bf16 v[40:43], a[28:31], a[56:59], v[40:43]
  v_mfma_f32_16x16x32_bf16 v[72:75], a[88:91], a[56:59], v[72:75]
  v_mfma_f32_16x16x32_bf16 v[44:47], a[28:31], a[60:63], v[44:47]
  v_mfma_f32_16x16x32_bf16 v[76:79], a[88:91], a[60:63], v[76:79]
  s_waitcnt lgkmcnt(0)
  s_nop 0
  v_mfma_f32_16x16x32_bf16 v[16:19], a[36:39], a[64:67], v[16:19]
  s_barrier
  ds_read_b128 a[16:19], v146 offset:0
  s_nop 0
  v_mfma_f32_16x16x32_bf16 v[48:51], a[40:43], a[64:67], v[48:51]
  ds_read_b128 a[76:79], v144 offset:0
  v_mfma_f32_16x16x32_bf16 v[20:23], a[36:39], a[68:71], v[20:23]
  ds_read_b128 a[20:23], v144 offset:2048
  v_mfma_f32_16x16x32_bf16 v[52:55], a[40:43], a[68:71], v[52:55]
  ds_read_b128 a[80:83], v146 offset:256
  v_mfma_f32_16x16x32_bf16 v[24:27], a[36:39], a[72:75], v[24:27]
  ds_read_b128 a[24:27], v146 offset:512
  v_mfma_f32_16x16x32_bf16 v[56:59], a[40:43], a[72:75], v[56:59]
  ds_read_b128 a[92:95], v146 offset:768
  v_mfma_f32_16x16x32_bf16 v[28:31], a[36:39], a[84:87], v[28:31]
  ds_read_b128 a[32:35], v146 offset:1024
  v_mfma_f32_16x16x32_bf16 v[60:63], a[40:43], a[84:87], v[60:63]
  ds_read_b128 a[44:47], v146 offset:1280
  v_mfma_f32_16x16x32_bf16 v[32:35], a[36:39], a[0:3], v[32:35]
  ds_read_b128 a[48:51], v146 offset:1536
  v_mfma_f32_16x16x32_bf16 v[64:67], a[40:43], a[0:3], v[64:67]
  ds_read_b128 a[52:55], v146 offset:1792
  v_mfma_f32_16x16x32_bf16 v[36:39], a[36:39], a[4:7], v[36:39]
  v_mfma_f32_16x16x32_bf16 v[68:71], a[40:43], a[4:7], v[68:71]
  v_mfma_f32_16x16x32_bf16 v[40:43], a[36:39], a[8:11], v[40:43]
  v_mfma_f32_16x16x32_bf16 v[72:75], a[40:43], a[8:11], v[72:75]
  v_mfma_f32_16x16x32_bf16 v[44:47], a[36:39], a[12:15], v[44:47]
  v_mfma_f32_16x16x32_bf16 v[76:79], a[40:43], a[12:15], v[76:79]
  s_waitcnt lgkmcnt(0)
  s_nop 0
  v_mfma_f32_16x16x32_bf16 v[16:19], a[76:79], a[16:19], v[16:19]
  ds_read_b128 a[56:59], v146 offset:8192
  v_mfma_f32_16x16x32_bf16 v[48:51], a[20:23], a[16:19], v[48:51]
  ds_read_b128 a[28:31], v145 offset:0
  v_mfma_f32_16x16x32_bf16 v[20:23], a[76:79], a[80:83], v[20:23]
  ds_read_b128 a[60:63], v145 offset:2048
  v_mfma_f32_16x16x32_bf16 v[52:55], a[20:23], a[80:83], v[52:55]
  ds_read_b128 a[88:91], v146 offset:8448
  v_mfma_f32_16x16x32_bf16 v[24:27], a[76:79], a[24:27], v[24:27]
  ds_read_b128 a[64:67], v146 offset:8704
  v_mfma_f32_16x16x32_bf16 v[56:59], a[20:23], a[24:27], v[56:59]
  ds_read_b128 a[68:71], v146 offset:8960
  v_mfma_f32_16x16x32_bf16 v[28:31], a[76:79], a[92:95], v[28:31]
  ds_read_b128 a[72:75], v146 offset:9216
  v_mfma_f32_16x16x32_bf16 v[60:63], a[20:23], a[92:95], v[60:63]
  ds_read_b128 a[84:87], v146 offset:9472
  v_mfma_f32_16x16x32_bf16 v[32:35], a[76:79], a[32:35], v[32:35]
  ds_read_b128 a[0:3], v146 offset:9728
  v_mfma_f32_16x16x32_bf16 v[64:67], a[20:23], a[32:35], v[64:67]
  ds_read_b128 a[4:7], v146 offset:9984
  v_mfma_f32_16x16x32_bf16 v[36:39], a[76:79], a[44:47], v[36:39]
  v_mfma_f32_16x16x32_bf16 v[68:71], a[20:23], a[44:47], v[68:71]
  v_mfma_f32_16x16x32_bf16 v[40:43], a[76:79], a[48:51], v[40:43]
  v_mfma_f32_16x16x32_bf16 v[72:75], a[20:23], a[48:51], v[72:75]
  v_mfma_f32_16x16x32_bf16 v[44:47], a[76:79], a[52:55], v[44:47]
  v_mfma_f32_16x16x32_bf16 v[76:79], a[20:23], a[52:55], v[76:79]
  s_waitcnt lgkmcnt(0)
  s_nop 0
  v_mfma_f32_16x16x32_bf16 v[16:19], a[28:31], a[56:59], v[16:19]
  ds_read_b128 a[8:11], v10 offset:0
  v_mfma_f32_16x16x32_bf16 v[48:51], a[60:63], a[56:59], v[48:51]
  ds_read_b128 a[36:39], v8 offset:4096
  v_mfma_f32_16x16x32_bf16 v[20:23], a[28:31], a[88:91], v[20:23]
  ds_read_b128 a[12:15], v8 offset:6144
  v_mfma_f32_16x16x32_bf16 v[52:55], a[60:63], a[88:91], v[52:55]
  ds_read_b128 a[40:43], v10 offset:256
  v_mfma_f32_16x16x32_bf16 v[24:27], a[28:31], a[64:67], v[24:27]
  ds_read_b128 a[16:19], v10 offset:512
  v_mfma_f32_16x16x32_bf16 v[56:59], a[60:63], a[64:67], v[56:59]
  ds_read_b128 a[80:83], v10 offset:768
  v_mfma_f32_16x16x32_bf16 v[28:31], a[28:31], a[68:71], v[28:31]
  ds_read_b128 a[24:27], v10 offset:1024
  v_mfma_f32_16x16x32_bf16 v[60:63], a[60:63], a[68:71], v[60:63]
  ds_read_b128 a[92:95], v10 offset:1280
  v_mfma_f32_16x16x32_bf16 v[32:35], a[28:31], a[72:75], v[32:35]
  ds_read_b128 a[32:35], v10 offset:1536
  v_mfma_f32_16x16x32_bf16 v[64:67], a[60:63], a[72:75], v[64:67]
  ds_read_b128 a[44:47], v10 offset:1792
  v_mfma_f32_16x16x32_bf16 v[36:39], a[28:31], a[84:87], v[36:39]
  v_mfma_f32_16x16x32_bf16 v[68:71], a[60:63], a[84:87], v[68:71]
  v_mfma_f32_16x16x32_bf16 v[40:43], a[28:31], a[0:3], v[40:43]
  v_mfma_f32_16x16x32_bf16 v[72:75], a[60:63], a[0:3], v[72:75]
  v_mfma_f32_16x16x32_bf16 v[44:47], a[28:31], a[4:7], v[44:47]
  v_mfma_f32_16x16x32_bf16 v[76:79], a[60:63], a[4:7], v[76:79]
  s_waitcnt lgkmcnt(0)
  s_nop 0
  v_mfma_f32_16x16x32_bf16 v[80:83], a[36:39], a[8:11], v[80:83]
  ds_read_b128 a[48:51], v10 offset:8192
  v_mfma_f32_16x16x32_bf16 v[112:115], a[12:15], a[8:11], v[112:115]
  ds_read_b128 a[76:79], v9 offset:4096
  v_mfma_f32_16x16x32_bf16 v[84:87], a[36:39], a[40:43], v[84:87]
  v_cvt_pk_bf16_f32 v148, v16, v20
  ds_read_b128 a[20:23], v9 offset:6144
  v_mfma_f32_16x16x32_bf16 v[116:119], a[12:15], a[40:43], v[116:119]
  v_cvt_pk_bf16_f32 v149, v24, v28
  ds_read_b128 a[52:55], v10 offset:8448
  v_mfma_f32_16x16x32_bf16 v[88:91], a[36:39], a[16:19], v[88:91]
  v_cvt_pk_bf16_f32 v150, v32, v36
  ds_read_b128 a[56:59], v10 offset:8704
  v_mfma_f32_16x16x32_bf16 v[120:123], a[12:15], a[16:19], v[120:123]
  v_cvt_pk_bf16_f32 v151, v40, v44
  ds_read_b128 a[88:91], v10 offset:8960
  v_mfma_f32_16x16x32_bf16 v[92:95], a[36:39], a[80:83], v[92:95]
  buffer_store_dwordx4 v[148:151], v147, s[32:35], s44 offen sc0 sc1
  ds_read_b128 a[64:67], v10 offset:9216
  v_mfma_f32_16x16x32_bf16 v[124:127], a[12:15], a[80:83], v[124:127]
  v_cvt_pk_bf16_f32 v152, v17, v21
  ds_read_b128 a[68:71], v10 offset:9472
  v_mfma_f32_16x16x32_bf16 v[96:99], a[36:39], a[24:27], v[96:99]
  ds_read_b128 a[72:75], v10 offset:9728
  v_mfma_f32_16x16x32_bf16 v[128:131], a[12:15], a[24:27], v[128:131]
  v_cvt_pk_bf16_f32 v153, v25, v29
  ds_read_b128 a[84:87], v10 offset:9984
  v_mfma_f32_16x16x32_bf16 v[100:103], a[36:39], a[92:95], v[100:103]
  v_cvt_pk_bf16_f32 v154, v33, v37
  v_mfma_f32_16x16x32_bf16 v[132:135], a[12:15], a[92:95], v[132:135]
  v_cvt_pk_bf16_f32 v155, v41, v45
  v_mfma_f32_16x16x32_bf16 v[104:107], a[36:39], a[32:35], v[104:107]
  buffer_store_dwordx4 v[152:155], v147, s[32:35], s45 offen sc0 sc1
  v_mfma_f32_16x16x32_bf16 v[136:139], a[12:15], a[32:35], v[136:139]
  v_cvt_pk_bf16_f32 v156, v18, v22
  v_mfma_f32_16x16x32_bf16 v[108:111], a[36:39], a[44:47], v[108:111]
  v_cvt_pk_bf16_f32 v157, v26, v30
  v_mfma_f32_16x16x32_bf16 v[140:143], a[12:15], a[44:47], v[140:143]
  s_waitcnt lgkmcnt(0)
  s_nop 0
  v_mfma_f32_16x16x32_bf16 v[80:83], a[76:79], a[48:51], v[80:83]
  v_cvt_pk_bf16_f32 v158, v34, v38
  ds_read_b128 a[0:3], v13 offset:0
  v_mfma_f32_16x16x32_bf16 v[112:115], a[20:23], a[48:51], v[112:115]
  v_cvt_pk_bf16_f32 v159, v42, v46
  ds_read_b128 a[28:31], v11 offset:4096
  v_mfma_f32_16x16x32_bf16 v[84:87], a[76:79], a[52:55], v[84:87]
  buffer_store_dwordx4 v[156:159], v147, s[32:35], s46 offen sc0 sc1
  ds_read_b128 a[4:7], v11 offset:6144
  v_mfma_f32_16x16x32_bf16 v[116:119], a[20:23], a[52:55], v[116:119]
  v_cvt_pk_bf16_f32 v148, v19, v23
  ds_read_b128 a[60:63], v13 offset:256
  v_mfma_f32_16x16x32_bf16 v[88:91], a[76:79], a[56:59], v[88:91]
  v_cvt_pk_bf16_f32 v149, v27, v31
  ds_read_b128 a[8:11], v13 offset:512
  v_mfma_f32_16x16x32_bf16 v[120:123], a[20:23], a[56:59], v[120:123]
  v_cvt_pk_bf16_f32 v150, v35, v39
  ds_read_b128 a[40:43], v13 offset:768
  v_mfma_f32_16x16x32_bf16 v[92:95], a[76:79], a[88:91], v[92:95]
  ds_read_b128 a[16:19], v13 offset:1024
  v_mfma_f32_16x16x32_bf16 v[124:127], a[20:23], a[88:91], v[124:127]
  v_cvt_pk_bf16_f32 v151, v43, v47
  ds_read_b128 a[80:83], v13 offset:1280
  v_mfma_f32_16x16x32_bf16 v[96:99], a[76:79], a[64:67], v[96:99]
  buffer_store_dwordx4 v[148:151], v147, s[32:35], s47 offen sc0 sc1
  ds_read_b128 a[24:27], v13 offset:1536
  v_mfma_f32_16x16x32_bf16 v[128:131], a[20:23], a[64:67], v[128:131]
  v_cvt_pk_bf16_f32 v152, v48, v52
  ds_read_b128 a[92:95], v13 offset:1792
  v_mfma_f32_16x16x32_bf16 v[100:103], a[76:79], a[68:71], v[100:103]
  v_cvt_pk_bf16_f32 v153, v56, v60
  v_mfma_f32_16x16x32_bf16 v[132:135], a[20:23], a[68:71], v[132:135]
  v_cvt_pk_bf16_f32 v154, v64, v68
  v_mfma_f32_16x16x32_bf16 v[104:107], a[76:79], a[72:75], v[104:107]
  v_mfma_f32_16x16x32_bf16 v[136:139], a[20:23], a[72:75], v[136:139]
  v_cvt_pk_bf16_f32 v155, v72, v76
  v_mfma_f32_16x16x32_bf16 v[108:111], a[76:79], a[84:87], v[108:111]
  buffer_store_dwordx4 v[152:155], v147, s[32:35], s48 offen sc0 sc1
  v_mfma_f32_16x16x32_bf16 v[140:143], a[20:23], a[84:87], v[140:143]
  v_cvt_pk_bf16_f32 v156, v49, v53
  s_waitcnt lgkmcnt(0)
  s_nop 0
  v_mfma_f32_16x16x32_bf16 v[80:83], a[28:31], a[0:3], v[80:83]
  v_cvt_pk_bf16_f32 v157, v57, v61
  ds_read_b128 a[32:35], v13 offset:8192
  v_mfma_f32_16x16x32_bf16 v[112:115], a[4:7], a[0:3], v[112:115]
  v_cvt_pk_bf16_f32 v158, v65, v69
  ds_read_b128 a[36:39], v12 offset:4096
  v_mfma_f32_16x16x32_bf16 v[84:87], a[28:31], a[60:63], v[84:87]
  v_cvt_pk_bf16_f32 v159, v73, v77
  ds_read_b128 a[12:15], v12 offset:6144
  v_mfma_f32_16x16x32_bf16 v[116:119], a[4:7], a[60:63], v[116:119]
  ds_read_b128 a[44:47], v13 offset:8448
  v_mfma_f32_16x16x32_bf16 v[88:91], a[28:31], a[8:11], v[88:91]
  buffer_store_dwordx4 v[156:159], v147, s[32:35], s49 offen sc0 sc1
  ds_read_b128 a[48:51], v13 offset:8704
  v_mfma_f32_16x16x32_bf16 v[120:123], a[4:7], a[8:11], v[120:123]
  v_cvt_pk_bf16_f32 v148, v50, v54
  ds_read_b128 a[52:55], v13 offset:8960
  v_mfma_f32_16x16x32_bf16 v[92:95], a[28:31], a[40:43], v[92:95]
  v_cvt_pk_bf16_f32 v149, v58, v62
  ds_read_b128 a[56:59], v13 offset:9216
  v_mfma_f32_16x16x32_bf16 v[124:127], a[4:7], a[40:43], v[124:127]
  v_cvt_pk_bf16_f32 v150, v66, v70
  ds_read_b128 a[88:91], v13 offset:9472
  v_mfma_f32_16x16x32_bf16 v[96:99], a[28:31], a[16:19], v[96:99]
  v_cvt_pk_bf16_f32 v151, v74, v78
  ds_read_b128 a[64:67], v13 offset:9728
  v_mfma_f32_16x16x32_bf16 v[128:131], a[4:7], a[16:19], v[128:131]
  buffer_store_dwordx4 v[148:151], v147, s[32:35], s50 offen sc0 sc1
  ds_read_b128 a[68:71], v13 offset:9984
  v_mfma_f32_16x16x32_bf16 v[100:103], a[28:31], a[80:83], v[100:103]
  v_mfma_f32_16x16x32_bf16 v[132:135], a[4:7], a[80:83], v[132:135]
  v_cvt_pk_bf16_f32 v152, v51, v55
  v_mfma_f32_16x16x32_bf16 v[104:107], a[28:31], a[24:27], v[104:107]
  v_cvt_pk_bf16_f32 v153, v59, v63
  v_mfma_f32_16x16x32_bf16 v[136:139], a[4:7], a[24:27], v[136:139]
  v_cvt_pk_bf16_f32 v154, v67, v71
  v_mfma_f32_16x16x32_bf16 v[108:111], a[28:31], a[92:95], v[108:111]
  v_cvt_pk_bf16_f32 v155, v75, v79
  v_mfma_f32_16x16x32_bf16 v[140:143], a[4:7], a[92:95], v[140:143]
  buffer_store_dwordx4 v[152:155], v147, s[32:35], s51 offen sc0 sc1
  s_waitcnt lgkmcnt(0)
  s_nop 0
  v_mfma_f32_16x16x32_bf16 v[80:83], a[36:39], a[32:35], v[80:83]
  ds_read_b128 a[72:75], v146 offset:0
  v_mfma_f32_16x16x32_bf16 v[112:115], a[12:15], a[32:35], v[112:115]
  s_barrier
  ds_read_b128 a[76:79], v144 offset:4096
  s_nop 0
  v_mfma_f32_16x16x32_bf16 v[84:87], a[36:39], a[44:47], v[84:87]
  ds_read_b128 a[20:23], v144 offset:6144
  v_mfma_f32_16x16x32_bf16 v[116:119], a[12:15], a[44:47], v[116:119]
  ds_read_b128 a[84:87], v146 offset:256
  v_mfma_f32_16x16x32_bf16 v[88:91], a[36:39], a[48:51], v[88:91]
  ds_read_b128 a[0:3], v146 offset:512
  v_mfma_f32_16x16x32_bf16 v[120:123], a[12:15], a[48:51], v[120:123]
  ds_read_b128 a[60:63], v146 offset:768
  v_mfma_f32_16x16x32_bf16 v[92:95], a[36:39], a[52:55], v[92:95]
  ds_read_b128 a[8:11], v146 offset:1024
  v_mfma_f32_16x16x32_bf16 v[124:127], a[12:15], a[52:55], v[124:127]
  ds_read_b128 a[40:43], v146 offset:1280
  v_mfma_f32_16x16x32_bf16 v[96:99], a[36:39], a[56:59], v[96:99]
  ds_read_b128 a[16:19], v146 offset:1536
  v_mfma_f32_16x16x32_bf16 v[128:131], a[12:15], a[56:59], v[128:131]
  ds_read_b128 a[80:83], v146 offset:1792
  v_mfma_f32_16x16x32_bf16 v[100:103], a[36:39], a[88:91], v[100:103]
  v_mfma_f32_16x16x32_bf16 v[132:135], a[12:15], a[88:91], v[132:135]
  v_mfma_f32_16x16x32_bf16 v[104:107], a[36:39], a[64:67], v[104:107]
  v_mfma_f32_16x16x32_bf16 v[136:139], a[12:15], a[64:67], v[136:139]
  v_mfma_f32_16x16x32_bf16 v[108:111], a[36:39], a[68:71], v[108:111]
  v_mfma_f32_16x16x32_bf16 v[140:143], a[12:15], a[68:71], v[140:143]
  s_waitcnt lgkmcnt(0)
  s_nop 0
  v_mfma_f32_16x16x32_bf16 v[80:83], a[76:79], a[72:75], v[80:83]
  ds_read_b128 a[24:27], v146 offset:8192
  v_mfma_f32_16x16x32_bf16 v[112:115], a[20:23], a[72:75], v[112:115]
  ds_read_b128 a[28:31], v145 offset:4096
  v_mfma_f32_16x16x32_bf16 v[84:87], a[76:79], a[84:87], v[84:87]
  ds_read_b128 a[4:7], v145 offset:6144
  v_mfma_f32_16x16x32_bf16 v[116:119], a[20:23], a[84:87], v[116:119]
  ds_read_b128 a[92:95], v146 offset:8448
  v_mfma_f32_16x16x32_bf16 v[88:91], a[76:79], a[0:3], v[88:91]
  ds_read_b128 a[32:35], v146 offset:8704
  v_mfma_f32_16x16x32_bf16 v[120:123], a[20:23], a[0:3], v[120:123]
  ds_read_b128 a[44:47], v146 offset:8960
  v_mfma_f32_16x16x32_bf16 v[92:95], a[76:79], a[60:63], v[92:95]
  ds_read_b128 a[48:51], v146 offset:9216
  v_mfma_f32_16x16x32_bf16 v[124:127], a[20:23], a[60:63], v[124:127]
  ds_read_b128 a[52:55], v146 offset:9472
  v_mfma_f32_16x16x32_bf16 v[96:99], a[76:79], a[8:11], v[96:99]
  ds_read_b128 a[56:59], v146 offset:9728
  v_mfma_f32_16x16x32_bf16 v[128:131], a[20:23], a[8:11], v[128:131]
  ds_read_b128 a[88:91], v146 offset:9984
  v_mfma_f32_16x16x32_bf16 v[100:103], a[76:79], a[40:43], v[100:103]
  v_mfma_f32_16x16x32_bf16 v[132:135], a[20:23], a[40:43], v[132:135]
  v_mfma_f32_16x16x32_bf16 v[104:107], a[76:79], a[16:19], v[104:107]
  v_mfma_f32_16x16x32_bf16 v[136:139], a[20:23], a[16:19], v[136:139]
  v_mfma_f32_16x16x32_bf16 v[108:111], a[76:79], a[80:83], v[108:111]
  v_mfma_f32_16x16x32_bf16 v[140:143], a[20:23], a[80:83], v[140:143]
  s_waitcnt lgkmcnt(0)
  s_nop 0
  v_mfma_f32_16x16x32_bf16 v[80:83], a[28:31], a[24:27], v[80:83]
  v_mfma_f32_16x16x32_bf16 v[84:87], a[28:31], a[92:95], v[84:87]
  v_mfma_f32_16x16x32_bf16 v[88:91], a[28:31], a[32:35], v[88:91]
  v_mfma_f32_16x16x32_bf16 v[92:95], a[28:31], a[44:47], v[92:95]
  v_mfma_f32_16x16x32_bf16 v[96:99], a[28:31], a[48:51], v[96:99]
  v_mfma_f32_16x16x32_bf16 v[100:103], a[28:31], a[52:55], v[100:103]
  v_mfma_f32_16x16x32_bf16 v[104:107], a[28:31], a[56:59], v[104:107]
  v_mfma_f32_16x16x32_bf16 v[108:111], a[28:31], a[88:91], v[108:111]
  v_mfma_f32_16x16x32_bf16 v[112:115], a[4:7], a[24:27], v[112:115]
  v_mfma_f32_16x16x32_bf16 v[116:119], a[4:7], a[92:95], v[116:119]
  v_mfma_f32_16x16x32_bf16 v[120:123], a[4:7], a[32:35], v[120:123]
  v_mfma_f32_16x16x32_bf16 v[124:127], a[4:7], a[44:47], v[124:127]
  v_mfma_f32_16x16x32_bf16 v[128:131], a[4:7], a[48:51], v[128:131]
  v_mfma_f32_16x16x32_bf16 v[132:135], a[4:7], a[52:55], v[132:135]
  v_mfma_f32_16x16x32_bf16 v[136:139], a[4:7], a[56:59], v[136:139]
  v_mfma_f32_16x16x32_bf16 v[140:143], a[4:7], a[88:91], v[140:143]
L_fin:
  v_cvt_pk_bf16_f32 v156, v80, v84
  v_cvt_pk_bf16_f32 v157, v88, v92
  v_cvt_pk_bf16_f32 v158, v96, v100
  v_cvt_pk_bf16_f32 v159, v104, v108
  buffer_store_dwordx4 v[156:159], v147, s[32:35], s52 offen sc0 sc1
  v_cvt_pk_bf16_f32 v148, v81, v85
  v_cvt_pk_bf16_f32 v149, v89, v93
  v_cvt_pk_bf16_f32 v150, v97, v101
  v_cvt_pk_bf16_f32 v151, v105, v109
  buffer_store_dwordx4 v[148:151], v147, s[32:35], s53 offen sc0 sc1
  v_cvt_pk_bf16_f32 v152, v82, v86
  v_cvt_pk_bf16_f32 v153, v90, v94
  v_cvt_pk_bf16_f32 v154, v98, v102
  v_cvt_pk_bf16_f32 v155, v106, v110
  buffer_store_dwordx4 v[152:155], v147, s[32:35], s54 offen sc0 sc1
  v_cvt_pk_bf16_f32 v156, v83, v87
  v_cvt_pk_bf16_f32 v157, v91, v95
  v_cvt_pk_bf16_f32 v158, v99, v103
  v_cvt_pk_bf16_f32 v159, v107, v111
  buffer_store_dwordx4 v[156:159], v147, s[32:35], s55 offen sc0 sc1
  v_cvt_pk_bf16_f32 v148, v112, v116
  v_cvt_pk_bf16_f32 v149, v120, v124
  v_cvt_pk_bf16_f32 v150, v128, v132
  v_cvt_pk_bf16_f32 v151, v136, v140
  buffer_store_dwordx4 v[148:151], v147, s[32:35], s56 offen sc0 sc1
  v_cvt_pk_bf16_f32 v152, v113, v117
  v_cvt_pk_bf16_f32 v153, v121, v125
  v_cvt_pk_bf16_f32 v154, v129, v133
  v_cvt_pk_bf16_f32 v155, v137, v141
  buffer_store_dwordx4 v[152:155], v147, s[32:35], s57 offen sc0 sc1
  v_cvt_pk_bf16_f32 v156, v114, v118
  v_cvt_pk_bf16_f32 v157, v122, v126
  v_cvt_pk_bf16_f32 v158, v130, v134
  v_cvt_pk_bf16_f32 v159, v138, v142
  buffer_store_dwordx4 v[156:159], v147, s[32:35], s58 offen sc0 sc1
  v_cvt_pk_bf16_f32 v148, v115, v119
  v_cvt_pk_bf16_f32 v149, v123, v127
  v_cvt_pk_bf16_f32 v150, v131, v135
  v_cvt_pk_bf16_f32 v151, v139, v143
  buffer_store_dwordx4 v[148:151], v147, s[32:35], s59 offen sc0 sc1
  s_endpgm
L_loader:
  s_add_u32 s58, s40, 2
  s_lshl_b32 s58, s58, 7
  s_load_dword s68, s[12:13], s58 offset:0
  s_load_dword s69, s[12:13], s58 offset:64
  s_load_dword s70, s[12:13], s58 offset:2048
  s_load_dword s71, s[12:13], s58 offset:2112
  s_load_dword s72, s[12:13], s58 offset:4096
  s_load_dword s73, s[12:13], s58 offset:4160
  s_waitcnt vmcnt(0)
  s_mov_b64 exec, 1
  buffer_store_dwordx2 v[10:11], v14, s[28:31], 0 offen sc1
  s_mov_b64 exec, -1
  s_barrier
  s_add_u32 s43, s40, 0
  s_lshl_b32 s43, s43, 9
  s_load_dwordx4 s[64:67], s[4:5], s43 glc
  s_add_u32 s41, s40, 0
  s_lshl_b32 s41, s41, 7
  s_add_u32 m0, s60, 49152
  s_nop 0
  buffer_load_dwordx4 v16, s[16:19], s41 offen offset:0 lds
  buffer_load_dwordx4 v17, s[16:19], s41 offen offset:1024 lds
  buffer_load_dwordx4 v18, s[16:19], s41 offen offset:2048 lds
  buffer_load_dwordx4 v19, s[16:19], s41 offen offset:3072 lds
  s_add_u32 m0, s60, 53248
  s_add_u32 s41, s41, 65536
  buffer_load_dwordx4 v16, s[16:19], s41 offen offset:0 lds
  buffer_load_dwordx4 v17, s[16:19], s41 offen offset:1024 lds
  buffer_load_dwordx4 v18, s[16:19], s41 offen offset:2048 lds
  buffer_load_dwordx4 v19, s[16:19], s41 offen offset:3072 lds
  s_mov_b32 s63, 0
L_sp1:
  s_waitcnt lgkmcnt(0)
  s_xor_b64 s[10:11], s[64:65], s[8:9]
  s_xor_b64 s[14:15], s[66:67], s[8:9]
  s_or_b64 s[10:11], s[10:11], s[14:15]
  s_cbranch_scc0 L_ok1
  s_load_dwordx4 s[64:67], s[4:5], s43 glc
  s_add_u32 s63, s63, 1
  s_cmp_lt_u32 s63, 20000
  s_cbranch_scc1 L_sp1
  s_waitcnt lgkmcnt(0)
L_ok1:
  s_add_u32 s43, s40, 1
  s_lshl_b32 s43, s43, 9
  s_load_dwordx4 s[64:67], s[4:5], s43 glc
  s_add_u32 m0, s61, 49152
  s_add_u32 s62, s40, 0
  s_lshl_b32 s62, s62, 14
  buffer_load_dwordx4 v20, s[28:31], s62 offen offset:0 sc1 lds
  buffer_load_dwordx4 v20, s[28:31], s62 offen offset:1024 sc1 lds
  buffer_load_dwordx4 v20, s[28:31], s62 offen offset:2048 sc1 lds
  buffer_load_dwordx4 v20, s[28:31], s62 offen offset:3072 sc1 lds
  s_add_u32 s41, s40, 1
  s_lshl_b32 s41, s41, 7
  s_add_u32 m0, s60, 98304
  s_nop 0
  buffer_load_dwordx4 v16, s[16:19], s41 offen offset:0 lds
  buffer_load_dwordx4 v17, s[16:19], s41 offen offset:1024 lds
  buffer_load_dwordx4 v18, s[16:19], s41 offen offset:2048 lds
  buffer_load_dwordx4 v19, s[16:19], s41 offen offset:3072 lds
  s_add_u32 m0, s60, 102400
  s_add_u32 s41, s41, 65536
  buffer_load_dwordx4 v16, s[16:19], s41 offen offset:0 lds
  buffer_load_dwordx4 v17, s[16:19], s41 offen offset:1024 lds
  buffer_load_dwordx4 v18, s[16:19], s41 offen offset:2048 lds
  buffer_load_dwordx4 v19, s[16:19], s41 offen offset:3072 lds
  s_mov_b32 s63, 0
L_sp2:
  s_waitcnt lgkmcnt(0)
  s_xor_b64 s[10:11], s[64:65], s[8:9]
  s_xor_b64 s[14:15], s[66:67], s[8:9]
  s_or_b64 s[10:11], s[10:11], s[14:15]
  s_cbranch_scc0 L_ok2
  s_load_dwordx4 s[64:67], s[4:5], s43 glc
  s_add_u32 s63, s63, 1
  s_cmp_lt_u32 s63, 20000
  s_cbranch_scc1 L_sp2
  s_waitcnt lgkmcnt(0)
L_ok2:
  s_add_u32 s43, s40, 2
  s_lshl_b32 s43, s43, 9
  s_load_dwordx4 s[64:67], s[4:5], s43 glc
  s_add_u32 m0, s61, 98304
  s_add_u32 s62, s40, 1
  s_lshl_b32 s62, s62, 14
  buffer_load_dwordx4 v20, s[28:31], s62 offen offset:0 sc1 lds
  buffer_load_dwordx4 v20, s[28:31], s62 offen offset:1024 sc1 lds
  buffer_load_dwordx4 v20, s[28:31], s62 offen offset:2048 sc1 lds
  buffer_load_dwordx4 v20, s[28:31], s62 offen offset:3072 sc1 lds
  s_add_u32 s58, s40, 3
  s_lshl_b32 s58, s58, 7
  s_load_dword s68, s[12:13], s58 offset:0
  s_load_dword s69, s[12:13], s58 offset:64
  s_load_dword s70, s[12:13], s58 offset:2048
  s_load_dword s71, s[12:13], s58 offset:2112
  s_load_dword s72, s[12:13], s58 offset:4096
  s_load_dword s73, s[12:13], s58 offset:4160
  s_waitcnt vmcnt(12)
  s_barrier
  s_add_u32 s41, s40, 2
  s_lshl_b32 s41, s41, 7
  s_add_u32 m0, s60, 0
  s_nop 0
  buffer_load_dwordx4 v16, s[16:19], s41 offen offset:0 lds
  buffer_load_dwordx4 v17, s[16:19], s41 offen offset:1024 lds
  buffer_load_dwordx4 v18, s[16:19], s41 offen offset:2048 lds
  buffer_load_dwordx4 v19, s[16:19], s41 offen offset:3072 lds
  s_add_u32 m0, s60, 4096
  s_add_u32 s41, s41, 65536
  buffer_load_dwordx4 v16, s[16:19], s41 offen offset:0 lds
  buffer_load_dwordx4 v17, s[16:19], s41 offen offset:1024 lds
  buffer_load_dwordx4 v18, s[16:19], s41 offen offset:2048 lds
  buffer_load_dwordx4 v19, s[16:19], s41 offen offset:3072 lds
  s_mov_b32 s63, 0
L_sp3:
  s_waitcnt lgkmcnt(0)
  s_xor_b64 s[10:11], s[64:65], s[8:9]
  s_xor_b64 s[14:15], s[66:67], s[8:9]
  s_or_b64 s[10:11], s[10:11], s[14:15]
  s_cbranch_scc0 L_ok3
  s_load_dwordx4 s[64:67], s[4:5], s43 glc
  s_add_u32 s63, s63, 1
  s_cmp_lt_u32 s63, 20000
  s_cbranch_scc1 L_sp3
  s_waitcnt lgkmcnt(0)
L_ok3:
  s_add_u32 s43, s40, 3
  s_lshl_b32 s43, s43, 9
  s_load_dwordx4 s[64:67], s[4:5], s43 glc
  s_add_u32 m0, s61, 0
  s_add_u32 s62, s40, 2
  s_lshl_b32 s62, s62, 14
  buffer_load_dwordx4 v20, s[28:31], s62 offen offset:0 sc1 lds
  buffer_load_dwordx4 v20, s[28:31], s62 offen offset:1024 sc1 lds
  buffer_load_dwordx4 v20, s[28:31], s62 offen offset:2048 sc1 lds
  buffer_load_dwordx4 v20, s[28:31], s62 offen offset:3072 sc1 lds
  s_xor_b32 s58, s40, 4
  s_cmp_ge_u32 s58, s36
  s_addc_u32 s58, s58, 0
  s_lshl_b32 s58, s58, 7
  s_load_dword s68, s[12:13], s58 offset:0
  s_load_dword s69, s[12:13], s58 offset:64
  s_load_dword s70, s[12:13], s58 offset:2048
  s_load_dword s71, s[12:13], s58 offset:2112
  s_load_dword s72, s[12:13], s58 offset:4096
  s_load_dword s73, s[12:13], s58 offset:4160
  s_waitcnt vmcnt(12)
  s_barrier
  s_add_u32 s41, s40, 3
  s_lshl_b32 s41, s41, 7
  s_add_u32 m0, s60, 49152
  s_nop 0
  buffer_load_dwordx4 v16, s[16:19], s41 offen offset:0 lds
  buffer_load_dwordx4 v17, s[16:19], s41 offen offset:1024 lds
  buffer_load_dwordx4 v18, s[16:19], s41 offen offset:2048 lds
  buffer_load_dwordx4 v19, s[16:19], s41 offen offset:3072 lds
  s_add_u32 m0, s60, 53248
  s_add_u32 s41, s41, 65536
  buffer_load_dwordx4 v16, s[16:19], s41 offen offset:0 lds
  buffer_load_dwordx4 v17, s[16:19], s41 offen offset:1024 lds
  buffer_load_dwordx4 v18, s[16:19], s41 offen offset:2048 lds
  buffer_load_dwordx4 v19, s[16:19], s41 offen offset:3072 lds
  s_mov_b32 s63, 0
L_sp4:
  s_waitcnt lgkmcnt(0)
  s_xor_b64 s[10:11], s[64:65], s[8:9]
  s_xor_b64 s[14:15], s[66:67], s[8:9]
  s_or_b64 s[10:11], s[10:11], s[14:15]
  s_cbranch_scc0 L_ok4
  s_load_dwordx4 s[64:67], s[4:5], s43 glc
  s_add_u32 s63, s63, 1
  s_cmp_lt_u32 s63, 20000
  s_cbranch_scc1 L_sp4
  s_waitcnt lgkmcnt(0)
L_ok4:
  s_xor_b32 s43, s40, 4
  s_cmp_ge_u32 s43, s36
  s_addc_u32 s43, s43, 0
  s_lshl_b32 s43, s43, 9
  s_load_dwordx4 s[64:67], s[4:5], s43 glc
  s_add_u32 m0, s61, 49152
  s_add_u32 s62, s40, 3
  s_lshl_b32 s62, s62, 14
  buffer_load_dwordx4 v20, s[28:31], s62 offen offset:0 sc1 lds
  buffer_load_dwordx4 v20, s[28:31], s62 offen offset:1024 sc1 lds
  buffer_load_dwordx4 v20, s[28:31], s62 offen offset:2048 sc1 lds
  buffer_load_dwordx4 v20, s[28:31], s62 offen offset:3072 sc1 lds
  s_xor_b32 s58, s40, 5
  s_cmp_ge_u32 s58, s36
  s_addc_u32 s58, s58, 0
  s_lshl_b32 s58, s58, 7
  s_load_dword s68, s[12:13], s58 offset:0
  s_load_dword s69, s[12:13], s58 offset:64
  s_load_dword s70, s[12:13], s58 offset:2048
  s_load_dword s71, s[12:13], s58 offset:2112
  s_load_dword s72, s[12:13], s58 offset:4096
  s_load_dword s73, s[12:13], s58 offset:4160
  s_waitcnt vmcnt(12)
  s_barrier
  s_xor_b32 s41, s40, 4
  s_cmp_ge_u32 s41, s36
  s_addc_u32 s41, s41, 0
  s_lshl_b32 s41, s41, 7
  s_add_u32 m0, s60, 98304
  s_nop 0
  buffer_load_dwordx4 v16, s[16:19], s41 offen offset:0 lds
  buffer_load_dwordx4 v17, s[16:19], s41 offen offset:1024 lds
  buffer_load_dwordx4 v18, s[16:19], s41 offen offset:2048 lds
  buffer_load_dwordx4 v19, s[16:19], s41 offen offset:3072 lds
  s_add_u32 m0, s60, 102400
  s_add_u32 s41, s41, 65536
  buffer_load_dwordx4 v16, s[16:19], s41 offen offset:0 lds
  buffer_load_dwordx4 v17, s[16:19], s41 offen offset:1024 lds
  buffer_load_dwordx4 v18, s[16:19], s41 offen offset:2048 lds
  buffer_load_dwordx4 v19, s[16:19], s41 offen offset:3072 lds
  s_mov_b32 s63, 0
L_sp5:
  s_waitcnt lgkmcnt(0)
  s_xor_b64 s[10:11], s[64:65], s[8:9]
  s_xor_b64 s[14:15], s[66:67], s[8:9]
  s_or_b64 s[10:11], s[10:11], s[14:15]
  s_cbranch_scc0 L_ok5
  s_load_dwordx4 s[64:67], s[4:5], s43 glc
  s_add_u32 s63, s63, 1
  s_cmp_lt_u32 s63, 20000
  s_cbranch_scc1 L_sp5
  s_waitcnt lgkmcnt(0)
L_ok5:
  s_xor_b32 s43, s40, 5
  s_cmp_ge_u32 s43, s36
  s_addc_u32 s43, s43, 0
  s_lshl_b32 s43, s43, 9
  s_load_dwordx4 s[64:67], s[4:5], s43 glc
  s_add_u32 m0, s61, 98304
  s_xor_b32 s62, s40, 4
  s_cmp_ge_u32 s62, s36
  s_addc_u32 s62, s62, 0
  s_lshl_b32 s62, s62, 14
  buffer_load_dwordx4 v20, s[28:31], s62 offen offset:0 sc1 lds
  buffer_load_dwordx4 v20, s[28:31], s62 offen offset:1024 sc1 lds
  buffer_load_dwordx4 v20, s[28:31], s62 offen offset:2048 sc1 lds
  buffer_load_dwordx4 v20, s[28:31], s62 offen offset:3072 sc1 lds
  s_xor_b32 s58, s40, 6
  s_cmp_ge_u32 s58, s36
  s_addc_u32 s58, s58, 0
  s_lshl_b32 s58, s58, 7
  s_load_dword s68, s[12:13], s58 offset:0
  s_load_dword s69, s[12:13], s58 offset:64
  s_load_dword s70, s[12:13], s58 offset:2048
  s_load_dword s71, s[12:13], s58 offset:2112
  s_load_dword s72, s[12:13], s58 offset:4096
  s_load_dword s73, s[12:13], s58 offset:4160
  s_waitcnt vmcnt(12)
  s_barrier
  s_xor_b32 s41, s40, 5
  s_cmp_ge_u32 s41, s36
  s_addc_u32 s41, s41, 0
  s_lshl_b32 s41, s41, 7
  s_add_u32 m0, s60, 0
  s_nop 0
  buffer_load_dwordx4 v16, s[16:19], s41 offen offset:0 lds
  buffer_load_dwordx4 v17, s[16:19], s41 offen offset:1024 lds
  buffer_load_dwordx4 v18, s[16:19], s41 offen offset:2048 lds
  buffer_load_dwordx4 v19, s[16:19], s41 offen offset:3072 lds
  s_add_u32 m0, s60, 4096
  s_add_u32 s41, s41, 65536
  buffer_load_dwordx4 v16, s[16:19], s41 offen offset:0 lds
  buffer_load_dwordx4 v17, s[16:19], s41 offen offset:1024 lds
  buffer_load_dwordx4 v18, s[16:19], s41 offen offset:2048 lds
  buffer_load_dwordx4 v19, s[16:19], s41 offen offset:3072 lds
  s_mov_b32 s63, 0
L_sp6:
  s_waitcnt lgkmcnt(0)
  s_xor_b64 s[10:11], s[64:65], s[8:9]
  s_xor_b64 s[14:15], s[66:67], s[8:9]
  s_or_b64 s[10:11], s[10:11], s[14:15]
  s_cbranch_scc0 L_ok6
  s_load_dwordx4 s[64:67], s[4:5], s43 glc
  s_add_u32 s63, s63, 1
  s_cmp_lt_u32 s63, 20000
  s_cbranch_scc1 L_sp6
  s_waitcnt lgkmcnt(0)
L_ok6:
  s_xor_b32 s43, s40, 6
  s_cmp_ge_u32 s43, s36
  s_addc_u32 s43, s43, 0
  s_lshl_b32 s43, s43, 9
  s_load_dwordx4 s[64:67], s[4:5], s43 glc
  s_add_u32 m0, s61, 0
  s_xor_b32 s62, s40, 5
  s_cmp_ge_u32 s62, s36
  s_addc_u32 s62, s62, 0
  s_lshl_b32 s62, s62, 14
  buffer_load_dwordx4 v20, s[28:31], s62 offen offset:0 sc1 lds
  buffer_load_dwordx4 v20, s[28:31], s62 offen offset:1024 sc1 lds
  buffer_load_dwordx4 v20, s[28:31], s62 offen offset:2048 sc1 lds
  buffer_load_dwordx4 v20, s[28:31], s62 offen offset:3072 sc1 lds
  s_mov_b32 s58, 1024
  s_load_dword s68, s[12:13], s58 offset:0
  s_load_dword s69, s[12:13], s58 offset:64
  s_load_dword s70, s[12:13], s58 offset:2048
  s_load_dword s71, s[12:13], s58 offset:2112
  s_load_dword s72, s[12:13], s58 offset:4096
  s_load_dword s73, s[12:13], s58 offset:4160
  s_waitcnt vmcnt(12)
  s_barrier
  s_xor_b32 s41, s40, 6
  s_cmp_ge_u32 s41, s36
  s_addc_u32 s41, s41, 0
  s_lshl_b32 s41, s41, 7
  s_add_u32 m0, s60, 49152
  s_nop 0
  buffer_load_dwordx4 v16, s[16:19], s41 offen offset:0 lds
  buffer_load_dwordx4 v17, s[16:19], s41 offen offset:1024 lds
  buffer_load_dwordx4 v18, s[16:19], s41 offen offset:2048 lds
  buffer_load_dwordx4 v19, s[16:19], s41 offen offset:3072 lds
  s_add_u32 m0, s60, 53248
  s_add_u32 s41, s41, 65536
  buffer_load_dwordx4 v16, s[16:19], s41 offen offset:0 lds
  buffer_load_dwordx4 v17, s[16:19], s41 offen offset:1024 lds
  buffer_load_dwordx4 v18, s[16:19], s41 offen offset:2048 lds
  buffer_load_dwordx4 v19, s[16:19], s41 offen offset:3072 lds
  s_mov_b32 s63, 0
L_sp7:
  s_waitcnt lgkmcnt(0)
  s_xor_b64 s[10:11], s[64:65], s[8:9]
  s_xor_b64 s[14:15], s[66:67], s[8:9]
  s_or_b64 s[10:11], s[10:11], s[14:15]
  s_cbranch_scc0 L_ok7
  s_load_dwordx4 s[64:67], s[4:5], s43 glc
  s_add_u32 s63, s63, 1
  s_cmp_lt_u32 s63, 20000
  s_cbranch_scc1 L_sp7
  s_waitcnt lgkmcnt(0)
L_ok7:
  s_mov_b32 s43, 4096
  s_load_dwordx4 s[64:67], s[4:5], s43 glc
  s_add_u32 m0, s61, 49152
  s_xor_b32 s62, s40, 6
  s_cmp_ge_u32 s62, s36
  s_addc_u32 s62, s62, 0
  s_lshl_b32 s62, s62, 14
  buffer_load_dwordx4 v20, s[28:31], s62 offen offset:0 sc1 lds
  buffer_load_dwordx4 v20, s[28:31], s62 offen offset:1024 sc1 lds
  buffer_load_dwordx4 v20, s[28:31], s62 offen offset:2048 sc1 lds
  buffer_load_dwordx4 v20, s[28:31], s62 offen offset:3072 sc1 lds
  s_mov_b32 s58, 1152
  s_load_dword s68, s[12:13], s58 offset:0
  s_load_dword s69, s[12:13], s58 offset:64
  s_load_dword s70, s[12:13], s58 offset:2048
  s_load_dword s71, s[12:13], s58 offset:2112
  s_load_dword s72, s[12:13], s58 offset:4096
  s_load_dword s73, s[12:13], s58 offset:4160
  s_waitcnt vmcnt(12)
  s_barrier
  s_mov_b32 s41, 1024
  s_add_u32 m0, s60, 98304
  s_nop 0
  buffer_load_dwordx4 v16, s[16:19], s41 offen offset:0 lds
  buffer_load_dwordx4 v17, s[16:19], s41 offen offset:1024 lds
  buffer_load_dwordx4 v18, s[16:19], s41 offen offset:2048 lds
  buffer_load_dwordx4 v19, s[16:19], s41 offen offset:3072 lds
  s_add_u32 m0, s60, 102400
  s_add_u32 s41, s41, 65536
  buffer_load_dwordx4 v16, s[16:19], s41 offen offset:0 lds
  buffer_load_dwordx4 v17, s[16:19], s41 offen offset:1024 lds
  buffer_load_dwordx4 v18, s[16:19], s41 offen offset:2048 lds
  buffer_load_dwordx4 v19, s[16:19], s41 offen offset:3072 lds
  s_mov_b32 s63, 0
L_sp8:
  s_waitcnt lgkmcnt(0)
  s_xor_b64 s[10:11], s[64:65], s[8:9]
  s_xor_b64 s[14:15], s[66:67], s[8:9]
  s_or_b64 s[10:11], s[10:11], s[14:15]
  s_cbranch_scc0 L_ok8
  s_load_dwordx4 s[64:67], s[4:5], s43 glc
  s_add_u32 s63, s63, 1
  s_cmp_lt_u32 s63, 20000
  s_cbranch_scc1 L_sp8
  s_waitcnt lgkmcnt(0)
L_ok8:
  s_mov_b32 s43, 4608
  s_load_dwordx4 s[64:67], s[4:5], s43 glc
  s_add_u32 m0, s61, 98304
  s_mov_b32 s62, 131072
  buffer_load_dwordx4 v20, s[28:31], s62 offen offset:0 sc1 lds
  buffer_load_dwordx4 v20, s[28:31], s62 offen offset:1024 sc1 lds
  buffer_load_dwordx4 v20, s[28:31], s62 offen offset:2048 sc1 lds
  buffer_load_dwordx4 v20, s[28:31], s62 offen offset:3072 sc1 lds
  s_mov_b32 s58, 1280
  s_load_dword s68, s[12:13], s58 offset:0
  s_load_dword s69, s[12:13], s58 offset:64
  s_load_dword s70, s[12:13], s58 offset:2048
  s_load_dword s71, s[12:13], s58 offset:2112
  s_load_dword s72, s[12:13], s58 offset:4096
  s_load_dword s73, s[12:13], s58 offset:4160
  s_waitcnt vmcnt(12)
  s_barrier
  s_mov_b32 s41, 1152
  s_add_u32 m0, s60, 0
  s_nop 0
  buffer_load_dwordx4 v16, s[16:19], s41 offen offset:0 lds
  buffer_load_dwordx4 v17, s[16:19], s41 offen offset:1024 lds
  buffer_load_dwordx4 v18, s[16:19], s41 offen offset:2048 lds
  buffer_load_dwordx4 v19, s[16:19], s41 offen offset:3072 lds
  s_add_u32 m0, s60, 4096
  s_add_u32 s41, s41, 65536
  buffer_load_dwordx4 v16, s[16:19], s41 offen offset:0 lds
  buffer_load_dwordx4 v17, s[16:19], s41 offen offset:1024 lds
  buffer_load_dwordx4 v18, s[16:19], s41 offen offset:2048 lds
  buffer_load_dwordx4 v19, s[16:19], s41 offen offset:3072 lds
  s_mov_b32 s63, 0
L_sp9:
  s_waitcnt lgkmcnt(0)
  s_xor_b64 s[10:11], s[64:65], s[8:9]
  s_xor_b64 s[14:15], s[66:67], s[8:9]
  s_or_b64 s[10:11], s[10:11], s[14:15]
  s_cbranch_scc0 L_ok9
  s_load_dwordx4 s[64:67], s[4:5], s43 glc
  s_add_u32 s63, s63, 1
  s_cmp_lt_u32 s63, 20000
  s_cbranch_scc1 L_sp9
  s_waitcnt lgkmcnt(0)
L_ok9:
  s_mov_b32 s43, 5120
  s_load_dwordx4 s[64:67], s[4:5], s43 glc
  s_add_u32 m0, s61, 0
  s_mov_b32 s62, 147456
  buffer_load_dwordx4 v20, s[28:31], s62 offen offset:0 sc1 lds
  buffer_load_dwordx4 v20, s[28:31], s62 offen offset:1024 sc1 lds
  buffer_load_dwordx4 v20, s[28:31], s62 offen offset:2048 sc1 lds
  buffer_load_dwordx4 v20, s[28:31], s62 offen offset:3072 sc1 lds
  s_mov_b32 s58, 1408
  s_load_dword s68, s[12:13], s58 offset:0
  s_load_dword s69, s[12:13], s58 offset:64
  s_load_dword s70, s[12:13], s58 offset:2048
  s_load_dword s71, s[12:13], s58 offset:2112
  s_load_dword s72, s[12:13], s58 offset:4096
  s_load_dword s73, s[12:13], s58 offset:4160
  s_waitcnt vmcnt(12)
  s_barrier
  s_mov_b32 s41, 1280
  s_add_u32 m0, s60, 49152
  s_nop 0
  buffer_load_dwordx4 v16, s[16:19], s41 offen offset:0 lds
  buffer_load_dwordx4 v17, s[16:19], s41 offen offset:1024 lds
  buffer_load_dwordx4 v18, s[16:19], s41 offen offset:2048 lds
  buffer_load_dwordx4 v19, s[16:19], s41 offen offset:3072 lds
  s_add_u32 m0, s60, 53248
  s_add_u32 s41, s41, 65536
  buffer_load_dwordx4 v16, s[16:19], s41 offen offset:0 lds
  buffer_load_dwordx4 v17, s[16:19], s41 offen offset:1024 lds
  buffer_load_dwordx4 v18, s[16:19], s41 offen offset:2048 lds
  buffer_load_dwordx4 v19, s[16:19], s41 offen offset:3072 lds
  s_mov_b32 s63, 0
L_sp10:
  s_waitcnt lgkmcnt(0)
  s_xor_b64 s[10:11], s[64:65], s[8:9]
  s_xor_b64 s[14:15], s[66:67], s[8:9]
  s_or_b64 s[10:11], s[10:11], s[14:15]
  s_cbranch_scc0 L_ok10
  s_load_dwordx4 s[64:67], s[4:5], s43 glc
  s_add_u32 s63, s63, 1
  s_cmp_lt_u32 s63, 20000
  s_cbranch_scc1 L_sp10
  s_waitcnt lgkmcnt(0)
L_ok10:
  s_mov_b32 s43, 5632
  s_load_dwordx4 s[64:67], s[4:5], s43 glc
  s_add_u32 m0, s61, 49152
  s_mov_b32 s62, 163840
  buffer_load_dwordx4 v20, s[28:31], s62 offen offset:0 sc1 lds
  buffer_load_dwordx4 v20, s[28:31], s62 offen offset:1024 sc1 lds
  buffer_load_dwordx4 v20, s[28:31], s62 offen offset:2048 sc1 lds
  buffer_load_dwordx4 v20, s[28:31], s62 offen offset:3072 sc1 lds
  s_mov_b32 s58, 1536
  s_load_dword s68, s[12:13], s58 offset:0
  s_load_dword s69, s[12:13], s58 offset:64
  s_load_dword s70, s[12:13], s58 offset:2048
  s_load_dword s71, s[12:13], s58 offset:2112
  s_load_dword s72, s[12:13], s58 offset:4096
  s_load_dword s73, s[12:13], s58 offset:4160
  s_waitcnt vmcnt(12)
  s_barrier
  s_mov_b32 s41, 1408
  s_add_u32 m0, s60, 98304
  s_nop 0
  buffer_load_dwordx4 v16, s[16:19], s41 offen offset:0 lds
  buffer_load_dwordx4 v17, s[16:19], s41 offen offset:1024 lds
  buffer_load_dwordx4 v18, s[16:19], s41 offen offset:2048 lds
  buffer_load_dwordx4 v19, s[16:19], s41 offen offset:3072 lds
  s_add_u32 m0, s60, 102400
  s_add_u32 s41, s41, 65536
  buffer_load_dwordx4 v16, s[16:19], s41 offen offset:0 lds
  buffer_load_dwordx4 v17, s[16:19], s41 offen offset:1024 lds
  buffer_load_dwordx4 v18, s[16:19], s41 offen offset:2048 lds
  buffer_load_dwordx4 v19, s[16:19], s41 offen offset:3072 lds
  s_mov_b32 s63, 0
L_sp11:
  s_waitcnt lgkmcnt(0)
  s_xor_b64 s[10:11], s[64:65], s[8:9]
  s_xor_b64 s[14:15], s[66:67], s[8:9]
  s_or_b64 s[10:11], s[10:11], s[14:15]
  s_cbranch_scc0 L_ok11
  s_load_dwordx4 s[64:67], s[4:5], s43 glc
  s_add_u32 s63, s63, 1
  s_cmp_lt_u32 s63, 20000
  s_cbranch_scc1 L_sp11
  s_waitcnt lgkmcnt(0)
L_ok11:
  s_mov_b32 s43, 6144
  s_load_dwordx4 s[64:67], s[4:5], s43 glc
  s_add_u32 m0, s61, 98304
  s_mov_b32 s62, 180224
  buffer_load_dwordx4 v20, s[28:31], s62 offen offset:0 sc1 lds
  buffer_load_dwordx4 v20, s[28:31], s62 offen offset:1024 sc1 lds
  buffer_load_dwordx4 v20, s[28:31], s62 offen offset:2048 sc1 lds
  buffer_load_dwordx4 v20, s[28:31], s62 offen offset:3072 sc1 lds
  s_mov_b32 s58, 1664
  s_load_dword s68, s[12:13], s58 offset:0
  s_load_dword s69, s[12:13], s58 offset:64
  s_load_dword s70, s[12:13], s58 offset:2048
  s_load_dword s71, s[12:13], s58 offset:2112
  s_load_dword s72, s[12:13], s58 offset:4096
  s_load_dword s73, s[12:13], s58 offset:4160
  s_waitcnt vmcnt(12)
  s_barrier
  s_mov_b32 s41, 1536
  s_add_u32 m0, s60, 0
  s_nop 0
  buffer_load_dwordx4 v16, s[16:19], s41 offen offset:0 lds
  buffer_load_dwordx4 v17, s[16:19], s41 offen offset:1024 lds
  buffer_load_dwordx4 v18, s[16:19], s41 offen offset:2048 lds
  buffer_load_dwordx4 v19, s[16:19], s41 offen offset:3072 lds
  s_add_u32 m0, s60, 4096
  s_add_u32 s41, s41, 65536
  buffer_load_dwordx4 v16, s[16:19], s41 offen offset:0 lds
  buffer_load_dwordx4 v17, s[16:19], s41 offen offset:1024 lds
  buffer_load_dwordx4 v18, s[16:19], s41 offen offset:2048 lds
  buffer_load_dwordx4 v19, s[16:19], s41 offen offset:3072 lds
  s_mov_b32 s63, 0
L_sp12:
  s_waitcnt lgkmcnt(0)
  s_xor_b64 s[10:11], s[64:65], s[8:9]
  s_xor_b64 s[14:15], s[66:67], s[8:9]
  s_or_b64 s[10:11], s[10:11], s[14:15]
  s_cbranch_scc0 L_ok12
  s_load_dwordx4 s[64:67], s[4:5], s43 glc
  s_add_u32 s63, s63, 1
  s_cmp_lt_u32 s63, 20000
  s_cbranch_scc1 L_sp12
  s_waitcnt lgkmcnt(0)
L_ok12:
  s_mov_b32 s43, 6656
  s_load_dwordx4 s[64:67], s[4:5], s43 glc
  s_add_u32 m0, s61, 0
  s_mov_b32 s62, 196608
  buffer_load_dwordx4 v20, s[28:31], s62 offen offset:0 sc1 lds
  buffer_load_dwordx4 v20, s[28:31], s62 offen offset:1024 sc1 lds
  buffer_load_dwordx4 v20, s[28:31], s62 offen offset:2048 sc1 lds
  buffer_load_dwordx4 v20, s[28:31], s62 offen offset:3072 sc1 lds
  s_mov_b32 s58, 1792
  s_load_dword s68, s[12:13], s58 offset:0
  s_load_dword s69, s[12:13], s58 offset:64
  s_load_dword s70, s[12:13], s58 offset:2048
  s_load_dword s71, s[12:13], s58 offset:2112
  s_load_dword s72, s[12:13], s58 offset:4096
  s_load_dword s73, s[12:13], s58 offset:4160
  s_waitcnt vmcnt(12)
  s_barrier
  s_mov_b32 s41, 1664
  s_add_u32 m0, s60, 49152
  s_nop 0
  buffer_load_dwordx4 v16, s[16:19], s41 offen offset:0 lds
  buffer_load_dwordx4 v17, s[16:19], s41 offen offset:1024 lds
  buffer_load_dwordx4 v18, s[16:19], s41 offen offset:2048 lds
  buffer_load_dwordx4 v19, s[16:19], s41 offen offset:3072 lds
  s_add_u32 m0, s60, 53248
  s_add_u32 s41, s41, 65536
  buffer_load_dwordx4 v16, s[16:19], s41 offen offset:0 lds
  buffer_load_dwordx4 v17, s[16:19], s41 offen offset:1024 lds
  buffer_load_dwordx4 v18, s[16:19], s41 offen offset:2048 lds
  buffer_load_dwordx4 v19, s[16:19], s41 offen offset:3072 lds
  s_mov_b32 s63, 0
L_sp13:
  s_waitcnt lgkmcnt(0)
  s_xor_b64 s[10:11], s[64:65], s[8:9]
  s_xor_b64 s[14:15], s[66:67], s[8:9]
  s_or_b64 s[10:11], s[10:11], s[14:15]
  s_cbranch_scc0 L_ok13
  s_load_dwordx4 s[64:67], s[4:5], s43 glc
  s_add_u32 s63, s63, 1
  s_cmp_lt_u32 s63, 20000
  s_cbranch_scc1 L_sp13
  s_waitcnt lgkmcnt(0)
L_ok13:
  s_mov_b32 s43, 7168
  s_load_dwordx4 s[64:67], s[4:5], s43 glc
  s_add_u32 m0, s61, 49152
  s_mov_b32 s62, 212992
  buffer_load_dwordx4 v20, s[28:31], s62 offen offset:0 sc1 lds
  buffer_load_dwordx4 v20, s[28:31], s62 offen offset:1024 sc1 lds
  buffer_load_dwordx4 v20, s[28:31], s62 offen offset:2048 sc1 lds
  buffer_load_dwordx4 v20, s[28:31], s62 offen offset:3072 sc1 lds
  s_mov_b32 s58, 1920
  s_load_dword s68, s[12:13], s58 offset:0
  s_load_dword s69, s[12:13], s58 offset:64
  s_load_dword s70, s[12:13], s58 offset:2048
  s_load_dword s71, s[12:13], s58 offset:2112
  s_load_dword s72, s[12:13], s58 offset:4096
  s_load_dword s73, s[12:13], s58 offset:4160
  s_waitcnt vmcnt(12)
  s_barrier
  s_mov_b32 s41, 1792
  s_add_u32 m0, s60, 98304
  s_nop 0
  buffer_load_dwordx4 v16, s[16:19], s41 offen offset:0 lds
  buffer_load_dwordx4 v17, s[16:19], s41 offen offset:1024 lds
  buffer_load_dwordx4 v18, s[16:19], s41 offen offset:2048 lds
  buffer_load_dwordx4 v19, s[16:19], s41 offen offset:3072 lds
  s_add_u32 m0, s60, 102400
  s_add_u32 s41, s41, 65536
  buffer_load_dwordx4 v16, s[16:19], s41 offen offset:0 lds
  buffer_load_dwordx4 v17, s[16:19], s41 offen offset:1024 lds
  buffer_load_dwordx4 v18, s[16:19], s41 offen offset:2048 lds
  buffer_load_dwordx4 v19, s[16:19], s41 offen offset:3072 lds
  s_mov_b32 s63, 0
L_sp14:
  s_waitcnt lgkmcnt(0)
  s_xor_b64 s[10:11], s[64:65], s[8:9]
  s_xor_b64 s[14:15], s[66:67], s[8:9]
  s_or_b64 s[10:11], s[10:11], s[14:15]
  s_cbranch_scc0 L_ok14
  s_load_dwordx4 s[64:67], s[4:5], s43 glc
  s_add_u32 s63, s63, 1
  s_cmp_lt_u32 s63, 20000
  s_cbranch_scc1 L_sp14
  s_waitcnt lgkmcnt(0)
L_ok14:
  s_mov_b32 s43, 7680
  s_load_dwordx4 s[64:67], s[4:5], s43 glc
  s_add_u32 m0, s61, 98304
  s_mov_b32 s62, 229376
  buffer_load_dwordx4 v20, s[28:31], s62 offen offset:0 sc1 lds
  buffer_load_dwordx4 v20, s[28:31], s62 offen offset:1024 sc1 lds
  buffer_load_dwordx4 v20, s[28:31], s62 offen offset:2048 sc1 lds
  buffer_load_dwordx4 v20, s[28:31], s62 offen offset:3072 sc1 lds
  s_waitcnt vmcnt(12)
  s_barrier
  s_mov_b32 s63, 0
L_sp15:
  s_waitcnt lgkmcnt(0)
  s_xor_b64 s[10:11], s[64:65], s[8:9]
  s_xor_b64 s[14:15], s[66:67], s[8:9]
  s_or_b64 s[10:11], s[10:11], s[14:15]
  s_cbranch_scc0 L_ok15
  s_load_dwordx4 s[64:67], s[4:5], s43 glc
  s_add_u32 s63, s63, 1
  s_cmp_lt_u32 s63, 20000
  s_cbranch_scc1 L_sp15
  s_waitcnt lgkmcnt(0)
L_ok15:
  s_add_u32 m0, s61, 0
  s_mov_b32 s62, 245760
  buffer_load_dwordx4 v20, s[28:31], s62 offen offset:0 sc1 lds
  buffer_load_dwordx4 v20, s[28:31], s62 offen offset:1024 sc1 lds
  buffer_load_dwordx4 v20, s[28:31], s62 offen offset:2048 sc1 lds
  buffer_load_dwordx4 v20, s[28:31], s62 offen offset:3072 sc1 lds
  s_mov_b32 s41, 1920
  s_add_u32 m0, s60, 0
  s_nop 0
  buffer_load_dwordx4 v16, s[16:19], s41 offen offset:0 lds
  buffer_load_dwordx4 v17, s[16:19], s41 offen offset:1024 lds
  buffer_load_dwordx4 v18, s[16:19], s41 offen offset:2048 lds
  buffer_load_dwordx4 v19, s[16:19], s41 offen offset:3072 lds
  s_waitcnt vmcnt(8)
  s_barrier
  s_add_u32 m0, s60, 4096
  s_add_u32 s41, s41, 65536
  buffer_load_dwordx4 v16, s[16:19], s41 offen offset:0 lds
  buffer_load_dwordx4 v17, s[16:19], s41 offen offset:1024 lds
  buffer_load_dwordx4 v18, s[16:19], s41 offen offset:2048 lds
  buffer_load_dwordx4 v19, s[16:19], s41 offen offset:3072 lds
  s_waitcnt vmcnt(4)
  s_barrier
  s_waitcnt vmcnt(0)
  s_barrier
  s_endpgm
L_prod:
  v_and_b32 v2, 63, v0
  v_lshlrev_b32 v5, 2, v3
  s_and_b32 s39, s38, 3
  s_mov_b32 s56, 917504
  s_mov_b32 s57, 16384
  s_mov_b32 s58, 512
  s_mov_b32 s59, 0
  s_mov_b32 s55, 7
  v_mov_b32 v15, 0x7ff00000
  s_cmp_lt_u32 s2, 28
  s_cbranch_scc1 L_pp
  s_mov_b32 s56, 512
  s_mov_b32 s57, 262144
  s_mov_b32 s58, 8192
  s_mov_b32 s59, 4096
  s_mov_b32 s51, 6
L_pl:
  s_add_u32 m0, m0, 4096
  v_add_u32 v16, 256, v16
  s_sub_u32 s51, s51, 1
  buffer_load_dword v16, s[24:27], 0 offen lds
  buffer_load_dword v16, s[24:27], s50 offen offset:256 lds
  s_cmp_lg_u32 s51, 0
  s_cbranch_scc1 L_pl
  s_branch L_pq
L_pp:
  s_mov_b32 s22, 13762560
L_pq:
  s_add_u32 s10, s28, 9437184
  s_addc_u32 s11, s29, 0
  s_load_dwordx2 s[6:7], s[10:11], 0
  s_lshl_b32 s53, s38, 11
  s_add_u32 s53, s53, 32768
  v_and_b32 v1, 1, v3
  v_lshlrev_b32 v1, 10, v1
  v_lshl_add_u32 v1, v9, 3, v1
  v_lshrrev_b32 v6, 1, v3
  v_lshl_add_u32 v6, v6, 4, v1
  v_add_u32 v6, s53, v6
  v_lshl_add_u32 v7, v2, 4, s53
  s_lshl_b32 s53, s37, 18
  s_lshl_b32 s54, s52, 11
  s_add_u32 s53, s53, s54
  v_lshl_add_u32 v8, v2, 4, s53
  s_lshl_b32 s53, s37, 6
  s_lshr_b32 s54, s52, 1
  s_add_u32 s53, s53, s54
  s_lshl_b32 s53, s53, 7
  s_and_b32 s54, s52, 1
  s_lshl_b32 s54, s54, 3
  s_add_u32 s53, s53, s54
  s_add_u32 s53, s53, 7340032
  v_lshl_add_u32 v14, v2, 7, s53
  s_waitcnt vmcnt(0)
  buffer_load_dwordx4 v[32:35], v4, s[20:23], 0 offen nt
  buffer_load_dwordx4 v[36:39], v4, s[20:23], s45 offen nt
  buffer_load_dwordx4 v[40:43], v4, s[20:23], s46 offen nt
  buffer_load_dwordx4 v[44:47], v4, s[20:23], s47 offen nt
  v_add_u32 v4, s56, v4
  buffer_load_dword v17, v15, s[20:23], 0 offen
  buffer_load_dword v17, v15, s[20:23], 0 offen
  buffer_load_dwordx4 v[48:51], v4, s[20:23], 0 offen nt
  buffer_load_dwordx4 v[52:55], v4, s[20:23], s45 offen nt
  buffer_load_dwordx4 v[56:59], v4, s[20:23], s46 offen nt
  buffer_load_dwordx4 v[60:63], v4, s[20:23], s47 offen nt
  v_add_u32 v4, s56, v4
  s_waitcnt lgkmcnt(0)
  s_mul_i32 s8, s6, 1664525
  s_mul_i32 s9, s7, 22695477
  s_add_u32 s8, s8, 1013904223
  s_add_u32 s9, s9, 1
  v_mov_b32 v10, s8
  v_mov_b32 v11, s9
  s_mov_b32 s60, 0
  s_mov_b32 s61, 0
  s_mov_b32 s62, 0
  s_waitcnt vmcnt(10)
  s_barrier
L_p:
  s_waitcnt vmcnt(9)
  v_lshl_add_u32 v32, v32, 8, v5
  v_lshl_add_u32 v33, v33, 8, v5
  v_lshl_add_u32 v34, v34, 8, v5
  v_lshl_add_u32 v35, v35, 8, v5
  ds_read_u16 v96, v32 offset:0
  ds_read_u16 v97, v33 offset:2
  ds_read_u16 v98, v34 offset:128
  ds_read_u16 v99, v35 offset:130
  s_waitcnt vmcnt(8)
  v_lshl_add_u32 v36, v36, 8, v5
  v_lshl_add_u32 v37, v37, 8, v5
  v_lshl_add_u32 v38, v38, 8, v5
  v_lshl_add_u32 v39, v39, 8, v5
  ds_read_u16 v100, v36 offset:0
  ds_read_u16 v101, v37 offset:2
  ds_read_u16 v102, v38 offset:128
  ds_read_u16 v103, v39 offset:130
  s_waitcnt vmcnt(7)
  v_lshl_add_u32 v40, v40, 8, v5
  v_lshl_add_u32 v41, v41, 8, v5
  v_lshl_add_u32 v42, v42, 8, v5
  v_lshl_add_u32 v43, v43, 8, v5
  ds_read_u16 v104, v40 offset:0
  ds_read_u16 v105, v41 offset:2
  ds_read_u16 v106, v42 offset:128
  ds_read_u16 v107, v43 offset:130
  s_waitcnt vmcnt(6)
  v_lshl_add_u32 v44, v44, 8, v5
  v_lshl_add_u32 v45, v45, 8, v5
  v_lshl_add_u32 v46, v46, 8, v5
  v_lshl_add_u32 v47, v47, 8, v5
  ds_read_u16 v108, v44 offset:0
  ds_read_u16 v109, v45 offset:2
  ds_read_u16 v110, v46 offset:128
  ds_read_u16 v111, v47 offset:130
  s_waitcnt lgkmcnt(8)
  v_lshl_or_b32 v112, v100, 16, v96
  v_lshl_or_b32 v114, v101, 16, v97
  v_lshl_or_b32 v116, v102, 16, v98
  v_lshl_or_b32 v118, v103, 16, v99
  s_waitcnt lgkmcnt(3)
  v_lshl_or_b32 v113, v108, 16, v104
  ds_write_b64 v6, v[112:113] offset:0
  s_waitcnt lgkmcnt(3)
  v_lshl_or_b32 v115, v109, 16, v105
  ds_write_b64 v6, v[114:115] offset:256
  s_waitcnt lgkmcnt(3)
  v_lshl_or_b32 v117, v110, 16, v106
  ds_write_b64 v6, v[116:117] offset:512
  s_waitcnt lgkmcnt(3)
  v_lshl_or_b32 v119, v111, 16, v107
  ds_write_b64 v6, v[118:119] offset:768
  s_waitcnt lgkmcnt(0)
  ds_read_b128 v[120:123], v7 offset:0
  ds_read_b128 v[124:127], v7 offset:1024
  s_cmp_eq_u32 s62, 0
  s_cbranch_scc1 L_pa0
  s_waitcnt vmcnt(4)
  s_mov_b64 exec, 1
  buffer_store_dwordx2 v[10:11], v14, s[28:31], s61 offen sc1
  s_mov_b64 exec, -1
  s_add_u32 s61, s61, s58
L_pa0:
  s_waitcnt lgkmcnt(1)
  buffer_store_dwordx4 v[120:123], v8, s[28:31], s60 offen offset:0 sc1
  s_waitcnt lgkmcnt(0)
  buffer_store_dwordx4 v[124:127], v8, s[28:31], s60 offen offset:1024 sc1
  buffer_load_dwordx4 v[32:35], v4, s[20:23], 0 offen nt
  buffer_load_dwordx4 v[36:39], v4, s[20:23], s45 offen nt
  buffer_load_dwordx4 v[40:43], v4, s[20:23], s46 offen nt
  buffer_load_dwordx4 v[44:47], v4, s[20:23], s47 offen nt
  v_add_u32 v4, s56, v4
  v_add_u32 v5, s59, v5
  s_add_u32 s62, s62, 1
  s_add_u32 s60, s60, s57
  s_cmp_lt_u32 s62, s55
  s_cbranch_scc0 L_pe
  s_waitcnt vmcnt(9)
  v_lshl_add_u32 v48, v48, 8, v5
  v_lshl_add_u32 v49, v49, 8, v5
  v_lshl_add_u32 v50, v50, 8, v5
  v_lshl_add_u32 v51, v51, 8, v5
  ds_read_u16 v96, v48 offset:0
  ds_read_u16 v97, v49 offset:2
  ds_read_u16 v98, v50 offset:128
  ds_read_u16 v99, v51 offset:130
  s_waitcnt vmcnt(8)
  v_lshl_add_u32 v52, v52, 8, v5
  v_lshl_add_u32 v53, v53, 8, v5
  v_lshl_add_u32 v54, v54, 8, v5
  v_lshl_add_u32 v55, v55, 8, v5
  ds_read_u16 v100, v52 offset:0
  ds_read_u16 v101, v53 offset:2
  ds_read_u16 v102, v54 offset:128
  ds_read_u16 v103, v55 offset:130
  s_waitcnt vmcnt(7)
  v_lshl_add_u32 v56, v56, 8, v5
  v_lshl_add_u32 v57, v57, 8, v5
  v_lshl_add_u32 v58, v58, 8, v5
  v_lshl_add_u32 v59, v59, 8, v5
  ds_read_u16 v104, v56 offset:0
  ds_read_u16 v105, v57 offset:2
  ds_read_u16 v106, v58 offset:128
  ds_read_u16 v107, v59 offset:130
  s_waitcnt vmcnt(6)
  v_lshl_add_u32 v60, v60, 8, v5
  v_lshl_add_u32 v61, v61, 8, v5
  v_lshl_add_u32 v62, v62, 8, v5
  v_lshl_add_u32 v63, v63, 8, v5
  ds_read_u16 v108, v60 offset:0
  ds_read_u16 v109, v61 offset:2
  ds_read_u16 v110, v62 offset:128
  ds_read_u16 v111, v63 offset:130
  s_waitcnt lgkmcnt(8)
  v_lshl_or_b32 v112, v100, 16, v96
  v_lshl_or_b32 v114, v101, 16, v97
  v_lshl_or_b32 v116, v102, 16, v98
  v_lshl_or_b32 v118, v103, 16, v99
  s_waitcnt lgkmcnt(3)
  v_lshl_or_b32 v113, v108, 16, v104
  ds_write_b64 v6, v[112:113] offset:0
  s_waitcnt lgkmcnt(3)
  v_lshl_or_b32 v115, v109, 16, v105
  ds_write_b64 v6, v[114:115] offset:256
  s_waitcnt lgkmcnt(3)
  v_lshl_or_b32 v117, v110, 16, v106
  ds_write_b64 v6, v[116:117] offset:512
  s_waitcnt lgkmcnt(3)
  v_lshl_or_b32 v119, v111, 16, v107
  ds_write_b64 v6, v[118:119] offset:768
  s_waitcnt lgkmcnt(0)
  ds_read_b128 v[128:131], v7 offset:0
  ds_read_b128 v[132:135], v7 offset:1024
  s_cmp_eq_u32 s62, 0
  s_cbranch_scc1 L_pa1
  s_waitcnt vmcnt(4)
  s_mov_b64 exec, 1
  buffer_store_dwordx2 v[10:11], v14, s[28:31], s61 offen sc1
  s_mov_b64 exec, -1
  s_add_u32 s61, s61, s58
L_pa1:
  s_waitcnt lgkmcnt(1)
  buffer_store_dwordx4 v[128:131], v8, s[28:31], s60 offen offset:0 sc1
  s_waitcnt lgkmcnt(0)
  buffer_store_dwordx4 v[132:135], v8, s[28:31], s60 offen offset:1024 sc1
  buffer_load_dwordx4 v[48:51], v4, s[20:23], 0 offen nt
  buffer_load_dwordx4 v[52:55], v4, s[20:23], s45 offen nt
  buffer_load_dwordx4 v[56:59], v4, s[20:23], s46 offen nt
  buffer_load_dwordx4 v[60:63], v4, s[20:23], s47 offen nt
  v_add_u32 v4, s56, v4
  v_add_u32 v5, s59, v5
  s_add_u32 s62, s62, 1
  s_add_u32 s60, s60, s57
  s_cmp_lt_u32 s62, s55
  s_cbranch_scc1 L_p
L_pe:
  s_waitcnt vmcnt(4)
  s_mov_b64 exec, 1
  buffer_store_dwordx2 v[10:11], v14, s[28:31], s61 offen sc1
  s_mov_b64 exec, -1
  s_cmp_eq_u32 s38, 0
  s_cbranch_scc0 L_pz
  s_lshl_b32 s3, s2, 6
  s_add_u32 s3, s3, 9441280
  v_mov_b32 v12, s3
  s_mov_b64 exec, 1
  buffer_store_dwordx2 v[10:11], v12, s[28:31], 0 offen sc1
  s_mov_b64 exec, -1
  s_cmp_eq_u32 s2, 0
  s_cbranch_scc0 L_pz
  s_mov_b32 s63, 0
  v_lshlrev_b32 v12, 6, v2
  v_add_u32 v12, 9441280, v12
L_pw:
  s_mov_b32 s53, 0
  buffer_load_dwordx2 v[20:21], v12, s[28:31], s53 offen sc1
  s_mov_b32 s53, 4096
  buffer_load_dwordx2 v[22:23], v12, s[28:31], s53 offen sc1
  s_mov_b32 s53, 8192
  buffer_load_dwordx2 v[24:25], v12, s[28:31], s53 offen sc1
  s_mov_b32 s53, 12288
  buffer_load_dwordx2 v[26:27], v12, s[28:31], s53 offen sc1
  s_add_u32 s63, s63, 1
  s_waitcnt vmcnt(0)
  v_cmp_ne_u64 s[52:53], v[20:21], v[10:11]
  v_cmp_ne_u64 vcc, v[22:23], v[10:11]
  s_or_b64 s[52:53], s[52:53], vcc
  v_cmp_ne_u64 vcc, v[24:25], v[10:11]
  s_or_b64 s[52:53], s[52:53], vcc
  v_cmp_ne_u64 vcc, v[26:27], v[10:11]
  s_or_b64 s[52:53], s[52:53], vcc
  s_cbranch_scc0 L_pv
  s_cmp_lt_u32 s63, 20000
  s_cbranch_scc1 L_pw
L_pv:
  v_mov_b32 v12, 9437184
  s_mov_b64 exec, 1
  buffer_store_dwordx2 v[10:11], v12, s[28:31], 0 offen sc1
  s_mov_b64 exec, -1
L_pz:
L_drain:
  s_waitcnt vmcnt(0)
L_done:
  s_endpgm
L_end:
.section .rodata,"a"
.p2align 6
.amdhsa_kernel standalone__weight_only_int_squeezellm__prompt_kernel
  .amdhsa_next_free_vgpr 256
  .amdhsa_next_free_sgpr 102
  .amdhsa_accum_offset 160
  .amdhsa_group_segment_fixed_size 0
  .amdhsa_kernarg_size 48
  .amdhsa_user_sgpr_count 2
  .amdhsa_user_sgpr_kernarg_segment_ptr 1
  .amdhsa_system_sgpr_workgroup_id_x 1
.end_amdhsa_kernel
```

```asm
; @launch grid=(256,1,1) block=(512,1,1) lds=163840
.amdgcn_target "amdgcn-amd-amdhsa--gfx950"
.text
.globl standalone__weight_only_int_squeezellm__prompt_kernel
.p2align 8
.type standalone__weight_only_int_squeezellm__prompt_kernel,@function
standalone__weight_only_int_squeezellm__prompt_kernel:
  s_cmp_ge_u32 s2, 256
  s_cbranch_scc1 L_done
  s_load_dwordx2 s[24:25], s[0:1], 16
  s_load_dwordx2 s[20:21], s[0:1], 8
  s_load_dwordx2 s[28:29], s[0:1], 40
  s_load_dwordx2 s[16:17], s[0:1], 0
  s_load_dwordx2 s[32:33], s[0:1], 24
  s_and_b32 s3, s2, 1
  s_bfe_u32 s36, s2, 0x20003
  s_lshl2_add_u32 s36, s3, s36
  s_bfe_u32 s3, s2, 0x20001
  s_mul_i32 s3, s3, 7
  s_lshr_b32 s37, s2, 5
  s_add_u32 s37, s37, s3
  s_sub_u32 s37, s37, 1
  s_sub_u32 s3, s2, 28
  s_mul_i32 s53, s3, 7
  s_cmp_lt_u32 s3, 4
  s_cselect_b32 s51, 15, 8
  s_cselect_b32 s53, s53, s2
  s_cmp_lt_u32 s2, 32
  s_cselect_b32 s36, s51, s36
  s_cselect_b32 s37, s53, s37
  s_cselect_b32 s51, 0, 147456
  v_lshrrev_b32 v1, 6, v0
  v_and_b32 v3, 31, v0
  v_readfirstlane_b32 s38, v1
  v_bfe_u32 v9, v0, 5, 1
  s_mov_b32 s26, 114688
  s_mov_b32 s27, 0x20000
  s_mov_b32 s22, 14680064
  s_mov_b32 s23, 0x20000
  v_mul_u32_u24 v1, 57344, v9
  v_lshl_add_u32 v4, v3, 4, v1
  v_lshlrev_b32 v1, 3, v3
  v_lshl_add_u32 v16, v9, 2, v1
  s_mul_i32 s53, s38, 14336
  s_lshl_b32 s54, s37, 8
  s_add_u32 s53, s53, s54
  v_add_u32 v16, s53, v16
  s_lshl_b32 s53, s38, 9
  s_add_u32 m0, s53, s51
  s_movk_i32 s50, 6912
  s_lshl3_add_u32 s52, s36, s38
  s_mul_i32 s53, s52, 114688
  s_lshl1_add_u32 s53, s54, s53
  v_add_u32 v4, s53, v4
  s_movk_i32 s45, 14336
  s_movk_i32 s46, 28672
  s_mov_b32 s47, 43008
  s_mov_b32 s30, 9457664
  s_mov_b32 s31, 0x20000
  s_mov_b32 s18, 4194304
  s_mov_b32 s19, 0x20000
  s_mov_b32 s34, 14680064
  s_mov_b32 s35, 0x20000
  s_cmp_lt_u32 s2, 32
  s_waitcnt lgkmcnt(0)
  buffer_load_dword v16, s[24:27], 0 offen lds
  buffer_load_dword v16, s[24:27], s50 offen offset:256 lds
  s_cbranch_scc0 L_ng
  v_and_b32 v20, 63, v0
  v_lshlrev_b32 v20, 20, v20
  buffer_load_dword v64, v20, s[20:23], 0 offen
  buffer_load_dword v65, v20, s[28:31], 0 offen
  buffer_load_dword v66, v20, s[16:19], 0 offen
  buffer_load_dword v67, v20, s[32:35], 0 offen
  s_getpc_b64 s[14:15]
L_pc:
  s_lshr_b32 s53, s2, 3
  s_lshl3_add_u32 s53, s53, s38
  s_mul_i32 s53, s53, 512
  s_min_u32 s53, s53, L_end-standalone__weight_only_int_squeezellm__prompt_kernel-512
  s_sub_u32 s14, s14, L_pc-standalone__weight_only_int_squeezellm__prompt_kernel
  s_subb_u32 s15, s15, 0
  s_load_dword s68, s[14:15], s53 offset:0
  s_load_dword s69, s[14:15], s53 offset:64
  s_load_dword s70, s[14:15], s53 offset:128
  s_load_dword s71, s[14:15], s53 offset:192
  s_load_dword s72, s[14:15], s53 offset:256
  s_load_dword s73, s[14:15], s53 offset:320
  s_load_dword s74, s[14:15], s53 offset:384
  s_load_dword s75, s[14:15], s53 offset:448
  s_branch L_prod
L_ng:
  buffer_load_dwordx4 v[32:35], v4, s[20:23], 0 offen nt
  buffer_load_dwordx4 v[36:39], v4, s[20:23], s45 offen nt
  buffer_load_dwordx4 v[40:43], v4, s[20:23], s46 offen nt
  buffer_load_dwordx4 v[44:47], v4, s[20:23], s47 offen nt
  s_add_u32 s10, s28, 9437184
  s_addc_u32 s11, s29, 0
  s_load_dwordx2 s[6:7], s[10:11], 0
  v_and_b32 v2, 63, v0
  v_lshlrev_b32 v5, 2, v3
  s_and_b32 s39, s38, 3
  v_add_u32 v5, 147456, v5
  s_lshl_b32 s53, s38, 11
  s_add_u32 s53, s53, 32768
  v_lshrrev_b32 v1, 4, v3
  v_lshlrev_b32 v1, 10, v1
  v_lshl_add_u32 v1, v9, 3, v1
  v_and_b32 v6, 15, v3
  v_lshl_add_u32 v6, v6, 4, v1
  v_add_u32 v6, s53, v6
  v_lshl_add_u32 v7, v2, 4, s53
  s_lshl_b32 s53, s37, 18
  s_lshl_b32 s54, s52, 11
  s_add_u32 s53, s53, s54
  v_lshl_add_u32 v8, v2, 4, s53
  s_lshl_b32 s53, s37, 6
  s_lshr_b32 s54, s52, 1
  s_add_u32 s53, s53, s54
  s_lshl_b32 s53, s53, 7
  s_and_b32 s54, s52, 1
  s_lshl_b32 s54, s54, 3
  s_add_u32 s53, s53, s54
  s_add_u32 s53, s53, 7340032
  v_lshl_add_u32 v14, v2, 7, s53
  s_lshl_b32 s53, s37, 2
  s_add_u32 s53, s53, s39
  s_mul_i32 s53, s53, 3
  s_min_u32 s53, s53, 253
  s_lshl_b32 s54, s36, 8
  s_add_u32 s53, s53, s54
  s_lshl_b32 s53, s53, 11
  s_add_u32 s12, s16, s53
  s_addc_u32 s13, s17, 0
  s_andn2_b32 s40, 4, s36
  v_and_b32 v3, 15, v2
  v_lshrrev_b32 v9, 4, v2
  v_lshrrev_b32 v1, 1, v3
  v_xor_b32 v1, v1, v9
  v_lshlrev_b32 v1, 4, v1
  v_lshl_add_u32 v144, v3, 7, v1
  s_lshl_b32 s54, s38, 13
  v_add_u32 v144, s54, v144
  v_xor_b32 v145, 64, v144
  v_lshlrev_b32 v1, 11, v9
  v_lshl_add_u32 v146, v3, 4, v1
  v_add_u32 v146, 32768, v146
  s_lshl_b32 s52, s36, 8
  s_lshl_b32 s53, s38, 6
  s_add_u32 s52, s52, s53
  s_mul_i32 s52, s52, 7168
  s_lshl_b32 s53, s37, 8
  s_add_u32 s52, s52, s53
  v_and_b32 v1, 1, v3
  v_lshl_add_u32 v1, v9, 2, v1
  v_mul_u32_u24 v1, 7168, v1
  v_lshrrev_b32 v147, 1, v3
  v_lshl_add_u32 v1, v147, 4, v1
  v_add_u32 v147, s52, v1
  v_lshrrev_b32 v20, 3, v2
  v_lshlrev_b32 v20, 11, v20
  v_lshrrev_b32 v1, 4, v2
  v_xor_b32 v1, v1, v2
  v_and_b32 v1, 7, v1
  v_lshl_add_u32 v20, v1, 4, v20
  s_lshl_b32 s52, s36, 19
  s_lshl_b32 s53, s39, 17
  s_add_u32 s53, s52, s53
  v_add_u32 v16, s53, v20
  v_xor_b32 v17, 64, v16
  v_add_u32 v18, 30720, v16
  v_add_u32 v19, 46080, v17
  v_add_u32 v17, 15360, v17
  s_lshl_b32 s60, s39, 13
  s_lshl_b32 s53, s37, 18
  s_lshl_b32 s54, s39, 12
  s_add_u32 s53, s53, s54
  v_lshl_add_u32 v20, v2, 4, s53
  s_add_u32 s61, s54, 32768
  s_lshl_b32 s53, s37, 13
  s_lshl_b32 s54, s39, 7
  s_add_u32 s53, s53, s54
  s_and_b32 s54, s36, 0
  s_lshl_b32 s54, s54, 7
  s_add_u32 s53, s53, s54
  s_add_u32 s53, s53, 7340032
  s_add_u32 s4, s28, s53
  s_addc_u32 s5, s29, 0
  s_lshl_b32 s41, s36, 7
  s_lshr_b32 s53, s38, 2
  s_lshl_b32 s54, s53, 16
  s_add_u32 s41, s41, s54
  s_lshl_b32 s53, s53, 12
  s_add_u32 m0, s60, s53
  s_waitcnt lgkmcnt(0)
  s_mul_i32 s8, s6, 1664525
  s_mul_i32 s9, s7, 22695477
  s_add_u32 s8, s8, 1013904223
  s_add_u32 s9, s9, 1
  v_mov_b32 v10, s8
  v_mov_b32 v11, s9
  s_waitcnt vmcnt(4)
  s_barrier
  s_waitcnt vmcnt(3)
  v_lshl_add_u32 v32, v32, 8, v5
  v_lshl_add_u32 v33, v33, 8, v5
  v_lshl_add_u32 v34, v34, 8, v5
  v_lshl_add_u32 v35, v35, 8, v5
  ds_read_u16 v96, v32 offset:0
  ds_read_u16 v97, v33 offset:2
  ds_read_u16 v98, v34 offset:128
  ds_read_u16 v99, v35 offset:130
  buffer_load_dwordx4 v16, s[16:19], s41 offen offset:0 lds
  s_waitcnt vmcnt(3)
  v_lshl_add_u32 v36, v36, 8, v5
  v_lshl_add_u32 v37, v37, 8, v5
  v_lshl_add_u32 v38, v38, 8, v5
  v_lshl_add_u32 v39, v39, 8, v5
  ds_read_u16 v100, v36 offset:0
  ds_read_u16 v101, v37 offset:2
  ds_read_u16 v102, v38 offset:128
  ds_read_u16 v103, v39 offset:130
  buffer_load_dwordx4 v17, s[16:19], s41 offen offset:1024 lds
  s_waitcnt vmcnt(3)
  v_lshl_add_u32 v40, v40, 8, v5
  v_lshl_add_u32 v41, v41, 8, v5
  v_lshl_add_u32 v42, v42, 8, v5
  v_lshl_add_u32 v43, v43, 8, v5
  ds_read_u16 v104, v40 offset:0
  ds_read_u16 v105, v41 offset:2
  ds_read_u16 v106, v42 offset:128
  ds_read_u16 v107, v43 offset:130
  buffer_load_dwordx4 v18, s[16:19], s41 offen offset:2048 lds
  s_waitcnt vmcnt(3)
  v_lshl_add_u32 v44, v44, 8, v5
  v_lshl_add_u32 v45, v45, 8, v5
  v_lshl_add_u32 v46, v46, 8, v5
  v_lshl_add_u32 v47, v47, 8, v5
  ds_read_u16 v108, v44 offset:0
  ds_read_u16 v109, v45 offset:2
  ds_read_u16 v110, v46 offset:128
  ds_read_u16 v111, v47 offset:130
  buffer_load_dwordx4 v19, s[16:19], s41 offen offset:3072 lds
  s_waitcnt lgkmcnt(8)
  v_lshl_or_b32 v112, v100, 16, v96
  v_lshl_or_b32 v114, v101, 16, v97
  v_lshl_or_b32 v116, v102, 16, v98
  v_lshl_or_b32 v118, v103, 16, v99
  s_waitcnt lgkmcnt(3)
  v_lshl_or_b32 v113, v108, 16, v104
  ds_write_b64 v6, v[112:113] offset:0
  s_waitcnt lgkmcnt(3)
  v_lshl_or_b32 v115, v109, 16, v105
  ds_write_b64 v6, v[114:115] offset:256
  s_waitcnt lgkmcnt(3)
  v_lshl_or_b32 v117, v110, 16, v106
  ds_write_b64 v6, v[116:117] offset:512
  s_waitcnt lgkmcnt(3)
  v_lshl_or_b32 v119, v111, 16, v107
  ds_write_b64 v6, v[118:119] offset:768
  s_waitcnt lgkmcnt(0)
  ds_read_b128 v[148:151], v7 offset:0
  ds_read_b128 v[152:155], v7 offset:1024
  s_waitcnt lgkmcnt(1)
  buffer_store_dwordx4 v[148:151], v8, s[28:31], 0 offen offset:0 sc1
  s_waitcnt lgkmcnt(0)
  buffer_store_dwordx4 v[152:155], v8, s[28:31], 0 offen offset:1024 sc1
  s_cmp_ge_u32 s38, 4
  s_cbranch_scc1 L_loader
  s_add_u32 s58, s40, 0
  s_lshl_b32 s58, s58, 7
  s_load_dword s92, s[12:13], s58 offset:0
  s_load_dword s93, s[12:13], s58 offset:64
  s_load_dword s94, s[12:13], s58 offset:2048
  s_load_dword s95, s[12:13], s58 offset:2112
  s_load_dword s96, s[12:13], s58 offset:4096
  s_load_dword s97, s[12:13], s58 offset:4160
  s_add_u32 s58, s40, 1
  s_lshl_b32 s58, s58, 7
  s_load_dword s92, s[12:13], s58 offset:0
  s_load_dword s93, s[12:13], s58 offset:64
  s_load_dword s94, s[12:13], s58 offset:2048
  s_load_dword s95, s[12:13], s58 offset:2112
  s_load_dword s96, s[12:13], s58 offset:4096
  s_load_dword s97, s[12:13], s58 offset:4160
  v_mov_b32 v5, v144
  v_mov_b32 v6, v145
  v_mov_b32 v7, v146
  v_mov_b32 v16, 0
  v_mov_b32 v17, 0
  v_mov_b32 v18, 0
  v_mov_b32 v19, 0
  v_mov_b32 v20, 0
  v_mov_b32 v21, 0
  v_mov_b32 v22, 0
  v_mov_b32 v23, 0
  v_mov_b32 v24, 0
  v_mov_b32 v25, 0
  v_mov_b32 v26, 0
  v_mov_b32 v27, 0
  v_mov_b32 v28, 0
  v_mov_b32 v29, 0
  v_mov_b32 v30, 0
  v_mov_b32 v31, 0
  v_mov_b32 v32, 0
  v_mov_b32 v33, 0
  v_mov_b32 v34, 0
  v_mov_b32 v35, 0
  v_mov_b32 v36, 0
  v_mov_b32 v37, 0
  v_mov_b32 v38, 0
  v_mov_b32 v39, 0
  v_mov_b32 v40, 0
  v_mov_b32 v41, 0
  v_mov_b32 v42, 0
  v_mov_b32 v43, 0
  v_mov_b32 v44, 0
  v_mov_b32 v45, 0
  v_mov_b32 v46, 0
  v_mov_b32 v47, 0
  v_mov_b32 v48, 0
  v_mov_b32 v49, 0
  v_mov_b32 v50, 0
  v_mov_b32 v51, 0
  v_mov_b32 v52, 0
  v_mov_b32 v53, 0
  v_mov_b32 v54, 0
  v_mov_b32 v55, 0
  v_mov_b32 v56, 0
  v_mov_b32 v57, 0
  v_mov_b32 v58, 0
  v_mov_b32 v59, 0
  v_mov_b32 v60, 0
  v_mov_b32 v61, 0
  v_mov_b32 v62, 0
  v_mov_b32 v63, 0
  v_mov_b32 v64, 0
  v_mov_b32 v65, 0
  v_mov_b32 v66, 0
  v_mov_b32 v67, 0
  v_mov_b32 v68, 0
  v_mov_b32 v69, 0
  v_mov_b32 v70, 0
  v_mov_b32 v71, 0
  v_mov_b32 v72, 0
  v_mov_b32 v73, 0
  v_mov_b32 v74, 0
  v_mov_b32 v75, 0
  v_mov_b32 v76, 0
  v_mov_b32 v77, 0
  v_mov_b32 v78, 0
  v_mov_b32 v79, 0
  v_mov_b32 v80, 0
  v_mov_b32 v81, 0
  v_mov_b32 v82, 0
  v_mov_b32 v83, 0
  v_mov_b32 v84, 0
  v_mov_b32 v85, 0
  v_mov_b32 v86, 0
  v_mov_b32 v87, 0
  v_mov_b32 v88, 0
  v_mov_b32 v89, 0
  v_mov_b32 v90, 0
  v_mov_b32 v91, 0
  v_mov_b32 v92, 0
  v_mov_b32 v93, 0
  v_mov_b32 v94, 0
  v_mov_b32 v95, 0
  v_mov_b32 v96, 0
  v_mov_b32 v97, 0
  v_mov_b32 v98, 0
  v_mov_b32 v99, 0
  v_mov_b32 v100, 0
  v_mov_b32 v101, 0
  v_mov_b32 v102, 0
  v_mov_b32 v103, 0
  v_mov_b32 v104, 0
  v_mov_b32 v105, 0
  v_mov_b32 v106, 0
  v_mov_b32 v107, 0
  v_mov_b32 v108, 0
  v_mov_b32 v109, 0
  v_mov_b32 v110, 0
  v_mov_b32 v111, 0
  v_mov_b32 v112, 0
  v_mov_b32 v113, 0
  v_mov_b32 v114, 0
  v_mov_b32 v115, 0
  v_mov_b32 v116, 0
  v_mov_b32 v117, 0
  v_mov_b32 v118, 0
  v_mov_b32 v119, 0
  v_mov_b32 v120, 0
  v_mov_b32 v121, 0
  v_mov_b32 v122, 0
  v_mov_b32 v123, 0
  v_mov_b32 v124, 0
  v_mov_b32 v125, 0
  v_mov_b32 v126, 0
  v_mov_b32 v127, 0
  v_mov_b32 v128, 0
  v_mov_b32 v129, 0
  v_mov_b32 v130, 0
  v_mov_b32 v131, 0
  v_mov_b32 v132, 0
  v_mov_b32 v133, 0
  v_mov_b32 v134, 0
  v_mov_b32 v135, 0
  v_mov_b32 v136, 0
  v_mov_b32 v137, 0
  v_mov_b32 v138, 0
  v_mov_b32 v139, 0
  v_mov_b32 v140, 0
  v_mov_b32 v141, 0
  v_mov_b32 v142, 0
  v_mov_b32 v143, 0
  s_waitcnt vmcnt(0)
  s_mov_b64 exec, 1
  buffer_store_dwordx2 v[10:11], v14, s[28:31], 0 offen sc1
  s_mov_b64 exec, -1
  s_mov_b32 s44, 0
  s_mov_b32 s45, 7168
  s_mov_b32 s46, 14336
  s_mov_b32 s47, 21504
  s_mov_b32 s48, 114688
  s_mov_b32 s49, 121856
  s_mov_b32 s50, 129024
  s_mov_b32 s51, 136192
  s_mov_b32 s52, 229376
  s_mov_b32 s53, 236544
  s_mov_b32 s54, 243712
  s_mov_b32 s55, 250880
  s_mov_b32 s56, 344064
  s_mov_b32 s57, 351232
  s_mov_b32 s58, 358400
  s_mov_b32 s59, 365568
  s_mov_b32 s60, 0
  s_mov_b32 s61, 0
  s_mov_b32 s60, 49152
  s_mov_b32 s61, 5
  s_mov_b32 s62, 49152
  s_lshl_b32 s63, s38, 12
  s_sub_u32 s63, 147456, s63
  s_mov_b32 vcc_lo, 0x55555555
  s_mov_b32 vcc_hi, 0x55555555
  s_barrier
  ds_read_b128 a[64:67], v7 offset:0
  ds_read_b128 a[68:71], v7 offset:8192
  ds_read_b128 a[0:3], v5 offset:0
  ds_read_b128 a[4:7], v6 offset:0
  ds_read_b128 a[8:11], v5 offset:2048
  ds_read_b128 a[12:15], v6 offset:2048
  ds_read_b128 a[16:19], v5 offset:4096
  ds_read_b128 a[72:75], v7 offset:256
  ds_read_b128 a[76:79], v7 offset:8448
  ds_read_b128 a[20:23], v6 offset:4096
  ds_read_b128 a[24:27], v5 offset:6144
  ds_read_b128 a[28:31], v6 offset:6144
  ds_read_b128 a[80:83], v7 offset:512
  ds_read_b128 a[84:87], v7 offset:8704
  s_cmp_eq_u32 s38, 0
  s_cbranch_scc0 L_c0
  s_lshl_b32 s3, s2, 6
  s_add_u32 s3, s3, 9441280
  v_mov_b32 v12, s3
  s_mov_b64 exec, 1
  buffer_store_dwordx2 v[10:11], v12, s[28:31], 0 offen sc1
  s_mov_b64 exec, -1
L_c0:
  s_waitcnt lgkmcnt(0)
.p2align 6
L_c:
  v_mfma_f32_16x16x32_bf16 v[16:19], a[0:3], a[64:67], v[16:19]
  v_mfma_f32_16x16x32_bf16 v[16:19], a[4:7], a[68:71], v[16:19]
  ds_read_b128 a[88:91], v7 offset:768
  ds_read_b128 a[92:95], v7 offset:8960
  v_mfma_f32_16x16x32_bf16 v[48:51], a[8:11], a[64:67], v[48:51]
  v_mfma_f32_16x16x32_bf16 v[48:51], a[12:15], a[68:71], v[48:51]
  s_cmp_eq_u32 s60, 147456
  v_mfma_f32_16x16x32_bf16 v[80:83], a[16:19], a[64:67], v[80:83]
  v_mfma_f32_16x16x32_bf16 v[80:83], a[20:23], a[68:71], v[80:83]
  s_cselect_b32 s60, 0, s60
  v_add_u32 v1, s60, v146
  v_mfma_f32_16x16x32_bf16 v[112:115], a[24:27], a[64:67], v[112:115]
  v_mfma_f32_16x16x32_bf16 v[112:115], a[28:31], a[68:71], v[112:115]
  v_mfma_f32_16x16x32_bf16 v[20:23], a[0:3], a[72:75], v[20:23]
  v_mfma_f32_16x16x32_bf16 v[20:23], a[4:7], a[76:79], v[20:23]
  ds_read_b128 a[64:67], v7 offset:1024
  ds_read_b128 a[68:71], v7 offset:9216
  v_mfma_f32_16x16x32_bf16 v[52:55], a[8:11], a[72:75], v[52:55]
  v_mfma_f32_16x16x32_bf16 v[52:55], a[12:15], a[76:79], v[52:55]
  v_mfma_f32_16x16x32_bf16 v[84:87], a[16:19], a[72:75], v[84:87]
  v_mfma_f32_16x16x32_bf16 v[84:87], a[20:23], a[76:79], v[84:87]
  v_mfma_f32_16x16x32_bf16 v[116:119], a[24:27], a[72:75], v[116:119]
  v_mfma_f32_16x16x32_bf16 v[116:119], a[28:31], a[76:79], v[116:119]
  v_mfma_f32_16x16x32_bf16 v[24:27], a[0:3], a[80:83], v[24:27]
  v_mfma_f32_16x16x32_bf16 v[24:27], a[4:7], a[84:87], v[24:27]
  ds_read_b128 a[72:75], v7 offset:1280
  ds_read_b128 a[76:79], v7 offset:9472
  v_mfma_f32_16x16x32_bf16 v[56:59], a[8:11], a[80:83], v[56:59]
  v_mfma_f32_16x16x32_bf16 v[56:59], a[12:15], a[84:87], v[56:59]
  v_mfma_f32_16x16x32_bf16 v[88:91], a[16:19], a[80:83], v[88:91]
  v_mfma_f32_16x16x32_bf16 v[88:91], a[20:23], a[84:87], v[88:91]
  v_mfma_f32_16x16x32_bf16 v[120:123], a[24:27], a[80:83], v[120:123]
  v_mfma_f32_16x16x32_bf16 v[120:123], a[28:31], a[84:87], v[120:123]
  v_add_u32 v3, s60, v144
  s_waitcnt lgkmcnt(0)
  v_mfma_f32_16x16x32_bf16 v[28:31], a[0:3], a[88:91], v[28:31]
  v_mfma_f32_16x16x32_bf16 v[28:31], a[4:7], a[92:95], v[28:31]
  ds_read_b128 a[80:83], v7 offset:1536
  ds_read_b128 a[84:87], v7 offset:9728
  v_mfma_f32_16x16x32_bf16 v[60:63], a[8:11], a[88:91], v[60:63]
  v_mfma_f32_16x16x32_bf16 v[60:63], a[12:15], a[92:95], v[60:63]
  v_add_u32_e64 v4, s60, v145
  v_mfma_f32_16x16x32_bf16 v[92:95], a[16:19], a[88:91], v[92:95]
  v_mfma_f32_16x16x32_bf16 v[92:95], a[20:23], a[92:95], v[92:95]
  v_mfma_f32_16x16x32_bf16 v[124:127], a[24:27], a[88:91], v[124:127]
  v_mfma_f32_16x16x32_bf16 v[124:127], a[28:31], a[92:95], v[124:127]
  v_mfma_f32_16x16x32_bf16 v[32:35], a[0:3], a[64:67], v[32:35]
  v_mfma_f32_16x16x32_bf16 v[32:35], a[4:7], a[68:71], v[32:35]
  ds_read_b128 a[88:91], v7 offset:1792
  ds_read_b128 a[92:95], v7 offset:9984
  v_mfma_f32_16x16x32_bf16 v[64:67], a[8:11], a[64:67], v[64:67]
  v_mfma_f32_16x16x32_bf16 v[64:67], a[12:15], a[68:71], v[64:67]
  v_mfma_f32_16x16x32_bf16 v[96:99], a[16:19], a[64:67], v[96:99]
  v_mfma_f32_16x16x32_bf16 v[96:99], a[20:23], a[68:71], v[96:99]
  v_mfma_f32_16x16x32_bf16 v[128:131], a[24:27], a[64:67], v[128:131]
  v_mfma_f32_16x16x32_bf16 v[128:131], a[28:31], a[68:71], v[128:131]
  s_waitcnt lgkmcnt(0)
  s_barrier
  v_mfma_f32_16x16x32_bf16 v[36:39], a[0:3], a[72:75], v[36:39]
  v_mfma_f32_16x16x32_bf16 v[36:39], a[4:7], a[76:79], v[36:39]
  ds_read_b128 a[64:67], v1 offset:0
  ds_read_b128 a[68:71], v1 offset:8192
  v_mfma_f32_16x16x32_bf16 v[68:71], a[8:11], a[72:75], v[68:71]
  v_mfma_f32_16x16x32_bf16 v[68:71], a[12:15], a[76:79], v[68:71]
  ds_read_b128 a[32:35], v3 offset:0
  ds_read_b128 a[36:39], v4 offset:0
  v_mfma_f32_16x16x32_bf16 v[100:103], a[16:19], a[72:75], v[100:103]
  v_mfma_f32_16x16x32_bf16 v[100:103], a[20:23], a[76:79], v[100:103]
  ds_read_b128 a[40:43], v3 offset:2048
  ds_read_b128 a[44:47], v4 offset:2048
  v_mfma_f32_16x16x32_bf16 v[132:135], a[24:27], a[72:75], v[132:135]
  v_mfma_f32_16x16x32_bf16 v[132:135], a[28:31], a[76:79], v[132:135]
  ds_read_b128 a[48:51], v3 offset:4096
  v_mfma_f32_16x16x32_bf16 v[40:43], a[0:3], a[80:83], v[40:43]
  v_mfma_f32_16x16x32_bf16 v[40:43], a[4:7], a[84:87], v[40:43]
  ds_read_b128 a[72:75], v1 offset:256
  ds_read_b128 a[76:79], v1 offset:8448
  v_mfma_f32_16x16x32_bf16 v[72:75], a[8:11], a[80:83], v[72:75]
  v_mfma_f32_16x16x32_bf16 v[72:75], a[12:15], a[84:87], v[72:75]
  ds_read_b128 a[52:55], v4 offset:4096
  v_mfma_f32_16x16x32_bf16 v[104:107], a[16:19], a[80:83], v[104:107]
  v_mfma_f32_16x16x32_bf16 v[104:107], a[20:23], a[84:87], v[104:107]
  ds_read_b128 a[56:59], v3 offset:6144
  v_mfma_f32_16x16x32_bf16 v[136:139], a[24:27], a[80:83], v[136:139]
  v_mfma_f32_16x16x32_bf16 v[136:139], a[28:31], a[84:87], v[136:139]
  ds_read_b128 a[60:63], v4 offset:6144
  v_mfma_f32_16x16x32_bf16 v[44:47], a[0:3], a[88:91], v[44:47]
  v_mfma_f32_16x16x32_bf16 v[44:47], a[4:7], a[92:95], v[44:47]
  ds_read_b128 a[80:83], v1 offset:512
  ds_read_b128 a[84:87], v1 offset:8704
  v_mfma_f32_16x16x32_bf16 v[76:79], a[8:11], a[88:91], v[76:79]
  v_mfma_f32_16x16x32_bf16 v[76:79], a[12:15], a[92:95], v[76:79]
  v_mfma_f32_16x16x32_bf16 v[108:111], a[16:19], a[88:91], v[108:111]
  v_mfma_f32_16x16x32_bf16 v[108:111], a[20:23], a[92:95], v[108:111]
  v_mfma_f32_16x16x32_bf16 v[140:143], a[24:27], a[88:91], v[140:143]
  v_mfma_f32_16x16x32_bf16 v[140:143], a[28:31], a[92:95], v[140:143]
  s_add_u32 s60, s60, s62
  s_waitcnt lgkmcnt(0)
  v_mfma_f32_16x16x32_bf16 v[16:19], a[32:35], a[64:67], v[16:19]
  v_mfma_f32_16x16x32_bf16 v[16:19], a[36:39], a[68:71], v[16:19]
  ds_read_b128 a[88:91], v1 offset:768
  ds_read_b128 a[92:95], v1 offset:8960
  v_mfma_f32_16x16x32_bf16 v[48:51], a[40:43], a[64:67], v[48:51]
  v_mfma_f32_16x16x32_bf16 v[48:51], a[44:47], a[68:71], v[48:51]
  s_cmp_eq_u32 s60, 147456
  v_mfma_f32_16x16x32_bf16 v[80:83], a[48:51], a[64:67], v[80:83]
  v_mfma_f32_16x16x32_bf16 v[80:83], a[52:55], a[68:71], v[80:83]
  s_cselect_b32 s60, 0, s60
  v_add_u32 v7, s60, v146
  v_mfma_f32_16x16x32_bf16 v[112:115], a[56:59], a[64:67], v[112:115]
  v_mfma_f32_16x16x32_bf16 v[112:115], a[60:63], a[68:71], v[112:115]
  v_mfma_f32_16x16x32_bf16 v[20:23], a[32:35], a[72:75], v[20:23]
  v_mfma_f32_16x16x32_bf16 v[20:23], a[36:39], a[76:79], v[20:23]
  ds_read_b128 a[64:67], v1 offset:1024
  ds_read_b128 a[68:71], v1 offset:9216
  v_mfma_f32_16x16x32_bf16 v[52:55], a[40:43], a[72:75], v[52:55]
  v_mfma_f32_16x16x32_bf16 v[52:55], a[44:47], a[76:79], v[52:55]
  v_mfma_f32_16x16x32_bf16 v[84:87], a[48:51], a[72:75], v[84:87]
  v_mfma_f32_16x16x32_bf16 v[84:87], a[52:55], a[76:79], v[84:87]
  v_mfma_f32_16x16x32_bf16 v[116:119], a[56:59], a[72:75], v[116:119]
  v_mfma_f32_16x16x32_bf16 v[116:119], a[60:63], a[76:79], v[116:119]
  v_mfma_f32_16x16x32_bf16 v[24:27], a[32:35], a[80:83], v[24:27]
  v_mfma_f32_16x16x32_bf16 v[24:27], a[36:39], a[84:87], v[24:27]
  ds_read_b128 a[72:75], v1 offset:1280
  ds_read_b128 a[76:79], v1 offset:9472
  v_mfma_f32_16x16x32_bf16 v[56:59], a[40:43], a[80:83], v[56:59]
  v_mfma_f32_16x16x32_bf16 v[56:59], a[44:47], a[84:87], v[56:59]
  v_mfma_f32_16x16x32_bf16 v[88:91], a[48:51], a[80:83], v[88:91]
  v_mfma_f32_16x16x32_bf16 v[88:91], a[52:55], a[84:87], v[88:91]
  v_mfma_f32_16x16x32_bf16 v[120:123], a[56:59], a[80:83], v[120:123]
  v_mfma_f32_16x16x32_bf16 v[120:123], a[60:63], a[84:87], v[120:123]
  v_add_u32 v5, s60, v144
  s_waitcnt lgkmcnt(0)
  v_mfma_f32_16x16x32_bf16 v[28:31], a[32:35], a[88:91], v[28:31]
  v_mfma_f32_16x16x32_bf16 v[28:31], a[36:39], a[92:95], v[28:31]
  ds_read_b128 a[80:83], v1 offset:1536
  ds_read_b128 a[84:87], v1 offset:9728
  v_mfma_f32_16x16x32_bf16 v[60:63], a[40:43], a[88:91], v[60:63]
  v_mfma_f32_16x16x32_bf16 v[60:63], a[44:47], a[92:95], v[60:63]
  v_add_u32_e64 v6, s60, v145
  v_mfma_f32_16x16x32_bf16 v[92:95], a[48:51], a[88:91], v[92:95]
  v_mfma_f32_16x16x32_bf16 v[92:95], a[52:55], a[92:95], v[92:95]
  v_mfma_f32_16x16x32_bf16 v[124:127], a[56:59], a[88:91], v[124:127]
  v_mfma_f32_16x16x32_bf16 v[124:127], a[60:63], a[92:95], v[124:127]
  v_mfma_f32_16x16x32_bf16 v[32:35], a[32:35], a[64:67], v[32:35]
  v_mfma_f32_16x16x32_bf16 v[32:35], a[36:39], a[68:71], v[32:35]
  ds_read_b128 a[88:91], v1 offset:1792
  ds_read_b128 a[92:95], v1 offset:9984
  v_mfma_f32_16x16x32_bf16 v[64:67], a[40:43], a[64:67], v[64:67]
  v_mfma_f32_16x16x32_bf16 v[64:67], a[44:47], a[68:71], v[64:67]
  v_mfma_f32_16x16x32_bf16 v[96:99], a[48:51], a[64:67], v[96:99]
  v_mfma_f32_16x16x32_bf16 v[96:99], a[52:55], a[68:71], v[96:99]
  v_mfma_f32_16x16x32_bf16 v[128:131], a[56:59], a[64:67], v[128:131]
  v_mfma_f32_16x16x32_bf16 v[128:131], a[60:63], a[68:71], v[128:131]
  s_waitcnt lgkmcnt(0)
  s_barrier
  v_mfma_f32_16x16x32_bf16 v[36:39], a[32:35], a[72:75], v[36:39]
  v_mfma_f32_16x16x32_bf16 v[36:39], a[36:39], a[76:79], v[36:39]
  ds_read_b128 a[64:67], v7 offset:0
  ds_read_b128 a[68:71], v7 offset:8192
  v_mfma_f32_16x16x32_bf16 v[68:71], a[40:43], a[72:75], v[68:71]
  v_mfma_f32_16x16x32_bf16 v[68:71], a[44:47], a[76:79], v[68:71]
  ds_read_b128 a[0:3], v5 offset:0
  ds_read_b128 a[4:7], v6 offset:0
  v_mfma_f32_16x16x32_bf16 v[100:103], a[48:51], a[72:75], v[100:103]
  v_mfma_f32_16x16x32_bf16 v[100:103], a[52:55], a[76:79], v[100:103]
  ds_read_b128 a[8:11], v5 offset:2048
  ds_read_b128 a[12:15], v6 offset:2048
  v_mfma_f32_16x16x32_bf16 v[132:135], a[56:59], a[72:75], v[132:135]
  v_mfma_f32_16x16x32_bf16 v[132:135], a[60:63], a[76:79], v[132:135]
  ds_read_b128 a[16:19], v5 offset:4096
  v_mfma_f32_16x16x32_bf16 v[40:43], a[32:35], a[80:83], v[40:43]
  v_mfma_f32_16x16x32_bf16 v[40:43], a[36:39], a[84:87], v[40:43]
  ds_read_b128 a[72:75], v7 offset:256
  ds_read_b128 a[76:79], v7 offset:8448
  v_mfma_f32_16x16x32_bf16 v[72:75], a[40:43], a[80:83], v[72:75]
  v_mfma_f32_16x16x32_bf16 v[72:75], a[44:47], a[84:87], v[72:75]
  ds_read_b128 a[20:23], v6 offset:4096
  v_mfma_f32_16x16x32_bf16 v[104:107], a[48:51], a[80:83], v[104:107]
  v_mfma_f32_16x16x32_bf16 v[104:107], a[52:55], a[84:87], v[104:107]
  ds_read_b128 a[24:27], v5 offset:6144
  v_mfma_f32_16x16x32_bf16 v[136:139], a[56:59], a[80:83], v[136:139]
  v_mfma_f32_16x16x32_bf16 v[136:139], a[60:63], a[84:87], v[136:139]
  ds_read_b128 a[28:31], v6 offset:6144
  v_mfma_f32_16x16x32_bf16 v[44:47], a[32:35], a[88:91], v[44:47]
  v_mfma_f32_16x16x32_bf16 v[44:47], a[36:39], a[92:95], v[44:47]
  ds_read_b128 a[80:83], v7 offset:512
  ds_read_b128 a[84:87], v7 offset:8704
  v_mfma_f32_16x16x32_bf16 v[76:79], a[40:43], a[88:91], v[76:79]
  v_mfma_f32_16x16x32_bf16 v[76:79], a[44:47], a[92:95], v[76:79]
  v_mfma_f32_16x16x32_bf16 v[108:111], a[48:51], a[88:91], v[108:111]
  v_mfma_f32_16x16x32_bf16 v[108:111], a[52:55], a[92:95], v[108:111]
  v_mfma_f32_16x16x32_bf16 v[140:143], a[56:59], a[88:91], v[140:143]
  v_mfma_f32_16x16x32_bf16 v[140:143], a[60:63], a[92:95], v[140:143]
  s_add_u32 s60, s60, s62
  s_sub_u32 s61, s61, 1
  s_waitcnt lgkmcnt(0)
  s_cbranch_scc0 L_c
  v_mfma_f32_16x16x32_bf16 v[16:19], a[0:3], a[64:67], v[16:19]
  v_mfma_f32_16x16x32_bf16 v[16:19], a[4:7], a[68:71], v[16:19]
  ds_read_b128 a[88:91], v7 offset:768
  ds_read_b128 a[92:95], v7 offset:8960
  v_mfma_f32_16x16x32_bf16 v[48:51], a[8:11], a[64:67], v[48:51]
  v_mfma_f32_16x16x32_bf16 v[48:51], a[12:15], a[68:71], v[48:51]
  v_mfma_f32_16x16x32_bf16 v[80:83], a[16:19], a[64:67], v[80:83]
  v_mfma_f32_16x16x32_bf16 v[80:83], a[20:23], a[68:71], v[80:83]
  v_add_u32 v8, 49152, v144
  v_mfma_f32_16x16x32_bf16 v[112:115], a[24:27], a[64:67], v[112:115]
  v_mfma_f32_16x16x32_bf16 v[112:115], a[28:31], a[68:71], v[112:115]
  v_add_u32 v9, 49152, v145
  v_mfma_f32_16x16x32_bf16 v[20:23], a[0:3], a[72:75], v[20:23]
  v_mfma_f32_16x16x32_bf16 v[20:23], a[4:7], a[76:79], v[20:23]
  ds_read_b128 a[64:67], v7 offset:1024
  ds_read_b128 a[68:71], v7 offset:9216
  v_mfma_f32_16x16x32_bf16 v[52:55], a[8:11], a[72:75], v[52:55]
  v_mfma_f32_16x16x32_bf16 v[52:55], a[12:15], a[76:79], v[52:55]
  v_mfma_f32_16x16x32_bf16 v[84:87], a[16:19], a[72:75], v[84:87]
  v_mfma_f32_16x16x32_bf16 v[84:87], a[20:23], a[76:79], v[84:87]
  v_add_u32 v10, 49152, v146
  v_mfma_f32_16x16x32_bf16 v[116:119], a[24:27], a[72:75], v[116:119]
  v_mfma_f32_16x16x32_bf16 v[116:119], a[28:31], a[76:79], v[116:119]
  v_mfma_f32_16x16x32_bf16 v[24:27], a[0:3], a[80:83], v[24:27]
  v_mfma_f32_16x16x32_bf16 v[24:27], a[4:7], a[84:87], v[24:27]
  v_add_u32 v11, 98304, v144
  ds_read_b128 a[72:75], v7 offset:1280
  ds_read_b128 a[76:79], v7 offset:9472
  v_mfma_f32_16x16x32_bf16 v[56:59], a[8:11], a[80:83], v[56:59]
  v_mfma_f32_16x16x32_bf16 v[56:59], a[12:15], a[84:87], v[56:59]
  v_add_u32 v12, 98304, v145
  v_mfma_f32_16x16x32_bf16 v[88:91], a[16:19], a[80:83], v[88:91]
  v_mfma_f32_16x16x32_bf16 v[88:91], a[20:23], a[84:87], v[88:91]
  v_mfma_f32_16x16x32_bf16 v[120:123], a[24:27], a[80:83], v[120:123]
  v_mfma_f32_16x16x32_bf16 v[120:123], a[28:31], a[84:87], v[120:123]
  s_waitcnt lgkmcnt(0)
  s_nop 0
  v_mfma_f32_16x16x32_bf16 v[28:31], a[0:3], a[88:91], v[28:31]
  v_mfma_f32_16x16x32_bf16 v[28:31], a[4:7], a[92:95], v[28:31]
  v_add_u32 v13, 98304, v146
  ds_read_b128 a[80:83], v7 offset:1536
  ds_read_b128 a[84:87], v7 offset:9728
  v_mfma_f32_16x16x32_bf16 v[60:63], a[8:11], a[88:91], v[60:63]
  v_mfma_f32_16x16x32_bf16 v[60:63], a[12:15], a[92:95], v[60:63]
  v_mfma_f32_16x16x32_bf16 v[92:95], a[16:19], a[88:91], v[92:95]
  v_mfma_f32_16x16x32_bf16 v[92:95], a[20:23], a[92:95], v[92:95]
  v_add_u32_e64 v14, s63, v144
  v_mfma_f32_16x16x32_bf16 v[124:127], a[24:27], a[88:91], v[124:127]
  v_mfma_f32_16x16x32_bf16 v[124:127], a[28:31], a[92:95], v[124:127]
  v_add_u32_e64 v15, s63, v145
  v_mfma_f32_16x16x32_bf16 v[32:35], a[0:3], a[64:67], v[32:35]
  v_mfma_f32_16x16x32_bf16 v[32:35], a[4:7], a[68:71], v[32:35]
  ds_read_b128 a[88:91], v7 offset:1792
  ds_read_b128 a[92:95], v7 offset:9984
  v_mfma_f32_16x16x32_bf16 v[64:67], a[8:11], a[64:67], v[64:67]
  v_mfma_f32_16x16x32_bf16 v[64:67], a[12:15], a[68:71], v[64:67]
  v_mfma_f32_16x16x32_bf16 v[96:99], a[16:19], a[64:67], v[96:99]
  v_mfma_f32_16x16x32_bf16 v[96:99], a[20:23], a[68:71], v[96:99]
  v_mfma_f32_16x16x32_bf16 v[128:131], a[24:27], a[64:67], v[128:131]
  v_mfma_f32_16x16x32_bf16 v[128:131], a[28:31], a[68:71], v[128:131]
  s_waitcnt lgkmcnt(0)
  s_barrier
  v_mfma_f32_16x16x32_bf16 v[36:39], a[0:3], a[72:75], v[36:39]
  v_mfma_f32_16x16x32_bf16 v[36:39], a[4:7], a[76:79], v[36:39]
  v_mfma_f32_16x16x32_bf16 v[68:71], a[8:11], a[72:75], v[68:71]
  v_mfma_f32_16x16x32_bf16 v[68:71], a[12:15], a[76:79], v[68:71]
  v_mfma_f32_16x16x32_bf16 v[100:103], a[16:19], a[72:75], v[100:103]
  v_mfma_f32_16x16x32_bf16 v[100:103], a[20:23], a[76:79], v[100:103]
  v_mfma_f32_16x16x32_bf16 v[132:135], a[24:27], a[72:75], v[132:135]
  v_mfma_f32_16x16x32_bf16 v[132:135], a[28:31], a[76:79], v[132:135]
  v_mfma_f32_16x16x32_bf16 v[40:43], a[0:3], a[80:83], v[40:43]
  v_mfma_f32_16x16x32_bf16 v[40:43], a[4:7], a[84:87], v[40:43]
  ds_read_b128 a[32:35], v10 offset:0
  ds_read_b128 a[36:39], v8 offset:0
  v_mfma_f32_16x16x32_bf16 v[72:75], a[8:11], a[80:83], v[72:75]
  v_mfma_f32_16x16x32_bf16 v[72:75], a[12:15], a[84:87], v[72:75]
  ds_read_b128 a[40:43], v8 offset:2048
  ds_read_b128 a[44:47], v10 offset:256
  v_mfma_f32_16x16x32_bf16 v[104:107], a[16:19], a[80:83], v[104:107]
  v_mfma_f32_16x16x32_bf16 v[104:107], a[20:23], a[84:87], v[104:107]
  ds_read_b128 a[48:51], v10 offset:512
  ds_read_b128 a[52:55], v10 offset:768
  v_mfma_f32_16x16x32_bf16 v[136:139], a[24:27], a[80:83], v[136:139]
  v_mfma_f32_16x16x32_bf16 v[136:139], a[28:31], a[84:87], v[136:139]
  v_mfma_f32_16x16x32_bf16 v[44:47], a[0:3], a[88:91], v[44:47]
  v_mfma_f32_16x16x32_bf16 v[44:47], a[4:7], a[92:95], v[44:47]
  ds_read_b128 a[56:59], v10 offset:8192
  ds_read_b128 a[60:63], v9 offset:0
  v_mfma_f32_16x16x32_bf16 v[76:79], a[8:11], a[88:91], v[76:79]
  v_mfma_f32_16x16x32_bf16 v[76:79], a[12:15], a[92:95], v[76:79]
  ds_read_b128 a[64:67], v9 offset:2048
  ds_read_b128 a[68:71], v10 offset:8448
  v_mfma_f32_16x16x32_bf16 v[108:111], a[16:19], a[88:91], v[108:111]
  v_mfma_f32_16x16x32_bf16 v[108:111], a[20:23], a[92:95], v[108:111]
  ds_read_b128 a[72:75], v10 offset:8704
  ds_read_b128 a[76:79], v10 offset:8960
  v_mfma_f32_16x16x32_bf16 v[140:143], a[24:27], a[88:91], v[140:143]
  v_mfma_f32_16x16x32_bf16 v[140:143], a[28:31], a[92:95], v[140:143]
  s_waitcnt lgkmcnt(4)
  s_nop 0
  v_mfma_f32_16x16x32_bf16 v[16:19], a[36:39], a[32:35], v[16:19]
  s_barrier
  ds_read_b128 a[80:83], v13 offset:0
  ds_read_b128 a[84:87], v11 offset:0
  s_nop 0
  v_mfma_f32_16x16x32_bf16 v[48:51], a[40:43], a[32:35], v[48:51]
  ds_read_b128 a[0:3], v11 offset:2048
  ds_read_b128 a[4:7], v13 offset:256
  v_mfma_f32_16x16x32_bf16 v[20:23], a[36:39], a[44:47], v[20:23]
  ds_read_b128 a[8:11], v13 offset:512
  ds_read_b128 a[12:15], v13 offset:768
  v_mfma_f32_16x16x32_bf16 v[52:55], a[40:43], a[44:47], v[52:55]
  v_mfma_f32_16x16x32_bf16 v[24:27], a[36:39], a[48:51], v[24:27]
  v_mfma_f32_16x16x32_bf16 v[56:59], a[40:43], a[48:51], v[56:59]
  v_mfma_f32_16x16x32_bf16 v[28:31], a[36:39], a[52:55], v[28:31]
  v_mfma_f32_16x16x32_bf16 v[60:63], a[40:43], a[52:55], v[60:63]
  v_mfma_f32_16x16x32_bf16 v[16:19], a[60:63], a[56:59], v[16:19]
  ds_read_b128 a[16:19], v13 offset:8192
  ds_read_b128 a[20:23], v12 offset:0
  s_waitcnt lgkmcnt(2)
  s_nop 0
  v_mfma_f32_16x16x32_bf16 v[48:51], a[64:67], a[56:59], v[48:51]
  ds_read_b128 a[24:27], v12 offset:2048
  ds_read_b128 a[28:31], v13 offset:8448
  v_mfma_f32_16x16x32_bf16 v[20:23], a[60:63], a[68:71], v[20:23]
  ds_read_b128 a[88:91], v13 offset:8704
  ds_read_b128 a[92:95], v13 offset:8960
  v_mfma_f32_16x16x32_bf16 v[52:55], a[64:67], a[68:71], v[52:55]
  v_mfma_f32_16x16x32_bf16 v[24:27], a[60:63], a[72:75], v[24:27]
  v_mfma_f32_16x16x32_bf16 v[56:59], a[64:67], a[72:75], v[56:59]
  v_mfma_f32_16x16x32_bf16 v[28:31], a[60:63], a[76:79], v[28:31]
  v_mfma_f32_16x16x32_bf16 v[60:63], a[64:67], a[76:79], v[60:63]
  v_mfma_f32_16x16x32_bf16 v[16:19], a[84:87], a[80:83], v[16:19]
  s_barrier
  ds_read_b128 a[32:35], v146 offset:0
  ds_read_b128 a[44:47], v14 offset:0
  s_nop 0
  v_mfma_f32_16x16x32_bf16 v[48:51], a[0:3], a[80:83], v[48:51]
  ds_read_b128 a[48:51], v14 offset:2048
  ds_read_b128 a[36:39], v146 offset:256
  v_mfma_f32_16x16x32_bf16 v[20:23], a[84:87], a[4:7], v[20:23]
  ds_read_b128 a[40:43], v146 offset:512
  ds_read_b128 a[52:55], v146 offset:768
  v_mfma_f32_16x16x32_bf16 v[52:55], a[0:3], a[4:7], v[52:55]
  v_mfma_f32_16x16x32_bf16 v[24:27], a[84:87], a[8:11], v[24:27]
  v_mfma_f32_16x16x32_bf16 v[56:59], a[0:3], a[8:11], v[56:59]
  v_mfma_f32_16x16x32_bf16 v[28:31], a[84:87], a[12:15], v[28:31]
  v_mfma_f32_16x16x32_bf16 v[60:63], a[0:3], a[12:15], v[60:63]
  s_waitcnt lgkmcnt(0)
  s_nop 0
  v_mfma_f32_16x16x32_bf16 v[16:19], a[20:23], a[16:19], v[16:19]
  ds_read_b128 a[56:59], v146 offset:8192
  ds_read_b128 a[68:71], v15 offset:0
  v_mfma_f32_16x16x32_bf16 v[48:51], a[24:27], a[16:19], v[48:51]
  ds_read_b128 a[72:75], v15 offset:2048
  ds_read_b128 a[60:63], v146 offset:8448
  v_mfma_f32_16x16x32_bf16 v[20:23], a[20:23], a[28:31], v[20:23]
  ds_read_b128 a[64:67], v146 offset:8704
  ds_read_b128 a[76:79], v146 offset:8960
  v_mfma_f32_16x16x32_bf16 v[52:55], a[24:27], a[28:31], v[52:55]
  v_mfma_f32_16x16x32_bf16 v[24:27], a[20:23], a[88:91], v[24:27]
  v_mfma_f32_16x16x32_bf16 v[56:59], a[24:27], a[88:91], v[56:59]
  v_mfma_f32_16x16x32_bf16 v[28:31], a[20:23], a[92:95], v[28:31]
  v_mfma_f32_16x16x32_bf16 v[60:63], a[24:27], a[92:95], v[60:63]
  v_mfma_f32_16x16x32_bf16 v[16:19], a[44:47], a[32:35], v[16:19]
  ds_read_b128 a[80:83], v10 offset:1024
  ds_read_b128 a[4:7], v8 offset:0
  v_mfma_f32_16x16x32_bf16 v[48:51], a[48:51], a[32:35], v[48:51]
  ds_read_b128 a[8:11], v8 offset:2048
  ds_read_b128 a[84:87], v10 offset:1280
  v_mfma_f32_16x16x32_bf16 v[20:23], a[44:47], a[36:39], v[20:23]
  ds_read_b128 a[0:3], v10 offset:1536
  ds_read_b128 a[12:15], v10 offset:1792
  v_mfma_f32_16x16x32_bf16 v[52:55], a[48:51], a[36:39], v[52:55]
  v_mfma_f32_16x16x32_bf16 v[24:27], a[44:47], a[40:43], v[24:27]
  v_mfma_f32_16x16x32_bf16 v[56:59], a[48:51], a[40:43], v[56:59]
  v_mfma_f32_16x16x32_bf16 v[28:31], a[44:47], a[52:55], v[28:31]
  v_mfma_f32_16x16x32_bf16 v[60:63], a[48:51], a[52:55], v[60:63]
  s_waitcnt lgkmcnt(0)
  s_nop 0
  v_mfma_f32_16x16x32_bf16 v[16:19], a[68:71], a[56:59], v[16:19]
  ds_read_b128 a[16:19], v10 offset:9216
  ds_read_b128 a[28:31], v9 offset:0
  v_mfma_f32_16x16x32_bf16 v[48:51], a[72:75], a[56:59], v[48:51]
  ds_read_b128 a[88:91], v9 offset:2048
  ds_read_b128 a[20:23], v10 offset:9472
  v_mfma_f32_16x16x32_bf16 v[20:23], a[68:71], a[60:63], v[20:23]
  ds_read_b128 a[24:27], v10 offset:9728
  ds_read_b128 a[92:95], v10 offset:9984
  v_mfma_f32_16x16x32_bf16 v[52:55], a[72:75], a[60:63], v[52:55]
  v_mfma_f32_16x16x32_bf16 v[24:27], a[68:71], a[64:67], v[24:27]
  v_mfma_f32_16x16x32_bf16 v[56:59], a[72:75], a[64:67], v[56:59]
  v_mfma_f32_16x16x32_bf16 v[28:31], a[68:71], a[76:79], v[28:31]
  v_mfma_f32_16x16x32_bf16 v[60:63], a[72:75], a[76:79], v[60:63]
  v_mfma_f32_16x16x32_bf16 v[32:35], a[4:7], a[80:83], v[32:35]
  ds_read_b128 a[32:35], v13 offset:1024
  ds_read_b128 a[36:39], v11 offset:0
  v_mfma_f32_16x16x32_bf16 v[64:67], a[8:11], a[80:83], v[64:67]
  ds_read_b128 a[40:43], v11 offset:2048
  ds_read_b128 a[44:47], v13 offset:1280
  v_mfma_f32_16x16x32_bf16 v[36:39], a[4:7], a[84:87], v[36:39]
  v_cvt_pk_bf16_f32 v150, v17, v21
  v_cvt_pk_bf16_f32 v151, v25, v29
  ds_read_b128 a[48:51], v13 offset:1536
  ds_read_b128 a[52:55], v13 offset:1792
  v_mfma_f32_16x16x32_bf16 v[68:71], a[8:11], a[84:87], v[68:71]
  v_cvt_pk_bf16_f32 v148, v16, v20
  v_cvt_pk_bf16_f32 v149, v24, v28
  v_mfma_f32_16x16x32_bf16 v[40:43], a[4:7], a[0:3], v[40:43]
  v_cndmask_b32_dpp v152, v150, v148, vcc quad_perm:[1,0,3,2] row_mask:0xf bank_mask:0xf
  v_cndmask_b32_dpp v153, v151, v149, vcc quad_perm:[1,0,3,2] row_mask:0xf bank_mask:0xf
  v_mfma_f32_16x16x32_bf16 v[72:75], a[8:11], a[0:3], v[72:75]
  s_not_b64 vcc, vcc
  s_nop 0
  v_mfma_f32_16x16x32_bf16 v[44:47], a[4:7], a[12:15], v[44:47]
  v_cndmask_b32_dpp v154, v148, v150, vcc quad_perm:[1,0,3,2] row_mask:0xf bank_mask:0xf
  v_cndmask_b32_dpp v155, v149, v151, vcc quad_perm:[1,0,3,2] row_mask:0xf bank_mask:0xf
  v_mfma_f32_16x16x32_bf16 v[76:79], a[8:11], a[12:15], v[76:79]
  buffer_store_dwordx4 v[152:155], v147, s[32:35], s44 offen offset:0 sc0 sc1
  v_cvt_pk_bf16_f32 v148, v18, v22
  s_waitcnt lgkmcnt(0)
  s_nop 0
  v_mfma_f32_16x16x32_bf16 v[32:35], a[28:31], a[16:19], v[32:35]
  v_cvt_pk_bf16_f32 v149, v26, v30
  v_cvt_pk_bf16_f32 v150, v19, v23
  ds_read_b128 a[56:59], v13 offset:9216
  ds_read_b128 a[60:63], v12 offset:0
  v_mfma_f32_16x16x32_bf16 v[64:67], a[88:91], a[16:19], v[64:67]
  v_cvt_pk_bf16_f32 v151, v27, v31
  ds_read_b128 a[64:67], v12 offset:2048
  ds_read_b128 a[68:71], v13 offset:9472
  v_mfma_f32_16x16x32_bf16 v[36:39], a[28:31], a[20:23], v[36:39]
  v_cndmask_b32_dpp v158, v148, v150, vcc quad_perm:[1,0,3,2] row_mask:0xf bank_mask:0xf
  v_cndmask_b32_dpp v159, v149, v151, vcc quad_perm:[1,0,3,2] row_mask:0xf bank_mask:0xf
  ds_read_b128 a[72:75], v13 offset:9728
  ds_read_b128 a[76:79], v13 offset:9984
  v_mfma_f32_16x16x32_bf16 v[68:71], a[88:91], a[20:23], v[68:71]
  s_not_b64 vcc, vcc
  v_cndmask_b32_dpp v156, v150, v148, vcc quad_perm:[1,0,3,2] row_mask:0xf bank_mask:0xf
  s_nop 0
  v_mfma_f32_16x16x32_bf16 v[40:43], a[28:31], a[24:27], v[40:43]
  v_cndmask_b32_dpp v157, v151, v149, vcc quad_perm:[1,0,3,2] row_mask:0xf bank_mask:0xf
  buffer_store_dwordx4 v[156:159], v147, s[32:35], s46 offen offset:0 sc0 sc1
  v_mfma_f32_16x16x32_bf16 v[72:75], a[88:91], a[24:27], v[72:75]
  v_cvt_pk_bf16_f32 v150, v49, v53
  v_mfma_f32_16x16x32_bf16 v[44:47], a[28:31], a[92:95], v[44:47]
  v_cvt_pk_bf16_f32 v151, v57, v61
  v_cvt_pk_bf16_f32 v148, v48, v52
  v_mfma_f32_16x16x32_bf16 v[76:79], a[88:91], a[92:95], v[76:79]
  v_cvt_pk_bf16_f32 v149, v56, v60
  v_cndmask_b32_dpp v152, v150, v148, vcc quad_perm:[1,0,3,2] row_mask:0xf bank_mask:0xf
  v_mfma_f32_16x16x32_bf16 v[32:35], a[36:39], a[32:35], v[32:35]
  v_cndmask_b32_dpp v153, v151, v149, vcc quad_perm:[1,0,3,2] row_mask:0xf bank_mask:0xf
  s_not_b64 vcc, vcc
  s_barrier
  ds_read_b128 a[80:83], v146 offset:1024
  ds_read_b128 a[84:87], v14 offset:0
  v_mfma_f32_16x16x32_bf16 v[64:67], a[40:43], a[32:35], v[64:67]
  v_cndmask_b32_dpp v154, v148, v150, vcc quad_perm:[1,0,3,2] row_mask:0xf bank_mask:0xf
  ds_read_b128 a[0:3], v14 offset:2048
  ds_read_b128 a[4:7], v146 offset:1280
  v_mfma_f32_16x16x32_bf16 v[36:39], a[36:39], a[44:47], v[36:39]
  v_cndmask_b32_dpp v155, v149, v151, vcc quad_perm:[1,0,3,2] row_mask:0xf bank_mask:0xf
  buffer_store_dwordx4 v[152:155], v147, s[32:35], s48 offen offset:0 sc0 sc1
  ds_read_b128 a[8:11], v146 offset:1536
  ds_read_b128 a[12:15], v146 offset:1792
  v_mfma_f32_16x16x32_bf16 v[68:71], a[40:43], a[44:47], v[68:71]
  v_cvt_pk_bf16_f32 v148, v50, v54
  v_cvt_pk_bf16_f32 v149, v58, v62
  v_mfma_f32_16x16x32_bf16 v[40:43], a[36:39], a[48:51], v[40:43]
  v_cvt_pk_bf16_f32 v150, v51, v55
  v_cvt_pk_bf16_f32 v151, v59, v63
  v_mfma_f32_16x16x32_bf16 v[72:75], a[40:43], a[48:51], v[72:75]
  v_cndmask_b32_dpp v158, v148, v150, vcc quad_perm:[1,0,3,2] row_mask:0xf bank_mask:0xf
  v_mfma_f32_16x16x32_bf16 v[44:47], a[36:39], a[52:55], v[44:47]
  v_cndmask_b32_dpp v159, v149, v151, vcc quad_perm:[1,0,3,2] row_mask:0xf bank_mask:0xf
  s_not_b64 vcc, vcc
  s_nop 0
  v_mfma_f32_16x16x32_bf16 v[76:79], a[40:43], a[52:55], v[76:79]
  v_cndmask_b32_dpp v156, v150, v148, vcc quad_perm:[1,0,3,2] row_mask:0xf bank_mask:0xf
  v_cndmask_b32_dpp v157, v151, v149, vcc quad_perm:[1,0,3,2] row_mask:0xf bank_mask:0xf
  s_waitcnt lgkmcnt(0)
  s_nop 0
  v_mfma_f32_16x16x32_bf16 v[32:35], a[60:63], a[56:59], v[32:35]
  buffer_store_dwordx4 v[156:159], v147, s[32:35], s50 offen offset:0 sc0 sc1
  ds_read_b128 a[16:19], v146 offset:9216
  ds_read_b128 a[20:23], v15 offset:0
  v_mfma_f32_16x16x32_bf16 v[64:67], a[64:67], a[56:59], v[64:67]
  ds_read_b128 a[24:27], v15 offset:2048
  ds_read_b128 a[28:31], v146 offset:9472
  v_mfma_f32_16x16x32_bf16 v[36:39], a[60:63], a[68:71], v[36:39]
  ds_read_b128 a[88:91], v146 offset:9728
  ds_read_b128 a[92:95], v146 offset:9984
  v_mfma_f32_16x16x32_bf16 v[68:71], a[64:67], a[68:71], v[68:71]
  v_mfma_f32_16x16x32_bf16 v[40:43], a[60:63], a[72:75], v[40:43]
  v_mfma_f32_16x16x32_bf16 v[72:75], a[64:67], a[72:75], v[72:75]
  v_mfma_f32_16x16x32_bf16 v[44:47], a[60:63], a[76:79], v[44:47]
  v_mfma_f32_16x16x32_bf16 v[76:79], a[64:67], a[76:79], v[76:79]
  v_mfma_f32_16x16x32_bf16 v[32:35], a[84:87], a[80:83], v[32:35]
  ds_read_b128 a[32:35], v10 offset:0
  ds_read_b128 a[44:47], v8 offset:4096
  v_mfma_f32_16x16x32_bf16 v[64:67], a[0:3], a[80:83], v[64:67]
  ds_read_b128 a[48:51], v8 offset:6144
  ds_read_b128 a[36:39], v10 offset:256
  v_mfma_f32_16x16x32_bf16 v[36:39], a[84:87], a[4:7], v[36:39]
  ds_read_b128 a[40:43], v10 offset:512
  ds_read_b128 a[52:55], v10 offset:768
  v_mfma_f32_16x16x32_bf16 v[68:71], a[0:3], a[4:7], v[68:71]
  v_mfma_f32_16x16x32_bf16 v[40:43], a[84:87], a[8:11], v[40:43]
  v_mfma_f32_16x16x32_bf16 v[72:75], a[0:3], a[8:11], v[72:75]
  v_mfma_f32_16x16x32_bf16 v[44:47], a[84:87], a[12:15], v[44:47]
  v_mfma_f32_16x16x32_bf16 v[76:79], a[0:3], a[12:15], v[76:79]
  s_waitcnt lgkmcnt(0)
  s_nop 0
  v_mfma_f32_16x16x32_bf16 v[32:35], a[20:23], a[16:19], v[32:35]
  ds_read_b128 a[56:59], v10 offset:8192
  ds_read_b128 a[68:71], v9 offset:4096
  v_mfma_f32_16x16x32_bf16 v[64:67], a[24:27], a[16:19], v[64:67]
  ds_read_b128 a[72:75], v9 offset:6144
  ds_read_b128 a[60:63], v10 offset:8448
  v_mfma_f32_16x16x32_bf16 v[36:39], a[20:23], a[28:31], v[36:39]
  ds_read_b128 a[64:67], v10 offset:8704
  ds_read_b128 a[76:79], v10 offset:8960
  v_mfma_f32_16x16x32_bf16 v[68:71], a[24:27], a[28:31], v[68:71]
  v_mfma_f32_16x16x32_bf16 v[40:43], a[20:23], a[88:91], v[40:43]
  v_mfma_f32_16x16x32_bf16 v[72:75], a[24:27], a[88:91], v[72:75]
  v_mfma_f32_16x16x32_bf16 v[44:47], a[20:23], a[92:95], v[44:47]
  v_mfma_f32_16x16x32_bf16 v[76:79], a[24:27], a[92:95], v[76:79]
  v_mfma_f32_16x16x32_bf16 v[80:83], a[44:47], a[32:35], v[80:83]
  ds_read_b128 a[80:83], v13 offset:0
  ds_read_b128 a[4:7], v11 offset:4096
  v_mfma_f32_16x16x32_bf16 v[112:115], a[48:51], a[32:35], v[112:115]
  ds_read_b128 a[8:11], v11 offset:6144
  ds_read_b128 a[84:87], v13 offset:256
  v_mfma_f32_16x16x32_bf16 v[84:87], a[44:47], a[36:39], v[84:87]
  v_cvt_pk_bf16_f32 v150, v33, v37
  v_cvt_pk_bf16_f32 v151, v41, v45
  ds_read_b128 a[0:3], v13 offset:512
  ds_read_b128 a[12:15], v13 offset:768
  v_mfma_f32_16x16x32_bf16 v[116:119], a[48:51], a[36:39], v[116:119]
  v_cvt_pk_bf16_f32 v148, v32, v36
  v_cvt_pk_bf16_f32 v149, v40, v44
  v_mfma_f32_16x16x32_bf16 v[88:91], a[44:47], a[40:43], v[88:91]
  v_cndmask_b32_dpp v152, v150, v148, vcc quad_perm:[1,0,3,2] row_mask:0xf bank_mask:0xf
  v_cndmask_b32_dpp v153, v151, v149, vcc quad_perm:[1,0,3,2] row_mask:0xf bank_mask:0xf
  v_mfma_f32_16x16x32_bf16 v[120:123], a[48:51], a[40:43], v[120:123]
  s_not_b64 vcc, vcc
  s_nop 0
  v_mfma_f32_16x16x32_bf16 v[92:95], a[44:47], a[52:55], v[92:95]
  v_cndmask_b32_dpp v154, v148, v150, vcc quad_perm:[1,0,3,2] row_mask:0xf bank_mask:0xf
  v_cndmask_b32_dpp v155, v149, v151, vcc quad_perm:[1,0,3,2] row_mask:0xf bank_mask:0xf
  v_mfma_f32_16x16x32_bf16 v[124:127], a[48:51], a[52:55], v[124:127]
  buffer_store_dwordx4 v[152:155], v147, s[32:35], s44 offen offset:128 sc0 sc1
  v_cvt_pk_bf16_f32 v148, v34, v38
  s_waitcnt lgkmcnt(0)
  s_nop 0
  v_mfma_f32_16x16x32_bf16 v[80:83], a[68:71], a[56:59], v[80:83]
  v_cvt_pk_bf16_f32 v149, v42, v46
  v_cvt_pk_bf16_f32 v150, v35, v39
  ds_read_b128 a[16:19], v13 offset:8192
  ds_read_b128 a[28:31], v12 offset:4096
  v_mfma_f32_16x16x32_bf16 v[112:115], a[72:75], a[56:59], v[112:115]
  v_cvt_pk_bf16_f32 v151, v43, v47
  ds_read_b128 a[88:91], v12 offset:6144
  ds_read_b128 a[20:23], v13 offset:8448
  v_mfma_f32_16x16x32_bf16 v[84:87], a[68:71], a[60:63], v[84:87]
  v_cndmask_b32_dpp v158, v148, v150, vcc quad_perm:[1,0,3,2] row_mask:0xf bank_mask:0xf
  v_cndmask_b32_dpp v159, v149, v151, vcc quad_perm:[1,0,3,2] row_mask:0xf bank_mask:0xf
  ds_read_b128 a[24:27], v13 offset:8704
  ds_read_b128 a[92:95], v13 offset:8960
  v_mfma_f32_16x16x32_bf16 v[116:119], a[72:75], a[60:63], v[116:119]
  s_not_b64 vcc, vcc
  v_cndmask_b32_dpp v156, v150, v148, vcc quad_perm:[1,0,3,2] row_mask:0xf bank_mask:0xf
  s_nop 0
  v_mfma_f32_16x16x32_bf16 v[88:91], a[68:71], a[64:67], v[88:91]
  v_cndmask_b32_dpp v157, v151, v149, vcc quad_perm:[1,0,3,2] row_mask:0xf bank_mask:0xf
  buffer_store_dwordx4 v[156:159], v147, s[32:35], s46 offen offset:128 sc0 sc1
  v_mfma_f32_16x16x32_bf16 v[120:123], a[72:75], a[64:67], v[120:123]
  v_cvt_pk_bf16_f32 v150, v65, v69
  v_mfma_f32_16x16x32_bf16 v[92:95], a[68:71], a[76:79], v[92:95]
  v_cvt_pk_bf16_f32 v151, v73, v77
  v_cvt_pk_bf16_f32 v148, v64, v68
  v_mfma_f32_16x16x32_bf16 v[124:127], a[72:75], a[76:79], v[124:127]
  v_cvt_pk_bf16_f32 v149, v72, v76
  v_cndmask_b32_dpp v152, v150, v148, vcc quad_perm:[1,0,3,2] row_mask:0xf bank_mask:0xf
  v_mfma_f32_16x16x32_bf16 v[80:83], a[4:7], a[80:83], v[80:83]
  v_cndmask_b32_dpp v153, v151, v149, vcc quad_perm:[1,0,3,2] row_mask:0xf bank_mask:0xf
  s_not_b64 vcc, vcc
  ds_read_b128 a[32:35], v146 offset:0
  ds_read_b128 a[36:39], v144 offset:4096
  s_nop 0
  v_mfma_f32_16x16x32_bf16 v[112:115], a[8:11], a[80:83], v[112:115]
  v_cndmask_b32_dpp v154, v148, v150, vcc quad_perm:[1,0,3,2] row_mask:0xf bank_mask:0xf
  ds_read_b128 a[40:43], v144 offset:6144
  ds_read_b128 a[44:47], v146 offset:256
  v_mfma_f32_16x16x32_bf16 v[84:87], a[4:7], a[84:87], v[84:87]
  v_cndmask_b32_dpp v155, v149, v151, vcc quad_perm:[1,0,3,2] row_mask:0xf bank_mask:0xf
  buffer_store_dwordx4 v[152:155], v147, s[32:35], s48 offen offset:128 sc0 sc1
  ds_read_b128 a[48:51], v146 offset:512
  ds_read_b128 a[52:55], v146 offset:768
  v_mfma_f32_16x16x32_bf16 v[116:119], a[8:11], a[84:87], v[116:119]
  v_cvt_pk_bf16_f32 v148, v66, v70
  v_cvt_pk_bf16_f32 v149, v74, v78
  v_mfma_f32_16x16x32_bf16 v[88:91], a[4:7], a[0:3], v[88:91]
  v_cvt_pk_bf16_f32 v150, v67, v71
  v_cvt_pk_bf16_f32 v151, v75, v79
  v_mfma_f32_16x16x32_bf16 v[120:123], a[8:11], a[0:3], v[120:123]
  v_cndmask_b32_dpp v158, v148, v150, vcc quad_perm:[1,0,3,2] row_mask:0xf bank_mask:0xf
  v_mfma_f32_16x16x32_bf16 v[92:95], a[4:7], a[12:15], v[92:95]
  v_cndmask_b32_dpp v159, v149, v151, vcc quad_perm:[1,0,3,2] row_mask:0xf bank_mask:0xf
  s_not_b64 vcc, vcc
  s_nop 0
  v_mfma_f32_16x16x32_bf16 v[124:127], a[8:11], a[12:15], v[124:127]
  v_cndmask_b32_dpp v156, v150, v148, vcc quad_perm:[1,0,3,2] row_mask:0xf bank_mask:0xf
  v_cndmask_b32_dpp v157, v151, v149, vcc quad_perm:[1,0,3,2] row_mask:0xf bank_mask:0xf
  s_waitcnt lgkmcnt(0)
  s_nop 0
  v_mfma_f32_16x16x32_bf16 v[80:83], a[28:31], a[16:19], v[80:83]
  buffer_store_dwordx4 v[156:159], v147, s[32:35], s50 offen offset:128 sc0 sc1
  ds_read_b128 a[56:59], v146 offset:8192
  ds_read_b128 a[60:63], v145 offset:4096
  v_mfma_f32_16x16x32_bf16 v[112:115], a[88:91], a[16:19], v[112:115]
  ds_read_b128 a[64:67], v145 offset:6144
  ds_read_b128 a[68:71], v146 offset:8448
  v_mfma_f32_16x16x32_bf16 v[84:87], a[28:31], a[20:23], v[84:87]
  ds_read_b128 a[72:75], v146 offset:8704
  ds_read_b128 a[76:79], v146 offset:8960
  v_mfma_f32_16x16x32_bf16 v[116:119], a[88:91], a[20:23], v[116:119]
  v_mfma_f32_16x16x32_bf16 v[88:91], a[28:31], a[24:27], v[88:91]
  v_mfma_f32_16x16x32_bf16 v[120:123], a[88:91], a[24:27], v[120:123]
  v_mfma_f32_16x16x32_bf16 v[92:95], a[28:31], a[92:95], v[92:95]
  v_mfma_f32_16x16x32_bf16 v[124:127], a[88:91], a[92:95], v[124:127]
  v_mfma_f32_16x16x32_bf16 v[80:83], a[36:39], a[32:35], v[80:83]
  ds_read_b128 a[80:83], v10 offset:1024
  ds_read_b128 a[84:87], v8 offset:4096
  v_mfma_f32_16x16x32_bf16 v[112:115], a[40:43], a[32:35], v[112:115]
  ds_read_b128 a[0:3], v8 offset:6144
  ds_read_b128 a[4:7], v10 offset:1280
  v_mfma_f32_16x16x32_bf16 v[84:87], a[36:39], a[44:47], v[84:87]
  ds_read_b128 a[8:11], v10 offset:1536
  ds_read_b128 a[12:15], v10 offset:1792
  v_mfma_f32_16x16x32_bf16 v[116:119], a[40:43], a[44:47], v[116:119]
  v_mfma_f32_16x16x32_bf16 v[88:91], a[36:39], a[48:51], v[88:91]
  v_mfma_f32_16x16x32_bf16 v[120:123], a[40:43], a[48:51], v[120:123]
  v_mfma_f32_16x16x32_bf16 v[92:95], a[36:39], a[52:55], v[92:95]
  v_mfma_f32_16x16x32_bf16 v[124:127], a[40:43], a[52:55], v[124:127]
  s_waitcnt lgkmcnt(0)
  s_nop 0
  v_mfma_f32_16x16x32_bf16 v[80:83], a[60:63], a[56:59], v[80:83]
  ds_read_b128 a[16:19], v10 offset:9216
  ds_read_b128 a[20:23], v9 offset:4096
  v_mfma_f32_16x16x32_bf16 v[112:115], a[64:67], a[56:59], v[112:115]
  ds_read_b128 a[24:27], v9 offset:6144
  ds_read_b128 a[28:31], v10 offset:9472
  v_mfma_f32_16x16x32_bf16 v[84:87], a[60:63], a[68:71], v[84:87]
  ds_read_b128 a[88:91], v10 offset:9728
  ds_read_b128 a[92:95], v10 offset:9984
  v_mfma_f32_16x16x32_bf16 v[116:119], a[64:67], a[68:71], v[116:119]
  v_mfma_f32_16x16x32_bf16 v[88:91], a[60:63], a[72:75], v[88:91]
  v_mfma_f32_16x16x32_bf16 v[120:123], a[64:67], a[72:75], v[120:123]
  v_mfma_f32_16x16x32_bf16 v[92:95], a[60:63], a[76:79], v[92:95]
  v_mfma_f32_16x16x32_bf16 v[124:127], a[64:67], a[76:79], v[124:127]
  v_mfma_f32_16x16x32_bf16 v[96:99], a[84:87], a[80:83], v[96:99]
  ds_read_b128 a[32:35], v13 offset:1024
  ds_read_b128 a[44:47], v11 offset:4096
  v_mfma_f32_16x16x32_bf16 v[128:131], a[0:3], a[80:83], v[128:131]
  ds_read_b128 a[48:51], v11 offset:6144
  ds_read_b128 a[36:39], v13 offset:1280
  v_mfma_f32_16x16x32_bf16 v[100:103], a[84:87], a[4:7], v[100:103]
  v_cvt_pk_bf16_f32 v150, v81, v85
  v_cvt_pk_bf16_f32 v151, v89, v93
  ds_read_b128 a[40:43], v13 offset:1536
  ds_read_b128 a[52:55], v13 offset:1792
  v_mfma_f32_16x16x32_bf16 v[132:135], a[0:3], a[4:7], v[132:135]
  v_cvt_pk_bf16_f32 v148, v80, v84
  v_cvt_pk_bf16_f32 v149, v88, v92
  v_mfma_f32_16x16x32_bf16 v[104:107], a[84:87], a[8:11], v[104:107]
  v_cndmask_b32_dpp v152, v150, v148, vcc quad_perm:[1,0,3,2] row_mask:0xf bank_mask:0xf
  v_cndmask_b32_dpp v153, v151, v149, vcc quad_perm:[1,0,3,2] row_mask:0xf bank_mask:0xf
  v_mfma_f32_16x16x32_bf16 v[136:139], a[0:3], a[8:11], v[136:139]
  s_not_b64 vcc, vcc
  s_nop 0
  v_mfma_f32_16x16x32_bf16 v[108:111], a[84:87], a[12:15], v[108:111]
  v_cndmask_b32_dpp v154, v148, v150, vcc quad_perm:[1,0,3,2] row_mask:0xf bank_mask:0xf
  v_cndmask_b32_dpp v155, v149, v151, vcc quad_perm:[1,0,3,2] row_mask:0xf bank_mask:0xf
  v_mfma_f32_16x16x32_bf16 v[140:143], a[0:3], a[12:15], v[140:143]
  buffer_store_dwordx4 v[152:155], v147, s[32:35], s52 offen offset:0 sc0 sc1
  v_cvt_pk_bf16_f32 v148, v82, v86
  s_waitcnt lgkmcnt(0)
  s_nop 0
  v_mfma_f32_16x16x32_bf16 v[96:99], a[20:23], a[16:19], v[96:99]
  v_cvt_pk_bf16_f32 v149, v90, v94
  v_cvt_pk_bf16_f32 v150, v83, v87
  ds_read_b128 a[56:59], v13 offset:9216
  ds_read_b128 a[68:71], v12 offset:4096
  v_mfma_f32_16x16x32_bf16 v[128:131], a[24:27], a[16:19], v[128:131]
  v_cvt_pk_bf16_f32 v151, v91, v95
  ds_read_b128 a[72:75], v12 offset:6144
  ds_read_b128 a[60:63], v13 offset:9472
  v_mfma_f32_16x16x32_bf16 v[100:103], a[20:23], a[28:31], v[100:103]
  v_cndmask_b32_dpp v158, v148, v150, vcc quad_perm:[1,0,3,2] row_mask:0xf bank_mask:0xf
  v_cndmask_b32_dpp v159, v149, v151, vcc quad_perm:[1,0,3,2] row_mask:0xf bank_mask:0xf
  ds_read_b128 a[64:67], v13 offset:9728
  ds_read_b128 a[76:79], v13 offset:9984
  v_mfma_f32_16x16x32_bf16 v[132:135], a[24:27], a[28:31], v[132:135]
  s_not_b64 vcc, vcc
  v_cndmask_b32_dpp v156, v150, v148, vcc quad_perm:[1,0,3,2] row_mask:0xf bank_mask:0xf
  s_nop 0
  v_mfma_f32_16x16x32_bf16 v[104:107], a[20:23], a[88:91], v[104:107]
  v_cndmask_b32_dpp v157, v151, v149, vcc quad_perm:[1,0,3,2] row_mask:0xf bank_mask:0xf
  buffer_store_dwordx4 v[156:159], v147, s[32:35], s54 offen offset:0 sc0 sc1
  v_mfma_f32_16x16x32_bf16 v[136:139], a[24:27], a[88:91], v[136:139]
  v_cvt_pk_bf16_f32 v150, v113, v117
  v_mfma_f32_16x16x32_bf16 v[108:111], a[20:23], a[92:95], v[108:111]
  v_cvt_pk_bf16_f32 v151, v121, v125
  v_cvt_pk_bf16_f32 v148, v112, v116
  v_mfma_f32_16x16x32_bf16 v[140:143], a[24:27], a[92:95], v[140:143]
  v_cvt_pk_bf16_f32 v149, v120, v124
  v_cndmask_b32_dpp v152, v150, v148, vcc quad_perm:[1,0,3,2] row_mask:0xf bank_mask:0xf
  v_mfma_f32_16x16x32_bf16 v[96:99], a[44:47], a[32:35], v[96:99]
  v_cndmask_b32_dpp v153, v151, v149, vcc quad_perm:[1,0,3,2] row_mask:0xf bank_mask:0xf
  s_not_b64 vcc, vcc
  ds_read_b128 a[80:83], v146 offset:1024
  ds_read_b128 a[4:7], v144 offset:4096
  s_nop 0
  v_mfma_f32_16x16x32_bf16 v[128:131], a[48:51], a[32:35], v[128:131]
  v_cndmask_b32_dpp v154, v148, v150, vcc quad_perm:[1,0,3,2] row_mask:0xf bank_mask:0xf
  ds_read_b128 a[8:11], v144 offset:6144
  ds_read_b128 a[84:87], v146 offset:1280
  v_mfma_f32_16x16x32_bf16 v[100:103], a[44:47], a[36:39], v[100:103]
  v_cndmask_b32_dpp v155, v149, v151, vcc quad_perm:[1,0,3,2] row_mask:0xf bank_mask:0xf
  buffer_store_dwordx4 v[152:155], v147, s[32:35], s56 offen offset:0 sc0 sc1
  ds_read_b128 a[0:3], v146 offset:1536
  ds_read_b128 a[12:15], v146 offset:1792
  v_mfma_f32_16x16x32_bf16 v[132:135], a[48:51], a[36:39], v[132:135]
  v_cvt_pk_bf16_f32 v148, v114, v118
  v_cvt_pk_bf16_f32 v149, v122, v126
  v_mfma_f32_16x16x32_bf16 v[104:107], a[44:47], a[40:43], v[104:107]
  v_cvt_pk_bf16_f32 v150, v115, v119
  v_cvt_pk_bf16_f32 v151, v123, v127
  v_mfma_f32_16x16x32_bf16 v[136:139], a[48:51], a[40:43], v[136:139]
  v_cndmask_b32_dpp v158, v148, v150, vcc quad_perm:[1,0,3,2] row_mask:0xf bank_mask:0xf
  v_mfma_f32_16x16x32_bf16 v[108:111], a[44:47], a[52:55], v[108:111]
  v_cndmask_b32_dpp v159, v149, v151, vcc quad_perm:[1,0,3,2] row_mask:0xf bank_mask:0xf
  s_not_b64 vcc, vcc
  s_nop 0
  v_mfma_f32_16x16x32_bf16 v[140:143], a[48:51], a[52:55], v[140:143]
  v_cndmask_b32_dpp v156, v150, v148, vcc quad_perm:[1,0,3,2] row_mask:0xf bank_mask:0xf
  v_cndmask_b32_dpp v157, v151, v149, vcc quad_perm:[1,0,3,2] row_mask:0xf bank_mask:0xf
  s_waitcnt lgkmcnt(0)
  s_nop 0
  v_mfma_f32_16x16x32_bf16 v[96:99], a[68:71], a[56:59], v[96:99]
  buffer_store_dwordx4 v[156:159], v147, s[32:35], s58 offen offset:0 sc0 sc1
  ds_read_b128 a[16:19], v146 offset:9216
  ds_read_b128 a[28:31], v145 offset:4096
  v_mfma_f32_16x16x32_bf16 v[128:131], a[72:75], a[56:59], v[128:131]
  ds_read_b128 a[88:91], v146 offset:9472
  ds_read_b128 a[20:23], v145 offset:6144
  v_mfma_f32_16x16x32_bf16 v[100:103], a[68:71], a[60:63], v[100:103]
  ds_read_b128 a[24:27], v146 offset:9728
  ds_read_b128 a[92:95], v146 offset:9984
  v_mfma_f32_16x16x32_bf16 v[132:135], a[72:75], a[60:63], v[132:135]
  v_mfma_f32_16x16x32_bf16 v[104:107], a[68:71], a[64:67], v[104:107]
  v_mfma_f32_16x16x32_bf16 v[136:139], a[72:75], a[64:67], v[136:139]
  v_mfma_f32_16x16x32_bf16 v[108:111], a[68:71], a[76:79], v[108:111]
  v_mfma_f32_16x16x32_bf16 v[140:143], a[72:75], a[76:79], v[140:143]
  v_mfma_f32_16x16x32_bf16 v[96:99], a[4:7], a[80:83], v[96:99]
  v_mfma_f32_16x16x32_bf16 v[128:131], a[8:11], a[80:83], v[128:131]
  v_mfma_f32_16x16x32_bf16 v[100:103], a[4:7], a[84:87], v[100:103]
  v_mfma_f32_16x16x32_bf16 v[132:135], a[8:11], a[84:87], v[132:135]
  v_mfma_f32_16x16x32_bf16 v[104:107], a[4:7], a[0:3], v[104:107]
  v_mfma_f32_16x16x32_bf16 v[136:139], a[8:11], a[0:3], v[136:139]
  v_mfma_f32_16x16x32_bf16 v[108:111], a[4:7], a[12:15], v[108:111]
  v_mfma_f32_16x16x32_bf16 v[140:143], a[8:11], a[12:15], v[140:143]
  s_waitcnt lgkmcnt(0)
  s_nop 0
  v_mfma_f32_16x16x32_bf16 v[96:99], a[28:31], a[16:19], v[96:99]
  v_mfma_f32_16x16x32_bf16 v[100:103], a[28:31], a[88:91], v[100:103]
  v_mfma_f32_16x16x32_bf16 v[104:107], a[28:31], a[24:27], v[104:107]
  v_mfma_f32_16x16x32_bf16 v[108:111], a[28:31], a[92:95], v[108:111]
  v_mfma_f32_16x16x32_bf16 v[128:131], a[20:23], a[16:19], v[128:131]
  v_mfma_f32_16x16x32_bf16 v[132:135], a[20:23], a[88:91], v[132:135]
  v_mfma_f32_16x16x32_bf16 v[136:139], a[20:23], a[24:27], v[136:139]
  v_mfma_f32_16x16x32_bf16 v[140:143], a[20:23], a[92:95], v[140:143]
  s_nop 7
L_fin:
  v_cvt_pk_bf16_f32 v150, v97, v101
  v_cvt_pk_bf16_f32 v151, v105, v109
  v_cvt_pk_bf16_f32 v148, v96, v100
  v_cvt_pk_bf16_f32 v149, v104, v108
  v_cndmask_b32_dpp v152, v150, v148, vcc quad_perm:[1,0,3,2] row_mask:0xf bank_mask:0xf
  v_cndmask_b32_dpp v153, v151, v149, vcc quad_perm:[1,0,3,2] row_mask:0xf bank_mask:0xf
  s_not_b64 vcc, vcc
  v_cndmask_b32_dpp v154, v148, v150, vcc quad_perm:[1,0,3,2] row_mask:0xf bank_mask:0xf
  v_cndmask_b32_dpp v155, v149, v151, vcc quad_perm:[1,0,3,2] row_mask:0xf bank_mask:0xf
  buffer_store_dwordx4 v[152:155], v147, s[32:35], s52 offen offset:128 sc0 sc1
  v_cvt_pk_bf16_f32 v148, v98, v102
  v_cvt_pk_bf16_f32 v149, v106, v110
  v_cvt_pk_bf16_f32 v150, v99, v103
  v_cvt_pk_bf16_f32 v151, v107, v111
  v_cndmask_b32_dpp v158, v148, v150, vcc quad_perm:[1,0,3,2] row_mask:0xf bank_mask:0xf
  v_cndmask_b32_dpp v159, v149, v151, vcc quad_perm:[1,0,3,2] row_mask:0xf bank_mask:0xf
  s_not_b64 vcc, vcc
  v_cndmask_b32_dpp v156, v150, v148, vcc quad_perm:[1,0,3,2] row_mask:0xf bank_mask:0xf
  v_cndmask_b32_dpp v157, v151, v149, vcc quad_perm:[1,0,3,2] row_mask:0xf bank_mask:0xf
  buffer_store_dwordx4 v[156:159], v147, s[32:35], s54 offen offset:128 sc0 sc1
  v_cvt_pk_bf16_f32 v150, v129, v133
  v_cvt_pk_bf16_f32 v151, v137, v141
  v_cvt_pk_bf16_f32 v148, v128, v132
  v_cvt_pk_bf16_f32 v149, v136, v140
  v_cndmask_b32_dpp v152, v150, v148, vcc quad_perm:[1,0,3,2] row_mask:0xf bank_mask:0xf
  v_cndmask_b32_dpp v153, v151, v149, vcc quad_perm:[1,0,3,2] row_mask:0xf bank_mask:0xf
  s_not_b64 vcc, vcc
  v_cndmask_b32_dpp v154, v148, v150, vcc quad_perm:[1,0,3,2] row_mask:0xf bank_mask:0xf
  v_cndmask_b32_dpp v155, v149, v151, vcc quad_perm:[1,0,3,2] row_mask:0xf bank_mask:0xf
  buffer_store_dwordx4 v[152:155], v147, s[32:35], s56 offen offset:128 sc0 sc1
  v_cvt_pk_bf16_f32 v148, v130, v134
  v_cvt_pk_bf16_f32 v149, v138, v142
  v_cvt_pk_bf16_f32 v150, v131, v135
  v_cvt_pk_bf16_f32 v151, v139, v143
  v_cndmask_b32_dpp v158, v148, v150, vcc quad_perm:[1,0,3,2] row_mask:0xf bank_mask:0xf
  v_cndmask_b32_dpp v159, v149, v151, vcc quad_perm:[1,0,3,2] row_mask:0xf bank_mask:0xf
  s_not_b64 vcc, vcc
  v_cndmask_b32_dpp v156, v150, v148, vcc quad_perm:[1,0,3,2] row_mask:0xf bank_mask:0xf
  v_cndmask_b32_dpp v157, v151, v149, vcc quad_perm:[1,0,3,2] row_mask:0xf bank_mask:0xf
  buffer_store_dwordx4 v[156:159], v147, s[32:35], s58 offen offset:128 sc0 sc1
  s_endpgm
L_loader:
  s_add_u32 s58, s40, 2
  s_lshl_b32 s58, s58, 7
  s_load_dword s68, s[12:13], s58 offset:0
  s_load_dword s69, s[12:13], s58 offset:64
  s_load_dword s70, s[12:13], s58 offset:2048
  s_load_dword s71, s[12:13], s58 offset:2112
  s_load_dword s72, s[12:13], s58 offset:4096
  s_load_dword s73, s[12:13], s58 offset:4160
  s_waitcnt vmcnt(0)
  s_mov_b64 exec, 1
  buffer_store_dwordx2 v[10:11], v14, s[28:31], 0 offen sc1
  s_mov_b64 exec, -1
  s_barrier
  s_add_u32 s43, s40, 0
  s_lshl_b32 s43, s43, 9
  s_load_dwordx4 s[64:67], s[4:5], s43 glc
  s_add_u32 s41, s40, 0
  s_lshl_b32 s41, s41, 7
  s_add_u32 m0, s60, 49152
  s_nop 0
  buffer_load_dwordx4 v16, s[16:19], s41 offen offset:0 lds
  buffer_load_dwordx4 v17, s[16:19], s41 offen offset:1024 lds
  buffer_load_dwordx4 v18, s[16:19], s41 offen offset:2048 lds
  buffer_load_dwordx4 v19, s[16:19], s41 offen offset:3072 lds
  s_add_u32 m0, s60, 53248
  s_add_u32 s41, s41, 65536
  buffer_load_dwordx4 v16, s[16:19], s41 offen offset:0 lds
  buffer_load_dwordx4 v17, s[16:19], s41 offen offset:1024 lds
  buffer_load_dwordx4 v18, s[16:19], s41 offen offset:2048 lds
  buffer_load_dwordx4 v19, s[16:19], s41 offen offset:3072 lds
  s_mov_b32 s63, 0
L_sp1:
  s_waitcnt lgkmcnt(0)
  s_xor_b64 s[10:11], s[64:65], s[8:9]
  s_xor_b64 s[14:15], s[66:67], s[8:9]
  s_or_b64 s[10:11], s[10:11], s[14:15]
  s_cbranch_scc0 L_ok1
  s_load_dwordx4 s[64:67], s[4:5], s43 glc
  s_add_u32 s63, s63, 1
  s_cmp_lt_u32 s63, 20000
  s_cbranch_scc1 L_sp1
  s_waitcnt lgkmcnt(0)
L_ok1:
  s_add_u32 s43, s40, 1
  s_lshl_b32 s43, s43, 9
  s_load_dwordx4 s[64:67], s[4:5], s43 glc
  s_add_u32 m0, s61, 49152
  s_add_u32 s62, s40, 0
  s_lshl_b32 s62, s62, 14
  buffer_load_dwordx4 v20, s[28:31], s62 offen offset:0 sc1 lds
  buffer_load_dwordx4 v20, s[28:31], s62 offen offset:1024 sc1 lds
  buffer_load_dwordx4 v20, s[28:31], s62 offen offset:2048 sc1 lds
  buffer_load_dwordx4 v20, s[28:31], s62 offen offset:3072 sc1 lds
  s_add_u32 s41, s40, 1
  s_lshl_b32 s41, s41, 7
  s_add_u32 m0, s60, 98304
  s_nop 0
  buffer_load_dwordx4 v16, s[16:19], s41 offen offset:0 lds
  buffer_load_dwordx4 v17, s[16:19], s41 offen offset:1024 lds
  buffer_load_dwordx4 v18, s[16:19], s41 offen offset:2048 lds
  buffer_load_dwordx4 v19, s[16:19], s41 offen offset:3072 lds
  s_add_u32 m0, s60, 102400
  s_add_u32 s41, s41, 65536
  buffer_load_dwordx4 v16, s[16:19], s41 offen offset:0 lds
  buffer_load_dwordx4 v17, s[16:19], s41 offen offset:1024 lds
  buffer_load_dwordx4 v18, s[16:19], s41 offen offset:2048 lds
  buffer_load_dwordx4 v19, s[16:19], s41 offen offset:3072 lds
  s_mov_b32 s63, 0
L_sp2:
  s_waitcnt lgkmcnt(0)
  s_xor_b64 s[10:11], s[64:65], s[8:9]
  s_xor_b64 s[14:15], s[66:67], s[8:9]
  s_or_b64 s[10:11], s[10:11], s[14:15]
  s_cbranch_scc0 L_ok2
  s_load_dwordx4 s[64:67], s[4:5], s43 glc
  s_add_u32 s63, s63, 1
  s_cmp_lt_u32 s63, 20000
  s_cbranch_scc1 L_sp2
  s_waitcnt lgkmcnt(0)
L_ok2:
  s_add_u32 s43, s40, 2
  s_lshl_b32 s43, s43, 9
  s_load_dwordx4 s[64:67], s[4:5], s43 glc
  s_add_u32 m0, s61, 98304
  s_add_u32 s62, s40, 1
  s_lshl_b32 s62, s62, 14
  buffer_load_dwordx4 v20, s[28:31], s62 offen offset:0 sc1 lds
  buffer_load_dwordx4 v20, s[28:31], s62 offen offset:1024 sc1 lds
  buffer_load_dwordx4 v20, s[28:31], s62 offen offset:2048 sc1 lds
  buffer_load_dwordx4 v20, s[28:31], s62 offen offset:3072 sc1 lds
  s_add_u32 s58, s40, 3
  s_lshl_b32 s58, s58, 7
  s_load_dword s68, s[12:13], s58 offset:0
  s_load_dword s69, s[12:13], s58 offset:64
  s_load_dword s70, s[12:13], s58 offset:2048
  s_load_dword s71, s[12:13], s58 offset:2112
  s_load_dword s72, s[12:13], s58 offset:4096
  s_load_dword s73, s[12:13], s58 offset:4160
  s_waitcnt vmcnt(12)
  s_barrier
  s_add_u32 s41, s40, 2
  s_lshl_b32 s41, s41, 7
  s_add_u32 m0, s60, 0
  s_nop 0
  buffer_load_dwordx4 v16, s[16:19], s41 offen offset:0 lds
  buffer_load_dwordx4 v17, s[16:19], s41 offen offset:1024 lds
  buffer_load_dwordx4 v18, s[16:19], s41 offen offset:2048 lds
  buffer_load_dwordx4 v19, s[16:19], s41 offen offset:3072 lds
  s_add_u32 m0, s60, 4096
  s_add_u32 s41, s41, 65536
  buffer_load_dwordx4 v16, s[16:19], s41 offen offset:0 lds
  buffer_load_dwordx4 v17, s[16:19], s41 offen offset:1024 lds
  buffer_load_dwordx4 v18, s[16:19], s41 offen offset:2048 lds
  buffer_load_dwordx4 v19, s[16:19], s41 offen offset:3072 lds
  s_mov_b32 s63, 0
L_sp3:
  s_waitcnt lgkmcnt(0)
  s_xor_b64 s[10:11], s[64:65], s[8:9]
  s_xor_b64 s[14:15], s[66:67], s[8:9]
  s_or_b64 s[10:11], s[10:11], s[14:15]
  s_cbranch_scc0 L_ok3
  s_load_dwordx4 s[64:67], s[4:5], s43 glc
  s_add_u32 s63, s63, 1
  s_cmp_lt_u32 s63, 20000
  s_cbranch_scc1 L_sp3
  s_waitcnt lgkmcnt(0)
L_ok3:
  s_add_u32 s43, s40, 3
  s_lshl_b32 s43, s43, 9
  s_load_dwordx4 s[64:67], s[4:5], s43 glc
  s_add_u32 m0, s61, 0
  s_add_u32 s62, s40, 2
  s_lshl_b32 s62, s62, 14
  buffer_load_dwordx4 v20, s[28:31], s62 offen offset:0 sc1 lds
  buffer_load_dwordx4 v20, s[28:31], s62 offen offset:1024 sc1 lds
  buffer_load_dwordx4 v20, s[28:31], s62 offen offset:2048 sc1 lds
  buffer_load_dwordx4 v20, s[28:31], s62 offen offset:3072 sc1 lds
  s_xor_b32 s58, s40, 4
  s_cmp_ge_u32 s58, s36
  s_addc_u32 s58, s58, 0
  s_lshl_b32 s58, s58, 7
  s_load_dword s68, s[12:13], s58 offset:0
  s_load_dword s69, s[12:13], s58 offset:64
  s_load_dword s70, s[12:13], s58 offset:2048
  s_load_dword s71, s[12:13], s58 offset:2112
  s_load_dword s72, s[12:13], s58 offset:4096
  s_load_dword s73, s[12:13], s58 offset:4160
  s_waitcnt vmcnt(12)
  s_barrier
  s_add_u32 s41, s40, 3
  s_lshl_b32 s41, s41, 7
  s_add_u32 m0, s60, 49152
  s_nop 0
  buffer_load_dwordx4 v16, s[16:19], s41 offen offset:0 lds
  buffer_load_dwordx4 v17, s[16:19], s41 offen offset:1024 lds
  buffer_load_dwordx4 v18, s[16:19], s41 offen offset:2048 lds
  buffer_load_dwordx4 v19, s[16:19], s41 offen offset:3072 lds
  s_add_u32 m0, s60, 53248
  s_add_u32 s41, s41, 65536
  buffer_load_dwordx4 v16, s[16:19], s41 offen offset:0 lds
  buffer_load_dwordx4 v17, s[16:19], s41 offen offset:1024 lds
  buffer_load_dwordx4 v18, s[16:19], s41 offen offset:2048 lds
  buffer_load_dwordx4 v19, s[16:19], s41 offen offset:3072 lds
  s_mov_b32 s63, 0
L_sp4:
  s_waitcnt lgkmcnt(0)
  s_xor_b64 s[10:11], s[64:65], s[8:9]
  s_xor_b64 s[14:15], s[66:67], s[8:9]
  s_or_b64 s[10:11], s[10:11], s[14:15]
  s_cbranch_scc0 L_ok4
  s_load_dwordx4 s[64:67], s[4:5], s43 glc
  s_add_u32 s63, s63, 1
  s_cmp_lt_u32 s63, 20000
  s_cbranch_scc1 L_sp4
  s_waitcnt lgkmcnt(0)
L_ok4:
  s_xor_b32 s43, s40, 4
  s_cmp_ge_u32 s43, s36
  s_addc_u32 s43, s43, 0
  s_lshl_b32 s43, s43, 9
  s_load_dwordx4 s[64:67], s[4:5], s43 glc
  s_add_u32 m0, s61, 49152
  s_add_u32 s62, s40, 3
  s_lshl_b32 s62, s62, 14
  buffer_load_dwordx4 v20, s[28:31], s62 offen offset:0 sc1 lds
  buffer_load_dwordx4 v20, s[28:31], s62 offen offset:1024 sc1 lds
  buffer_load_dwordx4 v20, s[28:31], s62 offen offset:2048 sc1 lds
  buffer_load_dwordx4 v20, s[28:31], s62 offen offset:3072 sc1 lds
  s_xor_b32 s58, s40, 5
  s_cmp_ge_u32 s58, s36
  s_addc_u32 s58, s58, 0
  s_lshl_b32 s58, s58, 7
  s_load_dword s68, s[12:13], s58 offset:0
  s_load_dword s69, s[12:13], s58 offset:64
  s_load_dword s70, s[12:13], s58 offset:2048
  s_load_dword s71, s[12:13], s58 offset:2112
  s_load_dword s72, s[12:13], s58 offset:4096
  s_load_dword s73, s[12:13], s58 offset:4160
  s_waitcnt vmcnt(12)
  s_barrier
  s_xor_b32 s41, s40, 4
  s_cmp_ge_u32 s41, s36
  s_addc_u32 s41, s41, 0
  s_lshl_b32 s41, s41, 7
  s_add_u32 m0, s60, 98304
  s_nop 0
  buffer_load_dwordx4 v16, s[16:19], s41 offen offset:0 lds
  buffer_load_dwordx4 v17, s[16:19], s41 offen offset:1024 lds
  buffer_load_dwordx4 v18, s[16:19], s41 offen offset:2048 lds
  buffer_load_dwordx4 v19, s[16:19], s41 offen offset:3072 lds
  s_add_u32 m0, s60, 102400
  s_add_u32 s41, s41, 65536
  buffer_load_dwordx4 v16, s[16:19], s41 offen offset:0 lds
  buffer_load_dwordx4 v17, s[16:19], s41 offen offset:1024 lds
  buffer_load_dwordx4 v18, s[16:19], s41 offen offset:2048 lds
  buffer_load_dwordx4 v19, s[16:19], s41 offen offset:3072 lds
  s_mov_b32 s63, 0
L_sp5:
  s_waitcnt lgkmcnt(0)
  s_xor_b64 s[10:11], s[64:65], s[8:9]
  s_xor_b64 s[14:15], s[66:67], s[8:9]
  s_or_b64 s[10:11], s[10:11], s[14:15]
  s_cbranch_scc0 L_ok5
  s_load_dwordx4 s[64:67], s[4:5], s43 glc
  s_add_u32 s63, s63, 1
  s_cmp_lt_u32 s63, 20000
  s_cbranch_scc1 L_sp5
  s_waitcnt lgkmcnt(0)
L_ok5:
  s_xor_b32 s43, s40, 5
  s_cmp_ge_u32 s43, s36
  s_addc_u32 s43, s43, 0
  s_lshl_b32 s43, s43, 9
  s_load_dwordx4 s[64:67], s[4:5], s43 glc
  s_add_u32 m0, s61, 98304
  s_xor_b32 s62, s40, 4
  s_cmp_ge_u32 s62, s36
  s_addc_u32 s62, s62, 0
  s_lshl_b32 s62, s62, 14
  buffer_load_dwordx4 v20, s[28:31], s62 offen offset:0 sc1 lds
  buffer_load_dwordx4 v20, s[28:31], s62 offen offset:1024 sc1 lds
  buffer_load_dwordx4 v20, s[28:31], s62 offen offset:2048 sc1 lds
  buffer_load_dwordx4 v20, s[28:31], s62 offen offset:3072 sc1 lds
  s_xor_b32 s58, s40, 6
  s_cmp_ge_u32 s58, s36
  s_addc_u32 s58, s58, 0
  s_lshl_b32 s58, s58, 7
  s_load_dword s68, s[12:13], s58 offset:0
  s_load_dword s69, s[12:13], s58 offset:64
  s_load_dword s70, s[12:13], s58 offset:2048
  s_load_dword s71, s[12:13], s58 offset:2112
  s_load_dword s72, s[12:13], s58 offset:4096
  s_load_dword s73, s[12:13], s58 offset:4160
  s_waitcnt vmcnt(12)
  s_barrier
  s_xor_b32 s41, s40, 5
  s_cmp_ge_u32 s41, s36
  s_addc_u32 s41, s41, 0
  s_lshl_b32 s41, s41, 7
  s_add_u32 m0, s60, 0
  s_nop 0
  buffer_load_dwordx4 v16, s[16:19], s41 offen offset:0 lds
  buffer_load_dwordx4 v17, s[16:19], s41 offen offset:1024 lds
  buffer_load_dwordx4 v18, s[16:19], s41 offen offset:2048 lds
  buffer_load_dwordx4 v19, s[16:19], s41 offen offset:3072 lds
  s_add_u32 m0, s60, 4096
  s_add_u32 s41, s41, 65536
  buffer_load_dwordx4 v16, s[16:19], s41 offen offset:0 lds
  buffer_load_dwordx4 v17, s[16:19], s41 offen offset:1024 lds
  buffer_load_dwordx4 v18, s[16:19], s41 offen offset:2048 lds
  buffer_load_dwordx4 v19, s[16:19], s41 offen offset:3072 lds
  s_mov_b32 s63, 0
L_sp6:
  s_waitcnt lgkmcnt(0)
  s_xor_b64 s[10:11], s[64:65], s[8:9]
  s_xor_b64 s[14:15], s[66:67], s[8:9]
  s_or_b64 s[10:11], s[10:11], s[14:15]
  s_cbranch_scc0 L_ok6
  s_load_dwordx4 s[64:67], s[4:5], s43 glc
  s_add_u32 s63, s63, 1
  s_cmp_lt_u32 s63, 20000
  s_cbranch_scc1 L_sp6
  s_waitcnt lgkmcnt(0)
L_ok6:
  s_xor_b32 s43, s40, 6
  s_cmp_ge_u32 s43, s36
  s_addc_u32 s43, s43, 0
  s_lshl_b32 s43, s43, 9
  s_load_dwordx4 s[64:67], s[4:5], s43 glc
  s_add_u32 m0, s61, 0
  s_xor_b32 s62, s40, 5
  s_cmp_ge_u32 s62, s36
  s_addc_u32 s62, s62, 0
  s_lshl_b32 s62, s62, 14
  buffer_load_dwordx4 v20, s[28:31], s62 offen offset:0 sc1 lds
  buffer_load_dwordx4 v20, s[28:31], s62 offen offset:1024 sc1 lds
  buffer_load_dwordx4 v20, s[28:31], s62 offen offset:2048 sc1 lds
  buffer_load_dwordx4 v20, s[28:31], s62 offen offset:3072 sc1 lds
  s_mov_b32 s58, 1024
  s_load_dword s68, s[12:13], s58 offset:0
  s_load_dword s69, s[12:13], s58 offset:64
  s_load_dword s70, s[12:13], s58 offset:2048
  s_load_dword s71, s[12:13], s58 offset:2112
  s_load_dword s72, s[12:13], s58 offset:4096
  s_load_dword s73, s[12:13], s58 offset:4160
  s_waitcnt vmcnt(12)
  s_barrier
  s_xor_b32 s41, s40, 6
  s_cmp_ge_u32 s41, s36
  s_addc_u32 s41, s41, 0
  s_lshl_b32 s41, s41, 7
  s_add_u32 m0, s60, 49152
  s_nop 0
  buffer_load_dwordx4 v16, s[16:19], s41 offen offset:0 lds
  buffer_load_dwordx4 v17, s[16:19], s41 offen offset:1024 lds
  buffer_load_dwordx4 v18, s[16:19], s41 offen offset:2048 lds
  buffer_load_dwordx4 v19, s[16:19], s41 offen offset:3072 lds
  s_add_u32 m0, s60, 53248
  s_add_u32 s41, s41, 65536
  buffer_load_dwordx4 v16, s[16:19], s41 offen offset:0 lds
  buffer_load_dwordx4 v17, s[16:19], s41 offen offset:1024 lds
  buffer_load_dwordx4 v18, s[16:19], s41 offen offset:2048 lds
  buffer_load_dwordx4 v19, s[16:19], s41 offen offset:3072 lds
  s_mov_b32 s63, 0
L_sp7:
  s_waitcnt lgkmcnt(0)
  s_xor_b64 s[10:11], s[64:65], s[8:9]
  s_xor_b64 s[14:15], s[66:67], s[8:9]
  s_or_b64 s[10:11], s[10:11], s[14:15]
  s_cbranch_scc0 L_ok7
  s_load_dwordx4 s[64:67], s[4:5], s43 glc
  s_add_u32 s63, s63, 1
  s_cmp_lt_u32 s63, 20000
  s_cbranch_scc1 L_sp7
  s_waitcnt lgkmcnt(0)
L_ok7:
  s_mov_b32 s43, 4096
  s_load_dwordx4 s[64:67], s[4:5], s43 glc
  s_add_u32 m0, s61, 49152
  s_xor_b32 s62, s40, 6
  s_cmp_ge_u32 s62, s36
  s_addc_u32 s62, s62, 0
  s_lshl_b32 s62, s62, 14
  buffer_load_dwordx4 v20, s[28:31], s62 offen offset:0 sc1 lds
  buffer_load_dwordx4 v20, s[28:31], s62 offen offset:1024 sc1 lds
  buffer_load_dwordx4 v20, s[28:31], s62 offen offset:2048 sc1 lds
  buffer_load_dwordx4 v20, s[28:31], s62 offen offset:3072 sc1 lds
  s_mov_b32 s58, 1152
  s_load_dword s68, s[12:13], s58 offset:0
  s_load_dword s69, s[12:13], s58 offset:64
  s_load_dword s70, s[12:13], s58 offset:2048
  s_load_dword s71, s[12:13], s58 offset:2112
  s_load_dword s72, s[12:13], s58 offset:4096
  s_load_dword s73, s[12:13], s58 offset:4160
  s_waitcnt vmcnt(12)
  s_barrier
  s_mov_b32 s41, 1024
  s_add_u32 m0, s60, 98304
  s_nop 0
  buffer_load_dwordx4 v16, s[16:19], s41 offen offset:0 lds
  buffer_load_dwordx4 v17, s[16:19], s41 offen offset:1024 lds
  buffer_load_dwordx4 v18, s[16:19], s41 offen offset:2048 lds
  buffer_load_dwordx4 v19, s[16:19], s41 offen offset:3072 lds
  s_add_u32 m0, s60, 102400
  s_add_u32 s41, s41, 65536
  buffer_load_dwordx4 v16, s[16:19], s41 offen offset:0 lds
  buffer_load_dwordx4 v17, s[16:19], s41 offen offset:1024 lds
  buffer_load_dwordx4 v18, s[16:19], s41 offen offset:2048 lds
  buffer_load_dwordx4 v19, s[16:19], s41 offen offset:3072 lds
  s_mov_b32 s63, 0
L_sp8:
  s_waitcnt lgkmcnt(0)
  s_xor_b64 s[10:11], s[64:65], s[8:9]
  s_xor_b64 s[14:15], s[66:67], s[8:9]
  s_or_b64 s[10:11], s[10:11], s[14:15]
  s_cbranch_scc0 L_ok8
  s_load_dwordx4 s[64:67], s[4:5], s43 glc
  s_add_u32 s63, s63, 1
  s_cmp_lt_u32 s63, 20000
  s_cbranch_scc1 L_sp8
  s_waitcnt lgkmcnt(0)
L_ok8:
  s_mov_b32 s43, 4608
  s_load_dwordx4 s[64:67], s[4:5], s43 glc
  s_add_u32 m0, s61, 98304
  s_mov_b32 s62, 131072
  buffer_load_dwordx4 v20, s[28:31], s62 offen offset:0 sc1 lds
  buffer_load_dwordx4 v20, s[28:31], s62 offen offset:1024 sc1 lds
  buffer_load_dwordx4 v20, s[28:31], s62 offen offset:2048 sc1 lds
  buffer_load_dwordx4 v20, s[28:31], s62 offen offset:3072 sc1 lds
  s_mov_b32 s58, 1280
  s_load_dword s68, s[12:13], s58 offset:0
  s_load_dword s69, s[12:13], s58 offset:64
  s_load_dword s70, s[12:13], s58 offset:2048
  s_load_dword s71, s[12:13], s58 offset:2112
  s_load_dword s72, s[12:13], s58 offset:4096
  s_load_dword s73, s[12:13], s58 offset:4160
  s_waitcnt vmcnt(12)
  s_barrier
  s_mov_b32 s41, 1152
  s_add_u32 m0, s60, 0
  s_nop 0
  buffer_load_dwordx4 v16, s[16:19], s41 offen offset:0 lds
  buffer_load_dwordx4 v17, s[16:19], s41 offen offset:1024 lds
  buffer_load_dwordx4 v18, s[16:19], s41 offen offset:2048 lds
  buffer_load_dwordx4 v19, s[16:19], s41 offen offset:3072 lds
  s_add_u32 m0, s60, 4096
  s_add_u32 s41, s41, 65536
  buffer_load_dwordx4 v16, s[16:19], s41 offen offset:0 lds
  buffer_load_dwordx4 v17, s[16:19], s41 offen offset:1024 lds
  buffer_load_dwordx4 v18, s[16:19], s41 offen offset:2048 lds
  buffer_load_dwordx4 v19, s[16:19], s41 offen offset:3072 lds
  s_mov_b32 s63, 0
L_sp9:
  s_waitcnt lgkmcnt(0)
  s_xor_b64 s[10:11], s[64:65], s[8:9]
  s_xor_b64 s[14:15], s[66:67], s[8:9]
  s_or_b64 s[10:11], s[10:11], s[14:15]
  s_cbranch_scc0 L_ok9
  s_load_dwordx4 s[64:67], s[4:5], s43 glc
  s_add_u32 s63, s63, 1
  s_cmp_lt_u32 s63, 20000
  s_cbranch_scc1 L_sp9
  s_waitcnt lgkmcnt(0)
L_ok9:
  s_mov_b32 s43, 5120
  s_load_dwordx4 s[64:67], s[4:5], s43 glc
  s_add_u32 m0, s61, 0
  s_mov_b32 s62, 147456
  buffer_load_dwordx4 v20, s[28:31], s62 offen offset:0 sc1 lds
  buffer_load_dwordx4 v20, s[28:31], s62 offen offset:1024 sc1 lds
  buffer_load_dwordx4 v20, s[28:31], s62 offen offset:2048 sc1 lds
  buffer_load_dwordx4 v20, s[28:31], s62 offen offset:3072 sc1 lds
  s_mov_b32 s58, 1408
  s_load_dword s68, s[12:13], s58 offset:0
  s_load_dword s69, s[12:13], s58 offset:64
  s_load_dword s70, s[12:13], s58 offset:2048
  s_load_dword s71, s[12:13], s58 offset:2112
  s_load_dword s72, s[12:13], s58 offset:4096
  s_load_dword s73, s[12:13], s58 offset:4160
  s_waitcnt vmcnt(12)
  s_barrier
  s_mov_b32 s41, 1280
  s_add_u32 m0, s60, 49152
  s_nop 0
  buffer_load_dwordx4 v16, s[16:19], s41 offen offset:0 lds
  buffer_load_dwordx4 v17, s[16:19], s41 offen offset:1024 lds
  buffer_load_dwordx4 v18, s[16:19], s41 offen offset:2048 lds
  buffer_load_dwordx4 v19, s[16:19], s41 offen offset:3072 lds
  s_add_u32 m0, s60, 53248
  s_add_u32 s41, s41, 65536
  buffer_load_dwordx4 v16, s[16:19], s41 offen offset:0 lds
  buffer_load_dwordx4 v17, s[16:19], s41 offen offset:1024 lds
  buffer_load_dwordx4 v18, s[16:19], s41 offen offset:2048 lds
  buffer_load_dwordx4 v19, s[16:19], s41 offen offset:3072 lds
  s_mov_b32 s63, 0
L_sp10:
  s_waitcnt lgkmcnt(0)
  s_xor_b64 s[10:11], s[64:65], s[8:9]
  s_xor_b64 s[14:15], s[66:67], s[8:9]
  s_or_b64 s[10:11], s[10:11], s[14:15]
  s_cbranch_scc0 L_ok10
  s_load_dwordx4 s[64:67], s[4:5], s43 glc
  s_add_u32 s63, s63, 1
  s_cmp_lt_u32 s63, 20000
  s_cbranch_scc1 L_sp10
  s_waitcnt lgkmcnt(0)
L_ok10:
  s_mov_b32 s43, 5632
  s_load_dwordx4 s[64:67], s[4:5], s43 glc
  s_add_u32 m0, s61, 49152
  s_mov_b32 s62, 163840
  buffer_load_dwordx4 v20, s[28:31], s62 offen offset:0 sc1 lds
  buffer_load_dwordx4 v20, s[28:31], s62 offen offset:1024 sc1 lds
  buffer_load_dwordx4 v20, s[28:31], s62 offen offset:2048 sc1 lds
  buffer_load_dwordx4 v20, s[28:31], s62 offen offset:3072 sc1 lds
  s_mov_b32 s58, 1536
  s_load_dword s68, s[12:13], s58 offset:0
  s_load_dword s69, s[12:13], s58 offset:64
  s_load_dword s70, s[12:13], s58 offset:2048
  s_load_dword s71, s[12:13], s58 offset:2112
  s_load_dword s72, s[12:13], s58 offset:4096
  s_load_dword s73, s[12:13], s58 offset:4160
  s_waitcnt vmcnt(12)
  s_barrier
  s_mov_b32 s41, 1408
  s_add_u32 m0, s60, 98304
  s_nop 0
  buffer_load_dwordx4 v16, s[16:19], s41 offen offset:0 lds
  buffer_load_dwordx4 v17, s[16:19], s41 offen offset:1024 lds
  buffer_load_dwordx4 v18, s[16:19], s41 offen offset:2048 lds
  buffer_load_dwordx4 v19, s[16:19], s41 offen offset:3072 lds
  s_add_u32 m0, s60, 102400
  s_add_u32 s41, s41, 65536
  buffer_load_dwordx4 v16, s[16:19], s41 offen offset:0 lds
  buffer_load_dwordx4 v17, s[16:19], s41 offen offset:1024 lds
  buffer_load_dwordx4 v18, s[16:19], s41 offen offset:2048 lds
  buffer_load_dwordx4 v19, s[16:19], s41 offen offset:3072 lds
  s_mov_b32 s63, 0
L_sp11:
  s_waitcnt lgkmcnt(0)
  s_xor_b64 s[10:11], s[64:65], s[8:9]
  s_xor_b64 s[14:15], s[66:67], s[8:9]
  s_or_b64 s[10:11], s[10:11], s[14:15]
  s_cbranch_scc0 L_ok11
  s_load_dwordx4 s[64:67], s[4:5], s43 glc
  s_add_u32 s63, s63, 1
  s_cmp_lt_u32 s63, 20000
  s_cbranch_scc1 L_sp11
  s_waitcnt lgkmcnt(0)
L_ok11:
  s_mov_b32 s43, 6144
  s_load_dwordx4 s[64:67], s[4:5], s43 glc
  s_add_u32 m0, s61, 98304
  s_mov_b32 s62, 180224
  buffer_load_dwordx4 v20, s[28:31], s62 offen offset:0 sc1 lds
  buffer_load_dwordx4 v20, s[28:31], s62 offen offset:1024 sc1 lds
  buffer_load_dwordx4 v20, s[28:31], s62 offen offset:2048 sc1 lds
  buffer_load_dwordx4 v20, s[28:31], s62 offen offset:3072 sc1 lds
  s_mov_b32 s58, 1664
  s_load_dword s68, s[12:13], s58 offset:0
  s_load_dword s69, s[12:13], s58 offset:64
  s_load_dword s70, s[12:13], s58 offset:2048
  s_load_dword s71, s[12:13], s58 offset:2112
  s_load_dword s72, s[12:13], s58 offset:4096
  s_load_dword s73, s[12:13], s58 offset:4160
  s_waitcnt vmcnt(12)
  s_barrier
  s_mov_b32 s41, 1536
  s_add_u32 m0, s60, 0
  s_nop 0
  buffer_load_dwordx4 v16, s[16:19], s41 offen offset:0 lds
  buffer_load_dwordx4 v17, s[16:19], s41 offen offset:1024 lds
  buffer_load_dwordx4 v18, s[16:19], s41 offen offset:2048 lds
  buffer_load_dwordx4 v19, s[16:19], s41 offen offset:3072 lds
  s_add_u32 m0, s60, 4096
  s_add_u32 s41, s41, 65536
  buffer_load_dwordx4 v16, s[16:19], s41 offen offset:0 lds
  buffer_load_dwordx4 v17, s[16:19], s41 offen offset:1024 lds
  buffer_load_dwordx4 v18, s[16:19], s41 offen offset:2048 lds
  buffer_load_dwordx4 v19, s[16:19], s41 offen offset:3072 lds
  s_mov_b32 s63, 0
L_sp12:
  s_waitcnt lgkmcnt(0)
  s_xor_b64 s[10:11], s[64:65], s[8:9]
  s_xor_b64 s[14:15], s[66:67], s[8:9]
  s_or_b64 s[10:11], s[10:11], s[14:15]
  s_cbranch_scc0 L_ok12
  s_load_dwordx4 s[64:67], s[4:5], s43 glc
  s_add_u32 s63, s63, 1
  s_cmp_lt_u32 s63, 20000
  s_cbranch_scc1 L_sp12
  s_waitcnt lgkmcnt(0)
L_ok12:
  s_mov_b32 s43, 6656
  s_load_dwordx4 s[64:67], s[4:5], s43 glc
  s_add_u32 m0, s61, 0
  s_mov_b32 s62, 196608
  buffer_load_dwordx4 v20, s[28:31], s62 offen offset:0 sc1 lds
  buffer_load_dwordx4 v20, s[28:31], s62 offen offset:1024 sc1 lds
  buffer_load_dwordx4 v20, s[28:31], s62 offen offset:2048 sc1 lds
  buffer_load_dwordx4 v20, s[28:31], s62 offen offset:3072 sc1 lds
  s_mov_b32 s58, 1792
  s_load_dword s68, s[12:13], s58 offset:0
  s_load_dword s69, s[12:13], s58 offset:64
  s_load_dword s70, s[12:13], s58 offset:2048
  s_load_dword s71, s[12:13], s58 offset:2112
  s_load_dword s72, s[12:13], s58 offset:4096
  s_load_dword s73, s[12:13], s58 offset:4160
  s_waitcnt vmcnt(12)
  s_barrier
  s_mov_b32 s41, 1664
  s_add_u32 m0, s60, 49152
  s_nop 0
  buffer_load_dwordx4 v16, s[16:19], s41 offen offset:0 lds
  buffer_load_dwordx4 v17, s[16:19], s41 offen offset:1024 lds
  buffer_load_dwordx4 v18, s[16:19], s41 offen offset:2048 lds
  buffer_load_dwordx4 v19, s[16:19], s41 offen offset:3072 lds
  s_add_u32 m0, s60, 53248
  s_add_u32 s41, s41, 65536
  buffer_load_dwordx4 v16, s[16:19], s41 offen offset:0 lds
  buffer_load_dwordx4 v17, s[16:19], s41 offen offset:1024 lds
  buffer_load_dwordx4 v18, s[16:19], s41 offen offset:2048 lds
  buffer_load_dwordx4 v19, s[16:19], s41 offen offset:3072 lds
  s_mov_b32 s63, 0
L_sp13:
  s_waitcnt lgkmcnt(0)
  s_xor_b64 s[10:11], s[64:65], s[8:9]
  s_xor_b64 s[14:15], s[66:67], s[8:9]
  s_or_b64 s[10:11], s[10:11], s[14:15]
  s_cbranch_scc0 L_ok13
  s_load_dwordx4 s[64:67], s[4:5], s43 glc
  s_add_u32 s63, s63, 1
  s_cmp_lt_u32 s63, 20000
  s_cbranch_scc1 L_sp13
  s_waitcnt lgkmcnt(0)
L_ok13:
  s_mov_b32 s43, 7168
  s_load_dwordx4 s[64:67], s[4:5], s43 glc
  s_add_u32 m0, s61, 49152
  s_mov_b32 s62, 212992
  buffer_load_dwordx4 v20, s[28:31], s62 offen offset:0 sc1 lds
  buffer_load_dwordx4 v20, s[28:31], s62 offen offset:1024 sc1 lds
  buffer_load_dwordx4 v20, s[28:31], s62 offen offset:2048 sc1 lds
  buffer_load_dwordx4 v20, s[28:31], s62 offen offset:3072 sc1 lds
  s_mov_b32 s58, 1920
  s_load_dword s68, s[12:13], s58 offset:0
  s_load_dword s69, s[12:13], s58 offset:64
  s_load_dword s70, s[12:13], s58 offset:2048
  s_load_dword s71, s[12:13], s58 offset:2112
  s_load_dword s72, s[12:13], s58 offset:4096
  s_load_dword s73, s[12:13], s58 offset:4160
  s_waitcnt vmcnt(12)
  s_barrier
  s_mov_b32 s41, 1792
  s_add_u32 m0, s60, 98304
  s_nop 0
  buffer_load_dwordx4 v16, s[16:19], s41 offen offset:0 lds
  buffer_load_dwordx4 v17, s[16:19], s41 offen offset:1024 lds
  buffer_load_dwordx4 v18, s[16:19], s41 offen offset:2048 lds
  buffer_load_dwordx4 v19, s[16:19], s41 offen offset:3072 lds
  s_add_u32 m0, s60, 102400
  s_add_u32 s41, s41, 65536
  buffer_load_dwordx4 v16, s[16:19], s41 offen offset:0 lds
  buffer_load_dwordx4 v17, s[16:19], s41 offen offset:1024 lds
  buffer_load_dwordx4 v18, s[16:19], s41 offen offset:2048 lds
  buffer_load_dwordx4 v19, s[16:19], s41 offen offset:3072 lds
  s_mov_b32 s63, 0
L_sp14:
  s_waitcnt lgkmcnt(0)
  s_xor_b64 s[10:11], s[64:65], s[8:9]
  s_xor_b64 s[14:15], s[66:67], s[8:9]
  s_or_b64 s[10:11], s[10:11], s[14:15]
  s_cbranch_scc0 L_ok14
  s_load_dwordx4 s[64:67], s[4:5], s43 glc
  s_add_u32 s63, s63, 1
  s_cmp_lt_u32 s63, 20000
  s_cbranch_scc1 L_sp14
  s_waitcnt lgkmcnt(0)
L_ok14:
  s_mov_b32 s43, 7680
  s_load_dwordx4 s[64:67], s[4:5], s43 glc
  s_add_u32 m0, s61, 98304
  s_mov_b32 s62, 229376
  buffer_load_dwordx4 v20, s[28:31], s62 offen offset:0 sc1 lds
  buffer_load_dwordx4 v20, s[28:31], s62 offen offset:1024 sc1 lds
  buffer_load_dwordx4 v20, s[28:31], s62 offen offset:2048 sc1 lds
  buffer_load_dwordx4 v20, s[28:31], s62 offen offset:3072 sc1 lds
  s_mov_b32 s41, 1920
  s_lshr_b32 s53, s60, 1
  s_add_u32 m0, s53, 147456
  s_nop 0
  buffer_load_dwordx4 v16, s[16:19], s41 offen offset:0 lds
  buffer_load_dwordx4 v17, s[16:19], s41 offen offset:1024 lds
  buffer_load_dwordx4 v18, s[16:19], s41 offen offset:2048 lds
  buffer_load_dwordx4 v19, s[16:19], s41 offen offset:3072 lds
  s_waitcnt vmcnt(16)
  s_barrier
  s_mov_b32 s63, 0
L_sp15:
  s_waitcnt lgkmcnt(0)
  s_xor_b64 s[10:11], s[64:65], s[8:9]
  s_xor_b64 s[14:15], s[66:67], s[8:9]
  s_or_b64 s[10:11], s[10:11], s[14:15]
  s_cbranch_scc0 L_ok15
  s_load_dwordx4 s[64:67], s[4:5], s43 glc
  s_add_u32 s63, s63, 1
  s_cmp_lt_u32 s63, 20000
  s_cbranch_scc1 L_sp15
  s_waitcnt lgkmcnt(0)
L_ok15:
  s_add_u32 m0, s61, 0
  s_mov_b32 s62, 245760
  buffer_load_dwordx4 v20, s[28:31], s62 offen offset:0 sc1 lds
  buffer_load_dwordx4 v20, s[28:31], s62 offen offset:2048 sc1 lds
  s_waitcnt vmcnt(6)
  s_barrier
  s_add_u32 m0, s61, 0
  s_mov_b32 s62, 245760
  buffer_load_dwordx4 v20, s[28:31], s62 offen offset:1024 sc1 lds
  buffer_load_dwordx4 v20, s[28:31], s62 offen offset:3072 sc1 lds
  s_add_u32 m0, s60, 4096
  s_add_u32 s41, s41, 65536
  buffer_load_dwordx4 v16, s[16:19], s41 offen offset:0 lds
  buffer_load_dwordx4 v17, s[16:19], s41 offen offset:1024 lds
  buffer_load_dwordx4 v18, s[16:19], s41 offen offset:2048 lds
  buffer_load_dwordx4 v19, s[16:19], s41 offen offset:3072 lds
  s_waitcnt vmcnt(6)
  s_barrier
  s_waitcnt vmcnt(0)
  s_barrier
  s_endpgm
L_prod:
  v_and_b32 v2, 63, v0
  v_lshlrev_b32 v5, 2, v3
  s_and_b32 s39, s38, 3
  s_mov_b32 s56, 917504
  s_mov_b32 s57, 16384
  s_mov_b32 s58, 512
  s_mov_b32 s59, 0
  s_mov_b32 s55, 7
  v_mov_b32 v15, 0x7ff00000
  s_cmp_lt_u32 s2, 28
  s_cbranch_scc1 L_pp
  s_mov_b32 s56, 512
  s_mov_b32 s57, 262144
  s_mov_b32 s58, 8192
  s_mov_b32 s59, 4096
  s_mov_b32 s51, 6
L_pl:
  s_add_u32 m0, m0, 4096
  v_add_u32 v16, 256, v16
  s_sub_u32 s51, s51, 1
  buffer_load_dword v16, s[24:27], 0 offen lds
  buffer_load_dword v16, s[24:27], s50 offen offset:256 lds
  s_cmp_lg_u32 s51, 0
  s_cbranch_scc1 L_pl
  s_waitcnt vmcnt(0)
  s_branch L_pq
L_pp:
  s_mov_b32 s22, 13762560
L_pq:
  s_add_u32 s10, s28, 9437184
  s_addc_u32 s11, s29, 0
  s_load_dwordx2 s[6:7], s[10:11], 0
  s_lshl_b32 s53, s38, 11
  s_add_u32 s53, s53, 32768
  v_lshrrev_b32 v1, 4, v3
  v_lshlrev_b32 v1, 10, v1
  v_lshl_add_u32 v1, v9, 3, v1
  v_and_b32 v6, 15, v3
  v_lshl_add_u32 v6, v6, 4, v1
  v_add_u32 v6, s53, v6
  v_lshl_add_u32 v7, v2, 4, s53
  s_lshl_b32 s53, s37, 18
  s_lshl_b32 s54, s52, 11
  s_add_u32 s53, s53, s54
  v_lshl_add_u32 v8, v2, 4, s53
  s_lshl_b32 s53, s37, 6
  s_lshr_b32 s54, s52, 1
  s_add_u32 s53, s53, s54
  s_lshl_b32 s53, s53, 7
  s_and_b32 s54, s52, 1
  s_lshl_b32 s54, s54, 3
  s_add_u32 s53, s53, s54
  s_add_u32 s53, s53, 7340032
  v_lshl_add_u32 v14, v2, 7, s53
  s_waitcnt vmcnt(0)
  buffer_load_dwordx4 v[32:35], v4, s[20:23], 0 offen nt
  buffer_load_dwordx4 v[36:39], v4, s[20:23], s45 offen nt
  buffer_load_dwordx4 v[40:43], v4, s[20:23], s46 offen nt
  buffer_load_dwordx4 v[44:47], v4, s[20:23], s47 offen nt
  v_add_u32 v4, s56, v4
  buffer_load_dword v17, v15, s[20:23], 0 offen
  buffer_load_dword v17, v15, s[20:23], 0 offen
  buffer_load_dwordx4 v[48:51], v4, s[20:23], 0 offen nt
  buffer_load_dwordx4 v[52:55], v4, s[20:23], s45 offen nt
  buffer_load_dwordx4 v[56:59], v4, s[20:23], s46 offen nt
  buffer_load_dwordx4 v[60:63], v4, s[20:23], s47 offen nt
  v_add_u32 v4, s56, v4
  s_waitcnt lgkmcnt(0)
  s_mul_i32 s8, s6, 1664525
  s_mul_i32 s9, s7, 22695477
  s_add_u32 s8, s8, 1013904223
  s_add_u32 s9, s9, 1
  v_mov_b32 v10, s8
  v_mov_b32 v11, s9
  s_mov_b32 s60, 0
  s_mov_b32 s61, 0
  s_mov_b32 s62, 0
  s_waitcnt vmcnt(10)
  s_barrier
L_p:
  s_waitcnt vmcnt(9)
  v_lshl_add_u32 v32, v32, 8, v5
  v_lshl_add_u32 v33, v33, 8, v5
  v_lshl_add_u32 v34, v34, 8, v5
  v_lshl_add_u32 v35, v35, 8, v5
  ds_read_u16 v96, v32 offset:0
  ds_read_u16 v97, v33 offset:2
  ds_read_u16 v98, v34 offset:128
  ds_read_u16 v99, v35 offset:130
  s_waitcnt vmcnt(8)
  v_lshl_add_u32 v36, v36, 8, v5
  v_lshl_add_u32 v37, v37, 8, v5
  v_lshl_add_u32 v38, v38, 8, v5
  v_lshl_add_u32 v39, v39, 8, v5
  ds_read_u16 v100, v36 offset:0
  ds_read_u16 v101, v37 offset:2
  ds_read_u16 v102, v38 offset:128
  ds_read_u16 v103, v39 offset:130
  s_waitcnt vmcnt(7)
  v_lshl_add_u32 v40, v40, 8, v5
  v_lshl_add_u32 v41, v41, 8, v5
  v_lshl_add_u32 v42, v42, 8, v5
  v_lshl_add_u32 v43, v43, 8, v5
  ds_read_u16 v104, v40 offset:0
  ds_read_u16 v105, v41 offset:2
  ds_read_u16 v106, v42 offset:128
  ds_read_u16 v107, v43 offset:130
  s_waitcnt vmcnt(6)
  v_lshl_add_u32 v44, v44, 8, v5
  v_lshl_add_u32 v45, v45, 8, v5
  v_lshl_add_u32 v46, v46, 8, v5
  v_lshl_add_u32 v47, v47, 8, v5
  ds_read_u16 v108, v44 offset:0
  ds_read_u16 v109, v45 offset:2
  ds_read_u16 v110, v46 offset:128
  ds_read_u16 v111, v47 offset:130
  s_waitcnt lgkmcnt(8)
  v_lshl_or_b32 v112, v100, 16, v96
  v_lshl_or_b32 v114, v101, 16, v97
  v_lshl_or_b32 v116, v102, 16, v98
  v_lshl_or_b32 v118, v103, 16, v99
  s_waitcnt lgkmcnt(3)
  v_lshl_or_b32 v113, v108, 16, v104
  ds_write_b64 v6, v[112:113] offset:0
  s_waitcnt lgkmcnt(3)
  v_lshl_or_b32 v115, v109, 16, v105
  ds_write_b64 v6, v[114:115] offset:256
  s_waitcnt lgkmcnt(3)
  v_lshl_or_b32 v117, v110, 16, v106
  ds_write_b64 v6, v[116:117] offset:512
  s_waitcnt lgkmcnt(3)
  v_lshl_or_b32 v119, v111, 16, v107
  ds_write_b64 v6, v[118:119] offset:768
  s_waitcnt lgkmcnt(0)
  ds_read_b128 v[120:123], v7 offset:0
  ds_read_b128 v[124:127], v7 offset:1024
  s_cmp_eq_u32 s62, 0
  s_cbranch_scc1 L_pa0
  s_waitcnt vmcnt(4)
  s_mov_b64 exec, 1
  buffer_store_dwordx2 v[10:11], v14, s[28:31], s61 offen sc1
  s_mov_b64 exec, -1
  s_add_u32 s61, s61, s58
L_pa0:
  s_waitcnt lgkmcnt(1)
  buffer_store_dwordx4 v[120:123], v8, s[28:31], s60 offen offset:0 sc1
  s_waitcnt lgkmcnt(0)
  buffer_store_dwordx4 v[124:127], v8, s[28:31], s60 offen offset:1024 sc1
  buffer_load_dwordx4 v[32:35], v4, s[20:23], 0 offen nt
  buffer_load_dwordx4 v[36:39], v4, s[20:23], s45 offen nt
  buffer_load_dwordx4 v[40:43], v4, s[20:23], s46 offen nt
  buffer_load_dwordx4 v[44:47], v4, s[20:23], s47 offen nt
  v_add_u32 v4, s56, v4
  v_add_u32 v5, s59, v5
  s_add_u32 s62, s62, 1
  s_add_u32 s60, s60, s57
  s_cmp_lt_u32 s62, s55
  s_cbranch_scc0 L_pe
  s_waitcnt vmcnt(9)
  v_lshl_add_u32 v48, v48, 8, v5
  v_lshl_add_u32 v49, v49, 8, v5
  v_lshl_add_u32 v50, v50, 8, v5
  v_lshl_add_u32 v51, v51, 8, v5
  ds_read_u16 v96, v48 offset:0
  ds_read_u16 v97, v49 offset:2
  ds_read_u16 v98, v50 offset:128
  ds_read_u16 v99, v51 offset:130
  s_waitcnt vmcnt(8)
  v_lshl_add_u32 v52, v52, 8, v5
  v_lshl_add_u32 v53, v53, 8, v5
  v_lshl_add_u32 v54, v54, 8, v5
  v_lshl_add_u32 v55, v55, 8, v5
  ds_read_u16 v100, v52 offset:0
  ds_read_u16 v101, v53 offset:2
  ds_read_u16 v102, v54 offset:128
  ds_read_u16 v103, v55 offset:130
  s_waitcnt vmcnt(7)
  v_lshl_add_u32 v56, v56, 8, v5
  v_lshl_add_u32 v57, v57, 8, v5
  v_lshl_add_u32 v58, v58, 8, v5
  v_lshl_add_u32 v59, v59, 8, v5
  ds_read_u16 v104, v56 offset:0
  ds_read_u16 v105, v57 offset:2
  ds_read_u16 v106, v58 offset:128
  ds_read_u16 v107, v59 offset:130
  s_waitcnt vmcnt(6)
  v_lshl_add_u32 v60, v60, 8, v5
  v_lshl_add_u32 v61, v61, 8, v5
  v_lshl_add_u32 v62, v62, 8, v5
  v_lshl_add_u32 v63, v63, 8, v5
  ds_read_u16 v108, v60 offset:0
  ds_read_u16 v109, v61 offset:2
  ds_read_u16 v110, v62 offset:128
  ds_read_u16 v111, v63 offset:130
  s_waitcnt lgkmcnt(8)
  v_lshl_or_b32 v112, v100, 16, v96
  v_lshl_or_b32 v114, v101, 16, v97
  v_lshl_or_b32 v116, v102, 16, v98
  v_lshl_or_b32 v118, v103, 16, v99
  s_waitcnt lgkmcnt(3)
  v_lshl_or_b32 v113, v108, 16, v104
  ds_write_b64 v6, v[112:113] offset:0
  s_waitcnt lgkmcnt(3)
  v_lshl_or_b32 v115, v109, 16, v105
  ds_write_b64 v6, v[114:115] offset:256
  s_waitcnt lgkmcnt(3)
  v_lshl_or_b32 v117, v110, 16, v106
  ds_write_b64 v6, v[116:117] offset:512
  s_waitcnt lgkmcnt(3)
  v_lshl_or_b32 v119, v111, 16, v107
  ds_write_b64 v6, v[118:119] offset:768
  s_waitcnt lgkmcnt(0)
  ds_read_b128 v[128:131], v7 offset:0
  ds_read_b128 v[132:135], v7 offset:1024
  s_cmp_eq_u32 s62, 0
  s_cbranch_scc1 L_pa1
  s_waitcnt vmcnt(4)
  s_mov_b64 exec, 1
  buffer_store_dwordx2 v[10:11], v14, s[28:31], s61 offen sc1
  s_mov_b64 exec, -1
  s_add_u32 s61, s61, s58
L_pa1:
  s_waitcnt lgkmcnt(1)
  buffer_store_dwordx4 v[128:131], v8, s[28:31], s60 offen offset:0 sc1
  s_waitcnt lgkmcnt(0)
  buffer_store_dwordx4 v[132:135], v8, s[28:31], s60 offen offset:1024 sc1
  buffer_load_dwordx4 v[48:51], v4, s[20:23], 0 offen nt
  buffer_load_dwordx4 v[52:55], v4, s[20:23], s45 offen nt
  buffer_load_dwordx4 v[56:59], v4, s[20:23], s46 offen nt
  buffer_load_dwordx4 v[60:63], v4, s[20:23], s47 offen nt
  v_add_u32 v4, s56, v4
  v_add_u32 v5, s59, v5
  s_add_u32 s62, s62, 1
  s_add_u32 s60, s60, s57
  s_cmp_lt_u32 s62, s55
  s_cbranch_scc1 L_p
L_pe:
  s_waitcnt vmcnt(4)
  s_mov_b64 exec, 1
  buffer_store_dwordx2 v[10:11], v14, s[28:31], s61 offen sc1
  s_mov_b64 exec, -1
  s_cmp_eq_u32 s38, 0
  s_cbranch_scc0 L_pz
  s_lshl_b32 s3, s2, 6
  s_add_u32 s3, s3, 9441280
  v_mov_b32 v12, s3
  s_mov_b64 exec, 1
  buffer_store_dwordx2 v[10:11], v12, s[28:31], 0 offen sc1
  s_mov_b64 exec, -1
  s_cmp_eq_u32 s2, 0
  s_cbranch_scc0 L_pz
  s_mov_b32 s63, 0
  v_lshlrev_b32 v12, 6, v2
  v_add_u32 v12, 9441280, v12
L_pw:
  s_mov_b32 s53, 0
  buffer_load_dwordx2 v[20:21], v12, s[28:31], s53 offen sc1
  s_mov_b32 s53, 4096
  buffer_load_dwordx2 v[22:23], v12, s[28:31], s53 offen sc1
  s_mov_b32 s53, 8192
  buffer_load_dwordx2 v[24:25], v12, s[28:31], s53 offen sc1
  s_mov_b32 s53, 12288
  buffer_load_dwordx2 v[26:27], v12, s[28:31], s53 offen sc1
  s_add_u32 s63, s63, 1
  s_waitcnt vmcnt(0)
  v_cmp_ne_u64 s[52:53], v[20:21], v[10:11]
  v_cmp_ne_u64 vcc, v[22:23], v[10:11]
  s_or_b64 s[52:53], s[52:53], vcc
  v_cmp_ne_u64 vcc, v[24:25], v[10:11]
  s_or_b64 s[52:53], s[52:53], vcc
  v_cmp_ne_u64 vcc, v[26:27], v[10:11]
  s_or_b64 s[52:53], s[52:53], vcc
  s_cbranch_scc0 L_pv
  s_cmp_lt_u32 s63, 20000
  s_cbranch_scc1 L_pw
L_pv:
  v_mov_b32 v12, 9437184
  s_mov_b64 exec, 1
  buffer_store_dwordx2 v[10:11], v12, s[28:31], 0 offen sc1
  s_mov_b64 exec, -1
L_pz:
L_drain:
  s_waitcnt vmcnt(0)
L_done:
  s_endpgm
L_end:
.section .rodata,"a"
.p2align 6
.amdhsa_kernel standalone__weight_only_int_squeezellm__prompt_kernel
  .amdhsa_next_free_vgpr 256
  .amdhsa_next_free_sgpr 102
  .amdhsa_accum_offset 160
  .amdhsa_group_segment_fixed_size 0
  .amdhsa_kernarg_size 48
  .amdhsa_user_sgpr_count 2
  .amdhsa_user_sgpr_kernarg_segment_ptr 1
  .amdhsa_system_sgpr_workgroup_id_x 1
.end_amdhsa_kernel
```

```asm
; @launch grid=(256,1,1) block=(512,1,1) lds=163840
.amdgcn_target "amdgcn-amd-amdhsa--gfx950"
.text
.globl standalone__weight_only_int_squeezellm__prompt_kernel
.p2align 8
.type standalone__weight_only_int_squeezellm__prompt_kernel,@function
standalone__weight_only_int_squeezellm__prompt_kernel:
  s_cmp_ge_u32 s2, 256
  s_cbranch_scc1 L_done
  s_load_dwordx2 s[24:25], s[0:1], 16
  s_load_dwordx2 s[20:21], s[0:1], 8
  s_load_dwordx2 s[28:29], s[0:1], 40
  s_load_dwordx2 s[16:17], s[0:1], 0
  s_load_dwordx2 s[32:33], s[0:1], 24
  s_and_b32 s3, s2, 1
  s_bfe_u32 s36, s2, 0x20003
  s_lshl2_add_u32 s36, s3, s36
  s_bfe_u32 s3, s2, 0x20001
  s_mul_i32 s3, s3, 7
  s_lshr_b32 s37, s2, 5
  s_add_u32 s37, s37, s3
  s_sub_u32 s37, s37, 1
  s_sub_u32 s3, s2, 28
  s_mul_i32 s53, s3, 7
  s_cmp_lt_u32 s3, 4
  s_cselect_b32 s51, 15, 8
  s_cselect_b32 s53, s53, s2
  s_cmp_lt_u32 s2, 32
  s_cselect_b32 s36, s51, s36
  s_cselect_b32 s37, s53, s37
  s_cselect_b32 s51, 0, 147456
  v_lshrrev_b32 v1, 6, v0
  v_and_b32 v3, 31, v0
  v_readfirstlane_b32 s38, v1
  v_bfe_u32 v9, v0, 5, 1
  s_mov_b32 s26, 114688
  s_mov_b32 s27, 0x20000
  s_mov_b32 s22, 14680064
  s_mov_b32 s23, 0x20000
  v_mul_u32_u24 v1, 57344, v9
  v_lshl_add_u32 v4, v3, 4, v1
  v_lshlrev_b32 v1, 3, v3
  v_lshl_add_u32 v16, v9, 2, v1
  s_mul_i32 s53, s38, 14336
  s_lshl_b32 s54, s37, 8
  s_add_u32 s53, s53, s54
  v_add_u32 v16, s53, v16
  s_lshl_b32 s53, s38, 9
  s_add_u32 m0, s53, s51
  s_movk_i32 s50, 6912
  s_lshl3_add_u32 s52, s36, s38
  s_mul_i32 s53, s52, 114688
  s_lshl1_add_u32 s53, s54, s53
  v_add_u32 v4, s53, v4
  s_movk_i32 s45, 14336
  s_movk_i32 s46, 28672
  s_mov_b32 s47, 43008
  s_cmp_lt_u32 s2, 32
  s_waitcnt lgkmcnt(0)
  buffer_load_dword v16, s[24:27], 0 offen lds
  buffer_load_dword v16, s[24:27], s50 offen offset:256 lds
  s_cbranch_scc1 L_h
  buffer_load_dwordx4 v[32:35], v4, s[20:23], 0 offen nt
  buffer_load_dwordx4 v[36:39], v4, s[20:23], s45 offen nt
  buffer_load_dwordx4 v[40:43], v4, s[20:23], s46 offen nt
  buffer_load_dwordx4 v[44:47], v4, s[20:23], s47 offen nt
  s_add_u32 s10, s28, 9437184
  s_addc_u32 s11, s29, 0
  s_load_dwordx2 s[6:7], s[10:11], 0
  s_branch L_ng
L_h:
  s_getpc_b64 s[14:15]
L_pc:
  s_lshr_b32 s53, s2, 3
  s_lshl3_add_u32 s53, s53, s38
  s_mul_i32 s53, s53, 512
  s_min_u32 s53, s53, L_end-standalone__weight_only_int_squeezellm__prompt_kernel-512
  s_sub_u32 s14, s14, L_pc-standalone__weight_only_int_squeezellm__prompt_kernel
  s_subb_u32 s15, s15, 0
  s_load_dword s68, s[14:15], s53 offset:0
  s_load_dword s69, s[14:15], s53 offset:64
  s_load_dword s70, s[14:15], s53 offset:128
  s_load_dword s71, s[14:15], s53 offset:192
  s_load_dword s72, s[14:15], s53 offset:256
  s_load_dword s73, s[14:15], s53 offset:320
  s_load_dword s74, s[14:15], s53 offset:384
  s_load_dword s75, s[14:15], s53 offset:448
  s_branch L_prod
L_ng:
  s_mov_b32 s30, 9457664
  s_mov_b32 s31, 0x20000
  s_mov_b32 s18, 4194304
  s_mov_b32 s19, 0x20000
  s_mov_b32 s34, 14680064
  s_mov_b32 s35, 0x20000
  v_and_b32 v2, 63, v0
  v_lshlrev_b32 v5, 2, v3
  s_and_b32 s39, s38, 3
  v_add_u32 v5, 147456, v5
  s_lshl_b32 s53, s38, 11
  s_add_u32 s53, s53, 32768
  v_lshrrev_b32 v1, 4, v3
  v_lshlrev_b32 v1, 10, v1
  v_lshl_add_u32 v1, v9, 3, v1
  v_and_b32 v6, 15, v3
  v_lshl_add_u32 v6, v6, 4, v1
  v_add_u32 v6, s53, v6
  v_lshl_add_u32 v7, v2, 4, s53
  s_lshl_b32 s53, s37, 18
  s_lshl_b32 s54, s52, 11
  s_add_u32 s53, s53, s54
  v_lshl_add_u32 v8, v2, 4, s53
  s_lshl_b32 s53, s37, 6
  s_lshr_b32 s54, s52, 1
  s_add_u32 s53, s53, s54
  s_lshl_b32 s53, s53, 7
  s_and_b32 s54, s52, 1
  s_lshl_b32 s54, s54, 3
  s_add_u32 s53, s53, s54
  s_add_u32 s53, s53, 7340032
  v_lshl_add_u32 v14, v2, 7, s53
  s_lshl_b32 s53, s37, 2
  s_add_u32 s53, s53, s39
  s_mul_i32 s53, s53, 3
  s_min_u32 s53, s53, 253
  s_lshl_b32 s54, s36, 8
  s_add_u32 s53, s53, s54
  s_lshl_b32 s53, s53, 11
  s_add_u32 s12, s16, s53
  s_addc_u32 s13, s17, 0
  s_andn2_b32 s40, 4, s36
  v_and_b32 v3, 15, v2
  v_lshrrev_b32 v9, 4, v2
  v_lshrrev_b32 v1, 1, v3
  v_xor_b32 v1, v1, v9
  v_lshlrev_b32 v1, 4, v1
  v_lshl_add_u32 v144, v3, 7, v1
  s_lshl_b32 s54, s38, 13
  v_add_u32 v144, s54, v144
  v_xor_b32 v145, 64, v144
  v_lshlrev_b32 v1, 11, v9
  v_lshl_add_u32 v146, v3, 4, v1
  v_add_u32 v146, 32768, v146
  s_lshl_b32 s52, s36, 8
  s_lshl_b32 s53, s38, 6
  s_add_u32 s52, s52, s53
  s_mul_i32 s52, s52, 7168
  s_lshl_b32 s53, s37, 8
  s_add_u32 s52, s52, s53
  v_and_b32 v1, 1, v3
  v_lshl_add_u32 v1, v9, 2, v1
  v_mul_u32_u24 v1, 7168, v1
  v_lshrrev_b32 v147, 1, v3
  v_lshl_add_u32 v1, v147, 4, v1
  v_add_u32 v147, s52, v1
  v_lshrrev_b32 v20, 3, v2
  v_lshlrev_b32 v20, 11, v20
  v_lshrrev_b32 v1, 4, v2
  v_xor_b32 v1, v1, v2
  v_and_b32 v1, 7, v1
  v_lshl_add_u32 v20, v1, 4, v20
  s_lshl_b32 s52, s36, 19
  s_lshl_b32 s53, s39, 17
  s_add_u32 s53, s52, s53
  v_add_u32 v16, s53, v20
  v_xor_b32 v17, 64, v16
  v_add_u32 v18, 30720, v16
  v_add_u32 v19, 46080, v17
  v_add_u32 v17, 15360, v17
  s_lshl_b32 s60, s39, 13
  s_lshl_b32 s53, s37, 18
  s_lshl_b32 s54, s39, 12
  s_add_u32 s53, s53, s54
  v_lshl_add_u32 v20, v2, 4, s53
  s_add_u32 s61, s54, 32768
  s_lshl_b32 s53, s37, 13
  s_lshl_b32 s54, s39, 7
  s_add_u32 s53, s53, s54
  s_and_b32 s54, s36, 0
  s_lshl_b32 s54, s54, 7
  s_add_u32 s53, s53, s54
  s_add_u32 s53, s53, 7340032
  s_add_u32 s4, s28, s53
  s_addc_u32 s5, s29, 0
  s_lshl_b32 s41, s36, 7
  s_lshr_b32 s53, s38, 2
  s_lshl_b32 s54, s53, 16
  s_add_u32 s41, s41, s54
  s_lshl_b32 s53, s53, 12
  s_add_u32 m0, s60, s53
  s_waitcnt lgkmcnt(0)
  s_mul_i32 s8, s6, 1664525
  s_mul_i32 s9, s7, 22695477
  s_add_u32 s8, s8, 1013904223
  s_add_u32 s9, s9, 1
  v_mov_b32 v10, s8
  v_mov_b32 v11, s9
  s_waitcnt vmcnt(4)
  s_barrier
  s_waitcnt vmcnt(3)
  v_lshl_add_u32 v32, v32, 8, v5
  v_lshl_add_u32 v33, v33, 8, v5
  v_lshl_add_u32 v34, v34, 8, v5
  v_lshl_add_u32 v35, v35, 8, v5
  ds_read_u16 v96, v32 offset:0
  ds_read_u16 v97, v33 offset:2
  ds_read_u16 v98, v34 offset:128
  ds_read_u16 v99, v35 offset:130
  buffer_load_dwordx4 v16, s[16:19], s41 offen offset:0 lds
  s_waitcnt vmcnt(3)
  v_lshl_add_u32 v36, v36, 8, v5
  v_lshl_add_u32 v37, v37, 8, v5
  v_lshl_add_u32 v38, v38, 8, v5
  v_lshl_add_u32 v39, v39, 8, v5
  ds_read_u16 v100, v36 offset:0
  ds_read_u16 v101, v37 offset:2
  ds_read_u16 v102, v38 offset:128
  ds_read_u16 v103, v39 offset:130
  buffer_load_dwordx4 v17, s[16:19], s41 offen offset:1024 lds
  s_waitcnt vmcnt(3)
  v_lshl_add_u32 v40, v40, 8, v5
  v_lshl_add_u32 v41, v41, 8, v5
  v_lshl_add_u32 v42, v42, 8, v5
  v_lshl_add_u32 v43, v43, 8, v5
  ds_read_u16 v104, v40 offset:0
  ds_read_u16 v105, v41 offset:2
  ds_read_u16 v106, v42 offset:128
  ds_read_u16 v107, v43 offset:130
  buffer_load_dwordx4 v18, s[16:19], s41 offen offset:2048 lds
  s_waitcnt vmcnt(3)
  v_lshl_add_u32 v44, v44, 8, v5
  v_lshl_add_u32 v45, v45, 8, v5
  v_lshl_add_u32 v46, v46, 8, v5
  v_lshl_add_u32 v47, v47, 8, v5
  ds_read_u16 v108, v44 offset:0
  ds_read_u16 v109, v45 offset:2
  ds_read_u16 v110, v46 offset:128
  ds_read_u16 v111, v47 offset:130
  buffer_load_dwordx4 v19, s[16:19], s41 offen offset:3072 lds
  s_waitcnt lgkmcnt(8)
  v_lshl_or_b32 v112, v100, 16, v96
  v_lshl_or_b32 v114, v101, 16, v97
  v_lshl_or_b32 v116, v102, 16, v98
  v_lshl_or_b32 v118, v103, 16, v99
  s_waitcnt lgkmcnt(3)
  v_lshl_or_b32 v113, v108, 16, v104
  ds_write_b64 v6, v[112:113] offset:0
  s_waitcnt lgkmcnt(3)
  v_lshl_or_b32 v115, v109, 16, v105
  ds_write_b64 v6, v[114:115] offset:256
  s_waitcnt lgkmcnt(3)
  v_lshl_or_b32 v117, v110, 16, v106
  ds_write_b64 v6, v[116:117] offset:512
  s_waitcnt lgkmcnt(3)
  v_lshl_or_b32 v119, v111, 16, v107
  ds_write_b64 v6, v[118:119] offset:768
  s_waitcnt lgkmcnt(0)
  ds_read_b128 v[148:151], v7 offset:0
  ds_read_b128 v[152:155], v7 offset:1024
  s_waitcnt lgkmcnt(1)
  buffer_store_dwordx4 v[148:151], v8, s[28:31], 0 offen offset:0 sc1
  s_waitcnt lgkmcnt(0)
  buffer_store_dwordx4 v[152:155], v8, s[28:31], 0 offen offset:1024 sc1
  s_cmp_ge_u32 s38, 4
  s_cbranch_scc1 L_loader
  s_add_u32 s58, s40, 0
  s_lshl_b32 s58, s58, 7
  s_load_dword s92, s[12:13], s58 offset:0
  s_load_dword s93, s[12:13], s58 offset:64
  s_load_dword s94, s[12:13], s58 offset:2048
  s_load_dword s95, s[12:13], s58 offset:2112
  s_load_dword s96, s[12:13], s58 offset:4096
  s_load_dword s97, s[12:13], s58 offset:4160
  s_add_u32 s58, s40, 1
  s_lshl_b32 s58, s58, 7
  s_load_dword s92, s[12:13], s58 offset:0
  s_load_dword s93, s[12:13], s58 offset:64
  s_load_dword s94, s[12:13], s58 offset:2048
  s_load_dword s95, s[12:13], s58 offset:2112
  s_load_dword s96, s[12:13], s58 offset:4096
  s_load_dword s97, s[12:13], s58 offset:4160
  v_mov_b32 v5, v144
  v_mov_b32 v6, v145
  v_mov_b32 v7, v146
  v_mov_b32 v16, 0
  v_mov_b32 v17, 0
  v_mov_b32 v18, 0
  v_mov_b32 v19, 0
  v_mov_b32 v20, 0
  v_mov_b32 v21, 0
  v_mov_b32 v22, 0
  v_mov_b32 v23, 0
  v_mov_b32 v24, 0
  v_mov_b32 v25, 0
  v_mov_b32 v26, 0
  v_mov_b32 v27, 0
  v_mov_b32 v28, 0
  v_mov_b32 v29, 0
  v_mov_b32 v30, 0
  v_mov_b32 v31, 0
  v_mov_b32 v32, 0
  v_mov_b32 v33, 0
  v_mov_b32 v34, 0
  v_mov_b32 v35, 0
  v_mov_b32 v36, 0
  v_mov_b32 v37, 0
  v_mov_b32 v38, 0
  v_mov_b32 v39, 0
  v_mov_b32 v40, 0
  v_mov_b32 v41, 0
  v_mov_b32 v42, 0
  v_mov_b32 v43, 0
  v_mov_b32 v44, 0
  v_mov_b32 v45, 0
  v_mov_b32 v46, 0
  v_mov_b32 v47, 0
  v_mov_b32 v48, 0
  v_mov_b32 v49, 0
  v_mov_b32 v50, 0
  v_mov_b32 v51, 0
  v_mov_b32 v52, 0
  v_mov_b32 v53, 0
  v_mov_b32 v54, 0
  v_mov_b32 v55, 0
  v_mov_b32 v56, 0
  v_mov_b32 v57, 0
  v_mov_b32 v58, 0
  v_mov_b32 v59, 0
  v_mov_b32 v60, 0
  v_mov_b32 v61, 0
  v_mov_b32 v62, 0
  v_mov_b32 v63, 0
  v_mov_b32 v64, 0
  v_mov_b32 v65, 0
  v_mov_b32 v66, 0
  v_mov_b32 v67, 0
  v_mov_b32 v68, 0
  v_mov_b32 v69, 0
  v_mov_b32 v70, 0
  v_mov_b32 v71, 0
  v_mov_b32 v72, 0
  v_mov_b32 v73, 0
  v_mov_b32 v74, 0
  v_mov_b32 v75, 0
  v_mov_b32 v76, 0
  v_mov_b32 v77, 0
  v_mov_b32 v78, 0
  v_mov_b32 v79, 0
  v_mov_b32 v80, 0
  v_mov_b32 v81, 0
  v_mov_b32 v82, 0
  v_mov_b32 v83, 0
  v_mov_b32 v84, 0
  v_mov_b32 v85, 0
  v_mov_b32 v86, 0
  v_mov_b32 v87, 0
  v_mov_b32 v88, 0
  v_mov_b32 v89, 0
  v_mov_b32 v90, 0
  v_mov_b32 v91, 0
  v_mov_b32 v92, 0
  v_mov_b32 v93, 0
  v_mov_b32 v94, 0
  v_mov_b32 v95, 0
  v_mov_b32 v96, 0
  v_mov_b32 v97, 0
  v_mov_b32 v98, 0
  v_mov_b32 v99, 0
  v_mov_b32 v100, 0
  v_mov_b32 v101, 0
  v_mov_b32 v102, 0
  v_mov_b32 v103, 0
  v_mov_b32 v104, 0
  v_mov_b32 v105, 0
  v_mov_b32 v106, 0
  v_mov_b32 v107, 0
  v_mov_b32 v108, 0
  v_mov_b32 v109, 0
  v_mov_b32 v110, 0
  v_mov_b32 v111, 0
  v_mov_b32 v112, 0
  v_mov_b32 v113, 0
  v_mov_b32 v114, 0
  v_mov_b32 v115, 0
  v_mov_b32 v116, 0
  v_mov_b32 v117, 0
  v_mov_b32 v118, 0
  v_mov_b32 v119, 0
  v_mov_b32 v120, 0
  v_mov_b32 v121, 0
  v_mov_b32 v122, 0
  v_mov_b32 v123, 0
  v_mov_b32 v124, 0
  v_mov_b32 v125, 0
  v_mov_b32 v126, 0
  v_mov_b32 v127, 0
  v_mov_b32 v128, 0
  v_mov_b32 v129, 0
  v_mov_b32 v130, 0
  v_mov_b32 v131, 0
  v_mov_b32 v132, 0
  v_mov_b32 v133, 0
  v_mov_b32 v134, 0
  v_mov_b32 v135, 0
  v_mov_b32 v136, 0
  v_mov_b32 v137, 0
  v_mov_b32 v138, 0
  v_mov_b32 v139, 0
  v_mov_b32 v140, 0
  v_mov_b32 v141, 0
  v_mov_b32 v142, 0
  v_mov_b32 v143, 0
  s_waitcnt vmcnt(0)
  s_mov_b64 exec, 1
  buffer_store_dwordx2 v[10:11], v14, s[28:31], 0 offen sc1
  s_mov_b64 exec, -1
  s_mov_b32 s44, 0
  s_mov_b32 s45, 7168
  s_mov_b32 s46, 14336
  s_mov_b32 s47, 21504
  s_mov_b32 s48, 114688
  s_mov_b32 s49, 121856
  s_mov_b32 s50, 129024
  s_mov_b32 s51, 136192
  s_mov_b32 s52, 229376
  s_mov_b32 s53, 236544
  s_mov_b32 s54, 243712
  s_mov_b32 s55, 250880
  s_mov_b32 s56, 344064
  s_mov_b32 s57, 351232
  s_mov_b32 s58, 358400
  s_mov_b32 s59, 365568
  s_mov_b32 s60, 0
  s_mov_b32 s61, 0
  s_mov_b32 s60, 49152
  s_mov_b32 s61, 5
  s_mov_b32 s62, 49152
  s_lshl_b32 s63, s38, 12
  s_sub_u32 s63, 147456, s63
  s_mov_b32 vcc_lo, 0x55555555
  s_mov_b32 vcc_hi, 0x55555555
  s_barrier
  ds_read_b128 a[64:67], v7 offset:0
  ds_read_b128 a[68:71], v7 offset:8192
  ds_read_b128 a[0:3], v5 offset:0
  ds_read_b128 a[4:7], v6 offset:0
  ds_read_b128 a[8:11], v5 offset:2048
  ds_read_b128 a[12:15], v6 offset:2048
  ds_read_b128 a[16:19], v5 offset:4096
  ds_read_b128 a[72:75], v7 offset:256
  ds_read_b128 a[76:79], v7 offset:8448
  ds_read_b128 a[20:23], v6 offset:4096
  ds_read_b128 a[24:27], v5 offset:6144
  ds_read_b128 a[28:31], v6 offset:6144
  ds_read_b128 a[80:83], v7 offset:512
  ds_read_b128 a[84:87], v7 offset:8704
  s_cmp_eq_u32 s38, 0
  s_cbranch_scc0 L_c0
  s_lshl_b32 s3, s2, 6
  s_add_u32 s3, s3, 9441280
  v_mov_b32 v12, s3
  s_mov_b64 exec, 1
  buffer_store_dwordx2 v[10:11], v12, s[28:31], 0 offen sc1
  s_mov_b64 exec, -1
L_c0:
  s_waitcnt lgkmcnt(0)
.p2align 6
L_c:
  v_mfma_f32_16x16x32_bf16 v[16:19], a[0:3], a[64:67], v[16:19]
  ds_read_b128 a[88:91], v7 offset:768
  v_mfma_f32_16x16x32_bf16 v[16:19], a[4:7], a[68:71], v[16:19]
  ds_read_b128 a[92:95], v7 offset:8960
  v_mfma_f32_16x16x32_bf16 v[48:51], a[8:11], a[64:67], v[48:51]
  v_mfma_f32_16x16x32_bf16 v[48:51], a[12:15], a[68:71], v[48:51]
  s_cmp_eq_u32 s60, 147456
  v_mfma_f32_16x16x32_bf16 v[80:83], a[16:19], a[64:67], v[80:83]
  v_mfma_f32_16x16x32_bf16 v[80:83], a[20:23], a[68:71], v[80:83]
  s_cselect_b32 s60, 0, s60
  v_add_u32 v1, s60, v146
  v_mfma_f32_16x16x32_bf16 v[112:115], a[24:27], a[64:67], v[112:115]
  v_mfma_f32_16x16x32_bf16 v[112:115], a[28:31], a[68:71], v[112:115]
  v_mfma_f32_16x16x32_bf16 v[20:23], a[0:3], a[72:75], v[20:23]
  ds_read_b128 a[64:67], v7 offset:1024
  v_mfma_f32_16x16x32_bf16 v[20:23], a[4:7], a[76:79], v[20:23]
  ds_read_b128 a[68:71], v7 offset:9216
  v_mfma_f32_16x16x32_bf16 v[52:55], a[8:11], a[72:75], v[52:55]
  v_mfma_f32_16x16x32_bf16 v[52:55], a[12:15], a[76:79], v[52:55]
  v_mfma_f32_16x16x32_bf16 v[84:87], a[16:19], a[72:75], v[84:87]
  v_mfma_f32_16x16x32_bf16 v[84:87], a[20:23], a[76:79], v[84:87]
  v_mfma_f32_16x16x32_bf16 v[116:119], a[24:27], a[72:75], v[116:119]
  v_mfma_f32_16x16x32_bf16 v[116:119], a[28:31], a[76:79], v[116:119]
  v_mfma_f32_16x16x32_bf16 v[24:27], a[0:3], a[80:83], v[24:27]
  ds_read_b128 a[72:75], v7 offset:1280
  v_mfma_f32_16x16x32_bf16 v[24:27], a[4:7], a[84:87], v[24:27]
  ds_read_b128 a[76:79], v7 offset:9472
  v_mfma_f32_16x16x32_bf16 v[56:59], a[8:11], a[80:83], v[56:59]
  v_mfma_f32_16x16x32_bf16 v[56:59], a[12:15], a[84:87], v[56:59]
  v_mfma_f32_16x16x32_bf16 v[88:91], a[16:19], a[80:83], v[88:91]
  v_mfma_f32_16x16x32_bf16 v[88:91], a[20:23], a[84:87], v[88:91]
  v_mfma_f32_16x16x32_bf16 v[120:123], a[24:27], a[80:83], v[120:123]
  v_mfma_f32_16x16x32_bf16 v[120:123], a[28:31], a[84:87], v[120:123]
  v_add_u32 v3, s60, v144
  s_waitcnt lgkmcnt(0)
  v_mfma_f32_16x16x32_bf16 v[28:31], a[0:3], a[88:91], v[28:31]
  ds_read_b128 a[80:83], v7 offset:1536
  v_mfma_f32_16x16x32_bf16 v[28:31], a[4:7], a[92:95], v[28:31]
  ds_read_b128 a[84:87], v7 offset:9728
  v_mfma_f32_16x16x32_bf16 v[60:63], a[8:11], a[88:91], v[60:63]
  v_mfma_f32_16x16x32_bf16 v[60:63], a[12:15], a[92:95], v[60:63]
  v_add_u32_e64 v4, s60, v145
  v_mfma_f32_16x16x32_bf16 v[92:95], a[16:19], a[88:91], v[92:95]
  v_mfma_f32_16x16x32_bf16 v[92:95], a[20:23], a[92:95], v[92:95]
  v_mfma_f32_16x16x32_bf16 v[124:127], a[24:27], a[88:91], v[124:127]
  v_mfma_f32_16x16x32_bf16 v[124:127], a[28:31], a[92:95], v[124:127]
  v_mfma_f32_16x16x32_bf16 v[32:35], a[0:3], a[64:67], v[32:35]
  ds_read_b128 a[88:91], v7 offset:1792
  v_mfma_f32_16x16x32_bf16 v[32:35], a[4:7], a[68:71], v[32:35]
  ds_read_b128 a[92:95], v7 offset:9984
  v_mfma_f32_16x16x32_bf16 v[64:67], a[8:11], a[64:67], v[64:67]
  v_mfma_f32_16x16x32_bf16 v[64:67], a[12:15], a[68:71], v[64:67]
  v_mfma_f32_16x16x32_bf16 v[96:99], a[16:19], a[64:67], v[96:99]
  v_mfma_f32_16x16x32_bf16 v[96:99], a[20:23], a[68:71], v[96:99]
  v_mfma_f32_16x16x32_bf16 v[128:131], a[24:27], a[64:67], v[128:131]
  v_mfma_f32_16x16x32_bf16 v[128:131], a[28:31], a[68:71], v[128:131]
  s_waitcnt lgkmcnt(0)
  s_barrier
  v_mfma_f32_16x16x32_bf16 v[36:39], a[0:3], a[72:75], v[36:39]
  ds_read_b128 a[64:67], v1 offset:0
  v_mfma_f32_16x16x32_bf16 v[36:39], a[4:7], a[76:79], v[36:39]
  ds_read_b128 a[68:71], v1 offset:8192
  v_mfma_f32_16x16x32_bf16 v[68:71], a[8:11], a[72:75], v[68:71]
  ds_read_b128 a[32:35], v3 offset:0
  v_mfma_f32_16x16x32_bf16 v[68:71], a[12:15], a[76:79], v[68:71]
  ds_read_b128 a[36:39], v4 offset:0
  v_mfma_f32_16x16x32_bf16 v[100:103], a[16:19], a[72:75], v[100:103]
  ds_read_b128 a[40:43], v3 offset:2048
  v_mfma_f32_16x16x32_bf16 v[100:103], a[20:23], a[76:79], v[100:103]
  ds_read_b128 a[44:47], v4 offset:2048
  v_mfma_f32_16x16x32_bf16 v[132:135], a[24:27], a[72:75], v[132:135]
  v_mfma_f32_16x16x32_bf16 v[132:135], a[28:31], a[76:79], v[132:135]
  ds_read_b128 a[48:51], v3 offset:4096
  v_mfma_f32_16x16x32_bf16 v[40:43], a[0:3], a[80:83], v[40:43]
  ds_read_b128 a[72:75], v1 offset:256
  v_mfma_f32_16x16x32_bf16 v[40:43], a[4:7], a[84:87], v[40:43]
  ds_read_b128 a[76:79], v1 offset:8448
  v_mfma_f32_16x16x32_bf16 v[72:75], a[8:11], a[80:83], v[72:75]
  v_mfma_f32_16x16x32_bf16 v[72:75], a[12:15], a[84:87], v[72:75]
  ds_read_b128 a[52:55], v4 offset:4096
  v_mfma_f32_16x16x32_bf16 v[104:107], a[16:19], a[80:83], v[104:107]
  v_mfma_f32_16x16x32_bf16 v[104:107], a[20:23], a[84:87], v[104:107]
  ds_read_b128 a[56:59], v3 offset:6144
  v_mfma_f32_16x16x32_bf16 v[136:139], a[24:27], a[80:83], v[136:139]
  v_mfma_f32_16x16x32_bf16 v[136:139], a[28:31], a[84:87], v[136:139]
  ds_read_b128 a[60:63], v4 offset:6144
  v_mfma_f32_16x16x32_bf16 v[44:47], a[0:3], a[88:91], v[44:47]
  ds_read_b128 a[80:83], v1 offset:512
  v_mfma_f32_16x16x32_bf16 v[44:47], a[4:7], a[92:95], v[44:47]
  ds_read_b128 a[84:87], v1 offset:8704
  v_mfma_f32_16x16x32_bf16 v[76:79], a[8:11], a[88:91], v[76:79]
  v_mfma_f32_16x16x32_bf16 v[76:79], a[12:15], a[92:95], v[76:79]
  v_mfma_f32_16x16x32_bf16 v[108:111], a[16:19], a[88:91], v[108:111]
  v_mfma_f32_16x16x32_bf16 v[108:111], a[20:23], a[92:95], v[108:111]
  v_mfma_f32_16x16x32_bf16 v[140:143], a[24:27], a[88:91], v[140:143]
  v_mfma_f32_16x16x32_bf16 v[140:143], a[28:31], a[92:95], v[140:143]
  s_add_u32 s60, s60, s62
  s_waitcnt lgkmcnt(0)
  v_mfma_f32_16x16x32_bf16 v[16:19], a[32:35], a[64:67], v[16:19]
  ds_read_b128 a[88:91], v1 offset:768
  v_mfma_f32_16x16x32_bf16 v[16:19], a[36:39], a[68:71], v[16:19]
  ds_read_b128 a[92:95], v1 offset:8960
  v_mfma_f32_16x16x32_bf16 v[48:51], a[40:43], a[64:67], v[48:51]
  v_mfma_f32_16x16x32_bf16 v[48:51], a[44:47], a[68:71], v[48:51]
  s_cmp_eq_u32 s60, 147456
  v_mfma_f32_16x16x32_bf16 v[80:83], a[48:51], a[64:67], v[80:83]
  v_mfma_f32_16x16x32_bf16 v[80:83], a[52:55], a[68:71], v[80:83]
  s_cselect_b32 s60, 0, s60
  v_add_u32 v7, s60, v146
  v_mfma_f32_16x16x32_bf16 v[112:115], a[56:59], a[64:67], v[112:115]
  v_mfma_f32_16x16x32_bf16 v[112:115], a[60:63], a[68:71], v[112:115]
  v_mfma_f32_16x16x32_bf16 v[20:23], a[32:35], a[72:75], v[20:23]
  ds_read_b128 a[64:67], v1 offset:1024
  v_mfma_f32_16x16x32_bf16 v[20:23], a[36:39], a[76:79], v[20:23]
  ds_read_b128 a[68:71], v1 offset:9216
  v_mfma_f32_16x16x32_bf16 v[52:55], a[40:43], a[72:75], v[52:55]
  v_mfma_f32_16x16x32_bf16 v[52:55], a[44:47], a[76:79], v[52:55]
  v_mfma_f32_16x16x32_bf16 v[84:87], a[48:51], a[72:75], v[84:87]
  v_mfma_f32_16x16x32_bf16 v[84:87], a[52:55], a[76:79], v[84:87]
  v_mfma_f32_16x16x32_bf16 v[116:119], a[56:59], a[72:75], v[116:119]
  v_mfma_f32_16x16x32_bf16 v[116:119], a[60:63], a[76:79], v[116:119]
  v_mfma_f32_16x16x32_bf16 v[24:27], a[32:35], a[80:83], v[24:27]
  ds_read_b128 a[72:75], v1 offset:1280
  v_mfma_f32_16x16x32_bf16 v[24:27], a[36:39], a[84:87], v[24:27]
  ds_read_b128 a[76:79], v1 offset:9472
  v_mfma_f32_16x16x32_bf16 v[56:59], a[40:43], a[80:83], v[56:59]
  v_mfma_f32_16x16x32_bf16 v[56:59], a[44:47], a[84:87], v[56:59]
  v_mfma_f32_16x16x32_bf16 v[88:91], a[48:51], a[80:83], v[88:91]
  v_mfma_f32_16x16x32_bf16 v[88:91], a[52:55], a[84:87], v[88:91]
  v_mfma_f32_16x16x32_bf16 v[120:123], a[56:59], a[80:83], v[120:123]
  v_mfma_f32_16x16x32_bf16 v[120:123], a[60:63], a[84:87], v[120:123]
  v_add_u32 v5, s60, v144
  s_waitcnt lgkmcnt(0)
  v_mfma_f32_16x16x32_bf16 v[28:31], a[32:35], a[88:91], v[28:31]
  ds_read_b128 a[80:83], v1 offset:1536
  v_mfma_f32_16x16x32_bf16 v[28:31], a[36:39], a[92:95], v[28:31]
  ds_read_b128 a[84:87], v1 offset:9728
  v_mfma_f32_16x16x32_bf16 v[60:63], a[40:43], a[88:91], v[60:63]
  v_mfma_f32_16x16x32_bf16 v[60:63], a[44:47], a[92:95], v[60:63]
  v_add_u32_e64 v6, s60, v145
  v_mfma_f32_16x16x32_bf16 v[92:95], a[48:51], a[88:91], v[92:95]
  v_mfma_f32_16x16x32_bf16 v[92:95], a[52:55], a[92:95], v[92:95]
  v_mfma_f32_16x16x32_bf16 v[124:127], a[56:59], a[88:91], v[124:127]
  v_mfma_f32_16x16x32_bf16 v[124:127], a[60:63], a[92:95], v[124:127]
  v_mfma_f32_16x16x32_bf16 v[32:35], a[32:35], a[64:67], v[32:35]
  ds_read_b128 a[88:91], v1 offset:1792
  v_mfma_f32_16x16x32_bf16 v[32:35], a[36:39], a[68:71], v[32:35]
  ds_read_b128 a[92:95], v1 offset:9984
  v_mfma_f32_16x16x32_bf16 v[64:67], a[40:43], a[64:67], v[64:67]
  v_mfma_f32_16x16x32_bf16 v[64:67], a[44:47], a[68:71], v[64:67]
  v_mfma_f32_16x16x32_bf16 v[96:99], a[48:51], a[64:67], v[96:99]
  v_mfma_f32_16x16x32_bf16 v[96:99], a[52:55], a[68:71], v[96:99]
  v_mfma_f32_16x16x32_bf16 v[128:131], a[56:59], a[64:67], v[128:131]
  v_mfma_f32_16x16x32_bf16 v[128:131], a[60:63], a[68:71], v[128:131]
  s_waitcnt lgkmcnt(0)
  s_barrier
  v_mfma_f32_16x16x32_bf16 v[36:39], a[32:35], a[72:75], v[36:39]
  ds_read_b128 a[64:67], v7 offset:0
  v_mfma_f32_16x16x32_bf16 v[36:39], a[36:39], a[76:79], v[36:39]
  ds_read_b128 a[68:71], v7 offset:8192
  v_mfma_f32_16x16x32_bf16 v[68:71], a[40:43], a[72:75], v[68:71]
  ds_read_b128 a[0:3], v5 offset:0
  v_mfma_f32_16x16x32_bf16 v[68:71], a[44:47], a[76:79], v[68:71]
  ds_read_b128 a[4:7], v6 offset:0
  v_mfma_f32_16x16x32_bf16 v[100:103], a[48:51], a[72:75], v[100:103]
  ds_read_b128 a[8:11], v5 offset:2048
  v_mfma_f32_16x16x32_bf16 v[100:103], a[52:55], a[76:79], v[100:103]
  ds_read_b128 a[12:15], v6 offset:2048
  v_mfma_f32_16x16x32_bf16 v[132:135], a[56:59], a[72:75], v[132:135]
  v_mfma_f32_16x16x32_bf16 v[132:135], a[60:63], a[76:79], v[132:135]
  ds_read_b128 a[16:19], v5 offset:4096
  v_mfma_f32_16x16x32_bf16 v[40:43], a[32:35], a[80:83], v[40:43]
  ds_read_b128 a[72:75], v7 offset:256
  v_mfma_f32_16x16x32_bf16 v[40:43], a[36:39], a[84:87], v[40:43]
  ds_read_b128 a[76:79], v7 offset:8448
  v_mfma_f32_16x16x32_bf16 v[72:75], a[40:43], a[80:83], v[72:75]
  v_mfma_f32_16x16x32_bf16 v[72:75], a[44:47], a[84:87], v[72:75]
  ds_read_b128 a[20:23], v6 offset:4096
  v_mfma_f32_16x16x32_bf16 v[104:107], a[48:51], a[80:83], v[104:107]
  v_mfma_f32_16x16x32_bf16 v[104:107], a[52:55], a[84:87], v[104:107]
  ds_read_b128 a[24:27], v5 offset:6144
  v_mfma_f32_16x16x32_bf16 v[136:139], a[56:59], a[80:83], v[136:139]
  v_mfma_f32_16x16x32_bf16 v[136:139], a[60:63], a[84:87], v[136:139]
  ds_read_b128 a[28:31], v6 offset:6144
  v_mfma_f32_16x16x32_bf16 v[44:47], a[32:35], a[88:91], v[44:47]
  ds_read_b128 a[80:83], v7 offset:512
  v_mfma_f32_16x16x32_bf16 v[44:47], a[36:39], a[92:95], v[44:47]
  ds_read_b128 a[84:87], v7 offset:8704
  v_mfma_f32_16x16x32_bf16 v[76:79], a[40:43], a[88:91], v[76:79]
  v_mfma_f32_16x16x32_bf16 v[76:79], a[44:47], a[92:95], v[76:79]
  v_mfma_f32_16x16x32_bf16 v[108:111], a[48:51], a[88:91], v[108:111]
  v_mfma_f32_16x16x32_bf16 v[108:111], a[52:55], a[92:95], v[108:111]
  v_mfma_f32_16x16x32_bf16 v[140:143], a[56:59], a[88:91], v[140:143]
  s_add_u32 s60, s60, s62
  s_sub_u32 s61, s61, 1
  v_mfma_f32_16x16x32_bf16 v[140:143], a[60:63], a[92:95], v[140:143]
  s_waitcnt lgkmcnt(0)
  s_cbranch_scc0 L_c
  v_mfma_f32_16x16x32_bf16 v[16:19], a[0:3], a[64:67], v[16:19]
  ds_read_b128 a[88:91], v7 offset:768
  v_mfma_f32_16x16x32_bf16 v[16:19], a[4:7], a[68:71], v[16:19]
  ds_read_b128 a[92:95], v7 offset:8960
  v_mfma_f32_16x16x32_bf16 v[48:51], a[8:11], a[64:67], v[48:51]
  v_mfma_f32_16x16x32_bf16 v[48:51], a[12:15], a[68:71], v[48:51]
  v_mfma_f32_16x16x32_bf16 v[80:83], a[16:19], a[64:67], v[80:83]
  v_mfma_f32_16x16x32_bf16 v[80:83], a[20:23], a[68:71], v[80:83]
  v_add_u32 v8, 49152, v144
  v_mfma_f32_16x16x32_bf16 v[112:115], a[24:27], a[64:67], v[112:115]
  v_mfma_f32_16x16x32_bf16 v[112:115], a[28:31], a[68:71], v[112:115]
  v_add_u32 v9, 49152, v145
  v_mfma_f32_16x16x32_bf16 v[20:23], a[0:3], a[72:75], v[20:23]
  ds_read_b128 a[64:67], v7 offset:1024
  v_mfma_f32_16x16x32_bf16 v[20:23], a[4:7], a[76:79], v[20:23]
  ds_read_b128 a[68:71], v7 offset:9216
  v_mfma_f32_16x16x32_bf16 v[52:55], a[8:11], a[72:75], v[52:55]
  v_mfma_f32_16x16x32_bf16 v[52:55], a[12:15], a[76:79], v[52:55]
  v_mfma_f32_16x16x32_bf16 v[84:87], a[16:19], a[72:75], v[84:87]
  v_mfma_f32_16x16x32_bf16 v[84:87], a[20:23], a[76:79], v[84:87]
  v_add_u32 v10, 49152, v146
  v_mfma_f32_16x16x32_bf16 v[116:119], a[24:27], a[72:75], v[116:119]
  v_mfma_f32_16x16x32_bf16 v[116:119], a[28:31], a[76:79], v[116:119]
  v_mfma_f32_16x16x32_bf16 v[24:27], a[0:3], a[80:83], v[24:27]
  v_add_u32 v11, 98304, v144
  v_mfma_f32_16x16x32_bf16 v[24:27], a[4:7], a[84:87], v[24:27]
  ds_read_b128 a[72:75], v7 offset:1280
  ds_read_b128 a[76:79], v7 offset:9472
  v_mfma_f32_16x16x32_bf16 v[56:59], a[8:11], a[80:83], v[56:59]
  v_mfma_f32_16x16x32_bf16 v[56:59], a[12:15], a[84:87], v[56:59]
  v_add_u32 v12, 98304, v145
  v_mfma_f32_16x16x32_bf16 v[88:91], a[16:19], a[80:83], v[88:91]
  v_mfma_f32_16x16x32_bf16 v[88:91], a[20:23], a[84:87], v[88:91]
  v_mfma_f32_16x16x32_bf16 v[120:123], a[24:27], a[80:83], v[120:123]
  v_mfma_f32_16x16x32_bf16 v[120:123], a[28:31], a[84:87], v[120:123]
  s_waitcnt lgkmcnt(0)
  s_nop 0
  v_mfma_f32_16x16x32_bf16 v[28:31], a[0:3], a[88:91], v[28:31]
  v_add_u32 v13, 98304, v146
  v_mfma_f32_16x16x32_bf16 v[28:31], a[4:7], a[92:95], v[28:31]
  ds_read_b128 a[80:83], v7 offset:1536
  ds_read_b128 a[84:87], v7 offset:9728
  v_mfma_f32_16x16x32_bf16 v[60:63], a[8:11], a[88:91], v[60:63]
  v_mfma_f32_16x16x32_bf16 v[60:63], a[12:15], a[92:95], v[60:63]
  v_mfma_f32_16x16x32_bf16 v[92:95], a[16:19], a[88:91], v[92:95]
  v_mfma_f32_16x16x32_bf16 v[92:95], a[20:23], a[92:95], v[92:95]
  v_add_u32_e64 v14, s63, v144
  v_mfma_f32_16x16x32_bf16 v[124:127], a[24:27], a[88:91], v[124:127]
  v_mfma_f32_16x16x32_bf16 v[124:127], a[28:31], a[92:95], v[124:127]
  v_add_u32_e64 v15, s63, v145
  v_mfma_f32_16x16x32_bf16 v[32:35], a[0:3], a[64:67], v[32:35]
  ds_read_b128 a[88:91], v7 offset:1792
  v_mfma_f32_16x16x32_bf16 v[32:35], a[4:7], a[68:71], v[32:35]
  ds_read_b128 a[92:95], v7 offset:9984
  v_mfma_f32_16x16x32_bf16 v[64:67], a[8:11], a[64:67], v[64:67]
  v_mfma_f32_16x16x32_bf16 v[64:67], a[12:15], a[68:71], v[64:67]
  v_mfma_f32_16x16x32_bf16 v[96:99], a[16:19], a[64:67], v[96:99]
  v_mfma_f32_16x16x32_bf16 v[96:99], a[20:23], a[68:71], v[96:99]
  v_mfma_f32_16x16x32_bf16 v[128:131], a[24:27], a[64:67], v[128:131]
  v_mfma_f32_16x16x32_bf16 v[128:131], a[28:31], a[68:71], v[128:131]
  s_waitcnt lgkmcnt(0)
  s_barrier
  v_mfma_f32_16x16x32_bf16 v[36:39], a[0:3], a[72:75], v[36:39]
  v_mfma_f32_16x16x32_bf16 v[36:39], a[4:7], a[76:79], v[36:39]
  v_mfma_f32_16x16x32_bf16 v[68:71], a[8:11], a[72:75], v[68:71]
  v_mfma_f32_16x16x32_bf16 v[68:71], a[12:15], a[76:79], v[68:71]
  v_mfma_f32_16x16x32_bf16 v[100:103], a[16:19], a[72:75], v[100:103]
  v_mfma_f32_16x16x32_bf16 v[100:103], a[20:23], a[76:79], v[100:103]
  v_mfma_f32_16x16x32_bf16 v[132:135], a[24:27], a[72:75], v[132:135]
  v_mfma_f32_16x16x32_bf16 v[132:135], a[28:31], a[76:79], v[132:135]
  v_mfma_f32_16x16x32_bf16 v[40:43], a[0:3], a[80:83], v[40:43]
  ds_read_b128 a[32:35], v10 offset:0
  v_mfma_f32_16x16x32_bf16 v[40:43], a[4:7], a[84:87], v[40:43]
  ds_read_b128 a[36:39], v8 offset:0
  v_mfma_f32_16x16x32_bf16 v[72:75], a[8:11], a[80:83], v[72:75]
  ds_read_b128 a[40:43], v8 offset:2048
  v_mfma_f32_16x16x32_bf16 v[72:75], a[12:15], a[84:87], v[72:75]
  ds_read_b128 a[44:47], v10 offset:256
  v_mfma_f32_16x16x32_bf16 v[104:107], a[16:19], a[80:83], v[104:107]
  ds_read_b128 a[48:51], v10 offset:512
  v_mfma_f32_16x16x32_bf16 v[104:107], a[20:23], a[84:87], v[104:107]
  ds_read_b128 a[52:55], v10 offset:768
  v_mfma_f32_16x16x32_bf16 v[136:139], a[24:27], a[80:83], v[136:139]
  v_mfma_f32_16x16x32_bf16 v[136:139], a[28:31], a[84:87], v[136:139]
  v_mfma_f32_16x16x32_bf16 v[44:47], a[0:3], a[88:91], v[44:47]
  ds_read_b128 a[56:59], v10 offset:8192
  v_mfma_f32_16x16x32_bf16 v[44:47], a[4:7], a[92:95], v[44:47]
  ds_read_b128 a[60:63], v9 offset:0
  v_mfma_f32_16x16x32_bf16 v[76:79], a[8:11], a[88:91], v[76:79]
  ds_read_b128 a[64:67], v9 offset:2048
  v_mfma_f32_16x16x32_bf16 v[76:79], a[12:15], a[92:95], v[76:79]
  ds_read_b128 a[68:71], v10 offset:8448
  v_mfma_f32_16x16x32_bf16 v[108:111], a[16:19], a[88:91], v[108:111]
  ds_read_b128 a[72:75], v10 offset:8704
  v_mfma_f32_16x16x32_bf16 v[108:111], a[20:23], a[92:95], v[108:111]
  ds_read_b128 a[76:79], v10 offset:8960
  v_mfma_f32_16x16x32_bf16 v[140:143], a[24:27], a[88:91], v[140:143]
  v_mfma_f32_16x16x32_bf16 v[140:143], a[28:31], a[92:95], v[140:143]
  s_waitcnt lgkmcnt(4)
  s_nop 0
  v_mfma_f32_16x16x32_bf16 v[16:19], a[36:39], a[32:35], v[16:19]
  s_barrier
  ds_read_b128 a[80:83], v13 offset:0
  ds_read_b128 a[84:87], v11 offset:0
  s_nop 0
  v_mfma_f32_16x16x32_bf16 v[48:51], a[40:43], a[32:35], v[48:51]
  ds_read_b128 a[0:3], v11 offset:2048
  ds_read_b128 a[4:7], v13 offset:256
  v_mfma_f32_16x16x32_bf16 v[20:23], a[36:39], a[44:47], v[20:23]
  ds_read_b128 a[8:11], v13 offset:512
  ds_read_b128 a[12:15], v13 offset:768
  v_mfma_f32_16x16x32_bf16 v[52:55], a[40:43], a[44:47], v[52:55]
  v_mfma_f32_16x16x32_bf16 v[24:27], a[36:39], a[48:51], v[24:27]
  v_mfma_f32_16x16x32_bf16 v[56:59], a[40:43], a[48:51], v[56:59]
  v_mfma_f32_16x16x32_bf16 v[28:31], a[36:39], a[52:55], v[28:31]
  v_mfma_f32_16x16x32_bf16 v[60:63], a[40:43], a[52:55], v[60:63]
  v_mfma_f32_16x16x32_bf16 v[16:19], a[60:63], a[56:59], v[16:19]
  ds_read_b128 a[16:19], v13 offset:8192
  ds_read_b128 a[20:23], v12 offset:0
  s_waitcnt lgkmcnt(2)
  s_nop 0
  v_mfma_f32_16x16x32_bf16 v[48:51], a[64:67], a[56:59], v[48:51]
  ds_read_b128 a[24:27], v12 offset:2048
  ds_read_b128 a[28:31], v13 offset:8448
  v_mfma_f32_16x16x32_bf16 v[20:23], a[60:63], a[68:71], v[20:23]
  ds_read_b128 a[88:91], v13 offset:8704
  ds_read_b128 a[92:95], v13 offset:8960
  v_mfma_f32_16x16x32_bf16 v[52:55], a[64:67], a[68:71], v[52:55]
  v_mfma_f32_16x16x32_bf16 v[24:27], a[60:63], a[72:75], v[24:27]
  v_mfma_f32_16x16x32_bf16 v[56:59], a[64:67], a[72:75], v[56:59]
  v_mfma_f32_16x16x32_bf16 v[28:31], a[60:63], a[76:79], v[28:31]
  v_mfma_f32_16x16x32_bf16 v[60:63], a[64:67], a[76:79], v[60:63]
  v_mfma_f32_16x16x32_bf16 v[16:19], a[84:87], a[80:83], v[16:19]
  s_barrier
  ds_read_b128 a[32:35], v146 offset:0
  ds_read_b128 a[44:47], v14 offset:0
  s_nop 0
  v_mfma_f32_16x16x32_bf16 v[48:51], a[0:3], a[80:83], v[48:51]
  ds_read_b128 a[48:51], v14 offset:2048
  ds_read_b128 a[36:39], v146 offset:256
  v_mfma_f32_16x16x32_bf16 v[20:23], a[84:87], a[4:7], v[20:23]
  ds_read_b128 a[40:43], v146 offset:512
  ds_read_b128 a[52:55], v146 offset:768
  v_mfma_f32_16x16x32_bf16 v[52:55], a[0:3], a[4:7], v[52:55]
  v_mfma_f32_16x16x32_bf16 v[24:27], a[84:87], a[8:11], v[24:27]
  v_mfma_f32_16x16x32_bf16 v[56:59], a[0:3], a[8:11], v[56:59]
  v_mfma_f32_16x16x32_bf16 v[28:31], a[84:87], a[12:15], v[28:31]
  v_mfma_f32_16x16x32_bf16 v[60:63], a[0:3], a[12:15], v[60:63]
  s_waitcnt lgkmcnt(0)
  s_nop 0
  v_mfma_f32_16x16x32_bf16 v[16:19], a[20:23], a[16:19], v[16:19]
  ds_read_b128 a[56:59], v146 offset:8192
  ds_read_b128 a[68:71], v15 offset:0
  v_mfma_f32_16x16x32_bf16 v[48:51], a[24:27], a[16:19], v[48:51]
  ds_read_b128 a[72:75], v15 offset:2048
  ds_read_b128 a[60:63], v146 offset:8448
  v_mfma_f32_16x16x32_bf16 v[20:23], a[20:23], a[28:31], v[20:23]
  ds_read_b128 a[64:67], v146 offset:8704
  ds_read_b128 a[76:79], v146 offset:8960
  v_mfma_f32_16x16x32_bf16 v[52:55], a[24:27], a[28:31], v[52:55]
  v_mfma_f32_16x16x32_bf16 v[24:27], a[20:23], a[88:91], v[24:27]
  v_mfma_f32_16x16x32_bf16 v[56:59], a[24:27], a[88:91], v[56:59]
  v_mfma_f32_16x16x32_bf16 v[28:31], a[20:23], a[92:95], v[28:31]
  v_mfma_f32_16x16x32_bf16 v[60:63], a[24:27], a[92:95], v[60:63]
  v_mfma_f32_16x16x32_bf16 v[16:19], a[44:47], a[32:35], v[16:19]
  ds_read_b128 a[80:83], v10 offset:1024
  ds_read_b128 a[4:7], v8 offset:0
  v_mfma_f32_16x16x32_bf16 v[48:51], a[48:51], a[32:35], v[48:51]
  ds_read_b128 a[8:11], v8 offset:2048
  ds_read_b128 a[84:87], v10 offset:1280
  v_mfma_f32_16x16x32_bf16 v[20:23], a[44:47], a[36:39], v[20:23]
  ds_read_b128 a[0:3], v10 offset:1536
  ds_read_b128 a[12:15], v10 offset:1792
  v_mfma_f32_16x16x32_bf16 v[52:55], a[48:51], a[36:39], v[52:55]
  v_mfma_f32_16x16x32_bf16 v[24:27], a[44:47], a[40:43], v[24:27]
  v_mfma_f32_16x16x32_bf16 v[56:59], a[48:51], a[40:43], v[56:59]
  v_mfma_f32_16x16x32_bf16 v[28:31], a[44:47], a[52:55], v[28:31]
  v_mfma_f32_16x16x32_bf16 v[60:63], a[48:51], a[52:55], v[60:63]
  s_waitcnt lgkmcnt(0)
  s_nop 0
  v_mfma_f32_16x16x32_bf16 v[16:19], a[68:71], a[56:59], v[16:19]
  ds_read_b128 a[16:19], v10 offset:9216
  ds_read_b128 a[28:31], v9 offset:0
  v_mfma_f32_16x16x32_bf16 v[48:51], a[72:75], a[56:59], v[48:51]
  ds_read_b128 a[88:91], v9 offset:2048
  ds_read_b128 a[20:23], v10 offset:9472
  v_mfma_f32_16x16x32_bf16 v[20:23], a[68:71], a[60:63], v[20:23]
  ds_read_b128 a[24:27], v10 offset:9728
  ds_read_b128 a[92:95], v10 offset:9984
  v_mfma_f32_16x16x32_bf16 v[52:55], a[72:75], a[60:63], v[52:55]
  v_mfma_f32_16x16x32_bf16 v[24:27], a[68:71], a[64:67], v[24:27]
  v_mfma_f32_16x16x32_bf16 v[56:59], a[72:75], a[64:67], v[56:59]
  v_mfma_f32_16x16x32_bf16 v[28:31], a[68:71], a[76:79], v[28:31]
  v_mfma_f32_16x16x32_bf16 v[60:63], a[72:75], a[76:79], v[60:63]
  v_mfma_f32_16x16x32_bf16 v[32:35], a[4:7], a[80:83], v[32:35]
  ds_read_b128 a[32:35], v13 offset:1024
  ds_read_b128 a[36:39], v11 offset:0
  v_mfma_f32_16x16x32_bf16 v[64:67], a[8:11], a[80:83], v[64:67]
  ds_read_b128 a[40:43], v11 offset:2048
  ds_read_b128 a[44:47], v13 offset:1280
  v_mfma_f32_16x16x32_bf16 v[36:39], a[4:7], a[84:87], v[36:39]
  v_cvt_pk_bf16_f32 v150, v17, v21
  v_cvt_pk_bf16_f32 v151, v25, v29
  ds_read_b128 a[48:51], v13 offset:1536
  ds_read_b128 a[52:55], v13 offset:1792
  v_mfma_f32_16x16x32_bf16 v[68:71], a[8:11], a[84:87], v[68:71]
  v_cvt_pk_bf16_f32 v148, v16, v20
  v_cvt_pk_bf16_f32 v149, v24, v28
  v_mfma_f32_16x16x32_bf16 v[40:43], a[4:7], a[0:3], v[40:43]
  v_cndmask_b32_dpp v152, v150, v148, vcc quad_perm:[1,0,3,2] row_mask:0xf bank_mask:0xf
  v_cndmask_b32_dpp v153, v151, v149, vcc quad_perm:[1,0,3,2] row_mask:0xf bank_mask:0xf
  v_mfma_f32_16x16x32_bf16 v[72:75], a[8:11], a[0:3], v[72:75]
  s_not_b64 vcc, vcc
  s_nop 0
  v_mfma_f32_16x16x32_bf16 v[44:47], a[4:7], a[12:15], v[44:47]
  v_cndmask_b32_dpp v154, v148, v150, vcc quad_perm:[1,0,3,2] row_mask:0xf bank_mask:0xf
  v_cndmask_b32_dpp v155, v149, v151, vcc quad_perm:[1,0,3,2] row_mask:0xf bank_mask:0xf
  v_mfma_f32_16x16x32_bf16 v[76:79], a[8:11], a[12:15], v[76:79]
  buffer_store_dwordx4 v[152:155], v147, s[32:35], s44 offen offset:0 sc0 sc1
  v_cvt_pk_bf16_f32 v148, v18, v22
  s_waitcnt lgkmcnt(0)
  s_nop 0
  v_mfma_f32_16x16x32_bf16 v[32:35], a[28:31], a[16:19], v[32:35]
  v_cvt_pk_bf16_f32 v149, v26, v30
  v_cvt_pk_bf16_f32 v150, v19, v23
  ds_read_b128 a[56:59], v13 offset:9216
  ds_read_b128 a[60:63], v12 offset:0
  v_mfma_f32_16x16x32_bf16 v[64:67], a[88:91], a[16:19], v[64:67]
  v_cvt_pk_bf16_f32 v151, v27, v31
  ds_read_b128 a[64:67], v12 offset:2048
  ds_read_b128 a[68:71], v13 offset:9472
  v_mfma_f32_16x16x32_bf16 v[36:39], a[28:31], a[20:23], v[36:39]
  v_cndmask_b32_dpp v158, v148, v150, vcc quad_perm:[1,0,3,2] row_mask:0xf bank_mask:0xf
  v_cndmask_b32_dpp v159, v149, v151, vcc quad_perm:[1,0,3,2] row_mask:0xf bank_mask:0xf
  ds_read_b128 a[72:75], v13 offset:9728
  ds_read_b128 a[76:79], v13 offset:9984
  v_mfma_f32_16x16x32_bf16 v[68:71], a[88:91], a[20:23], v[68:71]
  s_not_b64 vcc, vcc
  v_cndmask_b32_dpp v156, v150, v148, vcc quad_perm:[1,0,3,2] row_mask:0xf bank_mask:0xf
  s_nop 0
  v_mfma_f32_16x16x32_bf16 v[40:43], a[28:31], a[24:27], v[40:43]
  v_cndmask_b32_dpp v157, v151, v149, vcc quad_perm:[1,0,3,2] row_mask:0xf bank_mask:0xf
  buffer_store_dwordx4 v[156:159], v147, s[32:35], s46 offen offset:0 sc0 sc1
  v_mfma_f32_16x16x32_bf16 v[72:75], a[88:91], a[24:27], v[72:75]
  v_cvt_pk_bf16_f32 v150, v49, v53
  v_mfma_f32_16x16x32_bf16 v[44:47], a[28:31], a[92:95], v[44:47]
  v_cvt_pk_bf16_f32 v151, v57, v61
  v_cvt_pk_bf16_f32 v148, v48, v52
  v_mfma_f32_16x16x32_bf16 v[76:79], a[88:91], a[92:95], v[76:79]
  v_cvt_pk_bf16_f32 v149, v56, v60
  v_cndmask_b32_dpp v152, v150, v148, vcc quad_perm:[1,0,3,2] row_mask:0xf bank_mask:0xf
  v_mfma_f32_16x16x32_bf16 v[32:35], a[36:39], a[32:35], v[32:35]
  v_cndmask_b32_dpp v153, v151, v149, vcc quad_perm:[1,0,3,2] row_mask:0xf bank_mask:0xf
  s_not_b64 vcc, vcc
  s_barrier
  ds_read_b128 a[80:83], v146 offset:1024
  ds_read_b128 a[84:87], v14 offset:0
  v_mfma_f32_16x16x32_bf16 v[64:67], a[40:43], a[32:35], v[64:67]
  v_cndmask_b32_dpp v154, v148, v150, vcc quad_perm:[1,0,3,2] row_mask:0xf bank_mask:0xf
  ds_read_b128 a[0:3], v14 offset:2048
  ds_read_b128 a[4:7], v146 offset:1280
  v_mfma_f32_16x16x32_bf16 v[36:39], a[36:39], a[44:47], v[36:39]
  v_cndmask_b32_dpp v155, v149, v151, vcc quad_perm:[1,0,3,2] row_mask:0xf bank_mask:0xf
  buffer_store_dwordx4 v[152:155], v147, s[32:35], s48 offen offset:0 sc0 sc1
  ds_read_b128 a[8:11], v146 offset:1536
  ds_read_b128 a[12:15], v146 offset:1792
  v_mfma_f32_16x16x32_bf16 v[68:71], a[40:43], a[44:47], v[68:71]
  v_cvt_pk_bf16_f32 v148, v50, v54
  v_cvt_pk_bf16_f32 v149, v58, v62
  v_mfma_f32_16x16x32_bf16 v[40:43], a[36:39], a[48:51], v[40:43]
  v_cvt_pk_bf16_f32 v150, v51, v55
  v_cvt_pk_bf16_f32 v151, v59, v63
  v_mfma_f32_16x16x32_bf16 v[72:75], a[40:43], a[48:51], v[72:75]
  v_cndmask_b32_dpp v158, v148, v150, vcc quad_perm:[1,0,3,2] row_mask:0xf bank_mask:0xf
  v_mfma_f32_16x16x32_bf16 v[44:47], a[36:39], a[52:55], v[44:47]
  v_cndmask_b32_dpp v159, v149, v151, vcc quad_perm:[1,0,3,2] row_mask:0xf bank_mask:0xf
  s_not_b64 vcc, vcc
  s_nop 0
  v_mfma_f32_16x16x32_bf16 v[76:79], a[40:43], a[52:55], v[76:79]
  v_cndmask_b32_dpp v156, v150, v148, vcc quad_perm:[1,0,3,2] row_mask:0xf bank_mask:0xf
  v_cndmask_b32_dpp v157, v151, v149, vcc quad_perm:[1,0,3,2] row_mask:0xf bank_mask:0xf
  s_waitcnt lgkmcnt(0)
  s_nop 0
  v_mfma_f32_16x16x32_bf16 v[32:35], a[60:63], a[56:59], v[32:35]
  buffer_store_dwordx4 v[156:159], v147, s[32:35], s50 offen offset:0 sc0 sc1
  ds_read_b128 a[16:19], v146 offset:9216
  ds_read_b128 a[20:23], v15 offset:0
  v_mfma_f32_16x16x32_bf16 v[64:67], a[64:67], a[56:59], v[64:67]
  ds_read_b128 a[24:27], v15 offset:2048
  ds_read_b128 a[28:31], v146 offset:9472
  v_mfma_f32_16x16x32_bf16 v[36:39], a[60:63], a[68:71], v[36:39]
  ds_read_b128 a[88:91], v146 offset:9728
  ds_read_b128 a[92:95], v146 offset:9984
  v_mfma_f32_16x16x32_bf16 v[68:71], a[64:67], a[68:71], v[68:71]
  v_mfma_f32_16x16x32_bf16 v[40:43], a[60:63], a[72:75], v[40:43]
  v_mfma_f32_16x16x32_bf16 v[72:75], a[64:67], a[72:75], v[72:75]
  v_mfma_f32_16x16x32_bf16 v[44:47], a[60:63], a[76:79], v[44:47]
  v_mfma_f32_16x16x32_bf16 v[76:79], a[64:67], a[76:79], v[76:79]
  v_mfma_f32_16x16x32_bf16 v[32:35], a[84:87], a[80:83], v[32:35]
  ds_read_b128 a[32:35], v10 offset:0
  ds_read_b128 a[44:47], v8 offset:4096
  v_mfma_f32_16x16x32_bf16 v[64:67], a[0:3], a[80:83], v[64:67]
  ds_read_b128 a[48:51], v8 offset:6144
  ds_read_b128 a[36:39], v10 offset:256
  v_mfma_f32_16x16x32_bf16 v[36:39], a[84:87], a[4:7], v[36:39]
  ds_read_b128 a[40:43], v10 offset:512
  ds_read_b128 a[52:55], v10 offset:768
  v_mfma_f32_16x16x32_bf16 v[68:71], a[0:3], a[4:7], v[68:71]
  v_mfma_f32_16x16x32_bf16 v[40:43], a[84:87], a[8:11], v[40:43]
  v_mfma_f32_16x16x32_bf16 v[72:75], a[0:3], a[8:11], v[72:75]
  v_mfma_f32_16x16x32_bf16 v[44:47], a[84:87], a[12:15], v[44:47]
  v_mfma_f32_16x16x32_bf16 v[76:79], a[0:3], a[12:15], v[76:79]
  s_waitcnt lgkmcnt(0)
  s_nop 0
  v_mfma_f32_16x16x32_bf16 v[32:35], a[20:23], a[16:19], v[32:35]
  ds_read_b128 a[56:59], v10 offset:8192
  ds_read_b128 a[68:71], v9 offset:4096
  v_mfma_f32_16x16x32_bf16 v[64:67], a[24:27], a[16:19], v[64:67]
  ds_read_b128 a[72:75], v9 offset:6144
  ds_read_b128 a[60:63], v10 offset:8448
  v_mfma_f32_16x16x32_bf16 v[36:39], a[20:23], a[28:31], v[36:39]
  ds_read_b128 a[64:67], v10 offset:8704
  ds_read_b128 a[76:79], v10 offset:8960
  v_mfma_f32_16x16x32_bf16 v[68:71], a[24:27], a[28:31], v[68:71]
  v_mfma_f32_16x16x32_bf16 v[40:43], a[20:23], a[88:91], v[40:43]
  v_mfma_f32_16x16x32_bf16 v[72:75], a[24:27], a[88:91], v[72:75]
  v_mfma_f32_16x16x32_bf16 v[44:47], a[20:23], a[92:95], v[44:47]
  v_mfma_f32_16x16x32_bf16 v[76:79], a[24:27], a[92:95], v[76:79]
  v_mfma_f32_16x16x32_bf16 v[80:83], a[44:47], a[32:35], v[80:83]
  ds_read_b128 a[80:83], v13 offset:0
  ds_read_b128 a[4:7], v11 offset:4096
  v_mfma_f32_16x16x32_bf16 v[112:115], a[48:51], a[32:35], v[112:115]
  ds_read_b128 a[8:11], v11 offset:6144
  ds_read_b128 a[84:87], v13 offset:256
  v_mfma_f32_16x16x32_bf16 v[84:87], a[44:47], a[36:39], v[84:87]
  v_cvt_pk_bf16_f32 v150, v33, v37
  v_cvt_pk_bf16_f32 v151, v41, v45
  ds_read_b128 a[0:3], v13 offset:512
  ds_read_b128 a[12:15], v13 offset:768
  v_mfma_f32_16x16x32_bf16 v[116:119], a[48:51], a[36:39], v[116:119]
  v_cvt_pk_bf16_f32 v148, v32, v36
  v_cvt_pk_bf16_f32 v149, v40, v44
  v_mfma_f32_16x16x32_bf16 v[88:91], a[44:47], a[40:43], v[88:91]
  v_cndmask_b32_dpp v152, v150, v148, vcc quad_perm:[1,0,3,2] row_mask:0xf bank_mask:0xf
  v_cndmask_b32_dpp v153, v151, v149, vcc quad_perm:[1,0,3,2] row_mask:0xf bank_mask:0xf
  v_mfma_f32_16x16x32_bf16 v[120:123], a[48:51], a[40:43], v[120:123]
  s_not_b64 vcc, vcc
  s_nop 0
  v_mfma_f32_16x16x32_bf16 v[92:95], a[44:47], a[52:55], v[92:95]
  v_cndmask_b32_dpp v154, v148, v150, vcc quad_perm:[1,0,3,2] row_mask:0xf bank_mask:0xf
  v_cndmask_b32_dpp v155, v149, v151, vcc quad_perm:[1,0,3,2] row_mask:0xf bank_mask:0xf
  v_mfma_f32_16x16x32_bf16 v[124:127], a[48:51], a[52:55], v[124:127]
  buffer_store_dwordx4 v[152:155], v147, s[32:35], s44 offen offset:128 sc0 sc1
  v_cvt_pk_bf16_f32 v148, v34, v38
  s_waitcnt lgkmcnt(0)
  s_nop 0
  v_mfma_f32_16x16x32_bf16 v[80:83], a[68:71], a[56:59], v[80:83]
  v_cvt_pk_bf16_f32 v149, v42, v46
  v_cvt_pk_bf16_f32 v150, v35, v39
  ds_read_b128 a[16:19], v13 offset:8192
  ds_read_b128 a[28:31], v12 offset:4096
  v_mfma_f32_16x16x32_bf16 v[112:115], a[72:75], a[56:59], v[112:115]
  v_cvt_pk_bf16_f32 v151, v43, v47
  ds_read_b128 a[88:91], v12 offset:6144
  ds_read_b128 a[20:23], v13 offset:8448
  v_mfma_f32_16x16x32_bf16 v[84:87], a[68:71], a[60:63], v[84:87]
  v_cndmask_b32_dpp v158, v148, v150, vcc quad_perm:[1,0,3,2] row_mask:0xf bank_mask:0xf
  v_cndmask_b32_dpp v159, v149, v151, vcc quad_perm:[1,0,3,2] row_mask:0xf bank_mask:0xf
  ds_read_b128 a[24:27], v13 offset:8704
  ds_read_b128 a[92:95], v13 offset:8960
  v_mfma_f32_16x16x32_bf16 v[116:119], a[72:75], a[60:63], v[116:119]
  s_not_b64 vcc, vcc
  v_cndmask_b32_dpp v156, v150, v148, vcc quad_perm:[1,0,3,2] row_mask:0xf bank_mask:0xf
  s_nop 0
  v_mfma_f32_16x16x32_bf16 v[88:91], a[68:71], a[64:67], v[88:91]
  v_cndmask_b32_dpp v157, v151, v149, vcc quad_perm:[1,0,3,2] row_mask:0xf bank_mask:0xf
  buffer_store_dwordx4 v[156:159], v147, s[32:35], s46 offen offset:128 sc0 sc1
  v_mfma_f32_16x16x32_bf16 v[120:123], a[72:75], a[64:67], v[120:123]
  v_cvt_pk_bf16_f32 v150, v65, v69
  v_mfma_f32_16x16x32_bf16 v[92:95], a[68:71], a[76:79], v[92:95]
  v_cvt_pk_bf16_f32 v151, v73, v77
  v_cvt_pk_bf16_f32 v148, v64, v68
  v_mfma_f32_16x16x32_bf16 v[124:127], a[72:75], a[76:79], v[124:127]
  v_cvt_pk_bf16_f32 v149, v72, v76
  v_cndmask_b32_dpp v152, v150, v148, vcc quad_perm:[1,0,3,2] row_mask:0xf bank_mask:0xf
  v_mfma_f32_16x16x32_bf16 v[80:83], a[4:7], a[80:83], v[80:83]
  v_cndmask_b32_dpp v153, v151, v149, vcc quad_perm:[1,0,3,2] row_mask:0xf bank_mask:0xf
  s_not_b64 vcc, vcc
  ds_read_b128 a[32:35], v146 offset:0
  ds_read_b128 a[36:39], v144 offset:4096
  s_nop 0
  v_mfma_f32_16x16x32_bf16 v[112:115], a[8:11], a[80:83], v[112:115]
  v_cndmask_b32_dpp v154, v148, v150, vcc quad_perm:[1,0,3,2] row_mask:0xf bank_mask:0xf
  ds_read_b128 a[40:43], v144 offset:6144
  ds_read_b128 a[44:47], v146 offset:256
  v_mfma_f32_16x16x32_bf16 v[84:87], a[4:7], a[84:87], v[84:87]
  v_cndmask_b32_dpp v155, v149, v151, vcc quad_perm:[1,0,3,2] row_mask:0xf bank_mask:0xf
  buffer_store_dwordx4 v[152:155], v147, s[32:35], s48 offen offset:128 sc0 sc1
  ds_read_b128 a[48:51], v146 offset:512
  ds_read_b128 a[52:55], v146 offset:768
  v_mfma_f32_16x16x32_bf16 v[116:119], a[8:11], a[84:87], v[116:119]
  v_cvt_pk_bf16_f32 v148, v66, v70
  v_cvt_pk_bf16_f32 v149, v74, v78
  v_mfma_f32_16x16x32_bf16 v[88:91], a[4:7], a[0:3], v[88:91]
  v_cvt_pk_bf16_f32 v150, v67, v71
  v_cvt_pk_bf16_f32 v151, v75, v79
  v_mfma_f32_16x16x32_bf16 v[120:123], a[8:11], a[0:3], v[120:123]
  v_cndmask_b32_dpp v158, v148, v150, vcc quad_perm:[1,0,3,2] row_mask:0xf bank_mask:0xf
  v_mfma_f32_16x16x32_bf16 v[92:95], a[4:7], a[12:15], v[92:95]
  v_cndmask_b32_dpp v159, v149, v151, vcc quad_perm:[1,0,3,2] row_mask:0xf bank_mask:0xf
  s_not_b64 vcc, vcc
  s_nop 0
  v_mfma_f32_16x16x32_bf16 v[124:127], a[8:11], a[12:15], v[124:127]
  v_cndmask_b32_dpp v156, v150, v148, vcc quad_perm:[1,0,3,2] row_mask:0xf bank_mask:0xf
  v_cndmask_b32_dpp v157, v151, v149, vcc quad_perm:[1,0,3,2] row_mask:0xf bank_mask:0xf
  s_waitcnt lgkmcnt(0)
  s_nop 0
  v_mfma_f32_16x16x32_bf16 v[80:83], a[28:31], a[16:19], v[80:83]
  buffer_store_dwordx4 v[156:159], v147, s[32:35], s50 offen offset:128 sc0 sc1
  ds_read_b128 a[56:59], v146 offset:8192
  ds_read_b128 a[60:63], v145 offset:4096
  v_mfma_f32_16x16x32_bf16 v[112:115], a[88:91], a[16:19], v[112:115]
  ds_read_b128 a[64:67], v145 offset:6144
  ds_read_b128 a[68:71], v146 offset:8448
  v_mfma_f32_16x16x32_bf16 v[84:87], a[28:31], a[20:23], v[84:87]
  ds_read_b128 a[72:75], v146 offset:8704
  ds_read_b128 a[76:79], v146 offset:8960
  v_mfma_f32_16x16x32_bf16 v[116:119], a[88:91], a[20:23], v[116:119]
  v_mfma_f32_16x16x32_bf16 v[88:91], a[28:31], a[24:27], v[88:91]
  v_mfma_f32_16x16x32_bf16 v[120:123], a[88:91], a[24:27], v[120:123]
  v_mfma_f32_16x16x32_bf16 v[92:95], a[28:31], a[92:95], v[92:95]
  v_mfma_f32_16x16x32_bf16 v[124:127], a[88:91], a[92:95], v[124:127]
  v_mfma_f32_16x16x32_bf16 v[80:83], a[36:39], a[32:35], v[80:83]
  ds_read_b128 a[80:83], v10 offset:1024
  ds_read_b128 a[84:87], v8 offset:4096
  v_mfma_f32_16x16x32_bf16 v[112:115], a[40:43], a[32:35], v[112:115]
  ds_read_b128 a[0:3], v8 offset:6144
  ds_read_b128 a[4:7], v10 offset:1280
  v_mfma_f32_16x16x32_bf16 v[84:87], a[36:39], a[44:47], v[84:87]
  ds_read_b128 a[8:11], v10 offset:1536
  ds_read_b128 a[12:15], v10 offset:1792
  v_mfma_f32_16x16x32_bf16 v[116:119], a[40:43], a[44:47], v[116:119]
  v_mfma_f32_16x16x32_bf16 v[88:91], a[36:39], a[48:51], v[88:91]
  v_mfma_f32_16x16x32_bf16 v[120:123], a[40:43], a[48:51], v[120:123]
  v_mfma_f32_16x16x32_bf16 v[92:95], a[36:39], a[52:55], v[92:95]
  v_mfma_f32_16x16x32_bf16 v[124:127], a[40:43], a[52:55], v[124:127]
  s_waitcnt lgkmcnt(0)
  s_nop 0
  v_mfma_f32_16x16x32_bf16 v[80:83], a[60:63], a[56:59], v[80:83]
  ds_read_b128 a[16:19], v10 offset:9216
  ds_read_b128 a[20:23], v9 offset:4096
  v_mfma_f32_16x16x32_bf16 v[112:115], a[64:67], a[56:59], v[112:115]
  ds_read_b128 a[24:27], v9 offset:6144
  ds_read_b128 a[28:31], v10 offset:9472
  v_mfma_f32_16x16x32_bf16 v[84:87], a[60:63], a[68:71], v[84:87]
  ds_read_b128 a[88:91], v10 offset:9728
  ds_read_b128 a[92:95], v10 offset:9984
  v_mfma_f32_16x16x32_bf16 v[116:119], a[64:67], a[68:71], v[116:119]
  v_mfma_f32_16x16x32_bf16 v[88:91], a[60:63], a[72:75], v[88:91]
  v_mfma_f32_16x16x32_bf16 v[120:123], a[64:67], a[72:75], v[120:123]
  v_mfma_f32_16x16x32_bf16 v[92:95], a[60:63], a[76:79], v[92:95]
  v_mfma_f32_16x16x32_bf16 v[124:127], a[64:67], a[76:79], v[124:127]
  v_mfma_f32_16x16x32_bf16 v[96:99], a[84:87], a[80:83], v[96:99]
  ds_read_b128 a[32:35], v13 offset:1024
  ds_read_b128 a[44:47], v11 offset:4096
  v_mfma_f32_16x16x32_bf16 v[128:131], a[0:3], a[80:83], v[128:131]
  ds_read_b128 a[48:51], v11 offset:6144
  ds_read_b128 a[36:39], v13 offset:1280
  v_mfma_f32_16x16x32_bf16 v[100:103], a[84:87], a[4:7], v[100:103]
  v_cvt_pk_bf16_f32 v150, v81, v85
  v_cvt_pk_bf16_f32 v151, v89, v93
  ds_read_b128 a[40:43], v13 offset:1536
  ds_read_b128 a[52:55], v13 offset:1792
  v_mfma_f32_16x16x32_bf16 v[132:135], a[0:3], a[4:7], v[132:135]
  v_cvt_pk_bf16_f32 v148, v80, v84
  v_cvt_pk_bf16_f32 v149, v88, v92
  v_mfma_f32_16x16x32_bf16 v[104:107], a[84:87], a[8:11], v[104:107]
  v_cndmask_b32_dpp v152, v150, v148, vcc quad_perm:[1,0,3,2] row_mask:0xf bank_mask:0xf
  v_cndmask_b32_dpp v153, v151, v149, vcc quad_perm:[1,0,3,2] row_mask:0xf bank_mask:0xf
  v_mfma_f32_16x16x32_bf16 v[136:139], a[0:3], a[8:11], v[136:139]
  s_not_b64 vcc, vcc
  s_nop 0
  v_mfma_f32_16x16x32_bf16 v[108:111], a[84:87], a[12:15], v[108:111]
  v_cndmask_b32_dpp v154, v148, v150, vcc quad_perm:[1,0,3,2] row_mask:0xf bank_mask:0xf
  v_cndmask_b32_dpp v155, v149, v151, vcc quad_perm:[1,0,3,2] row_mask:0xf bank_mask:0xf
  v_mfma_f32_16x16x32_bf16 v[140:143], a[0:3], a[12:15], v[140:143]
  buffer_store_dwordx4 v[152:155], v147, s[32:35], s52 offen offset:0 sc0 sc1
  v_cvt_pk_bf16_f32 v148, v82, v86
  s_waitcnt lgkmcnt(0)
  s_nop 0
  v_mfma_f32_16x16x32_bf16 v[96:99], a[20:23], a[16:19], v[96:99]
  v_cvt_pk_bf16_f32 v149, v90, v94
  v_cvt_pk_bf16_f32 v150, v83, v87
  ds_read_b128 a[56:59], v13 offset:9216
  ds_read_b128 a[68:71], v12 offset:4096
  v_mfma_f32_16x16x32_bf16 v[128:131], a[24:27], a[16:19], v[128:131]
  v_cvt_pk_bf16_f32 v151, v91, v95
  ds_read_b128 a[72:75], v12 offset:6144
  ds_read_b128 a[60:63], v13 offset:9472
  v_mfma_f32_16x16x32_bf16 v[100:103], a[20:23], a[28:31], v[100:103]
  v_cndmask_b32_dpp v158, v148, v150, vcc quad_perm:[1,0,3,2] row_mask:0xf bank_mask:0xf
  v_cndmask_b32_dpp v159, v149, v151, vcc quad_perm:[1,0,3,2] row_mask:0xf bank_mask:0xf
  ds_read_b128 a[64:67], v13 offset:9728
  ds_read_b128 a[76:79], v13 offset:9984
  v_mfma_f32_16x16x32_bf16 v[132:135], a[24:27], a[28:31], v[132:135]
  s_not_b64 vcc, vcc
  v_cndmask_b32_dpp v156, v150, v148, vcc quad_perm:[1,0,3,2] row_mask:0xf bank_mask:0xf
  s_nop 0
  v_mfma_f32_16x16x32_bf16 v[104:107], a[20:23], a[88:91], v[104:107]
  v_cndmask_b32_dpp v157, v151, v149, vcc quad_perm:[1,0,3,2] row_mask:0xf bank_mask:0xf
  buffer_store_dwordx4 v[156:159], v147, s[32:35], s54 offen offset:0 sc0 sc1
  v_mfma_f32_16x16x32_bf16 v[136:139], a[24:27], a[88:91], v[136:139]
  v_cvt_pk_bf16_f32 v150, v113, v117
  v_mfma_f32_16x16x32_bf16 v[108:111], a[20:23], a[92:95], v[108:111]
  v_cvt_pk_bf16_f32 v151, v121, v125
  v_cvt_pk_bf16_f32 v148, v112, v116
  v_mfma_f32_16x16x32_bf16 v[140:143], a[24:27], a[92:95], v[140:143]
  v_cvt_pk_bf16_f32 v149, v120, v124
  v_cndmask_b32_dpp v152, v150, v148, vcc quad_perm:[1,0,3,2] row_mask:0xf bank_mask:0xf
  v_mfma_f32_16x16x32_bf16 v[96:99], a[44:47], a[32:35], v[96:99]
  v_cndmask_b32_dpp v153, v151, v149, vcc quad_perm:[1,0,3,2] row_mask:0xf bank_mask:0xf
  s_not_b64 vcc, vcc
  ds_read_b128 a[80:83], v146 offset:1024
  ds_read_b128 a[4:7], v144 offset:4096
  s_nop 0
  v_mfma_f32_16x16x32_bf16 v[128:131], a[48:51], a[32:35], v[128:131]
  v_cndmask_b32_dpp v154, v148, v150, vcc quad_perm:[1,0,3,2] row_mask:0xf bank_mask:0xf
  ds_read_b128 a[8:11], v144 offset:6144
  ds_read_b128 a[84:87], v146 offset:1280
  v_mfma_f32_16x16x32_bf16 v[100:103], a[44:47], a[36:39], v[100:103]
  v_cndmask_b32_dpp v155, v149, v151, vcc quad_perm:[1,0,3,2] row_mask:0xf bank_mask:0xf
  buffer_store_dwordx4 v[152:155], v147, s[32:35], s56 offen offset:0 sc0 sc1
  ds_read_b128 a[0:3], v146 offset:1536
  ds_read_b128 a[12:15], v146 offset:1792
  v_mfma_f32_16x16x32_bf16 v[132:135], a[48:51], a[36:39], v[132:135]
  v_cvt_pk_bf16_f32 v148, v114, v118
  v_cvt_pk_bf16_f32 v149, v122, v126
  v_mfma_f32_16x16x32_bf16 v[104:107], a[44:47], a[40:43], v[104:107]
  v_cvt_pk_bf16_f32 v150, v115, v119
  v_cvt_pk_bf16_f32 v151, v123, v127
  v_mfma_f32_16x16x32_bf16 v[136:139], a[48:51], a[40:43], v[136:139]
  v_cndmask_b32_dpp v158, v148, v150, vcc quad_perm:[1,0,3,2] row_mask:0xf bank_mask:0xf
  v_mfma_f32_16x16x32_bf16 v[108:111], a[44:47], a[52:55], v[108:111]
  v_cndmask_b32_dpp v159, v149, v151, vcc quad_perm:[1,0,3,2] row_mask:0xf bank_mask:0xf
  s_not_b64 vcc, vcc
  s_nop 0
  v_mfma_f32_16x16x32_bf16 v[140:143], a[48:51], a[52:55], v[140:143]
  v_cndmask_b32_dpp v156, v150, v148, vcc quad_perm:[1,0,3,2] row_mask:0xf bank_mask:0xf
  v_cndmask_b32_dpp v157, v151, v149, vcc quad_perm:[1,0,3,2] row_mask:0xf bank_mask:0xf
  s_waitcnt lgkmcnt(0)
  s_nop 0
  v_mfma_f32_16x16x32_bf16 v[96:99], a[68:71], a[56:59], v[96:99]
  buffer_store_dwordx4 v[156:159], v147, s[32:35], s58 offen offset:0 sc0 sc1
  ds_read_b128 a[16:19], v146 offset:9216
  ds_read_b128 a[28:31], v145 offset:4096
  v_mfma_f32_16x16x32_bf16 v[128:131], a[72:75], a[56:59], v[128:131]
  ds_read_b128 a[88:91], v146 offset:9472
  ds_read_b128 a[20:23], v145 offset:6144
  v_mfma_f32_16x16x32_bf16 v[100:103], a[68:71], a[60:63], v[100:103]
  ds_read_b128 a[24:27], v146 offset:9728
  ds_read_b128 a[92:95], v146 offset:9984
  v_mfma_f32_16x16x32_bf16 v[132:135], a[72:75], a[60:63], v[132:135]
  v_mfma_f32_16x16x32_bf16 v[104:107], a[68:71], a[64:67], v[104:107]
  v_mfma_f32_16x16x32_bf16 v[136:139], a[72:75], a[64:67], v[136:139]
  v_mfma_f32_16x16x32_bf16 v[108:111], a[68:71], a[76:79], v[108:111]
  v_mfma_f32_16x16x32_bf16 v[140:143], a[72:75], a[76:79], v[140:143]
  v_mfma_f32_16x16x32_bf16 v[96:99], a[4:7], a[80:83], v[96:99]
  v_mfma_f32_16x16x32_bf16 v[128:131], a[8:11], a[80:83], v[128:131]
  v_mfma_f32_16x16x32_bf16 v[100:103], a[4:7], a[84:87], v[100:103]
  v_mfma_f32_16x16x32_bf16 v[132:135], a[8:11], a[84:87], v[132:135]
  v_mfma_f32_16x16x32_bf16 v[104:107], a[4:7], a[0:3], v[104:107]
  v_mfma_f32_16x16x32_bf16 v[136:139], a[8:11], a[0:3], v[136:139]
  v_mfma_f32_16x16x32_bf16 v[108:111], a[4:7], a[12:15], v[108:111]
  v_mfma_f32_16x16x32_bf16 v[140:143], a[8:11], a[12:15], v[140:143]
  s_waitcnt lgkmcnt(0)
  s_nop 0
  v_mfma_f32_16x16x32_bf16 v[96:99], a[28:31], a[16:19], v[96:99]
  v_mfma_f32_16x16x32_bf16 v[100:103], a[28:31], a[88:91], v[100:103]
  v_mfma_f32_16x16x32_bf16 v[104:107], a[28:31], a[24:27], v[104:107]
  v_mfma_f32_16x16x32_bf16 v[108:111], a[28:31], a[92:95], v[108:111]
  v_mfma_f32_16x16x32_bf16 v[128:131], a[20:23], a[16:19], v[128:131]
  v_mfma_f32_16x16x32_bf16 v[132:135], a[20:23], a[88:91], v[132:135]
  v_mfma_f32_16x16x32_bf16 v[136:139], a[20:23], a[24:27], v[136:139]
  v_mfma_f32_16x16x32_bf16 v[140:143], a[20:23], a[92:95], v[140:143]
  s_nop 7
L_fin:
  v_cvt_pk_bf16_f32 v150, v97, v101
  v_cvt_pk_bf16_f32 v151, v105, v109
  v_cvt_pk_bf16_f32 v148, v96, v100
  v_cvt_pk_bf16_f32 v149, v104, v108
  v_cndmask_b32_dpp v152, v150, v148, vcc quad_perm:[1,0,3,2] row_mask:0xf bank_mask:0xf
  v_cndmask_b32_dpp v153, v151, v149, vcc quad_perm:[1,0,3,2] row_mask:0xf bank_mask:0xf
  s_not_b64 vcc, vcc
  v_cndmask_b32_dpp v154, v148, v150, vcc quad_perm:[1,0,3,2] row_mask:0xf bank_mask:0xf
  v_cndmask_b32_dpp v155, v149, v151, vcc quad_perm:[1,0,3,2] row_mask:0xf bank_mask:0xf
  buffer_store_dwordx4 v[152:155], v147, s[32:35], s52 offen offset:128 sc0 sc1
  v_cvt_pk_bf16_f32 v148, v98, v102
  v_cvt_pk_bf16_f32 v149, v106, v110
  v_cvt_pk_bf16_f32 v150, v99, v103
  v_cvt_pk_bf16_f32 v151, v107, v111
  v_cndmask_b32_dpp v158, v148, v150, vcc quad_perm:[1,0,3,2] row_mask:0xf bank_mask:0xf
  v_cndmask_b32_dpp v159, v149, v151, vcc quad_perm:[1,0,3,2] row_mask:0xf bank_mask:0xf
  s_not_b64 vcc, vcc
  v_cndmask_b32_dpp v156, v150, v148, vcc quad_perm:[1,0,3,2] row_mask:0xf bank_mask:0xf
  v_cndmask_b32_dpp v157, v151, v149, vcc quad_perm:[1,0,3,2] row_mask:0xf bank_mask:0xf
  buffer_store_dwordx4 v[156:159], v147, s[32:35], s54 offen offset:128 sc0 sc1
  v_cvt_pk_bf16_f32 v150, v129, v133
  v_cvt_pk_bf16_f32 v151, v137, v141
  v_cvt_pk_bf16_f32 v148, v128, v132
  v_cvt_pk_bf16_f32 v149, v136, v140
  v_cndmask_b32_dpp v152, v150, v148, vcc quad_perm:[1,0,3,2] row_mask:0xf bank_mask:0xf
  v_cndmask_b32_dpp v153, v151, v149, vcc quad_perm:[1,0,3,2] row_mask:0xf bank_mask:0xf
  s_not_b64 vcc, vcc
  v_cndmask_b32_dpp v154, v148, v150, vcc quad_perm:[1,0,3,2] row_mask:0xf bank_mask:0xf
  v_cndmask_b32_dpp v155, v149, v151, vcc quad_perm:[1,0,3,2] row_mask:0xf bank_mask:0xf
  buffer_store_dwordx4 v[152:155], v147, s[32:35], s56 offen offset:128 sc0 sc1
  v_cvt_pk_bf16_f32 v148, v130, v134
  v_cvt_pk_bf16_f32 v149, v138, v142
  v_cvt_pk_bf16_f32 v150, v131, v135
  v_cvt_pk_bf16_f32 v151, v139, v143
  v_cndmask_b32_dpp v158, v148, v150, vcc quad_perm:[1,0,3,2] row_mask:0xf bank_mask:0xf
  v_cndmask_b32_dpp v159, v149, v151, vcc quad_perm:[1,0,3,2] row_mask:0xf bank_mask:0xf
  s_not_b64 vcc, vcc
  v_cndmask_b32_dpp v156, v150, v148, vcc quad_perm:[1,0,3,2] row_mask:0xf bank_mask:0xf
  v_cndmask_b32_dpp v157, v151, v149, vcc quad_perm:[1,0,3,2] row_mask:0xf bank_mask:0xf
  buffer_store_dwordx4 v[156:159], v147, s[32:35], s58 offen offset:128 sc0 sc1
  s_endpgm
L_loader:
  s_add_u32 s58, s40, 2
  s_lshl_b32 s58, s58, 7
  s_load_dword s68, s[12:13], s58 offset:0
  s_load_dword s69, s[12:13], s58 offset:64
  s_load_dword s70, s[12:13], s58 offset:2048
  s_load_dword s71, s[12:13], s58 offset:2112
  s_load_dword s72, s[12:13], s58 offset:4096
  s_load_dword s73, s[12:13], s58 offset:4160
  s_waitcnt vmcnt(0)
  s_mov_b64 exec, 1
  buffer_store_dwordx2 v[10:11], v14, s[28:31], 0 offen sc1
  s_mov_b64 exec, -1
  s_barrier
  s_add_u32 s43, s40, 0
  s_lshl_b32 s43, s43, 9
  s_load_dwordx4 s[64:67], s[4:5], s43 glc
  s_add_u32 s41, s40, 0
  s_lshl_b32 s41, s41, 7
  s_add_u32 m0, s60, 49152
  s_nop 0
  buffer_load_dwordx4 v16, s[16:19], s41 offen offset:0  lds
  buffer_load_dwordx4 v17, s[16:19], s41 offen offset:1024  lds
  buffer_load_dwordx4 v18, s[16:19], s41 offen offset:2048  lds
  buffer_load_dwordx4 v19, s[16:19], s41 offen offset:3072  lds
  s_add_u32 m0, s60, 53248
  s_add_u32 s41, s41, 65536
  buffer_load_dwordx4 v16, s[16:19], s41 offen offset:0  lds
  buffer_load_dwordx4 v17, s[16:19], s41 offen offset:1024  lds
  buffer_load_dwordx4 v18, s[16:19], s41 offen offset:2048  lds
  buffer_load_dwordx4 v19, s[16:19], s41 offen offset:3072  lds
  s_mov_b32 s63, 0
L_sp1:
  s_waitcnt lgkmcnt(0)
  s_xor_b64 s[10:11], s[64:65], s[8:9]
  s_xor_b64 s[14:15], s[66:67], s[8:9]
  s_or_b64 s[10:11], s[10:11], s[14:15]
  s_cbranch_scc0 L_ok1
  s_load_dwordx4 s[64:67], s[4:5], s43 glc
  s_add_u32 s63, s63, 1
  s_cmp_lt_u32 s63, 20000
  s_cbranch_scc1 L_sp1
  s_waitcnt lgkmcnt(0)
L_ok1:
  s_add_u32 s43, s40, 1
  s_lshl_b32 s43, s43, 9
  s_load_dwordx4 s[64:67], s[4:5], s43 glc
  s_add_u32 m0, s61, 49152
  s_add_u32 s62, s40, 0
  s_lshl_b32 s62, s62, 14
  buffer_load_dwordx4 v20, s[28:31], s62 offen offset:0 sc1 lds
  buffer_load_dwordx4 v20, s[28:31], s62 offen offset:1024 sc1 lds
  buffer_load_dwordx4 v20, s[28:31], s62 offen offset:2048 sc1 lds
  buffer_load_dwordx4 v20, s[28:31], s62 offen offset:3072 sc1 lds
  s_add_u32 s41, s40, 1
  s_lshl_b32 s41, s41, 7
  s_add_u32 m0, s60, 98304
  s_nop 0
  buffer_load_dwordx4 v16, s[16:19], s41 offen offset:0  lds
  buffer_load_dwordx4 v17, s[16:19], s41 offen offset:1024  lds
  buffer_load_dwordx4 v18, s[16:19], s41 offen offset:2048  lds
  buffer_load_dwordx4 v19, s[16:19], s41 offen offset:3072  lds
  s_add_u32 m0, s60, 102400
  s_add_u32 s41, s41, 65536
  buffer_load_dwordx4 v16, s[16:19], s41 offen offset:0  lds
  buffer_load_dwordx4 v17, s[16:19], s41 offen offset:1024  lds
  buffer_load_dwordx4 v18, s[16:19], s41 offen offset:2048  lds
  buffer_load_dwordx4 v19, s[16:19], s41 offen offset:3072  lds
  s_mov_b32 s63, 0
L_sp2:
  s_waitcnt lgkmcnt(0)
  s_xor_b64 s[10:11], s[64:65], s[8:9]
  s_xor_b64 s[14:15], s[66:67], s[8:9]
  s_or_b64 s[10:11], s[10:11], s[14:15]
  s_cbranch_scc0 L_ok2
  s_load_dwordx4 s[64:67], s[4:5], s43 glc
  s_add_u32 s63, s63, 1
  s_cmp_lt_u32 s63, 20000
  s_cbranch_scc1 L_sp2
  s_waitcnt lgkmcnt(0)
L_ok2:
  s_add_u32 s43, s40, 2
  s_lshl_b32 s43, s43, 9
  s_load_dwordx4 s[64:67], s[4:5], s43 glc
  s_add_u32 m0, s61, 98304
  s_add_u32 s62, s40, 1
  s_lshl_b32 s62, s62, 14
  buffer_load_dwordx4 v20, s[28:31], s62 offen offset:0 sc1 lds
  buffer_load_dwordx4 v20, s[28:31], s62 offen offset:1024 sc1 lds
  buffer_load_dwordx4 v20, s[28:31], s62 offen offset:2048 sc1 lds
  buffer_load_dwordx4 v20, s[28:31], s62 offen offset:3072 sc1 lds
  s_add_u32 s58, s40, 3
  s_lshl_b32 s58, s58, 7
  s_load_dword s68, s[12:13], s58 offset:0
  s_load_dword s69, s[12:13], s58 offset:64
  s_load_dword s70, s[12:13], s58 offset:2048
  s_load_dword s71, s[12:13], s58 offset:2112
  s_load_dword s72, s[12:13], s58 offset:4096
  s_load_dword s73, s[12:13], s58 offset:4160
  s_waitcnt vmcnt(12)
  s_barrier
  s_add_u32 s41, s40, 2
  s_lshl_b32 s41, s41, 7
  s_add_u32 m0, s60, 0
  s_nop 0
  buffer_load_dwordx4 v16, s[16:19], s41 offen offset:0  lds
  buffer_load_dwordx4 v17, s[16:19], s41 offen offset:1024  lds
  buffer_load_dwordx4 v18, s[16:19], s41 offen offset:2048  lds
  buffer_load_dwordx4 v19, s[16:19], s41 offen offset:3072  lds
  s_add_u32 m0, s60, 4096
  s_add_u32 s41, s41, 65536
  buffer_load_dwordx4 v16, s[16:19], s41 offen offset:0  lds
  buffer_load_dwordx4 v17, s[16:19], s41 offen offset:1024  lds
  buffer_load_dwordx4 v18, s[16:19], s41 offen offset:2048  lds
  buffer_load_dwordx4 v19, s[16:19], s41 offen offset:3072  lds
  s_mov_b32 s63, 0
L_sp3:
  s_waitcnt lgkmcnt(0)
  s_xor_b64 s[10:11], s[64:65], s[8:9]
  s_xor_b64 s[14:15], s[66:67], s[8:9]
  s_or_b64 s[10:11], s[10:11], s[14:15]
  s_cbranch_scc0 L_ok3
  s_load_dwordx4 s[64:67], s[4:5], s43 glc
  s_add_u32 s63, s63, 1
  s_cmp_lt_u32 s63, 20000
  s_cbranch_scc1 L_sp3
  s_waitcnt lgkmcnt(0)
L_ok3:
  s_add_u32 s43, s40, 3
  s_lshl_b32 s43, s43, 9
  s_load_dwordx4 s[64:67], s[4:5], s43 glc
  s_add_u32 m0, s61, 0
  s_add_u32 s62, s40, 2
  s_lshl_b32 s62, s62, 14
  buffer_load_dwordx4 v20, s[28:31], s62 offen offset:0 sc1 lds
  buffer_load_dwordx4 v20, s[28:31], s62 offen offset:1024 sc1 lds
  buffer_load_dwordx4 v20, s[28:31], s62 offen offset:2048 sc1 lds
  buffer_load_dwordx4 v20, s[28:31], s62 offen offset:3072 sc1 lds
  s_xor_b32 s58, s40, 4
  s_cmp_ge_u32 s58, s36
  s_addc_u32 s58, s58, 0
  s_lshl_b32 s58, s58, 7
  s_load_dword s68, s[12:13], s58 offset:0
  s_load_dword s69, s[12:13], s58 offset:64
  s_load_dword s70, s[12:13], s58 offset:2048
  s_load_dword s71, s[12:13], s58 offset:2112
  s_load_dword s72, s[12:13], s58 offset:4096
  s_load_dword s73, s[12:13], s58 offset:4160
  s_waitcnt vmcnt(12)
  s_barrier
  s_add_u32 s41, s40, 3
  s_lshl_b32 s41, s41, 7
  s_add_u32 m0, s60, 49152
  s_nop 0
  buffer_load_dwordx4 v16, s[16:19], s41 offen offset:0  lds
  buffer_load_dwordx4 v17, s[16:19], s41 offen offset:1024  lds
  buffer_load_dwordx4 v18, s[16:19], s41 offen offset:2048  lds
  buffer_load_dwordx4 v19, s[16:19], s41 offen offset:3072  lds
  s_add_u32 m0, s60, 53248
  s_add_u32 s41, s41, 65536
  buffer_load_dwordx4 v16, s[16:19], s41 offen offset:0  lds
  buffer_load_dwordx4 v17, s[16:19], s41 offen offset:1024  lds
  buffer_load_dwordx4 v18, s[16:19], s41 offen offset:2048  lds
  buffer_load_dwordx4 v19, s[16:19], s41 offen offset:3072  lds
  s_mov_b32 s63, 0
L_sp4:
  s_waitcnt lgkmcnt(0)
  s_xor_b64 s[10:11], s[64:65], s[8:9]
  s_xor_b64 s[14:15], s[66:67], s[8:9]
  s_or_b64 s[10:11], s[10:11], s[14:15]
  s_cbranch_scc0 L_ok4
  s_load_dwordx4 s[64:67], s[4:5], s43 glc
  s_add_u32 s63, s63, 1
  s_cmp_lt_u32 s63, 20000
  s_cbranch_scc1 L_sp4
  s_waitcnt lgkmcnt(0)
L_ok4:
  s_xor_b32 s43, s40, 4
  s_cmp_ge_u32 s43, s36
  s_addc_u32 s43, s43, 0
  s_lshl_b32 s43, s43, 9
  s_load_dwordx4 s[64:67], s[4:5], s43 glc
  s_add_u32 m0, s61, 49152
  s_add_u32 s62, s40, 3
  s_lshl_b32 s62, s62, 14
  buffer_load_dwordx4 v20, s[28:31], s62 offen offset:0 sc1 lds
  buffer_load_dwordx4 v20, s[28:31], s62 offen offset:1024 sc1 lds
  buffer_load_dwordx4 v20, s[28:31], s62 offen offset:2048 sc1 lds
  buffer_load_dwordx4 v20, s[28:31], s62 offen offset:3072 sc1 lds
  s_xor_b32 s58, s40, 5
  s_cmp_ge_u32 s58, s36
  s_addc_u32 s58, s58, 0
  s_lshl_b32 s58, s58, 7
  s_load_dword s68, s[12:13], s58 offset:0
  s_load_dword s69, s[12:13], s58 offset:64
  s_load_dword s70, s[12:13], s58 offset:2048
  s_load_dword s71, s[12:13], s58 offset:2112
  s_load_dword s72, s[12:13], s58 offset:4096
  s_load_dword s73, s[12:13], s58 offset:4160
  s_waitcnt vmcnt(12)
  s_barrier
  s_xor_b32 s41, s40, 4
  s_cmp_ge_u32 s41, s36
  s_addc_u32 s41, s41, 0
  s_lshl_b32 s41, s41, 7
  s_add_u32 m0, s60, 98304
  s_nop 0
  buffer_load_dwordx4 v16, s[16:19], s41 offen offset:0  lds
  buffer_load_dwordx4 v17, s[16:19], s41 offen offset:1024  lds
  buffer_load_dwordx4 v18, s[16:19], s41 offen offset:2048  lds
  buffer_load_dwordx4 v19, s[16:19], s41 offen offset:3072  lds
  s_add_u32 m0, s60, 102400
  s_add_u32 s41, s41, 65536
  buffer_load_dwordx4 v16, s[16:19], s41 offen offset:0  lds
  buffer_load_dwordx4 v17, s[16:19], s41 offen offset:1024  lds
  buffer_load_dwordx4 v18, s[16:19], s41 offen offset:2048  lds
  buffer_load_dwordx4 v19, s[16:19], s41 offen offset:3072  lds
  s_mov_b32 s63, 0
L_sp5:
  s_waitcnt lgkmcnt(0)
  s_xor_b64 s[10:11], s[64:65], s[8:9]
  s_xor_b64 s[14:15], s[66:67], s[8:9]
  s_or_b64 s[10:11], s[10:11], s[14:15]
  s_cbranch_scc0 L_ok5
  s_load_dwordx4 s[64:67], s[4:5], s43 glc
  s_add_u32 s63, s63, 1
  s_cmp_lt_u32 s63, 20000
  s_cbranch_scc1 L_sp5
  s_waitcnt lgkmcnt(0)
L_ok5:
  s_xor_b32 s43, s40, 5
  s_cmp_ge_u32 s43, s36
  s_addc_u32 s43, s43, 0
  s_lshl_b32 s43, s43, 9
  s_load_dwordx4 s[64:67], s[4:5], s43 glc
  s_add_u32 m0, s61, 98304
  s_xor_b32 s62, s40, 4
  s_cmp_ge_u32 s62, s36
  s_addc_u32 s62, s62, 0
  s_lshl_b32 s62, s62, 14
  buffer_load_dwordx4 v20, s[28:31], s62 offen offset:0 sc1 lds
  buffer_load_dwordx4 v20, s[28:31], s62 offen offset:1024 sc1 lds
  buffer_load_dwordx4 v20, s[28:31], s62 offen offset:2048 sc1 lds
  buffer_load_dwordx4 v20, s[28:31], s62 offen offset:3072 sc1 lds
  s_xor_b32 s58, s40, 6
  s_cmp_ge_u32 s58, s36
  s_addc_u32 s58, s58, 0
  s_lshl_b32 s58, s58, 7
  s_load_dword s68, s[12:13], s58 offset:0
  s_load_dword s69, s[12:13], s58 offset:64
  s_load_dword s70, s[12:13], s58 offset:2048
  s_load_dword s71, s[12:13], s58 offset:2112
  s_load_dword s72, s[12:13], s58 offset:4096
  s_load_dword s73, s[12:13], s58 offset:4160
  s_waitcnt vmcnt(12)
  s_barrier
  s_xor_b32 s41, s40, 5
  s_cmp_ge_u32 s41, s36
  s_addc_u32 s41, s41, 0
  s_lshl_b32 s41, s41, 7
  s_add_u32 m0, s60, 0
  s_nop 0
  buffer_load_dwordx4 v16, s[16:19], s41 offen offset:0  lds
  buffer_load_dwordx4 v17, s[16:19], s41 offen offset:1024  lds
  buffer_load_dwordx4 v18, s[16:19], s41 offen offset:2048  lds
  buffer_load_dwordx4 v19, s[16:19], s41 offen offset:3072  lds
  s_add_u32 m0, s60, 4096
  s_add_u32 s41, s41, 65536
  buffer_load_dwordx4 v16, s[16:19], s41 offen offset:0  lds
  buffer_load_dwordx4 v17, s[16:19], s41 offen offset:1024  lds
  buffer_load_dwordx4 v18, s[16:19], s41 offen offset:2048  lds
  buffer_load_dwordx4 v19, s[16:19], s41 offen offset:3072  lds
  s_mov_b32 s63, 0
L_sp6:
  s_waitcnt lgkmcnt(0)
  s_xor_b64 s[10:11], s[64:65], s[8:9]
  s_xor_b64 s[14:15], s[66:67], s[8:9]
  s_or_b64 s[10:11], s[10:11], s[14:15]
  s_cbranch_scc0 L_ok6
  s_load_dwordx4 s[64:67], s[4:5], s43 glc
  s_add_u32 s63, s63, 1
  s_cmp_lt_u32 s63, 20000
  s_cbranch_scc1 L_sp6
  s_waitcnt lgkmcnt(0)
L_ok6:
  s_xor_b32 s43, s40, 6
  s_cmp_ge_u32 s43, s36
  s_addc_u32 s43, s43, 0
  s_lshl_b32 s43, s43, 9
  s_load_dwordx4 s[64:67], s[4:5], s43 glc
  s_add_u32 m0, s61, 0
  s_xor_b32 s62, s40, 5
  s_cmp_ge_u32 s62, s36
  s_addc_u32 s62, s62, 0
  s_lshl_b32 s62, s62, 14
  buffer_load_dwordx4 v20, s[28:31], s62 offen offset:0 sc1 lds
  buffer_load_dwordx4 v20, s[28:31], s62 offen offset:1024 sc1 lds
  buffer_load_dwordx4 v20, s[28:31], s62 offen offset:2048 sc1 lds
  buffer_load_dwordx4 v20, s[28:31], s62 offen offset:3072 sc1 lds
  s_mov_b32 s58, 1024
  s_load_dword s68, s[12:13], s58 offset:0
  s_load_dword s69, s[12:13], s58 offset:64
  s_load_dword s70, s[12:13], s58 offset:2048
  s_load_dword s71, s[12:13], s58 offset:2112
  s_load_dword s72, s[12:13], s58 offset:4096
  s_load_dword s73, s[12:13], s58 offset:4160
  s_waitcnt vmcnt(12)
  s_barrier
  s_xor_b32 s41, s40, 6
  s_cmp_ge_u32 s41, s36
  s_addc_u32 s41, s41, 0
  s_lshl_b32 s41, s41, 7
  s_add_u32 m0, s60, 49152
  s_nop 0
  buffer_load_dwordx4 v16, s[16:19], s41 offen offset:0  lds
  buffer_load_dwordx4 v17, s[16:19], s41 offen offset:1024  lds
  buffer_load_dwordx4 v18, s[16:19], s41 offen offset:2048  lds
  buffer_load_dwordx4 v19, s[16:19], s41 offen offset:3072  lds
  s_add_u32 m0, s60, 53248
  s_add_u32 s41, s41, 65536
  buffer_load_dwordx4 v16, s[16:19], s41 offen offset:0  lds
  buffer_load_dwordx4 v17, s[16:19], s41 offen offset:1024  lds
  buffer_load_dwordx4 v18, s[16:19], s41 offen offset:2048  lds
  buffer_load_dwordx4 v19, s[16:19], s41 offen offset:3072  lds
  s_mov_b32 s63, 0
L_sp7:
  s_waitcnt lgkmcnt(0)
  s_xor_b64 s[10:11], s[64:65], s[8:9]
  s_xor_b64 s[14:15], s[66:67], s[8:9]
  s_or_b64 s[10:11], s[10:11], s[14:15]
  s_cbranch_scc0 L_ok7
  s_load_dwordx4 s[64:67], s[4:5], s43 glc
  s_add_u32 s63, s63, 1
  s_cmp_lt_u32 s63, 20000
  s_cbranch_scc1 L_sp7
  s_waitcnt lgkmcnt(0)
L_ok7:
  s_mov_b32 s43, 4096
  s_load_dwordx4 s[64:67], s[4:5], s43 glc
  s_add_u32 m0, s61, 49152
  s_xor_b32 s62, s40, 6
  s_cmp_ge_u32 s62, s36
  s_addc_u32 s62, s62, 0
  s_lshl_b32 s62, s62, 14
  buffer_load_dwordx4 v20, s[28:31], s62 offen offset:0 sc1 lds
  buffer_load_dwordx4 v20, s[28:31], s62 offen offset:1024 sc1 lds
  buffer_load_dwordx4 v20, s[28:31], s62 offen offset:2048 sc1 lds
  buffer_load_dwordx4 v20, s[28:31], s62 offen offset:3072 sc1 lds
  s_mov_b32 s58, 1152
  s_load_dword s68, s[12:13], s58 offset:0
  s_load_dword s69, s[12:13], s58 offset:64
  s_load_dword s70, s[12:13], s58 offset:2048
  s_load_dword s71, s[12:13], s58 offset:2112
  s_load_dword s72, s[12:13], s58 offset:4096
  s_load_dword s73, s[12:13], s58 offset:4160
  s_waitcnt vmcnt(12)
  s_barrier
  s_mov_b32 s41, 1024
  s_add_u32 m0, s60, 98304
  s_nop 0
  buffer_load_dwordx4 v16, s[16:19], s41 offen offset:0  lds
  buffer_load_dwordx4 v17, s[16:19], s41 offen offset:1024  lds
  buffer_load_dwordx4 v18, s[16:19], s41 offen offset:2048  lds
  buffer_load_dwordx4 v19, s[16:19], s41 offen offset:3072  lds
  s_add_u32 m0, s60, 102400
  s_add_u32 s41, s41, 65536
  buffer_load_dwordx4 v16, s[16:19], s41 offen offset:0  lds
  buffer_load_dwordx4 v17, s[16:19], s41 offen offset:1024  lds
  buffer_load_dwordx4 v18, s[16:19], s41 offen offset:2048  lds
  buffer_load_dwordx4 v19, s[16:19], s41 offen offset:3072  lds
  s_mov_b32 s63, 0
L_sp8:
  s_waitcnt lgkmcnt(0)
  s_xor_b64 s[10:11], s[64:65], s[8:9]
  s_xor_b64 s[14:15], s[66:67], s[8:9]
  s_or_b64 s[10:11], s[10:11], s[14:15]
  s_cbranch_scc0 L_ok8
  s_load_dwordx4 s[64:67], s[4:5], s43 glc
  s_add_u32 s63, s63, 1
  s_cmp_lt_u32 s63, 20000
  s_cbranch_scc1 L_sp8
  s_waitcnt lgkmcnt(0)
L_ok8:
  s_mov_b32 s43, 4608
  s_load_dwordx4 s[64:67], s[4:5], s43 glc
  s_add_u32 m0, s61, 98304
  s_mov_b32 s62, 131072
  buffer_load_dwordx4 v20, s[28:31], s62 offen offset:0 sc1 lds
  buffer_load_dwordx4 v20, s[28:31], s62 offen offset:1024 sc1 lds
  buffer_load_dwordx4 v20, s[28:31], s62 offen offset:2048 sc1 lds
  buffer_load_dwordx4 v20, s[28:31], s62 offen offset:3072 sc1 lds
  s_mov_b32 s58, 1280
  s_load_dword s68, s[12:13], s58 offset:0
  s_load_dword s69, s[12:13], s58 offset:64
  s_load_dword s70, s[12:13], s58 offset:2048
  s_load_dword s71, s[12:13], s58 offset:2112
  s_load_dword s72, s[12:13], s58 offset:4096
  s_load_dword s73, s[12:13], s58 offset:4160
  s_waitcnt vmcnt(12)
  s_barrier
  s_mov_b32 s41, 1152
  s_add_u32 m0, s60, 0
  s_nop 0
  buffer_load_dwordx4 v16, s[16:19], s41 offen offset:0  lds
  buffer_load_dwordx4 v17, s[16:19], s41 offen offset:1024  lds
  buffer_load_dwordx4 v18, s[16:19], s41 offen offset:2048  lds
  buffer_load_dwordx4 v19, s[16:19], s41 offen offset:3072  lds
  s_add_u32 m0, s60, 4096
  s_add_u32 s41, s41, 65536
  buffer_load_dwordx4 v16, s[16:19], s41 offen offset:0  lds
  buffer_load_dwordx4 v17, s[16:19], s41 offen offset:1024  lds
  buffer_load_dwordx4 v18, s[16:19], s41 offen offset:2048  lds
  buffer_load_dwordx4 v19, s[16:19], s41 offen offset:3072  lds
  s_mov_b32 s63, 0
L_sp9:
  s_waitcnt lgkmcnt(0)
  s_xor_b64 s[10:11], s[64:65], s[8:9]
  s_xor_b64 s[14:15], s[66:67], s[8:9]
  s_or_b64 s[10:11], s[10:11], s[14:15]
  s_cbranch_scc0 L_ok9
  s_load_dwordx4 s[64:67], s[4:5], s43 glc
  s_add_u32 s63, s63, 1
  s_cmp_lt_u32 s63, 20000
  s_cbranch_scc1 L_sp9
  s_waitcnt lgkmcnt(0)
L_ok9:
  s_mov_b32 s43, 5120
  s_load_dwordx4 s[64:67], s[4:5], s43 glc
  s_add_u32 m0, s61, 0
  s_mov_b32 s62, 147456
  buffer_load_dwordx4 v20, s[28:31], s62 offen offset:0 sc1 lds
  buffer_load_dwordx4 v20, s[28:31], s62 offen offset:1024 sc1 lds
  buffer_load_dwordx4 v20, s[28:31], s62 offen offset:2048 sc1 lds
  buffer_load_dwordx4 v20, s[28:31], s62 offen offset:3072 sc1 lds
  s_mov_b32 s58, 1408
  s_load_dword s68, s[12:13], s58 offset:0
  s_load_dword s69, s[12:13], s58 offset:64
  s_load_dword s70, s[12:13], s58 offset:2048
  s_load_dword s71, s[12:13], s58 offset:2112
  s_load_dword s72, s[12:13], s58 offset:4096
  s_load_dword s73, s[12:13], s58 offset:4160
  s_waitcnt vmcnt(12)
  s_barrier
  s_mov_b32 s41, 1280
  s_add_u32 m0, s60, 49152
  s_nop 0
  buffer_load_dwordx4 v16, s[16:19], s41 offen offset:0  lds
  buffer_load_dwordx4 v17, s[16:19], s41 offen offset:1024  lds
  buffer_load_dwordx4 v18, s[16:19], s41 offen offset:2048  lds
  buffer_load_dwordx4 v19, s[16:19], s41 offen offset:3072  lds
  s_add_u32 m0, s60, 53248
  s_add_u32 s41, s41, 65536
  buffer_load_dwordx4 v16, s[16:19], s41 offen offset:0  lds
  buffer_load_dwordx4 v17, s[16:19], s41 offen offset:1024  lds
  buffer_load_dwordx4 v18, s[16:19], s41 offen offset:2048  lds
  buffer_load_dwordx4 v19, s[16:19], s41 offen offset:3072  lds
  s_mov_b32 s63, 0
L_sp10:
  s_waitcnt lgkmcnt(0)
  s_xor_b64 s[10:11], s[64:65], s[8:9]
  s_xor_b64 s[14:15], s[66:67], s[8:9]
  s_or_b64 s[10:11], s[10:11], s[14:15]
  s_cbranch_scc0 L_ok10
  s_load_dwordx4 s[64:67], s[4:5], s43 glc
  s_add_u32 s63, s63, 1
  s_cmp_lt_u32 s63, 20000
  s_cbranch_scc1 L_sp10
  s_waitcnt lgkmcnt(0)
L_ok10:
  s_mov_b32 s43, 5632
  s_load_dwordx4 s[64:67], s[4:5], s43 glc
  s_add_u32 m0, s61, 49152
  s_mov_b32 s62, 163840
  buffer_load_dwordx4 v20, s[28:31], s62 offen offset:0 sc1 lds
  buffer_load_dwordx4 v20, s[28:31], s62 offen offset:1024 sc1 lds
  buffer_load_dwordx4 v20, s[28:31], s62 offen offset:2048 sc1 lds
  buffer_load_dwordx4 v20, s[28:31], s62 offen offset:3072 sc1 lds
  s_mov_b32 s58, 1536
  s_load_dword s68, s[12:13], s58 offset:0
  s_load_dword s69, s[12:13], s58 offset:64
  s_load_dword s70, s[12:13], s58 offset:2048
  s_load_dword s71, s[12:13], s58 offset:2112
  s_load_dword s72, s[12:13], s58 offset:4096
  s_load_dword s73, s[12:13], s58 offset:4160
  s_waitcnt vmcnt(12)
  s_barrier
  s_mov_b32 s41, 1408
  s_add_u32 m0, s60, 98304
  s_nop 0
  buffer_load_dwordx4 v16, s[16:19], s41 offen offset:0  lds
  buffer_load_dwordx4 v17, s[16:19], s41 offen offset:1024  lds
  buffer_load_dwordx4 v18, s[16:19], s41 offen offset:2048  lds
  buffer_load_dwordx4 v19, s[16:19], s41 offen offset:3072  lds
  s_add_u32 m0, s60, 102400
  s_add_u32 s41, s41, 65536
  buffer_load_dwordx4 v16, s[16:19], s41 offen offset:0  lds
  buffer_load_dwordx4 v17, s[16:19], s41 offen offset:1024  lds
  buffer_load_dwordx4 v18, s[16:19], s41 offen offset:2048  lds
  buffer_load_dwordx4 v19, s[16:19], s41 offen offset:3072  lds
  s_mov_b32 s63, 0
L_sp11:
  s_waitcnt lgkmcnt(0)
  s_xor_b64 s[10:11], s[64:65], s[8:9]
  s_xor_b64 s[14:15], s[66:67], s[8:9]
  s_or_b64 s[10:11], s[10:11], s[14:15]
  s_cbranch_scc0 L_ok11
  s_load_dwordx4 s[64:67], s[4:5], s43 glc
  s_add_u32 s63, s63, 1
  s_cmp_lt_u32 s63, 20000
  s_cbranch_scc1 L_sp11
  s_waitcnt lgkmcnt(0)
L_ok11:
  s_mov_b32 s43, 6144
  s_load_dwordx4 s[64:67], s[4:5], s43 glc
  s_add_u32 m0, s61, 98304
  s_mov_b32 s62, 180224
  buffer_load_dwordx4 v20, s[28:31], s62 offen offset:0 sc1 lds
  buffer_load_dwordx4 v20, s[28:31], s62 offen offset:1024 sc1 lds
  buffer_load_dwordx4 v20, s[28:31], s62 offen offset:2048 sc1 lds
  buffer_load_dwordx4 v20, s[28:31], s62 offen offset:3072 sc1 lds
  s_mov_b32 s58, 1664
  s_load_dword s68, s[12:13], s58 offset:0
  s_load_dword s69, s[12:13], s58 offset:64
  s_load_dword s70, s[12:13], s58 offset:2048
  s_load_dword s71, s[12:13], s58 offset:2112
  s_load_dword s72, s[12:13], s58 offset:4096
  s_load_dword s73, s[12:13], s58 offset:4160
  s_waitcnt vmcnt(12)
  s_barrier
  s_mov_b32 s41, 1536
  s_add_u32 m0, s60, 0
  s_nop 0
  buffer_load_dwordx4 v16, s[16:19], s41 offen offset:0  lds
  buffer_load_dwordx4 v17, s[16:19], s41 offen offset:1024  lds
  buffer_load_dwordx4 v18, s[16:19], s41 offen offset:2048  lds
  buffer_load_dwordx4 v19, s[16:19], s41 offen offset:3072  lds
  s_add_u32 m0, s60, 4096
  s_add_u32 s41, s41, 65536
  buffer_load_dwordx4 v16, s[16:19], s41 offen offset:0  lds
  buffer_load_dwordx4 v17, s[16:19], s41 offen offset:1024  lds
  buffer_load_dwordx4 v18, s[16:19], s41 offen offset:2048  lds
  buffer_load_dwordx4 v19, s[16:19], s41 offen offset:3072  lds
  s_mov_b32 s63, 0
L_sp12:
  s_waitcnt lgkmcnt(0)
  s_xor_b64 s[10:11], s[64:65], s[8:9]
  s_xor_b64 s[14:15], s[66:67], s[8:9]
  s_or_b64 s[10:11], s[10:11], s[14:15]
  s_cbranch_scc0 L_ok12
  s_load_dwordx4 s[64:67], s[4:5], s43 glc
  s_add_u32 s63, s63, 1
  s_cmp_lt_u32 s63, 20000
  s_cbranch_scc1 L_sp12
  s_waitcnt lgkmcnt(0)
L_ok12:
  s_mov_b32 s43, 6656
  s_load_dwordx4 s[64:67], s[4:5], s43 glc
  s_add_u32 m0, s61, 0
  s_mov_b32 s62, 196608
  buffer_load_dwordx4 v20, s[28:31], s62 offen offset:0 sc1 lds
  buffer_load_dwordx4 v20, s[28:31], s62 offen offset:1024 sc1 lds
  buffer_load_dwordx4 v20, s[28:31], s62 offen offset:2048 sc1 lds
  buffer_load_dwordx4 v20, s[28:31], s62 offen offset:3072 sc1 lds
  s_mov_b32 s58, 1792
  s_load_dword s68, s[12:13], s58 offset:0
  s_load_dword s69, s[12:13], s58 offset:64
  s_load_dword s70, s[12:13], s58 offset:2048
  s_load_dword s71, s[12:13], s58 offset:2112
  s_load_dword s72, s[12:13], s58 offset:4096
  s_load_dword s73, s[12:13], s58 offset:4160
  s_waitcnt vmcnt(12)
  s_barrier
  s_mov_b32 s41, 1664
  s_add_u32 m0, s60, 49152
  s_nop 0
  buffer_load_dwordx4 v16, s[16:19], s41 offen offset:0  lds
  buffer_load_dwordx4 v17, s[16:19], s41 offen offset:1024  lds
  buffer_load_dwordx4 v18, s[16:19], s41 offen offset:2048  lds
  buffer_load_dwordx4 v19, s[16:19], s41 offen offset:3072  lds
  s_add_u32 m0, s60, 53248
  s_add_u32 s41, s41, 65536
  buffer_load_dwordx4 v16, s[16:19], s41 offen offset:0  lds
  buffer_load_dwordx4 v17, s[16:19], s41 offen offset:1024  lds
  buffer_load_dwordx4 v18, s[16:19], s41 offen offset:2048  lds
  buffer_load_dwordx4 v19, s[16:19], s41 offen offset:3072  lds
  s_mov_b32 s63, 0
L_sp13:
  s_waitcnt lgkmcnt(0)
  s_xor_b64 s[10:11], s[64:65], s[8:9]
  s_xor_b64 s[14:15], s[66:67], s[8:9]
  s_or_b64 s[10:11], s[10:11], s[14:15]
  s_cbranch_scc0 L_ok13
  s_load_dwordx4 s[64:67], s[4:5], s43 glc
  s_add_u32 s63, s63, 1
  s_cmp_lt_u32 s63, 20000
  s_cbranch_scc1 L_sp13
  s_waitcnt lgkmcnt(0)
L_ok13:
  s_mov_b32 s43, 7168
  s_load_dwordx4 s[64:67], s[4:5], s43 glc
  s_add_u32 m0, s61, 49152
  s_mov_b32 s62, 212992
  buffer_load_dwordx4 v20, s[28:31], s62 offen offset:0 sc1 lds
  buffer_load_dwordx4 v20, s[28:31], s62 offen offset:1024 sc1 lds
  buffer_load_dwordx4 v20, s[28:31], s62 offen offset:2048 sc1 lds
  buffer_load_dwordx4 v20, s[28:31], s62 offen offset:3072 sc1 lds
  s_mov_b32 s58, 1920
  s_load_dword s68, s[12:13], s58 offset:0
  s_load_dword s69, s[12:13], s58 offset:64
  s_load_dword s70, s[12:13], s58 offset:2048
  s_load_dword s71, s[12:13], s58 offset:2112
  s_load_dword s72, s[12:13], s58 offset:4096
  s_load_dword s73, s[12:13], s58 offset:4160
  s_waitcnt vmcnt(12)
  s_barrier
  s_mov_b32 s41, 1792
  s_add_u32 m0, s60, 98304
  s_nop 0
  buffer_load_dwordx4 v16, s[16:19], s41 offen offset:0  lds
  buffer_load_dwordx4 v17, s[16:19], s41 offen offset:1024  lds
  buffer_load_dwordx4 v18, s[16:19], s41 offen offset:2048  lds
  buffer_load_dwordx4 v19, s[16:19], s41 offen offset:3072  lds
  s_add_u32 m0, s60, 102400
  s_add_u32 s41, s41, 65536
  buffer_load_dwordx4 v16, s[16:19], s41 offen offset:0  lds
  buffer_load_dwordx4 v17, s[16:19], s41 offen offset:1024  lds
  buffer_load_dwordx4 v18, s[16:19], s41 offen offset:2048  lds
  buffer_load_dwordx4 v19, s[16:19], s41 offen offset:3072  lds
  s_mov_b32 s63, 0
L_sp14:
  s_waitcnt lgkmcnt(0)
  s_xor_b64 s[10:11], s[64:65], s[8:9]
  s_xor_b64 s[14:15], s[66:67], s[8:9]
  s_or_b64 s[10:11], s[10:11], s[14:15]
  s_cbranch_scc0 L_ok14
  s_load_dwordx4 s[64:67], s[4:5], s43 glc
  s_add_u32 s63, s63, 1
  s_cmp_lt_u32 s63, 20000
  s_cbranch_scc1 L_sp14
  s_waitcnt lgkmcnt(0)
L_ok14:
  s_mov_b32 s43, 7680
  s_load_dwordx4 s[64:67], s[4:5], s43 glc
  s_add_u32 m0, s61, 98304
  s_mov_b32 s62, 229376
  buffer_load_dwordx4 v20, s[28:31], s62 offen offset:0 sc1 lds
  buffer_load_dwordx4 v20, s[28:31], s62 offen offset:1024 sc1 lds
  buffer_load_dwordx4 v20, s[28:31], s62 offen offset:2048 sc1 lds
  buffer_load_dwordx4 v20, s[28:31], s62 offen offset:3072 sc1 lds
  s_mov_b32 s41, 1920
  s_lshr_b32 s53, s60, 1
  s_add_u32 m0, s53, 147456
  s_nop 0
  buffer_load_dwordx4 v16, s[16:19], s41 offen offset:0  lds
  buffer_load_dwordx4 v17, s[16:19], s41 offen offset:1024  lds
  buffer_load_dwordx4 v18, s[16:19], s41 offen offset:2048  lds
  buffer_load_dwordx4 v19, s[16:19], s41 offen offset:3072  lds
  s_waitcnt vmcnt(16)
  s_barrier
  s_mov_b32 s63, 0
L_sp15:
  s_waitcnt lgkmcnt(0)
  s_xor_b64 s[10:11], s[64:65], s[8:9]
  s_xor_b64 s[14:15], s[66:67], s[8:9]
  s_or_b64 s[10:11], s[10:11], s[14:15]
  s_cbranch_scc0 L_ok15
  s_load_dwordx4 s[64:67], s[4:5], s43 glc
  s_add_u32 s63, s63, 1
  s_cmp_lt_u32 s63, 20000
  s_cbranch_scc1 L_sp15
  s_waitcnt lgkmcnt(0)
L_ok15:
  s_add_u32 m0, s61, 0
  s_mov_b32 s62, 245760
  buffer_load_dwordx4 v20, s[28:31], s62 offen offset:0 sc1 lds
  buffer_load_dwordx4 v20, s[28:31], s62 offen offset:2048 sc1 lds
  s_waitcnt vmcnt(6)
  s_barrier
  s_add_u32 m0, s61, 0
  s_mov_b32 s62, 245760
  buffer_load_dwordx4 v20, s[28:31], s62 offen offset:1024 sc1 lds
  buffer_load_dwordx4 v20, s[28:31], s62 offen offset:3072 sc1 lds
  s_add_u32 m0, s60, 4096
  s_add_u32 s41, s41, 65536
  buffer_load_dwordx4 v16, s[16:19], s41 offen offset:0  lds
  buffer_load_dwordx4 v17, s[16:19], s41 offen offset:1024  lds
  buffer_load_dwordx4 v18, s[16:19], s41 offen offset:2048  lds
  buffer_load_dwordx4 v19, s[16:19], s41 offen offset:3072  lds
  s_waitcnt vmcnt(6)
  s_barrier
  s_waitcnt vmcnt(0)
  s_barrier
  s_endpgm
L_prod:
  s_mov_b32 s30, 9457664
  s_mov_b32 s31, 0x20000
  s_mov_b32 s18, 4194304
  s_mov_b32 s19, 0x20000
  s_mov_b32 s34, 14680064
  s_mov_b32 s35, 0x20000
  v_and_b32 v2, 63, v0
  v_lshlrev_b32 v5, 2, v3
  s_and_b32 s39, s38, 3
  s_mov_b32 s56, 917504
  s_mov_b32 s57, 16384
  s_mov_b32 s58, 512
  s_mov_b32 s59, 0
  s_mov_b32 s55, 7
  v_mov_b32 v15, 0x7ff00000
  s_cmp_lt_u32 s2, 28
  s_cbranch_scc1 L_pp
  s_mov_b32 s56, 512
  s_mov_b32 s57, 262144
  s_mov_b32 s58, 8192
  s_mov_b32 s59, 4096
  s_mov_b32 s51, 6
L_pl:
  s_add_u32 m0, m0, 4096
  v_add_u32 v16, 256, v16
  s_sub_u32 s51, s51, 1
  buffer_load_dword v16, s[24:27], 0 offen lds
  buffer_load_dword v16, s[24:27], s50 offen offset:256 lds
  s_cmp_lg_u32 s51, 0
  s_cbranch_scc1 L_pl
  s_waitcnt vmcnt(0)
  s_branch L_pq
L_pp:
  s_mov_b32 s22, 13762560
L_pq:
  s_add_u32 s10, s28, 9437184
  s_addc_u32 s11, s29, 0
  s_load_dwordx2 s[6:7], s[10:11], 0
  s_lshl_b32 s53, s38, 11
  s_add_u32 s53, s53, 32768
  v_lshrrev_b32 v1, 4, v3
  v_lshlrev_b32 v1, 10, v1
  v_lshl_add_u32 v1, v9, 3, v1
  v_and_b32 v6, 15, v3
  v_lshl_add_u32 v6, v6, 4, v1
  v_add_u32 v6, s53, v6
  v_lshl_add_u32 v7, v2, 4, s53
  s_lshl_b32 s53, s37, 18
  s_lshl_b32 s54, s52, 11
  s_add_u32 s53, s53, s54
  v_lshl_add_u32 v8, v2, 4, s53
  s_lshl_b32 s53, s37, 6
  s_lshr_b32 s54, s52, 1
  s_add_u32 s53, s53, s54
  s_lshl_b32 s53, s53, 7
  s_and_b32 s54, s52, 1
  s_lshl_b32 s54, s54, 3
  s_add_u32 s53, s53, s54
  s_add_u32 s53, s53, 7340032
  v_lshl_add_u32 v14, v2, 7, s53
  s_waitcnt vmcnt(0)
  buffer_load_dwordx4 v[32:35], v4, s[20:23], 0 offen nt
  buffer_load_dwordx4 v[36:39], v4, s[20:23], s45 offen nt
  buffer_load_dwordx4 v[40:43], v4, s[20:23], s46 offen nt
  buffer_load_dwordx4 v[44:47], v4, s[20:23], s47 offen nt
  v_add_u32 v4, s56, v4
  buffer_load_dword v17, v15, s[20:23], 0 offen
  buffer_load_dword v17, v15, s[20:23], 0 offen
  buffer_load_dwordx4 v[48:51], v4, s[20:23], 0 offen nt
  buffer_load_dwordx4 v[52:55], v4, s[20:23], s45 offen nt
  buffer_load_dwordx4 v[56:59], v4, s[20:23], s46 offen nt
  buffer_load_dwordx4 v[60:63], v4, s[20:23], s47 offen nt
  v_add_u32 v4, s56, v4
  s_waitcnt lgkmcnt(0)
  s_mul_i32 s8, s6, 1664525
  s_mul_i32 s9, s7, 22695477
  s_add_u32 s8, s8, 1013904223
  s_add_u32 s9, s9, 1
  v_mov_b32 v10, s8
  v_mov_b32 v11, s9
  s_mov_b32 s60, 0
  s_mov_b32 s61, 0
  s_mov_b32 s62, 0
  s_waitcnt vmcnt(10)
  s_barrier
L_p:
  s_waitcnt vmcnt(9)
  v_lshl_add_u32 v32, v32, 8, v5
  v_lshl_add_u32 v33, v33, 8, v5
  v_lshl_add_u32 v34, v34, 8, v5
  v_lshl_add_u32 v35, v35, 8, v5
  ds_read_u16 v96, v32 offset:0
  ds_read_u16 v97, v33 offset:2
  ds_read_u16 v98, v34 offset:128
  ds_read_u16 v99, v35 offset:130
  s_waitcnt vmcnt(8)
  v_lshl_add_u32 v36, v36, 8, v5
  v_lshl_add_u32 v37, v37, 8, v5
  v_lshl_add_u32 v38, v38, 8, v5
  v_lshl_add_u32 v39, v39, 8, v5
  ds_read_u16 v100, v36 offset:0
  ds_read_u16 v101, v37 offset:2
  ds_read_u16 v102, v38 offset:128
  ds_read_u16 v103, v39 offset:130
  s_waitcnt vmcnt(7)
  v_lshl_add_u32 v40, v40, 8, v5
  v_lshl_add_u32 v41, v41, 8, v5
  v_lshl_add_u32 v42, v42, 8, v5
  v_lshl_add_u32 v43, v43, 8, v5
  ds_read_u16 v104, v40 offset:0
  ds_read_u16 v105, v41 offset:2
  ds_read_u16 v106, v42 offset:128
  ds_read_u16 v107, v43 offset:130
  s_waitcnt vmcnt(6)
  v_lshl_add_u32 v44, v44, 8, v5
  v_lshl_add_u32 v45, v45, 8, v5
  v_lshl_add_u32 v46, v46, 8, v5
  v_lshl_add_u32 v47, v47, 8, v5
  ds_read_u16 v108, v44 offset:0
  ds_read_u16 v109, v45 offset:2
  ds_read_u16 v110, v46 offset:128
  ds_read_u16 v111, v47 offset:130
  s_waitcnt lgkmcnt(8)
  v_lshl_or_b32 v112, v100, 16, v96
  v_lshl_or_b32 v114, v101, 16, v97
  v_lshl_or_b32 v116, v102, 16, v98
  v_lshl_or_b32 v118, v103, 16, v99
  s_waitcnt lgkmcnt(3)
  v_lshl_or_b32 v113, v108, 16, v104
  ds_write_b64 v6, v[112:113] offset:0
  s_waitcnt lgkmcnt(3)
  v_lshl_or_b32 v115, v109, 16, v105
  ds_write_b64 v6, v[114:115] offset:256
  s_waitcnt lgkmcnt(3)
  v_lshl_or_b32 v117, v110, 16, v106
  ds_write_b64 v6, v[116:117] offset:512
  s_waitcnt lgkmcnt(3)
  v_lshl_or_b32 v119, v111, 16, v107
  ds_write_b64 v6, v[118:119] offset:768
  s_waitcnt lgkmcnt(0)
  ds_read_b128 v[120:123], v7 offset:0
  ds_read_b128 v[124:127], v7 offset:1024
  s_cmp_eq_u32 s62, 0
  s_cbranch_scc1 L_pa0
  s_waitcnt vmcnt(4)
  s_mov_b64 exec, 1
  buffer_store_dwordx2 v[10:11], v14, s[28:31], s61 offen sc1
  s_mov_b64 exec, -1
  s_add_u32 s61, s61, s58
L_pa0:
  s_waitcnt lgkmcnt(1)
  buffer_store_dwordx4 v[120:123], v8, s[28:31], s60 offen offset:0 sc1
  s_waitcnt lgkmcnt(0)
  buffer_store_dwordx4 v[124:127], v8, s[28:31], s60 offen offset:1024 sc1
  buffer_load_dwordx4 v[32:35], v4, s[20:23], 0 offen nt
  buffer_load_dwordx4 v[36:39], v4, s[20:23], s45 offen nt
  buffer_load_dwordx4 v[40:43], v4, s[20:23], s46 offen nt
  buffer_load_dwordx4 v[44:47], v4, s[20:23], s47 offen nt
  v_add_u32 v4, s56, v4
  v_add_u32 v5, s59, v5
  s_add_u32 s62, s62, 1
  s_add_u32 s60, s60, s57
  s_cmp_lt_u32 s62, s55
  s_cbranch_scc0 L_pe
  s_waitcnt vmcnt(9)
  v_lshl_add_u32 v48, v48, 8, v5
  v_lshl_add_u32 v49, v49, 8, v5
  v_lshl_add_u32 v50, v50, 8, v5
  v_lshl_add_u32 v51, v51, 8, v5
  ds_read_u16 v96, v48 offset:0
  ds_read_u16 v97, v49 offset:2
  ds_read_u16 v98, v50 offset:128
  ds_read_u16 v99, v51 offset:130
  s_waitcnt vmcnt(8)
  v_lshl_add_u32 v52, v52, 8, v5
  v_lshl_add_u32 v53, v53, 8, v5
  v_lshl_add_u32 v54, v54, 8, v5
  v_lshl_add_u32 v55, v55, 8, v5
  ds_read_u16 v100, v52 offset:0
  ds_read_u16 v101, v53 offset:2
  ds_read_u16 v102, v54 offset:128
  ds_read_u16 v103, v55 offset:130
  s_waitcnt vmcnt(7)
  v_lshl_add_u32 v56, v56, 8, v5
  v_lshl_add_u32 v57, v57, 8, v5
  v_lshl_add_u32 v58, v58, 8, v5
  v_lshl_add_u32 v59, v59, 8, v5
  ds_read_u16 v104, v56 offset:0
  ds_read_u16 v105, v57 offset:2
  ds_read_u16 v106, v58 offset:128
  ds_read_u16 v107, v59 offset:130
  s_waitcnt vmcnt(6)
  v_lshl_add_u32 v60, v60, 8, v5
  v_lshl_add_u32 v61, v61, 8, v5
  v_lshl_add_u32 v62, v62, 8, v5
  v_lshl_add_u32 v63, v63, 8, v5
  ds_read_u16 v108, v60 offset:0
  ds_read_u16 v109, v61 offset:2
  ds_read_u16 v110, v62 offset:128
  ds_read_u16 v111, v63 offset:130
  s_waitcnt lgkmcnt(8)
  v_lshl_or_b32 v112, v100, 16, v96
  v_lshl_or_b32 v114, v101, 16, v97
  v_lshl_or_b32 v116, v102, 16, v98
  v_lshl_or_b32 v118, v103, 16, v99
  s_waitcnt lgkmcnt(3)
  v_lshl_or_b32 v113, v108, 16, v104
  ds_write_b64 v6, v[112:113] offset:0
  s_waitcnt lgkmcnt(3)
  v_lshl_or_b32 v115, v109, 16, v105
  ds_write_b64 v6, v[114:115] offset:256
  s_waitcnt lgkmcnt(3)
  v_lshl_or_b32 v117, v110, 16, v106
  ds_write_b64 v6, v[116:117] offset:512
  s_waitcnt lgkmcnt(3)
  v_lshl_or_b32 v119, v111, 16, v107
  ds_write_b64 v6, v[118:119] offset:768
  s_waitcnt lgkmcnt(0)
  ds_read_b128 v[128:131], v7 offset:0
  ds_read_b128 v[132:135], v7 offset:1024
  s_cmp_eq_u32 s62, 0
  s_cbranch_scc1 L_pa1
  s_waitcnt vmcnt(4)
  s_mov_b64 exec, 1
  buffer_store_dwordx2 v[10:11], v14, s[28:31], s61 offen sc1
  s_mov_b64 exec, -1
  s_add_u32 s61, s61, s58
L_pa1:
  s_waitcnt lgkmcnt(1)
  buffer_store_dwordx4 v[128:131], v8, s[28:31], s60 offen offset:0 sc1
  s_waitcnt lgkmcnt(0)
  buffer_store_dwordx4 v[132:135], v8, s[28:31], s60 offen offset:1024 sc1
  buffer_load_dwordx4 v[48:51], v4, s[20:23], 0 offen nt
  buffer_load_dwordx4 v[52:55], v4, s[20:23], s45 offen nt
  buffer_load_dwordx4 v[56:59], v4, s[20:23], s46 offen nt
  buffer_load_dwordx4 v[60:63], v4, s[20:23], s47 offen nt
  v_add_u32 v4, s56, v4
  v_add_u32 v5, s59, v5
  s_add_u32 s62, s62, 1
  s_add_u32 s60, s60, s57
  s_cmp_lt_u32 s62, s55
  s_cbranch_scc1 L_p
L_pe:
  s_waitcnt vmcnt(4)
  s_mov_b64 exec, 1
  buffer_store_dwordx2 v[10:11], v14, s[28:31], s61 offen sc1
  s_mov_b64 exec, -1
  s_cmp_eq_u32 s38, 0
  s_cbranch_scc0 L_pz
  s_lshl_b32 s3, s2, 6
  s_add_u32 s3, s3, 9441280
  v_mov_b32 v12, s3
  s_mov_b64 exec, 1
  buffer_store_dwordx2 v[10:11], v12, s[28:31], 0 offen sc1
  s_mov_b64 exec, -1
  s_cmp_eq_u32 s2, 0
  s_cbranch_scc0 L_pz
  s_mov_b32 s63, 0
  v_lshlrev_b32 v12, 6, v2
  v_add_u32 v12, 9441280, v12
L_pw:
  s_mov_b32 s53, 0
  buffer_load_dwordx2 v[20:21], v12, s[28:31], s53 offen sc1
  s_mov_b32 s53, 4096
  buffer_load_dwordx2 v[22:23], v12, s[28:31], s53 offen sc1
  s_mov_b32 s53, 8192
  buffer_load_dwordx2 v[24:25], v12, s[28:31], s53 offen sc1
  s_mov_b32 s53, 12288
  buffer_load_dwordx2 v[26:27], v12, s[28:31], s53 offen sc1
  s_add_u32 s63, s63, 1
  s_waitcnt vmcnt(0)
  v_cmp_ne_u64 s[52:53], v[20:21], v[10:11]
  v_cmp_ne_u64 vcc, v[22:23], v[10:11]
  s_or_b64 s[52:53], s[52:53], vcc
  v_cmp_ne_u64 vcc, v[24:25], v[10:11]
  s_or_b64 s[52:53], s[52:53], vcc
  v_cmp_ne_u64 vcc, v[26:27], v[10:11]
  s_or_b64 s[52:53], s[52:53], vcc
  s_cbranch_scc0 L_pv
  s_cmp_lt_u32 s63, 20000
  s_cbranch_scc1 L_pw
L_pv:
  v_mov_b32 v12, 9437184
  s_mov_b64 exec, 1
  buffer_store_dwordx2 v[10:11], v12, s[28:31], 0 offen sc1
  s_mov_b64 exec, -1
L_pz:
L_drain:
  s_waitcnt vmcnt(0)
L_done:
  s_endpgm
L_end:
.section .rodata,"a"
.p2align 6
.amdhsa_kernel standalone__weight_only_int_squeezellm__prompt_kernel
  .amdhsa_next_free_vgpr 256
  .amdhsa_next_free_sgpr 102
  .amdhsa_accum_offset 160
  .amdhsa_group_segment_fixed_size 0
  .amdhsa_kernarg_size 48
  .amdhsa_user_sgpr_count 2
  .amdhsa_user_sgpr_kernarg_segment_ptr 1
  .amdhsa_system_sgpr_workgroup_id_x 1
.end_amdhsa_kernel
```

```asm
; @launch grid=(256,1,1) block=(512,1,1) lds=163840
.amdgcn_target "amdgcn-amd-amdhsa--gfx950"
.text
.globl standalone__weight_only_int_squeezellm__prompt_kernel
.p2align 8
.type standalone__weight_only_int_squeezellm__prompt_kernel,@function
standalone__weight_only_int_squeezellm__prompt_kernel:
  s_cmp_ge_u32 s2, 256
  s_cbranch_scc1 L_done
  s_load_dwordx2 s[24:25], s[0:1], 16
  s_load_dwordx2 s[20:21], s[0:1], 8
  s_load_dwordx2 s[28:29], s[0:1], 40
  s_load_dwordx2 s[16:17], s[0:1], 0
  s_load_dwordx2 s[32:33], s[0:1], 24
  s_and_b32 s3, s2, 1
  s_bfe_u32 s36, s2, 0x20003
  s_lshl2_add_u32 s36, s3, s36
  s_bfe_u32 s3, s2, 0x20001
  s_mul_i32 s3, s3, 7
  s_lshr_b32 s37, s2, 5
  s_add_u32 s37, s37, s3
  s_sub_u32 s37, s37, 1
  s_sub_u32 s3, s2, 28
  s_mul_i32 s53, s3, 7
  s_cmp_lt_u32 s3, 4
  s_cselect_b32 s51, 15, 8
  s_cselect_b32 s53, s53, s2
  s_cmp_lt_u32 s2, 32
  s_cselect_b32 s36, s51, s36
  s_cselect_b32 s37, s53, s37
  s_cselect_b32 s51, 0, 147456
  v_lshrrev_b32 v1, 6, v0
  v_and_b32 v3, 31, v0
  v_readfirstlane_b32 s38, v1
  v_bfe_u32 v9, v0, 5, 1
  s_mov_b32 s26, 114688
  s_mov_b32 s27, 0x20000
  s_mov_b32 s22, 14680064
  s_mov_b32 s23, 0x20000
  v_mul_u32_u24 v1, 57344, v9
  v_lshl_add_u32 v4, v3, 4, v1
  v_lshlrev_b32 v1, 3, v3
  v_lshl_add_u32 v16, v9, 2, v1
  s_mul_i32 s53, s38, 14336
  s_lshl_b32 s54, s37, 8
  s_add_u32 s53, s53, s54
  v_add_u32 v16, s53, v16
  s_lshl_b32 s53, s38, 9
  s_add_u32 m0, s53, s51
  s_movk_i32 s50, 6912
  s_lshl3_add_u32 s52, s36, s38
  s_mul_i32 s53, s52, 114688
  s_lshl1_add_u32 s53, s54, s53
  v_add_u32 v4, s53, v4
  s_movk_i32 s45, 14336
  s_movk_i32 s46, 28672
  s_mov_b32 s47, 43008
  s_cmp_lt_u32 s2, 32
  s_waitcnt lgkmcnt(0)
  buffer_load_dword v16, s[24:27], 0 offen lds
  buffer_load_dword v16, s[24:27], s50 offen offset:256 lds
  s_cbranch_scc1 L_h
  buffer_load_dwordx4 v[32:35], v4, s[20:23], 0 offen nt
  buffer_load_dwordx4 v[36:39], v4, s[20:23], s45 offen nt
  buffer_load_dwordx4 v[40:43], v4, s[20:23], s46 offen nt
  buffer_load_dwordx4 v[44:47], v4, s[20:23], s47 offen nt
  s_add_u32 s10, s28, 9437184
  s_addc_u32 s11, s29, 0
  s_load_dwordx2 s[6:7], s[10:11], 0
  s_branch L_ng
L_h:
  s_getpc_b64 s[14:15]
L_pc:
  s_lshr_b32 s53, s2, 3
  s_lshl3_add_u32 s53, s53, s38
  s_mul_i32 s53, s53, 512
  s_min_u32 s53, s53, L_end-standalone__weight_only_int_squeezellm__prompt_kernel-512
  s_sub_u32 s14, s14, L_pc-standalone__weight_only_int_squeezellm__prompt_kernel
  s_subb_u32 s15, s15, 0
  s_load_dword s68, s[14:15], s53 offset:0
  s_load_dword s69, s[14:15], s53 offset:64
  s_load_dword s70, s[14:15], s53 offset:128
  s_load_dword s71, s[14:15], s53 offset:192
  s_load_dword s72, s[14:15], s53 offset:256
  s_load_dword s73, s[14:15], s53 offset:320
  s_load_dword s74, s[14:15], s53 offset:384
  s_load_dword s75, s[14:15], s53 offset:448
  s_branch L_prod
L_ng:
  s_mov_b32 s30, 9457664
  s_mov_b32 s31, 0x20000
  s_mov_b32 s18, 4194304
  s_mov_b32 s19, 0x20000
  s_mov_b32 s34, 14680064
  s_mov_b32 s35, 0x20000
  v_and_b32 v2, 63, v0
  v_lshlrev_b32 v5, 2, v3
  s_and_b32 s39, s38, 3
  v_add_u32 v5, 147456, v5
  s_lshl_b32 s53, s38, 11
  s_add_u32 s53, s53, 32768
  v_lshrrev_b32 v1, 4, v3
  v_lshlrev_b32 v1, 10, v1
  v_lshl_add_u32 v1, v9, 3, v1
  v_and_b32 v6, 15, v3
  v_lshl_add_u32 v6, v6, 4, v1
  v_add_u32 v6, s53, v6
  v_lshl_add_u32 v7, v2, 4, s53
  s_lshl_b32 s53, s37, 18
  s_lshl_b32 s54, s52, 11
  s_add_u32 s53, s53, s54
  v_lshl_add_u32 v8, v2, 4, s53
  s_lshl_b32 s53, s37, 6
  s_lshr_b32 s54, s52, 1
  s_add_u32 s53, s53, s54
  s_lshl_b32 s53, s53, 7
  s_and_b32 s54, s52, 1
  s_lshl_b32 s54, s54, 3
  s_add_u32 s53, s53, s54
  s_add_u32 s53, s53, 7340032
  v_lshl_add_u32 v14, v2, 7, s53
  s_lshl_b32 s53, s37, 2
  s_add_u32 s53, s53, s39
  s_mul_i32 s53, s53, 3
  s_min_u32 s53, s53, 253
  s_lshl_b32 s54, s36, 8
  s_add_u32 s53, s53, s54
  s_lshl_b32 s53, s53, 11
  s_add_u32 s12, s16, s53
  s_addc_u32 s13, s17, 0
  s_andn2_b32 s40, 4, s36
  v_and_b32 v3, 15, v2
  v_lshrrev_b32 v9, 4, v2
  v_lshrrev_b32 v1, 1, v3
  v_xor_b32 v1, v1, v9
  v_lshlrev_b32 v1, 4, v1
  v_lshl_add_u32 v144, v3, 7, v1
  s_lshl_b32 s54, s38, 13
  v_add_u32 v144, s54, v144
  v_xor_b32 v145, 64, v144
  v_lshlrev_b32 v1, 11, v9
  v_lshl_add_u32 v146, v3, 4, v1
  v_add_u32 v146, 32768, v146
  s_lshl_b32 s52, s36, 8
  s_lshl_b32 s53, s38, 6
  s_add_u32 s52, s52, s53
  s_mul_i32 s52, s52, 7168
  s_lshl_b32 s53, s37, 8
  s_add_u32 s52, s52, s53
  v_and_b32 v1, 1, v3
  v_lshl_add_u32 v1, v9, 2, v1
  v_mul_u32_u24 v1, 7168, v1
  v_lshrrev_b32 v147, 1, v3
  v_lshl_add_u32 v1, v147, 4, v1
  v_add_u32 v147, s52, v1
  v_lshrrev_b32 v20, 3, v2
  v_lshlrev_b32 v20, 11, v20
  v_lshrrev_b32 v1, 4, v2
  v_xor_b32 v1, v1, v2
  v_and_b32 v1, 7, v1
  v_lshl_add_u32 v20, v1, 4, v20
  s_lshl_b32 s52, s36, 19
  s_lshl_b32 s53, s39, 17
  s_add_u32 s53, s52, s53
  v_add_u32 v16, s53, v20
  v_xor_b32 v17, 64, v16
  v_add_u32 v18, 30720, v16
  v_add_u32 v19, 46080, v17
  v_add_u32 v17, 15360, v17
  s_lshl_b32 s60, s39, 13
  s_lshl_b32 s53, s37, 18
  s_lshl_b32 s54, s39, 12
  s_add_u32 s53, s53, s54
  v_lshl_add_u32 v20, v2, 4, s53
  s_add_u32 s61, s54, 32768
  s_lshl_b32 s53, s37, 13
  s_lshl_b32 s54, s39, 7
  s_add_u32 s53, s53, s54
  s_and_b32 s54, s36, 0
  s_lshl_b32 s54, s54, 7
  s_add_u32 s53, s53, s54
  s_add_u32 s53, s53, 7340032
  s_add_u32 s4, s28, s53
  s_addc_u32 s5, s29, 0
  s_lshl_b32 s41, s36, 7
  s_lshr_b32 s53, s38, 2
  s_lshl_b32 s54, s53, 16
  s_add_u32 s41, s41, s54
  s_lshl_b32 s53, s53, 12
  s_add_u32 m0, s60, s53
  s_waitcnt lgkmcnt(0)
  s_mul_i32 s8, s6, 1664525
  s_mul_i32 s9, s7, 22695477
  s_add_u32 s8, s8, 1013904223
  s_add_u32 s9, s9, 1
  v_mov_b32 v10, s8
  v_mov_b32 v11, s9
  s_waitcnt vmcnt(4)
  s_barrier
  s_waitcnt vmcnt(3)
  v_lshl_add_u32 v32, v32, 8, v5
  v_lshl_add_u32 v33, v33, 8, v5
  v_lshl_add_u32 v34, v34, 8, v5
  v_lshl_add_u32 v35, v35, 8, v5
  ds_read_u16 v96, v32 offset:0
  ds_read_u16 v97, v33 offset:2
  ds_read_u16 v98, v34 offset:128
  ds_read_u16 v99, v35 offset:130
  buffer_load_dwordx4 v16, s[16:19], s41 offen offset:0 lds
  s_waitcnt vmcnt(3)
  v_lshl_add_u32 v36, v36, 8, v5
  v_lshl_add_u32 v37, v37, 8, v5
  v_lshl_add_u32 v38, v38, 8, v5
  v_lshl_add_u32 v39, v39, 8, v5
  ds_read_u16 v100, v36 offset:0
  ds_read_u16 v101, v37 offset:2
  ds_read_u16 v102, v38 offset:128
  ds_read_u16 v103, v39 offset:130
  buffer_load_dwordx4 v17, s[16:19], s41 offen offset:1024 lds
  s_waitcnt vmcnt(3)
  v_lshl_add_u32 v40, v40, 8, v5
  v_lshl_add_u32 v41, v41, 8, v5
  v_lshl_add_u32 v42, v42, 8, v5
  v_lshl_add_u32 v43, v43, 8, v5
  ds_read_u16 v104, v40 offset:0
  ds_read_u16 v105, v41 offset:2
  ds_read_u16 v106, v42 offset:128
  ds_read_u16 v107, v43 offset:130
  buffer_load_dwordx4 v18, s[16:19], s41 offen offset:2048 lds
  s_waitcnt vmcnt(3)
  v_lshl_add_u32 v44, v44, 8, v5
  v_lshl_add_u32 v45, v45, 8, v5
  v_lshl_add_u32 v46, v46, 8, v5
  v_lshl_add_u32 v47, v47, 8, v5
  ds_read_u16 v108, v44 offset:0
  ds_read_u16 v109, v45 offset:2
  ds_read_u16 v110, v46 offset:128
  ds_read_u16 v111, v47 offset:130
  buffer_load_dwordx4 v19, s[16:19], s41 offen offset:3072 lds
  s_waitcnt lgkmcnt(8)
  v_lshl_or_b32 v112, v100, 16, v96
  v_lshl_or_b32 v114, v101, 16, v97
  v_lshl_or_b32 v116, v102, 16, v98
  v_lshl_or_b32 v118, v103, 16, v99
  s_waitcnt lgkmcnt(3)
  v_lshl_or_b32 v113, v108, 16, v104
  ds_write_b64 v6, v[112:113] offset:0
  s_waitcnt lgkmcnt(3)
  v_lshl_or_b32 v115, v109, 16, v105
  ds_write_b64 v6, v[114:115] offset:256
  s_waitcnt lgkmcnt(3)
  v_lshl_or_b32 v117, v110, 16, v106
  ds_write_b64 v6, v[116:117] offset:512
  s_waitcnt lgkmcnt(3)
  v_lshl_or_b32 v119, v111, 16, v107
  ds_write_b64 v6, v[118:119] offset:768
  s_waitcnt lgkmcnt(0)
  ds_read_b128 v[148:151], v7 offset:0
  ds_read_b128 v[152:155], v7 offset:1024
  s_waitcnt lgkmcnt(1)
  buffer_store_dwordx4 v[148:151], v8, s[28:31], 0 offen offset:0 sc1
  s_waitcnt lgkmcnt(0)
  buffer_store_dwordx4 v[152:155], v8, s[28:31], 0 offen offset:1024 sc1
  s_cmp_ge_u32 s38, 4
  s_cbranch_scc1 L_loader
  s_add_u32 s58, s40, 0
  s_lshl_b32 s58, s58, 7
  s_load_dword s92, s[12:13], s58 offset:0
  s_load_dword s93, s[12:13], s58 offset:64
  s_load_dword s94, s[12:13], s58 offset:2048
  s_load_dword s95, s[12:13], s58 offset:2112
  s_load_dword s96, s[12:13], s58 offset:4096
  s_load_dword s97, s[12:13], s58 offset:4160
  s_add_u32 s58, s40, 1
  s_lshl_b32 s58, s58, 7
  s_load_dword s92, s[12:13], s58 offset:0
  s_load_dword s93, s[12:13], s58 offset:64
  s_load_dword s94, s[12:13], s58 offset:2048
  s_load_dword s95, s[12:13], s58 offset:2112
  s_load_dword s96, s[12:13], s58 offset:4096
  s_load_dword s97, s[12:13], s58 offset:4160
  v_mov_b32 v5, v144
  v_mov_b32 v6, v145
  v_mov_b32 v7, v146
  v_mov_b32 v16, 0
  v_mov_b32 v17, 0
  v_mov_b32 v18, 0
  v_mov_b32 v19, 0
  v_mov_b32 v20, 0
  v_mov_b32 v21, 0
  v_mov_b32 v22, 0
  v_mov_b32 v23, 0
  v_mov_b32 v24, 0
  v_mov_b32 v25, 0
  v_mov_b32 v26, 0
  v_mov_b32 v27, 0
  v_mov_b32 v28, 0
  v_mov_b32 v29, 0
  v_mov_b32 v30, 0
  v_mov_b32 v31, 0
  v_mov_b32 v32, 0
  v_mov_b32 v33, 0
  v_mov_b32 v34, 0
  v_mov_b32 v35, 0
  v_mov_b32 v36, 0
  v_mov_b32 v37, 0
  v_mov_b32 v38, 0
  v_mov_b32 v39, 0
  v_mov_b32 v40, 0
  v_mov_b32 v41, 0
  v_mov_b32 v42, 0
  v_mov_b32 v43, 0
  v_mov_b32 v44, 0
  v_mov_b32 v45, 0
  v_mov_b32 v46, 0
  v_mov_b32 v47, 0
  v_mov_b32 v48, 0
  v_mov_b32 v49, 0
  v_mov_b32 v50, 0
  v_mov_b32 v51, 0
  v_mov_b32 v52, 0
  v_mov_b32 v53, 0
  v_mov_b32 v54, 0
  v_mov_b32 v55, 0
  v_mov_b32 v56, 0
  v_mov_b32 v57, 0
  v_mov_b32 v58, 0
  v_mov_b32 v59, 0
  v_mov_b32 v60, 0
  v_mov_b32 v61, 0
  v_mov_b32 v62, 0
  v_mov_b32 v63, 0
  v_mov_b32 v64, 0
  v_mov_b32 v65, 0
  v_mov_b32 v66, 0
  v_mov_b32 v67, 0
  v_mov_b32 v68, 0
  v_mov_b32 v69, 0
  v_mov_b32 v70, 0
  v_mov_b32 v71, 0
  v_mov_b32 v72, 0
  v_mov_b32 v73, 0
  v_mov_b32 v74, 0
  v_mov_b32 v75, 0
  v_mov_b32 v76, 0
  v_mov_b32 v77, 0
  v_mov_b32 v78, 0
  v_mov_b32 v79, 0
  v_mov_b32 v80, 0
  v_mov_b32 v81, 0
  v_mov_b32 v82, 0
  v_mov_b32 v83, 0
  v_mov_b32 v84, 0
  v_mov_b32 v85, 0
  v_mov_b32 v86, 0
  v_mov_b32 v87, 0
  v_mov_b32 v88, 0
  v_mov_b32 v89, 0
  v_mov_b32 v90, 0
  v_mov_b32 v91, 0
  v_mov_b32 v92, 0
  v_mov_b32 v93, 0
  v_mov_b32 v94, 0
  v_mov_b32 v95, 0
  v_mov_b32 v96, 0
  v_mov_b32 v97, 0
  v_mov_b32 v98, 0
  v_mov_b32 v99, 0
  v_mov_b32 v100, 0
  v_mov_b32 v101, 0
  v_mov_b32 v102, 0
  v_mov_b32 v103, 0
  v_mov_b32 v104, 0
  v_mov_b32 v105, 0
  v_mov_b32 v106, 0
  v_mov_b32 v107, 0
  v_mov_b32 v108, 0
  v_mov_b32 v109, 0
  v_mov_b32 v110, 0
  v_mov_b32 v111, 0
  v_mov_b32 v112, 0
  v_mov_b32 v113, 0
  v_mov_b32 v114, 0
  v_mov_b32 v115, 0
  v_mov_b32 v116, 0
  v_mov_b32 v117, 0
  v_mov_b32 v118, 0
  v_mov_b32 v119, 0
  v_mov_b32 v120, 0
  v_mov_b32 v121, 0
  v_mov_b32 v122, 0
  v_mov_b32 v123, 0
  v_mov_b32 v124, 0
  v_mov_b32 v125, 0
  v_mov_b32 v126, 0
  v_mov_b32 v127, 0
  v_mov_b32 v128, 0
  v_mov_b32 v129, 0
  v_mov_b32 v130, 0
  v_mov_b32 v131, 0
  v_mov_b32 v132, 0
  v_mov_b32 v133, 0
  v_mov_b32 v134, 0
  v_mov_b32 v135, 0
  v_mov_b32 v136, 0
  v_mov_b32 v137, 0
  v_mov_b32 v138, 0
  v_mov_b32 v139, 0
  v_mov_b32 v140, 0
  v_mov_b32 v141, 0
  v_mov_b32 v142, 0
  v_mov_b32 v143, 0
  s_waitcnt vmcnt(0)
  s_mov_b64 exec, 1
  buffer_store_dwordx2 v[10:11], v14, s[28:31], 0 offen sc1
  s_mov_b64 exec, -1
  s_mov_b32 s44, 0
  s_mov_b32 s45, 7168
  s_mov_b32 s46, 14336
  s_mov_b32 s47, 21504
  s_mov_b32 s48, 114688
  s_mov_b32 s49, 121856
  s_mov_b32 s50, 129024
  s_mov_b32 s51, 136192
  s_mov_b32 s52, 229376
  s_mov_b32 s53, 236544
  s_mov_b32 s54, 243712
  s_mov_b32 s55, 250880
  s_mov_b32 s56, 344064
  s_mov_b32 s57, 351232
  s_mov_b32 s58, 358400
  s_mov_b32 s59, 365568
  s_mov_b32 s60, 0
  s_mov_b32 s61, 0
  s_mov_b32 s60, 49152
  s_mov_b32 s61, 5
  s_mov_b32 s62, 49152
  s_lshl_b32 s63, s38, 12
  s_sub_u32 s63, 147456, s63
  s_mov_b32 vcc_lo, 0x55555555
  s_mov_b32 vcc_hi, 0x55555555
  s_barrier
  ds_read_b128 a[64:67], v7 offset:0
  ds_read_b128 a[68:71], v7 offset:8192
  ds_read_b128 a[0:3], v5 offset:0
  ds_read_b128 a[4:7], v6 offset:0
  ds_read_b128 a[8:11], v5 offset:2048
  ds_read_b128 a[12:15], v6 offset:2048
  ds_read_b128 a[16:19], v5 offset:4096
  ds_read_b128 a[72:75], v7 offset:256
  ds_read_b128 a[76:79], v7 offset:8448
  ds_read_b128 a[20:23], v6 offset:4096
  ds_read_b128 a[24:27], v5 offset:6144
  ds_read_b128 a[28:31], v6 offset:6144
  ds_read_b128 a[80:83], v7 offset:512
  ds_read_b128 a[84:87], v7 offset:8704
  s_cmp_eq_u32 s38, 0
  s_cbranch_scc0 L_c0
  s_lshl_b32 s3, s2, 6
  s_add_u32 s3, s3, 9441280
  v_mov_b32 v12, s3
  s_mov_b64 exec, 1
  buffer_store_dwordx2 v[10:11], v12, s[28:31], 0 offen sc1
  s_mov_b64 exec, -1
L_c0:
  s_waitcnt lgkmcnt(0)
.p2align 6
L_c:
  v_mfma_f32_16x16x32_bf16 v[16:19], a[0:3], a[64:67], v[16:19]
  ds_read_b128 a[88:91], v7 offset:768
  v_mfma_f32_16x16x32_bf16 v[16:19], a[4:7], a[68:71], v[16:19]
  ds_read_b128 a[92:95], v7 offset:8960
  v_mfma_f32_16x16x32_bf16 v[48:51], a[8:11], a[64:67], v[48:51]
  v_mfma_f32_16x16x32_bf16 v[48:51], a[12:15], a[68:71], v[48:51]
  s_cmp_eq_u32 s60, 147456
  v_mfma_f32_16x16x32_bf16 v[80:83], a[16:19], a[64:67], v[80:83]
  v_mfma_f32_16x16x32_bf16 v[80:83], a[20:23], a[68:71], v[80:83]
  s_cselect_b32 s60, 0, s60
  v_add_u32 v1, s60, v146
  v_mfma_f32_16x16x32_bf16 v[112:115], a[24:27], a[64:67], v[112:115]
  v_mfma_f32_16x16x32_bf16 v[112:115], a[28:31], a[68:71], v[112:115]
  v_mfma_f32_16x16x32_bf16 v[20:23], a[0:3], a[72:75], v[20:23]
  ds_read_b128 a[64:67], v7 offset:1024
  v_mfma_f32_16x16x32_bf16 v[20:23], a[4:7], a[76:79], v[20:23]
  ds_read_b128 a[68:71], v7 offset:9216
  v_mfma_f32_16x16x32_bf16 v[52:55], a[8:11], a[72:75], v[52:55]
  v_mfma_f32_16x16x32_bf16 v[52:55], a[12:15], a[76:79], v[52:55]
  v_mfma_f32_16x16x32_bf16 v[84:87], a[16:19], a[72:75], v[84:87]
  v_mfma_f32_16x16x32_bf16 v[84:87], a[20:23], a[76:79], v[84:87]
  v_mfma_f32_16x16x32_bf16 v[116:119], a[24:27], a[72:75], v[116:119]
  v_mfma_f32_16x16x32_bf16 v[116:119], a[28:31], a[76:79], v[116:119]
  v_mfma_f32_16x16x32_bf16 v[24:27], a[0:3], a[80:83], v[24:27]
  ds_read_b128 a[72:75], v7 offset:1280
  v_mfma_f32_16x16x32_bf16 v[24:27], a[4:7], a[84:87], v[24:27]
  ds_read_b128 a[76:79], v7 offset:9472
  v_mfma_f32_16x16x32_bf16 v[56:59], a[8:11], a[80:83], v[56:59]
  v_mfma_f32_16x16x32_bf16 v[56:59], a[12:15], a[84:87], v[56:59]
  v_mfma_f32_16x16x32_bf16 v[88:91], a[16:19], a[80:83], v[88:91]
  v_mfma_f32_16x16x32_bf16 v[88:91], a[20:23], a[84:87], v[88:91]
  v_mfma_f32_16x16x32_bf16 v[120:123], a[24:27], a[80:83], v[120:123]
  v_mfma_f32_16x16x32_bf16 v[120:123], a[28:31], a[84:87], v[120:123]
  v_add_u32 v3, s60, v144
  s_waitcnt lgkmcnt(0)
  v_mfma_f32_16x16x32_bf16 v[28:31], a[0:3], a[88:91], v[28:31]
  ds_read_b128 a[80:83], v7 offset:1536
  v_mfma_f32_16x16x32_bf16 v[28:31], a[4:7], a[92:95], v[28:31]
  ds_read_b128 a[84:87], v7 offset:9728
  v_mfma_f32_16x16x32_bf16 v[60:63], a[8:11], a[88:91], v[60:63]
  v_mfma_f32_16x16x32_bf16 v[60:63], a[12:15], a[92:95], v[60:63]
  v_add_u32_e64 v4, s60, v145
  v_mfma_f32_16x16x32_bf16 v[92:95], a[16:19], a[88:91], v[92:95]
  v_mfma_f32_16x16x32_bf16 v[92:95], a[20:23], a[92:95], v[92:95]
  v_mfma_f32_16x16x32_bf16 v[124:127], a[24:27], a[88:91], v[124:127]
  v_mfma_f32_16x16x32_bf16 v[124:127], a[28:31], a[92:95], v[124:127]
  v_mfma_f32_16x16x32_bf16 v[32:35], a[0:3], a[64:67], v[32:35]
  ds_read_b128 a[88:91], v7 offset:1792
  v_mfma_f32_16x16x32_bf16 v[32:35], a[4:7], a[68:71], v[32:35]
  ds_read_b128 a[92:95], v7 offset:9984
  v_mfma_f32_16x16x32_bf16 v[64:67], a[8:11], a[64:67], v[64:67]
  v_mfma_f32_16x16x32_bf16 v[64:67], a[12:15], a[68:71], v[64:67]
  v_mfma_f32_16x16x32_bf16 v[96:99], a[16:19], a[64:67], v[96:99]
  v_mfma_f32_16x16x32_bf16 v[96:99], a[20:23], a[68:71], v[96:99]
  v_mfma_f32_16x16x32_bf16 v[128:131], a[24:27], a[64:67], v[128:131]
  v_mfma_f32_16x16x32_bf16 v[128:131], a[28:31], a[68:71], v[128:131]
  s_waitcnt lgkmcnt(0)
  s_barrier
  v_mfma_f32_16x16x32_bf16 v[36:39], a[0:3], a[72:75], v[36:39]
  ds_read_b128 a[64:67], v1 offset:0
  v_mfma_f32_16x16x32_bf16 v[36:39], a[4:7], a[76:79], v[36:39]
  ds_read_b128 a[68:71], v1 offset:8192
  v_mfma_f32_16x16x32_bf16 v[68:71], a[8:11], a[72:75], v[68:71]
  ds_read_b128 a[32:35], v3 offset:0
  v_mfma_f32_16x16x32_bf16 v[68:71], a[12:15], a[76:79], v[68:71]
  ds_read_b128 a[36:39], v4 offset:0
  v_mfma_f32_16x16x32_bf16 v[100:103], a[16:19], a[72:75], v[100:103]
  ds_read_b128 a[40:43], v3 offset:2048
  v_mfma_f32_16x16x32_bf16 v[100:103], a[20:23], a[76:79], v[100:103]
  ds_read_b128 a[44:47], v4 offset:2048
  v_mfma_f32_16x16x32_bf16 v[132:135], a[24:27], a[72:75], v[132:135]
  v_mfma_f32_16x16x32_bf16 v[132:135], a[28:31], a[76:79], v[132:135]
  ds_read_b128 a[48:51], v3 offset:4096
  v_mfma_f32_16x16x32_bf16 v[40:43], a[0:3], a[80:83], v[40:43]
  ds_read_b128 a[72:75], v1 offset:256
  v_mfma_f32_16x16x32_bf16 v[40:43], a[4:7], a[84:87], v[40:43]
  ds_read_b128 a[76:79], v1 offset:8448
  v_mfma_f32_16x16x32_bf16 v[72:75], a[8:11], a[80:83], v[72:75]
  v_mfma_f32_16x16x32_bf16 v[72:75], a[12:15], a[84:87], v[72:75]
  ds_read_b128 a[52:55], v4 offset:4096
  v_mfma_f32_16x16x32_bf16 v[104:107], a[16:19], a[80:83], v[104:107]
  v_mfma_f32_16x16x32_bf16 v[104:107], a[20:23], a[84:87], v[104:107]
  ds_read_b128 a[56:59], v3 offset:6144
  v_mfma_f32_16x16x32_bf16 v[136:139], a[24:27], a[80:83], v[136:139]
  v_mfma_f32_16x16x32_bf16 v[136:139], a[28:31], a[84:87], v[136:139]
  ds_read_b128 a[60:63], v4 offset:6144
  v_mfma_f32_16x16x32_bf16 v[44:47], a[0:3], a[88:91], v[44:47]
  ds_read_b128 a[80:83], v1 offset:512
  v_mfma_f32_16x16x32_bf16 v[44:47], a[4:7], a[92:95], v[44:47]
  ds_read_b128 a[84:87], v1 offset:8704
  v_mfma_f32_16x16x32_bf16 v[76:79], a[8:11], a[88:91], v[76:79]
  v_mfma_f32_16x16x32_bf16 v[76:79], a[12:15], a[92:95], v[76:79]
  v_mfma_f32_16x16x32_bf16 v[108:111], a[16:19], a[88:91], v[108:111]
  v_mfma_f32_16x16x32_bf16 v[108:111], a[20:23], a[92:95], v[108:111]
  v_mfma_f32_16x16x32_bf16 v[140:143], a[24:27], a[88:91], v[140:143]
  v_mfma_f32_16x16x32_bf16 v[140:143], a[28:31], a[92:95], v[140:143]
  s_add_u32 s60, s60, s62
  s_waitcnt lgkmcnt(0)
  v_mfma_f32_16x16x32_bf16 v[16:19], a[32:35], a[64:67], v[16:19]
  ds_read_b128 a[88:91], v1 offset:768
  v_mfma_f32_16x16x32_bf16 v[16:19], a[36:39], a[68:71], v[16:19]
  ds_read_b128 a[92:95], v1 offset:8960
  v_mfma_f32_16x16x32_bf16 v[48:51], a[40:43], a[64:67], v[48:51]
  v_mfma_f32_16x16x32_bf16 v[48:51], a[44:47], a[68:71], v[48:51]
  s_cmp_eq_u32 s60, 147456
  v_mfma_f32_16x16x32_bf16 v[80:83], a[48:51], a[64:67], v[80:83]
  v_mfma_f32_16x16x32_bf16 v[80:83], a[52:55], a[68:71], v[80:83]
  s_cselect_b32 s60, 0, s60
  v_add_u32 v7, s60, v146
  v_mfma_f32_16x16x32_bf16 v[112:115], a[56:59], a[64:67], v[112:115]
  v_mfma_f32_16x16x32_bf16 v[112:115], a[60:63], a[68:71], v[112:115]
  v_mfma_f32_16x16x32_bf16 v[20:23], a[32:35], a[72:75], v[20:23]
  ds_read_b128 a[64:67], v1 offset:1024
  v_mfma_f32_16x16x32_bf16 v[20:23], a[36:39], a[76:79], v[20:23]
  ds_read_b128 a[68:71], v1 offset:9216
  v_mfma_f32_16x16x32_bf16 v[52:55], a[40:43], a[72:75], v[52:55]
  v_mfma_f32_16x16x32_bf16 v[52:55], a[44:47], a[76:79], v[52:55]
  v_mfma_f32_16x16x32_bf16 v[84:87], a[48:51], a[72:75], v[84:87]
  v_mfma_f32_16x16x32_bf16 v[84:87], a[52:55], a[76:79], v[84:87]
  v_mfma_f32_16x16x32_bf16 v[116:119], a[56:59], a[72:75], v[116:119]
  v_mfma_f32_16x16x32_bf16 v[116:119], a[60:63], a[76:79], v[116:119]
  v_mfma_f32_16x16x32_bf16 v[24:27], a[32:35], a[80:83], v[24:27]
  ds_read_b128 a[72:75], v1 offset:1280
  v_mfma_f32_16x16x32_bf16 v[24:27], a[36:39], a[84:87], v[24:27]
  ds_read_b128 a[76:79], v1 offset:9472
  v_mfma_f32_16x16x32_bf16 v[56:59], a[40:43], a[80:83], v[56:59]
  v_mfma_f32_16x16x32_bf16 v[56:59], a[44:47], a[84:87], v[56:59]
  v_mfma_f32_16x16x32_bf16 v[88:91], a[48:51], a[80:83], v[88:91]
  v_mfma_f32_16x16x32_bf16 v[88:91], a[52:55], a[84:87], v[88:91]
  v_mfma_f32_16x16x32_bf16 v[120:123], a[56:59], a[80:83], v[120:123]
  v_mfma_f32_16x16x32_bf16 v[120:123], a[60:63], a[84:87], v[120:123]
  v_add_u32 v5, s60, v144
  s_waitcnt lgkmcnt(0)
  v_mfma_f32_16x16x32_bf16 v[28:31], a[32:35], a[88:91], v[28:31]
  ds_read_b128 a[80:83], v1 offset:1536
  v_mfma_f32_16x16x32_bf16 v[28:31], a[36:39], a[92:95], v[28:31]
  ds_read_b128 a[84:87], v1 offset:9728
  v_mfma_f32_16x16x32_bf16 v[60:63], a[40:43], a[88:91], v[60:63]
  v_mfma_f32_16x16x32_bf16 v[60:63], a[44:47], a[92:95], v[60:63]
  v_add_u32_e64 v6, s60, v145
  v_mfma_f32_16x16x32_bf16 v[92:95], a[48:51], a[88:91], v[92:95]
  v_mfma_f32_16x16x32_bf16 v[92:95], a[52:55], a[92:95], v[92:95]
  v_mfma_f32_16x16x32_bf16 v[124:127], a[56:59], a[88:91], v[124:127]
  v_mfma_f32_16x16x32_bf16 v[124:127], a[60:63], a[92:95], v[124:127]
  v_mfma_f32_16x16x32_bf16 v[32:35], a[32:35], a[64:67], v[32:35]
  ds_read_b128 a[88:91], v1 offset:1792
  v_mfma_f32_16x16x32_bf16 v[32:35], a[36:39], a[68:71], v[32:35]
  ds_read_b128 a[92:95], v1 offset:9984
  v_mfma_f32_16x16x32_bf16 v[64:67], a[40:43], a[64:67], v[64:67]
  v_mfma_f32_16x16x32_bf16 v[64:67], a[44:47], a[68:71], v[64:67]
  v_mfma_f32_16x16x32_bf16 v[96:99], a[48:51], a[64:67], v[96:99]
  v_mfma_f32_16x16x32_bf16 v[96:99], a[52:55], a[68:71], v[96:99]
  v_mfma_f32_16x16x32_bf16 v[128:131], a[56:59], a[64:67], v[128:131]
  v_mfma_f32_16x16x32_bf16 v[128:131], a[60:63], a[68:71], v[128:131]
  s_waitcnt lgkmcnt(0)
  s_barrier
  v_mfma_f32_16x16x32_bf16 v[36:39], a[32:35], a[72:75], v[36:39]
  ds_read_b128 a[64:67], v7 offset:0
  v_mfma_f32_16x16x32_bf16 v[36:39], a[36:39], a[76:79], v[36:39]
  ds_read_b128 a[68:71], v7 offset:8192
  v_mfma_f32_16x16x32_bf16 v[68:71], a[40:43], a[72:75], v[68:71]
  ds_read_b128 a[0:3], v5 offset:0
  v_mfma_f32_16x16x32_bf16 v[68:71], a[44:47], a[76:79], v[68:71]
  ds_read_b128 a[4:7], v6 offset:0
  v_mfma_f32_16x16x32_bf16 v[100:103], a[48:51], a[72:75], v[100:103]
  ds_read_b128 a[8:11], v5 offset:2048
  v_mfma_f32_16x16x32_bf16 v[100:103], a[52:55], a[76:79], v[100:103]
  ds_read_b128 a[12:15], v6 offset:2048
  v_mfma_f32_16x16x32_bf16 v[132:135], a[56:59], a[72:75], v[132:135]
  v_mfma_f32_16x16x32_bf16 v[132:135], a[60:63], a[76:79], v[132:135]
  ds_read_b128 a[16:19], v5 offset:4096
  v_mfma_f32_16x16x32_bf16 v[40:43], a[32:35], a[80:83], v[40:43]
  ds_read_b128 a[72:75], v7 offset:256
  v_mfma_f32_16x16x32_bf16 v[40:43], a[36:39], a[84:87], v[40:43]
  ds_read_b128 a[76:79], v7 offset:8448
  v_mfma_f32_16x16x32_bf16 v[72:75], a[40:43], a[80:83], v[72:75]
  v_mfma_f32_16x16x32_bf16 v[72:75], a[44:47], a[84:87], v[72:75]
  ds_read_b128 a[20:23], v6 offset:4096
  v_mfma_f32_16x16x32_bf16 v[104:107], a[48:51], a[80:83], v[104:107]
  v_mfma_f32_16x16x32_bf16 v[104:107], a[52:55], a[84:87], v[104:107]
  ds_read_b128 a[24:27], v5 offset:6144
  v_mfma_f32_16x16x32_bf16 v[136:139], a[56:59], a[80:83], v[136:139]
  v_mfma_f32_16x16x32_bf16 v[136:139], a[60:63], a[84:87], v[136:139]
  ds_read_b128 a[28:31], v6 offset:6144
  v_mfma_f32_16x16x32_bf16 v[44:47], a[32:35], a[88:91], v[44:47]
  ds_read_b128 a[80:83], v7 offset:512
  v_mfma_f32_16x16x32_bf16 v[44:47], a[36:39], a[92:95], v[44:47]
  ds_read_b128 a[84:87], v7 offset:8704
  v_mfma_f32_16x16x32_bf16 v[76:79], a[40:43], a[88:91], v[76:79]
  v_mfma_f32_16x16x32_bf16 v[76:79], a[44:47], a[92:95], v[76:79]
  v_mfma_f32_16x16x32_bf16 v[108:111], a[48:51], a[88:91], v[108:111]
  v_mfma_f32_16x16x32_bf16 v[108:111], a[52:55], a[92:95], v[108:111]
  v_mfma_f32_16x16x32_bf16 v[140:143], a[56:59], a[88:91], v[140:143]
  s_add_u32 s60, s60, s62
  s_sub_u32 s61, s61, 1
  v_mfma_f32_16x16x32_bf16 v[140:143], a[60:63], a[92:95], v[140:143]
  s_waitcnt lgkmcnt(0)
  s_cbranch_scc0 L_c
  v_mfma_f32_16x16x32_bf16 v[16:19], a[0:3], a[64:67], v[16:19]
  ds_read_b128 a[88:91], v7 offset:768
  v_mfma_f32_16x16x32_bf16 v[16:19], a[4:7], a[68:71], v[16:19]
  ds_read_b128 a[92:95], v7 offset:8960
  v_mfma_f32_16x16x32_bf16 v[48:51], a[8:11], a[64:67], v[48:51]
  v_mfma_f32_16x16x32_bf16 v[48:51], a[12:15], a[68:71], v[48:51]
  v_mfma_f32_16x16x32_bf16 v[80:83], a[16:19], a[64:67], v[80:83]
  v_mfma_f32_16x16x32_bf16 v[80:83], a[20:23], a[68:71], v[80:83]
  v_add_u32 v8, 49152, v144
  v_mfma_f32_16x16x32_bf16 v[112:115], a[24:27], a[64:67], v[112:115]
  v_mfma_f32_16x16x32_bf16 v[112:115], a[28:31], a[68:71], v[112:115]
  v_add_u32 v9, 49152, v145
  v_mfma_f32_16x16x32_bf16 v[20:23], a[0:3], a[72:75], v[20:23]
  ds_read_b128 a[64:67], v7 offset:1024
  v_mfma_f32_16x16x32_bf16 v[20:23], a[4:7], a[76:79], v[20:23]
  ds_read_b128 a[68:71], v7 offset:9216
  v_mfma_f32_16x16x32_bf16 v[52:55], a[8:11], a[72:75], v[52:55]
  v_mfma_f32_16x16x32_bf16 v[52:55], a[12:15], a[76:79], v[52:55]
  v_mfma_f32_16x16x32_bf16 v[84:87], a[16:19], a[72:75], v[84:87]
  v_mfma_f32_16x16x32_bf16 v[84:87], a[20:23], a[76:79], v[84:87]
  v_add_u32 v10, 49152, v146
  v_mfma_f32_16x16x32_bf16 v[116:119], a[24:27], a[72:75], v[116:119]
  v_mfma_f32_16x16x32_bf16 v[116:119], a[28:31], a[76:79], v[116:119]
  v_mfma_f32_16x16x32_bf16 v[24:27], a[0:3], a[80:83], v[24:27]
  v_add_u32 v11, 98304, v144
  v_mfma_f32_16x16x32_bf16 v[24:27], a[4:7], a[84:87], v[24:27]
  ds_read_b128 a[72:75], v7 offset:1280
  ds_read_b128 a[76:79], v7 offset:9472
  v_mfma_f32_16x16x32_bf16 v[56:59], a[8:11], a[80:83], v[56:59]
  v_mfma_f32_16x16x32_bf16 v[56:59], a[12:15], a[84:87], v[56:59]
  v_add_u32 v12, 98304, v145
  v_mfma_f32_16x16x32_bf16 v[88:91], a[16:19], a[80:83], v[88:91]
  v_mfma_f32_16x16x32_bf16 v[88:91], a[20:23], a[84:87], v[88:91]
  v_mfma_f32_16x16x32_bf16 v[120:123], a[24:27], a[80:83], v[120:123]
  v_mfma_f32_16x16x32_bf16 v[120:123], a[28:31], a[84:87], v[120:123]
  s_waitcnt lgkmcnt(0)
  s_nop 0
  v_mfma_f32_16x16x32_bf16 v[28:31], a[0:3], a[88:91], v[28:31]
  v_add_u32 v13, 98304, v146
  v_mfma_f32_16x16x32_bf16 v[28:31], a[4:7], a[92:95], v[28:31]
  ds_read_b128 a[80:83], v7 offset:1536
  ds_read_b128 a[84:87], v7 offset:9728
  v_mfma_f32_16x16x32_bf16 v[60:63], a[8:11], a[88:91], v[60:63]
  v_mfma_f32_16x16x32_bf16 v[60:63], a[12:15], a[92:95], v[60:63]
  v_mfma_f32_16x16x32_bf16 v[92:95], a[16:19], a[88:91], v[92:95]
  v_mfma_f32_16x16x32_bf16 v[92:95], a[20:23], a[92:95], v[92:95]
  v_add_u32_e64 v14, s63, v144
  v_mfma_f32_16x16x32_bf16 v[124:127], a[24:27], a[88:91], v[124:127]
  v_mfma_f32_16x16x32_bf16 v[124:127], a[28:31], a[92:95], v[124:127]
  v_add_u32_e64 v15, s63, v145
  v_mfma_f32_16x16x32_bf16 v[32:35], a[0:3], a[64:67], v[32:35]
  ds_read_b128 a[88:91], v7 offset:1792
  v_mfma_f32_16x16x32_bf16 v[32:35], a[4:7], a[68:71], v[32:35]
  ds_read_b128 a[92:95], v7 offset:9984
  v_mfma_f32_16x16x32_bf16 v[64:67], a[8:11], a[64:67], v[64:67]
  v_mfma_f32_16x16x32_bf16 v[64:67], a[12:15], a[68:71], v[64:67]
  v_mfma_f32_16x16x32_bf16 v[96:99], a[16:19], a[64:67], v[96:99]
  v_mfma_f32_16x16x32_bf16 v[96:99], a[20:23], a[68:71], v[96:99]
  v_mfma_f32_16x16x32_bf16 v[128:131], a[24:27], a[64:67], v[128:131]
  v_mfma_f32_16x16x32_bf16 v[128:131], a[28:31], a[68:71], v[128:131]
  s_waitcnt lgkmcnt(0)
  s_barrier
  v_mfma_f32_16x16x32_bf16 v[36:39], a[0:3], a[72:75], v[36:39]
  v_mfma_f32_16x16x32_bf16 v[36:39], a[4:7], a[76:79], v[36:39]
  v_mfma_f32_16x16x32_bf16 v[68:71], a[8:11], a[72:75], v[68:71]
  v_mfma_f32_16x16x32_bf16 v[68:71], a[12:15], a[76:79], v[68:71]
  v_mfma_f32_16x16x32_bf16 v[100:103], a[16:19], a[72:75], v[100:103]
  v_mfma_f32_16x16x32_bf16 v[100:103], a[20:23], a[76:79], v[100:103]
  v_mfma_f32_16x16x32_bf16 v[132:135], a[24:27], a[72:75], v[132:135]
  v_mfma_f32_16x16x32_bf16 v[132:135], a[28:31], a[76:79], v[132:135]
  v_mfma_f32_16x16x32_bf16 v[40:43], a[0:3], a[80:83], v[40:43]
  ds_read_b128 a[32:35], v10 offset:0
  v_mfma_f32_16x16x32_bf16 v[40:43], a[4:7], a[84:87], v[40:43]
  ds_read_b128 a[36:39], v8 offset:0
  v_mfma_f32_16x16x32_bf16 v[72:75], a[8:11], a[80:83], v[72:75]
  ds_read_b128 a[40:43], v8 offset:2048
  v_mfma_f32_16x16x32_bf16 v[72:75], a[12:15], a[84:87], v[72:75]
  ds_read_b128 a[44:47], v10 offset:256
  v_mfma_f32_16x16x32_bf16 v[104:107], a[16:19], a[80:83], v[104:107]
  ds_read_b128 a[48:51], v10 offset:512
  v_mfma_f32_16x16x32_bf16 v[104:107], a[20:23], a[84:87], v[104:107]
  ds_read_b128 a[52:55], v10 offset:768
  v_mfma_f32_16x16x32_bf16 v[136:139], a[24:27], a[80:83], v[136:139]
  v_mfma_f32_16x16x32_bf16 v[136:139], a[28:31], a[84:87], v[136:139]
  v_mfma_f32_16x16x32_bf16 v[44:47], a[0:3], a[88:91], v[44:47]
  ds_read_b128 a[56:59], v10 offset:8192
  v_mfma_f32_16x16x32_bf16 v[44:47], a[4:7], a[92:95], v[44:47]
  ds_read_b128 a[60:63], v9 offset:0
  v_mfma_f32_16x16x32_bf16 v[76:79], a[8:11], a[88:91], v[76:79]
  ds_read_b128 a[64:67], v9 offset:2048
  v_mfma_f32_16x16x32_bf16 v[76:79], a[12:15], a[92:95], v[76:79]
  ds_read_b128 a[68:71], v10 offset:8448
  v_mfma_f32_16x16x32_bf16 v[108:111], a[16:19], a[88:91], v[108:111]
  ds_read_b128 a[72:75], v10 offset:8704
  v_mfma_f32_16x16x32_bf16 v[108:111], a[20:23], a[92:95], v[108:111]
  ds_read_b128 a[76:79], v10 offset:8960
  v_mfma_f32_16x16x32_bf16 v[140:143], a[24:27], a[88:91], v[140:143]
  v_mfma_f32_16x16x32_bf16 v[140:143], a[28:31], a[92:95], v[140:143]
  s_waitcnt lgkmcnt(4)
  s_nop 0
  v_mfma_f32_16x16x32_bf16 v[16:19], a[36:39], a[32:35], v[16:19]
  s_barrier
  ds_read_b128 a[80:83], v13 offset:0
  ds_read_b128 a[84:87], v11 offset:0
  s_nop 0
  v_mfma_f32_16x16x32_bf16 v[48:51], a[40:43], a[32:35], v[48:51]
  ds_read_b128 a[0:3], v11 offset:2048
  ds_read_b128 a[4:7], v13 offset:256
  v_mfma_f32_16x16x32_bf16 v[20:23], a[36:39], a[44:47], v[20:23]
  ds_read_b128 a[8:11], v13 offset:512
  ds_read_b128 a[12:15], v13 offset:768
  v_mfma_f32_16x16x32_bf16 v[52:55], a[40:43], a[44:47], v[52:55]
  v_mfma_f32_16x16x32_bf16 v[24:27], a[36:39], a[48:51], v[24:27]
  v_mfma_f32_16x16x32_bf16 v[56:59], a[40:43], a[48:51], v[56:59]
  v_mfma_f32_16x16x32_bf16 v[28:31], a[36:39], a[52:55], v[28:31]
  v_mfma_f32_16x16x32_bf16 v[60:63], a[40:43], a[52:55], v[60:63]
  v_mfma_f32_16x16x32_bf16 v[16:19], a[60:63], a[56:59], v[16:19]
  ds_read_b128 a[16:19], v13 offset:8192
  ds_read_b128 a[20:23], v12 offset:0
  s_waitcnt lgkmcnt(2)
  s_nop 0
  v_mfma_f32_16x16x32_bf16 v[48:51], a[64:67], a[56:59], v[48:51]
  ds_read_b128 a[24:27], v12 offset:2048
  ds_read_b128 a[28:31], v13 offset:8448
  v_mfma_f32_16x16x32_bf16 v[20:23], a[60:63], a[68:71], v[20:23]
  ds_read_b128 a[88:91], v13 offset:8704
  ds_read_b128 a[92:95], v13 offset:8960
  v_mfma_f32_16x16x32_bf16 v[52:55], a[64:67], a[68:71], v[52:55]
  v_mfma_f32_16x16x32_bf16 v[24:27], a[60:63], a[72:75], v[24:27]
  v_mfma_f32_16x16x32_bf16 v[56:59], a[64:67], a[72:75], v[56:59]
  v_mfma_f32_16x16x32_bf16 v[28:31], a[60:63], a[76:79], v[28:31]
  v_mfma_f32_16x16x32_bf16 v[60:63], a[64:67], a[76:79], v[60:63]
  v_mfma_f32_16x16x32_bf16 v[16:19], a[84:87], a[80:83], v[16:19]
  s_barrier
  ds_read_b128 a[32:35], v146 offset:0
  ds_read_b128 a[44:47], v14 offset:0
  s_nop 0
  v_mfma_f32_16x16x32_bf16 v[48:51], a[0:3], a[80:83], v[48:51]
  ds_read_b128 a[48:51], v14 offset:2048
  ds_read_b128 a[36:39], v146 offset:256
  v_mfma_f32_16x16x32_bf16 v[20:23], a[84:87], a[4:7], v[20:23]
  ds_read_b128 a[40:43], v146 offset:512
  ds_read_b128 a[52:55], v146 offset:768
  v_mfma_f32_16x16x32_bf16 v[52:55], a[0:3], a[4:7], v[52:55]
  v_mfma_f32_16x16x32_bf16 v[24:27], a[84:87], a[8:11], v[24:27]
  v_mfma_f32_16x16x32_bf16 v[56:59], a[0:3], a[8:11], v[56:59]
  v_mfma_f32_16x16x32_bf16 v[28:31], a[84:87], a[12:15], v[28:31]
  v_mfma_f32_16x16x32_bf16 v[60:63], a[0:3], a[12:15], v[60:63]
  s_waitcnt lgkmcnt(0)
  s_nop 0
  v_mfma_f32_16x16x32_bf16 v[16:19], a[20:23], a[16:19], v[16:19]
  ds_read_b128 a[56:59], v146 offset:8192
  ds_read_b128 a[68:71], v15 offset:0
  v_mfma_f32_16x16x32_bf16 v[48:51], a[24:27], a[16:19], v[48:51]
  ds_read_b128 a[72:75], v15 offset:2048
  ds_read_b128 a[60:63], v146 offset:8448
  v_mfma_f32_16x16x32_bf16 v[20:23], a[20:23], a[28:31], v[20:23]
  ds_read_b128 a[64:67], v146 offset:8704
  ds_read_b128 a[76:79], v146 offset:8960
  v_mfma_f32_16x16x32_bf16 v[52:55], a[24:27], a[28:31], v[52:55]
  v_mfma_f32_16x16x32_bf16 v[24:27], a[20:23], a[88:91], v[24:27]
  v_mfma_f32_16x16x32_bf16 v[56:59], a[24:27], a[88:91], v[56:59]
  v_mfma_f32_16x16x32_bf16 v[28:31], a[20:23], a[92:95], v[28:31]
  v_mfma_f32_16x16x32_bf16 v[60:63], a[24:27], a[92:95], v[60:63]
  v_mfma_f32_16x16x32_bf16 v[16:19], a[44:47], a[32:35], v[16:19]
  ds_read_b128 a[80:83], v10 offset:1024
  ds_read_b128 a[4:7], v8 offset:0
  v_mfma_f32_16x16x32_bf16 v[48:51], a[48:51], a[32:35], v[48:51]
  ds_read_b128 a[8:11], v8 offset:2048
  ds_read_b128 a[84:87], v10 offset:1280
  v_mfma_f32_16x16x32_bf16 v[20:23], a[44:47], a[36:39], v[20:23]
  ds_read_b128 a[0:3], v10 offset:1536
  ds_read_b128 a[12:15], v10 offset:1792
  v_mfma_f32_16x16x32_bf16 v[52:55], a[48:51], a[36:39], v[52:55]
  v_mfma_f32_16x16x32_bf16 v[24:27], a[44:47], a[40:43], v[24:27]
  v_mfma_f32_16x16x32_bf16 v[56:59], a[48:51], a[40:43], v[56:59]
  v_mfma_f32_16x16x32_bf16 v[28:31], a[44:47], a[52:55], v[28:31]
  v_mfma_f32_16x16x32_bf16 v[60:63], a[48:51], a[52:55], v[60:63]
  s_waitcnt lgkmcnt(0)
  s_nop 0
  v_mfma_f32_16x16x32_bf16 v[16:19], a[68:71], a[56:59], v[16:19]
  ds_read_b128 a[16:19], v10 offset:9216
  ds_read_b128 a[28:31], v9 offset:0
  v_mfma_f32_16x16x32_bf16 v[48:51], a[72:75], a[56:59], v[48:51]
  ds_read_b128 a[88:91], v9 offset:2048
  ds_read_b128 a[20:23], v10 offset:9472
  v_mfma_f32_16x16x32_bf16 v[20:23], a[68:71], a[60:63], v[20:23]
  ds_read_b128 a[24:27], v10 offset:9728
  ds_read_b128 a[92:95], v10 offset:9984
  v_mfma_f32_16x16x32_bf16 v[52:55], a[72:75], a[60:63], v[52:55]
  v_mfma_f32_16x16x32_bf16 v[24:27], a[68:71], a[64:67], v[24:27]
  v_mfma_f32_16x16x32_bf16 v[56:59], a[72:75], a[64:67], v[56:59]
  v_mfma_f32_16x16x32_bf16 v[28:31], a[68:71], a[76:79], v[28:31]
  v_mfma_f32_16x16x32_bf16 v[60:63], a[72:75], a[76:79], v[60:63]
  v_mfma_f32_16x16x32_bf16 v[32:35], a[4:7], a[80:83], v[32:35]
  ds_read_b128 a[32:35], v13 offset:1024
  ds_read_b128 a[36:39], v11 offset:0
  v_mfma_f32_16x16x32_bf16 v[64:67], a[8:11], a[80:83], v[64:67]
  ds_read_b128 a[40:43], v11 offset:2048
  ds_read_b128 a[44:47], v13 offset:1280
  v_mfma_f32_16x16x32_bf16 v[36:39], a[4:7], a[84:87], v[36:39]
  v_cvt_pk_bf16_f32 v150, v17, v21
  v_cvt_pk_bf16_f32 v151, v25, v29
  ds_read_b128 a[48:51], v13 offset:1536
  ds_read_b128 a[52:55], v13 offset:1792
  v_mfma_f32_16x16x32_bf16 v[68:71], a[8:11], a[84:87], v[68:71]
  v_cvt_pk_bf16_f32 v148, v16, v20
  v_cvt_pk_bf16_f32 v149, v24, v28
  v_mfma_f32_16x16x32_bf16 v[40:43], a[4:7], a[0:3], v[40:43]
  v_cndmask_b32_dpp v152, v150, v148, vcc quad_perm:[1,0,3,2] row_mask:0xf bank_mask:0xf
  v_cndmask_b32_dpp v153, v151, v149, vcc quad_perm:[1,0,3,2] row_mask:0xf bank_mask:0xf
  v_mfma_f32_16x16x32_bf16 v[72:75], a[8:11], a[0:3], v[72:75]
  s_not_b64 vcc, vcc
  s_nop 0
  v_mfma_f32_16x16x32_bf16 v[44:47], a[4:7], a[12:15], v[44:47]
  v_cndmask_b32_dpp v154, v148, v150, vcc quad_perm:[1,0,3,2] row_mask:0xf bank_mask:0xf
  v_cndmask_b32_dpp v155, v149, v151, vcc quad_perm:[1,0,3,2] row_mask:0xf bank_mask:0xf
  v_mfma_f32_16x16x32_bf16 v[76:79], a[8:11], a[12:15], v[76:79]
  buffer_store_dwordx4 v[152:155], v147, s[32:35], s44 offen offset:0 sc0 sc1
  v_cvt_pk_bf16_f32 v148, v18, v22
  s_waitcnt lgkmcnt(0)
  s_nop 0
  v_mfma_f32_16x16x32_bf16 v[32:35], a[28:31], a[16:19], v[32:35]
  v_cvt_pk_bf16_f32 v149, v26, v30
  v_cvt_pk_bf16_f32 v150, v19, v23
  ds_read_b128 a[56:59], v13 offset:9216
  ds_read_b128 a[60:63], v12 offset:0
  v_mfma_f32_16x16x32_bf16 v[64:67], a[88:91], a[16:19], v[64:67]
  v_cvt_pk_bf16_f32 v151, v27, v31
  ds_read_b128 a[64:67], v12 offset:2048
  ds_read_b128 a[68:71], v13 offset:9472
  v_mfma_f32_16x16x32_bf16 v[36:39], a[28:31], a[20:23], v[36:39]
  v_cndmask_b32_dpp v158, v148, v150, vcc quad_perm:[1,0,3,2] row_mask:0xf bank_mask:0xf
  v_cndmask_b32_dpp v159, v149, v151, vcc quad_perm:[1,0,3,2] row_mask:0xf bank_mask:0xf
  ds_read_b128 a[72:75], v13 offset:9728
  ds_read_b128 a[76:79], v13 offset:9984
  v_mfma_f32_16x16x32_bf16 v[68:71], a[88:91], a[20:23], v[68:71]
  s_not_b64 vcc, vcc
  v_cndmask_b32_dpp v156, v150, v148, vcc quad_perm:[1,0,3,2] row_mask:0xf bank_mask:0xf
  s_nop 0
  v_mfma_f32_16x16x32_bf16 v[40:43], a[28:31], a[24:27], v[40:43]
  v_cndmask_b32_dpp v157, v151, v149, vcc quad_perm:[1,0,3,2] row_mask:0xf bank_mask:0xf
  buffer_store_dwordx4 v[156:159], v147, s[32:35], s46 offen offset:0 sc0 sc1
  v_mfma_f32_16x16x32_bf16 v[72:75], a[88:91], a[24:27], v[72:75]
  v_cvt_pk_bf16_f32 v150, v49, v53
  v_mfma_f32_16x16x32_bf16 v[44:47], a[28:31], a[92:95], v[44:47]
  v_cvt_pk_bf16_f32 v151, v57, v61
  v_cvt_pk_bf16_f32 v148, v48, v52
  v_mfma_f32_16x16x32_bf16 v[76:79], a[88:91], a[92:95], v[76:79]
  v_cvt_pk_bf16_f32 v149, v56, v60
  v_cndmask_b32_dpp v152, v150, v148, vcc quad_perm:[1,0,3,2] row_mask:0xf bank_mask:0xf
  v_mfma_f32_16x16x32_bf16 v[32:35], a[36:39], a[32:35], v[32:35]
  v_cndmask_b32_dpp v153, v151, v149, vcc quad_perm:[1,0,3,2] row_mask:0xf bank_mask:0xf
  s_not_b64 vcc, vcc
  s_barrier
  ds_read_b128 a[80:83], v146 offset:1024
  ds_read_b128 a[84:87], v14 offset:0
  v_mfma_f32_16x16x32_bf16 v[64:67], a[40:43], a[32:35], v[64:67]
  v_cndmask_b32_dpp v154, v148, v150, vcc quad_perm:[1,0,3,2] row_mask:0xf bank_mask:0xf
  ds_read_b128 a[0:3], v14 offset:2048
  ds_read_b128 a[4:7], v146 offset:1280
  v_mfma_f32_16x16x32_bf16 v[36:39], a[36:39], a[44:47], v[36:39]
  v_cndmask_b32_dpp v155, v149, v151, vcc quad_perm:[1,0,3,2] row_mask:0xf bank_mask:0xf
  buffer_store_dwordx4 v[152:155], v147, s[32:35], s48 offen offset:0 sc0 sc1
  ds_read_b128 a[8:11], v146 offset:1536
  ds_read_b128 a[12:15], v146 offset:1792
  v_mfma_f32_16x16x32_bf16 v[68:71], a[40:43], a[44:47], v[68:71]
  v_cvt_pk_bf16_f32 v148, v50, v54
  v_cvt_pk_bf16_f32 v149, v58, v62
  v_mfma_f32_16x16x32_bf16 v[40:43], a[36:39], a[48:51], v[40:43]
  v_cvt_pk_bf16_f32 v150, v51, v55
  v_cvt_pk_bf16_f32 v151, v59, v63
  v_mfma_f32_16x16x32_bf16 v[72:75], a[40:43], a[48:51], v[72:75]
  v_cndmask_b32_dpp v158, v148, v150, vcc quad_perm:[1,0,3,2] row_mask:0xf bank_mask:0xf
  v_mfma_f32_16x16x32_bf16 v[44:47], a[36:39], a[52:55], v[44:47]
  v_cndmask_b32_dpp v159, v149, v151, vcc quad_perm:[1,0,3,2] row_mask:0xf bank_mask:0xf
  s_not_b64 vcc, vcc
  s_nop 0
  v_mfma_f32_16x16x32_bf16 v[76:79], a[40:43], a[52:55], v[76:79]
  v_cndmask_b32_dpp v156, v150, v148, vcc quad_perm:[1,0,3,2] row_mask:0xf bank_mask:0xf
  v_cndmask_b32_dpp v157, v151, v149, vcc quad_perm:[1,0,3,2] row_mask:0xf bank_mask:0xf
  s_waitcnt lgkmcnt(0)
  s_nop 0
  v_mfma_f32_16x16x32_bf16 v[32:35], a[60:63], a[56:59], v[32:35]
  buffer_store_dwordx4 v[156:159], v147, s[32:35], s50 offen offset:0 sc0 sc1
  ds_read_b128 a[16:19], v146 offset:9216
  ds_read_b128 a[20:23], v15 offset:0
  v_mfma_f32_16x16x32_bf16 v[64:67], a[64:67], a[56:59], v[64:67]
  ds_read_b128 a[24:27], v15 offset:2048
  ds_read_b128 a[28:31], v146 offset:9472
  v_mfma_f32_16x16x32_bf16 v[36:39], a[60:63], a[68:71], v[36:39]
  ds_read_b128 a[88:91], v146 offset:9728
  ds_read_b128 a[92:95], v146 offset:9984
  v_mfma_f32_16x16x32_bf16 v[68:71], a[64:67], a[68:71], v[68:71]
  v_mfma_f32_16x16x32_bf16 v[40:43], a[60:63], a[72:75], v[40:43]
  v_mfma_f32_16x16x32_bf16 v[72:75], a[64:67], a[72:75], v[72:75]
  v_mfma_f32_16x16x32_bf16 v[44:47], a[60:63], a[76:79], v[44:47]
  v_mfma_f32_16x16x32_bf16 v[76:79], a[64:67], a[76:79], v[76:79]
  v_mfma_f32_16x16x32_bf16 v[32:35], a[84:87], a[80:83], v[32:35]
  ds_read_b128 a[32:35], v10 offset:0
  ds_read_b128 a[44:47], v8 offset:4096
  v_mfma_f32_16x16x32_bf16 v[64:67], a[0:3], a[80:83], v[64:67]
  ds_read_b128 a[48:51], v8 offset:6144
  ds_read_b128 a[36:39], v10 offset:256
  v_mfma_f32_16x16x32_bf16 v[36:39], a[84:87], a[4:7], v[36:39]
  ds_read_b128 a[40:43], v10 offset:512
  ds_read_b128 a[52:55], v10 offset:768
  v_mfma_f32_16x16x32_bf16 v[68:71], a[0:3], a[4:7], v[68:71]
  v_mfma_f32_16x16x32_bf16 v[40:43], a[84:87], a[8:11], v[40:43]
  v_mfma_f32_16x16x32_bf16 v[72:75], a[0:3], a[8:11], v[72:75]
  v_mfma_f32_16x16x32_bf16 v[44:47], a[84:87], a[12:15], v[44:47]
  v_mfma_f32_16x16x32_bf16 v[76:79], a[0:3], a[12:15], v[76:79]
  s_waitcnt lgkmcnt(0)
  s_nop 0
  v_mfma_f32_16x16x32_bf16 v[32:35], a[20:23], a[16:19], v[32:35]
  ds_read_b128 a[56:59], v10 offset:8192
  ds_read_b128 a[68:71], v9 offset:4096
  v_mfma_f32_16x16x32_bf16 v[64:67], a[24:27], a[16:19], v[64:67]
  ds_read_b128 a[72:75], v9 offset:6144
  ds_read_b128 a[60:63], v10 offset:8448
  v_mfma_f32_16x16x32_bf16 v[36:39], a[20:23], a[28:31], v[36:39]
  ds_read_b128 a[64:67], v10 offset:8704
  ds_read_b128 a[76:79], v10 offset:8960
  v_mfma_f32_16x16x32_bf16 v[68:71], a[24:27], a[28:31], v[68:71]
  v_mfma_f32_16x16x32_bf16 v[40:43], a[20:23], a[88:91], v[40:43]
  v_mfma_f32_16x16x32_bf16 v[72:75], a[24:27], a[88:91], v[72:75]
  v_mfma_f32_16x16x32_bf16 v[44:47], a[20:23], a[92:95], v[44:47]
  v_mfma_f32_16x16x32_bf16 v[76:79], a[24:27], a[92:95], v[76:79]
  v_mfma_f32_16x16x32_bf16 v[80:83], a[44:47], a[32:35], v[80:83]
  ds_read_b128 a[80:83], v13 offset:0
  ds_read_b128 a[4:7], v11 offset:4096
  v_mfma_f32_16x16x32_bf16 v[112:115], a[48:51], a[32:35], v[112:115]
  ds_read_b128 a[8:11], v11 offset:6144
  ds_read_b128 a[84:87], v13 offset:256
  v_mfma_f32_16x16x32_bf16 v[84:87], a[44:47], a[36:39], v[84:87]
  v_cvt_pk_bf16_f32 v150, v33, v37
  v_cvt_pk_bf16_f32 v151, v41, v45
  ds_read_b128 a[0:3], v13 offset:512
  ds_read_b128 a[12:15], v13 offset:768
  v_mfma_f32_16x16x32_bf16 v[116:119], a[48:51], a[36:39], v[116:119]
  v_cvt_pk_bf16_f32 v148, v32, v36
  v_cvt_pk_bf16_f32 v149, v40, v44
  v_mfma_f32_16x16x32_bf16 v[88:91], a[44:47], a[40:43], v[88:91]
  v_cndmask_b32_dpp v152, v150, v148, vcc quad_perm:[1,0,3,2] row_mask:0xf bank_mask:0xf
  v_cndmask_b32_dpp v153, v151, v149, vcc quad_perm:[1,0,3,2] row_mask:0xf bank_mask:0xf
  v_mfma_f32_16x16x32_bf16 v[120:123], a[48:51], a[40:43], v[120:123]
  s_not_b64 vcc, vcc
  s_nop 0
  v_mfma_f32_16x16x32_bf16 v[92:95], a[44:47], a[52:55], v[92:95]
  v_cndmask_b32_dpp v154, v148, v150, vcc quad_perm:[1,0,3,2] row_mask:0xf bank_mask:0xf
  v_cndmask_b32_dpp v155, v149, v151, vcc quad_perm:[1,0,3,2] row_mask:0xf bank_mask:0xf
  v_mfma_f32_16x16x32_bf16 v[124:127], a[48:51], a[52:55], v[124:127]
  buffer_store_dwordx4 v[152:155], v147, s[32:35], s44 offen offset:128 sc0 sc1
  v_cvt_pk_bf16_f32 v148, v34, v38
  s_waitcnt lgkmcnt(0)
  s_nop 0
  v_mfma_f32_16x16x32_bf16 v[80:83], a[68:71], a[56:59], v[80:83]
  v_cvt_pk_bf16_f32 v149, v42, v46
  v_cvt_pk_bf16_f32 v150, v35, v39
  ds_read_b128 a[16:19], v13 offset:8192
  ds_read_b128 a[28:31], v12 offset:4096
  v_mfma_f32_16x16x32_bf16 v[112:115], a[72:75], a[56:59], v[112:115]
  v_cvt_pk_bf16_f32 v151, v43, v47
  ds_read_b128 a[88:91], v12 offset:6144
  ds_read_b128 a[20:23], v13 offset:8448
  v_mfma_f32_16x16x32_bf16 v[84:87], a[68:71], a[60:63], v[84:87]
  v_cndmask_b32_dpp v158, v148, v150, vcc quad_perm:[1,0,3,2] row_mask:0xf bank_mask:0xf
  v_cndmask_b32_dpp v159, v149, v151, vcc quad_perm:[1,0,3,2] row_mask:0xf bank_mask:0xf
  ds_read_b128 a[24:27], v13 offset:8704
  ds_read_b128 a[92:95], v13 offset:8960
  v_mfma_f32_16x16x32_bf16 v[116:119], a[72:75], a[60:63], v[116:119]
  s_not_b64 vcc, vcc
  v_cndmask_b32_dpp v156, v150, v148, vcc quad_perm:[1,0,3,2] row_mask:0xf bank_mask:0xf
  s_nop 0
  v_mfma_f32_16x16x32_bf16 v[88:91], a[68:71], a[64:67], v[88:91]
  v_cndmask_b32_dpp v157, v151, v149, vcc quad_perm:[1,0,3,2] row_mask:0xf bank_mask:0xf
  buffer_store_dwordx4 v[156:159], v147, s[32:35], s46 offen offset:128 sc0 sc1
  v_mfma_f32_16x16x32_bf16 v[120:123], a[72:75], a[64:67], v[120:123]
  v_cvt_pk_bf16_f32 v150, v65, v69
  v_mfma_f32_16x16x32_bf16 v[92:95], a[68:71], a[76:79], v[92:95]
  v_cvt_pk_bf16_f32 v151, v73, v77
  v_cvt_pk_bf16_f32 v148, v64, v68
  v_mfma_f32_16x16x32_bf16 v[124:127], a[72:75], a[76:79], v[124:127]
  v_cvt_pk_bf16_f32 v149, v72, v76
  v_cndmask_b32_dpp v152, v150, v148, vcc quad_perm:[1,0,3,2] row_mask:0xf bank_mask:0xf
  v_mfma_f32_16x16x32_bf16 v[80:83], a[4:7], a[80:83], v[80:83]
  v_cndmask_b32_dpp v153, v151, v149, vcc quad_perm:[1,0,3,2] row_mask:0xf bank_mask:0xf
  s_not_b64 vcc, vcc
  ds_read_b128 a[32:35], v146 offset:0
  ds_read_b128 a[36:39], v144 offset:4096
  s_nop 0
  v_mfma_f32_16x16x32_bf16 v[112:115], a[8:11], a[80:83], v[112:115]
  v_cndmask_b32_dpp v154, v148, v150, vcc quad_perm:[1,0,3,2] row_mask:0xf bank_mask:0xf
  ds_read_b128 a[40:43], v144 offset:6144
  ds_read_b128 a[44:47], v146 offset:256
  v_mfma_f32_16x16x32_bf16 v[84:87], a[4:7], a[84:87], v[84:87]
  v_cndmask_b32_dpp v155, v149, v151, vcc quad_perm:[1,0,3,2] row_mask:0xf bank_mask:0xf
  buffer_store_dwordx4 v[152:155], v147, s[32:35], s48 offen offset:128 sc0 sc1
  ds_read_b128 a[48:51], v146 offset:512
  ds_read_b128 a[52:55], v146 offset:768
  v_mfma_f32_16x16x32_bf16 v[116:119], a[8:11], a[84:87], v[116:119]
  v_cvt_pk_bf16_f32 v148, v66, v70
  v_cvt_pk_bf16_f32 v149, v74, v78
  v_mfma_f32_16x16x32_bf16 v[88:91], a[4:7], a[0:3], v[88:91]
  v_cvt_pk_bf16_f32 v150, v67, v71
  v_cvt_pk_bf16_f32 v151, v75, v79
  v_mfma_f32_16x16x32_bf16 v[120:123], a[8:11], a[0:3], v[120:123]
  v_cndmask_b32_dpp v158, v148, v150, vcc quad_perm:[1,0,3,2] row_mask:0xf bank_mask:0xf
  v_mfma_f32_16x16x32_bf16 v[92:95], a[4:7], a[12:15], v[92:95]
  v_cndmask_b32_dpp v159, v149, v151, vcc quad_perm:[1,0,3,2] row_mask:0xf bank_mask:0xf
  s_not_b64 vcc, vcc
  s_nop 0
  v_mfma_f32_16x16x32_bf16 v[124:127], a[8:11], a[12:15], v[124:127]
  v_cndmask_b32_dpp v156, v150, v148, vcc quad_perm:[1,0,3,2] row_mask:0xf bank_mask:0xf
  v_cndmask_b32_dpp v157, v151, v149, vcc quad_perm:[1,0,3,2] row_mask:0xf bank_mask:0xf
  s_waitcnt lgkmcnt(0)
  s_nop 0
  v_mfma_f32_16x16x32_bf16 v[80:83], a[28:31], a[16:19], v[80:83]
  buffer_store_dwordx4 v[156:159], v147, s[32:35], s50 offen offset:128 sc0 sc1
  ds_read_b128 a[56:59], v146 offset:8192
  ds_read_b128 a[60:63], v145 offset:4096
  v_mfma_f32_16x16x32_bf16 v[112:115], a[88:91], a[16:19], v[112:115]
  ds_read_b128 a[64:67], v145 offset:6144
  ds_read_b128 a[68:71], v146 offset:8448
  v_mfma_f32_16x16x32_bf16 v[84:87], a[28:31], a[20:23], v[84:87]
  ds_read_b128 a[72:75], v146 offset:8704
  ds_read_b128 a[76:79], v146 offset:8960
  v_mfma_f32_16x16x32_bf16 v[116:119], a[88:91], a[20:23], v[116:119]
  v_mfma_f32_16x16x32_bf16 v[88:91], a[28:31], a[24:27], v[88:91]
  v_mfma_f32_16x16x32_bf16 v[120:123], a[88:91], a[24:27], v[120:123]
  v_mfma_f32_16x16x32_bf16 v[92:95], a[28:31], a[92:95], v[92:95]
  v_mfma_f32_16x16x32_bf16 v[124:127], a[88:91], a[92:95], v[124:127]
  v_mfma_f32_16x16x32_bf16 v[80:83], a[36:39], a[32:35], v[80:83]
  ds_read_b128 a[80:83], v10 offset:1024
  ds_read_b128 a[84:87], v8 offset:4096
  v_mfma_f32_16x16x32_bf16 v[112:115], a[40:43], a[32:35], v[112:115]
  ds_read_b128 a[0:3], v8 offset:6144
  ds_read_b128 a[4:7], v10 offset:1280
  v_mfma_f32_16x16x32_bf16 v[84:87], a[36:39], a[44:47], v[84:87]
  ds_read_b128 a[8:11], v10 offset:1536
  ds_read_b128 a[12:15], v10 offset:1792
  v_mfma_f32_16x16x32_bf16 v[116:119], a[40:43], a[44:47], v[116:119]
  v_mfma_f32_16x16x32_bf16 v[88:91], a[36:39], a[48:51], v[88:91]
  v_mfma_f32_16x16x32_bf16 v[120:123], a[40:43], a[48:51], v[120:123]
  v_mfma_f32_16x16x32_bf16 v[92:95], a[36:39], a[52:55], v[92:95]
  v_mfma_f32_16x16x32_bf16 v[124:127], a[40:43], a[52:55], v[124:127]
  s_waitcnt lgkmcnt(0)
  s_nop 0
  v_mfma_f32_16x16x32_bf16 v[80:83], a[60:63], a[56:59], v[80:83]
  ds_read_b128 a[16:19], v10 offset:9216
  ds_read_b128 a[20:23], v9 offset:4096
  v_mfma_f32_16x16x32_bf16 v[112:115], a[64:67], a[56:59], v[112:115]
  ds_read_b128 a[24:27], v9 offset:6144
  ds_read_b128 a[28:31], v10 offset:9472
  v_mfma_f32_16x16x32_bf16 v[84:87], a[60:63], a[68:71], v[84:87]
  ds_read_b128 a[88:91], v10 offset:9728
  ds_read_b128 a[92:95], v10 offset:9984
  v_mfma_f32_16x16x32_bf16 v[116:119], a[64:67], a[68:71], v[116:119]
  v_mfma_f32_16x16x32_bf16 v[88:91], a[60:63], a[72:75], v[88:91]
  v_mfma_f32_16x16x32_bf16 v[120:123], a[64:67], a[72:75], v[120:123]
  v_mfma_f32_16x16x32_bf16 v[92:95], a[60:63], a[76:79], v[92:95]
  v_mfma_f32_16x16x32_bf16 v[124:127], a[64:67], a[76:79], v[124:127]
  v_mfma_f32_16x16x32_bf16 v[96:99], a[84:87], a[80:83], v[96:99]
  ds_read_b128 a[32:35], v13 offset:1024
  ds_read_b128 a[44:47], v11 offset:4096
  v_mfma_f32_16x16x32_bf16 v[128:131], a[0:3], a[80:83], v[128:131]
  ds_read_b128 a[48:51], v11 offset:6144
  ds_read_b128 a[36:39], v13 offset:1280
  v_mfma_f32_16x16x32_bf16 v[100:103], a[84:87], a[4:7], v[100:103]
  v_cvt_pk_bf16_f32 v150, v81, v85
  v_cvt_pk_bf16_f32 v151, v89, v93
  ds_read_b128 a[40:43], v13 offset:1536
  ds_read_b128 a[52:55], v13 offset:1792
  v_mfma_f32_16x16x32_bf16 v[132:135], a[0:3], a[4:7], v[132:135]
  v_cvt_pk_bf16_f32 v148, v80, v84
  v_cvt_pk_bf16_f32 v149, v88, v92
  v_mfma_f32_16x16x32_bf16 v[104:107], a[84:87], a[8:11], v[104:107]
  v_cndmask_b32_dpp v152, v150, v148, vcc quad_perm:[1,0,3,2] row_mask:0xf bank_mask:0xf
  v_cndmask_b32_dpp v153, v151, v149, vcc quad_perm:[1,0,3,2] row_mask:0xf bank_mask:0xf
  v_mfma_f32_16x16x32_bf16 v[136:139], a[0:3], a[8:11], v[136:139]
  s_not_b64 vcc, vcc
  s_nop 0
  v_mfma_f32_16x16x32_bf16 v[108:111], a[84:87], a[12:15], v[108:111]
  v_cndmask_b32_dpp v154, v148, v150, vcc quad_perm:[1,0,3,2] row_mask:0xf bank_mask:0xf
  v_cndmask_b32_dpp v155, v149, v151, vcc quad_perm:[1,0,3,2] row_mask:0xf bank_mask:0xf
  v_mfma_f32_16x16x32_bf16 v[140:143], a[0:3], a[12:15], v[140:143]
  buffer_store_dwordx4 v[152:155], v147, s[32:35], s52 offen offset:0 sc0 sc1
  v_cvt_pk_bf16_f32 v148, v82, v86
  s_waitcnt lgkmcnt(0)
  s_nop 0
  v_mfma_f32_16x16x32_bf16 v[96:99], a[20:23], a[16:19], v[96:99]
  v_cvt_pk_bf16_f32 v149, v90, v94
  v_cvt_pk_bf16_f32 v150, v83, v87
  ds_read_b128 a[56:59], v13 offset:9216
  ds_read_b128 a[68:71], v12 offset:4096
  v_mfma_f32_16x16x32_bf16 v[128:131], a[24:27], a[16:19], v[128:131]
  v_cvt_pk_bf16_f32 v151, v91, v95
  ds_read_b128 a[72:75], v12 offset:6144
  ds_read_b128 a[60:63], v13 offset:9472
  v_mfma_f32_16x16x32_bf16 v[100:103], a[20:23], a[28:31], v[100:103]
  v_cndmask_b32_dpp v158, v148, v150, vcc quad_perm:[1,0,3,2] row_mask:0xf bank_mask:0xf
  v_cndmask_b32_dpp v159, v149, v151, vcc quad_perm:[1,0,3,2] row_mask:0xf bank_mask:0xf
  ds_read_b128 a[64:67], v13 offset:9728
  ds_read_b128 a[76:79], v13 offset:9984
  v_mfma_f32_16x16x32_bf16 v[132:135], a[24:27], a[28:31], v[132:135]
  s_not_b64 vcc, vcc
  v_cndmask_b32_dpp v156, v150, v148, vcc quad_perm:[1,0,3,2] row_mask:0xf bank_mask:0xf
  s_nop 0
  v_mfma_f32_16x16x32_bf16 v[104:107], a[20:23], a[88:91], v[104:107]
  v_cndmask_b32_dpp v157, v151, v149, vcc quad_perm:[1,0,3,2] row_mask:0xf bank_mask:0xf
  buffer_store_dwordx4 v[156:159], v147, s[32:35], s54 offen offset:0 sc0 sc1
  v_mfma_f32_16x16x32_bf16 v[136:139], a[24:27], a[88:91], v[136:139]
  v_cvt_pk_bf16_f32 v150, v113, v117
  v_mfma_f32_16x16x32_bf16 v[108:111], a[20:23], a[92:95], v[108:111]
  v_cvt_pk_bf16_f32 v151, v121, v125
  v_cvt_pk_bf16_f32 v148, v112, v116
  v_mfma_f32_16x16x32_bf16 v[140:143], a[24:27], a[92:95], v[140:143]
  v_cvt_pk_bf16_f32 v149, v120, v124
  v_cndmask_b32_dpp v152, v150, v148, vcc quad_perm:[1,0,3,2] row_mask:0xf bank_mask:0xf
  v_mfma_f32_16x16x32_bf16 v[96:99], a[44:47], a[32:35], v[96:99]
  v_cndmask_b32_dpp v153, v151, v149, vcc quad_perm:[1,0,3,2] row_mask:0xf bank_mask:0xf
  s_not_b64 vcc, vcc
  ds_read_b128 a[80:83], v146 offset:1024
  ds_read_b128 a[4:7], v144 offset:4096
  s_nop 0
  v_mfma_f32_16x16x32_bf16 v[128:131], a[48:51], a[32:35], v[128:131]
  v_cndmask_b32_dpp v154, v148, v150, vcc quad_perm:[1,0,3,2] row_mask:0xf bank_mask:0xf
  ds_read_b128 a[8:11], v144 offset:6144
  ds_read_b128 a[84:87], v146 offset:1280
  v_mfma_f32_16x16x32_bf16 v[100:103], a[44:47], a[36:39], v[100:103]
  v_cndmask_b32_dpp v155, v149, v151, vcc quad_perm:[1,0,3,2] row_mask:0xf bank_mask:0xf
  buffer_store_dwordx4 v[152:155], v147, s[32:35], s56 offen offset:0 sc0 sc1
  ds_read_b128 a[0:3], v146 offset:1536
  ds_read_b128 a[12:15], v146 offset:1792
  v_mfma_f32_16x16x32_bf16 v[132:135], a[48:51], a[36:39], v[132:135]
  v_cvt_pk_bf16_f32 v148, v114, v118
  v_cvt_pk_bf16_f32 v149, v122, v126
  v_mfma_f32_16x16x32_bf16 v[104:107], a[44:47], a[40:43], v[104:107]
  v_cvt_pk_bf16_f32 v150, v115, v119
  v_cvt_pk_bf16_f32 v151, v123, v127
  v_mfma_f32_16x16x32_bf16 v[136:139], a[48:51], a[40:43], v[136:139]
  v_cndmask_b32_dpp v158, v148, v150, vcc quad_perm:[1,0,3,2] row_mask:0xf bank_mask:0xf
  v_mfma_f32_16x16x32_bf16 v[108:111], a[44:47], a[52:55], v[108:111]
  v_cndmask_b32_dpp v159, v149, v151, vcc quad_perm:[1,0,3,2] row_mask:0xf bank_mask:0xf
  s_not_b64 vcc, vcc
  s_nop 0
  v_mfma_f32_16x16x32_bf16 v[140:143], a[48:51], a[52:55], v[140:143]
  v_cndmask_b32_dpp v156, v150, v148, vcc quad_perm:[1,0,3,2] row_mask:0xf bank_mask:0xf
  v_cndmask_b32_dpp v157, v151, v149, vcc quad_perm:[1,0,3,2] row_mask:0xf bank_mask:0xf
  s_waitcnt lgkmcnt(0)
  s_nop 0
  v_mfma_f32_16x16x32_bf16 v[96:99], a[68:71], a[56:59], v[96:99]
  buffer_store_dwordx4 v[156:159], v147, s[32:35], s58 offen offset:0 sc0 sc1
  ds_read_b128 a[16:19], v146 offset:9216
  ds_read_b128 a[28:31], v145 offset:4096
  v_mfma_f32_16x16x32_bf16 v[128:131], a[72:75], a[56:59], v[128:131]
  ds_read_b128 a[88:91], v146 offset:9472
  ds_read_b128 a[20:23], v145 offset:6144
  v_mfma_f32_16x16x32_bf16 v[100:103], a[68:71], a[60:63], v[100:103]
  ds_read_b128 a[24:27], v146 offset:9728
  ds_read_b128 a[92:95], v146 offset:9984
  v_mfma_f32_16x16x32_bf16 v[132:135], a[72:75], a[60:63], v[132:135]
  v_mfma_f32_16x16x32_bf16 v[104:107], a[68:71], a[64:67], v[104:107]
  v_mfma_f32_16x16x32_bf16 v[136:139], a[72:75], a[64:67], v[136:139]
  v_mfma_f32_16x16x32_bf16 v[108:111], a[68:71], a[76:79], v[108:111]
  v_mfma_f32_16x16x32_bf16 v[140:143], a[72:75], a[76:79], v[140:143]
  v_mfma_f32_16x16x32_bf16 v[96:99], a[4:7], a[80:83], v[96:99]
  v_mfma_f32_16x16x32_bf16 v[128:131], a[8:11], a[80:83], v[128:131]
  v_mfma_f32_16x16x32_bf16 v[100:103], a[4:7], a[84:87], v[100:103]
  v_mfma_f32_16x16x32_bf16 v[132:135], a[8:11], a[84:87], v[132:135]
  v_mfma_f32_16x16x32_bf16 v[104:107], a[4:7], a[0:3], v[104:107]
  v_mfma_f32_16x16x32_bf16 v[136:139], a[8:11], a[0:3], v[136:139]
  v_mfma_f32_16x16x32_bf16 v[108:111], a[4:7], a[12:15], v[108:111]
  v_mfma_f32_16x16x32_bf16 v[140:143], a[8:11], a[12:15], v[140:143]
  s_waitcnt lgkmcnt(0)
  s_nop 0
  v_mfma_f32_16x16x32_bf16 v[96:99], a[28:31], a[16:19], v[96:99]
  v_mfma_f32_16x16x32_bf16 v[100:103], a[28:31], a[88:91], v[100:103]
  v_mfma_f32_16x16x32_bf16 v[104:107], a[28:31], a[24:27], v[104:107]
  v_mfma_f32_16x16x32_bf16 v[108:111], a[28:31], a[92:95], v[108:111]
  v_mfma_f32_16x16x32_bf16 v[128:131], a[20:23], a[16:19], v[128:131]
  v_mfma_f32_16x16x32_bf16 v[132:135], a[20:23], a[88:91], v[132:135]
  v_mfma_f32_16x16x32_bf16 v[136:139], a[20:23], a[24:27], v[136:139]
  v_mfma_f32_16x16x32_bf16 v[140:143], a[20:23], a[92:95], v[140:143]
  s_nop 7
L_fin:
  v_cvt_pk_bf16_f32 v150, v97, v101
  v_cvt_pk_bf16_f32 v151, v105, v109
  v_cvt_pk_bf16_f32 v148, v96, v100
  v_cvt_pk_bf16_f32 v149, v104, v108
  v_cndmask_b32_dpp v152, v150, v148, vcc quad_perm:[1,0,3,2] row_mask:0xf bank_mask:0xf
  v_cndmask_b32_dpp v153, v151, v149, vcc quad_perm:[1,0,3,2] row_mask:0xf bank_mask:0xf
  s_not_b64 vcc, vcc
  v_cndmask_b32_dpp v154, v148, v150, vcc quad_perm:[1,0,3,2] row_mask:0xf bank_mask:0xf
  v_cndmask_b32_dpp v155, v149, v151, vcc quad_perm:[1,0,3,2] row_mask:0xf bank_mask:0xf
  buffer_store_dwordx4 v[152:155], v147, s[32:35], s52 offen offset:128 sc0 sc1
  v_cvt_pk_bf16_f32 v148, v98, v102
  v_cvt_pk_bf16_f32 v149, v106, v110
  v_cvt_pk_bf16_f32 v150, v99, v103
  v_cvt_pk_bf16_f32 v151, v107, v111
  v_cndmask_b32_dpp v158, v148, v150, vcc quad_perm:[1,0,3,2] row_mask:0xf bank_mask:0xf
  v_cndmask_b32_dpp v159, v149, v151, vcc quad_perm:[1,0,3,2] row_mask:0xf bank_mask:0xf
  s_not_b64 vcc, vcc
  v_cndmask_b32_dpp v156, v150, v148, vcc quad_perm:[1,0,3,2] row_mask:0xf bank_mask:0xf
  v_cndmask_b32_dpp v157, v151, v149, vcc quad_perm:[1,0,3,2] row_mask:0xf bank_mask:0xf
  buffer_store_dwordx4 v[156:159], v147, s[32:35], s54 offen offset:128 sc0 sc1
  v_cvt_pk_bf16_f32 v150, v129, v133
  v_cvt_pk_bf16_f32 v151, v137, v141
  v_cvt_pk_bf16_f32 v148, v128, v132
  v_cvt_pk_bf16_f32 v149, v136, v140
  v_cndmask_b32_dpp v152, v150, v148, vcc quad_perm:[1,0,3,2] row_mask:0xf bank_mask:0xf
  v_cndmask_b32_dpp v153, v151, v149, vcc quad_perm:[1,0,3,2] row_mask:0xf bank_mask:0xf
  s_not_b64 vcc, vcc
  v_cndmask_b32_dpp v154, v148, v150, vcc quad_perm:[1,0,3,2] row_mask:0xf bank_mask:0xf
  v_cndmask_b32_dpp v155, v149, v151, vcc quad_perm:[1,0,3,2] row_mask:0xf bank_mask:0xf
  buffer_store_dwordx4 v[152:155], v147, s[32:35], s56 offen offset:128 sc0 sc1
  v_cvt_pk_bf16_f32 v148, v130, v134
  v_cvt_pk_bf16_f32 v149, v138, v142
  v_cvt_pk_bf16_f32 v150, v131, v135
  v_cvt_pk_bf16_f32 v151, v139, v143
  v_cndmask_b32_dpp v158, v148, v150, vcc quad_perm:[1,0,3,2] row_mask:0xf bank_mask:0xf
  v_cndmask_b32_dpp v159, v149, v151, vcc quad_perm:[1,0,3,2] row_mask:0xf bank_mask:0xf
  s_not_b64 vcc, vcc
  v_cndmask_b32_dpp v156, v150, v148, vcc quad_perm:[1,0,3,2] row_mask:0xf bank_mask:0xf
  v_cndmask_b32_dpp v157, v151, v149, vcc quad_perm:[1,0,3,2] row_mask:0xf bank_mask:0xf
  buffer_store_dwordx4 v[156:159], v147, s[32:35], s58 offen offset:128 sc0 sc1
  s_endpgm
L_loader:
  s_add_u32 s58, s40, 2
  s_lshl_b32 s58, s58, 7
  s_load_dword s68, s[12:13], s58 offset:0
  s_load_dword s69, s[12:13], s58 offset:64
  s_load_dword s70, s[12:13], s58 offset:2048
  s_load_dword s71, s[12:13], s58 offset:2112
  s_load_dword s72, s[12:13], s58 offset:4096
  s_load_dword s73, s[12:13], s58 offset:4160
  s_waitcnt vmcnt(0)
  s_mov_b64 exec, 1
  buffer_store_dwordx2 v[10:11], v14, s[28:31], 0 offen sc1
  s_mov_b64 exec, -1
  s_barrier
  s_add_u32 s43, s40, 0
  s_lshl_b32 s43, s43, 9
  s_load_dwordx4 s[64:67], s[4:5], s43 glc
  s_add_u32 s41, s40, 0
  s_lshl_b32 s41, s41, 7
  s_add_u32 m0, s60, 49152
  s_nop 0
  buffer_load_dwordx4 v16, s[16:19], s41 offen offset:0  lds
  buffer_load_dwordx4 v17, s[16:19], s41 offen offset:1024  lds
  buffer_load_dwordx4 v18, s[16:19], s41 offen offset:2048  lds
  buffer_load_dwordx4 v19, s[16:19], s41 offen offset:3072  lds
  s_add_u32 m0, s60, 53248
  s_add_u32 s41, s41, 65536
  buffer_load_dwordx4 v16, s[16:19], s41 offen offset:0  lds
  buffer_load_dwordx4 v17, s[16:19], s41 offen offset:1024  lds
  buffer_load_dwordx4 v18, s[16:19], s41 offen offset:2048  lds
  buffer_load_dwordx4 v19, s[16:19], s41 offen offset:3072  lds
  s_mov_b32 s63, 0
L_sp1:
  s_waitcnt lgkmcnt(0)
  s_xor_b64 s[10:11], s[64:65], s[8:9]
  s_xor_b64 s[14:15], s[66:67], s[8:9]
  s_or_b64 s[10:11], s[10:11], s[14:15]
  s_cbranch_scc0 L_ok1
  s_load_dwordx4 s[64:67], s[4:5], s43 glc
  s_add_u32 s63, s63, 1
  s_cmp_lt_u32 s63, 20000
  s_cbranch_scc1 L_sp1
  s_waitcnt lgkmcnt(0)
L_ok1:
  s_add_u32 s43, s40, 1
  s_lshl_b32 s43, s43, 9
  s_load_dwordx4 s[64:67], s[4:5], s43 glc
  s_add_u32 m0, s61, 49152
  s_add_u32 s62, s40, 0
  s_lshl_b32 s62, s62, 14
  buffer_load_dwordx4 v20, s[28:31], s62 offen offset:0 sc1 lds
  buffer_load_dwordx4 v20, s[28:31], s62 offen offset:1024 sc1 lds
  buffer_load_dwordx4 v20, s[28:31], s62 offen offset:2048 sc1 lds
  buffer_load_dwordx4 v20, s[28:31], s62 offen offset:3072 sc1 lds
  s_add_u32 s41, s40, 1
  s_lshl_b32 s41, s41, 7
  s_add_u32 m0, s60, 98304
  s_nop 0
  buffer_load_dwordx4 v16, s[16:19], s41 offen offset:0  lds
  buffer_load_dwordx4 v17, s[16:19], s41 offen offset:1024  lds
  buffer_load_dwordx4 v18, s[16:19], s41 offen offset:2048  lds
  buffer_load_dwordx4 v19, s[16:19], s41 offen offset:3072  lds
  s_add_u32 m0, s60, 102400
  s_add_u32 s41, s41, 65536
  buffer_load_dwordx4 v16, s[16:19], s41 offen offset:0  lds
  buffer_load_dwordx4 v17, s[16:19], s41 offen offset:1024  lds
  buffer_load_dwordx4 v18, s[16:19], s41 offen offset:2048  lds
  buffer_load_dwordx4 v19, s[16:19], s41 offen offset:3072  lds
  s_mov_b32 s63, 0
L_sp2:
  s_waitcnt lgkmcnt(0)
  s_xor_b64 s[10:11], s[64:65], s[8:9]
  s_xor_b64 s[14:15], s[66:67], s[8:9]
  s_or_b64 s[10:11], s[10:11], s[14:15]
  s_cbranch_scc0 L_ok2
  s_load_dwordx4 s[64:67], s[4:5], s43 glc
  s_add_u32 s63, s63, 1
  s_cmp_lt_u32 s63, 20000
  s_cbranch_scc1 L_sp2
  s_waitcnt lgkmcnt(0)
L_ok2:
  s_add_u32 s43, s40, 2
  s_lshl_b32 s43, s43, 9
  s_load_dwordx4 s[64:67], s[4:5], s43 glc
  s_add_u32 m0, s61, 98304
  s_add_u32 s62, s40, 1
  s_lshl_b32 s62, s62, 14
  buffer_load_dwordx4 v20, s[28:31], s62 offen offset:0 sc1 lds
  buffer_load_dwordx4 v20, s[28:31], s62 offen offset:1024 sc1 lds
  buffer_load_dwordx4 v20, s[28:31], s62 offen offset:2048 sc1 lds
  buffer_load_dwordx4 v20, s[28:31], s62 offen offset:3072 sc1 lds
  s_add_u32 s58, s40, 3
  s_lshl_b32 s58, s58, 7
  s_load_dword s68, s[12:13], s58 offset:0
  s_load_dword s69, s[12:13], s58 offset:64
  s_load_dword s70, s[12:13], s58 offset:2048
  s_load_dword s71, s[12:13], s58 offset:2112
  s_load_dword s72, s[12:13], s58 offset:4096
  s_load_dword s73, s[12:13], s58 offset:4160
  s_waitcnt vmcnt(12)
  s_barrier
  s_add_u32 s41, s40, 2
  s_lshl_b32 s41, s41, 7
  s_add_u32 m0, s60, 0
  s_nop 0
  buffer_load_dwordx4 v16, s[16:19], s41 offen offset:0  lds
  buffer_load_dwordx4 v17, s[16:19], s41 offen offset:1024  lds
  buffer_load_dwordx4 v18, s[16:19], s41 offen offset:2048  lds
  buffer_load_dwordx4 v19, s[16:19], s41 offen offset:3072  lds
  s_add_u32 m0, s60, 4096
  s_add_u32 s41, s41, 65536
  buffer_load_dwordx4 v16, s[16:19], s41 offen offset:0  lds
  buffer_load_dwordx4 v17, s[16:19], s41 offen offset:1024  lds
  buffer_load_dwordx4 v18, s[16:19], s41 offen offset:2048  lds
  buffer_load_dwordx4 v19, s[16:19], s41 offen offset:3072  lds
  s_mov_b32 s63, 0
L_sp3:
  s_waitcnt lgkmcnt(0)
  s_xor_b64 s[10:11], s[64:65], s[8:9]
  s_xor_b64 s[14:15], s[66:67], s[8:9]
  s_or_b64 s[10:11], s[10:11], s[14:15]
  s_cbranch_scc0 L_ok3
  s_load_dwordx4 s[64:67], s[4:5], s43 glc
  s_add_u32 s63, s63, 1
  s_cmp_lt_u32 s63, 20000
  s_cbranch_scc1 L_sp3
  s_waitcnt lgkmcnt(0)
L_ok3:
  s_add_u32 s43, s40, 3
  s_lshl_b32 s43, s43, 9
  s_load_dwordx4 s[64:67], s[4:5], s43 glc
  s_add_u32 m0, s61, 0
  s_add_u32 s62, s40, 2
  s_lshl_b32 s62, s62, 14
  buffer_load_dwordx4 v20, s[28:31], s62 offen offset:0 sc1 lds
  buffer_load_dwordx4 v20, s[28:31], s62 offen offset:1024 sc1 lds
  buffer_load_dwordx4 v20, s[28:31], s62 offen offset:2048 sc1 lds
  buffer_load_dwordx4 v20, s[28:31], s62 offen offset:3072 sc1 lds
  s_xor_b32 s58, s40, 4
  s_cmp_ge_u32 s58, s36
  s_addc_u32 s58, s58, 0
  s_lshl_b32 s58, s58, 7
  s_load_dword s68, s[12:13], s58 offset:0
  s_load_dword s69, s[12:13], s58 offset:64
  s_load_dword s70, s[12:13], s58 offset:2048
  s_load_dword s71, s[12:13], s58 offset:2112
  s_load_dword s72, s[12:13], s58 offset:4096
  s_load_dword s73, s[12:13], s58 offset:4160
  s_waitcnt vmcnt(12)
  s_barrier
  s_add_u32 s41, s40, 3
  s_lshl_b32 s41, s41, 7
  s_add_u32 m0, s60, 49152
  s_nop 0
  buffer_load_dwordx4 v16, s[16:19], s41 offen offset:0  lds
  buffer_load_dwordx4 v17, s[16:19], s41 offen offset:1024  lds
  buffer_load_dwordx4 v18, s[16:19], s41 offen offset:2048  lds
  buffer_load_dwordx4 v19, s[16:19], s41 offen offset:3072  lds
  s_add_u32 m0, s60, 53248
  s_add_u32 s41, s41, 65536
  buffer_load_dwordx4 v16, s[16:19], s41 offen offset:0  lds
  buffer_load_dwordx4 v17, s[16:19], s41 offen offset:1024  lds
  buffer_load_dwordx4 v18, s[16:19], s41 offen offset:2048  lds
  buffer_load_dwordx4 v19, s[16:19], s41 offen offset:3072  lds
  s_mov_b32 s63, 0
L_sp4:
  s_waitcnt lgkmcnt(0)
  s_xor_b64 s[10:11], s[64:65], s[8:9]
  s_xor_b64 s[14:15], s[66:67], s[8:9]
  s_or_b64 s[10:11], s[10:11], s[14:15]
  s_cbranch_scc0 L_ok4
  s_load_dwordx4 s[64:67], s[4:5], s43 glc
  s_add_u32 s63, s63, 1
  s_cmp_lt_u32 s63, 20000
  s_cbranch_scc1 L_sp4
  s_waitcnt lgkmcnt(0)
L_ok4:
  s_xor_b32 s43, s40, 4
  s_cmp_ge_u32 s43, s36
  s_addc_u32 s43, s43, 0
  s_lshl_b32 s43, s43, 9
  s_load_dwordx4 s[64:67], s[4:5], s43 glc
  s_add_u32 m0, s61, 49152
  s_add_u32 s62, s40, 3
  s_lshl_b32 s62, s62, 14
  buffer_load_dwordx4 v20, s[28:31], s62 offen offset:0 sc1 lds
  buffer_load_dwordx4 v20, s[28:31], s62 offen offset:1024 sc1 lds
  buffer_load_dwordx4 v20, s[28:31], s62 offen offset:2048 sc1 lds
  buffer_load_dwordx4 v20, s[28:31], s62 offen offset:3072 sc1 lds
  s_xor_b32 s58, s40, 5
  s_cmp_ge_u32 s58, s36
  s_addc_u32 s58, s58, 0
  s_lshl_b32 s58, s58, 7
  s_load_dword s68, s[12:13], s58 offset:0
  s_load_dword s69, s[12:13], s58 offset:64
  s_load_dword s70, s[12:13], s58 offset:2048
  s_load_dword s71, s[12:13], s58 offset:2112
  s_load_dword s72, s[12:13], s58 offset:4096
  s_load_dword s73, s[12:13], s58 offset:4160
  s_waitcnt vmcnt(12)
  s_barrier
  s_xor_b32 s41, s40, 4
  s_cmp_ge_u32 s41, s36
  s_addc_u32 s41, s41, 0
  s_lshl_b32 s41, s41, 7
  s_add_u32 m0, s60, 98304
  s_nop 0
  buffer_load_dwordx4 v16, s[16:19], s41 offen offset:0  lds
  buffer_load_dwordx4 v17, s[16:19], s41 offen offset:1024  lds
  buffer_load_dwordx4 v18, s[16:19], s41 offen offset:2048  lds
  buffer_load_dwordx4 v19, s[16:19], s41 offen offset:3072  lds
  s_add_u32 m0, s60, 102400
  s_add_u32 s41, s41, 65536
  buffer_load_dwordx4 v16, s[16:19], s41 offen offset:0  lds
  buffer_load_dwordx4 v17, s[16:19], s41 offen offset:1024  lds
  buffer_load_dwordx4 v18, s[16:19], s41 offen offset:2048  lds
  buffer_load_dwordx4 v19, s[16:19], s41 offen offset:3072  lds
  s_mov_b32 s63, 0
L_sp5:
  s_waitcnt lgkmcnt(0)
  s_xor_b64 s[10:11], s[64:65], s[8:9]
  s_xor_b64 s[14:15], s[66:67], s[8:9]
  s_or_b64 s[10:11], s[10:11], s[14:15]
  s_cbranch_scc0 L_ok5
  s_load_dwordx4 s[64:67], s[4:5], s43 glc
  s_add_u32 s63, s63, 1
  s_cmp_lt_u32 s63, 20000
  s_cbranch_scc1 L_sp5
  s_waitcnt lgkmcnt(0)
L_ok5:
  s_xor_b32 s43, s40, 5
  s_cmp_ge_u32 s43, s36
  s_addc_u32 s43, s43, 0
  s_lshl_b32 s43, s43, 9
  s_load_dwordx4 s[64:67], s[4:5], s43 glc
  s_add_u32 m0, s61, 98304
  s_xor_b32 s62, s40, 4
  s_cmp_ge_u32 s62, s36
  s_addc_u32 s62, s62, 0
  s_lshl_b32 s62, s62, 14
  buffer_load_dwordx4 v20, s[28:31], s62 offen offset:0 sc1 lds
  buffer_load_dwordx4 v20, s[28:31], s62 offen offset:1024 sc1 lds
  buffer_load_dwordx4 v20, s[28:31], s62 offen offset:2048 sc1 lds
  buffer_load_dwordx4 v20, s[28:31], s62 offen offset:3072 sc1 lds
  s_xor_b32 s58, s40, 6
  s_cmp_ge_u32 s58, s36
  s_addc_u32 s58, s58, 0
  s_lshl_b32 s58, s58, 7
  s_load_dword s68, s[12:13], s58 offset:0
  s_load_dword s69, s[12:13], s58 offset:64
  s_load_dword s70, s[12:13], s58 offset:2048
  s_load_dword s71, s[12:13], s58 offset:2112
  s_load_dword s72, s[12:13], s58 offset:4096
  s_load_dword s73, s[12:13], s58 offset:4160
  s_waitcnt vmcnt(12)
  s_barrier
  s_xor_b32 s41, s40, 5
  s_cmp_ge_u32 s41, s36
  s_addc_u32 s41, s41, 0
  s_lshl_b32 s41, s41, 7
  s_add_u32 m0, s60, 0
  s_nop 0
  buffer_load_dwordx4 v16, s[16:19], s41 offen offset:0  lds
  buffer_load_dwordx4 v17, s[16:19], s41 offen offset:1024  lds
  buffer_load_dwordx4 v18, s[16:19], s41 offen offset:2048  lds
  buffer_load_dwordx4 v19, s[16:19], s41 offen offset:3072  lds
  s_add_u32 m0, s60, 4096
  s_add_u32 s41, s41, 65536
  buffer_load_dwordx4 v16, s[16:19], s41 offen offset:0  lds
  buffer_load_dwordx4 v17, s[16:19], s41 offen offset:1024  lds
  buffer_load_dwordx4 v18, s[16:19], s41 offen offset:2048  lds
  buffer_load_dwordx4 v19, s[16:19], s41 offen offset:3072  lds
  s_mov_b32 s63, 0
L_sp6:
  s_waitcnt lgkmcnt(0)
  s_xor_b64 s[10:11], s[64:65], s[8:9]
  s_xor_b64 s[14:15], s[66:67], s[8:9]
  s_or_b64 s[10:11], s[10:11], s[14:15]
  s_cbranch_scc0 L_ok6
  s_load_dwordx4 s[64:67], s[4:5], s43 glc
  s_add_u32 s63, s63, 1
  s_cmp_lt_u32 s63, 20000
  s_cbranch_scc1 L_sp6
  s_waitcnt lgkmcnt(0)
L_ok6:
  s_xor_b32 s43, s40, 6
  s_cmp_ge_u32 s43, s36
  s_addc_u32 s43, s43, 0
  s_lshl_b32 s43, s43, 9
  s_load_dwordx4 s[64:67], s[4:5], s43 glc
  s_add_u32 m0, s61, 0
  s_xor_b32 s62, s40, 5
  s_cmp_ge_u32 s62, s36
  s_addc_u32 s62, s62, 0
  s_lshl_b32 s62, s62, 14
  buffer_load_dwordx4 v20, s[28:31], s62 offen offset:0 sc1 lds
  buffer_load_dwordx4 v20, s[28:31], s62 offen offset:1024 sc1 lds
  buffer_load_dwordx4 v20, s[28:31], s62 offen offset:2048 sc1 lds
  buffer_load_dwordx4 v20, s[28:31], s62 offen offset:3072 sc1 lds
  s_mov_b32 s58, 1024
  s_load_dword s68, s[12:13], s58 offset:0
  s_load_dword s69, s[12:13], s58 offset:64
  s_load_dword s70, s[12:13], s58 offset:2048
  s_load_dword s71, s[12:13], s58 offset:2112
  s_load_dword s72, s[12:13], s58 offset:4096
  s_load_dword s73, s[12:13], s58 offset:4160
  s_waitcnt vmcnt(12)
  s_barrier
  s_xor_b32 s41, s40, 6
  s_cmp_ge_u32 s41, s36
  s_addc_u32 s41, s41, 0
  s_lshl_b32 s41, s41, 7
  s_add_u32 m0, s60, 49152
  s_nop 0
  buffer_load_dwordx4 v16, s[16:19], s41 offen offset:0  lds
  buffer_load_dwordx4 v17, s[16:19], s41 offen offset:1024  lds
  buffer_load_dwordx4 v18, s[16:19], s41 offen offset:2048  lds
  buffer_load_dwordx4 v19, s[16:19], s41 offen offset:3072  lds
  s_add_u32 m0, s60, 53248
  s_add_u32 s41, s41, 65536
  buffer_load_dwordx4 v16, s[16:19], s41 offen offset:0  lds
  buffer_load_dwordx4 v17, s[16:19], s41 offen offset:1024  lds
  buffer_load_dwordx4 v18, s[16:19], s41 offen offset:2048  lds
  buffer_load_dwordx4 v19, s[16:19], s41 offen offset:3072  lds
  s_mov_b32 s63, 0
L_sp7:
  s_waitcnt lgkmcnt(0)
  s_xor_b64 s[10:11], s[64:65], s[8:9]
  s_xor_b64 s[14:15], s[66:67], s[8:9]
  s_or_b64 s[10:11], s[10:11], s[14:15]
  s_cbranch_scc0 L_ok7
  s_load_dwordx4 s[64:67], s[4:5], s43 glc
  s_add_u32 s63, s63, 1
  s_cmp_lt_u32 s63, 20000
  s_cbranch_scc1 L_sp7
  s_waitcnt lgkmcnt(0)
L_ok7:
  s_mov_b32 s43, 4096
  s_load_dwordx4 s[64:67], s[4:5], s43 glc
  s_add_u32 m0, s61, 49152
  s_xor_b32 s62, s40, 6
  s_cmp_ge_u32 s62, s36
  s_addc_u32 s62, s62, 0
  s_lshl_b32 s62, s62, 14
  buffer_load_dwordx4 v20, s[28:31], s62 offen offset:0 sc1 lds
  buffer_load_dwordx4 v20, s[28:31], s62 offen offset:1024 sc1 lds
  buffer_load_dwordx4 v20, s[28:31], s62 offen offset:2048 sc1 lds
  buffer_load_dwordx4 v20, s[28:31], s62 offen offset:3072 sc1 lds
  s_mov_b32 s58, 1152
  s_load_dword s68, s[12:13], s58 offset:0
  s_load_dword s69, s[12:13], s58 offset:64
  s_load_dword s70, s[12:13], s58 offset:2048
  s_load_dword s71, s[12:13], s58 offset:2112
  s_load_dword s72, s[12:13], s58 offset:4096
  s_load_dword s73, s[12:13], s58 offset:4160
  s_waitcnt vmcnt(12)
  s_barrier
  s_mov_b32 s41, 1024
  s_add_u32 m0, s60, 98304
  s_nop 0
  buffer_load_dwordx4 v16, s[16:19], s41 offen offset:0  lds
  buffer_load_dwordx4 v17, s[16:19], s41 offen offset:1024  lds
  buffer_load_dwordx4 v18, s[16:19], s41 offen offset:2048  lds
  buffer_load_dwordx4 v19, s[16:19], s41 offen offset:3072  lds
  s_add_u32 m0, s60, 102400
  s_add_u32 s41, s41, 65536
  buffer_load_dwordx4 v16, s[16:19], s41 offen offset:0  lds
  buffer_load_dwordx4 v17, s[16:19], s41 offen offset:1024  lds
  buffer_load_dwordx4 v18, s[16:19], s41 offen offset:2048  lds
  buffer_load_dwordx4 v19, s[16:19], s41 offen offset:3072  lds
  s_mov_b32 s63, 0
L_sp8:
  s_waitcnt lgkmcnt(0)
  s_xor_b64 s[10:11], s[64:65], s[8:9]
  s_xor_b64 s[14:15], s[66:67], s[8:9]
  s_or_b64 s[10:11], s[10:11], s[14:15]
  s_cbranch_scc0 L_ok8
  s_load_dwordx4 s[64:67], s[4:5], s43 glc
  s_add_u32 s63, s63, 1
  s_cmp_lt_u32 s63, 20000
  s_cbranch_scc1 L_sp8
  s_waitcnt lgkmcnt(0)
L_ok8:
  s_mov_b32 s43, 4608
  s_load_dwordx4 s[64:67], s[4:5], s43 glc
  s_add_u32 m0, s61, 98304
  s_mov_b32 s62, 131072
  buffer_load_dwordx4 v20, s[28:31], s62 offen offset:0 sc1 lds
  buffer_load_dwordx4 v20, s[28:31], s62 offen offset:1024 sc1 lds
  buffer_load_dwordx4 v20, s[28:31], s62 offen offset:2048 sc1 lds
  buffer_load_dwordx4 v20, s[28:31], s62 offen offset:3072 sc1 lds
  s_mov_b32 s58, 1280
  s_load_dword s68, s[12:13], s58 offset:0
  s_load_dword s69, s[12:13], s58 offset:64
  s_load_dword s70, s[12:13], s58 offset:2048
  s_load_dword s71, s[12:13], s58 offset:2112
  s_load_dword s72, s[12:13], s58 offset:4096
  s_load_dword s73, s[12:13], s58 offset:4160
  s_waitcnt vmcnt(12)
  s_barrier
  s_mov_b32 s41, 1152
  s_add_u32 m0, s60, 0
  s_nop 0
  buffer_load_dwordx4 v16, s[16:19], s41 offen offset:0  lds
  buffer_load_dwordx4 v17, s[16:19], s41 offen offset:1024  lds
  buffer_load_dwordx4 v18, s[16:19], s41 offen offset:2048  lds
  buffer_load_dwordx4 v19, s[16:19], s41 offen offset:3072  lds
  s_add_u32 m0, s60, 4096
  s_add_u32 s41, s41, 65536
  buffer_load_dwordx4 v16, s[16:19], s41 offen offset:0  lds
  buffer_load_dwordx4 v17, s[16:19], s41 offen offset:1024  lds
  buffer_load_dwordx4 v18, s[16:19], s41 offen offset:2048  lds
  buffer_load_dwordx4 v19, s[16:19], s41 offen offset:3072  lds
  s_mov_b32 s63, 0
L_sp9:
  s_waitcnt lgkmcnt(0)
  s_xor_b64 s[10:11], s[64:65], s[8:9]
  s_xor_b64 s[14:15], s[66:67], s[8:9]
  s_or_b64 s[10:11], s[10:11], s[14:15]
  s_cbranch_scc0 L_ok9
  s_load_dwordx4 s[64:67], s[4:5], s43 glc
  s_add_u32 s63, s63, 1
  s_cmp_lt_u32 s63, 20000
  s_cbranch_scc1 L_sp9
  s_waitcnt lgkmcnt(0)
L_ok9:
  s_mov_b32 s43, 5120
  s_load_dwordx4 s[64:67], s[4:5], s43 glc
  s_add_u32 m0, s61, 0
  s_mov_b32 s62, 147456
  buffer_load_dwordx4 v20, s[28:31], s62 offen offset:0 sc1 lds
  buffer_load_dwordx4 v20, s[28:31], s62 offen offset:1024 sc1 lds
  buffer_load_dwordx4 v20, s[28:31], s62 offen offset:2048 sc1 lds
  buffer_load_dwordx4 v20, s[28:31], s62 offen offset:3072 sc1 lds
  s_mov_b32 s58, 1408
  s_load_dword s68, s[12:13], s58 offset:0
  s_load_dword s69, s[12:13], s58 offset:64
  s_load_dword s70, s[12:13], s58 offset:2048
  s_load_dword s71, s[12:13], s58 offset:2112
  s_load_dword s72, s[12:13], s58 offset:4096
  s_load_dword s73, s[12:13], s58 offset:4160
  s_waitcnt vmcnt(12)
  s_barrier
  s_mov_b32 s41, 1280
  s_add_u32 m0, s60, 49152
  s_nop 0
  buffer_load_dwordx4 v16, s[16:19], s41 offen offset:0  lds
  buffer_load_dwordx4 v17, s[16:19], s41 offen offset:1024  lds
  buffer_load_dwordx4 v18, s[16:19], s41 offen offset:2048  lds
  buffer_load_dwordx4 v19, s[16:19], s41 offen offset:3072  lds
  s_add_u32 m0, s60, 53248
  s_add_u32 s41, s41, 65536
  buffer_load_dwordx4 v16, s[16:19], s41 offen offset:0  lds
  buffer_load_dwordx4 v17, s[16:19], s41 offen offset:1024  lds
  buffer_load_dwordx4 v18, s[16:19], s41 offen offset:2048  lds
  buffer_load_dwordx4 v19, s[16:19], s41 offen offset:3072  lds
  s_mov_b32 s63, 0
L_sp10:
  s_waitcnt lgkmcnt(0)
  s_xor_b64 s[10:11], s[64:65], s[8:9]
  s_xor_b64 s[14:15], s[66:67], s[8:9]
  s_or_b64 s[10:11], s[10:11], s[14:15]
  s_cbranch_scc0 L_ok10
  s_load_dwordx4 s[64:67], s[4:5], s43 glc
  s_add_u32 s63, s63, 1
  s_cmp_lt_u32 s63, 20000
  s_cbranch_scc1 L_sp10
  s_waitcnt lgkmcnt(0)
L_ok10:
  s_mov_b32 s43, 5632
  s_load_dwordx4 s[64:67], s[4:5], s43 glc
  s_add_u32 m0, s61, 49152
  s_mov_b32 s62, 163840
  buffer_load_dwordx4 v20, s[28:31], s62 offen offset:0 sc1 lds
  buffer_load_dwordx4 v20, s[28:31], s62 offen offset:1024 sc1 lds
  buffer_load_dwordx4 v20, s[28:31], s62 offen offset:2048 sc1 lds
  buffer_load_dwordx4 v20, s[28:31], s62 offen offset:3072 sc1 lds
  s_mov_b32 s58, 1536
  s_load_dword s68, s[12:13], s58 offset:0
  s_load_dword s69, s[12:13], s58 offset:64
  s_load_dword s70, s[12:13], s58 offset:2048
  s_load_dword s71, s[12:13], s58 offset:2112
  s_load_dword s72, s[12:13], s58 offset:4096
  s_load_dword s73, s[12:13], s58 offset:4160
  s_waitcnt vmcnt(12)
  s_barrier
  s_mov_b32 s41, 1408
  s_add_u32 m0, s60, 98304
  s_nop 0
  buffer_load_dwordx4 v16, s[16:19], s41 offen offset:0  lds
  buffer_load_dwordx4 v17, s[16:19], s41 offen offset:1024  lds
  buffer_load_dwordx4 v18, s[16:19], s41 offen offset:2048  lds
  buffer_load_dwordx4 v19, s[16:19], s41 offen offset:3072  lds
  s_add_u32 m0, s60, 102400
  s_add_u32 s41, s41, 65536
  buffer_load_dwordx4 v16, s[16:19], s41 offen offset:0  lds
  buffer_load_dwordx4 v17, s[16:19], s41 offen offset:1024  lds
  buffer_load_dwordx4 v18, s[16:19], s41 offen offset:2048  lds
  buffer_load_dwordx4 v19, s[16:19], s41 offen offset:3072  lds
  s_mov_b32 s63, 0
L_sp11:
  s_waitcnt lgkmcnt(0)
  s_xor_b64 s[10:11], s[64:65], s[8:9]
  s_xor_b64 s[14:15], s[66:67], s[8:9]
  s_or_b64 s[10:11], s[10:11], s[14:15]
  s_cbranch_scc0 L_ok11
  s_load_dwordx4 s[64:67], s[4:5], s43 glc
  s_add_u32 s63, s63, 1
  s_cmp_lt_u32 s63, 20000
  s_cbranch_scc1 L_sp11
  s_waitcnt lgkmcnt(0)
L_ok11:
  s_mov_b32 s43, 6144
  s_load_dwordx4 s[64:67], s[4:5], s43 glc
  s_add_u32 m0, s61, 98304
  s_mov_b32 s62, 180224
  buffer_load_dwordx4 v20, s[28:31], s62 offen offset:0 sc1 lds
  buffer_load_dwordx4 v20, s[28:31], s62 offen offset:1024 sc1 lds
  buffer_load_dwordx4 v20, s[28:31], s62 offen offset:2048 sc1 lds
  buffer_load_dwordx4 v20, s[28:31], s62 offen offset:3072 sc1 lds
  s_mov_b32 s58, 1664
  s_load_dword s68, s[12:13], s58 offset:0
  s_load_dword s69, s[12:13], s58 offset:64
  s_load_dword s70, s[12:13], s58 offset:2048
  s_load_dword s71, s[12:13], s58 offset:2112
  s_load_dword s72, s[12:13], s58 offset:4096
  s_load_dword s73, s[12:13], s58 offset:4160
  s_waitcnt vmcnt(12)
  s_barrier
  s_mov_b32 s41, 1536
  s_add_u32 m0, s60, 0
  s_nop 0
  buffer_load_dwordx4 v16, s[16:19], s41 offen offset:0  lds
  buffer_load_dwordx4 v17, s[16:19], s41 offen offset:1024  lds
  buffer_load_dwordx4 v18, s[16:19], s41 offen offset:2048  lds
  buffer_load_dwordx4 v19, s[16:19], s41 offen offset:3072  lds
  s_add_u32 m0, s60, 4096
  s_add_u32 s41, s41, 65536
  buffer_load_dwordx4 v16, s[16:19], s41 offen offset:0  lds
  buffer_load_dwordx4 v17, s[16:19], s41 offen offset:1024  lds
  buffer_load_dwordx4 v18, s[16:19], s41 offen offset:2048  lds
  buffer_load_dwordx4 v19, s[16:19], s41 offen offset:3072  lds
  s_mov_b32 s63, 0
L_sp12:
  s_waitcnt lgkmcnt(0)
  s_xor_b64 s[10:11], s[64:65], s[8:9]
  s_xor_b64 s[14:15], s[66:67], s[8:9]
  s_or_b64 s[10:11], s[10:11], s[14:15]
  s_cbranch_scc0 L_ok12
  s_load_dwordx4 s[64:67], s[4:5], s43 glc
  s_add_u32 s63, s63, 1
  s_cmp_lt_u32 s63, 20000
  s_cbranch_scc1 L_sp12
  s_waitcnt lgkmcnt(0)
L_ok12:
  s_mov_b32 s43, 6656
  s_load_dwordx4 s[64:67], s[4:5], s43 glc
  s_add_u32 m0, s61, 0
  s_mov_b32 s62, 196608
  buffer_load_dwordx4 v20, s[28:31], s62 offen offset:0 sc1 lds
  buffer_load_dwordx4 v20, s[28:31], s62 offen offset:1024 sc1 lds
  buffer_load_dwordx4 v20, s[28:31], s62 offen offset:2048 sc1 lds
  buffer_load_dwordx4 v20, s[28:31], s62 offen offset:3072 sc1 lds
  s_mov_b32 s58, 1792
  s_load_dword s68, s[12:13], s58 offset:0
  s_load_dword s69, s[12:13], s58 offset:64
  s_load_dword s70, s[12:13], s58 offset:2048
  s_load_dword s71, s[12:13], s58 offset:2112
  s_load_dword s72, s[12:13], s58 offset:4096
  s_load_dword s73, s[12:13], s58 offset:4160
  s_waitcnt vmcnt(12)
  s_barrier
  s_mov_b32 s41, 1664
  s_add_u32 m0, s60, 49152
  s_nop 0
  buffer_load_dwordx4 v16, s[16:19], s41 offen offset:0  lds
  buffer_load_dwordx4 v17, s[16:19], s41 offen offset:1024  lds
  buffer_load_dwordx4 v18, s[16:19], s41 offen offset:2048  lds
  buffer_load_dwordx4 v19, s[16:19], s41 offen offset:3072  lds
  s_add_u32 m0, s60, 53248
  s_add_u32 s41, s41, 65536
  buffer_load_dwordx4 v16, s[16:19], s41 offen offset:0  lds
  buffer_load_dwordx4 v17, s[16:19], s41 offen offset:1024  lds
  buffer_load_dwordx4 v18, s[16:19], s41 offen offset:2048  lds
  buffer_load_dwordx4 v19, s[16:19], s41 offen offset:3072  lds
  s_mov_b32 s63, 0
L_sp13:
  s_waitcnt lgkmcnt(0)
  s_xor_b64 s[10:11], s[64:65], s[8:9]
  s_xor_b64 s[14:15], s[66:67], s[8:9]
  s_or_b64 s[10:11], s[10:11], s[14:15]
  s_cbranch_scc0 L_ok13
  s_load_dwordx4 s[64:67], s[4:5], s43 glc
  s_add_u32 s63, s63, 1
  s_cmp_lt_u32 s63, 20000
  s_cbranch_scc1 L_sp13
  s_waitcnt lgkmcnt(0)
L_ok13:
  s_mov_b32 s43, 7168
  s_load_dwordx4 s[64:67], s[4:5], s43 glc
  s_add_u32 m0, s61, 49152
  s_mov_b32 s62, 212992
  buffer_load_dwordx4 v20, s[28:31], s62 offen offset:0 sc1 lds
  buffer_load_dwordx4 v20, s[28:31], s62 offen offset:1024 sc1 lds
  buffer_load_dwordx4 v20, s[28:31], s62 offen offset:2048 sc1 lds
  buffer_load_dwordx4 v20, s[28:31], s62 offen offset:3072 sc1 lds
  s_mov_b32 s58, 1920
  s_load_dword s68, s[12:13], s58 offset:0
  s_load_dword s69, s[12:13], s58 offset:64
  s_load_dword s70, s[12:13], s58 offset:2048
  s_load_dword s71, s[12:13], s58 offset:2112
  s_load_dword s72, s[12:13], s58 offset:4096
  s_load_dword s73, s[12:13], s58 offset:4160
  s_waitcnt vmcnt(12)
  s_barrier
  s_mov_b32 s41, 1792
  s_add_u32 m0, s60, 98304
  s_nop 0
  buffer_load_dwordx4 v16, s[16:19], s41 offen offset:0  lds
  buffer_load_dwordx4 v17, s[16:19], s41 offen offset:1024  lds
  buffer_load_dwordx4 v18, s[16:19], s41 offen offset:2048  lds
  buffer_load_dwordx4 v19, s[16:19], s41 offen offset:3072  lds
  s_add_u32 m0, s60, 102400
  s_add_u32 s41, s41, 65536
  buffer_load_dwordx4 v16, s[16:19], s41 offen offset:0  lds
  buffer_load_dwordx4 v17, s[16:19], s41 offen offset:1024  lds
  buffer_load_dwordx4 v18, s[16:19], s41 offen offset:2048  lds
  buffer_load_dwordx4 v19, s[16:19], s41 offen offset:3072  lds
  s_mov_b32 s63, 0
L_sp14:
  s_waitcnt lgkmcnt(0)
  s_xor_b64 s[10:11], s[64:65], s[8:9]
  s_xor_b64 s[14:15], s[66:67], s[8:9]
  s_or_b64 s[10:11], s[10:11], s[14:15]
  s_cbranch_scc0 L_ok14
  s_load_dwordx4 s[64:67], s[4:5], s43 glc
  s_add_u32 s63, s63, 1
  s_cmp_lt_u32 s63, 20000
  s_cbranch_scc1 L_sp14
  s_waitcnt lgkmcnt(0)
L_ok14:
  s_mov_b32 s43, 7680
  s_load_dwordx4 s[64:67], s[4:5], s43 glc
  s_add_u32 m0, s61, 98304
  s_mov_b32 s62, 229376
  buffer_load_dwordx4 v20, s[28:31], s62 offen offset:0 sc1 lds
  buffer_load_dwordx4 v20, s[28:31], s62 offen offset:1024 sc1 lds
  buffer_load_dwordx4 v20, s[28:31], s62 offen offset:2048 sc1 lds
  buffer_load_dwordx4 v20, s[28:31], s62 offen offset:3072 sc1 lds
  s_mov_b32 s41, 1920
  s_lshr_b32 s53, s60, 1
  s_add_u32 m0, s53, 147456
  s_nop 0
  buffer_load_dwordx4 v16, s[16:19], s41 offen offset:0  lds
  buffer_load_dwordx4 v17, s[16:19], s41 offen offset:1024  lds
  buffer_load_dwordx4 v18, s[16:19], s41 offen offset:2048  lds
  buffer_load_dwordx4 v19, s[16:19], s41 offen offset:3072  lds
  s_waitcnt vmcnt(16)
  s_barrier
  s_mov_b32 s63, 0
L_sp15:
  s_waitcnt lgkmcnt(0)
  s_xor_b64 s[10:11], s[64:65], s[8:9]
  s_xor_b64 s[14:15], s[66:67], s[8:9]
  s_or_b64 s[10:11], s[10:11], s[14:15]
  s_cbranch_scc0 L_ok15
  s_load_dwordx4 s[64:67], s[4:5], s43 glc
  s_add_u32 s63, s63, 1
  s_cmp_lt_u32 s63, 20000
  s_cbranch_scc1 L_sp15
  s_waitcnt lgkmcnt(0)
L_ok15:
  s_add_u32 m0, s61, 0
  s_mov_b32 s62, 245760
  buffer_load_dwordx4 v20, s[28:31], s62 offen offset:0 sc1 lds
  buffer_load_dwordx4 v20, s[28:31], s62 offen offset:2048 sc1 lds
  s_waitcnt vmcnt(6)
  s_barrier
  s_add_u32 m0, s61, 0
  s_mov_b32 s62, 245760
  buffer_load_dwordx4 v20, s[28:31], s62 offen offset:1024 sc1 lds
  buffer_load_dwordx4 v20, s[28:31], s62 offen offset:3072 sc1 lds
  s_add_u32 m0, s60, 4096
  s_add_u32 s41, s41, 65536
  buffer_load_dwordx4 v16, s[16:19], s41 offen offset:0  lds
  buffer_load_dwordx4 v17, s[16:19], s41 offen offset:1024  lds
  buffer_load_dwordx4 v18, s[16:19], s41 offen offset:2048  lds
  buffer_load_dwordx4 v19, s[16:19], s41 offen offset:3072  lds
  s_waitcnt vmcnt(6)
  s_barrier
  s_waitcnt vmcnt(0)
  s_barrier
  s_endpgm
L_prod:
  s_mov_b32 s30, 9457664
  s_mov_b32 s31, 0x20000
  s_mov_b32 s18, 4194304
  s_mov_b32 s19, 0x20000
  s_mov_b32 s34, 14680064
  s_mov_b32 s35, 0x20000
  v_and_b32 v2, 63, v0
  v_lshlrev_b32 v5, 2, v3
  s_and_b32 s39, s38, 3
  s_mov_b32 s56, 917504
  s_mov_b32 s57, 16384
  s_mov_b32 s58, 512
  s_mov_b32 s59, 0
  s_mov_b32 s55, 7
  v_mov_b32 v15, 0x7ff00000
  s_cmp_lt_u32 s2, 28
  s_cbranch_scc1 L_pp
  s_mov_b32 s56, 512
  s_mov_b32 s57, 262144
  s_mov_b32 s58, 8192
  s_mov_b32 s59, 4096
  s_mov_b32 s51, 6
L_pl:
  s_add_u32 m0, m0, 4096
  v_add_u32 v16, 256, v16
  s_sub_u32 s51, s51, 1
  buffer_load_dword v16, s[24:27], 0 offen lds
  buffer_load_dword v16, s[24:27], s50 offen offset:256 lds
  s_cmp_lg_u32 s51, 0
  s_cbranch_scc1 L_pl
  s_waitcnt vmcnt(0)
  s_branch L_pq
L_pp:
  s_mov_b32 s22, 13762560
L_pq:
  s_add_u32 s10, s28, 9437184
  s_addc_u32 s11, s29, 0
  s_load_dwordx2 s[6:7], s[10:11], 0
  s_lshl_b32 s53, s38, 11
  s_add_u32 s53, s53, 32768
  v_lshrrev_b32 v1, 4, v3
  v_lshlrev_b32 v1, 10, v1
  v_lshl_add_u32 v1, v9, 3, v1
  v_and_b32 v6, 15, v3
  v_lshl_add_u32 v6, v6, 4, v1
  v_add_u32 v6, s53, v6
  v_lshl_add_u32 v7, v2, 4, s53
  s_lshl_b32 s53, s37, 18
  s_lshl_b32 s54, s52, 11
  s_add_u32 s53, s53, s54
  v_lshl_add_u32 v8, v2, 4, s53
  s_lshl_b32 s53, s37, 6
  s_lshr_b32 s54, s52, 1
  s_add_u32 s53, s53, s54
  s_lshl_b32 s53, s53, 7
  s_and_b32 s54, s52, 1
  s_lshl_b32 s54, s54, 3
  s_add_u32 s53, s53, s54
  s_add_u32 s53, s53, 7340032
  v_lshl_add_u32 v14, v2, 7, s53
  s_waitcnt vmcnt(0)
  buffer_load_dwordx4 v[32:35], v4, s[20:23], 0 offen nt
  buffer_load_dwordx4 v[36:39], v4, s[20:23], s45 offen nt
  buffer_load_dwordx4 v[40:43], v4, s[20:23], s46 offen nt
  buffer_load_dwordx4 v[44:47], v4, s[20:23], s47 offen nt
  v_add_u32 v4, s56, v4
  buffer_load_dword v17, v15, s[20:23], 0 offen
  buffer_load_dword v17, v15, s[20:23], 0 offen
  buffer_load_dwordx4 v[48:51], v4, s[20:23], 0 offen nt
  buffer_load_dwordx4 v[52:55], v4, s[20:23], s45 offen nt
  buffer_load_dwordx4 v[56:59], v4, s[20:23], s46 offen nt
  buffer_load_dwordx4 v[60:63], v4, s[20:23], s47 offen nt
  v_add_u32 v4, s56, v4
  s_waitcnt lgkmcnt(0)
  s_mul_i32 s8, s6, 1664525
  s_mul_i32 s9, s7, 22695477
  s_add_u32 s8, s8, 1013904223
  s_add_u32 s9, s9, 1
  v_mov_b32 v10, s8
  v_mov_b32 v11, s9
  s_mov_b32 s60, 0
  s_mov_b32 s61, 0
  s_mov_b32 s62, 0
  s_waitcnt vmcnt(10)
  s_barrier
L_p:
  s_waitcnt vmcnt(9)
  v_lshl_add_u32 v32, v32, 8, v5
  v_lshl_add_u32 v33, v33, 8, v5
  v_lshl_add_u32 v34, v34, 8, v5
  v_lshl_add_u32 v35, v35, 8, v5
  ds_read_u16 v96, v32 offset:0
  ds_read_u16 v97, v33 offset:2
  ds_read_u16 v98, v34 offset:128
  ds_read_u16 v99, v35 offset:130
  s_waitcnt vmcnt(8)
  v_lshl_add_u32 v36, v36, 8, v5
  v_lshl_add_u32 v37, v37, 8, v5
  v_lshl_add_u32 v38, v38, 8, v5
  v_lshl_add_u32 v39, v39, 8, v5
  ds_read_u16 v100, v36 offset:0
  ds_read_u16 v101, v37 offset:2
  ds_read_u16 v102, v38 offset:128
  ds_read_u16 v103, v39 offset:130
  s_waitcnt vmcnt(7)
  v_lshl_add_u32 v40, v40, 8, v5
  v_lshl_add_u32 v41, v41, 8, v5
  v_lshl_add_u32 v42, v42, 8, v5
  v_lshl_add_u32 v43, v43, 8, v5
  ds_read_u16 v104, v40 offset:0
  ds_read_u16 v105, v41 offset:2
  ds_read_u16 v106, v42 offset:128
  ds_read_u16 v107, v43 offset:130
  s_waitcnt vmcnt(6)
  v_lshl_add_u32 v44, v44, 8, v5
  v_lshl_add_u32 v45, v45, 8, v5
  v_lshl_add_u32 v46, v46, 8, v5
  v_lshl_add_u32 v47, v47, 8, v5
  ds_read_u16 v108, v44 offset:0
  ds_read_u16 v109, v45 offset:2
  ds_read_u16 v110, v46 offset:128
  ds_read_u16 v111, v47 offset:130
  s_cmp_eq_u32 s62, 0
  s_cbranch_scc1 L_pa0
  s_waitcnt vmcnt(4)
  s_mov_b64 exec, 1
  buffer_store_dwordx2 v[10:11], v14, s[28:31], s61 offen sc1
  s_mov_b64 exec, -1
  s_add_u32 s61, s61, s58
L_pa0:
  s_waitcnt lgkmcnt(8)
  v_lshl_or_b32 v112, v100, 16, v96
  v_lshl_or_b32 v114, v101, 16, v97
  v_lshl_or_b32 v116, v102, 16, v98
  v_lshl_or_b32 v118, v103, 16, v99
  s_waitcnt lgkmcnt(3)
  v_lshl_or_b32 v113, v108, 16, v104
  ds_write_b64 v6, v[112:113] offset:0
  s_waitcnt lgkmcnt(3)
  v_lshl_or_b32 v115, v109, 16, v105
  ds_write_b64 v6, v[114:115] offset:256
  s_waitcnt lgkmcnt(3)
  v_lshl_or_b32 v117, v110, 16, v106
  ds_write_b64 v6, v[116:117] offset:512
  s_waitcnt lgkmcnt(3)
  v_lshl_or_b32 v119, v111, 16, v107
  ds_write_b64 v6, v[118:119] offset:768
  s_waitcnt lgkmcnt(0)
  ds_read_b128 v[120:123], v7 offset:0
  ds_read_b128 v[124:127], v7 offset:1024
  s_waitcnt lgkmcnt(1)
  buffer_store_dwordx4 v[120:123], v8, s[28:31], s60 offen offset:0 sc1
  s_waitcnt lgkmcnt(0)
  buffer_store_dwordx4 v[124:127], v8, s[28:31], s60 offen offset:1024 sc1
  buffer_load_dwordx4 v[32:35], v4, s[20:23], 0 offen nt
  buffer_load_dwordx4 v[36:39], v4, s[20:23], s45 offen nt
  buffer_load_dwordx4 v[40:43], v4, s[20:23], s46 offen nt
  buffer_load_dwordx4 v[44:47], v4, s[20:23], s47 offen nt
  v_add_u32 v4, s56, v4
  v_add_u32 v5, s59, v5
  s_add_u32 s62, s62, 1
  s_add_u32 s60, s60, s57
  s_cmp_lt_u32 s62, s55
  s_cbranch_scc0 L_pe
  s_waitcnt vmcnt(9)
  v_lshl_add_u32 v48, v48, 8, v5
  v_lshl_add_u32 v49, v49, 8, v5
  v_lshl_add_u32 v50, v50, 8, v5
  v_lshl_add_u32 v51, v51, 8, v5
  ds_read_u16 v96, v48 offset:0
  ds_read_u16 v97, v49 offset:2
  ds_read_u16 v98, v50 offset:128
  ds_read_u16 v99, v51 offset:130
  s_waitcnt vmcnt(8)
  v_lshl_add_u32 v52, v52, 8, v5
  v_lshl_add_u32 v53, v53, 8, v5
  v_lshl_add_u32 v54, v54, 8, v5
  v_lshl_add_u32 v55, v55, 8, v5
  ds_read_u16 v100, v52 offset:0
  ds_read_u16 v101, v53 offset:2
  ds_read_u16 v102, v54 offset:128
  ds_read_u16 v103, v55 offset:130
  s_waitcnt vmcnt(7)
  v_lshl_add_u32 v56, v56, 8, v5
  v_lshl_add_u32 v57, v57, 8, v5
  v_lshl_add_u32 v58, v58, 8, v5
  v_lshl_add_u32 v59, v59, 8, v5
  ds_read_u16 v104, v56 offset:0
  ds_read_u16 v105, v57 offset:2
  ds_read_u16 v106, v58 offset:128
  ds_read_u16 v107, v59 offset:130
  s_waitcnt vmcnt(6)
  v_lshl_add_u32 v60, v60, 8, v5
  v_lshl_add_u32 v61, v61, 8, v5
  v_lshl_add_u32 v62, v62, 8, v5
  v_lshl_add_u32 v63, v63, 8, v5
  ds_read_u16 v108, v60 offset:0
  ds_read_u16 v109, v61 offset:2
  ds_read_u16 v110, v62 offset:128
  ds_read_u16 v111, v63 offset:130
  s_cmp_eq_u32 s62, 0
  s_cbranch_scc1 L_pa1
  s_waitcnt vmcnt(4)
  s_mov_b64 exec, 1
  buffer_store_dwordx2 v[10:11], v14, s[28:31], s61 offen sc1
  s_mov_b64 exec, -1
  s_add_u32 s61, s61, s58
L_pa1:
  s_waitcnt lgkmcnt(8)
  v_lshl_or_b32 v112, v100, 16, v96
  v_lshl_or_b32 v114, v101, 16, v97
  v_lshl_or_b32 v116, v102, 16, v98
  v_lshl_or_b32 v118, v103, 16, v99
  s_waitcnt lgkmcnt(3)
  v_lshl_or_b32 v113, v108, 16, v104
  ds_write_b64 v6, v[112:113] offset:0
  s_waitcnt lgkmcnt(3)
  v_lshl_or_b32 v115, v109, 16, v105
  ds_write_b64 v6, v[114:115] offset:256
  s_waitcnt lgkmcnt(3)
  v_lshl_or_b32 v117, v110, 16, v106
  ds_write_b64 v6, v[116:117] offset:512
  s_waitcnt lgkmcnt(3)
  v_lshl_or_b32 v119, v111, 16, v107
  ds_write_b64 v6, v[118:119] offset:768
  s_waitcnt lgkmcnt(0)
  ds_read_b128 v[128:131], v7 offset:0
  ds_read_b128 v[132:135], v7 offset:1024
  s_waitcnt lgkmcnt(1)
  buffer_store_dwordx4 v[128:131], v8, s[28:31], s60 offen offset:0 sc1
  s_waitcnt lgkmcnt(0)
  buffer_store_dwordx4 v[132:135], v8, s[28:31], s60 offen offset:1024 sc1
  buffer_load_dwordx4 v[48:51], v4, s[20:23], 0 offen nt
  buffer_load_dwordx4 v[52:55], v4, s[20:23], s45 offen nt
  buffer_load_dwordx4 v[56:59], v4, s[20:23], s46 offen nt
  buffer_load_dwordx4 v[60:63], v4, s[20:23], s47 offen nt
  v_add_u32 v4, s56, v4
  v_add_u32 v5, s59, v5
  s_add_u32 s62, s62, 1
  s_add_u32 s60, s60, s57
  s_cmp_lt_u32 s62, s55
  s_cbranch_scc1 L_p
L_pe:
  s_waitcnt vmcnt(4)
  s_mov_b64 exec, 1
  buffer_store_dwordx2 v[10:11], v14, s[28:31], s61 offen sc1
  s_mov_b64 exec, -1
  s_cmp_eq_u32 s38, 0
  s_cbranch_scc0 L_pz
  s_lshl_b32 s3, s2, 6
  s_add_u32 s3, s3, 9441280
  v_mov_b32 v12, s3
  s_mov_b64 exec, 1
  buffer_store_dwordx2 v[10:11], v12, s[28:31], 0 offen sc1
  s_mov_b64 exec, -1
  s_cmp_eq_u32 s2, 0
  s_cbranch_scc0 L_pz
  s_mov_b32 s63, 0
  v_lshlrev_b32 v12, 6, v2
  v_add_u32 v12, 9441280, v12
L_pw:
  s_mov_b32 s53, 0
  buffer_load_dwordx2 v[20:21], v12, s[28:31], s53 offen sc1
  s_mov_b32 s53, 4096
  buffer_load_dwordx2 v[22:23], v12, s[28:31], s53 offen sc1
  s_mov_b32 s53, 8192
  buffer_load_dwordx2 v[24:25], v12, s[28:31], s53 offen sc1
  s_mov_b32 s53, 12288
  buffer_load_dwordx2 v[26:27], v12, s[28:31], s53 offen sc1
  s_add_u32 s63, s63, 1
  s_waitcnt vmcnt(0)
  v_cmp_ne_u64 s[52:53], v[20:21], v[10:11]
  v_cmp_ne_u64 vcc, v[22:23], v[10:11]
  s_or_b64 s[52:53], s[52:53], vcc
  v_cmp_ne_u64 vcc, v[24:25], v[10:11]
  s_or_b64 s[52:53], s[52:53], vcc
  v_cmp_ne_u64 vcc, v[26:27], v[10:11]
  s_or_b64 s[52:53], s[52:53], vcc
  s_cbranch_scc0 L_pv
  s_cmp_lt_u32 s63, 20000
  s_cbranch_scc1 L_pw
L_pv:
  v_mov_b32 v12, 9437184
  s_mov_b64 exec, 1
  buffer_store_dwordx2 v[10:11], v12, s[28:31], 0 offen sc1
  s_mov_b64 exec, -1
L_pz:
L_drain:
  s_waitcnt vmcnt(0)
L_done:
  s_endpgm
L_end:
.section .rodata,"a"
.p2align 6
.amdhsa_kernel standalone__weight_only_int_squeezellm__prompt_kernel
  .amdhsa_next_free_vgpr 256
  .amdhsa_next_free_sgpr 102
  .amdhsa_accum_offset 160
  .amdhsa_group_segment_fixed_size 0
  .amdhsa_kernarg_size 48
  .amdhsa_user_sgpr_count 2
  .amdhsa_user_sgpr_kernarg_segment_ptr 1
  .amdhsa_system_sgpr_workgroup_id_x 1
.end_amdhsa_kernel
```

```asm
; @launch grid=(256,1,1) block=(512,1,1) lds=163840
.amdgcn_target "amdgcn-amd-amdhsa--gfx950"
.text
.globl standalone__weight_only_int_squeezellm__prompt_kernel
.p2align 8
.type standalone__weight_only_int_squeezellm__prompt_kernel,@function
standalone__weight_only_int_squeezellm__prompt_kernel:
  s_cmp_ge_u32 s2, 256
  s_cbranch_scc1 L_done
  s_load_dwordx2 s[24:25], s[0:1], 16
  s_load_dwordx2 s[20:21], s[0:1], 8
  s_load_dwordx2 s[28:29], s[0:1], 40
  s_load_dwordx2 s[16:17], s[0:1], 0
  s_load_dwordx2 s[32:33], s[0:1], 24
  s_and_b32 s3, s2, 1
  s_bfe_u32 s36, s2, 0x20003
  s_lshl2_add_u32 s36, s3, s36
  s_bfe_u32 s3, s2, 0x20001
  s_mul_i32 s3, s3, 7
  s_lshr_b32 s37, s2, 5
  s_add_u32 s37, s37, s3
  s_sub_u32 s37, s37, 1
  s_sub_u32 s3, s2, 28
  s_mul_i32 s53, s3, 7
  s_cmp_lt_u32 s3, 4
  s_cselect_b32 s51, 15, 8
  s_cselect_b32 s53, s53, s2
  s_cmp_lt_u32 s2, 32
  s_cselect_b32 s36, s51, s36
  s_cselect_b32 s37, s53, s37
  s_cselect_b32 s51, 0, 147456
  v_lshrrev_b32 v1, 6, v0
  v_and_b32 v3, 31, v0
  v_readfirstlane_b32 s38, v1
  v_bfe_u32 v9, v0, 5, 1
  s_mov_b32 s26, 114688
  s_mov_b32 s27, 0x20000
  s_mov_b32 s22, 14680064
  s_mov_b32 s23, 0x20000
  v_mul_u32_u24 v1, 57344, v9
  v_lshl_add_u32 v4, v3, 4, v1
  v_lshlrev_b32 v1, 3, v3
  v_lshl_add_u32 v16, v9, 2, v1
  s_mul_i32 s53, s38, 14336
  s_lshl_b32 s54, s37, 8
  s_add_u32 s53, s53, s54
  v_add_u32 v16, s53, v16
  s_lshl_b32 s53, s38, 9
  s_add_u32 m0, s53, s51
  s_movk_i32 s50, 6912
  s_lshl3_add_u32 s52, s36, s38
  s_mul_i32 s53, s52, 114688
  s_lshl1_add_u32 s53, s54, s53
  v_add_u32 v4, s53, v4
  s_movk_i32 s45, 14336
  s_movk_i32 s46, 28672
  s_mov_b32 s47, 43008
  s_cmp_lt_u32 s2, 32
  s_waitcnt lgkmcnt(0)
  buffer_load_dword v16, s[24:27], 0 offen lds
  buffer_load_dword v16, s[24:27], s50 offen offset:256 lds
  s_cbranch_scc1 L_h
  buffer_load_dwordx4 v[32:35], v4, s[20:23], 0 offen nt
  buffer_load_dwordx4 v[36:39], v4, s[20:23], s45 offen nt
  buffer_load_dwordx4 v[40:43], v4, s[20:23], s46 offen nt
  buffer_load_dwordx4 v[44:47], v4, s[20:23], s47 offen nt
  s_add_u32 s10, s28, 9437184
  s_addc_u32 s11, s29, 0
  s_load_dwordx2 s[6:7], s[10:11], 0
  s_branch L_ng
L_h:
  s_getpc_b64 s[14:15]
L_pc:
  s_lshr_b32 s53, s2, 3
  s_lshl3_add_u32 s53, s53, s38
  s_mul_i32 s53, s53, 512
  s_min_u32 s53, s53, L_end-standalone__weight_only_int_squeezellm__prompt_kernel-512
  s_sub_u32 s14, s14, L_pc-standalone__weight_only_int_squeezellm__prompt_kernel
  s_subb_u32 s15, s15, 0
  s_load_dword s68, s[14:15], s53 offset:0
  s_load_dword s69, s[14:15], s53 offset:64
  s_load_dword s70, s[14:15], s53 offset:128
  s_load_dword s71, s[14:15], s53 offset:192
  s_load_dword s72, s[14:15], s53 offset:256
  s_load_dword s73, s[14:15], s53 offset:320
  s_load_dword s74, s[14:15], s53 offset:384
  s_load_dword s75, s[14:15], s53 offset:448
  s_branch L_prod
L_ng:
  s_mov_b32 s30, 9457664
  s_mov_b32 s31, 0x20000
  s_mov_b32 s18, 4194304
  s_mov_b32 s19, 0x20000
  s_mov_b32 s34, 14680064
  s_mov_b32 s35, 0x20000
  v_and_b32 v2, 63, v0
  v_lshlrev_b32 v5, 2, v3
  s_and_b32 s39, s38, 3
  v_add_u32 v5, 147456, v5
  s_lshl_b32 s53, s38, 11
  s_add_u32 s53, s53, 32768
  v_lshrrev_b32 v1, 4, v3
  v_lshlrev_b32 v1, 10, v1
  v_lshl_add_u32 v1, v9, 3, v1
  v_and_b32 v6, 15, v3
  v_lshl_add_u32 v6, v6, 4, v1
  v_add_u32 v6, s53, v6
  v_lshl_add_u32 v7, v2, 4, s53
  s_lshl_b32 s53, s37, 18
  s_lshl_b32 s54, s52, 11
  s_add_u32 s53, s53, s54
  v_lshl_add_u32 v8, v2, 4, s53
  s_lshl_b32 s53, s37, 6
  s_lshr_b32 s54, s52, 1
  s_add_u32 s53, s53, s54
  s_lshl_b32 s53, s53, 7
  s_and_b32 s54, s52, 1
  s_lshl_b32 s54, s54, 3
  s_add_u32 s53, s53, s54
  s_add_u32 s53, s53, 7340032
  v_lshl_add_u32 v14, v2, 7, s53
  s_lshl_b32 s53, s37, 2
  s_add_u32 s53, s53, s39
  s_mul_i32 s53, s53, 3
  s_min_u32 s53, s53, 253
  s_lshl_b32 s54, s36, 8
  s_add_u32 s53, s53, s54
  s_lshl_b32 s53, s53, 11
  s_add_u32 s12, s16, s53
  s_addc_u32 s13, s17, 0
  s_andn2_b32 s40, 4, s36
  v_and_b32 v3, 15, v2
  v_lshrrev_b32 v9, 4, v2
  v_lshrrev_b32 v1, 1, v3
  v_xor_b32 v1, v1, v9
  v_lshlrev_b32 v1, 4, v1
  v_lshl_add_u32 v144, v3, 7, v1
  s_lshl_b32 s54, s38, 13
  v_add_u32 v144, s54, v144
  v_xor_b32 v145, 64, v144
  v_lshlrev_b32 v1, 11, v9
  v_lshl_add_u32 v146, v3, 4, v1
  v_add_u32 v146, 32768, v146
  s_lshl_b32 s52, s36, 8
  s_lshl_b32 s53, s38, 6
  s_add_u32 s52, s52, s53
  s_mul_i32 s52, s52, 7168
  s_lshl_b32 s53, s37, 8
  s_add_u32 s52, s52, s53
  v_and_b32 v1, 1, v3
  v_lshl_add_u32 v1, v9, 2, v1
  v_mul_u32_u24 v1, 7168, v1
  v_lshrrev_b32 v147, 1, v3
  v_lshl_add_u32 v1, v147, 4, v1
  v_add_u32 v147, s52, v1
  v_lshrrev_b32 v20, 3, v2
  v_lshlrev_b32 v20, 11, v20
  v_lshrrev_b32 v1, 4, v2
  v_xor_b32 v1, v1, v2
  v_and_b32 v1, 7, v1
  v_lshl_add_u32 v20, v1, 4, v20
  s_lshl_b32 s52, s36, 19
  s_lshl_b32 s53, s39, 17
  s_add_u32 s53, s52, s53
  v_add_u32 v16, s53, v20
  v_xor_b32 v17, 64, v16
  v_add_u32 v18, 30720, v16
  v_add_u32 v19, 46080, v17
  v_add_u32 v17, 15360, v17
  s_lshl_b32 s60, s39, 13
  s_lshl_b32 s53, s37, 18
  s_lshl_b32 s54, s39, 12
  s_add_u32 s53, s53, s54
  v_lshl_add_u32 v20, v2, 4, s53
  s_add_u32 s61, s54, 32768
  s_lshl_b32 s53, s37, 13
  s_lshl_b32 s54, s39, 7
  s_add_u32 s53, s53, s54
  s_and_b32 s54, s36, 0
  s_lshl_b32 s54, s54, 7
  s_add_u32 s53, s53, s54
  s_add_u32 s53, s53, 7340032
  s_add_u32 s4, s28, s53
  s_addc_u32 s5, s29, 0
  s_lshl_b32 s41, s36, 7
  s_lshr_b32 s53, s38, 2
  s_lshl_b32 s54, s53, 16
  s_add_u32 s41, s41, s54
  s_lshl_b32 s53, s53, 12
  s_add_u32 m0, s60, s53
  s_waitcnt lgkmcnt(0)
  s_mul_i32 s8, s6, 1664525
  s_mul_i32 s9, s7, 22695477
  s_add_u32 s8, s8, 1013904223
  s_add_u32 s9, s9, 1
  v_mov_b32 v10, s8
  v_mov_b32 v11, s9
  s_waitcnt vmcnt(4)
  s_barrier
  s_waitcnt vmcnt(3)
  v_lshl_add_u32 v32, v32, 8, v5
  v_lshl_add_u32 v33, v33, 8, v5
  v_lshl_add_u32 v34, v34, 8, v5
  v_lshl_add_u32 v35, v35, 8, v5
  ds_read_u16 v96, v32 offset:0
  ds_read_u16 v97, v33 offset:2
  ds_read_u16 v98, v34 offset:128
  ds_read_u16 v99, v35 offset:130
  buffer_load_dwordx4 v16, s[16:19], s41 offen offset:0 lds
  s_waitcnt vmcnt(3)
  v_lshl_add_u32 v36, v36, 8, v5
  v_lshl_add_u32 v37, v37, 8, v5
  v_lshl_add_u32 v38, v38, 8, v5
  v_lshl_add_u32 v39, v39, 8, v5
  ds_read_u16 v100, v36 offset:0
  ds_read_u16 v101, v37 offset:2
  ds_read_u16 v102, v38 offset:128
  ds_read_u16 v103, v39 offset:130
  buffer_load_dwordx4 v17, s[16:19], s41 offen offset:1024 lds
  s_waitcnt vmcnt(3)
  v_lshl_add_u32 v40, v40, 8, v5
  v_lshl_add_u32 v41, v41, 8, v5
  v_lshl_add_u32 v42, v42, 8, v5
  v_lshl_add_u32 v43, v43, 8, v5
  ds_read_u16 v104, v40 offset:0
  ds_read_u16 v105, v41 offset:2
  ds_read_u16 v106, v42 offset:128
  ds_read_u16 v107, v43 offset:130
  buffer_load_dwordx4 v18, s[16:19], s41 offen offset:2048 lds
  s_waitcnt vmcnt(3)
  v_lshl_add_u32 v44, v44, 8, v5
  v_lshl_add_u32 v45, v45, 8, v5
  v_lshl_add_u32 v46, v46, 8, v5
  v_lshl_add_u32 v47, v47, 8, v5
  ds_read_u16 v108, v44 offset:0
  ds_read_u16 v109, v45 offset:2
  ds_read_u16 v110, v46 offset:128
  ds_read_u16 v111, v47 offset:130
  buffer_load_dwordx4 v19, s[16:19], s41 offen offset:3072 lds
  s_waitcnt lgkmcnt(8)
  v_lshl_or_b32 v112, v100, 16, v96
  v_lshl_or_b32 v114, v101, 16, v97
  v_lshl_or_b32 v116, v102, 16, v98
  v_lshl_or_b32 v118, v103, 16, v99
  s_waitcnt lgkmcnt(3)
  v_lshl_or_b32 v113, v108, 16, v104
  ds_write_b64 v6, v[112:113] offset:0
  s_waitcnt lgkmcnt(3)
  v_lshl_or_b32 v115, v109, 16, v105
  ds_write_b64 v6, v[114:115] offset:256
  s_waitcnt lgkmcnt(3)
  v_lshl_or_b32 v117, v110, 16, v106
  ds_write_b64 v6, v[116:117] offset:512
  s_waitcnt lgkmcnt(3)
  v_lshl_or_b32 v119, v111, 16, v107
  ds_write_b64 v6, v[118:119] offset:768
  s_waitcnt lgkmcnt(0)
  ds_read_b128 v[148:151], v7 offset:0
  ds_read_b128 v[152:155], v7 offset:1024
  s_waitcnt lgkmcnt(1)
  buffer_store_dwordx4 v[148:151], v8, s[28:31], 0 offen offset:0 sc1
  s_waitcnt lgkmcnt(0)
  buffer_store_dwordx4 v[152:155], v8, s[28:31], 0 offen offset:1024 sc1
  s_cmp_ge_u32 s38, 4
  s_cbranch_scc1 L_loader
  s_add_u32 s58, s40, 0
  s_lshl_b32 s58, s58, 7
  s_load_dword s92, s[12:13], s58 offset:0
  s_load_dword s93, s[12:13], s58 offset:64
  s_load_dword s94, s[12:13], s58 offset:2048
  s_load_dword s95, s[12:13], s58 offset:2112
  s_load_dword s96, s[12:13], s58 offset:4096
  s_load_dword s97, s[12:13], s58 offset:4160
  s_add_u32 s58, s40, 1
  s_lshl_b32 s58, s58, 7
  s_load_dword s92, s[12:13], s58 offset:0
  s_load_dword s93, s[12:13], s58 offset:64
  s_load_dword s94, s[12:13], s58 offset:2048
  s_load_dword s95, s[12:13], s58 offset:2112
  s_load_dword s96, s[12:13], s58 offset:4096
  s_load_dword s97, s[12:13], s58 offset:4160
  v_mov_b32 v5, v144
  v_mov_b32 v6, v145
  v_mov_b32 v7, v146
  v_mov_b32 v16, 0
  v_mov_b32 v17, 0
  v_mov_b32 v18, 0
  v_mov_b32 v19, 0
  v_mov_b32 v20, 0
  v_mov_b32 v21, 0
  v_mov_b32 v22, 0
  v_mov_b32 v23, 0
  v_mov_b32 v24, 0
  v_mov_b32 v25, 0
  v_mov_b32 v26, 0
  v_mov_b32 v27, 0
  v_mov_b32 v28, 0
  v_mov_b32 v29, 0
  v_mov_b32 v30, 0
  v_mov_b32 v31, 0
  v_mov_b32 v32, 0
  v_mov_b32 v33, 0
  v_mov_b32 v34, 0
  v_mov_b32 v35, 0
  v_mov_b32 v36, 0
  v_mov_b32 v37, 0
  v_mov_b32 v38, 0
  v_mov_b32 v39, 0
  v_mov_b32 v40, 0
  v_mov_b32 v41, 0
  v_mov_b32 v42, 0
  v_mov_b32 v43, 0
  v_mov_b32 v44, 0
  v_mov_b32 v45, 0
  v_mov_b32 v46, 0
  v_mov_b32 v47, 0
  v_mov_b32 v48, 0
  v_mov_b32 v49, 0
  v_mov_b32 v50, 0
  v_mov_b32 v51, 0
  v_mov_b32 v52, 0
  v_mov_b32 v53, 0
  v_mov_b32 v54, 0
  v_mov_b32 v55, 0
  v_mov_b32 v56, 0
  v_mov_b32 v57, 0
  v_mov_b32 v58, 0
  v_mov_b32 v59, 0
  v_mov_b32 v60, 0
  v_mov_b32 v61, 0
  v_mov_b32 v62, 0
  v_mov_b32 v63, 0
  v_mov_b32 v64, 0
  v_mov_b32 v65, 0
  v_mov_b32 v66, 0
  v_mov_b32 v67, 0
  v_mov_b32 v68, 0
  v_mov_b32 v69, 0
  v_mov_b32 v70, 0
  v_mov_b32 v71, 0
  v_mov_b32 v72, 0
  v_mov_b32 v73, 0
  v_mov_b32 v74, 0
  v_mov_b32 v75, 0
  v_mov_b32 v76, 0
  v_mov_b32 v77, 0
  v_mov_b32 v78, 0
  v_mov_b32 v79, 0
  v_mov_b32 v80, 0
  v_mov_b32 v81, 0
  v_mov_b32 v82, 0
  v_mov_b32 v83, 0
  v_mov_b32 v84, 0
  v_mov_b32 v85, 0
  v_mov_b32 v86, 0
  v_mov_b32 v87, 0
  v_mov_b32 v88, 0
  v_mov_b32 v89, 0
  v_mov_b32 v90, 0
  v_mov_b32 v91, 0
  v_mov_b32 v92, 0
  v_mov_b32 v93, 0
  v_mov_b32 v94, 0
  v_mov_b32 v95, 0
  v_mov_b32 v96, 0
  v_mov_b32 v97, 0
  v_mov_b32 v98, 0
  v_mov_b32 v99, 0
  v_mov_b32 v100, 0
  v_mov_b32 v101, 0
  v_mov_b32 v102, 0
  v_mov_b32 v103, 0
  v_mov_b32 v104, 0
  v_mov_b32 v105, 0
  v_mov_b32 v106, 0
  v_mov_b32 v107, 0
  v_mov_b32 v108, 0
  v_mov_b32 v109, 0
  v_mov_b32 v110, 0
  v_mov_b32 v111, 0
  v_mov_b32 v112, 0
  v_mov_b32 v113, 0
  v_mov_b32 v114, 0
  v_mov_b32 v115, 0
  v_mov_b32 v116, 0
  v_mov_b32 v117, 0
  v_mov_b32 v118, 0
  v_mov_b32 v119, 0
  v_mov_b32 v120, 0
  v_mov_b32 v121, 0
  v_mov_b32 v122, 0
  v_mov_b32 v123, 0
  v_mov_b32 v124, 0
  v_mov_b32 v125, 0
  v_mov_b32 v126, 0
  v_mov_b32 v127, 0
  v_mov_b32 v128, 0
  v_mov_b32 v129, 0
  v_mov_b32 v130, 0
  v_mov_b32 v131, 0
  v_mov_b32 v132, 0
  v_mov_b32 v133, 0
  v_mov_b32 v134, 0
  v_mov_b32 v135, 0
  v_mov_b32 v136, 0
  v_mov_b32 v137, 0
  v_mov_b32 v138, 0
  v_mov_b32 v139, 0
  v_mov_b32 v140, 0
  v_mov_b32 v141, 0
  v_mov_b32 v142, 0
  v_mov_b32 v143, 0
  s_waitcnt vmcnt(0)
  s_mov_b64 exec, 1
  buffer_store_dwordx2 v[10:11], v14, s[28:31], 0 offen sc1
  s_mov_b64 exec, -1
  s_mov_b32 s44, 0
  s_mov_b32 s45, 7168
  s_mov_b32 s46, 14336
  s_mov_b32 s47, 21504
  s_mov_b32 s48, 114688
  s_mov_b32 s49, 121856
  s_mov_b32 s50, 129024
  s_mov_b32 s51, 136192
  s_mov_b32 s52, 229376
  s_mov_b32 s53, 236544
  s_mov_b32 s54, 243712
  s_mov_b32 s55, 250880
  s_mov_b32 s56, 344064
  s_mov_b32 s57, 351232
  s_mov_b32 s58, 358400
  s_mov_b32 s59, 365568
  s_mov_b32 s60, 0
  s_mov_b32 s61, 0
  s_mov_b32 s60, 49152
  s_mov_b32 s61, 5
  s_mov_b32 s62, 49152
  s_lshl_b32 s63, s38, 12
  s_sub_u32 s63, 147456, s63
  s_mov_b32 vcc_lo, 0x55555555
  s_mov_b32 vcc_hi, 0x55555555
  s_barrier
  ds_read_b128 a[64:67], v7 offset:0
  ds_read_b128 a[68:71], v7 offset:8192
  ds_read_b128 a[0:3], v5 offset:0
  ds_read_b128 a[4:7], v6 offset:0
  ds_read_b128 a[8:11], v5 offset:2048
  ds_read_b128 a[12:15], v6 offset:2048
  ds_read_b128 a[16:19], v5 offset:4096
  ds_read_b128 a[72:75], v7 offset:256
  ds_read_b128 a[76:79], v7 offset:8448
  ds_read_b128 a[20:23], v6 offset:4096
  ds_read_b128 a[24:27], v5 offset:6144
  ds_read_b128 a[28:31], v6 offset:6144
  ds_read_b128 a[80:83], v7 offset:512
  ds_read_b128 a[84:87], v7 offset:8704
  s_cmp_eq_u32 s38, 0
  s_cbranch_scc0 L_c0
  s_lshl_b32 s3, s2, 6
  s_add_u32 s3, s3, 9441280
  v_mov_b32 v12, s3
  s_mov_b64 exec, 1
  buffer_store_dwordx2 v[10:11], v12, s[28:31], 0 offen sc1
  s_mov_b64 exec, -1
L_c0:
  s_waitcnt lgkmcnt(0)
.p2align 6
L_c:
  v_mfma_f32_16x16x32_bf16 v[16:19], a[0:3], a[64:67], v[16:19]
  ds_read_b128 a[88:91], v7 offset:768
  v_mfma_f32_16x16x32_bf16 v[16:19], a[4:7], a[68:71], v[16:19]
  ds_read_b128 a[92:95], v7 offset:8960
  v_mfma_f32_16x16x32_bf16 v[48:51], a[8:11], a[64:67], v[48:51]
  v_mfma_f32_16x16x32_bf16 v[48:51], a[12:15], a[68:71], v[48:51]
  s_cmp_eq_u32 s60, 147456
  v_mfma_f32_16x16x32_bf16 v[80:83], a[16:19], a[64:67], v[80:83]
  v_mfma_f32_16x16x32_bf16 v[80:83], a[20:23], a[68:71], v[80:83]
  s_cselect_b32 s60, 0, s60
  v_add_u32 v1, s60, v146
  v_mfma_f32_16x16x32_bf16 v[112:115], a[24:27], a[64:67], v[112:115]
  v_mfma_f32_16x16x32_bf16 v[112:115], a[28:31], a[68:71], v[112:115]
  v_mfma_f32_16x16x32_bf16 v[20:23], a[0:3], a[72:75], v[20:23]
  ds_read_b128 a[64:67], v7 offset:1024
  v_mfma_f32_16x16x32_bf16 v[20:23], a[4:7], a[76:79], v[20:23]
  ds_read_b128 a[68:71], v7 offset:9216
  v_mfma_f32_16x16x32_bf16 v[52:55], a[8:11], a[72:75], v[52:55]
  v_mfma_f32_16x16x32_bf16 v[52:55], a[12:15], a[76:79], v[52:55]
  v_mfma_f32_16x16x32_bf16 v[84:87], a[16:19], a[72:75], v[84:87]
  v_mfma_f32_16x16x32_bf16 v[84:87], a[20:23], a[76:79], v[84:87]
  v_mfma_f32_16x16x32_bf16 v[116:119], a[24:27], a[72:75], v[116:119]
  v_mfma_f32_16x16x32_bf16 v[116:119], a[28:31], a[76:79], v[116:119]
  v_mfma_f32_16x16x32_bf16 v[24:27], a[0:3], a[80:83], v[24:27]
  ds_read_b128 a[72:75], v7 offset:1280
  v_mfma_f32_16x16x32_bf16 v[24:27], a[4:7], a[84:87], v[24:27]
  ds_read_b128 a[76:79], v7 offset:9472
  v_mfma_f32_16x16x32_bf16 v[56:59], a[8:11], a[80:83], v[56:59]
  v_mfma_f32_16x16x32_bf16 v[56:59], a[12:15], a[84:87], v[56:59]
  v_mfma_f32_16x16x32_bf16 v[88:91], a[16:19], a[80:83], v[88:91]
  v_mfma_f32_16x16x32_bf16 v[88:91], a[20:23], a[84:87], v[88:91]
  v_mfma_f32_16x16x32_bf16 v[120:123], a[24:27], a[80:83], v[120:123]
  v_mfma_f32_16x16x32_bf16 v[120:123], a[28:31], a[84:87], v[120:123]
  v_add_u32 v3, s60, v144
  s_waitcnt lgkmcnt(0)
  v_mfma_f32_16x16x32_bf16 v[28:31], a[0:3], a[88:91], v[28:31]
  ds_read_b128 a[80:83], v7 offset:1536
  v_mfma_f32_16x16x32_bf16 v[28:31], a[4:7], a[92:95], v[28:31]
  ds_read_b128 a[84:87], v7 offset:9728
  v_mfma_f32_16x16x32_bf16 v[60:63], a[8:11], a[88:91], v[60:63]
  v_mfma_f32_16x16x32_bf16 v[60:63], a[12:15], a[92:95], v[60:63]
  v_add_u32_e64 v4, s60, v145
  v_mfma_f32_16x16x32_bf16 v[92:95], a[16:19], a[88:91], v[92:95]
  v_mfma_f32_16x16x32_bf16 v[92:95], a[20:23], a[92:95], v[92:95]
  v_mfma_f32_16x16x32_bf16 v[124:127], a[24:27], a[88:91], v[124:127]
  v_mfma_f32_16x16x32_bf16 v[124:127], a[28:31], a[92:95], v[124:127]
  v_mfma_f32_16x16x32_bf16 v[32:35], a[0:3], a[64:67], v[32:35]
  ds_read_b128 a[88:91], v7 offset:1792
  v_mfma_f32_16x16x32_bf16 v[32:35], a[4:7], a[68:71], v[32:35]
  ds_read_b128 a[92:95], v7 offset:9984
  v_mfma_f32_16x16x32_bf16 v[64:67], a[8:11], a[64:67], v[64:67]
  v_mfma_f32_16x16x32_bf16 v[64:67], a[12:15], a[68:71], v[64:67]
  v_mfma_f32_16x16x32_bf16 v[96:99], a[16:19], a[64:67], v[96:99]
  v_mfma_f32_16x16x32_bf16 v[96:99], a[20:23], a[68:71], v[96:99]
  v_mfma_f32_16x16x32_bf16 v[128:131], a[24:27], a[64:67], v[128:131]
  v_mfma_f32_16x16x32_bf16 v[128:131], a[28:31], a[68:71], v[128:131]
  s_waitcnt lgkmcnt(0)
  s_barrier
  v_mfma_f32_16x16x32_bf16 v[36:39], a[0:3], a[72:75], v[36:39]
  ds_read_b128 a[64:67], v1 offset:0
  v_mfma_f32_16x16x32_bf16 v[36:39], a[4:7], a[76:79], v[36:39]
  ds_read_b128 a[68:71], v1 offset:8192
  v_mfma_f32_16x16x32_bf16 v[68:71], a[8:11], a[72:75], v[68:71]
  ds_read_b128 a[32:35], v3 offset:0
  v_mfma_f32_16x16x32_bf16 v[68:71], a[12:15], a[76:79], v[68:71]
  ds_read_b128 a[36:39], v4 offset:0
  v_mfma_f32_16x16x32_bf16 v[100:103], a[16:19], a[72:75], v[100:103]
  ds_read_b128 a[40:43], v3 offset:2048
  v_mfma_f32_16x16x32_bf16 v[100:103], a[20:23], a[76:79], v[100:103]
  ds_read_b128 a[44:47], v4 offset:2048
  v_mfma_f32_16x16x32_bf16 v[132:135], a[24:27], a[72:75], v[132:135]
  v_mfma_f32_16x16x32_bf16 v[132:135], a[28:31], a[76:79], v[132:135]
  ds_read_b128 a[48:51], v3 offset:4096
  v_mfma_f32_16x16x32_bf16 v[40:43], a[0:3], a[80:83], v[40:43]
  ds_read_b128 a[72:75], v1 offset:256
  v_mfma_f32_16x16x32_bf16 v[40:43], a[4:7], a[84:87], v[40:43]
  ds_read_b128 a[76:79], v1 offset:8448
  v_mfma_f32_16x16x32_bf16 v[72:75], a[8:11], a[80:83], v[72:75]
  v_mfma_f32_16x16x32_bf16 v[72:75], a[12:15], a[84:87], v[72:75]
  ds_read_b128 a[52:55], v4 offset:4096
  v_mfma_f32_16x16x32_bf16 v[104:107], a[16:19], a[80:83], v[104:107]
  v_mfma_f32_16x16x32_bf16 v[104:107], a[20:23], a[84:87], v[104:107]
  ds_read_b128 a[56:59], v3 offset:6144
  v_mfma_f32_16x16x32_bf16 v[136:139], a[24:27], a[80:83], v[136:139]
  v_mfma_f32_16x16x32_bf16 v[136:139], a[28:31], a[84:87], v[136:139]
  ds_read_b128 a[60:63], v4 offset:6144
  v_mfma_f32_16x16x32_bf16 v[44:47], a[0:3], a[88:91], v[44:47]
  ds_read_b128 a[80:83], v1 offset:512
  v_mfma_f32_16x16x32_bf16 v[44:47], a[4:7], a[92:95], v[44:47]
  ds_read_b128 a[84:87], v1 offset:8704
  v_mfma_f32_16x16x32_bf16 v[76:79], a[8:11], a[88:91], v[76:79]
  v_mfma_f32_16x16x32_bf16 v[76:79], a[12:15], a[92:95], v[76:79]
  v_mfma_f32_16x16x32_bf16 v[108:111], a[16:19], a[88:91], v[108:111]
  v_mfma_f32_16x16x32_bf16 v[108:111], a[20:23], a[92:95], v[108:111]
  v_mfma_f32_16x16x32_bf16 v[140:143], a[24:27], a[88:91], v[140:143]
  v_mfma_f32_16x16x32_bf16 v[140:143], a[28:31], a[92:95], v[140:143]
  s_add_u32 s60, s60, s62
  s_waitcnt lgkmcnt(0)
  v_mfma_f32_16x16x32_bf16 v[16:19], a[32:35], a[64:67], v[16:19]
  ds_read_b128 a[88:91], v1 offset:768
  v_mfma_f32_16x16x32_bf16 v[16:19], a[36:39], a[68:71], v[16:19]
  ds_read_b128 a[92:95], v1 offset:8960
  v_mfma_f32_16x16x32_bf16 v[48:51], a[40:43], a[64:67], v[48:51]
  v_mfma_f32_16x16x32_bf16 v[48:51], a[44:47], a[68:71], v[48:51]
  s_cmp_eq_u32 s60, 147456
  v_mfma_f32_16x16x32_bf16 v[80:83], a[48:51], a[64:67], v[80:83]
  v_mfma_f32_16x16x32_bf16 v[80:83], a[52:55], a[68:71], v[80:83]
  s_cselect_b32 s60, 0, s60
  v_add_u32 v7, s60, v146
  v_mfma_f32_16x16x32_bf16 v[112:115], a[56:59], a[64:67], v[112:115]
  v_mfma_f32_16x16x32_bf16 v[112:115], a[60:63], a[68:71], v[112:115]
  v_mfma_f32_16x16x32_bf16 v[20:23], a[32:35], a[72:75], v[20:23]
  ds_read_b128 a[64:67], v1 offset:1024
  v_mfma_f32_16x16x32_bf16 v[20:23], a[36:39], a[76:79], v[20:23]
  ds_read_b128 a[68:71], v1 offset:9216
  v_mfma_f32_16x16x32_bf16 v[52:55], a[40:43], a[72:75], v[52:55]
  v_mfma_f32_16x16x32_bf16 v[52:55], a[44:47], a[76:79], v[52:55]
  v_mfma_f32_16x16x32_bf16 v[84:87], a[48:51], a[72:75], v[84:87]
  v_mfma_f32_16x16x32_bf16 v[84:87], a[52:55], a[76:79], v[84:87]
  v_mfma_f32_16x16x32_bf16 v[116:119], a[56:59], a[72:75], v[116:119]
  v_mfma_f32_16x16x32_bf16 v[116:119], a[60:63], a[76:79], v[116:119]
  v_mfma_f32_16x16x32_bf16 v[24:27], a[32:35], a[80:83], v[24:27]
  ds_read_b128 a[72:75], v1 offset:1280
  v_mfma_f32_16x16x32_bf16 v[24:27], a[36:39], a[84:87], v[24:27]
  ds_read_b128 a[76:79], v1 offset:9472
  v_mfma_f32_16x16x32_bf16 v[56:59], a[40:43], a[80:83], v[56:59]
  v_mfma_f32_16x16x32_bf16 v[56:59], a[44:47], a[84:87], v[56:59]
  v_mfma_f32_16x16x32_bf16 v[88:91], a[48:51], a[80:83], v[88:91]
  v_mfma_f32_16x16x32_bf16 v[88:91], a[52:55], a[84:87], v[88:91]
  v_mfma_f32_16x16x32_bf16 v[120:123], a[56:59], a[80:83], v[120:123]
  v_mfma_f32_16x16x32_bf16 v[120:123], a[60:63], a[84:87], v[120:123]
  v_add_u32 v5, s60, v144
  s_waitcnt lgkmcnt(0)
  v_mfma_f32_16x16x32_bf16 v[28:31], a[32:35], a[88:91], v[28:31]
  ds_read_b128 a[80:83], v1 offset:1536
  v_mfma_f32_16x16x32_bf16 v[28:31], a[36:39], a[92:95], v[28:31]
  ds_read_b128 a[84:87], v1 offset:9728
  v_mfma_f32_16x16x32_bf16 v[60:63], a[40:43], a[88:91], v[60:63]
  v_mfma_f32_16x16x32_bf16 v[60:63], a[44:47], a[92:95], v[60:63]
  v_add_u32_e64 v6, s60, v145
  v_mfma_f32_16x16x32_bf16 v[92:95], a[48:51], a[88:91], v[92:95]
  v_mfma_f32_16x16x32_bf16 v[92:95], a[52:55], a[92:95], v[92:95]
  v_mfma_f32_16x16x32_bf16 v[124:127], a[56:59], a[88:91], v[124:127]
  v_mfma_f32_16x16x32_bf16 v[124:127], a[60:63], a[92:95], v[124:127]
  v_mfma_f32_16x16x32_bf16 v[32:35], a[32:35], a[64:67], v[32:35]
  ds_read_b128 a[88:91], v1 offset:1792
  v_mfma_f32_16x16x32_bf16 v[32:35], a[36:39], a[68:71], v[32:35]
  ds_read_b128 a[92:95], v1 offset:9984
  v_mfma_f32_16x16x32_bf16 v[64:67], a[40:43], a[64:67], v[64:67]
  v_mfma_f32_16x16x32_bf16 v[64:67], a[44:47], a[68:71], v[64:67]
  v_mfma_f32_16x16x32_bf16 v[96:99], a[48:51], a[64:67], v[96:99]
  v_mfma_f32_16x16x32_bf16 v[96:99], a[52:55], a[68:71], v[96:99]
  v_mfma_f32_16x16x32_bf16 v[128:131], a[56:59], a[64:67], v[128:131]
  v_mfma_f32_16x16x32_bf16 v[128:131], a[60:63], a[68:71], v[128:131]
  s_waitcnt lgkmcnt(0)
  s_barrier
  v_mfma_f32_16x16x32_bf16 v[36:39], a[32:35], a[72:75], v[36:39]
  ds_read_b128 a[64:67], v7 offset:0
  v_mfma_f32_16x16x32_bf16 v[36:39], a[36:39], a[76:79], v[36:39]
  ds_read_b128 a[68:71], v7 offset:8192
  v_mfma_f32_16x16x32_bf16 v[68:71], a[40:43], a[72:75], v[68:71]
  ds_read_b128 a[0:3], v5 offset:0
  v_mfma_f32_16x16x32_bf16 v[68:71], a[44:47], a[76:79], v[68:71]
  ds_read_b128 a[4:7], v6 offset:0
  v_mfma_f32_16x16x32_bf16 v[100:103], a[48:51], a[72:75], v[100:103]
  ds_read_b128 a[8:11], v5 offset:2048
  v_mfma_f32_16x16x32_bf16 v[100:103], a[52:55], a[76:79], v[100:103]
  ds_read_b128 a[12:15], v6 offset:2048
  v_mfma_f32_16x16x32_bf16 v[132:135], a[56:59], a[72:75], v[132:135]
  v_mfma_f32_16x16x32_bf16 v[132:135], a[60:63], a[76:79], v[132:135]
  ds_read_b128 a[16:19], v5 offset:4096
  v_mfma_f32_16x16x32_bf16 v[40:43], a[32:35], a[80:83], v[40:43]
  ds_read_b128 a[72:75], v7 offset:256
  v_mfma_f32_16x16x32_bf16 v[40:43], a[36:39], a[84:87], v[40:43]
  ds_read_b128 a[76:79], v7 offset:8448
  v_mfma_f32_16x16x32_bf16 v[72:75], a[40:43], a[80:83], v[72:75]
  v_mfma_f32_16x16x32_bf16 v[72:75], a[44:47], a[84:87], v[72:75]
  ds_read_b128 a[20:23], v6 offset:4096
  v_mfma_f32_16x16x32_bf16 v[104:107], a[48:51], a[80:83], v[104:107]
  v_mfma_f32_16x16x32_bf16 v[104:107], a[52:55], a[84:87], v[104:107]
  ds_read_b128 a[24:27], v5 offset:6144
  v_mfma_f32_16x16x32_bf16 v[136:139], a[56:59], a[80:83], v[136:139]
  v_mfma_f32_16x16x32_bf16 v[136:139], a[60:63], a[84:87], v[136:139]
  ds_read_b128 a[28:31], v6 offset:6144
  v_mfma_f32_16x16x32_bf16 v[44:47], a[32:35], a[88:91], v[44:47]
  ds_read_b128 a[80:83], v7 offset:512
  v_mfma_f32_16x16x32_bf16 v[44:47], a[36:39], a[92:95], v[44:47]
  ds_read_b128 a[84:87], v7 offset:8704
  v_mfma_f32_16x16x32_bf16 v[76:79], a[40:43], a[88:91], v[76:79]
  v_mfma_f32_16x16x32_bf16 v[76:79], a[44:47], a[92:95], v[76:79]
  v_mfma_f32_16x16x32_bf16 v[108:111], a[48:51], a[88:91], v[108:111]
  v_mfma_f32_16x16x32_bf16 v[108:111], a[52:55], a[92:95], v[108:111]
  v_mfma_f32_16x16x32_bf16 v[140:143], a[56:59], a[88:91], v[140:143]
  s_add_u32 s60, s60, s62
  s_sub_u32 s61, s61, 1
  v_mfma_f32_16x16x32_bf16 v[140:143], a[60:63], a[92:95], v[140:143]
  s_waitcnt lgkmcnt(0)
  s_cbranch_scc0 L_c
  v_mfma_f32_16x16x32_bf16 v[16:19], a[0:3], a[64:67], v[16:19]
  ds_read_b128 a[88:91], v7 offset:768
  v_mfma_f32_16x16x32_bf16 v[16:19], a[4:7], a[68:71], v[16:19]
  ds_read_b128 a[92:95], v7 offset:8960
  v_mfma_f32_16x16x32_bf16 v[48:51], a[8:11], a[64:67], v[48:51]
  v_mfma_f32_16x16x32_bf16 v[48:51], a[12:15], a[68:71], v[48:51]
  v_mfma_f32_16x16x32_bf16 v[80:83], a[16:19], a[64:67], v[80:83]
  v_mfma_f32_16x16x32_bf16 v[80:83], a[20:23], a[68:71], v[80:83]
  v_add_u32 v8, 49152, v144
  v_mfma_f32_16x16x32_bf16 v[112:115], a[24:27], a[64:67], v[112:115]
  v_mfma_f32_16x16x32_bf16 v[112:115], a[28:31], a[68:71], v[112:115]
  v_add_u32 v9, 49152, v145
  v_mfma_f32_16x16x32_bf16 v[20:23], a[0:3], a[72:75], v[20:23]
  ds_read_b128 a[64:67], v7 offset:1024
  v_mfma_f32_16x16x32_bf16 v[20:23], a[4:7], a[76:79], v[20:23]
  ds_read_b128 a[68:71], v7 offset:9216
  v_mfma_f32_16x16x32_bf16 v[52:55], a[8:11], a[72:75], v[52:55]
  v_mfma_f32_16x16x32_bf16 v[52:55], a[12:15], a[76:79], v[52:55]
  v_mfma_f32_16x16x32_bf16 v[84:87], a[16:19], a[72:75], v[84:87]
  v_mfma_f32_16x16x32_bf16 v[84:87], a[20:23], a[76:79], v[84:87]
  v_add_u32 v10, 49152, v146
  v_mfma_f32_16x16x32_bf16 v[116:119], a[24:27], a[72:75], v[116:119]
  v_mfma_f32_16x16x32_bf16 v[116:119], a[28:31], a[76:79], v[116:119]
  v_mfma_f32_16x16x32_bf16 v[24:27], a[0:3], a[80:83], v[24:27]
  v_add_u32 v11, 98304, v144
  v_mfma_f32_16x16x32_bf16 v[24:27], a[4:7], a[84:87], v[24:27]
  ds_read_b128 a[72:75], v7 offset:1280
  ds_read_b128 a[76:79], v7 offset:9472
  v_mfma_f32_16x16x32_bf16 v[56:59], a[8:11], a[80:83], v[56:59]
  v_mfma_f32_16x16x32_bf16 v[56:59], a[12:15], a[84:87], v[56:59]
  v_add_u32 v12, 98304, v145
  v_mfma_f32_16x16x32_bf16 v[88:91], a[16:19], a[80:83], v[88:91]
  v_mfma_f32_16x16x32_bf16 v[88:91], a[20:23], a[84:87], v[88:91]
  v_mfma_f32_16x16x32_bf16 v[120:123], a[24:27], a[80:83], v[120:123]
  v_mfma_f32_16x16x32_bf16 v[120:123], a[28:31], a[84:87], v[120:123]
  s_waitcnt lgkmcnt(0)
  s_nop 0
  v_mfma_f32_16x16x32_bf16 v[28:31], a[0:3], a[88:91], v[28:31]
  v_add_u32 v13, 98304, v146
  v_mfma_f32_16x16x32_bf16 v[28:31], a[4:7], a[92:95], v[28:31]
  ds_read_b128 a[80:83], v7 offset:1536
  ds_read_b128 a[84:87], v7 offset:9728
  v_mfma_f32_16x16x32_bf16 v[60:63], a[8:11], a[88:91], v[60:63]
  v_mfma_f32_16x16x32_bf16 v[60:63], a[12:15], a[92:95], v[60:63]
  v_mfma_f32_16x16x32_bf16 v[92:95], a[16:19], a[88:91], v[92:95]
  v_mfma_f32_16x16x32_bf16 v[92:95], a[20:23], a[92:95], v[92:95]
  v_add_u32_e64 v14, s63, v144
  v_mfma_f32_16x16x32_bf16 v[124:127], a[24:27], a[88:91], v[124:127]
  v_mfma_f32_16x16x32_bf16 v[124:127], a[28:31], a[92:95], v[124:127]
  v_add_u32_e64 v15, s63, v145
  v_mfma_f32_16x16x32_bf16 v[32:35], a[0:3], a[64:67], v[32:35]
  ds_read_b128 a[88:91], v7 offset:1792
  v_mfma_f32_16x16x32_bf16 v[32:35], a[4:7], a[68:71], v[32:35]
  ds_read_b128 a[92:95], v7 offset:9984
  v_mfma_f32_16x16x32_bf16 v[64:67], a[8:11], a[64:67], v[64:67]
  v_mfma_f32_16x16x32_bf16 v[64:67], a[12:15], a[68:71], v[64:67]
  v_mfma_f32_16x16x32_bf16 v[96:99], a[16:19], a[64:67], v[96:99]
  v_mfma_f32_16x16x32_bf16 v[96:99], a[20:23], a[68:71], v[96:99]
  v_mfma_f32_16x16x32_bf16 v[128:131], a[24:27], a[64:67], v[128:131]
  v_mfma_f32_16x16x32_bf16 v[128:131], a[28:31], a[68:71], v[128:131]
  s_waitcnt lgkmcnt(0)
  s_barrier
  v_mfma_f32_16x16x32_bf16 v[36:39], a[0:3], a[72:75], v[36:39]
  v_mfma_f32_16x16x32_bf16 v[36:39], a[4:7], a[76:79], v[36:39]
  v_mfma_f32_16x16x32_bf16 v[68:71], a[8:11], a[72:75], v[68:71]
  v_mfma_f32_16x16x32_bf16 v[68:71], a[12:15], a[76:79], v[68:71]
  v_mfma_f32_16x16x32_bf16 v[100:103], a[16:19], a[72:75], v[100:103]
  v_mfma_f32_16x16x32_bf16 v[100:103], a[20:23], a[76:79], v[100:103]
  v_mfma_f32_16x16x32_bf16 v[132:135], a[24:27], a[72:75], v[132:135]
  v_mfma_f32_16x16x32_bf16 v[132:135], a[28:31], a[76:79], v[132:135]
  v_mfma_f32_16x16x32_bf16 v[40:43], a[0:3], a[80:83], v[40:43]
  ds_read_b128 a[32:35], v10 offset:0
  v_mfma_f32_16x16x32_bf16 v[40:43], a[4:7], a[84:87], v[40:43]
  ds_read_b128 a[36:39], v8 offset:0
  v_mfma_f32_16x16x32_bf16 v[72:75], a[8:11], a[80:83], v[72:75]
  ds_read_b128 a[40:43], v8 offset:2048
  v_mfma_f32_16x16x32_bf16 v[72:75], a[12:15], a[84:87], v[72:75]
  ds_read_b128 a[44:47], v10 offset:256
  v_mfma_f32_16x16x32_bf16 v[104:107], a[16:19], a[80:83], v[104:107]
  ds_read_b128 a[48:51], v10 offset:512
  v_mfma_f32_16x16x32_bf16 v[104:107], a[20:23], a[84:87], v[104:107]
  ds_read_b128 a[52:55], v10 offset:768
  v_mfma_f32_16x16x32_bf16 v[136:139], a[24:27], a[80:83], v[136:139]
  v_mfma_f32_16x16x32_bf16 v[136:139], a[28:31], a[84:87], v[136:139]
  v_mfma_f32_16x16x32_bf16 v[44:47], a[0:3], a[88:91], v[44:47]
  ds_read_b128 a[56:59], v10 offset:8192
  v_mfma_f32_16x16x32_bf16 v[44:47], a[4:7], a[92:95], v[44:47]
  ds_read_b128 a[60:63], v9 offset:0
  v_mfma_f32_16x16x32_bf16 v[76:79], a[8:11], a[88:91], v[76:79]
  ds_read_b128 a[64:67], v9 offset:2048
  v_mfma_f32_16x16x32_bf16 v[76:79], a[12:15], a[92:95], v[76:79]
  ds_read_b128 a[68:71], v10 offset:8448
  v_mfma_f32_16x16x32_bf16 v[108:111], a[16:19], a[88:91], v[108:111]
  ds_read_b128 a[72:75], v10 offset:8704
  v_mfma_f32_16x16x32_bf16 v[108:111], a[20:23], a[92:95], v[108:111]
  ds_read_b128 a[76:79], v10 offset:8960
  v_mfma_f32_16x16x32_bf16 v[140:143], a[24:27], a[88:91], v[140:143]
  v_mfma_f32_16x16x32_bf16 v[140:143], a[28:31], a[92:95], v[140:143]
  s_waitcnt lgkmcnt(4)
  s_nop 0
  v_mfma_f32_16x16x32_bf16 v[16:19], a[36:39], a[32:35], v[16:19]
  s_barrier
  ds_read_b128 a[80:83], v13 offset:0
  ds_read_b128 a[84:87], v11 offset:0
  s_nop 0
  v_mfma_f32_16x16x32_bf16 v[48:51], a[40:43], a[32:35], v[48:51]
  ds_read_b128 a[0:3], v11 offset:2048
  ds_read_b128 a[4:7], v13 offset:256
  v_mfma_f32_16x16x32_bf16 v[20:23], a[36:39], a[44:47], v[20:23]
  ds_read_b128 a[8:11], v13 offset:512
  ds_read_b128 a[12:15], v13 offset:768
  v_mfma_f32_16x16x32_bf16 v[52:55], a[40:43], a[44:47], v[52:55]
  v_mfma_f32_16x16x32_bf16 v[24:27], a[36:39], a[48:51], v[24:27]
  v_mfma_f32_16x16x32_bf16 v[56:59], a[40:43], a[48:51], v[56:59]
  v_mfma_f32_16x16x32_bf16 v[28:31], a[36:39], a[52:55], v[28:31]
  v_mfma_f32_16x16x32_bf16 v[60:63], a[40:43], a[52:55], v[60:63]
  v_mfma_f32_16x16x32_bf16 v[16:19], a[60:63], a[56:59], v[16:19]
  ds_read_b128 a[16:19], v13 offset:8192
  ds_read_b128 a[20:23], v12 offset:0
  s_waitcnt lgkmcnt(2)
  s_nop 0
  v_mfma_f32_16x16x32_bf16 v[48:51], a[64:67], a[56:59], v[48:51]
  ds_read_b128 a[24:27], v12 offset:2048
  ds_read_b128 a[28:31], v13 offset:8448
  v_mfma_f32_16x16x32_bf16 v[20:23], a[60:63], a[68:71], v[20:23]
  ds_read_b128 a[88:91], v13 offset:8704
  ds_read_b128 a[92:95], v13 offset:8960
  v_mfma_f32_16x16x32_bf16 v[52:55], a[64:67], a[68:71], v[52:55]
  v_mfma_f32_16x16x32_bf16 v[24:27], a[60:63], a[72:75], v[24:27]
  v_mfma_f32_16x16x32_bf16 v[56:59], a[64:67], a[72:75], v[56:59]
  v_mfma_f32_16x16x32_bf16 v[28:31], a[60:63], a[76:79], v[28:31]
  v_mfma_f32_16x16x32_bf16 v[60:63], a[64:67], a[76:79], v[60:63]
  v_mfma_f32_16x16x32_bf16 v[16:19], a[84:87], a[80:83], v[16:19]
  s_barrier
  ds_read_b128 a[32:35], v146 offset:0
  ds_read_b128 a[44:47], v14 offset:0
  s_nop 0
  v_mfma_f32_16x16x32_bf16 v[48:51], a[0:3], a[80:83], v[48:51]
  ds_read_b128 a[48:51], v14 offset:2048
  ds_read_b128 a[36:39], v146 offset:256
  v_mfma_f32_16x16x32_bf16 v[20:23], a[84:87], a[4:7], v[20:23]
  ds_read_b128 a[40:43], v146 offset:512
  ds_read_b128 a[52:55], v146 offset:768
  v_mfma_f32_16x16x32_bf16 v[52:55], a[0:3], a[4:7], v[52:55]
  v_mfma_f32_16x16x32_bf16 v[24:27], a[84:87], a[8:11], v[24:27]
  v_mfma_f32_16x16x32_bf16 v[56:59], a[0:3], a[8:11], v[56:59]
  v_mfma_f32_16x16x32_bf16 v[28:31], a[84:87], a[12:15], v[28:31]
  v_mfma_f32_16x16x32_bf16 v[60:63], a[0:3], a[12:15], v[60:63]
  s_waitcnt lgkmcnt(0)
  s_nop 0
  v_mfma_f32_16x16x32_bf16 v[16:19], a[20:23], a[16:19], v[16:19]
  ds_read_b128 a[56:59], v146 offset:8192
  ds_read_b128 a[68:71], v15 offset:0
  v_mfma_f32_16x16x32_bf16 v[48:51], a[24:27], a[16:19], v[48:51]
  ds_read_b128 a[72:75], v15 offset:2048
  ds_read_b128 a[60:63], v146 offset:8448
  v_mfma_f32_16x16x32_bf16 v[20:23], a[20:23], a[28:31], v[20:23]
  ds_read_b128 a[64:67], v146 offset:8704
  ds_read_b128 a[76:79], v146 offset:8960
  v_mfma_f32_16x16x32_bf16 v[52:55], a[24:27], a[28:31], v[52:55]
  v_mfma_f32_16x16x32_bf16 v[24:27], a[20:23], a[88:91], v[24:27]
  v_mfma_f32_16x16x32_bf16 v[56:59], a[24:27], a[88:91], v[56:59]
  v_mfma_f32_16x16x32_bf16 v[28:31], a[20:23], a[92:95], v[28:31]
  v_mfma_f32_16x16x32_bf16 v[60:63], a[24:27], a[92:95], v[60:63]
  v_mfma_f32_16x16x32_bf16 v[16:19], a[44:47], a[32:35], v[16:19]
  ds_read_b128 a[80:83], v10 offset:1024
  ds_read_b128 a[4:7], v8 offset:0
  v_mfma_f32_16x16x32_bf16 v[48:51], a[48:51], a[32:35], v[48:51]
  ds_read_b128 a[8:11], v8 offset:2048
  ds_read_b128 a[84:87], v10 offset:1280
  v_mfma_f32_16x16x32_bf16 v[20:23], a[44:47], a[36:39], v[20:23]
  ds_read_b128 a[0:3], v10 offset:1536
  ds_read_b128 a[12:15], v10 offset:1792
  v_mfma_f32_16x16x32_bf16 v[52:55], a[48:51], a[36:39], v[52:55]
  v_mfma_f32_16x16x32_bf16 v[24:27], a[44:47], a[40:43], v[24:27]
  v_mfma_f32_16x16x32_bf16 v[56:59], a[48:51], a[40:43], v[56:59]
  v_mfma_f32_16x16x32_bf16 v[28:31], a[44:47], a[52:55], v[28:31]
  v_mfma_f32_16x16x32_bf16 v[60:63], a[48:51], a[52:55], v[60:63]
  s_waitcnt lgkmcnt(0)
  s_nop 0
  v_mfma_f32_16x16x32_bf16 v[16:19], a[68:71], a[56:59], v[16:19]
  ds_read_b128 a[16:19], v10 offset:9216
  ds_read_b128 a[28:31], v9 offset:0
  v_mfma_f32_16x16x32_bf16 v[48:51], a[72:75], a[56:59], v[48:51]
  ds_read_b128 a[88:91], v9 offset:2048
  ds_read_b128 a[20:23], v10 offset:9472
  v_mfma_f32_16x16x32_bf16 v[20:23], a[68:71], a[60:63], v[20:23]
  ds_read_b128 a[24:27], v10 offset:9728
  ds_read_b128 a[92:95], v10 offset:9984
  v_mfma_f32_16x16x32_bf16 v[52:55], a[72:75], a[60:63], v[52:55]
  v_mfma_f32_16x16x32_bf16 v[24:27], a[68:71], a[64:67], v[24:27]
  v_mfma_f32_16x16x32_bf16 v[56:59], a[72:75], a[64:67], v[56:59]
  v_mfma_f32_16x16x32_bf16 v[28:31], a[68:71], a[76:79], v[28:31]
  v_mfma_f32_16x16x32_bf16 v[60:63], a[72:75], a[76:79], v[60:63]
  v_mfma_f32_16x16x32_bf16 v[32:35], a[4:7], a[80:83], v[32:35]
  ds_read_b128 a[32:35], v13 offset:1024
  ds_read_b128 a[36:39], v11 offset:0
  v_mfma_f32_16x16x32_bf16 v[64:67], a[8:11], a[80:83], v[64:67]
  ds_read_b128 a[40:43], v11 offset:2048
  ds_read_b128 a[44:47], v13 offset:1280
  v_mfma_f32_16x16x32_bf16 v[36:39], a[4:7], a[84:87], v[36:39]
  v_cvt_pk_bf16_f32 v150, v17, v21
  v_cvt_pk_bf16_f32 v151, v25, v29
  ds_read_b128 a[48:51], v13 offset:1536
  ds_read_b128 a[52:55], v13 offset:1792
  v_mfma_f32_16x16x32_bf16 v[68:71], a[8:11], a[84:87], v[68:71]
  v_cvt_pk_bf16_f32 v148, v16, v20
  v_cvt_pk_bf16_f32 v149, v24, v28
  v_mfma_f32_16x16x32_bf16 v[40:43], a[4:7], a[0:3], v[40:43]
  v_cndmask_b32_dpp v152, v150, v148, vcc quad_perm:[1,0,3,2] row_mask:0xf bank_mask:0xf
  v_cndmask_b32_dpp v153, v151, v149, vcc quad_perm:[1,0,3,2] row_mask:0xf bank_mask:0xf
  v_mfma_f32_16x16x32_bf16 v[72:75], a[8:11], a[0:3], v[72:75]
  s_not_b64 vcc, vcc
  s_nop 0
  v_mfma_f32_16x16x32_bf16 v[44:47], a[4:7], a[12:15], v[44:47]
  v_cndmask_b32_dpp v154, v148, v150, vcc quad_perm:[1,0,3,2] row_mask:0xf bank_mask:0xf
  v_cndmask_b32_dpp v155, v149, v151, vcc quad_perm:[1,0,3,2] row_mask:0xf bank_mask:0xf
  v_mfma_f32_16x16x32_bf16 v[76:79], a[8:11], a[12:15], v[76:79]
  buffer_store_dwordx4 v[152:155], v147, s[32:35], s44 offen offset:0 sc0 sc1
  v_cvt_pk_bf16_f32 v148, v18, v22
  s_waitcnt lgkmcnt(0)
  s_nop 0
  v_mfma_f32_16x16x32_bf16 v[32:35], a[28:31], a[16:19], v[32:35]
  v_cvt_pk_bf16_f32 v149, v26, v30
  v_cvt_pk_bf16_f32 v150, v19, v23
  ds_read_b128 a[56:59], v13 offset:9216
  ds_read_b128 a[60:63], v12 offset:0
  v_mfma_f32_16x16x32_bf16 v[64:67], a[88:91], a[16:19], v[64:67]
  v_cvt_pk_bf16_f32 v151, v27, v31
  ds_read_b128 a[64:67], v12 offset:2048
  ds_read_b128 a[68:71], v13 offset:9472
  v_mfma_f32_16x16x32_bf16 v[36:39], a[28:31], a[20:23], v[36:39]
  v_cndmask_b32_dpp v158, v148, v150, vcc quad_perm:[1,0,3,2] row_mask:0xf bank_mask:0xf
  v_cndmask_b32_dpp v159, v149, v151, vcc quad_perm:[1,0,3,2] row_mask:0xf bank_mask:0xf
  ds_read_b128 a[72:75], v13 offset:9728
  ds_read_b128 a[76:79], v13 offset:9984
  v_mfma_f32_16x16x32_bf16 v[68:71], a[88:91], a[20:23], v[68:71]
  s_not_b64 vcc, vcc
  v_cndmask_b32_dpp v156, v150, v148, vcc quad_perm:[1,0,3,2] row_mask:0xf bank_mask:0xf
  s_nop 0
  v_mfma_f32_16x16x32_bf16 v[40:43], a[28:31], a[24:27], v[40:43]
  v_cndmask_b32_dpp v157, v151, v149, vcc quad_perm:[1,0,3,2] row_mask:0xf bank_mask:0xf
  buffer_store_dwordx4 v[156:159], v147, s[32:35], s46 offen offset:0 sc0 sc1
  v_mfma_f32_16x16x32_bf16 v[72:75], a[88:91], a[24:27], v[72:75]
  v_cvt_pk_bf16_f32 v150, v49, v53
  v_mfma_f32_16x16x32_bf16 v[44:47], a[28:31], a[92:95], v[44:47]
  v_cvt_pk_bf16_f32 v151, v57, v61
  v_cvt_pk_bf16_f32 v148, v48, v52
  v_mfma_f32_16x16x32_bf16 v[76:79], a[88:91], a[92:95], v[76:79]
  v_cvt_pk_bf16_f32 v149, v56, v60
  v_cndmask_b32_dpp v152, v150, v148, vcc quad_perm:[1,0,3,2] row_mask:0xf bank_mask:0xf
  v_mfma_f32_16x16x32_bf16 v[32:35], a[36:39], a[32:35], v[32:35]
  v_cndmask_b32_dpp v153, v151, v149, vcc quad_perm:[1,0,3,2] row_mask:0xf bank_mask:0xf
  s_not_b64 vcc, vcc
  s_barrier
  ds_read_b128 a[80:83], v146 offset:1024
  ds_read_b128 a[84:87], v14 offset:0
  v_mfma_f32_16x16x32_bf16 v[64:67], a[40:43], a[32:35], v[64:67]
  v_cndmask_b32_dpp v154, v148, v150, vcc quad_perm:[1,0,3,2] row_mask:0xf bank_mask:0xf
  ds_read_b128 a[0:3], v14 offset:2048
  ds_read_b128 a[4:7], v146 offset:1280
  v_mfma_f32_16x16x32_bf16 v[36:39], a[36:39], a[44:47], v[36:39]
  v_cndmask_b32_dpp v155, v149, v151, vcc quad_perm:[1,0,3,2] row_mask:0xf bank_mask:0xf
  buffer_store_dwordx4 v[152:155], v147, s[32:35], s48 offen offset:0 sc0 sc1
  ds_read_b128 a[8:11], v146 offset:1536
  ds_read_b128 a[12:15], v146 offset:1792
  v_mfma_f32_16x16x32_bf16 v[68:71], a[40:43], a[44:47], v[68:71]
  v_cvt_pk_bf16_f32 v148, v50, v54
  v_cvt_pk_bf16_f32 v149, v58, v62
  v_mfma_f32_16x16x32_bf16 v[40:43], a[36:39], a[48:51], v[40:43]
  v_cvt_pk_bf16_f32 v150, v51, v55
  v_cvt_pk_bf16_f32 v151, v59, v63
  v_mfma_f32_16x16x32_bf16 v[72:75], a[40:43], a[48:51], v[72:75]
  v_cndmask_b32_dpp v158, v148, v150, vcc quad_perm:[1,0,3,2] row_mask:0xf bank_mask:0xf
  v_mfma_f32_16x16x32_bf16 v[44:47], a[36:39], a[52:55], v[44:47]
  v_cndmask_b32_dpp v159, v149, v151, vcc quad_perm:[1,0,3,2] row_mask:0xf bank_mask:0xf
  s_not_b64 vcc, vcc
  s_nop 0
  v_mfma_f32_16x16x32_bf16 v[76:79], a[40:43], a[52:55], v[76:79]
  v_cndmask_b32_dpp v156, v150, v148, vcc quad_perm:[1,0,3,2] row_mask:0xf bank_mask:0xf
  v_cndmask_b32_dpp v157, v151, v149, vcc quad_perm:[1,0,3,2] row_mask:0xf bank_mask:0xf
  s_waitcnt lgkmcnt(0)
  s_nop 0
  v_mfma_f32_16x16x32_bf16 v[32:35], a[60:63], a[56:59], v[32:35]
  buffer_store_dwordx4 v[156:159], v147, s[32:35], s50 offen offset:0 sc0 sc1
  ds_read_b128 a[16:19], v146 offset:9216
  ds_read_b128 a[20:23], v15 offset:0
  v_mfma_f32_16x16x32_bf16 v[64:67], a[64:67], a[56:59], v[64:67]
  ds_read_b128 a[24:27], v15 offset:2048
  ds_read_b128 a[28:31], v146 offset:9472
  v_mfma_f32_16x16x32_bf16 v[36:39], a[60:63], a[68:71], v[36:39]
  ds_read_b128 a[88:91], v146 offset:9728
  ds_read_b128 a[92:95], v146 offset:9984
  v_mfma_f32_16x16x32_bf16 v[68:71], a[64:67], a[68:71], v[68:71]
  v_mfma_f32_16x16x32_bf16 v[40:43], a[60:63], a[72:75], v[40:43]
  v_mfma_f32_16x16x32_bf16 v[72:75], a[64:67], a[72:75], v[72:75]
  v_mfma_f32_16x16x32_bf16 v[44:47], a[60:63], a[76:79], v[44:47]
  v_mfma_f32_16x16x32_bf16 v[76:79], a[64:67], a[76:79], v[76:79]
  v_mfma_f32_16x16x32_bf16 v[32:35], a[84:87], a[80:83], v[32:35]
  ds_read_b128 a[32:35], v10 offset:0
  ds_read_b128 a[44:47], v8 offset:4096
  v_mfma_f32_16x16x32_bf16 v[64:67], a[0:3], a[80:83], v[64:67]
  ds_read_b128 a[48:51], v8 offset:6144
  ds_read_b128 a[36:39], v10 offset:256
  v_mfma_f32_16x16x32_bf16 v[36:39], a[84:87], a[4:7], v[36:39]
  ds_read_b128 a[40:43], v10 offset:512
  ds_read_b128 a[52:55], v10 offset:768
  v_mfma_f32_16x16x32_bf16 v[68:71], a[0:3], a[4:7], v[68:71]
  v_mfma_f32_16x16x32_bf16 v[40:43], a[84:87], a[8:11], v[40:43]
  v_mfma_f32_16x16x32_bf16 v[72:75], a[0:3], a[8:11], v[72:75]
  v_mfma_f32_16x16x32_bf16 v[44:47], a[84:87], a[12:15], v[44:47]
  v_mfma_f32_16x16x32_bf16 v[76:79], a[0:3], a[12:15], v[76:79]
  s_waitcnt lgkmcnt(0)
  s_nop 0
  v_mfma_f32_16x16x32_bf16 v[32:35], a[20:23], a[16:19], v[32:35]
  ds_read_b128 a[56:59], v10 offset:8192
  ds_read_b128 a[68:71], v9 offset:4096
  v_mfma_f32_16x16x32_bf16 v[64:67], a[24:27], a[16:19], v[64:67]
  ds_read_b128 a[72:75], v9 offset:6144
  ds_read_b128 a[60:63], v10 offset:8448
  v_mfma_f32_16x16x32_bf16 v[36:39], a[20:23], a[28:31], v[36:39]
  ds_read_b128 a[64:67], v10 offset:8704
  ds_read_b128 a[76:79], v10 offset:8960
  v_mfma_f32_16x16x32_bf16 v[68:71], a[24:27], a[28:31], v[68:71]
  v_mfma_f32_16x16x32_bf16 v[40:43], a[20:23], a[88:91], v[40:43]
  v_mfma_f32_16x16x32_bf16 v[72:75], a[24:27], a[88:91], v[72:75]
  v_mfma_f32_16x16x32_bf16 v[44:47], a[20:23], a[92:95], v[44:47]
  v_mfma_f32_16x16x32_bf16 v[76:79], a[24:27], a[92:95], v[76:79]
  v_mfma_f32_16x16x32_bf16 v[80:83], a[44:47], a[32:35], v[80:83]
  ds_read_b128 a[80:83], v13 offset:0
  ds_read_b128 a[4:7], v11 offset:4096
  v_mfma_f32_16x16x32_bf16 v[112:115], a[48:51], a[32:35], v[112:115]
  ds_read_b128 a[8:11], v11 offset:6144
  ds_read_b128 a[84:87], v13 offset:256
  v_mfma_f32_16x16x32_bf16 v[84:87], a[44:47], a[36:39], v[84:87]
  v_cvt_pk_bf16_f32 v150, v33, v37
  v_cvt_pk_bf16_f32 v151, v41, v45
  ds_read_b128 a[0:3], v13 offset:512
  ds_read_b128 a[12:15], v13 offset:768
  v_mfma_f32_16x16x32_bf16 v[116:119], a[48:51], a[36:39], v[116:119]
  v_cvt_pk_bf16_f32 v148, v32, v36
  v_cvt_pk_bf16_f32 v149, v40, v44
  v_mfma_f32_16x16x32_bf16 v[88:91], a[44:47], a[40:43], v[88:91]
  v_cndmask_b32_dpp v152, v150, v148, vcc quad_perm:[1,0,3,2] row_mask:0xf bank_mask:0xf
  v_cndmask_b32_dpp v153, v151, v149, vcc quad_perm:[1,0,3,2] row_mask:0xf bank_mask:0xf
  v_mfma_f32_16x16x32_bf16 v[120:123], a[48:51], a[40:43], v[120:123]
  s_not_b64 vcc, vcc
  s_nop 0
  v_mfma_f32_16x16x32_bf16 v[92:95], a[44:47], a[52:55], v[92:95]
  v_cndmask_b32_dpp v154, v148, v150, vcc quad_perm:[1,0,3,2] row_mask:0xf bank_mask:0xf
  v_cndmask_b32_dpp v155, v149, v151, vcc quad_perm:[1,0,3,2] row_mask:0xf bank_mask:0xf
  v_mfma_f32_16x16x32_bf16 v[124:127], a[48:51], a[52:55], v[124:127]
  buffer_store_dwordx4 v[152:155], v147, s[32:35], s44 offen offset:128 sc0 sc1
  v_cvt_pk_bf16_f32 v148, v34, v38
  s_waitcnt lgkmcnt(0)
  s_nop 0
  v_mfma_f32_16x16x32_bf16 v[80:83], a[68:71], a[56:59], v[80:83]
  v_cvt_pk_bf16_f32 v149, v42, v46
  v_cvt_pk_bf16_f32 v150, v35, v39
  ds_read_b128 a[16:19], v13 offset:8192
  ds_read_b128 a[28:31], v12 offset:4096
  v_mfma_f32_16x16x32_bf16 v[112:115], a[72:75], a[56:59], v[112:115]
  v_cvt_pk_bf16_f32 v151, v43, v47
  ds_read_b128 a[88:91], v12 offset:6144
  ds_read_b128 a[20:23], v13 offset:8448
  v_mfma_f32_16x16x32_bf16 v[84:87], a[68:71], a[60:63], v[84:87]
  v_cndmask_b32_dpp v158, v148, v150, vcc quad_perm:[1,0,3,2] row_mask:0xf bank_mask:0xf
  v_cndmask_b32_dpp v159, v149, v151, vcc quad_perm:[1,0,3,2] row_mask:0xf bank_mask:0xf
  ds_read_b128 a[24:27], v13 offset:8704
  ds_read_b128 a[92:95], v13 offset:8960
  v_mfma_f32_16x16x32_bf16 v[116:119], a[72:75], a[60:63], v[116:119]
  s_not_b64 vcc, vcc
  v_cndmask_b32_dpp v156, v150, v148, vcc quad_perm:[1,0,3,2] row_mask:0xf bank_mask:0xf
  s_nop 0
  v_mfma_f32_16x16x32_bf16 v[88:91], a[68:71], a[64:67], v[88:91]
  v_cndmask_b32_dpp v157, v151, v149, vcc quad_perm:[1,0,3,2] row_mask:0xf bank_mask:0xf
  buffer_store_dwordx4 v[156:159], v147, s[32:35], s46 offen offset:128 sc0 sc1
  v_mfma_f32_16x16x32_bf16 v[120:123], a[72:75], a[64:67], v[120:123]
  v_cvt_pk_bf16_f32 v150, v65, v69
  v_mfma_f32_16x16x32_bf16 v[92:95], a[68:71], a[76:79], v[92:95]
  v_cvt_pk_bf16_f32 v151, v73, v77
  v_cvt_pk_bf16_f32 v148, v64, v68
  v_mfma_f32_16x16x32_bf16 v[124:127], a[72:75], a[76:79], v[124:127]
  v_cvt_pk_bf16_f32 v149, v72, v76
  v_cndmask_b32_dpp v152, v150, v148, vcc quad_perm:[1,0,3,2] row_mask:0xf bank_mask:0xf
  v_mfma_f32_16x16x32_bf16 v[80:83], a[4:7], a[80:83], v[80:83]
  v_cndmask_b32_dpp v153, v151, v149, vcc quad_perm:[1,0,3,2] row_mask:0xf bank_mask:0xf
  s_not_b64 vcc, vcc
  ds_read_b128 a[32:35], v146 offset:0
  ds_read_b128 a[36:39], v144 offset:4096
  s_nop 0
  v_mfma_f32_16x16x32_bf16 v[112:115], a[8:11], a[80:83], v[112:115]
  v_cndmask_b32_dpp v154, v148, v150, vcc quad_perm:[1,0,3,2] row_mask:0xf bank_mask:0xf
  ds_read_b128 a[40:43], v144 offset:6144
  ds_read_b128 a[44:47], v146 offset:256
  v_mfma_f32_16x16x32_bf16 v[84:87], a[4:7], a[84:87], v[84:87]
  v_cndmask_b32_dpp v155, v149, v151, vcc quad_perm:[1,0,3,2] row_mask:0xf bank_mask:0xf
  buffer_store_dwordx4 v[152:155], v147, s[32:35], s48 offen offset:128 sc0 sc1
  ds_read_b128 a[48:51], v146 offset:512
  ds_read_b128 a[52:55], v146 offset:768
  v_mfma_f32_16x16x32_bf16 v[116:119], a[8:11], a[84:87], v[116:119]
  v_cvt_pk_bf16_f32 v148, v66, v70
  v_cvt_pk_bf16_f32 v149, v74, v78
  v_mfma_f32_16x16x32_bf16 v[88:91], a[4:7], a[0:3], v[88:91]
  v_cvt_pk_bf16_f32 v150, v67, v71
  v_cvt_pk_bf16_f32 v151, v75, v79
  v_mfma_f32_16x16x32_bf16 v[120:123], a[8:11], a[0:3], v[120:123]
  v_cndmask_b32_dpp v158, v148, v150, vcc quad_perm:[1,0,3,2] row_mask:0xf bank_mask:0xf
  v_mfma_f32_16x16x32_bf16 v[92:95], a[4:7], a[12:15], v[92:95]
  v_cndmask_b32_dpp v159, v149, v151, vcc quad_perm:[1,0,3,2] row_mask:0xf bank_mask:0xf
  s_not_b64 vcc, vcc
  s_nop 0
  v_mfma_f32_16x16x32_bf16 v[124:127], a[8:11], a[12:15], v[124:127]
  v_cndmask_b32_dpp v156, v150, v148, vcc quad_perm:[1,0,3,2] row_mask:0xf bank_mask:0xf
  v_cndmask_b32_dpp v157, v151, v149, vcc quad_perm:[1,0,3,2] row_mask:0xf bank_mask:0xf
  s_waitcnt lgkmcnt(0)
  s_nop 0
  v_mfma_f32_16x16x32_bf16 v[80:83], a[28:31], a[16:19], v[80:83]
  buffer_store_dwordx4 v[156:159], v147, s[32:35], s50 offen offset:128 sc0 sc1
  ds_read_b128 a[56:59], v146 offset:8192
  ds_read_b128 a[60:63], v145 offset:4096
  v_mfma_f32_16x16x32_bf16 v[112:115], a[88:91], a[16:19], v[112:115]
  ds_read_b128 a[64:67], v145 offset:6144
  ds_read_b128 a[68:71], v146 offset:8448
  v_mfma_f32_16x16x32_bf16 v[84:87], a[28:31], a[20:23], v[84:87]
  ds_read_b128 a[72:75], v146 offset:8704
  ds_read_b128 a[76:79], v146 offset:8960
  v_mfma_f32_16x16x32_bf16 v[116:119], a[88:91], a[20:23], v[116:119]
  v_mfma_f32_16x16x32_bf16 v[88:91], a[28:31], a[24:27], v[88:91]
  v_mfma_f32_16x16x32_bf16 v[120:123], a[88:91], a[24:27], v[120:123]
  v_mfma_f32_16x16x32_bf16 v[92:95], a[28:31], a[92:95], v[92:95]
  v_mfma_f32_16x16x32_bf16 v[124:127], a[88:91], a[92:95], v[124:127]
  v_mfma_f32_16x16x32_bf16 v[80:83], a[36:39], a[32:35], v[80:83]
  ds_read_b128 a[80:83], v10 offset:1024
  ds_read_b128 a[84:87], v8 offset:4096
  v_mfma_f32_16x16x32_bf16 v[112:115], a[40:43], a[32:35], v[112:115]
  ds_read_b128 a[0:3], v8 offset:6144
  ds_read_b128 a[4:7], v10 offset:1280
  v_mfma_f32_16x16x32_bf16 v[84:87], a[36:39], a[44:47], v[84:87]
  ds_read_b128 a[8:11], v10 offset:1536
  ds_read_b128 a[12:15], v10 offset:1792
  v_mfma_f32_16x16x32_bf16 v[116:119], a[40:43], a[44:47], v[116:119]
  v_mfma_f32_16x16x32_bf16 v[88:91], a[36:39], a[48:51], v[88:91]
  v_mfma_f32_16x16x32_bf16 v[120:123], a[40:43], a[48:51], v[120:123]
  v_mfma_f32_16x16x32_bf16 v[92:95], a[36:39], a[52:55], v[92:95]
  v_mfma_f32_16x16x32_bf16 v[124:127], a[40:43], a[52:55], v[124:127]
  s_waitcnt lgkmcnt(0)
  s_nop 0
  v_mfma_f32_16x16x32_bf16 v[80:83], a[60:63], a[56:59], v[80:83]
  ds_read_b128 a[16:19], v10 offset:9216
  ds_read_b128 a[20:23], v9 offset:4096
  v_mfma_f32_16x16x32_bf16 v[112:115], a[64:67], a[56:59], v[112:115]
  ds_read_b128 a[24:27], v9 offset:6144
  ds_read_b128 a[28:31], v10 offset:9472
  v_mfma_f32_16x16x32_bf16 v[84:87], a[60:63], a[68:71], v[84:87]
  ds_read_b128 a[88:91], v10 offset:9728
  ds_read_b128 a[92:95], v10 offset:9984
  v_mfma_f32_16x16x32_bf16 v[116:119], a[64:67], a[68:71], v[116:119]
  v_mfma_f32_16x16x32_bf16 v[88:91], a[60:63], a[72:75], v[88:91]
  v_mfma_f32_16x16x32_bf16 v[120:123], a[64:67], a[72:75], v[120:123]
  v_mfma_f32_16x16x32_bf16 v[92:95], a[60:63], a[76:79], v[92:95]
  v_mfma_f32_16x16x32_bf16 v[124:127], a[64:67], a[76:79], v[124:127]
  v_mfma_f32_16x16x32_bf16 v[96:99], a[84:87], a[80:83], v[96:99]
  ds_read_b128 a[32:35], v13 offset:1024
  ds_read_b128 a[44:47], v11 offset:4096
  v_mfma_f32_16x16x32_bf16 v[128:131], a[0:3], a[80:83], v[128:131]
  ds_read_b128 a[48:51], v11 offset:6144
  ds_read_b128 a[36:39], v13 offset:1280
  v_mfma_f32_16x16x32_bf16 v[100:103], a[84:87], a[4:7], v[100:103]
  v_cvt_pk_bf16_f32 v150, v81, v85
  v_cvt_pk_bf16_f32 v151, v89, v93
  ds_read_b128 a[40:43], v13 offset:1536
  ds_read_b128 a[52:55], v13 offset:1792
  v_mfma_f32_16x16x32_bf16 v[132:135], a[0:3], a[4:7], v[132:135]
  v_cvt_pk_bf16_f32 v148, v80, v84
  v_cvt_pk_bf16_f32 v149, v88, v92
  v_mfma_f32_16x16x32_bf16 v[104:107], a[84:87], a[8:11], v[104:107]
  v_cndmask_b32_dpp v152, v150, v148, vcc quad_perm:[1,0,3,2] row_mask:0xf bank_mask:0xf
  v_cndmask_b32_dpp v153, v151, v149, vcc quad_perm:[1,0,3,2] row_mask:0xf bank_mask:0xf
  v_mfma_f32_16x16x32_bf16 v[136:139], a[0:3], a[8:11], v[136:139]
  s_not_b64 vcc, vcc
  s_nop 0
  v_mfma_f32_16x16x32_bf16 v[108:111], a[84:87], a[12:15], v[108:111]
  v_cndmask_b32_dpp v154, v148, v150, vcc quad_perm:[1,0,3,2] row_mask:0xf bank_mask:0xf
  v_cndmask_b32_dpp v155, v149, v151, vcc quad_perm:[1,0,3,2] row_mask:0xf bank_mask:0xf
  v_mfma_f32_16x16x32_bf16 v[140:143], a[0:3], a[12:15], v[140:143]
  buffer_store_dwordx4 v[152:155], v147, s[32:35], s52 offen offset:0 sc0 sc1
  v_cvt_pk_bf16_f32 v148, v82, v86
  s_waitcnt lgkmcnt(0)
  s_nop 0
  v_mfma_f32_16x16x32_bf16 v[96:99], a[20:23], a[16:19], v[96:99]
  v_cvt_pk_bf16_f32 v149, v90, v94
  v_cvt_pk_bf16_f32 v150, v83, v87
  ds_read_b128 a[56:59], v13 offset:9216
  ds_read_b128 a[68:71], v12 offset:4096
  v_mfma_f32_16x16x32_bf16 v[128:131], a[24:27], a[16:19], v[128:131]
  v_cvt_pk_bf16_f32 v151, v91, v95
  ds_read_b128 a[72:75], v12 offset:6144
  ds_read_b128 a[60:63], v13 offset:9472
  v_mfma_f32_16x16x32_bf16 v[100:103], a[20:23], a[28:31], v[100:103]
  v_cndmask_b32_dpp v158, v148, v150, vcc quad_perm:[1,0,3,2] row_mask:0xf bank_mask:0xf
  v_cndmask_b32_dpp v159, v149, v151, vcc quad_perm:[1,0,3,2] row_mask:0xf bank_mask:0xf
  ds_read_b128 a[64:67], v13 offset:9728
  ds_read_b128 a[76:79], v13 offset:9984
  v_mfma_f32_16x16x32_bf16 v[132:135], a[24:27], a[28:31], v[132:135]
  s_not_b64 vcc, vcc
  v_cndmask_b32_dpp v156, v150, v148, vcc quad_perm:[1,0,3,2] row_mask:0xf bank_mask:0xf
  s_nop 0
  v_mfma_f32_16x16x32_bf16 v[104:107], a[20:23], a[88:91], v[104:107]
  v_cndmask_b32_dpp v157, v151, v149, vcc quad_perm:[1,0,3,2] row_mask:0xf bank_mask:0xf
  buffer_store_dwordx4 v[156:159], v147, s[32:35], s54 offen offset:0 sc0 sc1
  v_mfma_f32_16x16x32_bf16 v[136:139], a[24:27], a[88:91], v[136:139]
  v_cvt_pk_bf16_f32 v150, v113, v117
  v_mfma_f32_16x16x32_bf16 v[108:111], a[20:23], a[92:95], v[108:111]
  v_cvt_pk_bf16_f32 v151, v121, v125
  v_cvt_pk_bf16_f32 v148, v112, v116
  v_mfma_f32_16x16x32_bf16 v[140:143], a[24:27], a[92:95], v[140:143]
  v_cvt_pk_bf16_f32 v149, v120, v124
  v_cndmask_b32_dpp v152, v150, v148, vcc quad_perm:[1,0,3,2] row_mask:0xf bank_mask:0xf
  v_mfma_f32_16x16x32_bf16 v[96:99], a[44:47], a[32:35], v[96:99]
  v_cndmask_b32_dpp v153, v151, v149, vcc quad_perm:[1,0,3,2] row_mask:0xf bank_mask:0xf
  s_not_b64 vcc, vcc
  ds_read_b128 a[80:83], v146 offset:1024
  ds_read_b128 a[4:7], v144 offset:4096
  s_nop 0
  v_mfma_f32_16x16x32_bf16 v[128:131], a[48:51], a[32:35], v[128:131]
  v_cndmask_b32_dpp v154, v148, v150, vcc quad_perm:[1,0,3,2] row_mask:0xf bank_mask:0xf
  ds_read_b128 a[8:11], v144 offset:6144
  ds_read_b128 a[84:87], v146 offset:1280
  v_mfma_f32_16x16x32_bf16 v[100:103], a[44:47], a[36:39], v[100:103]
  v_cndmask_b32_dpp v155, v149, v151, vcc quad_perm:[1,0,3,2] row_mask:0xf bank_mask:0xf
  buffer_store_dwordx4 v[152:155], v147, s[32:35], s56 offen offset:0 sc0 sc1
  ds_read_b128 a[0:3], v146 offset:1536
  ds_read_b128 a[12:15], v146 offset:1792
  v_mfma_f32_16x16x32_bf16 v[132:135], a[48:51], a[36:39], v[132:135]
  v_cvt_pk_bf16_f32 v148, v114, v118
  v_cvt_pk_bf16_f32 v149, v122, v126
  v_mfma_f32_16x16x32_bf16 v[104:107], a[44:47], a[40:43], v[104:107]
  v_cvt_pk_bf16_f32 v150, v115, v119
  v_cvt_pk_bf16_f32 v151, v123, v127
  v_mfma_f32_16x16x32_bf16 v[136:139], a[48:51], a[40:43], v[136:139]
  v_cndmask_b32_dpp v158, v148, v150, vcc quad_perm:[1,0,3,2] row_mask:0xf bank_mask:0xf
  v_mfma_f32_16x16x32_bf16 v[108:111], a[44:47], a[52:55], v[108:111]
  v_cndmask_b32_dpp v159, v149, v151, vcc quad_perm:[1,0,3,2] row_mask:0xf bank_mask:0xf
  s_not_b64 vcc, vcc
  s_nop 0
  v_mfma_f32_16x16x32_bf16 v[140:143], a[48:51], a[52:55], v[140:143]
  v_cndmask_b32_dpp v156, v150, v148, vcc quad_perm:[1,0,3,2] row_mask:0xf bank_mask:0xf
  v_cndmask_b32_dpp v157, v151, v149, vcc quad_perm:[1,0,3,2] row_mask:0xf bank_mask:0xf
  s_waitcnt lgkmcnt(0)
  s_nop 0
  v_mfma_f32_16x16x32_bf16 v[96:99], a[68:71], a[56:59], v[96:99]
  buffer_store_dwordx4 v[156:159], v147, s[32:35], s58 offen offset:0 sc0 sc1
  ds_read_b128 a[16:19], v146 offset:9216
  ds_read_b128 a[28:31], v145 offset:4096
  v_mfma_f32_16x16x32_bf16 v[128:131], a[72:75], a[56:59], v[128:131]
  ds_read_b128 a[88:91], v146 offset:9472
  ds_read_b128 a[20:23], v145 offset:6144
  v_mfma_f32_16x16x32_bf16 v[100:103], a[68:71], a[60:63], v[100:103]
  ds_read_b128 a[24:27], v146 offset:9728
  ds_read_b128 a[92:95], v146 offset:9984
  v_mfma_f32_16x16x32_bf16 v[132:135], a[72:75], a[60:63], v[132:135]
  v_mfma_f32_16x16x32_bf16 v[104:107], a[68:71], a[64:67], v[104:107]
  v_mfma_f32_16x16x32_bf16 v[136:139], a[72:75], a[64:67], v[136:139]
  v_mfma_f32_16x16x32_bf16 v[108:111], a[68:71], a[76:79], v[108:111]
  v_mfma_f32_16x16x32_bf16 v[140:143], a[72:75], a[76:79], v[140:143]
  v_mfma_f32_16x16x32_bf16 v[96:99], a[4:7], a[80:83], v[96:99]
  v_mfma_f32_16x16x32_bf16 v[128:131], a[8:11], a[80:83], v[128:131]
  v_mfma_f32_16x16x32_bf16 v[100:103], a[4:7], a[84:87], v[100:103]
  v_mfma_f32_16x16x32_bf16 v[132:135], a[8:11], a[84:87], v[132:135]
  v_mfma_f32_16x16x32_bf16 v[104:107], a[4:7], a[0:3], v[104:107]
  v_mfma_f32_16x16x32_bf16 v[136:139], a[8:11], a[0:3], v[136:139]
  v_mfma_f32_16x16x32_bf16 v[108:111], a[4:7], a[12:15], v[108:111]
  v_mfma_f32_16x16x32_bf16 v[140:143], a[8:11], a[12:15], v[140:143]
  s_waitcnt lgkmcnt(0)
  s_nop 0
  v_mfma_f32_16x16x32_bf16 v[96:99], a[28:31], a[16:19], v[96:99]
  v_mfma_f32_16x16x32_bf16 v[100:103], a[28:31], a[88:91], v[100:103]
  v_mfma_f32_16x16x32_bf16 v[104:107], a[28:31], a[24:27], v[104:107]
  v_mfma_f32_16x16x32_bf16 v[108:111], a[28:31], a[92:95], v[108:111]
  v_mfma_f32_16x16x32_bf16 v[128:131], a[20:23], a[16:19], v[128:131]
  v_mfma_f32_16x16x32_bf16 v[132:135], a[20:23], a[88:91], v[132:135]
  v_mfma_f32_16x16x32_bf16 v[136:139], a[20:23], a[24:27], v[136:139]
  v_mfma_f32_16x16x32_bf16 v[140:143], a[20:23], a[92:95], v[140:143]
  s_nop 7
L_fin:
  v_cvt_pk_bf16_f32 v150, v97, v101
  v_cvt_pk_bf16_f32 v151, v105, v109
  v_cvt_pk_bf16_f32 v148, v96, v100
  v_cvt_pk_bf16_f32 v149, v104, v108
  v_cndmask_b32_dpp v152, v150, v148, vcc quad_perm:[1,0,3,2] row_mask:0xf bank_mask:0xf
  v_cndmask_b32_dpp v153, v151, v149, vcc quad_perm:[1,0,3,2] row_mask:0xf bank_mask:0xf
  s_not_b64 vcc, vcc
  v_cndmask_b32_dpp v154, v148, v150, vcc quad_perm:[1,0,3,2] row_mask:0xf bank_mask:0xf
  v_cndmask_b32_dpp v155, v149, v151, vcc quad_perm:[1,0,3,2] row_mask:0xf bank_mask:0xf
  buffer_store_dwordx4 v[152:155], v147, s[32:35], s52 offen offset:128 sc0 sc1
  v_cvt_pk_bf16_f32 v148, v98, v102
  v_cvt_pk_bf16_f32 v149, v106, v110
  v_cvt_pk_bf16_f32 v150, v99, v103
  v_cvt_pk_bf16_f32 v151, v107, v111
  v_cndmask_b32_dpp v158, v148, v150, vcc quad_perm:[1,0,3,2] row_mask:0xf bank_mask:0xf
  v_cndmask_b32_dpp v159, v149, v151, vcc quad_perm:[1,0,3,2] row_mask:0xf bank_mask:0xf
  s_not_b64 vcc, vcc
  v_cndmask_b32_dpp v156, v150, v148, vcc quad_perm:[1,0,3,2] row_mask:0xf bank_mask:0xf
  v_cndmask_b32_dpp v157, v151, v149, vcc quad_perm:[1,0,3,2] row_mask:0xf bank_mask:0xf
  buffer_store_dwordx4 v[156:159], v147, s[32:35], s54 offen offset:128 sc0 sc1
  v_cvt_pk_bf16_f32 v150, v129, v133
  v_cvt_pk_bf16_f32 v151, v137, v141
  v_cvt_pk_bf16_f32 v148, v128, v132
  v_cvt_pk_bf16_f32 v149, v136, v140
  v_cndmask_b32_dpp v152, v150, v148, vcc quad_perm:[1,0,3,2] row_mask:0xf bank_mask:0xf
  v_cndmask_b32_dpp v153, v151, v149, vcc quad_perm:[1,0,3,2] row_mask:0xf bank_mask:0xf
  s_not_b64 vcc, vcc
  v_cndmask_b32_dpp v154, v148, v150, vcc quad_perm:[1,0,3,2] row_mask:0xf bank_mask:0xf
  v_cndmask_b32_dpp v155, v149, v151, vcc quad_perm:[1,0,3,2] row_mask:0xf bank_mask:0xf
  buffer_store_dwordx4 v[152:155], v147, s[32:35], s56 offen offset:128 sc0 sc1
  v_cvt_pk_bf16_f32 v148, v130, v134
  v_cvt_pk_bf16_f32 v149, v138, v142
  v_cvt_pk_bf16_f32 v150, v131, v135
  v_cvt_pk_bf16_f32 v151, v139, v143
  v_cndmask_b32_dpp v158, v148, v150, vcc quad_perm:[1,0,3,2] row_mask:0xf bank_mask:0xf
  v_cndmask_b32_dpp v159, v149, v151, vcc quad_perm:[1,0,3,2] row_mask:0xf bank_mask:0xf
  s_not_b64 vcc, vcc
  v_cndmask_b32_dpp v156, v150, v148, vcc quad_perm:[1,0,3,2] row_mask:0xf bank_mask:0xf
  v_cndmask_b32_dpp v157, v151, v149, vcc quad_perm:[1,0,3,2] row_mask:0xf bank_mask:0xf
  buffer_store_dwordx4 v[156:159], v147, s[32:35], s58 offen offset:128 sc0 sc1
  s_endpgm
L_loader:
  s_add_u32 s58, s40, 2
  s_lshl_b32 s58, s58, 7
  s_load_dword s68, s[12:13], s58 offset:0
  s_load_dword s69, s[12:13], s58 offset:64
  s_load_dword s70, s[12:13], s58 offset:2048
  s_load_dword s71, s[12:13], s58 offset:2112
  s_load_dword s72, s[12:13], s58 offset:4096
  s_load_dword s73, s[12:13], s58 offset:4160
  s_waitcnt vmcnt(0)
  s_mov_b64 exec, 1
  buffer_store_dwordx2 v[10:11], v14, s[28:31], 0 offen sc1
  s_mov_b64 exec, -1
  s_barrier
  s_add_u32 s43, s40, 0
  s_lshl_b32 s43, s43, 9
  s_load_dwordx4 s[64:67], s[4:5], s43 glc
  s_add_u32 s41, s40, 0
  s_lshl_b32 s41, s41, 7
  s_add_u32 m0, s60, 49152
  s_nop 0
  buffer_load_dwordx4 v16, s[16:19], s41 offen offset:0  lds
  buffer_load_dwordx4 v17, s[16:19], s41 offen offset:1024  lds
  buffer_load_dwordx4 v18, s[16:19], s41 offen offset:2048  lds
  buffer_load_dwordx4 v19, s[16:19], s41 offen offset:3072  lds
  s_add_u32 m0, s60, 53248
  s_add_u32 s41, s41, 65536
  buffer_load_dwordx4 v16, s[16:19], s41 offen offset:0  lds
  buffer_load_dwordx4 v17, s[16:19], s41 offen offset:1024  lds
  buffer_load_dwordx4 v18, s[16:19], s41 offen offset:2048  lds
  buffer_load_dwordx4 v19, s[16:19], s41 offen offset:3072  lds
  s_mov_b32 s63, 0
L_sp1:
  s_waitcnt lgkmcnt(0)
  s_xor_b64 s[10:11], s[64:65], s[8:9]
  s_xor_b64 s[14:15], s[66:67], s[8:9]
  s_or_b64 s[10:11], s[10:11], s[14:15]
  s_cbranch_scc0 L_ok1
  s_load_dwordx4 s[64:67], s[4:5], s43 glc
  s_add_u32 s63, s63, 1
  s_cmp_lt_u32 s63, 20000
  s_cbranch_scc1 L_sp1
  s_waitcnt lgkmcnt(0)
L_ok1:
  s_add_u32 s43, s40, 1
  s_lshl_b32 s43, s43, 9
  s_load_dwordx4 s[64:67], s[4:5], s43 glc
  s_add_u32 m0, s61, 49152
  s_add_u32 s62, s40, 0
  s_lshl_b32 s62, s62, 14
  buffer_load_dwordx4 v20, s[28:31], s62 offen offset:0 sc1 lds
  buffer_load_dwordx4 v20, s[28:31], s62 offen offset:1024 sc1 lds
  buffer_load_dwordx4 v20, s[28:31], s62 offen offset:2048 sc1 lds
  buffer_load_dwordx4 v20, s[28:31], s62 offen offset:3072 sc1 lds
  s_add_u32 s41, s40, 1
  s_lshl_b32 s41, s41, 7
  s_add_u32 m0, s60, 98304
  s_nop 0
  buffer_load_dwordx4 v16, s[16:19], s41 offen offset:0  lds
  buffer_load_dwordx4 v17, s[16:19], s41 offen offset:1024  lds
  buffer_load_dwordx4 v18, s[16:19], s41 offen offset:2048  lds
  buffer_load_dwordx4 v19, s[16:19], s41 offen offset:3072  lds
  s_add_u32 m0, s60, 102400
  s_add_u32 s41, s41, 65536
  buffer_load_dwordx4 v16, s[16:19], s41 offen offset:0  lds
  buffer_load_dwordx4 v17, s[16:19], s41 offen offset:1024  lds
  buffer_load_dwordx4 v18, s[16:19], s41 offen offset:2048  lds
  buffer_load_dwordx4 v19, s[16:19], s41 offen offset:3072  lds
  s_mov_b32 s63, 0
L_sp2:
  s_waitcnt lgkmcnt(0)
  s_xor_b64 s[10:11], s[64:65], s[8:9]
  s_xor_b64 s[14:15], s[66:67], s[8:9]
  s_or_b64 s[10:11], s[10:11], s[14:15]
  s_cbranch_scc0 L_ok2
  s_load_dwordx4 s[64:67], s[4:5], s43 glc
  s_add_u32 s63, s63, 1
  s_cmp_lt_u32 s63, 20000
  s_cbranch_scc1 L_sp2
  s_waitcnt lgkmcnt(0)
L_ok2:
  s_add_u32 s43, s40, 2
  s_lshl_b32 s43, s43, 9
  s_load_dwordx4 s[64:67], s[4:5], s43 glc
  s_add_u32 s58, s40, 3
  s_lshl_b32 s58, s58, 7
  s_load_dword s68, s[12:13], s58 offset:0
  s_load_dword s69, s[12:13], s58 offset:64
  s_load_dword s70, s[12:13], s58 offset:2048
  s_load_dword s71, s[12:13], s58 offset:2112
  s_load_dword s72, s[12:13], s58 offset:4096
  s_load_dword s73, s[12:13], s58 offset:4160
  s_add_u32 m0, s61, 98304
  s_add_u32 s62, s40, 1
  s_lshl_b32 s62, s62, 14
  buffer_load_dwordx4 v20, s[28:31], s62 offen offset:0 sc1 lds
  buffer_load_dwordx4 v20, s[28:31], s62 offen offset:1024 sc1 lds
  buffer_load_dwordx4 v20, s[28:31], s62 offen offset:2048 sc1 lds
  buffer_load_dwordx4 v20, s[28:31], s62 offen offset:3072 sc1 lds
  s_waitcnt vmcnt(12)
  s_barrier
  s_add_u32 s41, s40, 2
  s_lshl_b32 s41, s41, 7
  s_add_u32 m0, s60, 0
  s_nop 0
  buffer_load_dwordx4 v16, s[16:19], s41 offen offset:0  lds
  buffer_load_dwordx4 v17, s[16:19], s41 offen offset:1024  lds
  buffer_load_dwordx4 v18, s[16:19], s41 offen offset:2048  lds
  buffer_load_dwordx4 v19, s[16:19], s41 offen offset:3072  lds
  s_add_u32 m0, s60, 4096
  s_add_u32 s41, s41, 65536
  buffer_load_dwordx4 v16, s[16:19], s41 offen offset:0  lds
  buffer_load_dwordx4 v17, s[16:19], s41 offen offset:1024  lds
  buffer_load_dwordx4 v18, s[16:19], s41 offen offset:2048  lds
  buffer_load_dwordx4 v19, s[16:19], s41 offen offset:3072  lds
  s_mov_b32 s63, 0
L_sp3:
  s_waitcnt lgkmcnt(0)
  s_xor_b64 s[10:11], s[64:65], s[8:9]
  s_xor_b64 s[14:15], s[66:67], s[8:9]
  s_or_b64 s[10:11], s[10:11], s[14:15]
  s_cbranch_scc0 L_ok3
  s_load_dwordx4 s[64:67], s[4:5], s43 glc
  s_add_u32 s63, s63, 1
  s_cmp_lt_u32 s63, 20000
  s_cbranch_scc1 L_sp3
  s_waitcnt lgkmcnt(0)
L_ok3:
  s_add_u32 s43, s40, 3
  s_lshl_b32 s43, s43, 9
  s_load_dwordx4 s[64:67], s[4:5], s43 glc
  s_xor_b32 s58, s40, 4
  s_cmp_ge_u32 s58, s36
  s_addc_u32 s58, s58, 0
  s_lshl_b32 s58, s58, 7
  s_load_dword s68, s[12:13], s58 offset:0
  s_load_dword s69, s[12:13], s58 offset:64
  s_load_dword s70, s[12:13], s58 offset:2048
  s_load_dword s71, s[12:13], s58 offset:2112
  s_load_dword s72, s[12:13], s58 offset:4096
  s_load_dword s73, s[12:13], s58 offset:4160
  s_add_u32 m0, s61, 0
  s_add_u32 s62, s40, 2
  s_lshl_b32 s62, s62, 14
  buffer_load_dwordx4 v20, s[28:31], s62 offen offset:0 sc1 lds
  buffer_load_dwordx4 v20, s[28:31], s62 offen offset:1024 sc1 lds
  buffer_load_dwordx4 v20, s[28:31], s62 offen offset:2048 sc1 lds
  buffer_load_dwordx4 v20, s[28:31], s62 offen offset:3072 sc1 lds
  s_waitcnt vmcnt(12)
  s_barrier
  s_add_u32 s41, s40, 3
  s_lshl_b32 s41, s41, 7
  s_add_u32 m0, s60, 49152
  s_nop 0
  buffer_load_dwordx4 v16, s[16:19], s41 offen offset:0  lds
  buffer_load_dwordx4 v17, s[16:19], s41 offen offset:1024  lds
  buffer_load_dwordx4 v18, s[16:19], s41 offen offset:2048  lds
  buffer_load_dwordx4 v19, s[16:19], s41 offen offset:3072  lds
  s_add_u32 m0, s60, 53248
  s_add_u32 s41, s41, 65536
  buffer_load_dwordx4 v16, s[16:19], s41 offen offset:0  lds
  buffer_load_dwordx4 v17, s[16:19], s41 offen offset:1024  lds
  buffer_load_dwordx4 v18, s[16:19], s41 offen offset:2048  lds
  buffer_load_dwordx4 v19, s[16:19], s41 offen offset:3072  lds
  s_mov_b32 s63, 0
L_sp4:
  s_waitcnt lgkmcnt(0)
  s_xor_b64 s[10:11], s[64:65], s[8:9]
  s_xor_b64 s[14:15], s[66:67], s[8:9]
  s_or_b64 s[10:11], s[10:11], s[14:15]
  s_cbranch_scc0 L_ok4
  s_load_dwordx4 s[64:67], s[4:5], s43 glc
  s_add_u32 s63, s63, 1
  s_cmp_lt_u32 s63, 20000
  s_cbranch_scc1 L_sp4
  s_waitcnt lgkmcnt(0)
L_ok4:
  s_xor_b32 s43, s40, 4
  s_cmp_ge_u32 s43, s36
  s_addc_u32 s43, s43, 0
  s_lshl_b32 s43, s43, 9
  s_load_dwordx4 s[64:67], s[4:5], s43 glc
  s_xor_b32 s58, s40, 5
  s_cmp_ge_u32 s58, s36
  s_addc_u32 s58, s58, 0
  s_lshl_b32 s58, s58, 7
  s_load_dword s68, s[12:13], s58 offset:0
  s_load_dword s69, s[12:13], s58 offset:64
  s_load_dword s70, s[12:13], s58 offset:2048
  s_load_dword s71, s[12:13], s58 offset:2112
  s_load_dword s72, s[12:13], s58 offset:4096
  s_load_dword s73, s[12:13], s58 offset:4160
  s_xor_b32 s58, s40, 6
  s_cmp_ge_u32 s58, s36
  s_addc_u32 s58, s58, 0
  s_lshl_b32 s58, s58, 7
  s_load_dword s68, s[12:13], s58 offset:0
  s_load_dword s69, s[12:13], s58 offset:64
  s_load_dword s70, s[12:13], s58 offset:2048
  s_load_dword s71, s[12:13], s58 offset:2112
  s_load_dword s72, s[12:13], s58 offset:4096
  s_load_dword s73, s[12:13], s58 offset:4160
  s_add_u32 m0, s61, 49152
  s_add_u32 s62, s40, 3
  s_lshl_b32 s62, s62, 14
  buffer_load_dwordx4 v20, s[28:31], s62 offen offset:0 sc1 lds
  buffer_load_dwordx4 v20, s[28:31], s62 offen offset:1024 sc1 lds
  buffer_load_dwordx4 v20, s[28:31], s62 offen offset:2048 sc1 lds
  buffer_load_dwordx4 v20, s[28:31], s62 offen offset:3072 sc1 lds
  s_waitcnt vmcnt(12)
  s_barrier
  s_xor_b32 s41, s40, 4
  s_cmp_ge_u32 s41, s36
  s_addc_u32 s41, s41, 0
  s_lshl_b32 s41, s41, 7
  s_add_u32 m0, s60, 98304
  s_nop 0
  buffer_load_dwordx4 v16, s[16:19], s41 offen offset:0  lds
  buffer_load_dwordx4 v17, s[16:19], s41 offen offset:1024  lds
  buffer_load_dwordx4 v18, s[16:19], s41 offen offset:2048  lds
  buffer_load_dwordx4 v19, s[16:19], s41 offen offset:3072  lds
  s_add_u32 m0, s60, 102400
  s_add_u32 s41, s41, 65536
  buffer_load_dwordx4 v16, s[16:19], s41 offen offset:0  lds
  buffer_load_dwordx4 v17, s[16:19], s41 offen offset:1024  lds
  buffer_load_dwordx4 v18, s[16:19], s41 offen offset:2048  lds
  buffer_load_dwordx4 v19, s[16:19], s41 offen offset:3072  lds
  s_mov_b32 s63, 0
L_sp5:
  s_waitcnt lgkmcnt(0)
  s_xor_b64 s[10:11], s[64:65], s[8:9]
  s_xor_b64 s[14:15], s[66:67], s[8:9]
  s_or_b64 s[10:11], s[10:11], s[14:15]
  s_cbranch_scc0 L_ok5
  s_load_dwordx4 s[64:67], s[4:5], s43 glc
  s_add_u32 s63, s63, 1
  s_cmp_lt_u32 s63, 20000
  s_cbranch_scc1 L_sp5
  s_waitcnt lgkmcnt(0)
L_ok5:
  s_xor_b32 s43, s40, 5
  s_cmp_ge_u32 s43, s36
  s_addc_u32 s43, s43, 0
  s_lshl_b32 s43, s43, 9
  s_load_dwordx4 s[64:67], s[4:5], s43 glc
  s_mov_b32 s58, 1024
  s_load_dword s68, s[12:13], s58 offset:0
  s_load_dword s69, s[12:13], s58 offset:64
  s_load_dword s70, s[12:13], s58 offset:2048
  s_load_dword s71, s[12:13], s58 offset:2112
  s_load_dword s72, s[12:13], s58 offset:4096
  s_load_dword s73, s[12:13], s58 offset:4160
  s_mov_b32 s58, 1152
  s_load_dword s68, s[12:13], s58 offset:0
  s_load_dword s69, s[12:13], s58 offset:64
  s_load_dword s70, s[12:13], s58 offset:2048
  s_load_dword s71, s[12:13], s58 offset:2112
  s_load_dword s72, s[12:13], s58 offset:4096
  s_load_dword s73, s[12:13], s58 offset:4160
  s_add_u32 m0, s61, 98304
  s_xor_b32 s62, s40, 4
  s_cmp_ge_u32 s62, s36
  s_addc_u32 s62, s62, 0
  s_lshl_b32 s62, s62, 14
  buffer_load_dwordx4 v20, s[28:31], s62 offen offset:0 sc1 lds
  buffer_load_dwordx4 v20, s[28:31], s62 offen offset:1024 sc1 lds
  buffer_load_dwordx4 v20, s[28:31], s62 offen offset:2048 sc1 lds
  buffer_load_dwordx4 v20, s[28:31], s62 offen offset:3072 sc1 lds
  s_waitcnt vmcnt(12)
  s_barrier
  s_xor_b32 s41, s40, 5
  s_cmp_ge_u32 s41, s36
  s_addc_u32 s41, s41, 0
  s_lshl_b32 s41, s41, 7
  s_add_u32 m0, s60, 0
  s_nop 0
  buffer_load_dwordx4 v16, s[16:19], s41 offen offset:0  lds
  buffer_load_dwordx4 v17, s[16:19], s41 offen offset:1024  lds
  buffer_load_dwordx4 v18, s[16:19], s41 offen offset:2048  lds
  buffer_load_dwordx4 v19, s[16:19], s41 offen offset:3072  lds
  s_add_u32 m0, s60, 4096
  s_add_u32 s41, s41, 65536
  buffer_load_dwordx4 v16, s[16:19], s41 offen offset:0  lds
  buffer_load_dwordx4 v17, s[16:19], s41 offen offset:1024  lds
  buffer_load_dwordx4 v18, s[16:19], s41 offen offset:2048  lds
  buffer_load_dwordx4 v19, s[16:19], s41 offen offset:3072  lds
  s_mov_b32 s63, 0
L_sp6:
  s_waitcnt lgkmcnt(0)
  s_xor_b64 s[10:11], s[64:65], s[8:9]
  s_xor_b64 s[14:15], s[66:67], s[8:9]
  s_or_b64 s[10:11], s[10:11], s[14:15]
  s_cbranch_scc0 L_ok6
  s_load_dwordx4 s[64:67], s[4:5], s43 glc
  s_add_u32 s63, s63, 1
  s_cmp_lt_u32 s63, 20000
  s_cbranch_scc1 L_sp6
  s_waitcnt lgkmcnt(0)
L_ok6:
  s_xor_b32 s43, s40, 6
  s_cmp_ge_u32 s43, s36
  s_addc_u32 s43, s43, 0
  s_lshl_b32 s43, s43, 9
  s_load_dwordx4 s[64:67], s[4:5], s43 glc
  s_mov_b32 s58, 1280
  s_load_dword s68, s[12:13], s58 offset:0
  s_load_dword s69, s[12:13], s58 offset:64
  s_load_dword s70, s[12:13], s58 offset:2048
  s_load_dword s71, s[12:13], s58 offset:2112
  s_load_dword s72, s[12:13], s58 offset:4096
  s_load_dword s73, s[12:13], s58 offset:4160
  s_add_u32 m0, s61, 0
  s_xor_b32 s62, s40, 5
  s_cmp_ge_u32 s62, s36
  s_addc_u32 s62, s62, 0
  s_lshl_b32 s62, s62, 14
  buffer_load_dwordx4 v20, s[28:31], s62 offen offset:0 sc1 lds
  buffer_load_dwordx4 v20, s[28:31], s62 offen offset:1024 sc1 lds
  buffer_load_dwordx4 v20, s[28:31], s62 offen offset:2048 sc1 lds
  buffer_load_dwordx4 v20, s[28:31], s62 offen offset:3072 sc1 lds
  s_waitcnt vmcnt(12)
  s_barrier
  s_xor_b32 s41, s40, 6
  s_cmp_ge_u32 s41, s36
  s_addc_u32 s41, s41, 0
  s_lshl_b32 s41, s41, 7
  s_add_u32 m0, s60, 49152
  s_nop 0
  buffer_load_dwordx4 v16, s[16:19], s41 offen offset:0  lds
  buffer_load_dwordx4 v17, s[16:19], s41 offen offset:1024  lds
  buffer_load_dwordx4 v18, s[16:19], s41 offen offset:2048  lds
  buffer_load_dwordx4 v19, s[16:19], s41 offen offset:3072  lds
  s_add_u32 m0, s60, 53248
  s_add_u32 s41, s41, 65536
  buffer_load_dwordx4 v16, s[16:19], s41 offen offset:0  lds
  buffer_load_dwordx4 v17, s[16:19], s41 offen offset:1024  lds
  buffer_load_dwordx4 v18, s[16:19], s41 offen offset:2048  lds
  buffer_load_dwordx4 v19, s[16:19], s41 offen offset:3072  lds
  s_mov_b32 s63, 0
L_sp7:
  s_waitcnt lgkmcnt(0)
  s_xor_b64 s[10:11], s[64:65], s[8:9]
  s_xor_b64 s[14:15], s[66:67], s[8:9]
  s_or_b64 s[10:11], s[10:11], s[14:15]
  s_cbranch_scc0 L_ok7
  s_load_dwordx4 s[64:67], s[4:5], s43 glc
  s_add_u32 s63, s63, 1
  s_cmp_lt_u32 s63, 20000
  s_cbranch_scc1 L_sp7
  s_waitcnt lgkmcnt(0)
L_ok7:
  s_mov_b32 s43, 4096
  s_load_dwordx4 s[64:67], s[4:5], s43 glc
  s_mov_b32 s58, 1408
  s_load_dword s68, s[12:13], s58 offset:0
  s_load_dword s69, s[12:13], s58 offset:64
  s_load_dword s70, s[12:13], s58 offset:2048
  s_load_dword s71, s[12:13], s58 offset:2112
  s_load_dword s72, s[12:13], s58 offset:4096
  s_load_dword s73, s[12:13], s58 offset:4160
  s_add_u32 m0, s61, 49152
  s_xor_b32 s62, s40, 6
  s_cmp_ge_u32 s62, s36
  s_addc_u32 s62, s62, 0
  s_lshl_b32 s62, s62, 14
  buffer_load_dwordx4 v20, s[28:31], s62 offen offset:0 sc1 lds
  buffer_load_dwordx4 v20, s[28:31], s62 offen offset:1024 sc1 lds
  buffer_load_dwordx4 v20, s[28:31], s62 offen offset:2048 sc1 lds
  buffer_load_dwordx4 v20, s[28:31], s62 offen offset:3072 sc1 lds
  s_waitcnt vmcnt(12)
  s_barrier
  s_mov_b32 s41, 1024
  s_add_u32 m0, s60, 98304
  s_nop 0
  buffer_load_dwordx4 v16, s[16:19], s41 offen offset:0  lds
  buffer_load_dwordx4 v17, s[16:19], s41 offen offset:1024  lds
  buffer_load_dwordx4 v18, s[16:19], s41 offen offset:2048  lds
  buffer_load_dwordx4 v19, s[16:19], s41 offen offset:3072  lds
  s_add_u32 m0, s60, 102400
  s_add_u32 s41, s41, 65536
  buffer_load_dwordx4 v16, s[16:19], s41 offen offset:0  lds
  buffer_load_dwordx4 v17, s[16:19], s41 offen offset:1024  lds
  buffer_load_dwordx4 v18, s[16:19], s41 offen offset:2048  lds
  buffer_load_dwordx4 v19, s[16:19], s41 offen offset:3072  lds
  s_mov_b32 s63, 0
L_sp8:
  s_waitcnt lgkmcnt(0)
  s_xor_b64 s[10:11], s[64:65], s[8:9]
  s_xor_b64 s[14:15], s[66:67], s[8:9]
  s_or_b64 s[10:11], s[10:11], s[14:15]
  s_cbranch_scc0 L_ok8
  s_load_dwordx4 s[64:67], s[4:5], s43 glc
  s_add_u32 s63, s63, 1
  s_cmp_lt_u32 s63, 20000
  s_cbranch_scc1 L_sp8
  s_waitcnt lgkmcnt(0)
L_ok8:
  s_mov_b32 s43, 4608
  s_load_dwordx4 s[64:67], s[4:5], s43 glc
  s_mov_b32 s58, 1536
  s_load_dword s68, s[12:13], s58 offset:0
  s_load_dword s69, s[12:13], s58 offset:64
  s_load_dword s70, s[12:13], s58 offset:2048
  s_load_dword s71, s[12:13], s58 offset:2112
  s_load_dword s72, s[12:13], s58 offset:4096
  s_load_dword s73, s[12:13], s58 offset:4160
  s_add_u32 m0, s61, 98304
  s_mov_b32 s62, 131072
  buffer_load_dwordx4 v20, s[28:31], s62 offen offset:0 sc1 lds
  buffer_load_dwordx4 v20, s[28:31], s62 offen offset:1024 sc1 lds
  buffer_load_dwordx4 v20, s[28:31], s62 offen offset:2048 sc1 lds
  buffer_load_dwordx4 v20, s[28:31], s62 offen offset:3072 sc1 lds
  s_waitcnt vmcnt(12)
  s_barrier
  s_mov_b32 s41, 1152
  s_add_u32 m0, s60, 0
  s_nop 0
  buffer_load_dwordx4 v16, s[16:19], s41 offen offset:0  lds
  buffer_load_dwordx4 v17, s[16:19], s41 offen offset:1024  lds
  buffer_load_dwordx4 v18, s[16:19], s41 offen offset:2048  lds
  buffer_load_dwordx4 v19, s[16:19], s41 offen offset:3072  lds
  s_add_u32 m0, s60, 4096
  s_add_u32 s41, s41, 65536
  buffer_load_dwordx4 v16, s[16:19], s41 offen offset:0  lds
  buffer_load_dwordx4 v17, s[16:19], s41 offen offset:1024  lds
  buffer_load_dwordx4 v18, s[16:19], s41 offen offset:2048  lds
  buffer_load_dwordx4 v19, s[16:19], s41 offen offset:3072  lds
  s_mov_b32 s63, 0
L_sp9:
  s_waitcnt lgkmcnt(0)
  s_xor_b64 s[10:11], s[64:65], s[8:9]
  s_xor_b64 s[14:15], s[66:67], s[8:9]
  s_or_b64 s[10:11], s[10:11], s[14:15]
  s_cbranch_scc0 L_ok9
  s_load_dwordx4 s[64:67], s[4:5], s43 glc
  s_add_u32 s63, s63, 1
  s_cmp_lt_u32 s63, 20000
  s_cbranch_scc1 L_sp9
  s_waitcnt lgkmcnt(0)
L_ok9:
  s_mov_b32 s43, 5120
  s_load_dwordx4 s[64:67], s[4:5], s43 glc
  s_mov_b32 s58, 1664
  s_load_dword s68, s[12:13], s58 offset:0
  s_load_dword s69, s[12:13], s58 offset:64
  s_load_dword s70, s[12:13], s58 offset:2048
  s_load_dword s71, s[12:13], s58 offset:2112
  s_load_dword s72, s[12:13], s58 offset:4096
  s_load_dword s73, s[12:13], s58 offset:4160
  s_add_u32 m0, s61, 0
  s_mov_b32 s62, 147456
  buffer_load_dwordx4 v20, s[28:31], s62 offen offset:0 sc1 lds
  buffer_load_dwordx4 v20, s[28:31], s62 offen offset:1024 sc1 lds
  buffer_load_dwordx4 v20, s[28:31], s62 offen offset:2048 sc1 lds
  buffer_load_dwordx4 v20, s[28:31], s62 offen offset:3072 sc1 lds
  s_waitcnt vmcnt(12)
  s_barrier
  s_mov_b32 s41, 1280
  s_add_u32 m0, s60, 49152
  s_nop 0
  buffer_load_dwordx4 v16, s[16:19], s41 offen offset:0  lds
  buffer_load_dwordx4 v17, s[16:19], s41 offen offset:1024  lds
  buffer_load_dwordx4 v18, s[16:19], s41 offen offset:2048  lds
  buffer_load_dwordx4 v19, s[16:19], s41 offen offset:3072  lds
  s_add_u32 m0, s60, 53248
  s_add_u32 s41, s41, 65536
  buffer_load_dwordx4 v16, s[16:19], s41 offen offset:0  lds
  buffer_load_dwordx4 v17, s[16:19], s41 offen offset:1024  lds
  buffer_load_dwordx4 v18, s[16:19], s41 offen offset:2048  lds
  buffer_load_dwordx4 v19, s[16:19], s41 offen offset:3072  lds
  s_mov_b32 s63, 0
L_sp10:
  s_waitcnt lgkmcnt(0)
  s_xor_b64 s[10:11], s[64:65], s[8:9]
  s_xor_b64 s[14:15], s[66:67], s[8:9]
  s_or_b64 s[10:11], s[10:11], s[14:15]
  s_cbranch_scc0 L_ok10
  s_load_dwordx4 s[64:67], s[4:5], s43 glc
  s_add_u32 s63, s63, 1
  s_cmp_lt_u32 s63, 20000
  s_cbranch_scc1 L_sp10
  s_waitcnt lgkmcnt(0)
L_ok10:
  s_mov_b32 s43, 5632
  s_load_dwordx4 s[64:67], s[4:5], s43 glc
  s_mov_b32 s58, 1792
  s_load_dword s68, s[12:13], s58 offset:0
  s_load_dword s69, s[12:13], s58 offset:64
  s_load_dword s70, s[12:13], s58 offset:2048
  s_load_dword s71, s[12:13], s58 offset:2112
  s_load_dword s72, s[12:13], s58 offset:4096
  s_load_dword s73, s[12:13], s58 offset:4160
  s_add_u32 m0, s61, 49152
  s_mov_b32 s62, 163840
  buffer_load_dwordx4 v20, s[28:31], s62 offen offset:0 sc1 lds
  buffer_load_dwordx4 v20, s[28:31], s62 offen offset:1024 sc1 lds
  buffer_load_dwordx4 v20, s[28:31], s62 offen offset:2048 sc1 lds
  buffer_load_dwordx4 v20, s[28:31], s62 offen offset:3072 sc1 lds
  s_waitcnt vmcnt(12)
  s_barrier
  s_mov_b32 s41, 1408
  s_add_u32 m0, s60, 98304
  s_nop 0
  buffer_load_dwordx4 v16, s[16:19], s41 offen offset:0  lds
  buffer_load_dwordx4 v17, s[16:19], s41 offen offset:1024  lds
  buffer_load_dwordx4 v18, s[16:19], s41 offen offset:2048  lds
  buffer_load_dwordx4 v19, s[16:19], s41 offen offset:3072  lds
  s_add_u32 m0, s60, 102400
  s_add_u32 s41, s41, 65536
  buffer_load_dwordx4 v16, s[16:19], s41 offen offset:0  lds
  buffer_load_dwordx4 v17, s[16:19], s41 offen offset:1024  lds
  buffer_load_dwordx4 v18, s[16:19], s41 offen offset:2048  lds
  buffer_load_dwordx4 v19, s[16:19], s41 offen offset:3072  lds
  s_mov_b32 s63, 0
L_sp11:
  s_waitcnt lgkmcnt(0)
  s_xor_b64 s[10:11], s[64:65], s[8:9]
  s_xor_b64 s[14:15], s[66:67], s[8:9]
  s_or_b64 s[10:11], s[10:11], s[14:15]
  s_cbranch_scc0 L_ok11
  s_load_dwordx4 s[64:67], s[4:5], s43 glc
  s_add_u32 s63, s63, 1
  s_cmp_lt_u32 s63, 20000
  s_cbranch_scc1 L_sp11
  s_waitcnt lgkmcnt(0)
L_ok11:
  s_mov_b32 s43, 6144
  s_load_dwordx4 s[64:67], s[4:5], s43 glc
  s_mov_b32 s58, 1920
  s_load_dword s68, s[12:13], s58 offset:0
  s_load_dword s69, s[12:13], s58 offset:64
  s_load_dword s70, s[12:13], s58 offset:2048
  s_load_dword s71, s[12:13], s58 offset:2112
  s_load_dword s72, s[12:13], s58 offset:4096
  s_load_dword s73, s[12:13], s58 offset:4160
  s_add_u32 m0, s61, 98304
  s_mov_b32 s62, 180224
  buffer_load_dwordx4 v20, s[28:31], s62 offen offset:0 sc1 lds
  buffer_load_dwordx4 v20, s[28:31], s62 offen offset:1024 sc1 lds
  buffer_load_dwordx4 v20, s[28:31], s62 offen offset:2048 sc1 lds
  buffer_load_dwordx4 v20, s[28:31], s62 offen offset:3072 sc1 lds
  s_waitcnt vmcnt(12)
  s_barrier
  s_mov_b32 s41, 1536
  s_add_u32 m0, s60, 0
  s_nop 0
  buffer_load_dwordx4 v16, s[16:19], s41 offen offset:0  lds
  buffer_load_dwordx4 v17, s[16:19], s41 offen offset:1024  lds
  buffer_load_dwordx4 v18, s[16:19], s41 offen offset:2048  lds
  buffer_load_dwordx4 v19, s[16:19], s41 offen offset:3072  lds
  s_add_u32 m0, s60, 4096
  s_add_u32 s41, s41, 65536
  buffer_load_dwordx4 v16, s[16:19], s41 offen offset:0  lds
  buffer_load_dwordx4 v17, s[16:19], s41 offen offset:1024  lds
  buffer_load_dwordx4 v18, s[16:19], s41 offen offset:2048  lds
  buffer_load_dwordx4 v19, s[16:19], s41 offen offset:3072  lds
  s_mov_b32 s63, 0
L_sp12:
  s_waitcnt lgkmcnt(0)
  s_xor_b64 s[10:11], s[64:65], s[8:9]
  s_xor_b64 s[14:15], s[66:67], s[8:9]
  s_or_b64 s[10:11], s[10:11], s[14:15]
  s_cbranch_scc0 L_ok12
  s_load_dwordx4 s[64:67], s[4:5], s43 glc
  s_add_u32 s63, s63, 1
  s_cmp_lt_u32 s63, 20000
  s_cbranch_scc1 L_sp12
  s_waitcnt lgkmcnt(0)
L_ok12:
  s_mov_b32 s43, 6656
  s_load_dwordx4 s[64:67], s[4:5], s43 glc
  s_add_u32 m0, s61, 0
  s_mov_b32 s62, 196608
  buffer_load_dwordx4 v20, s[28:31], s62 offen offset:0 sc1 lds
  buffer_load_dwordx4 v20, s[28:31], s62 offen offset:1024 sc1 lds
  buffer_load_dwordx4 v20, s[28:31], s62 offen offset:2048 sc1 lds
  buffer_load_dwordx4 v20, s[28:31], s62 offen offset:3072 sc1 lds
  s_waitcnt vmcnt(12)
  s_barrier
  s_mov_b32 s41, 1664
  s_add_u32 m0, s60, 49152
  s_nop 0
  buffer_load_dwordx4 v16, s[16:19], s41 offen offset:0  lds
  buffer_load_dwordx4 v17, s[16:19], s41 offen offset:1024  lds
  buffer_load_dwordx4 v18, s[16:19], s41 offen offset:2048  lds
  buffer_load_dwordx4 v19, s[16:19], s41 offen offset:3072  lds
  s_add_u32 m0, s60, 53248
  s_add_u32 s41, s41, 65536
  buffer_load_dwordx4 v16, s[16:19], s41 offen offset:0  lds
  buffer_load_dwordx4 v17, s[16:19], s41 offen offset:1024  lds
  buffer_load_dwordx4 v18, s[16:19], s41 offen offset:2048  lds
  buffer_load_dwordx4 v19, s[16:19], s41 offen offset:3072  lds
  s_mov_b32 s63, 0
L_sp13:
  s_waitcnt lgkmcnt(0)
  s_xor_b64 s[10:11], s[64:65], s[8:9]
  s_xor_b64 s[14:15], s[66:67], s[8:9]
  s_or_b64 s[10:11], s[10:11], s[14:15]
  s_cbranch_scc0 L_ok13
  s_load_dwordx4 s[64:67], s[4:5], s43 glc
  s_add_u32 s63, s63, 1
  s_cmp_lt_u32 s63, 20000
  s_cbranch_scc1 L_sp13
  s_waitcnt lgkmcnt(0)
L_ok13:
  s_mov_b32 s43, 7168
  s_load_dwordx4 s[64:67], s[4:5], s43 glc
  s_add_u32 m0, s61, 49152
  s_mov_b32 s62, 212992
  buffer_load_dwordx4 v20, s[28:31], s62 offen offset:0 sc1 lds
  buffer_load_dwordx4 v20, s[28:31], s62 offen offset:1024 sc1 lds
  buffer_load_dwordx4 v20, s[28:31], s62 offen offset:2048 sc1 lds
  buffer_load_dwordx4 v20, s[28:31], s62 offen offset:3072 sc1 lds
  s_waitcnt vmcnt(12)
  s_barrier
  s_mov_b32 s41, 1792
  s_add_u32 m0, s60, 98304
  s_nop 0
  buffer_load_dwordx4 v16, s[16:19], s41 offen offset:0  lds
  buffer_load_dwordx4 v17, s[16:19], s41 offen offset:1024  lds
  buffer_load_dwordx4 v18, s[16:19], s41 offen offset:2048  lds
  buffer_load_dwordx4 v19, s[16:19], s41 offen offset:3072  lds
  s_add_u32 m0, s60, 102400
  s_add_u32 s41, s41, 65536
  buffer_load_dwordx4 v16, s[16:19], s41 offen offset:0  lds
  buffer_load_dwordx4 v17, s[16:19], s41 offen offset:1024  lds
  buffer_load_dwordx4 v18, s[16:19], s41 offen offset:2048  lds
  buffer_load_dwordx4 v19, s[16:19], s41 offen offset:3072  lds
  s_mov_b32 s63, 0
L_sp14:
  s_waitcnt lgkmcnt(0)
  s_xor_b64 s[10:11], s[64:65], s[8:9]
  s_xor_b64 s[14:15], s[66:67], s[8:9]
  s_or_b64 s[10:11], s[10:11], s[14:15]
  s_cbranch_scc0 L_ok14
  s_load_dwordx4 s[64:67], s[4:5], s43 glc
  s_add_u32 s63, s63, 1
  s_cmp_lt_u32 s63, 20000
  s_cbranch_scc1 L_sp14
  s_waitcnt lgkmcnt(0)
L_ok14:
  s_mov_b32 s43, 7680
  s_load_dwordx4 s[64:67], s[4:5], s43 glc
  s_add_u32 m0, s61, 98304
  s_mov_b32 s62, 229376
  buffer_load_dwordx4 v20, s[28:31], s62 offen offset:0 sc1 lds
  buffer_load_dwordx4 v20, s[28:31], s62 offen offset:1024 sc1 lds
  buffer_load_dwordx4 v20, s[28:31], s62 offen offset:2048 sc1 lds
  buffer_load_dwordx4 v20, s[28:31], s62 offen offset:3072 sc1 lds
  s_mov_b32 s41, 1920
  s_lshr_b32 s53, s60, 1
  s_add_u32 m0, s53, 147456
  s_nop 0
  buffer_load_dwordx4 v16, s[16:19], s41 offen offset:0  lds
  buffer_load_dwordx4 v17, s[16:19], s41 offen offset:1024  lds
  buffer_load_dwordx4 v18, s[16:19], s41 offen offset:2048  lds
  buffer_load_dwordx4 v19, s[16:19], s41 offen offset:3072  lds
  s_waitcnt vmcnt(16)
  s_barrier
  s_mov_b32 s63, 0
L_sp15:
  s_waitcnt lgkmcnt(0)
  s_xor_b64 s[10:11], s[64:65], s[8:9]
  s_xor_b64 s[14:15], s[66:67], s[8:9]
  s_or_b64 s[10:11], s[10:11], s[14:15]
  s_cbranch_scc0 L_ok15
  s_load_dwordx4 s[64:67], s[4:5], s43 glc
  s_add_u32 s63, s63, 1
  s_cmp_lt_u32 s63, 20000
  s_cbranch_scc1 L_sp15
  s_waitcnt lgkmcnt(0)
L_ok15:
  s_add_u32 m0, s61, 0
  s_mov_b32 s62, 245760
  buffer_load_dwordx4 v20, s[28:31], s62 offen offset:0 sc1 lds
  buffer_load_dwordx4 v20, s[28:31], s62 offen offset:2048 sc1 lds
  s_waitcnt vmcnt(6)
  s_barrier
  s_add_u32 m0, s61, 0
  s_mov_b32 s62, 245760
  buffer_load_dwordx4 v20, s[28:31], s62 offen offset:1024 sc1 lds
  buffer_load_dwordx4 v20, s[28:31], s62 offen offset:3072 sc1 lds
  s_add_u32 m0, s60, 4096
  s_add_u32 s41, s41, 65536
  buffer_load_dwordx4 v16, s[16:19], s41 offen offset:0  lds
  buffer_load_dwordx4 v17, s[16:19], s41 offen offset:1024  lds
  buffer_load_dwordx4 v18, s[16:19], s41 offen offset:2048  lds
  buffer_load_dwordx4 v19, s[16:19], s41 offen offset:3072  lds
  s_waitcnt vmcnt(6)
  s_barrier
  s_waitcnt vmcnt(0)
  s_barrier
  s_endpgm
L_prod:
  s_mov_b32 s30, 9457664
  s_mov_b32 s31, 0x20000
  s_mov_b32 s18, 4194304
  s_mov_b32 s19, 0x20000
  s_mov_b32 s34, 14680064
  s_mov_b32 s35, 0x20000
  v_and_b32 v2, 63, v0
  v_lshlrev_b32 v5, 2, v3
  s_and_b32 s39, s38, 3
  s_mov_b32 s56, 917504
  s_mov_b32 s57, 16384
  s_mov_b32 s58, 512
  s_mov_b32 s59, 0
  s_mov_b32 s55, 7
  v_mov_b32 v15, 0x7ff00000
  s_cmp_lt_u32 s2, 28
  s_cbranch_scc1 L_pp
  s_mov_b32 s56, 512
  s_mov_b32 s57, 262144
  s_mov_b32 s58, 8192
  s_mov_b32 s59, 4096
  s_mov_b32 s51, 6
L_pl:
  s_add_u32 m0, m0, 4096
  v_add_u32 v16, 256, v16
  s_sub_u32 s51, s51, 1
  buffer_load_dword v16, s[24:27], 0 offen lds
  buffer_load_dword v16, s[24:27], s50 offen offset:256 lds
  s_cmp_lg_u32 s51, 0
  s_cbranch_scc1 L_pl
  s_waitcnt vmcnt(0)
  s_branch L_pq
L_pp:
  s_mov_b32 s22, 13762560
L_pq:
  s_add_u32 s10, s28, 9437184
  s_addc_u32 s11, s29, 0
  s_load_dwordx2 s[6:7], s[10:11], 0
  s_lshl_b32 s53, s38, 11
  s_add_u32 s53, s53, 32768
  v_lshrrev_b32 v1, 4, v3
  v_lshlrev_b32 v1, 10, v1
  v_lshl_add_u32 v1, v9, 3, v1
  v_and_b32 v6, 15, v3
  v_lshl_add_u32 v6, v6, 4, v1
  v_add_u32 v6, s53, v6
  v_lshl_add_u32 v7, v2, 4, s53
  s_lshl_b32 s53, s37, 18
  s_lshl_b32 s54, s52, 11
  s_add_u32 s53, s53, s54
  v_lshl_add_u32 v8, v2, 4, s53
  s_lshl_b32 s53, s37, 6
  s_lshr_b32 s54, s52, 1
  s_add_u32 s53, s53, s54
  s_lshl_b32 s53, s53, 7
  s_and_b32 s54, s52, 1
  s_lshl_b32 s54, s54, 3
  s_add_u32 s53, s53, s54
  s_add_u32 s53, s53, 7340032
  v_lshl_add_u32 v14, v2, 7, s53
  s_waitcnt vmcnt(0)
  buffer_load_dwordx4 v[32:35], v4, s[20:23], 0 offen nt
  buffer_load_dwordx4 v[36:39], v4, s[20:23], s45 offen nt
  buffer_load_dwordx4 v[40:43], v4, s[20:23], s46 offen nt
  buffer_load_dwordx4 v[44:47], v4, s[20:23], s47 offen nt
  v_add_u32 v4, s56, v4
  buffer_load_dword v17, v15, s[20:23], 0 offen
  buffer_load_dword v17, v15, s[20:23], 0 offen
  buffer_load_dwordx4 v[48:51], v4, s[20:23], 0 offen nt
  buffer_load_dwordx4 v[52:55], v4, s[20:23], s45 offen nt
  buffer_load_dwordx4 v[56:59], v4, s[20:23], s46 offen nt
  buffer_load_dwordx4 v[60:63], v4, s[20:23], s47 offen nt
  v_add_u32 v4, s56, v4
  s_waitcnt lgkmcnt(0)
  s_mul_i32 s8, s6, 1664525
  s_mul_i32 s9, s7, 22695477
  s_add_u32 s8, s8, 1013904223
  s_add_u32 s9, s9, 1
  v_mov_b32 v10, s8
  v_mov_b32 v11, s9
  s_mov_b32 s60, 0
  s_mov_b32 s61, 0
  s_mov_b32 s62, 0
  s_waitcnt vmcnt(10)
  s_barrier
L_p:
  s_waitcnt vmcnt(9)
  v_lshl_add_u32 v32, v32, 8, v5
  v_lshl_add_u32 v33, v33, 8, v5
  v_lshl_add_u32 v34, v34, 8, v5
  v_lshl_add_u32 v35, v35, 8, v5
  ds_read_u16 v96, v32 offset:0
  ds_read_u16 v97, v33 offset:2
  ds_read_u16 v98, v34 offset:128
  ds_read_u16 v99, v35 offset:130
  s_waitcnt vmcnt(8)
  v_lshl_add_u32 v36, v36, 8, v5
  v_lshl_add_u32 v37, v37, 8, v5
  v_lshl_add_u32 v38, v38, 8, v5
  v_lshl_add_u32 v39, v39, 8, v5
  ds_read_u16 v100, v36 offset:0
  ds_read_u16 v101, v37 offset:2
  ds_read_u16 v102, v38 offset:128
  ds_read_u16 v103, v39 offset:130
  s_waitcnt vmcnt(7)
  v_lshl_add_u32 v40, v40, 8, v5
  v_lshl_add_u32 v41, v41, 8, v5
  v_lshl_add_u32 v42, v42, 8, v5
  v_lshl_add_u32 v43, v43, 8, v5
  ds_read_u16 v104, v40 offset:0
  ds_read_u16 v105, v41 offset:2
  ds_read_u16 v106, v42 offset:128
  ds_read_u16 v107, v43 offset:130
  s_waitcnt vmcnt(6)
  v_lshl_add_u32 v44, v44, 8, v5
  v_lshl_add_u32 v45, v45, 8, v5
  v_lshl_add_u32 v46, v46, 8, v5
  v_lshl_add_u32 v47, v47, 8, v5
  ds_read_u16 v108, v44 offset:0
  ds_read_u16 v109, v45 offset:2
  ds_read_u16 v110, v46 offset:128
  ds_read_u16 v111, v47 offset:130
  s_cmp_eq_u32 s62, 0
  s_cbranch_scc1 L_pa0
  s_waitcnt vmcnt(4)
  s_mov_b64 exec, 1
  buffer_store_dwordx2 v[10:11], v14, s[28:31], s61 offen sc1
  s_mov_b64 exec, -1
  s_add_u32 s61, s61, s58
L_pa0:
  s_waitcnt lgkmcnt(8)
  v_lshl_or_b32 v112, v100, 16, v96
  v_lshl_or_b32 v114, v101, 16, v97
  v_lshl_or_b32 v116, v102, 16, v98
  v_lshl_or_b32 v118, v103, 16, v99
  s_waitcnt lgkmcnt(3)
  v_lshl_or_b32 v113, v108, 16, v104
  ds_write_b64 v6, v[112:113] offset:0
  s_waitcnt lgkmcnt(3)
  v_lshl_or_b32 v115, v109, 16, v105
  ds_write_b64 v6, v[114:115] offset:256
  s_waitcnt lgkmcnt(3)
  v_lshl_or_b32 v117, v110, 16, v106
  ds_write_b64 v6, v[116:117] offset:512
  s_waitcnt lgkmcnt(3)
  v_lshl_or_b32 v119, v111, 16, v107
  ds_write_b64 v6, v[118:119] offset:768
  s_waitcnt lgkmcnt(0)
  ds_read_b128 v[120:123], v7 offset:0
  ds_read_b128 v[124:127], v7 offset:1024
  s_waitcnt lgkmcnt(1)
  buffer_store_dwordx4 v[120:123], v8, s[28:31], s60 offen offset:0 sc1
  s_waitcnt lgkmcnt(0)
  buffer_store_dwordx4 v[124:127], v8, s[28:31], s60 offen offset:1024 sc1
  buffer_load_dwordx4 v[32:35], v4, s[20:23], 0 offen nt
  buffer_load_dwordx4 v[36:39], v4, s[20:23], s45 offen nt
  buffer_load_dwordx4 v[40:43], v4, s[20:23], s46 offen nt
  buffer_load_dwordx4 v[44:47], v4, s[20:23], s47 offen nt
  v_add_u32 v4, s56, v4
  v_add_u32 v5, s59, v5
  s_add_u32 s62, s62, 1
  s_add_u32 s60, s60, s57
  s_cmp_lt_u32 s62, s55
  s_cbranch_scc0 L_pe
  s_waitcnt vmcnt(9)
  v_lshl_add_u32 v48, v48, 8, v5
  v_lshl_add_u32 v49, v49, 8, v5
  v_lshl_add_u32 v50, v50, 8, v5
  v_lshl_add_u32 v51, v51, 8, v5
  ds_read_u16 v96, v48 offset:0
  ds_read_u16 v97, v49 offset:2
  ds_read_u16 v98, v50 offset:128
  ds_read_u16 v99, v51 offset:130
  s_waitcnt vmcnt(8)
  v_lshl_add_u32 v52, v52, 8, v5
  v_lshl_add_u32 v53, v53, 8, v5
  v_lshl_add_u32 v54, v54, 8, v5
  v_lshl_add_u32 v55, v55, 8, v5
  ds_read_u16 v100, v52 offset:0
  ds_read_u16 v101, v53 offset:2
  ds_read_u16 v102, v54 offset:128
  ds_read_u16 v103, v55 offset:130
  s_waitcnt vmcnt(7)
  v_lshl_add_u32 v56, v56, 8, v5
  v_lshl_add_u32 v57, v57, 8, v5
  v_lshl_add_u32 v58, v58, 8, v5
  v_lshl_add_u32 v59, v59, 8, v5
  ds_read_u16 v104, v56 offset:0
  ds_read_u16 v105, v57 offset:2
  ds_read_u16 v106, v58 offset:128
  ds_read_u16 v107, v59 offset:130
  s_waitcnt vmcnt(6)
  v_lshl_add_u32 v60, v60, 8, v5
  v_lshl_add_u32 v61, v61, 8, v5
  v_lshl_add_u32 v62, v62, 8, v5
  v_lshl_add_u32 v63, v63, 8, v5
  ds_read_u16 v108, v60 offset:0
  ds_read_u16 v109, v61 offset:2
  ds_read_u16 v110, v62 offset:128
  ds_read_u16 v111, v63 offset:130
  s_cmp_eq_u32 s62, 0
  s_cbranch_scc1 L_pa1
  s_waitcnt vmcnt(4)
  s_mov_b64 exec, 1
  buffer_store_dwordx2 v[10:11], v14, s[28:31], s61 offen sc1
  s_mov_b64 exec, -1
  s_add_u32 s61, s61, s58
L_pa1:
  s_waitcnt lgkmcnt(8)
  v_lshl_or_b32 v112, v100, 16, v96
  v_lshl_or_b32 v114, v101, 16, v97
  v_lshl_or_b32 v116, v102, 16, v98
  v_lshl_or_b32 v118, v103, 16, v99
  s_waitcnt lgkmcnt(3)
  v_lshl_or_b32 v113, v108, 16, v104
  ds_write_b64 v6, v[112:113] offset:0
  s_waitcnt lgkmcnt(3)
  v_lshl_or_b32 v115, v109, 16, v105
  ds_write_b64 v6, v[114:115] offset:256
  s_waitcnt lgkmcnt(3)
  v_lshl_or_b32 v117, v110, 16, v106
  ds_write_b64 v6, v[116:117] offset:512
  s_waitcnt lgkmcnt(3)
  v_lshl_or_b32 v119, v111, 16, v107
  ds_write_b64 v6, v[118:119] offset:768
  s_waitcnt lgkmcnt(0)
  ds_read_b128 v[128:131], v7 offset:0
  ds_read_b128 v[132:135], v7 offset:1024
  s_waitcnt lgkmcnt(1)
  buffer_store_dwordx4 v[128:131], v8, s[28:31], s60 offen offset:0 sc1
  s_waitcnt lgkmcnt(0)
  buffer_store_dwordx4 v[132:135], v8, s[28:31], s60 offen offset:1024 sc1
  buffer_load_dwordx4 v[48:51], v4, s[20:23], 0 offen nt
  buffer_load_dwordx4 v[52:55], v4, s[20:23], s45 offen nt
  buffer_load_dwordx4 v[56:59], v4, s[20:23], s46 offen nt
  buffer_load_dwordx4 v[60:63], v4, s[20:23], s47 offen nt
  v_add_u32 v4, s56, v4
  v_add_u32 v5, s59, v5
  s_add_u32 s62, s62, 1
  s_add_u32 s60, s60, s57
  s_cmp_lt_u32 s62, s55
  s_cbranch_scc1 L_p
L_pe:
  s_waitcnt vmcnt(4)
  s_mov_b64 exec, 1
  buffer_store_dwordx2 v[10:11], v14, s[28:31], s61 offen sc1
  s_mov_b64 exec, -1
  s_cmp_eq_u32 s38, 0
  s_cbranch_scc0 L_pz
  s_lshl_b32 s3, s2, 6
  s_add_u32 s3, s3, 9441280
  v_mov_b32 v12, s3
  s_mov_b64 exec, 1
  buffer_store_dwordx2 v[10:11], v12, s[28:31], 0 offen sc1
  s_mov_b64 exec, -1
  s_cmp_eq_u32 s2, 0
  s_cbranch_scc0 L_pz
  s_mov_b32 s63, 0
  v_lshlrev_b32 v12, 6, v2
  v_add_u32 v12, 9441280, v12
L_pw:
  s_mov_b32 s53, 0
  buffer_load_dwordx2 v[20:21], v12, s[28:31], s53 offen sc1
  s_mov_b32 s53, 4096
  buffer_load_dwordx2 v[22:23], v12, s[28:31], s53 offen sc1
  s_mov_b32 s53, 8192
  buffer_load_dwordx2 v[24:25], v12, s[28:31], s53 offen sc1
  s_mov_b32 s53, 12288
  buffer_load_dwordx2 v[26:27], v12, s[28:31], s53 offen sc1
  s_add_u32 s63, s63, 1
  s_waitcnt vmcnt(0)
  v_cmp_ne_u64 s[52:53], v[20:21], v[10:11]
  v_cmp_ne_u64 vcc, v[22:23], v[10:11]
  s_or_b64 s[52:53], s[52:53], vcc
  v_cmp_ne_u64 vcc, v[24:25], v[10:11]
  s_or_b64 s[52:53], s[52:53], vcc
  v_cmp_ne_u64 vcc, v[26:27], v[10:11]
  s_or_b64 s[52:53], s[52:53], vcc
  s_cbranch_scc0 L_pv
  s_cmp_lt_u32 s63, 20000
  s_cbranch_scc1 L_pw
L_pv:
  v_mov_b32 v12, 9437184
  s_mov_b64 exec, 1
  buffer_store_dwordx2 v[10:11], v12, s[28:31], 0 offen sc1
  s_mov_b64 exec, -1
L_pz:
L_drain:
  s_waitcnt vmcnt(0)
L_done:
  s_endpgm
L_end:
.section .rodata,"a"
.p2align 6
.amdhsa_kernel standalone__weight_only_int_squeezellm__prompt_kernel
  .amdhsa_next_free_vgpr 256
  .amdhsa_next_free_sgpr 102
  .amdhsa_accum_offset 160
  .amdhsa_group_segment_fixed_size 0
  .amdhsa_kernarg_size 48
  .amdhsa_user_sgpr_count 2
  .amdhsa_user_sgpr_kernarg_segment_ptr 1
  .amdhsa_system_sgpr_workgroup_id_x 1
.end_amdhsa_kernel
```

```asm
; @launch grid=(256,1,1) block=(512,1,1) lds=163840
.amdgcn_target "amdgcn-amd-amdhsa--gfx950"
.text
.globl standalone__weight_only_int_squeezellm__prompt_kernel
.p2align 8
.type standalone__weight_only_int_squeezellm__prompt_kernel,@function
standalone__weight_only_int_squeezellm__prompt_kernel:
  s_cmp_ge_u32 s2, 256
  s_cbranch_scc1 L_done
  s_load_dwordx2 s[24:25], s[0:1], 16
  s_load_dwordx2 s[20:21], s[0:1], 8
  s_load_dwordx2 s[28:29], s[0:1], 40
  s_load_dwordx2 s[16:17], s[0:1], 0
  s_load_dwordx2 s[32:33], s[0:1], 24
  s_and_b32 s3, s2, 1
  s_bfe_u32 s36, s2, 0x20003
  s_lshl2_add_u32 s36, s3, s36
  s_bfe_u32 s3, s2, 0x20001
  s_mul_i32 s3, s3, 7
  s_lshr_b32 s37, s2, 5
  s_add_u32 s37, s37, s3
  s_sub_u32 s37, s37, 1
  s_sub_u32 s3, s2, 28
  s_mul_i32 s53, s3, 7
  s_cmp_lt_u32 s3, 4
  s_cselect_b32 s51, 15, 8
  s_cselect_b32 s53, s53, s2
  s_cmp_lt_u32 s2, 32
  s_cselect_b32 s36, s51, s36
  s_cselect_b32 s37, s53, s37
  s_cselect_b32 s51, 0, 147456
  v_lshrrev_b32 v1, 6, v0
  v_and_b32 v3, 31, v0
  v_readfirstlane_b32 s38, v1
  v_bfe_u32 v9, v0, 5, 1
  s_mov_b32 s26, 114688
  s_mov_b32 s27, 0x20000
  s_mov_b32 s22, 14680064
  s_mov_b32 s23, 0x20000
  v_mul_u32_u24 v1, 57344, v9
  v_lshl_add_u32 v4, v3, 4, v1
  v_lshlrev_b32 v1, 3, v3
  v_lshl_add_u32 v16, v9, 2, v1
  s_mul_i32 s53, s38, 14336
  s_lshl_b32 s54, s37, 8
  s_add_u32 s53, s53, s54
  v_add_u32 v16, s53, v16
  s_lshl_b32 s53, s38, 9
  s_add_u32 m0, s53, s51
  s_movk_i32 s50, 6912
  s_lshl3_add_u32 s52, s36, s38
  s_mul_i32 s53, s52, 114688
  s_lshl1_add_u32 s53, s54, s53
  v_add_u32 v4, s53, v4
  s_movk_i32 s45, 14336
  s_movk_i32 s46, 28672
  s_mov_b32 s47, 43008
  s_cmp_lt_u32 s2, 32
  s_waitcnt lgkmcnt(0)
  buffer_load_dword v16, s[24:27], 0 offen lds
  buffer_load_dword v16, s[24:27], s50 offen offset:256 lds
  s_cbranch_scc1 L_h
  buffer_load_dwordx4 v[32:35], v4, s[20:23], 0 offen nt
  buffer_load_dwordx4 v[36:39], v4, s[20:23], s45 offen nt
  buffer_load_dwordx4 v[40:43], v4, s[20:23], s46 offen nt
  buffer_load_dwordx4 v[44:47], v4, s[20:23], s47 offen nt
  s_add_u32 s10, s28, 9437184
  s_addc_u32 s11, s29, 0
  s_load_dwordx2 s[6:7], s[10:11], 0
  s_branch L_ng
L_h:
  s_getpc_b64 s[14:15]
L_pc:
  s_lshr_b32 s53, s2, 3
  s_lshl3_add_u32 s53, s53, s38
  s_mul_i32 s53, s53, 512
  s_min_u32 s53, s53, L_end-standalone__weight_only_int_squeezellm__prompt_kernel-512
  s_sub_u32 s14, s14, L_pc-standalone__weight_only_int_squeezellm__prompt_kernel
  s_subb_u32 s15, s15, 0
  s_load_dword s68, s[14:15], s53 offset:0
  s_load_dword s69, s[14:15], s53 offset:64
  s_load_dword s70, s[14:15], s53 offset:128
  s_load_dword s71, s[14:15], s53 offset:192
  s_load_dword s72, s[14:15], s53 offset:256
  s_load_dword s73, s[14:15], s53 offset:320
  s_load_dword s74, s[14:15], s53 offset:384
  s_load_dword s75, s[14:15], s53 offset:448
  s_branch L_prod
L_ng:
  s_mov_b32 s30, 9457664
  s_mov_b32 s31, 0x20000
  s_mov_b32 s18, 4194304
  s_mov_b32 s19, 0x20000
  s_mov_b32 s34, 14680064
  s_mov_b32 s35, 0x20000
  v_and_b32 v2, 63, v0
  v_lshlrev_b32 v5, 2, v3
  s_and_b32 s39, s38, 3
  v_add_u32 v5, 147456, v5
  s_lshl_b32 s53, s38, 11
  s_add_u32 s53, s53, 32768
  v_lshrrev_b32 v1, 4, v3
  v_lshlrev_b32 v1, 10, v1
  v_lshl_add_u32 v1, v9, 3, v1
  v_and_b32 v6, 15, v3
  v_lshl_add_u32 v6, v6, 4, v1
  v_add_u32 v6, s53, v6
  v_lshl_add_u32 v7, v2, 4, s53
  s_lshl_b32 s53, s37, 18
  s_lshl_b32 s54, s52, 11
  s_add_u32 s53, s53, s54
  v_lshl_add_u32 v8, v2, 4, s53
  s_lshl_b32 s53, s37, 6
  s_lshr_b32 s54, s52, 1
  s_add_u32 s53, s53, s54
  s_lshl_b32 s53, s53, 7
  s_and_b32 s54, s52, 1
  s_lshl_b32 s54, s54, 3
  s_add_u32 s53, s53, s54
  s_add_u32 s53, s53, 7340032
  v_lshl_add_u32 v14, v2, 7, s53
  s_lshl_b32 s53, s37, 2
  s_add_u32 s53, s53, s39
  s_mul_i32 s53, s53, 3
  s_min_u32 s53, s53, 253
  s_lshl_b32 s54, s36, 8
  s_add_u32 s53, s53, s54
  s_lshl_b32 s53, s53, 11
  s_add_u32 s12, s16, s53
  s_addc_u32 s13, s17, 0
  s_andn2_b32 s40, 4, s36
  v_and_b32 v3, 15, v2
  v_lshrrev_b32 v9, 4, v2
  v_lshrrev_b32 v1, 1, v3
  v_xor_b32 v1, v1, v9
  v_lshlrev_b32 v1, 4, v1
  v_lshl_add_u32 v144, v3, 7, v1
  s_lshl_b32 s54, s38, 13
  v_add_u32 v144, s54, v144
  v_xor_b32 v145, 64, v144
  v_lshlrev_b32 v1, 11, v9
  v_lshl_add_u32 v146, v3, 4, v1
  v_add_u32 v146, 32768, v146
  s_lshl_b32 s52, s36, 8
  s_lshl_b32 s53, s38, 6
  s_add_u32 s52, s52, s53
  s_mul_i32 s52, s52, 7168
  s_lshl_b32 s53, s37, 8
  s_add_u32 s52, s52, s53
  v_and_b32 v1, 1, v3
  v_lshl_add_u32 v1, v9, 2, v1
  v_mul_u32_u24 v1, 7168, v1
  v_lshrrev_b32 v147, 1, v3
  v_lshl_add_u32 v1, v147, 4, v1
  v_add_u32 v147, s52, v1
  v_lshrrev_b32 v20, 3, v2
  v_lshlrev_b32 v20, 11, v20
  v_lshrrev_b32 v1, 4, v2
  v_xor_b32 v1, v1, v2
  v_and_b32 v1, 7, v1
  v_lshl_add_u32 v20, v1, 4, v20
  s_lshl_b32 s52, s36, 19
  s_lshl_b32 s53, s39, 17
  s_add_u32 s53, s52, s53
  v_add_u32 v16, s53, v20
  v_xor_b32 v17, 64, v16
  v_add_u32 v18, 30720, v16
  v_add_u32 v19, 46080, v17
  v_add_u32 v17, 15360, v17
  s_lshl_b32 s60, s39, 13
  s_lshl_b32 s53, s37, 18
  s_lshl_b32 s54, s39, 12
  s_add_u32 s53, s53, s54
  v_lshl_add_u32 v20, v2, 4, s53
  s_add_u32 s61, s54, 32768
  s_lshl_b32 s53, s37, 13
  s_lshl_b32 s54, s39, 7
  s_add_u32 s53, s53, s54
  s_and_b32 s54, s36, 0
  s_lshl_b32 s54, s54, 7
  s_add_u32 s53, s53, s54
  s_add_u32 s53, s53, 7340032
  s_add_u32 s4, s28, s53
  s_addc_u32 s5, s29, 0
  s_lshl_b32 s41, s36, 7
  s_lshr_b32 s53, s38, 2
  s_lshl_b32 s54, s53, 16
  s_add_u32 s41, s41, s54
  s_lshl_b32 s53, s53, 12
  s_add_u32 m0, s60, s53
  s_waitcnt lgkmcnt(0)
  s_mul_i32 s8, s6, 1664525
  s_mul_i32 s9, s7, 22695477
  s_add_u32 s8, s8, 1013904223
  s_add_u32 s9, s9, 1
  v_mov_b32 v10, s8
  v_mov_b32 v11, s9
  s_waitcnt vmcnt(4)
  s_barrier
  s_waitcnt vmcnt(3)
  v_lshl_add_u32 v32, v32, 8, v5
  v_lshl_add_u32 v33, v33, 8, v5
  v_lshl_add_u32 v34, v34, 8, v5
  v_lshl_add_u32 v35, v35, 8, v5
  ds_read_u16 v96, v32 offset:0
  ds_read_u16 v97, v33 offset:2
  ds_read_u16 v98, v34 offset:128
  ds_read_u16 v99, v35 offset:130
  buffer_load_dwordx4 v16, s[16:19], s41 offen offset:0 lds
  s_waitcnt vmcnt(3)
  v_lshl_add_u32 v36, v36, 8, v5
  v_lshl_add_u32 v37, v37, 8, v5
  v_lshl_add_u32 v38, v38, 8, v5
  v_lshl_add_u32 v39, v39, 8, v5
  ds_read_u16 v100, v36 offset:0
  ds_read_u16 v101, v37 offset:2
  ds_read_u16 v102, v38 offset:128
  ds_read_u16 v103, v39 offset:130
  buffer_load_dwordx4 v17, s[16:19], s41 offen offset:1024 lds
  s_waitcnt vmcnt(3)
  v_lshl_add_u32 v40, v40, 8, v5
  v_lshl_add_u32 v41, v41, 8, v5
  v_lshl_add_u32 v42, v42, 8, v5
  v_lshl_add_u32 v43, v43, 8, v5
  ds_read_u16 v104, v40 offset:0
  ds_read_u16 v105, v41 offset:2
  ds_read_u16 v106, v42 offset:128
  ds_read_u16 v107, v43 offset:130
  buffer_load_dwordx4 v18, s[16:19], s41 offen offset:2048 lds
  s_waitcnt vmcnt(3)
  v_lshl_add_u32 v44, v44, 8, v5
  v_lshl_add_u32 v45, v45, 8, v5
  v_lshl_add_u32 v46, v46, 8, v5
  v_lshl_add_u32 v47, v47, 8, v5
  ds_read_u16 v108, v44 offset:0
  ds_read_u16 v109, v45 offset:2
  ds_read_u16 v110, v46 offset:128
  ds_read_u16 v111, v47 offset:130
  buffer_load_dwordx4 v19, s[16:19], s41 offen offset:3072 lds
  s_waitcnt lgkmcnt(8)
  v_lshl_or_b32 v112, v100, 16, v96
  v_lshl_or_b32 v114, v101, 16, v97
  v_lshl_or_b32 v116, v102, 16, v98
  v_lshl_or_b32 v118, v103, 16, v99
  s_waitcnt lgkmcnt(3)
  v_lshl_or_b32 v113, v108, 16, v104
  ds_write_b64 v6, v[112:113] offset:0
  s_waitcnt lgkmcnt(3)
  v_lshl_or_b32 v115, v109, 16, v105
  ds_write_b64 v6, v[114:115] offset:256
  s_waitcnt lgkmcnt(3)
  v_lshl_or_b32 v117, v110, 16, v106
  ds_write_b64 v6, v[116:117] offset:512
  s_waitcnt lgkmcnt(3)
  v_lshl_or_b32 v119, v111, 16, v107
  ds_write_b64 v6, v[118:119] offset:768
  s_waitcnt lgkmcnt(0)
  ds_read_b128 v[148:151], v7 offset:0
  ds_read_b128 v[152:155], v7 offset:1024
  s_waitcnt lgkmcnt(1)
  buffer_store_dwordx4 v[148:151], v8, s[28:31], 0 offen offset:0 sc1
  s_waitcnt lgkmcnt(0)
  buffer_store_dwordx4 v[152:155], v8, s[28:31], 0 offen offset:1024 sc1
  s_cmp_ge_u32 s38, 4
  s_cbranch_scc1 L_loader
  s_add_u32 s58, s40, 0
  s_lshl_b32 s58, s58, 7
  s_load_dword s92, s[12:13], s58 offset:0
  s_load_dword s93, s[12:13], s58 offset:64
  s_load_dword s94, s[12:13], s58 offset:2048
  s_load_dword s95, s[12:13], s58 offset:2112
  s_load_dword s96, s[12:13], s58 offset:4096
  s_load_dword s97, s[12:13], s58 offset:4160
  s_add_u32 s58, s40, 1
  s_lshl_b32 s58, s58, 7
  s_load_dword s92, s[12:13], s58 offset:0
  s_load_dword s93, s[12:13], s58 offset:64
  s_load_dword s94, s[12:13], s58 offset:2048
  s_load_dword s95, s[12:13], s58 offset:2112
  s_load_dword s96, s[12:13], s58 offset:4096
  s_load_dword s97, s[12:13], s58 offset:4160
  v_mov_b32 v5, v144
  v_mov_b32 v6, v145
  v_mov_b32 v7, v146
  v_mov_b32 v16, 0
  v_mov_b32 v17, 0
  v_mov_b32 v18, 0
  v_mov_b32 v19, 0
  v_mov_b32 v20, 0
  v_mov_b32 v21, 0
  v_mov_b32 v22, 0
  v_mov_b32 v23, 0
  v_mov_b32 v24, 0
  v_mov_b32 v25, 0
  v_mov_b32 v26, 0
  v_mov_b32 v27, 0
  v_mov_b32 v28, 0
  v_mov_b32 v29, 0
  v_mov_b32 v30, 0
  v_mov_b32 v31, 0
  v_mov_b32 v32, 0
  v_mov_b32 v33, 0
  v_mov_b32 v34, 0
  v_mov_b32 v35, 0
  v_mov_b32 v36, 0
  v_mov_b32 v37, 0
  v_mov_b32 v38, 0
  v_mov_b32 v39, 0
  v_mov_b32 v40, 0
  v_mov_b32 v41, 0
  v_mov_b32 v42, 0
  v_mov_b32 v43, 0
  v_mov_b32 v44, 0
  v_mov_b32 v45, 0
  v_mov_b32 v46, 0
  v_mov_b32 v47, 0
  v_mov_b32 v48, 0
  v_mov_b32 v49, 0
  v_mov_b32 v50, 0
  v_mov_b32 v51, 0
  v_mov_b32 v52, 0
  v_mov_b32 v53, 0
  v_mov_b32 v54, 0
  v_mov_b32 v55, 0
  v_mov_b32 v56, 0
  v_mov_b32 v57, 0
  v_mov_b32 v58, 0
  v_mov_b32 v59, 0
  v_mov_b32 v60, 0
  v_mov_b32 v61, 0
  v_mov_b32 v62, 0
  v_mov_b32 v63, 0
  v_mov_b32 v64, 0
  v_mov_b32 v65, 0
  v_mov_b32 v66, 0
  v_mov_b32 v67, 0
  v_mov_b32 v68, 0
  v_mov_b32 v69, 0
  v_mov_b32 v70, 0
  v_mov_b32 v71, 0
  v_mov_b32 v72, 0
  v_mov_b32 v73, 0
  v_mov_b32 v74, 0
  v_mov_b32 v75, 0
  v_mov_b32 v76, 0
  v_mov_b32 v77, 0
  v_mov_b32 v78, 0
  v_mov_b32 v79, 0
  v_mov_b32 v80, 0
  v_mov_b32 v81, 0
  v_mov_b32 v82, 0
  v_mov_b32 v83, 0
  v_mov_b32 v84, 0
  v_mov_b32 v85, 0
  v_mov_b32 v86, 0
  v_mov_b32 v87, 0
  v_mov_b32 v88, 0
  v_mov_b32 v89, 0
  v_mov_b32 v90, 0
  v_mov_b32 v91, 0
  v_mov_b32 v92, 0
  v_mov_b32 v93, 0
  v_mov_b32 v94, 0
  v_mov_b32 v95, 0
  v_mov_b32 v96, 0
  v_mov_b32 v97, 0
  v_mov_b32 v98, 0
  v_mov_b32 v99, 0
  v_mov_b32 v100, 0
  v_mov_b32 v101, 0
  v_mov_b32 v102, 0
  v_mov_b32 v103, 0
  v_mov_b32 v104, 0
  v_mov_b32 v105, 0
  v_mov_b32 v106, 0
  v_mov_b32 v107, 0
  v_mov_b32 v108, 0
  v_mov_b32 v109, 0
  v_mov_b32 v110, 0
  v_mov_b32 v111, 0
  v_mov_b32 v112, 0
  v_mov_b32 v113, 0
  v_mov_b32 v114, 0
  v_mov_b32 v115, 0
  v_mov_b32 v116, 0
  v_mov_b32 v117, 0
  v_mov_b32 v118, 0
  v_mov_b32 v119, 0
  v_mov_b32 v120, 0
  v_mov_b32 v121, 0
  v_mov_b32 v122, 0
  v_mov_b32 v123, 0
  v_mov_b32 v124, 0
  v_mov_b32 v125, 0
  v_mov_b32 v126, 0
  v_mov_b32 v127, 0
  v_mov_b32 v128, 0
  v_mov_b32 v129, 0
  v_mov_b32 v130, 0
  v_mov_b32 v131, 0
  v_mov_b32 v132, 0
  v_mov_b32 v133, 0
  v_mov_b32 v134, 0
  v_mov_b32 v135, 0
  v_mov_b32 v136, 0
  v_mov_b32 v137, 0
  v_mov_b32 v138, 0
  v_mov_b32 v139, 0
  v_mov_b32 v140, 0
  v_mov_b32 v141, 0
  v_mov_b32 v142, 0
  v_mov_b32 v143, 0
  s_waitcnt vmcnt(0)
  s_mov_b64 exec, 1
  buffer_store_dwordx2 v[10:11], v14, s[28:31], 0 offen sc1
  s_mov_b64 exec, -1
  s_mov_b32 s44, 0
  s_mov_b32 s45, 7168
  s_mov_b32 s46, 14336
  s_mov_b32 s47, 21504
  s_mov_b32 s48, 114688
  s_mov_b32 s49, 121856
  s_mov_b32 s50, 129024
  s_mov_b32 s51, 136192
  s_mov_b32 s52, 229376
  s_mov_b32 s53, 236544
  s_mov_b32 s54, 243712
  s_mov_b32 s55, 250880
  s_mov_b32 s56, 344064
  s_mov_b32 s57, 351232
  s_mov_b32 s58, 358400
  s_mov_b32 s59, 365568
  s_mov_b32 s60, 0
  s_mov_b32 s61, 0
  s_mov_b32 s60, 49152
  s_mov_b32 s61, 5
  s_mov_b32 s62, 49152
  s_lshl_b32 s63, s38, 12
  s_sub_u32 s63, 147456, s63
  s_mov_b32 vcc_lo, 0x55555555
  s_mov_b32 vcc_hi, 0x55555555
  s_barrier
  ds_read_b128 a[64:67], v7 offset:0
  ds_read_b128 a[68:71], v7 offset:8192
  ds_read_b128 a[0:3], v5 offset:0
  ds_read_b128 a[4:7], v6 offset:0
  ds_read_b128 a[8:11], v5 offset:2048
  ds_read_b128 a[12:15], v6 offset:2048
  ds_read_b128 a[16:19], v5 offset:4096
  ds_read_b128 a[72:75], v7 offset:256
  ds_read_b128 a[76:79], v7 offset:8448
  ds_read_b128 a[20:23], v6 offset:4096
  ds_read_b128 a[24:27], v5 offset:6144
  ds_read_b128 a[28:31], v6 offset:6144
  ds_read_b128 a[80:83], v7 offset:512
  ds_read_b128 a[84:87], v7 offset:8704
  s_cmp_eq_u32 s38, 0
  s_cbranch_scc0 L_c0
  s_lshl_b32 s3, s2, 6
  s_add_u32 s3, s3, 9441280
  v_mov_b32 v12, s3
  s_mov_b64 exec, 1
  buffer_store_dwordx2 v[10:11], v12, s[28:31], 0 offen sc1
  s_mov_b64 exec, -1
L_c0:
  s_waitcnt lgkmcnt(0)
.p2align 6
L_c:
  v_mfma_f32_16x16x32_bf16 v[16:19], a[0:3], a[64:67], v[16:19]
  ds_read_b128 a[88:91], v7 offset:768
  v_mfma_f32_16x16x32_bf16 v[16:19], a[4:7], a[68:71], v[16:19]
  ds_read_b128 a[92:95], v7 offset:8960
  v_mfma_f32_16x16x32_bf16 v[48:51], a[8:11], a[64:67], v[48:51]
  v_mfma_f32_16x16x32_bf16 v[48:51], a[12:15], a[68:71], v[48:51]
  s_cmp_eq_u32 s60, 147456
  v_mfma_f32_16x16x32_bf16 v[80:83], a[16:19], a[64:67], v[80:83]
  v_mfma_f32_16x16x32_bf16 v[80:83], a[20:23], a[68:71], v[80:83]
  s_cselect_b32 s60, 0, s60
  v_add_u32 v1, s60, v146
  v_mfma_f32_16x16x32_bf16 v[112:115], a[24:27], a[64:67], v[112:115]
  v_mfma_f32_16x16x32_bf16 v[112:115], a[28:31], a[68:71], v[112:115]
  v_mfma_f32_16x16x32_bf16 v[20:23], a[0:3], a[72:75], v[20:23]
  ds_read_b128 a[64:67], v7 offset:1024
  v_mfma_f32_16x16x32_bf16 v[20:23], a[4:7], a[76:79], v[20:23]
  ds_read_b128 a[68:71], v7 offset:9216
  v_mfma_f32_16x16x32_bf16 v[52:55], a[8:11], a[72:75], v[52:55]
  v_mfma_f32_16x16x32_bf16 v[52:55], a[12:15], a[76:79], v[52:55]
  v_mfma_f32_16x16x32_bf16 v[84:87], a[16:19], a[72:75], v[84:87]
  v_mfma_f32_16x16x32_bf16 v[84:87], a[20:23], a[76:79], v[84:87]
  v_mfma_f32_16x16x32_bf16 v[116:119], a[24:27], a[72:75], v[116:119]
  v_mfma_f32_16x16x32_bf16 v[116:119], a[28:31], a[76:79], v[116:119]
  v_mfma_f32_16x16x32_bf16 v[24:27], a[0:3], a[80:83], v[24:27]
  ds_read_b128 a[72:75], v7 offset:1280
  v_mfma_f32_16x16x32_bf16 v[24:27], a[4:7], a[84:87], v[24:27]
  ds_read_b128 a[76:79], v7 offset:9472
  v_mfma_f32_16x16x32_bf16 v[56:59], a[8:11], a[80:83], v[56:59]
  v_mfma_f32_16x16x32_bf16 v[56:59], a[12:15], a[84:87], v[56:59]
  v_mfma_f32_16x16x32_bf16 v[88:91], a[16:19], a[80:83], v[88:91]
  v_mfma_f32_16x16x32_bf16 v[88:91], a[20:23], a[84:87], v[88:91]
  v_mfma_f32_16x16x32_bf16 v[120:123], a[24:27], a[80:83], v[120:123]
  v_mfma_f32_16x16x32_bf16 v[120:123], a[28:31], a[84:87], v[120:123]
  v_add_u32 v3, s60, v144
  s_waitcnt lgkmcnt(0)
  v_mfma_f32_16x16x32_bf16 v[28:31], a[0:3], a[88:91], v[28:31]
  ds_read_b128 a[80:83], v7 offset:1536
  v_mfma_f32_16x16x32_bf16 v[28:31], a[4:7], a[92:95], v[28:31]
  ds_read_b128 a[84:87], v7 offset:9728
  v_mfma_f32_16x16x32_bf16 v[60:63], a[8:11], a[88:91], v[60:63]
  v_mfma_f32_16x16x32_bf16 v[60:63], a[12:15], a[92:95], v[60:63]
  v_add_u32_e64 v4, s60, v145
  v_mfma_f32_16x16x32_bf16 v[92:95], a[16:19], a[88:91], v[92:95]
  v_mfma_f32_16x16x32_bf16 v[92:95], a[20:23], a[92:95], v[92:95]
  v_mfma_f32_16x16x32_bf16 v[124:127], a[24:27], a[88:91], v[124:127]
  v_mfma_f32_16x16x32_bf16 v[124:127], a[28:31], a[92:95], v[124:127]
  v_mfma_f32_16x16x32_bf16 v[32:35], a[0:3], a[64:67], v[32:35]
  ds_read_b128 a[88:91], v7 offset:1792
  v_mfma_f32_16x16x32_bf16 v[32:35], a[4:7], a[68:71], v[32:35]
  ds_read_b128 a[92:95], v7 offset:9984
  v_mfma_f32_16x16x32_bf16 v[64:67], a[8:11], a[64:67], v[64:67]
  v_mfma_f32_16x16x32_bf16 v[64:67], a[12:15], a[68:71], v[64:67]
  v_mfma_f32_16x16x32_bf16 v[96:99], a[16:19], a[64:67], v[96:99]
  v_mfma_f32_16x16x32_bf16 v[96:99], a[20:23], a[68:71], v[96:99]
  v_mfma_f32_16x16x32_bf16 v[128:131], a[24:27], a[64:67], v[128:131]
  v_mfma_f32_16x16x32_bf16 v[128:131], a[28:31], a[68:71], v[128:131]
  s_waitcnt lgkmcnt(0)
  s_barrier
  v_mfma_f32_16x16x32_bf16 v[36:39], a[0:3], a[72:75], v[36:39]
  ds_read_b128 a[64:67], v1 offset:0
  v_mfma_f32_16x16x32_bf16 v[36:39], a[4:7], a[76:79], v[36:39]
  ds_read_b128 a[68:71], v1 offset:8192
  v_mfma_f32_16x16x32_bf16 v[68:71], a[8:11], a[72:75], v[68:71]
  ds_read_b128 a[32:35], v3 offset:0
  v_mfma_f32_16x16x32_bf16 v[68:71], a[12:15], a[76:79], v[68:71]
  ds_read_b128 a[36:39], v4 offset:0
  v_mfma_f32_16x16x32_bf16 v[100:103], a[16:19], a[72:75], v[100:103]
  ds_read_b128 a[40:43], v3 offset:2048
  v_mfma_f32_16x16x32_bf16 v[100:103], a[20:23], a[76:79], v[100:103]
  ds_read_b128 a[44:47], v4 offset:2048
  v_mfma_f32_16x16x32_bf16 v[132:135], a[24:27], a[72:75], v[132:135]
  v_mfma_f32_16x16x32_bf16 v[132:135], a[28:31], a[76:79], v[132:135]
  ds_read_b128 a[48:51], v3 offset:4096
  v_mfma_f32_16x16x32_bf16 v[40:43], a[0:3], a[80:83], v[40:43]
  ds_read_b128 a[72:75], v1 offset:256
  v_mfma_f32_16x16x32_bf16 v[40:43], a[4:7], a[84:87], v[40:43]
  ds_read_b128 a[76:79], v1 offset:8448
  v_mfma_f32_16x16x32_bf16 v[72:75], a[8:11], a[80:83], v[72:75]
  v_mfma_f32_16x16x32_bf16 v[72:75], a[12:15], a[84:87], v[72:75]
  ds_read_b128 a[52:55], v4 offset:4096
  v_mfma_f32_16x16x32_bf16 v[104:107], a[16:19], a[80:83], v[104:107]
  v_mfma_f32_16x16x32_bf16 v[104:107], a[20:23], a[84:87], v[104:107]
  ds_read_b128 a[56:59], v3 offset:6144
  v_mfma_f32_16x16x32_bf16 v[136:139], a[24:27], a[80:83], v[136:139]
  v_mfma_f32_16x16x32_bf16 v[136:139], a[28:31], a[84:87], v[136:139]
  ds_read_b128 a[60:63], v4 offset:6144
  v_mfma_f32_16x16x32_bf16 v[44:47], a[0:3], a[88:91], v[44:47]
  ds_read_b128 a[80:83], v1 offset:512
  v_mfma_f32_16x16x32_bf16 v[44:47], a[4:7], a[92:95], v[44:47]
  ds_read_b128 a[84:87], v1 offset:8704
  v_mfma_f32_16x16x32_bf16 v[76:79], a[8:11], a[88:91], v[76:79]
  v_mfma_f32_16x16x32_bf16 v[76:79], a[12:15], a[92:95], v[76:79]
  v_mfma_f32_16x16x32_bf16 v[108:111], a[16:19], a[88:91], v[108:111]
  v_mfma_f32_16x16x32_bf16 v[108:111], a[20:23], a[92:95], v[108:111]
  v_mfma_f32_16x16x32_bf16 v[140:143], a[24:27], a[88:91], v[140:143]
  v_mfma_f32_16x16x32_bf16 v[140:143], a[28:31], a[92:95], v[140:143]
  s_add_u32 s60, s60, s62
  s_waitcnt lgkmcnt(0)
  v_mfma_f32_16x16x32_bf16 v[16:19], a[32:35], a[64:67], v[16:19]
  ds_read_b128 a[88:91], v1 offset:768
  v_mfma_f32_16x16x32_bf16 v[16:19], a[36:39], a[68:71], v[16:19]
  ds_read_b128 a[92:95], v1 offset:8960
  v_mfma_f32_16x16x32_bf16 v[48:51], a[40:43], a[64:67], v[48:51]
  v_mfma_f32_16x16x32_bf16 v[48:51], a[44:47], a[68:71], v[48:51]
  s_cmp_eq_u32 s60, 147456
  v_mfma_f32_16x16x32_bf16 v[80:83], a[48:51], a[64:67], v[80:83]
  v_mfma_f32_16x16x32_bf16 v[80:83], a[52:55], a[68:71], v[80:83]
  s_cselect_b32 s60, 0, s60
  v_add_u32 v7, s60, v146
  v_mfma_f32_16x16x32_bf16 v[112:115], a[56:59], a[64:67], v[112:115]
  v_mfma_f32_16x16x32_bf16 v[112:115], a[60:63], a[68:71], v[112:115]
  v_mfma_f32_16x16x32_bf16 v[20:23], a[32:35], a[72:75], v[20:23]
  ds_read_b128 a[64:67], v1 offset:1024
  v_mfma_f32_16x16x32_bf16 v[20:23], a[36:39], a[76:79], v[20:23]
  ds_read_b128 a[68:71], v1 offset:9216
  v_mfma_f32_16x16x32_bf16 v[52:55], a[40:43], a[72:75], v[52:55]
  v_mfma_f32_16x16x32_bf16 v[52:55], a[44:47], a[76:79], v[52:55]
  v_mfma_f32_16x16x32_bf16 v[84:87], a[48:51], a[72:75], v[84:87]
  v_mfma_f32_16x16x32_bf16 v[84:87], a[52:55], a[76:79], v[84:87]
  v_mfma_f32_16x16x32_bf16 v[116:119], a[56:59], a[72:75], v[116:119]
  v_mfma_f32_16x16x32_bf16 v[116:119], a[60:63], a[76:79], v[116:119]
  v_mfma_f32_16x16x32_bf16 v[24:27], a[32:35], a[80:83], v[24:27]
  ds_read_b128 a[72:75], v1 offset:1280
  v_mfma_f32_16x16x32_bf16 v[24:27], a[36:39], a[84:87], v[24:27]
  ds_read_b128 a[76:79], v1 offset:9472
  v_mfma_f32_16x16x32_bf16 v[56:59], a[40:43], a[80:83], v[56:59]
  v_mfma_f32_16x16x32_bf16 v[56:59], a[44:47], a[84:87], v[56:59]
  v_mfma_f32_16x16x32_bf16 v[88:91], a[48:51], a[80:83], v[88:91]
  v_mfma_f32_16x16x32_bf16 v[88:91], a[52:55], a[84:87], v[88:91]
  v_mfma_f32_16x16x32_bf16 v[120:123], a[56:59], a[80:83], v[120:123]
  v_mfma_f32_16x16x32_bf16 v[120:123], a[60:63], a[84:87], v[120:123]
  v_add_u32 v5, s60, v144
  s_waitcnt lgkmcnt(0)
  v_mfma_f32_16x16x32_bf16 v[28:31], a[32:35], a[88:91], v[28:31]
  ds_read_b128 a[80:83], v1 offset:1536
  v_mfma_f32_16x16x32_bf16 v[28:31], a[36:39], a[92:95], v[28:31]
  ds_read_b128 a[84:87], v1 offset:9728
  v_mfma_f32_16x16x32_bf16 v[60:63], a[40:43], a[88:91], v[60:63]
  v_mfma_f32_16x16x32_bf16 v[60:63], a[44:47], a[92:95], v[60:63]
  v_add_u32_e64 v6, s60, v145
  v_mfma_f32_16x16x32_bf16 v[92:95], a[48:51], a[88:91], v[92:95]
  v_mfma_f32_16x16x32_bf16 v[92:95], a[52:55], a[92:95], v[92:95]
  v_mfma_f32_16x16x32_bf16 v[124:127], a[56:59], a[88:91], v[124:127]
  v_mfma_f32_16x16x32_bf16 v[124:127], a[60:63], a[92:95], v[124:127]
  v_mfma_f32_16x16x32_bf16 v[32:35], a[32:35], a[64:67], v[32:35]
  ds_read_b128 a[88:91], v1 offset:1792
  v_mfma_f32_16x16x32_bf16 v[32:35], a[36:39], a[68:71], v[32:35]
  ds_read_b128 a[92:95], v1 offset:9984
  v_mfma_f32_16x16x32_bf16 v[64:67], a[40:43], a[64:67], v[64:67]
  v_mfma_f32_16x16x32_bf16 v[64:67], a[44:47], a[68:71], v[64:67]
  v_mfma_f32_16x16x32_bf16 v[96:99], a[48:51], a[64:67], v[96:99]
  v_mfma_f32_16x16x32_bf16 v[96:99], a[52:55], a[68:71], v[96:99]
  v_mfma_f32_16x16x32_bf16 v[128:131], a[56:59], a[64:67], v[128:131]
  v_mfma_f32_16x16x32_bf16 v[128:131], a[60:63], a[68:71], v[128:131]
  s_waitcnt lgkmcnt(0)
  s_barrier
  v_mfma_f32_16x16x32_bf16 v[36:39], a[32:35], a[72:75], v[36:39]
  ds_read_b128 a[64:67], v7 offset:0
  v_mfma_f32_16x16x32_bf16 v[36:39], a[36:39], a[76:79], v[36:39]
  ds_read_b128 a[68:71], v7 offset:8192
  v_mfma_f32_16x16x32_bf16 v[68:71], a[40:43], a[72:75], v[68:71]
  ds_read_b128 a[0:3], v5 offset:0
  v_mfma_f32_16x16x32_bf16 v[68:71], a[44:47], a[76:79], v[68:71]
  ds_read_b128 a[4:7], v6 offset:0
  v_mfma_f32_16x16x32_bf16 v[100:103], a[48:51], a[72:75], v[100:103]
  ds_read_b128 a[8:11], v5 offset:2048
  v_mfma_f32_16x16x32_bf16 v[100:103], a[52:55], a[76:79], v[100:103]
  ds_read_b128 a[12:15], v6 offset:2048
  v_mfma_f32_16x16x32_bf16 v[132:135], a[56:59], a[72:75], v[132:135]
  v_mfma_f32_16x16x32_bf16 v[132:135], a[60:63], a[76:79], v[132:135]
  ds_read_b128 a[16:19], v5 offset:4096
  v_mfma_f32_16x16x32_bf16 v[40:43], a[32:35], a[80:83], v[40:43]
  ds_read_b128 a[72:75], v7 offset:256
  v_mfma_f32_16x16x32_bf16 v[40:43], a[36:39], a[84:87], v[40:43]
  ds_read_b128 a[76:79], v7 offset:8448
  v_mfma_f32_16x16x32_bf16 v[72:75], a[40:43], a[80:83], v[72:75]
  v_mfma_f32_16x16x32_bf16 v[72:75], a[44:47], a[84:87], v[72:75]
  ds_read_b128 a[20:23], v6 offset:4096
  v_mfma_f32_16x16x32_bf16 v[104:107], a[48:51], a[80:83], v[104:107]
  v_mfma_f32_16x16x32_bf16 v[104:107], a[52:55], a[84:87], v[104:107]
  ds_read_b128 a[24:27], v5 offset:6144
  v_mfma_f32_16x16x32_bf16 v[136:139], a[56:59], a[80:83], v[136:139]
  v_mfma_f32_16x16x32_bf16 v[136:139], a[60:63], a[84:87], v[136:139]
  ds_read_b128 a[28:31], v6 offset:6144
  v_mfma_f32_16x16x32_bf16 v[44:47], a[32:35], a[88:91], v[44:47]
  ds_read_b128 a[80:83], v7 offset:512
  v_mfma_f32_16x16x32_bf16 v[44:47], a[36:39], a[92:95], v[44:47]
  ds_read_b128 a[84:87], v7 offset:8704
  v_mfma_f32_16x16x32_bf16 v[76:79], a[40:43], a[88:91], v[76:79]
  v_mfma_f32_16x16x32_bf16 v[76:79], a[44:47], a[92:95], v[76:79]
  v_mfma_f32_16x16x32_bf16 v[108:111], a[48:51], a[88:91], v[108:111]
  v_mfma_f32_16x16x32_bf16 v[108:111], a[52:55], a[92:95], v[108:111]
  v_mfma_f32_16x16x32_bf16 v[140:143], a[56:59], a[88:91], v[140:143]
  s_add_u32 s60, s60, s62
  s_sub_u32 s61, s61, 1
  v_mfma_f32_16x16x32_bf16 v[140:143], a[60:63], a[92:95], v[140:143]
  s_waitcnt lgkmcnt(0)
  s_cbranch_scc0 L_c
  v_mfma_f32_16x16x32_bf16 v[16:19], a[0:3], a[64:67], v[16:19]
  ds_read_b128 a[88:91], v7 offset:768
  v_mfma_f32_16x16x32_bf16 v[16:19], a[4:7], a[68:71], v[16:19]
  ds_read_b128 a[92:95], v7 offset:8960
  v_mfma_f32_16x16x32_bf16 v[48:51], a[8:11], a[64:67], v[48:51]
  v_mfma_f32_16x16x32_bf16 v[48:51], a[12:15], a[68:71], v[48:51]
  v_mfma_f32_16x16x32_bf16 v[80:83], a[16:19], a[64:67], v[80:83]
  v_mfma_f32_16x16x32_bf16 v[80:83], a[20:23], a[68:71], v[80:83]
  v_add_u32 v8, 49152, v144
  v_mfma_f32_16x16x32_bf16 v[112:115], a[24:27], a[64:67], v[112:115]
  v_mfma_f32_16x16x32_bf16 v[112:115], a[28:31], a[68:71], v[112:115]
  v_add_u32 v9, 49152, v145
  v_mfma_f32_16x16x32_bf16 v[20:23], a[0:3], a[72:75], v[20:23]
  ds_read_b128 a[64:67], v7 offset:1024
  v_mfma_f32_16x16x32_bf16 v[20:23], a[4:7], a[76:79], v[20:23]
  ds_read_b128 a[68:71], v7 offset:9216
  v_mfma_f32_16x16x32_bf16 v[52:55], a[8:11], a[72:75], v[52:55]
  v_mfma_f32_16x16x32_bf16 v[52:55], a[12:15], a[76:79], v[52:55]
  v_mfma_f32_16x16x32_bf16 v[84:87], a[16:19], a[72:75], v[84:87]
  v_mfma_f32_16x16x32_bf16 v[84:87], a[20:23], a[76:79], v[84:87]
  v_add_u32 v10, 49152, v146
  v_mfma_f32_16x16x32_bf16 v[116:119], a[24:27], a[72:75], v[116:119]
  v_mfma_f32_16x16x32_bf16 v[116:119], a[28:31], a[76:79], v[116:119]
  v_mfma_f32_16x16x32_bf16 v[24:27], a[0:3], a[80:83], v[24:27]
  v_add_u32 v11, 98304, v144
  v_mfma_f32_16x16x32_bf16 v[24:27], a[4:7], a[84:87], v[24:27]
  ds_read_b128 a[72:75], v7 offset:1280
  ds_read_b128 a[76:79], v7 offset:9472
  v_mfma_f32_16x16x32_bf16 v[56:59], a[8:11], a[80:83], v[56:59]
  v_mfma_f32_16x16x32_bf16 v[56:59], a[12:15], a[84:87], v[56:59]
  v_add_u32 v12, 98304, v145
  v_mfma_f32_16x16x32_bf16 v[88:91], a[16:19], a[80:83], v[88:91]
  v_mfma_f32_16x16x32_bf16 v[88:91], a[20:23], a[84:87], v[88:91]
  v_mfma_f32_16x16x32_bf16 v[120:123], a[24:27], a[80:83], v[120:123]
  v_mfma_f32_16x16x32_bf16 v[120:123], a[28:31], a[84:87], v[120:123]
  s_waitcnt lgkmcnt(0)
  s_nop 0
  v_mfma_f32_16x16x32_bf16 v[28:31], a[0:3], a[88:91], v[28:31]
  v_add_u32 v13, 98304, v146
  v_mfma_f32_16x16x32_bf16 v[28:31], a[4:7], a[92:95], v[28:31]
  ds_read_b128 a[80:83], v7 offset:1536
  ds_read_b128 a[84:87], v7 offset:9728
  v_mfma_f32_16x16x32_bf16 v[60:63], a[8:11], a[88:91], v[60:63]
  v_mfma_f32_16x16x32_bf16 v[60:63], a[12:15], a[92:95], v[60:63]
  v_mfma_f32_16x16x32_bf16 v[92:95], a[16:19], a[88:91], v[92:95]
  v_mfma_f32_16x16x32_bf16 v[92:95], a[20:23], a[92:95], v[92:95]
  v_add_u32_e64 v14, s63, v144
  v_mfma_f32_16x16x32_bf16 v[124:127], a[24:27], a[88:91], v[124:127]
  v_mfma_f32_16x16x32_bf16 v[124:127], a[28:31], a[92:95], v[124:127]
  v_add_u32_e64 v15, s63, v145
  v_mfma_f32_16x16x32_bf16 v[32:35], a[0:3], a[64:67], v[32:35]
  ds_read_b128 a[88:91], v7 offset:1792
  v_mfma_f32_16x16x32_bf16 v[32:35], a[4:7], a[68:71], v[32:35]
  ds_read_b128 a[92:95], v7 offset:9984
  v_mfma_f32_16x16x32_bf16 v[64:67], a[8:11], a[64:67], v[64:67]
  v_mfma_f32_16x16x32_bf16 v[64:67], a[12:15], a[68:71], v[64:67]
  v_mfma_f32_16x16x32_bf16 v[96:99], a[16:19], a[64:67], v[96:99]
  v_mfma_f32_16x16x32_bf16 v[96:99], a[20:23], a[68:71], v[96:99]
  v_mfma_f32_16x16x32_bf16 v[128:131], a[24:27], a[64:67], v[128:131]
  v_mfma_f32_16x16x32_bf16 v[128:131], a[28:31], a[68:71], v[128:131]
  s_waitcnt lgkmcnt(0)
  s_barrier
  v_mfma_f32_16x16x32_bf16 v[36:39], a[0:3], a[72:75], v[36:39]
  v_mfma_f32_16x16x32_bf16 v[36:39], a[4:7], a[76:79], v[36:39]
  v_mfma_f32_16x16x32_bf16 v[68:71], a[8:11], a[72:75], v[68:71]
  v_mfma_f32_16x16x32_bf16 v[68:71], a[12:15], a[76:79], v[68:71]
  v_mfma_f32_16x16x32_bf16 v[100:103], a[16:19], a[72:75], v[100:103]
  v_mfma_f32_16x16x32_bf16 v[100:103], a[20:23], a[76:79], v[100:103]
  v_mfma_f32_16x16x32_bf16 v[132:135], a[24:27], a[72:75], v[132:135]
  v_mfma_f32_16x16x32_bf16 v[132:135], a[28:31], a[76:79], v[132:135]
  v_mfma_f32_16x16x32_bf16 v[40:43], a[0:3], a[80:83], v[40:43]
  ds_read_b128 a[32:35], v10 offset:0
  v_mfma_f32_16x16x32_bf16 v[40:43], a[4:7], a[84:87], v[40:43]
  ds_read_b128 a[36:39], v8 offset:0
  v_mfma_f32_16x16x32_bf16 v[72:75], a[8:11], a[80:83], v[72:75]
  ds_read_b128 a[40:43], v8 offset:2048
  v_mfma_f32_16x16x32_bf16 v[72:75], a[12:15], a[84:87], v[72:75]
  ds_read_b128 a[44:47], v10 offset:256
  v_mfma_f32_16x16x32_bf16 v[104:107], a[16:19], a[80:83], v[104:107]
  ds_read_b128 a[48:51], v10 offset:512
  v_mfma_f32_16x16x32_bf16 v[104:107], a[20:23], a[84:87], v[104:107]
  ds_read_b128 a[52:55], v10 offset:768
  v_mfma_f32_16x16x32_bf16 v[136:139], a[24:27], a[80:83], v[136:139]
  v_mfma_f32_16x16x32_bf16 v[136:139], a[28:31], a[84:87], v[136:139]
  v_mfma_f32_16x16x32_bf16 v[44:47], a[0:3], a[88:91], v[44:47]
  ds_read_b128 a[56:59], v10 offset:8192
  v_mfma_f32_16x16x32_bf16 v[44:47], a[4:7], a[92:95], v[44:47]
  ds_read_b128 a[60:63], v9 offset:0
  v_mfma_f32_16x16x32_bf16 v[76:79], a[8:11], a[88:91], v[76:79]
  ds_read_b128 a[64:67], v9 offset:2048
  v_mfma_f32_16x16x32_bf16 v[76:79], a[12:15], a[92:95], v[76:79]
  ds_read_b128 a[68:71], v10 offset:8448
  v_mfma_f32_16x16x32_bf16 v[108:111], a[16:19], a[88:91], v[108:111]
  ds_read_b128 a[72:75], v10 offset:8704
  v_mfma_f32_16x16x32_bf16 v[108:111], a[20:23], a[92:95], v[108:111]
  ds_read_b128 a[76:79], v10 offset:8960
  v_mfma_f32_16x16x32_bf16 v[140:143], a[24:27], a[88:91], v[140:143]
  v_mfma_f32_16x16x32_bf16 v[140:143], a[28:31], a[92:95], v[140:143]
  s_waitcnt lgkmcnt(4)
  s_nop 0
  v_mfma_f32_16x16x32_bf16 v[16:19], a[36:39], a[32:35], v[16:19]
  s_barrier
  ds_read_b128 a[80:83], v13 offset:0
  ds_read_b128 a[84:87], v11 offset:0
  s_nop 0
  v_mfma_f32_16x16x32_bf16 v[48:51], a[40:43], a[32:35], v[48:51]
  ds_read_b128 a[0:3], v11 offset:2048
  ds_read_b128 a[4:7], v13 offset:256
  v_mfma_f32_16x16x32_bf16 v[20:23], a[36:39], a[44:47], v[20:23]
  ds_read_b128 a[8:11], v13 offset:512
  ds_read_b128 a[12:15], v13 offset:768
  v_mfma_f32_16x16x32_bf16 v[52:55], a[40:43], a[44:47], v[52:55]
  v_mfma_f32_16x16x32_bf16 v[24:27], a[36:39], a[48:51], v[24:27]
  v_mfma_f32_16x16x32_bf16 v[56:59], a[40:43], a[48:51], v[56:59]
  v_mfma_f32_16x16x32_bf16 v[28:31], a[36:39], a[52:55], v[28:31]
  v_mfma_f32_16x16x32_bf16 v[60:63], a[40:43], a[52:55], v[60:63]
  v_mfma_f32_16x16x32_bf16 v[16:19], a[60:63], a[56:59], v[16:19]
  ds_read_b128 a[16:19], v13 offset:8192
  ds_read_b128 a[20:23], v12 offset:0
  s_waitcnt lgkmcnt(2)
  s_nop 0
  v_mfma_f32_16x16x32_bf16 v[48:51], a[64:67], a[56:59], v[48:51]
  ds_read_b128 a[24:27], v12 offset:2048
  ds_read_b128 a[28:31], v13 offset:8448
  v_mfma_f32_16x16x32_bf16 v[20:23], a[60:63], a[68:71], v[20:23]
  ds_read_b128 a[88:91], v13 offset:8704
  ds_read_b128 a[92:95], v13 offset:8960
  v_mfma_f32_16x16x32_bf16 v[52:55], a[64:67], a[68:71], v[52:55]
  v_mfma_f32_16x16x32_bf16 v[24:27], a[60:63], a[72:75], v[24:27]
  v_mfma_f32_16x16x32_bf16 v[56:59], a[64:67], a[72:75], v[56:59]
  v_mfma_f32_16x16x32_bf16 v[28:31], a[60:63], a[76:79], v[28:31]
  v_mfma_f32_16x16x32_bf16 v[60:63], a[64:67], a[76:79], v[60:63]
  v_mfma_f32_16x16x32_bf16 v[16:19], a[84:87], a[80:83], v[16:19]
  s_barrier
  ds_read_b128 a[32:35], v146 offset:0
  ds_read_b128 a[44:47], v14 offset:0
  s_nop 0
  v_mfma_f32_16x16x32_bf16 v[48:51], a[0:3], a[80:83], v[48:51]
  ds_read_b128 a[48:51], v14 offset:2048
  ds_read_b128 a[36:39], v146 offset:256
  v_mfma_f32_16x16x32_bf16 v[20:23], a[84:87], a[4:7], v[20:23]
  ds_read_b128 a[40:43], v146 offset:512
  ds_read_b128 a[52:55], v146 offset:768
  v_mfma_f32_16x16x32_bf16 v[52:55], a[0:3], a[4:7], v[52:55]
  v_mfma_f32_16x16x32_bf16 v[24:27], a[84:87], a[8:11], v[24:27]
  v_mfma_f32_16x16x32_bf16 v[56:59], a[0:3], a[8:11], v[56:59]
  v_mfma_f32_16x16x32_bf16 v[28:31], a[84:87], a[12:15], v[28:31]
  v_mfma_f32_16x16x32_bf16 v[60:63], a[0:3], a[12:15], v[60:63]
  s_waitcnt lgkmcnt(0)
  s_nop 0
  v_mfma_f32_16x16x32_bf16 v[16:19], a[20:23], a[16:19], v[16:19]
  ds_read_b128 a[56:59], v146 offset:8192
  ds_read_b128 a[68:71], v15 offset:0
  v_mfma_f32_16x16x32_bf16 v[48:51], a[24:27], a[16:19], v[48:51]
  ds_read_b128 a[72:75], v15 offset:2048
  ds_read_b128 a[60:63], v146 offset:8448
  v_mfma_f32_16x16x32_bf16 v[20:23], a[20:23], a[28:31], v[20:23]
  ds_read_b128 a[64:67], v146 offset:8704
  ds_read_b128 a[76:79], v146 offset:8960
  v_mfma_f32_16x16x32_bf16 v[52:55], a[24:27], a[28:31], v[52:55]
  v_mfma_f32_16x16x32_bf16 v[24:27], a[20:23], a[88:91], v[24:27]
  v_mfma_f32_16x16x32_bf16 v[56:59], a[24:27], a[88:91], v[56:59]
  v_mfma_f32_16x16x32_bf16 v[28:31], a[20:23], a[92:95], v[28:31]
  v_mfma_f32_16x16x32_bf16 v[60:63], a[24:27], a[92:95], v[60:63]
  v_mfma_f32_16x16x32_bf16 v[16:19], a[44:47], a[32:35], v[16:19]
  ds_read_b128 a[80:83], v10 offset:1024
  ds_read_b128 a[4:7], v8 offset:0
  v_mfma_f32_16x16x32_bf16 v[48:51], a[48:51], a[32:35], v[48:51]
  ds_read_b128 a[8:11], v8 offset:2048
  ds_read_b128 a[84:87], v10 offset:1280
  v_mfma_f32_16x16x32_bf16 v[20:23], a[44:47], a[36:39], v[20:23]
  ds_read_b128 a[0:3], v10 offset:1536
  ds_read_b128 a[12:15], v10 offset:1792
  v_mfma_f32_16x16x32_bf16 v[52:55], a[48:51], a[36:39], v[52:55]
  v_mfma_f32_16x16x32_bf16 v[24:27], a[44:47], a[40:43], v[24:27]
  v_mfma_f32_16x16x32_bf16 v[56:59], a[48:51], a[40:43], v[56:59]
  v_mfma_f32_16x16x32_bf16 v[28:31], a[44:47], a[52:55], v[28:31]
  v_mfma_f32_16x16x32_bf16 v[60:63], a[48:51], a[52:55], v[60:63]
  s_waitcnt lgkmcnt(0)
  s_nop 0
  v_mfma_f32_16x16x32_bf16 v[16:19], a[68:71], a[56:59], v[16:19]
  ds_read_b128 a[16:19], v10 offset:9216
  ds_read_b128 a[28:31], v9 offset:0
  v_mfma_f32_16x16x32_bf16 v[48:51], a[72:75], a[56:59], v[48:51]
  ds_read_b128 a[88:91], v9 offset:2048
  ds_read_b128 a[20:23], v10 offset:9472
  v_mfma_f32_16x16x32_bf16 v[20:23], a[68:71], a[60:63], v[20:23]
  ds_read_b128 a[24:27], v10 offset:9728
  ds_read_b128 a[92:95], v10 offset:9984
  v_mfma_f32_16x16x32_bf16 v[52:55], a[72:75], a[60:63], v[52:55]
  v_mfma_f32_16x16x32_bf16 v[24:27], a[68:71], a[64:67], v[24:27]
  v_mfma_f32_16x16x32_bf16 v[56:59], a[72:75], a[64:67], v[56:59]
  v_mfma_f32_16x16x32_bf16 v[28:31], a[68:71], a[76:79], v[28:31]
  v_mfma_f32_16x16x32_bf16 v[60:63], a[72:75], a[76:79], v[60:63]
  v_mfma_f32_16x16x32_bf16 v[32:35], a[4:7], a[80:83], v[32:35]
  ds_read_b128 a[32:35], v13 offset:1024
  ds_read_b128 a[36:39], v11 offset:0
  v_mfma_f32_16x16x32_bf16 v[64:67], a[8:11], a[80:83], v[64:67]
  ds_read_b128 a[40:43], v11 offset:2048
  ds_read_b128 a[44:47], v13 offset:1280
  v_mfma_f32_16x16x32_bf16 v[36:39], a[4:7], a[84:87], v[36:39]
  ds_read_b128 a[48:51], v13 offset:1536
  ds_read_b128 a[52:55], v13 offset:1792
  v_mfma_f32_16x16x32_bf16 v[68:71], a[8:11], a[84:87], v[68:71]
  v_cvt_pk_bf16_f32 v150, v17, v21
  v_cvt_pk_bf16_f32 v151, v25, v29
  v_mfma_f32_16x16x32_bf16 v[40:43], a[4:7], a[0:3], v[40:43]
  v_cvt_pk_bf16_f32 v148, v16, v20
  v_cvt_pk_bf16_f32 v149, v24, v28
  v_mfma_f32_16x16x32_bf16 v[72:75], a[8:11], a[0:3], v[72:75]
  v_cndmask_b32_dpp v152, v150, v148, vcc quad_perm:[1,0,3,2] row_mask:0xf bank_mask:0xf
  v_cndmask_b32_dpp v153, v151, v149, vcc quad_perm:[1,0,3,2] row_mask:0xf bank_mask:0xf
  v_mfma_f32_16x16x32_bf16 v[44:47], a[4:7], a[12:15], v[44:47]
  s_not_b64 vcc, vcc
  v_cndmask_b32_dpp v154, v148, v150, vcc quad_perm:[1,0,3,2] row_mask:0xf bank_mask:0xf
  s_nop 0
  v_mfma_f32_16x16x32_bf16 v[76:79], a[8:11], a[12:15], v[76:79]
  v_cndmask_b32_dpp v155, v149, v151, vcc quad_perm:[1,0,3,2] row_mask:0xf bank_mask:0xf
  buffer_store_dwordx4 v[152:155], v147, s[32:35], s44 offen offset:0 sc0 sc1
  s_waitcnt lgkmcnt(0)
  s_nop 0
  v_mfma_f32_16x16x32_bf16 v[32:35], a[28:31], a[16:19], v[32:35]
  ds_read_b128 a[56:59], v13 offset:9216
  ds_read_b128 a[60:63], v12 offset:0
  v_mfma_f32_16x16x32_bf16 v[64:67], a[88:91], a[16:19], v[64:67]
  ds_read_b128 a[64:67], v12 offset:2048
  ds_read_b128 a[68:71], v13 offset:9472
  v_mfma_f32_16x16x32_bf16 v[36:39], a[28:31], a[20:23], v[36:39]
  ds_read_b128 a[72:75], v13 offset:9728
  ds_read_b128 a[76:79], v13 offset:9984
  v_mfma_f32_16x16x32_bf16 v[68:71], a[88:91], a[20:23], v[68:71]
  v_cvt_pk_bf16_f32 v148, v18, v22
  v_cvt_pk_bf16_f32 v149, v26, v30
  v_mfma_f32_16x16x32_bf16 v[40:43], a[28:31], a[24:27], v[40:43]
  v_cvt_pk_bf16_f32 v150, v19, v23
  v_cvt_pk_bf16_f32 v151, v27, v31
  v_mfma_f32_16x16x32_bf16 v[72:75], a[88:91], a[24:27], v[72:75]
  v_cndmask_b32_dpp v158, v148, v150, vcc quad_perm:[1,0,3,2] row_mask:0xf bank_mask:0xf
  v_cndmask_b32_dpp v159, v149, v151, vcc quad_perm:[1,0,3,2] row_mask:0xf bank_mask:0xf
  v_mfma_f32_16x16x32_bf16 v[44:47], a[28:31], a[92:95], v[44:47]
  s_not_b64 vcc, vcc
  v_cndmask_b32_dpp v156, v150, v148, vcc quad_perm:[1,0,3,2] row_mask:0xf bank_mask:0xf
  s_nop 0
  v_mfma_f32_16x16x32_bf16 v[76:79], a[88:91], a[92:95], v[76:79]
  v_cndmask_b32_dpp v157, v151, v149, vcc quad_perm:[1,0,3,2] row_mask:0xf bank_mask:0xf
  buffer_store_dwordx4 v[156:159], v147, s[32:35], s46 offen offset:0 sc0 sc1
  v_mfma_f32_16x16x32_bf16 v[32:35], a[36:39], a[32:35], v[32:35]
  s_barrier
  ds_read_b128 a[80:83], v146 offset:1024
  ds_read_b128 a[84:87], v14 offset:0
  s_nop 0
  v_mfma_f32_16x16x32_bf16 v[64:67], a[40:43], a[32:35], v[64:67]
  ds_read_b128 a[0:3], v14 offset:2048
  ds_read_b128 a[4:7], v146 offset:1280
  v_mfma_f32_16x16x32_bf16 v[36:39], a[36:39], a[44:47], v[36:39]
  ds_read_b128 a[8:11], v146 offset:1536
  ds_read_b128 a[12:15], v146 offset:1792
  v_mfma_f32_16x16x32_bf16 v[68:71], a[40:43], a[44:47], v[68:71]
  v_cvt_pk_bf16_f32 v150, v49, v53
  v_cvt_pk_bf16_f32 v151, v57, v61
  v_mfma_f32_16x16x32_bf16 v[40:43], a[36:39], a[48:51], v[40:43]
  v_cvt_pk_bf16_f32 v148, v48, v52
  v_cvt_pk_bf16_f32 v149, v56, v60
  v_mfma_f32_16x16x32_bf16 v[72:75], a[40:43], a[48:51], v[72:75]
  v_cndmask_b32_dpp v152, v150, v148, vcc quad_perm:[1,0,3,2] row_mask:0xf bank_mask:0xf
  v_cndmask_b32_dpp v153, v151, v149, vcc quad_perm:[1,0,3,2] row_mask:0xf bank_mask:0xf
  v_mfma_f32_16x16x32_bf16 v[44:47], a[36:39], a[52:55], v[44:47]
  s_not_b64 vcc, vcc
  v_cndmask_b32_dpp v154, v148, v150, vcc quad_perm:[1,0,3,2] row_mask:0xf bank_mask:0xf
  s_nop 0
  v_mfma_f32_16x16x32_bf16 v[76:79], a[40:43], a[52:55], v[76:79]
  v_cndmask_b32_dpp v155, v149, v151, vcc quad_perm:[1,0,3,2] row_mask:0xf bank_mask:0xf
  buffer_store_dwordx4 v[152:155], v147, s[32:35], s48 offen offset:0 sc0 sc1
  s_waitcnt lgkmcnt(0)
  s_nop 0
  v_mfma_f32_16x16x32_bf16 v[32:35], a[60:63], a[56:59], v[32:35]
  ds_read_b128 a[16:19], v146 offset:9216
  ds_read_b128 a[20:23], v15 offset:0
  v_mfma_f32_16x16x32_bf16 v[64:67], a[64:67], a[56:59], v[64:67]
  ds_read_b128 a[24:27], v15 offset:2048
  ds_read_b128 a[28:31], v146 offset:9472
  v_mfma_f32_16x16x32_bf16 v[36:39], a[60:63], a[68:71], v[36:39]
  ds_read_b128 a[88:91], v146 offset:9728
  ds_read_b128 a[92:95], v146 offset:9984
  v_mfma_f32_16x16x32_bf16 v[68:71], a[64:67], a[68:71], v[68:71]
  v_cvt_pk_bf16_f32 v148, v50, v54
  v_cvt_pk_bf16_f32 v149, v58, v62
  v_mfma_f32_16x16x32_bf16 v[40:43], a[60:63], a[72:75], v[40:43]
  v_cvt_pk_bf16_f32 v150, v51, v55
  v_cvt_pk_bf16_f32 v151, v59, v63
  v_mfma_f32_16x16x32_bf16 v[72:75], a[64:67], a[72:75], v[72:75]
  v_cndmask_b32_dpp v158, v148, v150, vcc quad_perm:[1,0,3,2] row_mask:0xf bank_mask:0xf
  v_cndmask_b32_dpp v159, v149, v151, vcc quad_perm:[1,0,3,2] row_mask:0xf bank_mask:0xf
  v_mfma_f32_16x16x32_bf16 v[44:47], a[60:63], a[76:79], v[44:47]
  s_not_b64 vcc, vcc
  v_cndmask_b32_dpp v156, v150, v148, vcc quad_perm:[1,0,3,2] row_mask:0xf bank_mask:0xf
  s_nop 0
  v_mfma_f32_16x16x32_bf16 v[76:79], a[64:67], a[76:79], v[76:79]
  v_cndmask_b32_dpp v157, v151, v149, vcc quad_perm:[1,0,3,2] row_mask:0xf bank_mask:0xf
  buffer_store_dwordx4 v[156:159], v147, s[32:35], s50 offen offset:0 sc0 sc1
  v_mfma_f32_16x16x32_bf16 v[32:35], a[84:87], a[80:83], v[32:35]
  ds_read_b128 a[32:35], v10 offset:0
  ds_read_b128 a[44:47], v8 offset:4096
  v_mfma_f32_16x16x32_bf16 v[64:67], a[0:3], a[80:83], v[64:67]
  ds_read_b128 a[48:51], v8 offset:6144
  ds_read_b128 a[36:39], v10 offset:256
  v_mfma_f32_16x16x32_bf16 v[36:39], a[84:87], a[4:7], v[36:39]
  ds_read_b128 a[40:43], v10 offset:512
  ds_read_b128 a[52:55], v10 offset:768
  v_mfma_f32_16x16x32_bf16 v[68:71], a[0:3], a[4:7], v[68:71]
  v_mfma_f32_16x16x32_bf16 v[40:43], a[84:87], a[8:11], v[40:43]
  v_mfma_f32_16x16x32_bf16 v[72:75], a[0:3], a[8:11], v[72:75]
  v_mfma_f32_16x16x32_bf16 v[44:47], a[84:87], a[12:15], v[44:47]
  v_mfma_f32_16x16x32_bf16 v[76:79], a[0:3], a[12:15], v[76:79]
  s_waitcnt lgkmcnt(0)
  s_nop 0
  v_mfma_f32_16x16x32_bf16 v[32:35], a[20:23], a[16:19], v[32:35]
  ds_read_b128 a[56:59], v10 offset:8192
  ds_read_b128 a[68:71], v9 offset:4096
  v_mfma_f32_16x16x32_bf16 v[64:67], a[24:27], a[16:19], v[64:67]
  ds_read_b128 a[72:75], v9 offset:6144
  ds_read_b128 a[60:63], v10 offset:8448
  v_mfma_f32_16x16x32_bf16 v[36:39], a[20:23], a[28:31], v[36:39]
  ds_read_b128 a[64:67], v10 offset:8704
  ds_read_b128 a[76:79], v10 offset:8960
  v_mfma_f32_16x16x32_bf16 v[68:71], a[24:27], a[28:31], v[68:71]
  v_mfma_f32_16x16x32_bf16 v[40:43], a[20:23], a[88:91], v[40:43]
  v_mfma_f32_16x16x32_bf16 v[72:75], a[24:27], a[88:91], v[72:75]
  v_mfma_f32_16x16x32_bf16 v[44:47], a[20:23], a[92:95], v[44:47]
  v_mfma_f32_16x16x32_bf16 v[76:79], a[24:27], a[92:95], v[76:79]
  v_mfma_f32_16x16x32_bf16 v[80:83], a[44:47], a[32:35], v[80:83]
  ds_read_b128 a[80:83], v13 offset:0
  ds_read_b128 a[4:7], v11 offset:4096
  v_mfma_f32_16x16x32_bf16 v[112:115], a[48:51], a[32:35], v[112:115]
  ds_read_b128 a[8:11], v11 offset:6144
  ds_read_b128 a[84:87], v13 offset:256
  v_mfma_f32_16x16x32_bf16 v[84:87], a[44:47], a[36:39], v[84:87]
  ds_read_b128 a[0:3], v13 offset:512
  ds_read_b128 a[12:15], v13 offset:768
  v_mfma_f32_16x16x32_bf16 v[116:119], a[48:51], a[36:39], v[116:119]
  v_cvt_pk_bf16_f32 v150, v33, v37
  v_cvt_pk_bf16_f32 v151, v41, v45
  v_mfma_f32_16x16x32_bf16 v[88:91], a[44:47], a[40:43], v[88:91]
  v_cvt_pk_bf16_f32 v148, v32, v36
  v_cvt_pk_bf16_f32 v149, v40, v44
  v_mfma_f32_16x16x32_bf16 v[120:123], a[48:51], a[40:43], v[120:123]
  v_cndmask_b32_dpp v152, v150, v148, vcc quad_perm:[1,0,3,2] row_mask:0xf bank_mask:0xf
  v_cndmask_b32_dpp v153, v151, v149, vcc quad_perm:[1,0,3,2] row_mask:0xf bank_mask:0xf
  v_mfma_f32_16x16x32_bf16 v[92:95], a[44:47], a[52:55], v[92:95]
  s_not_b64 vcc, vcc
  v_cndmask_b32_dpp v154, v148, v150, vcc quad_perm:[1,0,3,2] row_mask:0xf bank_mask:0xf
  s_nop 0
  v_mfma_f32_16x16x32_bf16 v[124:127], a[48:51], a[52:55], v[124:127]
  v_cndmask_b32_dpp v155, v149, v151, vcc quad_perm:[1,0,3,2] row_mask:0xf bank_mask:0xf
  buffer_store_dwordx4 v[152:155], v147, s[32:35], s44 offen offset:128 sc0 sc1
  s_waitcnt lgkmcnt(0)
  s_nop 0
  v_mfma_f32_16x16x32_bf16 v[80:83], a[68:71], a[56:59], v[80:83]
  ds_read_b128 a[16:19], v13 offset:8192
  ds_read_b128 a[28:31], v12 offset:4096
  v_mfma_f32_16x16x32_bf16 v[112:115], a[72:75], a[56:59], v[112:115]
  ds_read_b128 a[88:91], v12 offset:6144
  ds_read_b128 a[20:23], v13 offset:8448
  v_mfma_f32_16x16x32_bf16 v[84:87], a[68:71], a[60:63], v[84:87]
  ds_read_b128 a[24:27], v13 offset:8704
  ds_read_b128 a[92:95], v13 offset:8960
  v_mfma_f32_16x16x32_bf16 v[116:119], a[72:75], a[60:63], v[116:119]
  v_cvt_pk_bf16_f32 v148, v34, v38
  v_cvt_pk_bf16_f32 v149, v42, v46
  v_mfma_f32_16x16x32_bf16 v[88:91], a[68:71], a[64:67], v[88:91]
  v_cvt_pk_bf16_f32 v150, v35, v39
  v_cvt_pk_bf16_f32 v151, v43, v47
  v_mfma_f32_16x16x32_bf16 v[120:123], a[72:75], a[64:67], v[120:123]
  v_cndmask_b32_dpp v158, v148, v150, vcc quad_perm:[1,0,3,2] row_mask:0xf bank_mask:0xf
  v_cndmask_b32_dpp v159, v149, v151, vcc quad_perm:[1,0,3,2] row_mask:0xf bank_mask:0xf
  v_mfma_f32_16x16x32_bf16 v[92:95], a[68:71], a[76:79], v[92:95]
  s_not_b64 vcc, vcc
  v_cndmask_b32_dpp v156, v150, v148, vcc quad_perm:[1,0,3,2] row_mask:0xf bank_mask:0xf
  s_nop 0
  v_mfma_f32_16x16x32_bf16 v[124:127], a[72:75], a[76:79], v[124:127]
  v_cndmask_b32_dpp v157, v151, v149, vcc quad_perm:[1,0,3,2] row_mask:0xf bank_mask:0xf
  buffer_store_dwordx4 v[156:159], v147, s[32:35], s46 offen offset:128 sc0 sc1
  v_mfma_f32_16x16x32_bf16 v[80:83], a[4:7], a[80:83], v[80:83]
  ds_read_b128 a[32:35], v146 offset:0
  ds_read_b128 a[36:39], v144 offset:4096
  v_mfma_f32_16x16x32_bf16 v[112:115], a[8:11], a[80:83], v[112:115]
  ds_read_b128 a[40:43], v144 offset:6144
  ds_read_b128 a[44:47], v146 offset:256
  v_mfma_f32_16x16x32_bf16 v[84:87], a[4:7], a[84:87], v[84:87]
  ds_read_b128 a[48:51], v146 offset:512
  ds_read_b128 a[52:55], v146 offset:768
  v_mfma_f32_16x16x32_bf16 v[116:119], a[8:11], a[84:87], v[116:119]
  v_cvt_pk_bf16_f32 v150, v65, v69
  v_cvt_pk_bf16_f32 v151, v73, v77
  v_mfma_f32_16x16x32_bf16 v[88:91], a[4:7], a[0:3], v[88:91]
  v_cvt_pk_bf16_f32 v148, v64, v68
  v_cvt_pk_bf16_f32 v149, v72, v76
  v_mfma_f32_16x16x32_bf16 v[120:123], a[8:11], a[0:3], v[120:123]
  v_cndmask_b32_dpp v152, v150, v148, vcc quad_perm:[1,0,3,2] row_mask:0xf bank_mask:0xf
  v_cndmask_b32_dpp v153, v151, v149, vcc quad_perm:[1,0,3,2] row_mask:0xf bank_mask:0xf
  v_mfma_f32_16x16x32_bf16 v[92:95], a[4:7], a[12:15], v[92:95]
  s_not_b64 vcc, vcc
  v_cndmask_b32_dpp v154, v148, v150, vcc quad_perm:[1,0,3,2] row_mask:0xf bank_mask:0xf
  s_nop 0
  v_mfma_f32_16x16x32_bf16 v[124:127], a[8:11], a[12:15], v[124:127]
  v_cndmask_b32_dpp v155, v149, v151, vcc quad_perm:[1,0,3,2] row_mask:0xf bank_mask:0xf
  buffer_store_dwordx4 v[152:155], v147, s[32:35], s48 offen offset:128 sc0 sc1
  s_waitcnt lgkmcnt(0)
  s_nop 0
  v_mfma_f32_16x16x32_bf16 v[80:83], a[28:31], a[16:19], v[80:83]
  ds_read_b128 a[56:59], v146 offset:8192
  ds_read_b128 a[60:63], v145 offset:4096
  v_mfma_f32_16x16x32_bf16 v[112:115], a[88:91], a[16:19], v[112:115]
  ds_read_b128 a[64:67], v145 offset:6144
  ds_read_b128 a[68:71], v146 offset:8448
  v_mfma_f32_16x16x32_bf16 v[84:87], a[28:31], a[20:23], v[84:87]
  ds_read_b128 a[72:75], v146 offset:8704
  ds_read_b128 a[76:79], v146 offset:8960
  v_mfma_f32_16x16x32_bf16 v[116:119], a[88:91], a[20:23], v[116:119]
  v_cvt_pk_bf16_f32 v148, v66, v70
  v_cvt_pk_bf16_f32 v149, v74, v78
  v_mfma_f32_16x16x32_bf16 v[88:91], a[28:31], a[24:27], v[88:91]
  v_cvt_pk_bf16_f32 v150, v67, v71
  v_cvt_pk_bf16_f32 v151, v75, v79
  v_mfma_f32_16x16x32_bf16 v[120:123], a[88:91], a[24:27], v[120:123]
  v_cndmask_b32_dpp v158, v148, v150, vcc quad_perm:[1,0,3,2] row_mask:0xf bank_mask:0xf
  v_cndmask_b32_dpp v159, v149, v151, vcc quad_perm:[1,0,3,2] row_mask:0xf bank_mask:0xf
  v_mfma_f32_16x16x32_bf16 v[92:95], a[28:31], a[92:95], v[92:95]
  s_not_b64 vcc, vcc
  v_cndmask_b32_dpp v156, v150, v148, vcc quad_perm:[1,0,3,2] row_mask:0xf bank_mask:0xf
  s_nop 0
  v_mfma_f32_16x16x32_bf16 v[124:127], a[88:91], a[92:95], v[124:127]
  v_cndmask_b32_dpp v157, v151, v149, vcc quad_perm:[1,0,3,2] row_mask:0xf bank_mask:0xf
  buffer_store_dwordx4 v[156:159], v147, s[32:35], s50 offen offset:128 sc0 sc1
  v_mfma_f32_16x16x32_bf16 v[80:83], a[36:39], a[32:35], v[80:83]
  ds_read_b128 a[80:83], v10 offset:1024
  ds_read_b128 a[84:87], v8 offset:4096
  v_mfma_f32_16x16x32_bf16 v[112:115], a[40:43], a[32:35], v[112:115]
  ds_read_b128 a[0:3], v8 offset:6144
  ds_read_b128 a[4:7], v10 offset:1280
  v_mfma_f32_16x16x32_bf16 v[84:87], a[36:39], a[44:47], v[84:87]
  ds_read_b128 a[8:11], v10 offset:1536
  ds_read_b128 a[12:15], v10 offset:1792
  v_mfma_f32_16x16x32_bf16 v[116:119], a[40:43], a[44:47], v[116:119]
  v_mfma_f32_16x16x32_bf16 v[88:91], a[36:39], a[48:51], v[88:91]
  v_mfma_f32_16x16x32_bf16 v[120:123], a[40:43], a[48:51], v[120:123]
  v_mfma_f32_16x16x32_bf16 v[92:95], a[36:39], a[52:55], v[92:95]
  v_mfma_f32_16x16x32_bf16 v[124:127], a[40:43], a[52:55], v[124:127]
  s_waitcnt lgkmcnt(0)
  s_nop 0
  v_mfma_f32_16x16x32_bf16 v[80:83], a[60:63], a[56:59], v[80:83]
  ds_read_b128 a[16:19], v10 offset:9216
  ds_read_b128 a[20:23], v9 offset:4096
  v_mfma_f32_16x16x32_bf16 v[112:115], a[64:67], a[56:59], v[112:115]
  ds_read_b128 a[24:27], v9 offset:6144
  ds_read_b128 a[28:31], v10 offset:9472
  v_mfma_f32_16x16x32_bf16 v[84:87], a[60:63], a[68:71], v[84:87]
  ds_read_b128 a[88:91], v10 offset:9728
  ds_read_b128 a[92:95], v10 offset:9984
  v_mfma_f32_16x16x32_bf16 v[116:119], a[64:67], a[68:71], v[116:119]
  v_mfma_f32_16x16x32_bf16 v[88:91], a[60:63], a[72:75], v[88:91]
  v_mfma_f32_16x16x32_bf16 v[120:123], a[64:67], a[72:75], v[120:123]
  v_mfma_f32_16x16x32_bf16 v[92:95], a[60:63], a[76:79], v[92:95]
  v_mfma_f32_16x16x32_bf16 v[124:127], a[64:67], a[76:79], v[124:127]
  v_mfma_f32_16x16x32_bf16 v[96:99], a[84:87], a[80:83], v[96:99]
  ds_read_b128 a[32:35], v13 offset:1024
  ds_read_b128 a[44:47], v11 offset:4096
  v_mfma_f32_16x16x32_bf16 v[128:131], a[0:3], a[80:83], v[128:131]
  ds_read_b128 a[48:51], v11 offset:6144
  ds_read_b128 a[36:39], v13 offset:1280
  v_mfma_f32_16x16x32_bf16 v[100:103], a[84:87], a[4:7], v[100:103]
  ds_read_b128 a[40:43], v13 offset:1536
  ds_read_b128 a[52:55], v13 offset:1792
  v_mfma_f32_16x16x32_bf16 v[132:135], a[0:3], a[4:7], v[132:135]
  v_cvt_pk_bf16_f32 v150, v81, v85
  v_cvt_pk_bf16_f32 v151, v89, v93
  v_mfma_f32_16x16x32_bf16 v[104:107], a[84:87], a[8:11], v[104:107]
  v_cvt_pk_bf16_f32 v148, v80, v84
  v_cvt_pk_bf16_f32 v149, v88, v92
  v_mfma_f32_16x16x32_bf16 v[136:139], a[0:3], a[8:11], v[136:139]
  v_cndmask_b32_dpp v152, v150, v148, vcc quad_perm:[1,0,3,2] row_mask:0xf bank_mask:0xf
  v_cndmask_b32_dpp v153, v151, v149, vcc quad_perm:[1,0,3,2] row_mask:0xf bank_mask:0xf
  v_mfma_f32_16x16x32_bf16 v[108:111], a[84:87], a[12:15], v[108:111]
  s_not_b64 vcc, vcc
  v_cndmask_b32_dpp v154, v148, v150, vcc quad_perm:[1,0,3,2] row_mask:0xf bank_mask:0xf
  s_nop 0
  v_mfma_f32_16x16x32_bf16 v[140:143], a[0:3], a[12:15], v[140:143]
  v_cndmask_b32_dpp v155, v149, v151, vcc quad_perm:[1,0,3,2] row_mask:0xf bank_mask:0xf
  buffer_store_dwordx4 v[152:155], v147, s[32:35], s52 offen offset:0 sc0 sc1
  s_waitcnt lgkmcnt(0)
  s_nop 0
  v_mfma_f32_16x16x32_bf16 v[96:99], a[20:23], a[16:19], v[96:99]
  ds_read_b128 a[56:59], v13 offset:9216
  ds_read_b128 a[68:71], v12 offset:4096
  v_mfma_f32_16x16x32_bf16 v[128:131], a[24:27], a[16:19], v[128:131]
  ds_read_b128 a[72:75], v12 offset:6144
  ds_read_b128 a[60:63], v13 offset:9472
  v_mfma_f32_16x16x32_bf16 v[100:103], a[20:23], a[28:31], v[100:103]
  ds_read_b128 a[64:67], v13 offset:9728
  ds_read_b128 a[76:79], v13 offset:9984
  v_mfma_f32_16x16x32_bf16 v[132:135], a[24:27], a[28:31], v[132:135]
  v_cvt_pk_bf16_f32 v148, v82, v86
  v_cvt_pk_bf16_f32 v149, v90, v94
  v_mfma_f32_16x16x32_bf16 v[104:107], a[20:23], a[88:91], v[104:107]
  v_cvt_pk_bf16_f32 v150, v83, v87
  v_cvt_pk_bf16_f32 v151, v91, v95
  v_mfma_f32_16x16x32_bf16 v[136:139], a[24:27], a[88:91], v[136:139]
  v_cndmask_b32_dpp v158, v148, v150, vcc quad_perm:[1,0,3,2] row_mask:0xf bank_mask:0xf
  v_cndmask_b32_dpp v159, v149, v151, vcc quad_perm:[1,0,3,2] row_mask:0xf bank_mask:0xf
  v_mfma_f32_16x16x32_bf16 v[108:111], a[20:23], a[92:95], v[108:111]
  s_not_b64 vcc, vcc
  v_cndmask_b32_dpp v156, v150, v148, vcc quad_perm:[1,0,3,2] row_mask:0xf bank_mask:0xf
  s_nop 0
  v_mfma_f32_16x16x32_bf16 v[140:143], a[24:27], a[92:95], v[140:143]
  v_cndmask_b32_dpp v157, v151, v149, vcc quad_perm:[1,0,3,2] row_mask:0xf bank_mask:0xf
  buffer_store_dwordx4 v[156:159], v147, s[32:35], s54 offen offset:0 sc0 sc1
  v_mfma_f32_16x16x32_bf16 v[96:99], a[44:47], a[32:35], v[96:99]
  ds_read_b128 a[80:83], v146 offset:1024
  ds_read_b128 a[4:7], v144 offset:4096
  v_mfma_f32_16x16x32_bf16 v[128:131], a[48:51], a[32:35], v[128:131]
  ds_read_b128 a[8:11], v144 offset:6144
  ds_read_b128 a[84:87], v146 offset:1280
  v_mfma_f32_16x16x32_bf16 v[100:103], a[44:47], a[36:39], v[100:103]
  ds_read_b128 a[0:3], v146 offset:1536
  ds_read_b128 a[12:15], v146 offset:1792
  v_mfma_f32_16x16x32_bf16 v[132:135], a[48:51], a[36:39], v[132:135]
  v_cvt_pk_bf16_f32 v150, v113, v117
  v_cvt_pk_bf16_f32 v151, v121, v125
  v_mfma_f32_16x16x32_bf16 v[104:107], a[44:47], a[40:43], v[104:107]
  v_cvt_pk_bf16_f32 v148, v112, v116
  v_cvt_pk_bf16_f32 v149, v120, v124
  v_mfma_f32_16x16x32_bf16 v[136:139], a[48:51], a[40:43], v[136:139]
  v_cndmask_b32_dpp v152, v150, v148, vcc quad_perm:[1,0,3,2] row_mask:0xf bank_mask:0xf
  v_cndmask_b32_dpp v153, v151, v149, vcc quad_perm:[1,0,3,2] row_mask:0xf bank_mask:0xf
  v_mfma_f32_16x16x32_bf16 v[108:111], a[44:47], a[52:55], v[108:111]
  s_not_b64 vcc, vcc
  v_cndmask_b32_dpp v154, v148, v150, vcc quad_perm:[1,0,3,2] row_mask:0xf bank_mask:0xf
  s_nop 0
  v_mfma_f32_16x16x32_bf16 v[140:143], a[48:51], a[52:55], v[140:143]
  v_cndmask_b32_dpp v155, v149, v151, vcc quad_perm:[1,0,3,2] row_mask:0xf bank_mask:0xf
  buffer_store_dwordx4 v[152:155], v147, s[32:35], s56 offen offset:0 sc0 sc1
  s_waitcnt lgkmcnt(0)
  s_nop 0
  v_mfma_f32_16x16x32_bf16 v[96:99], a[68:71], a[56:59], v[96:99]
  ds_read_b128 a[16:19], v146 offset:9216
  ds_read_b128 a[28:31], v145 offset:4096
  v_mfma_f32_16x16x32_bf16 v[128:131], a[72:75], a[56:59], v[128:131]
  ds_read_b128 a[88:91], v146 offset:9472
  ds_read_b128 a[20:23], v145 offset:6144
  v_mfma_f32_16x16x32_bf16 v[100:103], a[68:71], a[60:63], v[100:103]
  ds_read_b128 a[24:27], v146 offset:9728
  ds_read_b128 a[92:95], v146 offset:9984
  v_mfma_f32_16x16x32_bf16 v[132:135], a[72:75], a[60:63], v[132:135]
  v_cvt_pk_bf16_f32 v148, v114, v118
  v_cvt_pk_bf16_f32 v149, v122, v126
  v_mfma_f32_16x16x32_bf16 v[104:107], a[68:71], a[64:67], v[104:107]
  v_cvt_pk_bf16_f32 v150, v115, v119
  v_cvt_pk_bf16_f32 v151, v123, v127
  v_mfma_f32_16x16x32_bf16 v[136:139], a[72:75], a[64:67], v[136:139]
  v_cndmask_b32_dpp v158, v148, v150, vcc quad_perm:[1,0,3,2] row_mask:0xf bank_mask:0xf
  v_cndmask_b32_dpp v159, v149, v151, vcc quad_perm:[1,0,3,2] row_mask:0xf bank_mask:0xf
  v_mfma_f32_16x16x32_bf16 v[108:111], a[68:71], a[76:79], v[108:111]
  s_not_b64 vcc, vcc
  v_cndmask_b32_dpp v156, v150, v148, vcc quad_perm:[1,0,3,2] row_mask:0xf bank_mask:0xf
  s_nop 0
  v_mfma_f32_16x16x32_bf16 v[140:143], a[72:75], a[76:79], v[140:143]
  v_cndmask_b32_dpp v157, v151, v149, vcc quad_perm:[1,0,3,2] row_mask:0xf bank_mask:0xf
  buffer_store_dwordx4 v[156:159], v147, s[32:35], s58 offen offset:0 sc0 sc1
  v_mfma_f32_16x16x32_bf16 v[96:99], a[4:7], a[80:83], v[96:99]
  v_mfma_f32_16x16x32_bf16 v[128:131], a[8:11], a[80:83], v[128:131]
  v_mfma_f32_16x16x32_bf16 v[100:103], a[4:7], a[84:87], v[100:103]
  v_mfma_f32_16x16x32_bf16 v[132:135], a[8:11], a[84:87], v[132:135]
  v_mfma_f32_16x16x32_bf16 v[104:107], a[4:7], a[0:3], v[104:107]
  v_mfma_f32_16x16x32_bf16 v[136:139], a[8:11], a[0:3], v[136:139]
  v_mfma_f32_16x16x32_bf16 v[108:111], a[4:7], a[12:15], v[108:111]
  v_mfma_f32_16x16x32_bf16 v[140:143], a[8:11], a[12:15], v[140:143]
  s_waitcnt lgkmcnt(0)
  s_nop 0
  v_mfma_f32_16x16x32_bf16 v[96:99], a[28:31], a[16:19], v[96:99]
  v_mfma_f32_16x16x32_bf16 v[100:103], a[28:31], a[88:91], v[100:103]
  v_mfma_f32_16x16x32_bf16 v[104:107], a[28:31], a[24:27], v[104:107]
  v_mfma_f32_16x16x32_bf16 v[108:111], a[28:31], a[92:95], v[108:111]
  v_mfma_f32_16x16x32_bf16 v[128:131], a[20:23], a[16:19], v[128:131]
  v_mfma_f32_16x16x32_bf16 v[132:135], a[20:23], a[88:91], v[132:135]
  v_mfma_f32_16x16x32_bf16 v[136:139], a[20:23], a[24:27], v[136:139]
  v_mfma_f32_16x16x32_bf16 v[140:143], a[20:23], a[92:95], v[140:143]
  s_nop 7
L_fin:
  v_cvt_pk_bf16_f32 v150, v97, v101
  v_cvt_pk_bf16_f32 v151, v105, v109
  v_cvt_pk_bf16_f32 v148, v96, v100
  v_cvt_pk_bf16_f32 v149, v104, v108
  v_cndmask_b32_dpp v152, v150, v148, vcc quad_perm:[1,0,3,2] row_mask:0xf bank_mask:0xf
  v_cndmask_b32_dpp v153, v151, v149, vcc quad_perm:[1,0,3,2] row_mask:0xf bank_mask:0xf
  s_not_b64 vcc, vcc
  v_cndmask_b32_dpp v154, v148, v150, vcc quad_perm:[1,0,3,2] row_mask:0xf bank_mask:0xf
  v_cndmask_b32_dpp v155, v149, v151, vcc quad_perm:[1,0,3,2] row_mask:0xf bank_mask:0xf
  buffer_store_dwordx4 v[152:155], v147, s[32:35], s52 offen offset:128 sc0 sc1
  v_cvt_pk_bf16_f32 v148, v98, v102
  v_cvt_pk_bf16_f32 v149, v106, v110
  v_cvt_pk_bf16_f32 v150, v99, v103
  v_cvt_pk_bf16_f32 v151, v107, v111
  v_cndmask_b32_dpp v158, v148, v150, vcc quad_perm:[1,0,3,2] row_mask:0xf bank_mask:0xf
  v_cndmask_b32_dpp v159, v149, v151, vcc quad_perm:[1,0,3,2] row_mask:0xf bank_mask:0xf
  s_not_b64 vcc, vcc
  v_cndmask_b32_dpp v156, v150, v148, vcc quad_perm:[1,0,3,2] row_mask:0xf bank_mask:0xf
  v_cndmask_b32_dpp v157, v151, v149, vcc quad_perm:[1,0,3,2] row_mask:0xf bank_mask:0xf
  buffer_store_dwordx4 v[156:159], v147, s[32:35], s54 offen offset:128 sc0 sc1
  v_cvt_pk_bf16_f32 v150, v129, v133
  v_cvt_pk_bf16_f32 v151, v137, v141
  v_cvt_pk_bf16_f32 v148, v128, v132
  v_cvt_pk_bf16_f32 v149, v136, v140
  v_cndmask_b32_dpp v152, v150, v148, vcc quad_perm:[1,0,3,2] row_mask:0xf bank_mask:0xf
  v_cndmask_b32_dpp v153, v151, v149, vcc quad_perm:[1,0,3,2] row_mask:0xf bank_mask:0xf
  s_not_b64 vcc, vcc
  v_cndmask_b32_dpp v154, v148, v150, vcc quad_perm:[1,0,3,2] row_mask:0xf bank_mask:0xf
  v_cndmask_b32_dpp v155, v149, v151, vcc quad_perm:[1,0,3,2] row_mask:0xf bank_mask:0xf
  buffer_store_dwordx4 v[152:155], v147, s[32:35], s56 offen offset:128 sc0 sc1
  v_cvt_pk_bf16_f32 v148, v130, v134
  v_cvt_pk_bf16_f32 v149, v138, v142
  v_cvt_pk_bf16_f32 v150, v131, v135
  v_cvt_pk_bf16_f32 v151, v139, v143
  v_cndmask_b32_dpp v158, v148, v150, vcc quad_perm:[1,0,3,2] row_mask:0xf bank_mask:0xf
  v_cndmask_b32_dpp v159, v149, v151, vcc quad_perm:[1,0,3,2] row_mask:0xf bank_mask:0xf
  s_not_b64 vcc, vcc
  v_cndmask_b32_dpp v156, v150, v148, vcc quad_perm:[1,0,3,2] row_mask:0xf bank_mask:0xf
  v_cndmask_b32_dpp v157, v151, v149, vcc quad_perm:[1,0,3,2] row_mask:0xf bank_mask:0xf
  buffer_store_dwordx4 v[156:159], v147, s[32:35], s58 offen offset:128 sc0 sc1
  s_endpgm
L_loader:
  s_add_u32 s58, s40, 2
  s_lshl_b32 s58, s58, 7
  s_load_dword s68, s[12:13], s58 offset:0
  s_load_dword s69, s[12:13], s58 offset:64
  s_load_dword s70, s[12:13], s58 offset:2048
  s_load_dword s71, s[12:13], s58 offset:2112
  s_load_dword s72, s[12:13], s58 offset:4096
  s_load_dword s73, s[12:13], s58 offset:4160
  s_waitcnt vmcnt(0)
  s_mov_b64 exec, 1
  buffer_store_dwordx2 v[10:11], v14, s[28:31], 0 offen sc1
  s_mov_b64 exec, -1
  s_barrier
  s_add_u32 s43, s40, 0
  s_lshl_b32 s43, s43, 9
  s_load_dwordx4 s[64:67], s[4:5], s43 glc
  s_add_u32 s41, s40, 0
  s_lshl_b32 s41, s41, 7
  s_add_u32 m0, s60, 49152
  s_nop 0
  buffer_load_dwordx4 v16, s[16:19], s41 offen offset:0  lds
  buffer_load_dwordx4 v17, s[16:19], s41 offen offset:1024  lds
  buffer_load_dwordx4 v18, s[16:19], s41 offen offset:2048  lds
  buffer_load_dwordx4 v19, s[16:19], s41 offen offset:3072  lds
  s_add_u32 m0, s60, 53248
  s_add_u32 s41, s41, 65536
  buffer_load_dwordx4 v16, s[16:19], s41 offen offset:0  lds
  buffer_load_dwordx4 v17, s[16:19], s41 offen offset:1024  lds
  buffer_load_dwordx4 v18, s[16:19], s41 offen offset:2048  lds
  buffer_load_dwordx4 v19, s[16:19], s41 offen offset:3072  lds
  s_mov_b32 s63, 0
L_sp1:
  s_waitcnt lgkmcnt(0)
  s_xor_b64 s[10:11], s[64:65], s[8:9]
  s_xor_b64 s[14:15], s[66:67], s[8:9]
  s_or_b64 s[10:11], s[10:11], s[14:15]
  s_cbranch_scc0 L_ok1
  s_load_dwordx4 s[64:67], s[4:5], s43 glc
  s_add_u32 s63, s63, 1
  s_cmp_lt_u32 s63, 20000
  s_cbranch_scc1 L_sp1
  s_waitcnt lgkmcnt(0)
L_ok1:
  s_add_u32 s43, s40, 1
  s_lshl_b32 s43, s43, 9
  s_load_dwordx4 s[64:67], s[4:5], s43 glc
  s_add_u32 m0, s61, 49152
  s_add_u32 s62, s40, 0
  s_lshl_b32 s62, s62, 14
  buffer_load_dwordx4 v20, s[28:31], s62 offen offset:0 sc1 lds
  buffer_load_dwordx4 v20, s[28:31], s62 offen offset:1024 sc1 lds
  buffer_load_dwordx4 v20, s[28:31], s62 offen offset:2048 sc1 lds
  buffer_load_dwordx4 v20, s[28:31], s62 offen offset:3072 sc1 lds
  s_add_u32 s41, s40, 1
  s_lshl_b32 s41, s41, 7
  s_add_u32 m0, s60, 98304
  s_nop 0
  buffer_load_dwordx4 v16, s[16:19], s41 offen offset:0  lds
  buffer_load_dwordx4 v17, s[16:19], s41 offen offset:1024  lds
  buffer_load_dwordx4 v18, s[16:19], s41 offen offset:2048  lds
  buffer_load_dwordx4 v19, s[16:19], s41 offen offset:3072  lds
  s_add_u32 m0, s60, 102400
  s_add_u32 s41, s41, 65536
  buffer_load_dwordx4 v16, s[16:19], s41 offen offset:0  lds
  buffer_load_dwordx4 v17, s[16:19], s41 offen offset:1024  lds
  buffer_load_dwordx4 v18, s[16:19], s41 offen offset:2048  lds
  buffer_load_dwordx4 v19, s[16:19], s41 offen offset:3072  lds
  s_mov_b32 s63, 0
L_sp2:
  s_waitcnt lgkmcnt(0)
  s_xor_b64 s[10:11], s[64:65], s[8:9]
  s_xor_b64 s[14:15], s[66:67], s[8:9]
  s_or_b64 s[10:11], s[10:11], s[14:15]
  s_cbranch_scc0 L_ok2
  s_load_dwordx4 s[64:67], s[4:5], s43 glc
  s_add_u32 s63, s63, 1
  s_cmp_lt_u32 s63, 20000
  s_cbranch_scc1 L_sp2
  s_waitcnt lgkmcnt(0)
L_ok2:
  s_add_u32 s43, s40, 2
  s_lshl_b32 s43, s43, 9
  s_load_dwordx4 s[64:67], s[4:5], s43 glc
  s_add_u32 s58, s40, 3
  s_lshl_b32 s58, s58, 7
  s_load_dword s68, s[12:13], s58 offset:0
  s_load_dword s69, s[12:13], s58 offset:64
  s_load_dword s70, s[12:13], s58 offset:2048
  s_load_dword s71, s[12:13], s58 offset:2112
  s_load_dword s72, s[12:13], s58 offset:4096
  s_load_dword s73, s[12:13], s58 offset:4160
  s_add_u32 m0, s61, 98304
  s_add_u32 s62, s40, 1
  s_lshl_b32 s62, s62, 14
  buffer_load_dwordx4 v20, s[28:31], s62 offen offset:0 sc1 lds
  buffer_load_dwordx4 v20, s[28:31], s62 offen offset:1024 sc1 lds
  buffer_load_dwordx4 v20, s[28:31], s62 offen offset:2048 sc1 lds
  buffer_load_dwordx4 v20, s[28:31], s62 offen offset:3072 sc1 lds
  s_waitcnt vmcnt(12)
  s_barrier
  s_add_u32 s41, s40, 2
  s_lshl_b32 s41, s41, 7
  s_add_u32 m0, s60, 0
  s_nop 0
  buffer_load_dwordx4 v16, s[16:19], s41 offen offset:0  lds
  buffer_load_dwordx4 v17, s[16:19], s41 offen offset:1024  lds
  buffer_load_dwordx4 v18, s[16:19], s41 offen offset:2048  lds
  buffer_load_dwordx4 v19, s[16:19], s41 offen offset:3072  lds
  s_add_u32 m0, s60, 4096
  s_add_u32 s41, s41, 65536
  buffer_load_dwordx4 v16, s[16:19], s41 offen offset:0  lds
  buffer_load_dwordx4 v17, s[16:19], s41 offen offset:1024  lds
  buffer_load_dwordx4 v18, s[16:19], s41 offen offset:2048  lds
  buffer_load_dwordx4 v19, s[16:19], s41 offen offset:3072  lds
  s_mov_b32 s63, 0
L_sp3:
  s_waitcnt lgkmcnt(0)
  s_xor_b64 s[10:11], s[64:65], s[8:9]
  s_xor_b64 s[14:15], s[66:67], s[8:9]
  s_or_b64 s[10:11], s[10:11], s[14:15]
  s_cbranch_scc0 L_ok3
  s_load_dwordx4 s[64:67], s[4:5], s43 glc
  s_add_u32 s63, s63, 1
  s_cmp_lt_u32 s63, 20000
  s_cbranch_scc1 L_sp3
  s_waitcnt lgkmcnt(0)
L_ok3:
  s_add_u32 s43, s40, 3
  s_lshl_b32 s43, s43, 9
  s_load_dwordx4 s[64:67], s[4:5], s43 glc
  s_xor_b32 s58, s40, 4
  s_cmp_ge_u32 s58, s36
  s_addc_u32 s58, s58, 0
  s_lshl_b32 s58, s58, 7
  s_load_dword s68, s[12:13], s58 offset:0
  s_load_dword s69, s[12:13], s58 offset:64
  s_load_dword s70, s[12:13], s58 offset:2048
  s_load_dword s71, s[12:13], s58 offset:2112
  s_load_dword s72, s[12:13], s58 offset:4096
  s_load_dword s73, s[12:13], s58 offset:4160
  s_add_u32 m0, s61, 0
  s_add_u32 s62, s40, 2
  s_lshl_b32 s62, s62, 14
  buffer_load_dwordx4 v20, s[28:31], s62 offen offset:0 sc1 lds
  buffer_load_dwordx4 v20, s[28:31], s62 offen offset:1024 sc1 lds
  buffer_load_dwordx4 v20, s[28:31], s62 offen offset:2048 sc1 lds
  buffer_load_dwordx4 v20, s[28:31], s62 offen offset:3072 sc1 lds
  s_waitcnt vmcnt(12)
  s_barrier
  s_add_u32 s41, s40, 3
  s_lshl_b32 s41, s41, 7
  s_add_u32 m0, s60, 49152
  s_nop 0
  buffer_load_dwordx4 v16, s[16:19], s41 offen offset:0  lds
  buffer_load_dwordx4 v17, s[16:19], s41 offen offset:1024  lds
  buffer_load_dwordx4 v18, s[16:19], s41 offen offset:2048  lds
  buffer_load_dwordx4 v19, s[16:19], s41 offen offset:3072  lds
  s_add_u32 m0, s60, 53248
  s_add_u32 s41, s41, 65536
  buffer_load_dwordx4 v16, s[16:19], s41 offen offset:0  lds
  buffer_load_dwordx4 v17, s[16:19], s41 offen offset:1024  lds
  buffer_load_dwordx4 v18, s[16:19], s41 offen offset:2048  lds
  buffer_load_dwordx4 v19, s[16:19], s41 offen offset:3072  lds
  s_mov_b32 s63, 0
L_sp4:
  s_waitcnt lgkmcnt(0)
  s_xor_b64 s[10:11], s[64:65], s[8:9]
  s_xor_b64 s[14:15], s[66:67], s[8:9]
  s_or_b64 s[10:11], s[10:11], s[14:15]
  s_cbranch_scc0 L_ok4
  s_load_dwordx4 s[64:67], s[4:5], s43 glc
  s_add_u32 s63, s63, 1
  s_cmp_lt_u32 s63, 20000
  s_cbranch_scc1 L_sp4
  s_waitcnt lgkmcnt(0)
L_ok4:
  s_xor_b32 s43, s40, 4
  s_cmp_ge_u32 s43, s36
  s_addc_u32 s43, s43, 0
  s_lshl_b32 s43, s43, 9
  s_load_dwordx4 s[64:67], s[4:5], s43 glc
  s_xor_b32 s58, s40, 5
  s_cmp_ge_u32 s58, s36
  s_addc_u32 s58, s58, 0
  s_lshl_b32 s58, s58, 7
  s_load_dword s68, s[12:13], s58 offset:0
  s_load_dword s69, s[12:13], s58 offset:64
  s_load_dword s70, s[12:13], s58 offset:2048
  s_load_dword s71, s[12:13], s58 offset:2112
  s_load_dword s72, s[12:13], s58 offset:4096
  s_load_dword s73, s[12:13], s58 offset:4160
  s_xor_b32 s58, s40, 6
  s_cmp_ge_u32 s58, s36
  s_addc_u32 s58, s58, 0
  s_lshl_b32 s58, s58, 7
  s_load_dword s68, s[12:13], s58 offset:0
  s_load_dword s69, s[12:13], s58 offset:64
  s_load_dword s70, s[12:13], s58 offset:2048
  s_load_dword s71, s[12:13], s58 offset:2112
  s_load_dword s72, s[12:13], s58 offset:4096
  s_load_dword s73, s[12:13], s58 offset:4160
  s_add_u32 m0, s61, 49152
  s_add_u32 s62, s40, 3
  s_lshl_b32 s62, s62, 14
  buffer_load_dwordx4 v20, s[28:31], s62 offen offset:0 sc1 lds
  buffer_load_dwordx4 v20, s[28:31], s62 offen offset:1024 sc1 lds
  buffer_load_dwordx4 v20, s[28:31], s62 offen offset:2048 sc1 lds
  buffer_load_dwordx4 v20, s[28:31], s62 offen offset:3072 sc1 lds
  s_waitcnt vmcnt(12)
  s_barrier
  s_xor_b32 s41, s40, 4
  s_cmp_ge_u32 s41, s36
  s_addc_u32 s41, s41, 0
  s_lshl_b32 s41, s41, 7
  s_add_u32 m0, s60, 98304
  s_nop 0
  buffer_load_dwordx4 v16, s[16:19], s41 offen offset:0  lds
  buffer_load_dwordx4 v17, s[16:19], s41 offen offset:1024  lds
  buffer_load_dwordx4 v18, s[16:19], s41 offen offset:2048  lds
  buffer_load_dwordx4 v19, s[16:19], s41 offen offset:3072  lds
  s_add_u32 m0, s60, 102400
  s_add_u32 s41, s41, 65536
  buffer_load_dwordx4 v16, s[16:19], s41 offen offset:0  lds
  buffer_load_dwordx4 v17, s[16:19], s41 offen offset:1024  lds
  buffer_load_dwordx4 v18, s[16:19], s41 offen offset:2048  lds
  buffer_load_dwordx4 v19, s[16:19], s41 offen offset:3072  lds
  s_mov_b32 s63, 0
L_sp5:
  s_waitcnt lgkmcnt(0)
  s_xor_b64 s[10:11], s[64:65], s[8:9]
  s_xor_b64 s[14:15], s[66:67], s[8:9]
  s_or_b64 s[10:11], s[10:11], s[14:15]
  s_cbranch_scc0 L_ok5
  s_load_dwordx4 s[64:67], s[4:5], s43 glc
  s_add_u32 s63, s63, 1
  s_cmp_lt_u32 s63, 20000
  s_cbranch_scc1 L_sp5
  s_waitcnt lgkmcnt(0)
L_ok5:
  s_xor_b32 s43, s40, 5
  s_cmp_ge_u32 s43, s36
  s_addc_u32 s43, s43, 0
  s_lshl_b32 s43, s43, 9
  s_load_dwordx4 s[64:67], s[4:5], s43 glc
  s_mov_b32 s58, 1024
  s_load_dword s68, s[12:13], s58 offset:0
  s_load_dword s69, s[12:13], s58 offset:64
  s_load_dword s70, s[12:13], s58 offset:2048
  s_load_dword s71, s[12:13], s58 offset:2112
  s_load_dword s72, s[12:13], s58 offset:4096
  s_load_dword s73, s[12:13], s58 offset:4160
  s_mov_b32 s58, 1152
  s_load_dword s68, s[12:13], s58 offset:0
  s_load_dword s69, s[12:13], s58 offset:64
  s_load_dword s70, s[12:13], s58 offset:2048
  s_load_dword s71, s[12:13], s58 offset:2112
  s_load_dword s72, s[12:13], s58 offset:4096
  s_load_dword s73, s[12:13], s58 offset:4160
  s_add_u32 m0, s61, 98304
  s_xor_b32 s62, s40, 4
  s_cmp_ge_u32 s62, s36
  s_addc_u32 s62, s62, 0
  s_lshl_b32 s62, s62, 14
  buffer_load_dwordx4 v20, s[28:31], s62 offen offset:0 sc1 lds
  buffer_load_dwordx4 v20, s[28:31], s62 offen offset:1024 sc1 lds
  buffer_load_dwordx4 v20, s[28:31], s62 offen offset:2048 sc1 lds
  buffer_load_dwordx4 v20, s[28:31], s62 offen offset:3072 sc1 lds
  s_waitcnt vmcnt(12)
  s_barrier
  s_xor_b32 s41, s40, 5
  s_cmp_ge_u32 s41, s36
  s_addc_u32 s41, s41, 0
  s_lshl_b32 s41, s41, 7
  s_add_u32 m0, s60, 0
  s_nop 0
  buffer_load_dwordx4 v16, s[16:19], s41 offen offset:0  lds
  buffer_load_dwordx4 v17, s[16:19], s41 offen offset:1024  lds
  buffer_load_dwordx4 v18, s[16:19], s41 offen offset:2048  lds
  buffer_load_dwordx4 v19, s[16:19], s41 offen offset:3072  lds
  s_add_u32 m0, s60, 4096
  s_add_u32 s41, s41, 65536
  buffer_load_dwordx4 v16, s[16:19], s41 offen offset:0  lds
  buffer_load_dwordx4 v17, s[16:19], s41 offen offset:1024  lds
  buffer_load_dwordx4 v18, s[16:19], s41 offen offset:2048  lds
  buffer_load_dwordx4 v19, s[16:19], s41 offen offset:3072  lds
  s_mov_b32 s63, 0
L_sp6:
  s_waitcnt lgkmcnt(0)
  s_xor_b64 s[10:11], s[64:65], s[8:9]
  s_xor_b64 s[14:15], s[66:67], s[8:9]
  s_or_b64 s[10:11], s[10:11], s[14:15]
  s_cbranch_scc0 L_ok6
  s_load_dwordx4 s[64:67], s[4:5], s43 glc
  s_add_u32 s63, s63, 1
  s_cmp_lt_u32 s63, 20000
  s_cbranch_scc1 L_sp6
  s_waitcnt lgkmcnt(0)
L_ok6:
  s_xor_b32 s43, s40, 6
  s_cmp_ge_u32 s43, s36
  s_addc_u32 s43, s43, 0
  s_lshl_b32 s43, s43, 9
  s_load_dwordx4 s[64:67], s[4:5], s43 glc
  s_mov_b32 s58, 1280
  s_load_dword s68, s[12:13], s58 offset:0
  s_load_dword s69, s[12:13], s58 offset:64
  s_load_dword s70, s[12:13], s58 offset:2048
  s_load_dword s71, s[12:13], s58 offset:2112
  s_load_dword s72, s[12:13], s58 offset:4096
  s_load_dword s73, s[12:13], s58 offset:4160
  s_add_u32 m0, s61, 0
  s_xor_b32 s62, s40, 5
  s_cmp_ge_u32 s62, s36
  s_addc_u32 s62, s62, 0
  s_lshl_b32 s62, s62, 14
  buffer_load_dwordx4 v20, s[28:31], s62 offen offset:0 sc1 lds
  buffer_load_dwordx4 v20, s[28:31], s62 offen offset:1024 sc1 lds
  buffer_load_dwordx4 v20, s[28:31], s62 offen offset:2048 sc1 lds
  buffer_load_dwordx4 v20, s[28:31], s62 offen offset:3072 sc1 lds
  s_waitcnt vmcnt(12)
  s_barrier
  s_xor_b32 s41, s40, 6
  s_cmp_ge_u32 s41, s36
  s_addc_u32 s41, s41, 0
  s_lshl_b32 s41, s41, 7
  s_add_u32 m0, s60, 49152
  s_nop 0
  buffer_load_dwordx4 v16, s[16:19], s41 offen offset:0  lds
  buffer_load_dwordx4 v17, s[16:19], s41 offen offset:1024  lds
  buffer_load_dwordx4 v18, s[16:19], s41 offen offset:2048  lds
  buffer_load_dwordx4 v19, s[16:19], s41 offen offset:3072  lds
  s_add_u32 m0, s60, 53248
  s_add_u32 s41, s41, 65536
  buffer_load_dwordx4 v16, s[16:19], s41 offen offset:0  lds
  buffer_load_dwordx4 v17, s[16:19], s41 offen offset:1024  lds
  buffer_load_dwordx4 v18, s[16:19], s41 offen offset:2048  lds
  buffer_load_dwordx4 v19, s[16:19], s41 offen offset:3072  lds
  s_mov_b32 s63, 0
L_sp7:
  s_waitcnt lgkmcnt(0)
  s_xor_b64 s[10:11], s[64:65], s[8:9]
  s_xor_b64 s[14:15], s[66:67], s[8:9]
  s_or_b64 s[10:11], s[10:11], s[14:15]
  s_cbranch_scc0 L_ok7
  s_load_dwordx4 s[64:67], s[4:5], s43 glc
  s_add_u32 s63, s63, 1
  s_cmp_lt_u32 s63, 20000
  s_cbranch_scc1 L_sp7
  s_waitcnt lgkmcnt(0)
L_ok7:
  s_mov_b32 s43, 4096
  s_load_dwordx4 s[64:67], s[4:5], s43 glc
  s_mov_b32 s58, 1408
  s_load_dword s68, s[12:13], s58 offset:0
  s_load_dword s69, s[12:13], s58 offset:64
  s_load_dword s70, s[12:13], s58 offset:2048
  s_load_dword s71, s[12:13], s58 offset:2112
  s_load_dword s72, s[12:13], s58 offset:4096
  s_load_dword s73, s[12:13], s58 offset:4160
  s_add_u32 m0, s61, 49152
  s_xor_b32 s62, s40, 6
  s_cmp_ge_u32 s62, s36
  s_addc_u32 s62, s62, 0
  s_lshl_b32 s62, s62, 14
  buffer_load_dwordx4 v20, s[28:31], s62 offen offset:0 sc1 lds
  buffer_load_dwordx4 v20, s[28:31], s62 offen offset:1024 sc1 lds
  buffer_load_dwordx4 v20, s[28:31], s62 offen offset:2048 sc1 lds
  buffer_load_dwordx4 v20, s[28:31], s62 offen offset:3072 sc1 lds
  s_waitcnt vmcnt(12)
  s_barrier
  s_mov_b32 s41, 1024
  s_add_u32 m0, s60, 98304
  s_nop 0
  buffer_load_dwordx4 v16, s[16:19], s41 offen offset:0  lds
  buffer_load_dwordx4 v17, s[16:19], s41 offen offset:1024  lds
  buffer_load_dwordx4 v18, s[16:19], s41 offen offset:2048  lds
  buffer_load_dwordx4 v19, s[16:19], s41 offen offset:3072  lds
  s_add_u32 m0, s60, 102400
  s_add_u32 s41, s41, 65536
  buffer_load_dwordx4 v16, s[16:19], s41 offen offset:0  lds
  buffer_load_dwordx4 v17, s[16:19], s41 offen offset:1024  lds
  buffer_load_dwordx4 v18, s[16:19], s41 offen offset:2048  lds
  buffer_load_dwordx4 v19, s[16:19], s41 offen offset:3072  lds
  s_mov_b32 s63, 0
L_sp8:
  s_waitcnt lgkmcnt(0)
  s_xor_b64 s[10:11], s[64:65], s[8:9]
  s_xor_b64 s[14:15], s[66:67], s[8:9]
  s_or_b64 s[10:11], s[10:11], s[14:15]
  s_cbranch_scc0 L_ok8
  s_load_dwordx4 s[64:67], s[4:5], s43 glc
  s_add_u32 s63, s63, 1
  s_cmp_lt_u32 s63, 20000
  s_cbranch_scc1 L_sp8
  s_waitcnt lgkmcnt(0)
L_ok8:
  s_mov_b32 s43, 4608
  s_load_dwordx4 s[64:67], s[4:5], s43 glc
  s_mov_b32 s58, 1536
  s_load_dword s68, s[12:13], s58 offset:0
  s_load_dword s69, s[12:13], s58 offset:64
  s_load_dword s70, s[12:13], s58 offset:2048
  s_load_dword s71, s[12:13], s58 offset:2112
  s_load_dword s72, s[12:13], s58 offset:4096
  s_load_dword s73, s[12:13], s58 offset:4160
  s_add_u32 m0, s61, 98304
  s_mov_b32 s62, 131072
  buffer_load_dwordx4 v20, s[28:31], s62 offen offset:0 sc1 lds
  buffer_load_dwordx4 v20, s[28:31], s62 offen offset:1024 sc1 lds
  buffer_load_dwordx4 v20, s[28:31], s62 offen offset:2048 sc1 lds
  buffer_load_dwordx4 v20, s[28:31], s62 offen offset:3072 sc1 lds
  s_waitcnt vmcnt(12)
  s_barrier
  s_mov_b32 s41, 1152
  s_add_u32 m0, s60, 0
  s_nop 0
  buffer_load_dwordx4 v16, s[16:19], s41 offen offset:0  lds
  buffer_load_dwordx4 v17, s[16:19], s41 offen offset:1024  lds
  buffer_load_dwordx4 v18, s[16:19], s41 offen offset:2048  lds
  buffer_load_dwordx4 v19, s[16:19], s41 offen offset:3072  lds
  s_add_u32 m0, s60, 4096
  s_add_u32 s41, s41, 65536
  buffer_load_dwordx4 v16, s[16:19], s41 offen offset:0  lds
  buffer_load_dwordx4 v17, s[16:19], s41 offen offset:1024  lds
  buffer_load_dwordx4 v18, s[16:19], s41 offen offset:2048  lds
  buffer_load_dwordx4 v19, s[16:19], s41 offen offset:3072  lds
  s_mov_b32 s63, 0
L_sp9:
  s_waitcnt lgkmcnt(0)
  s_xor_b64 s[10:11], s[64:65], s[8:9]
  s_xor_b64 s[14:15], s[66:67], s[8:9]
  s_or_b64 s[10:11], s[10:11], s[14:15]
  s_cbranch_scc0 L_ok9
  s_load_dwordx4 s[64:67], s[4:5], s43 glc
  s_add_u32 s63, s63, 1
  s_cmp_lt_u32 s63, 20000
  s_cbranch_scc1 L_sp9
  s_waitcnt lgkmcnt(0)
L_ok9:
  s_mov_b32 s43, 5120
  s_load_dwordx4 s[64:67], s[4:5], s43 glc
  s_mov_b32 s58, 1664
  s_load_dword s68, s[12:13], s58 offset:0
  s_load_dword s69, s[12:13], s58 offset:64
  s_load_dword s70, s[12:13], s58 offset:2048
  s_load_dword s71, s[12:13], s58 offset:2112
  s_load_dword s72, s[12:13], s58 offset:4096
  s_load_dword s73, s[12:13], s58 offset:4160
  s_add_u32 m0, s61, 0
  s_mov_b32 s62, 147456
  buffer_load_dwordx4 v20, s[28:31], s62 offen offset:0 sc1 lds
  buffer_load_dwordx4 v20, s[28:31], s62 offen offset:1024 sc1 lds
  buffer_load_dwordx4 v20, s[28:31], s62 offen offset:2048 sc1 lds
  buffer_load_dwordx4 v20, s[28:31], s62 offen offset:3072 sc1 lds
  s_waitcnt vmcnt(12)
  s_barrier
  s_mov_b32 s41, 1280
  s_add_u32 m0, s60, 49152
  s_nop 0
  buffer_load_dwordx4 v16, s[16:19], s41 offen offset:0  lds
  buffer_load_dwordx4 v17, s[16:19], s41 offen offset:1024  lds
  buffer_load_dwordx4 v18, s[16:19], s41 offen offset:2048  lds
  buffer_load_dwordx4 v19, s[16:19], s41 offen offset:3072  lds
  s_add_u32 m0, s60, 53248
  s_add_u32 s41, s41, 65536
  buffer_load_dwordx4 v16, s[16:19], s41 offen offset:0  lds
  buffer_load_dwordx4 v17, s[16:19], s41 offen offset:1024  lds
  buffer_load_dwordx4 v18, s[16:19], s41 offen offset:2048  lds
  buffer_load_dwordx4 v19, s[16:19], s41 offen offset:3072  lds
  s_mov_b32 s63, 0
L_sp10:
  s_waitcnt lgkmcnt(0)
  s_xor_b64 s[10:11], s[64:65], s[8:9]
  s_xor_b64 s[14:15], s[66:67], s[8:9]
  s_or_b64 s[10:11], s[10:11], s[14:15]
  s_cbranch_scc0 L_ok10
  s_load_dwordx4 s[64:67], s[4:5], s43 glc
  s_add_u32 s63, s63, 1
  s_cmp_lt_u32 s63, 20000
  s_cbranch_scc1 L_sp10
  s_waitcnt lgkmcnt(0)
L_ok10:
  s_mov_b32 s43, 5632
  s_load_dwordx4 s[64:67], s[4:5], s43 glc
  s_mov_b32 s58, 1792
  s_load_dword s68, s[12:13], s58 offset:0
  s_load_dword s69, s[12:13], s58 offset:64
  s_load_dword s70, s[12:13], s58 offset:2048
  s_load_dword s71, s[12:13], s58 offset:2112
  s_load_dword s72, s[12:13], s58 offset:4096
  s_load_dword s73, s[12:13], s58 offset:4160
  s_add_u32 m0, s61, 49152
  s_mov_b32 s62, 163840
  buffer_load_dwordx4 v20, s[28:31], s62 offen offset:0 sc1 lds
  buffer_load_dwordx4 v20, s[28:31], s62 offen offset:1024 sc1 lds
  buffer_load_dwordx4 v20, s[28:31], s62 offen offset:2048 sc1 lds
  buffer_load_dwordx4 v20, s[28:31], s62 offen offset:3072 sc1 lds
  s_waitcnt vmcnt(12)
  s_barrier
  s_mov_b32 s41, 1408
  s_add_u32 m0, s60, 98304
  s_nop 0
  buffer_load_dwordx4 v16, s[16:19], s41 offen offset:0  lds
  buffer_load_dwordx4 v17, s[16:19], s41 offen offset:1024  lds
  buffer_load_dwordx4 v18, s[16:19], s41 offen offset:2048  lds
  buffer_load_dwordx4 v19, s[16:19], s41 offen offset:3072  lds
  s_add_u32 m0, s60, 102400
  s_add_u32 s41, s41, 65536
  buffer_load_dwordx4 v16, s[16:19], s41 offen offset:0  lds
  buffer_load_dwordx4 v17, s[16:19], s41 offen offset:1024  lds
  buffer_load_dwordx4 v18, s[16:19], s41 offen offset:2048  lds
  buffer_load_dwordx4 v19, s[16:19], s41 offen offset:3072  lds
  s_mov_b32 s63, 0
L_sp11:
  s_waitcnt lgkmcnt(0)
  s_xor_b64 s[10:11], s[64:65], s[8:9]
  s_xor_b64 s[14:15], s[66:67], s[8:9]
  s_or_b64 s[10:11], s[10:11], s[14:15]
  s_cbranch_scc0 L_ok11
  s_load_dwordx4 s[64:67], s[4:5], s43 glc
  s_add_u32 s63, s63, 1
  s_cmp_lt_u32 s63, 20000
  s_cbranch_scc1 L_sp11
  s_waitcnt lgkmcnt(0)
L_ok11:
  s_mov_b32 s43, 6144
  s_load_dwordx4 s[64:67], s[4:5], s43 glc
  s_mov_b32 s58, 1920
  s_load_dword s68, s[12:13], s58 offset:0
  s_load_dword s69, s[12:13], s58 offset:64
  s_load_dword s70, s[12:13], s58 offset:2048
  s_load_dword s71, s[12:13], s58 offset:2112
  s_load_dword s72, s[12:13], s58 offset:4096
  s_load_dword s73, s[12:13], s58 offset:4160
  s_add_u32 m0, s61, 98304
  s_mov_b32 s62, 180224
  buffer_load_dwordx4 v20, s[28:31], s62 offen offset:0 sc1 lds
  buffer_load_dwordx4 v20, s[28:31], s62 offen offset:1024 sc1 lds
  buffer_load_dwordx4 v20, s[28:31], s62 offen offset:2048 sc1 lds
  buffer_load_dwordx4 v20, s[28:31], s62 offen offset:3072 sc1 lds
  s_waitcnt vmcnt(12)
  s_barrier
  s_mov_b32 s41, 1536
  s_add_u32 m0, s60, 0
  s_nop 0
  buffer_load_dwordx4 v16, s[16:19], s41 offen offset:0  lds
  buffer_load_dwordx4 v17, s[16:19], s41 offen offset:1024  lds
  buffer_load_dwordx4 v18, s[16:19], s41 offen offset:2048  lds
  buffer_load_dwordx4 v19, s[16:19], s41 offen offset:3072  lds
  s_add_u32 m0, s60, 4096
  s_add_u32 s41, s41, 65536
  buffer_load_dwordx4 v16, s[16:19], s41 offen offset:0  lds
  buffer_load_dwordx4 v17, s[16:19], s41 offen offset:1024  lds
  buffer_load_dwordx4 v18, s[16:19], s41 offen offset:2048  lds
  buffer_load_dwordx4 v19, s[16:19], s41 offen offset:3072  lds
  s_mov_b32 s63, 0
L_sp12:
  s_waitcnt lgkmcnt(0)
  s_xor_b64 s[10:11], s[64:65], s[8:9]
  s_xor_b64 s[14:15], s[66:67], s[8:9]
  s_or_b64 s[10:11], s[10:11], s[14:15]
  s_cbranch_scc0 L_ok12
  s_load_dwordx4 s[64:67], s[4:5], s43 glc
  s_add_u32 s63, s63, 1
  s_cmp_lt_u32 s63, 20000
  s_cbranch_scc1 L_sp12
  s_waitcnt lgkmcnt(0)
L_ok12:
  s_mov_b32 s43, 6656
  s_load_dwordx4 s[64:67], s[4:5], s43 glc
  s_add_u32 m0, s61, 0
  s_mov_b32 s62, 196608
  buffer_load_dwordx4 v20, s[28:31], s62 offen offset:0 sc1 lds
  buffer_load_dwordx4 v20, s[28:31], s62 offen offset:1024 sc1 lds
  buffer_load_dwordx4 v20, s[28:31], s62 offen offset:2048 sc1 lds
  buffer_load_dwordx4 v20, s[28:31], s62 offen offset:3072 sc1 lds
  s_waitcnt vmcnt(12)
  s_barrier
  s_mov_b32 s41, 1664
  s_add_u32 m0, s60, 49152
  s_nop 0
  buffer_load_dwordx4 v16, s[16:19], s41 offen offset:0  lds
  buffer_load_dwordx4 v17, s[16:19], s41 offen offset:1024  lds
  buffer_load_dwordx4 v18, s[16:19], s41 offen offset:2048  lds
  buffer_load_dwordx4 v19, s[16:19], s41 offen offset:3072  lds
  s_add_u32 m0, s60, 53248
  s_add_u32 s41, s41, 65536
  buffer_load_dwordx4 v16, s[16:19], s41 offen offset:0  lds
  buffer_load_dwordx4 v17, s[16:19], s41 offen offset:1024  lds
  buffer_load_dwordx4 v18, s[16:19], s41 offen offset:2048  lds
  buffer_load_dwordx4 v19, s[16:19], s41 offen offset:3072  lds
  s_mov_b32 s63, 0
L_sp13:
  s_waitcnt lgkmcnt(0)
  s_xor_b64 s[10:11], s[64:65], s[8:9]
  s_xor_b64 s[14:15], s[66:67], s[8:9]
  s_or_b64 s[10:11], s[10:11], s[14:15]
  s_cbranch_scc0 L_ok13
  s_load_dwordx4 s[64:67], s[4:5], s43 glc
  s_add_u32 s63, s63, 1
  s_cmp_lt_u32 s63, 20000
  s_cbranch_scc1 L_sp13
  s_waitcnt lgkmcnt(0)
L_ok13:
  s_mov_b32 s43, 7168
  s_load_dwordx4 s[64:67], s[4:5], s43 glc
  s_add_u32 m0, s61, 49152
  s_mov_b32 s62, 212992
  buffer_load_dwordx4 v20, s[28:31], s62 offen offset:0 sc1 lds
  buffer_load_dwordx4 v20, s[28:31], s62 offen offset:1024 sc1 lds
  buffer_load_dwordx4 v20, s[28:31], s62 offen offset:2048 sc1 lds
  buffer_load_dwordx4 v20, s[28:31], s62 offen offset:3072 sc1 lds
  s_waitcnt vmcnt(12)
  s_barrier
  s_mov_b32 s41, 1792
  s_add_u32 m0, s60, 98304
  s_nop 0
  buffer_load_dwordx4 v16, s[16:19], s41 offen offset:0  lds
  buffer_load_dwordx4 v17, s[16:19], s41 offen offset:1024  lds
  buffer_load_dwordx4 v18, s[16:19], s41 offen offset:2048  lds
  buffer_load_dwordx4 v19, s[16:19], s41 offen offset:3072  lds
  s_add_u32 m0, s60, 102400
  s_add_u32 s41, s41, 65536
  buffer_load_dwordx4 v16, s[16:19], s41 offen offset:0  lds
  buffer_load_dwordx4 v17, s[16:19], s41 offen offset:1024  lds
  buffer_load_dwordx4 v18, s[16:19], s41 offen offset:2048  lds
  buffer_load_dwordx4 v19, s[16:19], s41 offen offset:3072  lds
  s_mov_b32 s63, 0
L_sp14:
  s_waitcnt lgkmcnt(0)
  s_xor_b64 s[10:11], s[64:65], s[8:9]
  s_xor_b64 s[14:15], s[66:67], s[8:9]
  s_or_b64 s[10:11], s[10:11], s[14:15]
  s_cbranch_scc0 L_ok14
  s_load_dwordx4 s[64:67], s[4:5], s43 glc
  s_add_u32 s63, s63, 1
  s_cmp_lt_u32 s63, 20000
  s_cbranch_scc1 L_sp14
  s_waitcnt lgkmcnt(0)
L_ok14:
  s_mov_b32 s43, 7680
  s_load_dwordx4 s[64:67], s[4:5], s43 glc
  s_add_u32 m0, s61, 98304
  s_mov_b32 s62, 229376
  buffer_load_dwordx4 v20, s[28:31], s62 offen offset:0 sc1 lds
  buffer_load_dwordx4 v20, s[28:31], s62 offen offset:1024 sc1 lds
  buffer_load_dwordx4 v20, s[28:31], s62 offen offset:2048 sc1 lds
  buffer_load_dwordx4 v20, s[28:31], s62 offen offset:3072 sc1 lds
  s_mov_b32 s41, 1920
  s_lshr_b32 s53, s60, 1
  s_add_u32 m0, s53, 147456
  s_nop 0
  buffer_load_dwordx4 v16, s[16:19], s41 offen offset:0  lds
  buffer_load_dwordx4 v17, s[16:19], s41 offen offset:1024  lds
  buffer_load_dwordx4 v18, s[16:19], s41 offen offset:2048  lds
  buffer_load_dwordx4 v19, s[16:19], s41 offen offset:3072  lds
  s_waitcnt vmcnt(16)
  s_barrier
  s_mov_b32 s63, 0
L_sp15:
  s_waitcnt lgkmcnt(0)
  s_xor_b64 s[10:11], s[64:65], s[8:9]
  s_xor_b64 s[14:15], s[66:67], s[8:9]
  s_or_b64 s[10:11], s[10:11], s[14:15]
  s_cbranch_scc0 L_ok15
  s_load_dwordx4 s[64:67], s[4:5], s43 glc
  s_add_u32 s63, s63, 1
  s_cmp_lt_u32 s63, 20000
  s_cbranch_scc1 L_sp15
  s_waitcnt lgkmcnt(0)
L_ok15:
  s_add_u32 m0, s61, 0
  s_mov_b32 s62, 245760
  buffer_load_dwordx4 v20, s[28:31], s62 offen offset:0 sc1 lds
  buffer_load_dwordx4 v20, s[28:31], s62 offen offset:2048 sc1 lds
  s_waitcnt vmcnt(6)
  s_barrier
  s_add_u32 m0, s61, 0
  s_mov_b32 s62, 245760
  buffer_load_dwordx4 v20, s[28:31], s62 offen offset:1024 sc1 lds
  buffer_load_dwordx4 v20, s[28:31], s62 offen offset:3072 sc1 lds
  s_add_u32 m0, s60, 4096
  s_add_u32 s41, s41, 65536
  buffer_load_dwordx4 v16, s[16:19], s41 offen offset:0  lds
  buffer_load_dwordx4 v17, s[16:19], s41 offen offset:1024  lds
  buffer_load_dwordx4 v18, s[16:19], s41 offen offset:2048  lds
  buffer_load_dwordx4 v19, s[16:19], s41 offen offset:3072  lds
  s_waitcnt vmcnt(6)
  s_barrier
  s_waitcnt vmcnt(0)
  s_barrier
  s_endpgm
L_prod:
  s_mov_b32 s30, 9457664
  s_mov_b32 s31, 0x20000
  s_mov_b32 s18, 4194304
  s_mov_b32 s19, 0x20000
  s_mov_b32 s34, 14680064
  s_mov_b32 s35, 0x20000
  v_and_b32 v2, 63, v0
  v_lshlrev_b32 v5, 2, v3
  s_and_b32 s39, s38, 3
  s_mov_b32 s56, 917504
  s_mov_b32 s57, 16384
  s_mov_b32 s58, 512
  s_mov_b32 s59, 0
  s_mov_b32 s55, 7
  v_mov_b32 v15, 0x7ff00000
  s_cmp_lt_u32 s2, 28
  s_cbranch_scc1 L_pp
  s_mov_b32 s56, 512
  s_mov_b32 s57, 262144
  s_mov_b32 s58, 8192
  s_mov_b32 s59, 4096
  s_mov_b32 s51, 6
L_pl:
  s_add_u32 m0, m0, 4096
  v_add_u32 v16, 256, v16
  s_sub_u32 s51, s51, 1
  buffer_load_dword v16, s[24:27], 0 offen lds
  buffer_load_dword v16, s[24:27], s50 offen offset:256 lds
  s_cmp_lg_u32 s51, 0
  s_cbranch_scc1 L_pl
  s_waitcnt vmcnt(0)
  s_branch L_pq
L_pp:
  s_mov_b32 s22, 13762560
L_pq:
  s_add_u32 s10, s28, 9437184
  s_addc_u32 s11, s29, 0
  s_load_dwordx2 s[6:7], s[10:11], 0
  s_lshl_b32 s53, s38, 11
  s_add_u32 s53, s53, 32768
  v_lshrrev_b32 v1, 4, v3
  v_lshlrev_b32 v1, 10, v1
  v_lshl_add_u32 v1, v9, 3, v1
  v_and_b32 v6, 15, v3
  v_lshl_add_u32 v6, v6, 4, v1
  v_add_u32 v6, s53, v6
  v_lshl_add_u32 v7, v2, 4, s53
  s_lshl_b32 s53, s37, 18
  s_lshl_b32 s54, s52, 11
  s_add_u32 s53, s53, s54
  v_lshl_add_u32 v8, v2, 4, s53
  s_lshl_b32 s53, s37, 6
  s_lshr_b32 s54, s52, 1
  s_add_u32 s53, s53, s54
  s_lshl_b32 s53, s53, 7
  s_and_b32 s54, s52, 1
  s_lshl_b32 s54, s54, 3
  s_add_u32 s53, s53, s54
  s_add_u32 s53, s53, 7340032
  v_lshl_add_u32 v14, v2, 7, s53
  s_waitcnt vmcnt(0)
  buffer_load_dwordx4 v[32:35], v4, s[20:23], 0 offen nt
  buffer_load_dwordx4 v[36:39], v4, s[20:23], s45 offen nt
  buffer_load_dwordx4 v[40:43], v4, s[20:23], s46 offen nt
  buffer_load_dwordx4 v[44:47], v4, s[20:23], s47 offen nt
  v_add_u32 v4, s56, v4
  buffer_load_dword v17, v15, s[20:23], 0 offen
  buffer_load_dword v17, v15, s[20:23], 0 offen
  buffer_load_dwordx4 v[48:51], v4, s[20:23], 0 offen nt
  buffer_load_dwordx4 v[52:55], v4, s[20:23], s45 offen nt
  buffer_load_dwordx4 v[56:59], v4, s[20:23], s46 offen nt
  buffer_load_dwordx4 v[60:63], v4, s[20:23], s47 offen nt
  v_add_u32 v4, s56, v4
  s_waitcnt lgkmcnt(0)
  s_mul_i32 s8, s6, 1664525
  s_mul_i32 s9, s7, 22695477
  s_add_u32 s8, s8, 1013904223
  s_add_u32 s9, s9, 1
  v_mov_b32 v10, s8
  v_mov_b32 v11, s9
  s_mov_b32 s60, 0
  s_mov_b32 s61, 0
  s_mov_b32 s62, 0
  s_waitcnt vmcnt(10)
  s_barrier
L_p:
  s_waitcnt vmcnt(9)
  v_lshl_add_u32 v32, v32, 8, v5
  v_lshl_add_u32 v33, v33, 8, v5
  v_lshl_add_u32 v34, v34, 8, v5
  v_lshl_add_u32 v35, v35, 8, v5
  ds_read_u16 v96, v32 offset:0
  ds_read_u16 v97, v33 offset:2
  ds_read_u16 v98, v34 offset:128
  ds_read_u16 v99, v35 offset:130
  s_waitcnt vmcnt(8)
  v_lshl_add_u32 v36, v36, 8, v5
  v_lshl_add_u32 v37, v37, 8, v5
  v_lshl_add_u32 v38, v38, 8, v5
  v_lshl_add_u32 v39, v39, 8, v5
  ds_read_u16 v100, v36 offset:0
  ds_read_u16 v101, v37 offset:2
  ds_read_u16 v102, v38 offset:128
  ds_read_u16 v103, v39 offset:130
  s_waitcnt vmcnt(7)
  v_lshl_add_u32 v40, v40, 8, v5
  v_lshl_add_u32 v41, v41, 8, v5
  v_lshl_add_u32 v42, v42, 8, v5
  v_lshl_add_u32 v43, v43, 8, v5
  ds_read_u16 v104, v40 offset:0
  ds_read_u16 v105, v41 offset:2
  ds_read_u16 v106, v42 offset:128
  ds_read_u16 v107, v43 offset:130
  s_waitcnt vmcnt(6)
  v_lshl_add_u32 v44, v44, 8, v5
  v_lshl_add_u32 v45, v45, 8, v5
  v_lshl_add_u32 v46, v46, 8, v5
  v_lshl_add_u32 v47, v47, 8, v5
  ds_read_u16 v108, v44 offset:0
  ds_read_u16 v109, v45 offset:2
  ds_read_u16 v110, v46 offset:128
  ds_read_u16 v111, v47 offset:130
  s_cmp_eq_u32 s62, 0
  s_cbranch_scc1 L_pa0
  s_waitcnt vmcnt(4)
  s_mov_b64 exec, 1
  buffer_store_dwordx2 v[10:11], v14, s[28:31], s61 offen sc1
  s_mov_b64 exec, -1
  s_add_u32 s61, s61, s58
L_pa0:
  s_waitcnt lgkmcnt(8)
  v_lshl_or_b32 v112, v100, 16, v96
  v_lshl_or_b32 v114, v101, 16, v97
  v_lshl_or_b32 v116, v102, 16, v98
  v_lshl_or_b32 v118, v103, 16, v99
  s_waitcnt lgkmcnt(3)
  v_lshl_or_b32 v113, v108, 16, v104
  ds_write_b64 v6, v[112:113] offset:0
  s_waitcnt lgkmcnt(3)
  v_lshl_or_b32 v115, v109, 16, v105
  ds_write_b64 v6, v[114:115] offset:256
  s_waitcnt lgkmcnt(3)
  v_lshl_or_b32 v117, v110, 16, v106
  ds_write_b64 v6, v[116:117] offset:512
  s_waitcnt lgkmcnt(3)
  v_lshl_or_b32 v119, v111, 16, v107
  ds_write_b64 v6, v[118:119] offset:768
  s_waitcnt lgkmcnt(0)
  ds_read_b128 v[120:123], v7 offset:0
  ds_read_b128 v[124:127], v7 offset:1024
  s_waitcnt lgkmcnt(1)
  buffer_store_dwordx4 v[120:123], v8, s[28:31], s60 offen offset:0 sc1
  s_waitcnt lgkmcnt(0)
  buffer_store_dwordx4 v[124:127], v8, s[28:31], s60 offen offset:1024 sc1
  buffer_load_dwordx4 v[32:35], v4, s[20:23], 0 offen nt
  buffer_load_dwordx4 v[36:39], v4, s[20:23], s45 offen nt
  buffer_load_dwordx4 v[40:43], v4, s[20:23], s46 offen nt
  buffer_load_dwordx4 v[44:47], v4, s[20:23], s47 offen nt
  v_add_u32 v4, s56, v4
  v_add_u32 v5, s59, v5
  s_add_u32 s62, s62, 1
  s_add_u32 s60, s60, s57
  s_cmp_lt_u32 s62, s55
  s_cbranch_scc0 L_pe
  s_waitcnt vmcnt(9)
  v_lshl_add_u32 v48, v48, 8, v5
  v_lshl_add_u32 v49, v49, 8, v5
  v_lshl_add_u32 v50, v50, 8, v5
  v_lshl_add_u32 v51, v51, 8, v5
  ds_read_u16 v96, v48 offset:0
  ds_read_u16 v97, v49 offset:2
  ds_read_u16 v98, v50 offset:128
  ds_read_u16 v99, v51 offset:130
  s_waitcnt vmcnt(8)
  v_lshl_add_u32 v52, v52, 8, v5
  v_lshl_add_u32 v53, v53, 8, v5
  v_lshl_add_u32 v54, v54, 8, v5
  v_lshl_add_u32 v55, v55, 8, v5
  ds_read_u16 v100, v52 offset:0
  ds_read_u16 v101, v53 offset:2
  ds_read_u16 v102, v54 offset:128
  ds_read_u16 v103, v55 offset:130
  s_waitcnt vmcnt(7)
  v_lshl_add_u32 v56, v56, 8, v5
  v_lshl_add_u32 v57, v57, 8, v5
  v_lshl_add_u32 v58, v58, 8, v5
  v_lshl_add_u32 v59, v59, 8, v5
  ds_read_u16 v104, v56 offset:0
  ds_read_u16 v105, v57 offset:2
  ds_read_u16 v106, v58 offset:128
  ds_read_u16 v107, v59 offset:130
  s_waitcnt vmcnt(6)
  v_lshl_add_u32 v60, v60, 8, v5
  v_lshl_add_u32 v61, v61, 8, v5
  v_lshl_add_u32 v62, v62, 8, v5
  v_lshl_add_u32 v63, v63, 8, v5
  ds_read_u16 v108, v60 offset:0
  ds_read_u16 v109, v61 offset:2
  ds_read_u16 v110, v62 offset:128
  ds_read_u16 v111, v63 offset:130
  s_cmp_eq_u32 s62, 0
  s_cbranch_scc1 L_pa1
  s_waitcnt vmcnt(4)
  s_mov_b64 exec, 1
  buffer_store_dwordx2 v[10:11], v14, s[28:31], s61 offen sc1
  s_mov_b64 exec, -1
  s_add_u32 s61, s61, s58
L_pa1:
  s_waitcnt lgkmcnt(8)
  v_lshl_or_b32 v112, v100, 16, v96
  v_lshl_or_b32 v114, v101, 16, v97
  v_lshl_or_b32 v116, v102, 16, v98
  v_lshl_or_b32 v118, v103, 16, v99
  s_waitcnt lgkmcnt(3)
  v_lshl_or_b32 v113, v108, 16, v104
  ds_write_b64 v6, v[112:113] offset:0
  s_waitcnt lgkmcnt(3)
  v_lshl_or_b32 v115, v109, 16, v105
  ds_write_b64 v6, v[114:115] offset:256
  s_waitcnt lgkmcnt(3)
  v_lshl_or_b32 v117, v110, 16, v106
  ds_write_b64 v6, v[116:117] offset:512
  s_waitcnt lgkmcnt(3)
  v_lshl_or_b32 v119, v111, 16, v107
  ds_write_b64 v6, v[118:119] offset:768
  s_waitcnt lgkmcnt(0)
  ds_read_b128 v[128:131], v7 offset:0
  ds_read_b128 v[132:135], v7 offset:1024
  s_waitcnt lgkmcnt(1)
  buffer_store_dwordx4 v[128:131], v8, s[28:31], s60 offen offset:0 sc1
  s_waitcnt lgkmcnt(0)
  buffer_store_dwordx4 v[132:135], v8, s[28:31], s60 offen offset:1024 sc1
  buffer_load_dwordx4 v[48:51], v4, s[20:23], 0 offen nt
  buffer_load_dwordx4 v[52:55], v4, s[20:23], s45 offen nt
  buffer_load_dwordx4 v[56:59], v4, s[20:23], s46 offen nt
  buffer_load_dwordx4 v[60:63], v4, s[20:23], s47 offen nt
  v_add_u32 v4, s56, v4
  v_add_u32 v5, s59, v5
  s_add_u32 s62, s62, 1
  s_add_u32 s60, s60, s57
  s_cmp_lt_u32 s62, s55
  s_cbranch_scc1 L_p
L_pe:
  s_waitcnt vmcnt(4)
  s_mov_b64 exec, 1
  buffer_store_dwordx2 v[10:11], v14, s[28:31], s61 offen sc1
  s_mov_b64 exec, -1
  s_cmp_eq_u32 s38, 0
  s_cbranch_scc0 L_pz
  s_lshl_b32 s3, s2, 6
  s_add_u32 s3, s3, 9441280
  v_mov_b32 v12, s3
  s_mov_b64 exec, 1
  buffer_store_dwordx2 v[10:11], v12, s[28:31], 0 offen sc1
  s_mov_b64 exec, -1
  s_cmp_eq_u32 s2, 0
  s_cbranch_scc0 L_pz
  s_mov_b32 s63, 0
  v_lshlrev_b32 v12, 6, v2
  v_add_u32 v12, 9441280, v12
L_pw:
  s_mov_b32 s53, 0
  buffer_load_dwordx2 v[20:21], v12, s[28:31], s53 offen sc1
  s_mov_b32 s53, 4096
  buffer_load_dwordx2 v[22:23], v12, s[28:31], s53 offen sc1
  s_mov_b32 s53, 8192
  buffer_load_dwordx2 v[24:25], v12, s[28:31], s53 offen sc1
  s_mov_b32 s53, 12288
  buffer_load_dwordx2 v[26:27], v12, s[28:31], s53 offen sc1
  s_add_u32 s63, s63, 1
  s_waitcnt vmcnt(0)
  v_cmp_ne_u64 s[52:53], v[20:21], v[10:11]
  v_cmp_ne_u64 vcc, v[22:23], v[10:11]
  s_or_b64 s[52:53], s[52:53], vcc
  v_cmp_ne_u64 vcc, v[24:25], v[10:11]
  s_or_b64 s[52:53], s[52:53], vcc
  v_cmp_ne_u64 vcc, v[26:27], v[10:11]
  s_or_b64 s[52:53], s[52:53], vcc
  s_cbranch_scc0 L_pv
  s_cmp_lt_u32 s63, 20000
  s_cbranch_scc1 L_pw
L_pv:
  v_mov_b32 v12, 9437184
  s_mov_b64 exec, 1
  buffer_store_dwordx2 v[10:11], v12, s[28:31], 0 offen sc1
  s_mov_b64 exec, -1
L_pz:
L_drain:
  s_waitcnt vmcnt(0)
L_done:
  s_endpgm
L_end:
.section .rodata,"a"
.p2align 6
.amdhsa_kernel standalone__weight_only_int_squeezellm__prompt_kernel
  .amdhsa_next_free_vgpr 256
  .amdhsa_next_free_sgpr 102
  .amdhsa_accum_offset 160
  .amdhsa_group_segment_fixed_size 0
  .amdhsa_kernarg_size 48
  .amdhsa_user_sgpr_count 2
  .amdhsa_user_sgpr_kernarg_segment_ptr 1
  .amdhsa_system_sgpr_workgroup_id_x 1
.end_amdhsa_kernel
```

```asm
; @launch grid=(256,1,1) block=(512,1,1) lds=163840
.amdgcn_target "amdgcn-amd-amdhsa--gfx950"
.text
.globl standalone__weight_only_int_squeezellm__prompt_kernel
.p2align 8
.type standalone__weight_only_int_squeezellm__prompt_kernel,@function
standalone__weight_only_int_squeezellm__prompt_kernel:
  s_cmp_ge_u32 s2, 256
  s_cbranch_scc1 L_done
  s_load_dwordx2 s[24:25], s[0:1], 16
  s_load_dwordx2 s[20:21], s[0:1], 8
  s_load_dwordx2 s[28:29], s[0:1], 40
  s_load_dwordx2 s[16:17], s[0:1], 0
  s_load_dwordx2 s[32:33], s[0:1], 24
  s_and_b32 s3, s2, 1
  s_bfe_u32 s36, s2, 0x20003
  s_lshl2_add_u32 s36, s3, s36
  s_bfe_u32 s3, s2, 0x20001
  s_mul_i32 s3, s3, 7
  s_lshr_b32 s37, s2, 5
  s_add_u32 s37, s37, s3
  s_sub_u32 s37, s37, 1
  s_sub_u32 s3, s2, 28
  s_mul_i32 s53, s3, 7
  s_cmp_lt_u32 s3, 4
  s_cselect_b32 s51, 15, 8
  s_cselect_b32 s53, s53, s2
  s_cmp_lt_u32 s2, 32
  s_cselect_b32 s36, s51, s36
  s_cselect_b32 s37, s53, s37
  s_cselect_b32 s51, 0, 147456
  v_lshrrev_b32 v1, 6, v0
  v_and_b32 v3, 31, v0
  v_readfirstlane_b32 s38, v1
  v_bfe_u32 v9, v0, 5, 1
  s_mov_b32 s26, 114688
  s_mov_b32 s27, 0x20000
  s_mov_b32 s22, 14680064
  s_mov_b32 s23, 0x20000
  v_mul_u32_u24 v1, 57344, v9
  v_lshl_add_u32 v4, v3, 4, v1
  v_lshlrev_b32 v1, 3, v3
  v_lshl_add_u32 v16, v9, 2, v1
  s_mul_i32 s53, s38, 14336
  s_lshl_b32 s54, s37, 8
  s_add_u32 s53, s53, s54
  v_add_u32 v16, s53, v16
  s_lshl_b32 s53, s38, 9
  s_add_u32 m0, s53, s51
  s_movk_i32 s50, 6912
  s_lshl3_add_u32 s52, s36, s38
  s_mul_i32 s53, s52, 114688
  s_lshl1_add_u32 s53, s54, s53
  v_add_u32 v4, s53, v4
  s_movk_i32 s45, 14336
  s_movk_i32 s46, 28672
  s_mov_b32 s47, 43008
  s_cmp_lt_u32 s2, 32
  s_waitcnt lgkmcnt(0)
  buffer_load_dword v16, s[24:27], 0 offen lds
  buffer_load_dword v16, s[24:27], s50 offen offset:256 lds
  s_cbranch_scc1 L_h
  buffer_load_dwordx4 v[32:35], v4, s[20:23], 0 offen nt
  buffer_load_dwordx4 v[36:39], v4, s[20:23], s45 offen nt
  buffer_load_dwordx4 v[40:43], v4, s[20:23], s46 offen nt
  buffer_load_dwordx4 v[44:47], v4, s[20:23], s47 offen nt
  s_add_u32 s10, s28, 9437184
  s_addc_u32 s11, s29, 0
  s_load_dwordx2 s[6:7], s[10:11], 0
  s_branch L_ng
L_h:
  s_getpc_b64 s[14:15]
L_pc:
  s_lshr_b32 s53, s2, 3
  s_lshl3_add_u32 s53, s53, s38
  s_mul_i32 s53, s53, 512
  s_min_u32 s53, s53, L_end-standalone__weight_only_int_squeezellm__prompt_kernel-512
  s_sub_u32 s14, s14, L_pc-standalone__weight_only_int_squeezellm__prompt_kernel
  s_subb_u32 s15, s15, 0
  s_load_dword s68, s[14:15], s53 offset:0
  s_load_dword s69, s[14:15], s53 offset:64
  s_load_dword s70, s[14:15], s53 offset:128
  s_load_dword s71, s[14:15], s53 offset:192
  s_load_dword s72, s[14:15], s53 offset:256
  s_load_dword s73, s[14:15], s53 offset:320
  s_load_dword s74, s[14:15], s53 offset:384
  s_load_dword s75, s[14:15], s53 offset:448
  s_branch L_prod
L_ng:
  s_mov_b32 s30, 9457664
  s_mov_b32 s31, 0x20000
  s_mov_b32 s18, 4194304
  s_mov_b32 s19, 0x20000
  s_mov_b32 s34, 14680064
  s_mov_b32 s35, 0x20000
  v_and_b32 v2, 63, v0
  v_lshlrev_b32 v5, 2, v3
  s_and_b32 s39, s38, 3
  v_add_u32 v5, 147456, v5
  s_lshl_b32 s53, s38, 11
  s_add_u32 s53, s53, 32768
  v_lshrrev_b32 v1, 4, v3
  v_lshlrev_b32 v1, 10, v1
  v_lshl_add_u32 v1, v9, 3, v1
  v_and_b32 v6, 15, v3
  v_lshl_add_u32 v6, v6, 4, v1
  v_add_u32 v6, s53, v6
  v_lshl_add_u32 v7, v2, 4, s53
  s_lshl_b32 s53, s37, 18
  s_lshl_b32 s54, s52, 11
  s_add_u32 s53, s53, s54
  v_lshl_add_u32 v8, v2, 4, s53
  s_lshl_b32 s53, s37, 6
  s_lshr_b32 s54, s52, 1
  s_add_u32 s53, s53, s54
  s_lshl_b32 s53, s53, 7
  s_and_b32 s54, s52, 1
  s_lshl_b32 s54, s54, 3
  s_add_u32 s53, s53, s54
  s_add_u32 s53, s53, 7340032
  v_lshl_add_u32 v14, v2, 7, s53
  s_lshl_b32 s53, s37, 2
  s_add_u32 s53, s53, s39
  s_mul_i32 s53, s53, 3
  s_min_u32 s53, s53, 253
  s_lshl_b32 s54, s36, 8
  s_add_u32 s53, s53, s54
  s_lshl_b32 s53, s53, 11
  s_add_u32 s12, s16, s53
  s_addc_u32 s13, s17, 0
  s_andn2_b32 s40, 4, s36
  v_and_b32 v3, 15, v2
  v_lshrrev_b32 v9, 4, v2
  v_lshrrev_b32 v1, 1, v3
  v_xor_b32 v1, v1, v9
  v_lshlrev_b32 v1, 4, v1
  v_lshl_add_u32 v144, v3, 7, v1
  s_lshl_b32 s54, s38, 13
  v_add_u32 v144, s54, v144
  v_xor_b32 v145, 64, v144
  v_lshlrev_b32 v1, 11, v9
  v_lshl_add_u32 v146, v3, 4, v1
  v_add_u32 v146, 32768, v146
  s_lshl_b32 s52, s36, 8
  s_lshl_b32 s53, s38, 6
  s_add_u32 s52, s52, s53
  s_mul_i32 s52, s52, 7168
  s_lshl_b32 s53, s37, 8
  s_add_u32 s52, s52, s53
  v_and_b32 v1, 1, v3
  v_lshl_add_u32 v1, v9, 2, v1
  v_mul_u32_u24 v1, 7168, v1
  v_lshrrev_b32 v147, 1, v3
  v_lshl_add_u32 v1, v147, 4, v1
  v_add_u32 v147, s52, v1
  v_lshrrev_b32 v20, 3, v2
  v_lshlrev_b32 v20, 11, v20
  v_lshrrev_b32 v1, 4, v2
  v_xor_b32 v1, v1, v2
  v_and_b32 v1, 7, v1
  v_lshl_add_u32 v20, v1, 4, v20
  s_lshl_b32 s52, s36, 19
  s_lshl_b32 s53, s39, 17
  s_add_u32 s53, s52, s53
  v_add_u32 v16, s53, v20
  v_xor_b32 v17, 64, v16
  v_add_u32 v18, 30720, v16
  v_add_u32 v19, 46080, v17
  v_add_u32 v17, 15360, v17
  s_lshl_b32 s60, s39, 13
  s_lshl_b32 s53, s37, 18
  s_lshl_b32 s54, s39, 12
  s_add_u32 s53, s53, s54
  v_lshl_add_u32 v20, v2, 4, s53
  s_add_u32 s61, s54, 32768
  s_lshl_b32 s53, s37, 13
  s_lshl_b32 s54, s39, 7
  s_add_u32 s53, s53, s54
  s_and_b32 s54, s36, 0
  s_lshl_b32 s54, s54, 7
  s_add_u32 s53, s53, s54
  s_add_u32 s53, s53, 7340032
  s_add_u32 s4, s28, s53
  s_addc_u32 s5, s29, 0
  s_lshl_b32 s41, s36, 7
  s_lshr_b32 s53, s38, 2
  s_lshl_b32 s54, s53, 16
  s_add_u32 s41, s41, s54
  s_lshl_b32 s53, s53, 12
  s_add_u32 m0, s60, s53
  s_waitcnt lgkmcnt(0)
  s_mul_i32 s8, s6, 1664525
  s_mul_i32 s9, s7, 22695477
  s_add_u32 s8, s8, 1013904223
  s_add_u32 s9, s9, 1
  v_mov_b32 v10, s8
  v_mov_b32 v11, s9
  s_waitcnt vmcnt(4)
  s_barrier
  s_waitcnt vmcnt(3)
  v_lshl_add_u32 v32, v32, 8, v5
  v_lshl_add_u32 v33, v33, 8, v5
  v_lshl_add_u32 v34, v34, 8, v5
  v_lshl_add_u32 v35, v35, 8, v5
  ds_read_u16 v96, v32 offset:0
  ds_read_u16 v97, v33 offset:2
  ds_read_u16 v98, v34 offset:128
  ds_read_u16 v99, v35 offset:130
  buffer_load_dwordx4 v16, s[16:19], s41 offen offset:0 lds
  s_waitcnt vmcnt(3)
  v_lshl_add_u32 v36, v36, 8, v5
  v_lshl_add_u32 v37, v37, 8, v5
  v_lshl_add_u32 v38, v38, 8, v5
  v_lshl_add_u32 v39, v39, 8, v5
  ds_read_u16 v100, v36 offset:0
  ds_read_u16 v101, v37 offset:2
  ds_read_u16 v102, v38 offset:128
  ds_read_u16 v103, v39 offset:130
  buffer_load_dwordx4 v17, s[16:19], s41 offen offset:1024 lds
  s_waitcnt vmcnt(3)
  v_lshl_add_u32 v40, v40, 8, v5
  v_lshl_add_u32 v41, v41, 8, v5
  v_lshl_add_u32 v42, v42, 8, v5
  v_lshl_add_u32 v43, v43, 8, v5
  ds_read_u16 v104, v40 offset:0
  ds_read_u16 v105, v41 offset:2
  ds_read_u16 v106, v42 offset:128
  ds_read_u16 v107, v43 offset:130
  buffer_load_dwordx4 v18, s[16:19], s41 offen offset:2048 lds
  s_waitcnt vmcnt(3)
  v_lshl_add_u32 v44, v44, 8, v5
  v_lshl_add_u32 v45, v45, 8, v5
  v_lshl_add_u32 v46, v46, 8, v5
  v_lshl_add_u32 v47, v47, 8, v5
  ds_read_u16 v108, v44 offset:0
  ds_read_u16 v109, v45 offset:2
  ds_read_u16 v110, v46 offset:128
  ds_read_u16 v111, v47 offset:130
  buffer_load_dwordx4 v19, s[16:19], s41 offen offset:3072 lds
  s_waitcnt lgkmcnt(8)
  v_lshl_or_b32 v112, v100, 16, v96
  v_lshl_or_b32 v114, v101, 16, v97
  v_lshl_or_b32 v116, v102, 16, v98
  v_lshl_or_b32 v118, v103, 16, v99
  s_waitcnt lgkmcnt(3)
  v_lshl_or_b32 v113, v108, 16, v104
  ds_write_b64 v6, v[112:113] offset:0
  s_waitcnt lgkmcnt(3)
  v_lshl_or_b32 v115, v109, 16, v105
  ds_write_b64 v6, v[114:115] offset:256
  s_waitcnt lgkmcnt(3)
  v_lshl_or_b32 v117, v110, 16, v106
  ds_write_b64 v6, v[116:117] offset:512
  s_waitcnt lgkmcnt(3)
  v_lshl_or_b32 v119, v111, 16, v107
  ds_write_b64 v6, v[118:119] offset:768
  s_waitcnt lgkmcnt(0)
  ds_read_b128 v[148:151], v7 offset:0
  ds_read_b128 v[152:155], v7 offset:1024
  s_waitcnt lgkmcnt(1)
  buffer_store_dwordx4 v[148:151], v8, s[28:31], 0 offen offset:0 sc1
  s_waitcnt lgkmcnt(0)
  buffer_store_dwordx4 v[152:155], v8, s[28:31], 0 offen offset:1024 sc1
  s_cmp_ge_u32 s38, 4
  s_cbranch_scc1 L_loader
  s_add_u32 s58, s40, 0
  s_lshl_b32 s58, s58, 7
  s_load_dword s92, s[12:13], s58 offset:0
  s_load_dword s93, s[12:13], s58 offset:64
  s_load_dword s94, s[12:13], s58 offset:2048
  s_load_dword s95, s[12:13], s58 offset:2112
  s_load_dword s96, s[12:13], s58 offset:4096
  s_load_dword s97, s[12:13], s58 offset:4160
  s_add_u32 s58, s40, 1
  s_lshl_b32 s58, s58, 7
  s_load_dword s92, s[12:13], s58 offset:0
  s_load_dword s93, s[12:13], s58 offset:64
  s_load_dword s94, s[12:13], s58 offset:2048
  s_load_dword s95, s[12:13], s58 offset:2112
  s_load_dword s96, s[12:13], s58 offset:4096
  s_load_dword s97, s[12:13], s58 offset:4160
  v_mov_b32 v5, v144
  v_mov_b32 v6, v145
  v_mov_b32 v7, v146
  v_mov_b32 v16, 0
  v_mov_b32 v17, 0
  v_mov_b32 v18, 0
  v_mov_b32 v19, 0
  v_mov_b32 v20, 0
  v_mov_b32 v21, 0
  v_mov_b32 v22, 0
  v_mov_b32 v23, 0
  v_mov_b32 v24, 0
  v_mov_b32 v25, 0
  v_mov_b32 v26, 0
  v_mov_b32 v27, 0
  v_mov_b32 v28, 0
  v_mov_b32 v29, 0
  v_mov_b32 v30, 0
  v_mov_b32 v31, 0
  v_mov_b32 v32, 0
  v_mov_b32 v33, 0
  v_mov_b32 v34, 0
  v_mov_b32 v35, 0
  v_mov_b32 v36, 0
  v_mov_b32 v37, 0
  v_mov_b32 v38, 0
  v_mov_b32 v39, 0
  v_mov_b32 v40, 0
  v_mov_b32 v41, 0
  v_mov_b32 v42, 0
  v_mov_b32 v43, 0
  v_mov_b32 v44, 0
  v_mov_b32 v45, 0
  v_mov_b32 v46, 0
  v_mov_b32 v47, 0
  v_mov_b32 v48, 0
  v_mov_b32 v49, 0
  v_mov_b32 v50, 0
  v_mov_b32 v51, 0
  v_mov_b32 v52, 0
  v_mov_b32 v53, 0
  v_mov_b32 v54, 0
  v_mov_b32 v55, 0
  v_mov_b32 v56, 0
  v_mov_b32 v57, 0
  v_mov_b32 v58, 0
  v_mov_b32 v59, 0
  v_mov_b32 v60, 0
  v_mov_b32 v61, 0
  v_mov_b32 v62, 0
  v_mov_b32 v63, 0
  v_mov_b32 v64, 0
  v_mov_b32 v65, 0
  v_mov_b32 v66, 0
  v_mov_b32 v67, 0
  v_mov_b32 v68, 0
  v_mov_b32 v69, 0
  v_mov_b32 v70, 0
  v_mov_b32 v71, 0
  v_mov_b32 v72, 0
  v_mov_b32 v73, 0
  v_mov_b32 v74, 0
  v_mov_b32 v75, 0
  v_mov_b32 v76, 0
  v_mov_b32 v77, 0
  v_mov_b32 v78, 0
  v_mov_b32 v79, 0
  v_mov_b32 v80, 0
  v_mov_b32 v81, 0
  v_mov_b32 v82, 0
  v_mov_b32 v83, 0
  v_mov_b32 v84, 0
  v_mov_b32 v85, 0
  v_mov_b32 v86, 0
  v_mov_b32 v87, 0
  v_mov_b32 v88, 0
  v_mov_b32 v89, 0
  v_mov_b32 v90, 0
  v_mov_b32 v91, 0
  v_mov_b32 v92, 0
  v_mov_b32 v93, 0
  v_mov_b32 v94, 0
  v_mov_b32 v95, 0
  v_mov_b32 v96, 0
  v_mov_b32 v97, 0
  v_mov_b32 v98, 0
  v_mov_b32 v99, 0
  v_mov_b32 v100, 0
  v_mov_b32 v101, 0
  v_mov_b32 v102, 0
  v_mov_b32 v103, 0
  v_mov_b32 v104, 0
  v_mov_b32 v105, 0
  v_mov_b32 v106, 0
  v_mov_b32 v107, 0
  v_mov_b32 v108, 0
  v_mov_b32 v109, 0
  v_mov_b32 v110, 0
  v_mov_b32 v111, 0
  v_mov_b32 v112, 0
  v_mov_b32 v113, 0
  v_mov_b32 v114, 0
  v_mov_b32 v115, 0
  v_mov_b32 v116, 0
  v_mov_b32 v117, 0
  v_mov_b32 v118, 0
  v_mov_b32 v119, 0
  v_mov_b32 v120, 0
  v_mov_b32 v121, 0
  v_mov_b32 v122, 0
  v_mov_b32 v123, 0
  v_mov_b32 v124, 0
  v_mov_b32 v125, 0
  v_mov_b32 v126, 0
  v_mov_b32 v127, 0
  v_mov_b32 v128, 0
  v_mov_b32 v129, 0
  v_mov_b32 v130, 0
  v_mov_b32 v131, 0
  v_mov_b32 v132, 0
  v_mov_b32 v133, 0
  v_mov_b32 v134, 0
  v_mov_b32 v135, 0
  v_mov_b32 v136, 0
  v_mov_b32 v137, 0
  v_mov_b32 v138, 0
  v_mov_b32 v139, 0
  v_mov_b32 v140, 0
  v_mov_b32 v141, 0
  v_mov_b32 v142, 0
  v_mov_b32 v143, 0
  s_waitcnt vmcnt(0)
  s_mov_b64 exec, 1
  buffer_store_dwordx2 v[10:11], v14, s[28:31], 0 offen sc1
  s_mov_b64 exec, -1
  s_mov_b32 s44, 0
  s_mov_b32 s45, 7168
  s_mov_b32 s46, 14336
  s_mov_b32 s47, 21504
  s_mov_b32 s48, 114688
  s_mov_b32 s49, 121856
  s_mov_b32 s50, 129024
  s_mov_b32 s51, 136192
  s_mov_b32 s52, 229376
  s_mov_b32 s53, 236544
  s_mov_b32 s54, 243712
  s_mov_b32 s55, 250880
  s_mov_b32 s56, 344064
  s_mov_b32 s57, 351232
  s_mov_b32 s58, 358400
  s_mov_b32 s59, 365568
  s_mov_b32 s60, 0
  s_mov_b32 s61, 0
  s_mov_b32 s60, 49152
  s_mov_b32 s61, 5
  s_mov_b32 s62, 49152
  s_lshl_b32 s63, s38, 12
  s_sub_u32 s63, 147456, s63
  s_mov_b32 vcc_lo, 0x55555555
  s_mov_b32 vcc_hi, 0x55555555
  s_barrier
  ds_read_b128 a[64:67], v7 offset:0
  ds_read_b128 a[68:71], v7 offset:8192
  ds_read_b128 a[0:3], v5 offset:0
  ds_read_b128 a[4:7], v6 offset:0
  ds_read_b128 a[8:11], v5 offset:2048
  ds_read_b128 a[12:15], v6 offset:2048
  ds_read_b128 a[16:19], v5 offset:4096
  ds_read_b128 a[72:75], v7 offset:256
  ds_read_b128 a[76:79], v7 offset:8448
  ds_read_b128 a[20:23], v6 offset:4096
  ds_read_b128 a[24:27], v5 offset:6144
  ds_read_b128 a[28:31], v6 offset:6144
  ds_read_b128 a[80:83], v7 offset:512
  ds_read_b128 a[84:87], v7 offset:8704
  s_cmp_eq_u32 s38, 0
  s_cbranch_scc0 L_c0
  s_lshl_b32 s3, s2, 6
  s_add_u32 s3, s3, 9441280
  v_mov_b32 v12, s3
  s_mov_b64 exec, 1
  buffer_store_dwordx2 v[10:11], v12, s[28:31], 0 offen sc1
  s_mov_b64 exec, -1
L_c0:
  s_waitcnt lgkmcnt(0)
.p2align 6
L_c:
  v_mfma_f32_16x16x32_bf16 v[16:19], a[0:3], a[64:67], v[16:19]
  ds_read_b128 a[88:91], v7 offset:768
  v_mfma_f32_16x16x32_bf16 v[16:19], a[4:7], a[68:71], v[16:19]
  ds_read_b128 a[92:95], v7 offset:8960
  v_mfma_f32_16x16x32_bf16 v[48:51], a[8:11], a[64:67], v[48:51]
  v_mfma_f32_16x16x32_bf16 v[48:51], a[12:15], a[68:71], v[48:51]
  s_cmp_eq_u32 s60, 147456
  v_mfma_f32_16x16x32_bf16 v[80:83], a[16:19], a[64:67], v[80:83]
  v_mfma_f32_16x16x32_bf16 v[80:83], a[20:23], a[68:71], v[80:83]
  s_cselect_b32 s60, 0, s60
  v_add_u32 v1, s60, v146
  v_mfma_f32_16x16x32_bf16 v[112:115], a[24:27], a[64:67], v[112:115]
  v_mfma_f32_16x16x32_bf16 v[112:115], a[28:31], a[68:71], v[112:115]
  v_mfma_f32_16x16x32_bf16 v[20:23], a[0:3], a[72:75], v[20:23]
  ds_read_b128 a[64:67], v7 offset:1024
  v_mfma_f32_16x16x32_bf16 v[20:23], a[4:7], a[76:79], v[20:23]
  ds_read_b128 a[68:71], v7 offset:9216
  v_mfma_f32_16x16x32_bf16 v[52:55], a[8:11], a[72:75], v[52:55]
  v_mfma_f32_16x16x32_bf16 v[52:55], a[12:15], a[76:79], v[52:55]
  v_mfma_f32_16x16x32_bf16 v[84:87], a[16:19], a[72:75], v[84:87]
  v_mfma_f32_16x16x32_bf16 v[84:87], a[20:23], a[76:79], v[84:87]
  v_mfma_f32_16x16x32_bf16 v[116:119], a[24:27], a[72:75], v[116:119]
  v_mfma_f32_16x16x32_bf16 v[116:119], a[28:31], a[76:79], v[116:119]
  v_mfma_f32_16x16x32_bf16 v[24:27], a[0:3], a[80:83], v[24:27]
  ds_read_b128 a[72:75], v7 offset:1280
  v_mfma_f32_16x16x32_bf16 v[24:27], a[4:7], a[84:87], v[24:27]
  ds_read_b128 a[76:79], v7 offset:9472
  v_mfma_f32_16x16x32_bf16 v[56:59], a[8:11], a[80:83], v[56:59]
  v_mfma_f32_16x16x32_bf16 v[56:59], a[12:15], a[84:87], v[56:59]
  v_mfma_f32_16x16x32_bf16 v[88:91], a[16:19], a[80:83], v[88:91]
  v_mfma_f32_16x16x32_bf16 v[88:91], a[20:23], a[84:87], v[88:91]
  v_mfma_f32_16x16x32_bf16 v[120:123], a[24:27], a[80:83], v[120:123]
  v_mfma_f32_16x16x32_bf16 v[120:123], a[28:31], a[84:87], v[120:123]
  v_add_u32 v3, s60, v144
  s_waitcnt lgkmcnt(0)
  v_mfma_f32_16x16x32_bf16 v[28:31], a[0:3], a[88:91], v[28:31]
  ds_read_b128 a[80:83], v7 offset:1536
  v_mfma_f32_16x16x32_bf16 v[28:31], a[4:7], a[92:95], v[28:31]
  ds_read_b128 a[84:87], v7 offset:9728
  v_mfma_f32_16x16x32_bf16 v[60:63], a[8:11], a[88:91], v[60:63]
  v_mfma_f32_16x16x32_bf16 v[60:63], a[12:15], a[92:95], v[60:63]
  v_add_u32_e64 v4, s60, v145
  v_mfma_f32_16x16x32_bf16 v[92:95], a[16:19], a[88:91], v[92:95]
  v_mfma_f32_16x16x32_bf16 v[92:95], a[20:23], a[92:95], v[92:95]
  v_mfma_f32_16x16x32_bf16 v[124:127], a[24:27], a[88:91], v[124:127]
  v_mfma_f32_16x16x32_bf16 v[124:127], a[28:31], a[92:95], v[124:127]
  v_mfma_f32_16x16x32_bf16 v[32:35], a[0:3], a[64:67], v[32:35]
  ds_read_b128 a[88:91], v7 offset:1792
  v_mfma_f32_16x16x32_bf16 v[32:35], a[4:7], a[68:71], v[32:35]
  ds_read_b128 a[92:95], v7 offset:9984
  v_mfma_f32_16x16x32_bf16 v[64:67], a[8:11], a[64:67], v[64:67]
  v_mfma_f32_16x16x32_bf16 v[64:67], a[12:15], a[68:71], v[64:67]
  v_mfma_f32_16x16x32_bf16 v[96:99], a[16:19], a[64:67], v[96:99]
  v_mfma_f32_16x16x32_bf16 v[96:99], a[20:23], a[68:71], v[96:99]
  v_mfma_f32_16x16x32_bf16 v[128:131], a[24:27], a[64:67], v[128:131]
  v_mfma_f32_16x16x32_bf16 v[128:131], a[28:31], a[68:71], v[128:131]
  s_waitcnt lgkmcnt(0)
  s_barrier
  v_mfma_f32_16x16x32_bf16 v[36:39], a[0:3], a[72:75], v[36:39]
  ds_read_b128 a[64:67], v1 offset:0
  v_mfma_f32_16x16x32_bf16 v[36:39], a[4:7], a[76:79], v[36:39]
  ds_read_b128 a[68:71], v1 offset:8192
  v_mfma_f32_16x16x32_bf16 v[68:71], a[8:11], a[72:75], v[68:71]
  ds_read_b128 a[32:35], v3 offset:0
  v_mfma_f32_16x16x32_bf16 v[68:71], a[12:15], a[76:79], v[68:71]
  ds_read_b128 a[36:39], v4 offset:0
  v_mfma_f32_16x16x32_bf16 v[100:103], a[16:19], a[72:75], v[100:103]
  ds_read_b128 a[40:43], v3 offset:2048
  v_mfma_f32_16x16x32_bf16 v[100:103], a[20:23], a[76:79], v[100:103]
  ds_read_b128 a[44:47], v4 offset:2048
  v_mfma_f32_16x16x32_bf16 v[132:135], a[24:27], a[72:75], v[132:135]
  v_mfma_f32_16x16x32_bf16 v[132:135], a[28:31], a[76:79], v[132:135]
  ds_read_b128 a[48:51], v3 offset:4096
  v_mfma_f32_16x16x32_bf16 v[40:43], a[0:3], a[80:83], v[40:43]
  ds_read_b128 a[72:75], v1 offset:256
  v_mfma_f32_16x16x32_bf16 v[40:43], a[4:7], a[84:87], v[40:43]
  ds_read_b128 a[76:79], v1 offset:8448
  v_mfma_f32_16x16x32_bf16 v[72:75], a[8:11], a[80:83], v[72:75]
  v_mfma_f32_16x16x32_bf16 v[72:75], a[12:15], a[84:87], v[72:75]
  ds_read_b128 a[52:55], v4 offset:4096
  v_mfma_f32_16x16x32_bf16 v[104:107], a[16:19], a[80:83], v[104:107]
  v_mfma_f32_16x16x32_bf16 v[104:107], a[20:23], a[84:87], v[104:107]
  ds_read_b128 a[56:59], v3 offset:6144
  v_mfma_f32_16x16x32_bf16 v[136:139], a[24:27], a[80:83], v[136:139]
  v_mfma_f32_16x16x32_bf16 v[136:139], a[28:31], a[84:87], v[136:139]
  ds_read_b128 a[60:63], v4 offset:6144
  v_mfma_f32_16x16x32_bf16 v[44:47], a[0:3], a[88:91], v[44:47]
  ds_read_b128 a[80:83], v1 offset:512
  v_mfma_f32_16x16x32_bf16 v[44:47], a[4:7], a[92:95], v[44:47]
  ds_read_b128 a[84:87], v1 offset:8704
  v_mfma_f32_16x16x32_bf16 v[76:79], a[8:11], a[88:91], v[76:79]
  v_mfma_f32_16x16x32_bf16 v[76:79], a[12:15], a[92:95], v[76:79]
  v_mfma_f32_16x16x32_bf16 v[108:111], a[16:19], a[88:91], v[108:111]
  v_mfma_f32_16x16x32_bf16 v[108:111], a[20:23], a[92:95], v[108:111]
  v_mfma_f32_16x16x32_bf16 v[140:143], a[24:27], a[88:91], v[140:143]
  v_mfma_f32_16x16x32_bf16 v[140:143], a[28:31], a[92:95], v[140:143]
  s_add_u32 s60, s60, s62
  s_waitcnt lgkmcnt(0)
  v_mfma_f32_16x16x32_bf16 v[16:19], a[32:35], a[64:67], v[16:19]
  ds_read_b128 a[88:91], v1 offset:768
  v_mfma_f32_16x16x32_bf16 v[16:19], a[36:39], a[68:71], v[16:19]
  ds_read_b128 a[92:95], v1 offset:8960
  v_mfma_f32_16x16x32_bf16 v[48:51], a[40:43], a[64:67], v[48:51]
  v_mfma_f32_16x16x32_bf16 v[48:51], a[44:47], a[68:71], v[48:51]
  s_cmp_eq_u32 s60, 147456
  v_mfma_f32_16x16x32_bf16 v[80:83], a[48:51], a[64:67], v[80:83]
  v_mfma_f32_16x16x32_bf16 v[80:83], a[52:55], a[68:71], v[80:83]
  s_cselect_b32 s60, 0, s60
  v_add_u32 v7, s60, v146
  v_mfma_f32_16x16x32_bf16 v[112:115], a[56:59], a[64:67], v[112:115]
  v_mfma_f32_16x16x32_bf16 v[112:115], a[60:63], a[68:71], v[112:115]
  v_mfma_f32_16x16x32_bf16 v[20:23], a[32:35], a[72:75], v[20:23]
  ds_read_b128 a[64:67], v1 offset:1024
  v_mfma_f32_16x16x32_bf16 v[20:23], a[36:39], a[76:79], v[20:23]
  ds_read_b128 a[68:71], v1 offset:9216
  v_mfma_f32_16x16x32_bf16 v[52:55], a[40:43], a[72:75], v[52:55]
  v_mfma_f32_16x16x32_bf16 v[52:55], a[44:47], a[76:79], v[52:55]
  v_mfma_f32_16x16x32_bf16 v[84:87], a[48:51], a[72:75], v[84:87]
  v_mfma_f32_16x16x32_bf16 v[84:87], a[52:55], a[76:79], v[84:87]
  v_mfma_f32_16x16x32_bf16 v[116:119], a[56:59], a[72:75], v[116:119]
  v_mfma_f32_16x16x32_bf16 v[116:119], a[60:63], a[76:79], v[116:119]
  v_mfma_f32_16x16x32_bf16 v[24:27], a[32:35], a[80:83], v[24:27]
  ds_read_b128 a[72:75], v1 offset:1280
  v_mfma_f32_16x16x32_bf16 v[24:27], a[36:39], a[84:87], v[24:27]
  ds_read_b128 a[76:79], v1 offset:9472
  v_mfma_f32_16x16x32_bf16 v[56:59], a[40:43], a[80:83], v[56:59]
  v_mfma_f32_16x16x32_bf16 v[56:59], a[44:47], a[84:87], v[56:59]
  v_mfma_f32_16x16x32_bf16 v[88:91], a[48:51], a[80:83], v[88:91]
  v_mfma_f32_16x16x32_bf16 v[88:91], a[52:55], a[84:87], v[88:91]
  v_mfma_f32_16x16x32_bf16 v[120:123], a[56:59], a[80:83], v[120:123]
  v_mfma_f32_16x16x32_bf16 v[120:123], a[60:63], a[84:87], v[120:123]
  v_add_u32 v5, s60, v144
  s_waitcnt lgkmcnt(0)
  v_mfma_f32_16x16x32_bf16 v[28:31], a[32:35], a[88:91], v[28:31]
  ds_read_b128 a[80:83], v1 offset:1536
  v_mfma_f32_16x16x32_bf16 v[28:31], a[36:39], a[92:95], v[28:31]
  ds_read_b128 a[84:87], v1 offset:9728
  v_mfma_f32_16x16x32_bf16 v[60:63], a[40:43], a[88:91], v[60:63]
  v_mfma_f32_16x16x32_bf16 v[60:63], a[44:47], a[92:95], v[60:63]
  v_add_u32_e64 v6, s60, v145
  v_mfma_f32_16x16x32_bf16 v[92:95], a[48:51], a[88:91], v[92:95]
  v_mfma_f32_16x16x32_bf16 v[92:95], a[52:55], a[92:95], v[92:95]
  v_mfma_f32_16x16x32_bf16 v[124:127], a[56:59], a[88:91], v[124:127]
  v_mfma_f32_16x16x32_bf16 v[124:127], a[60:63], a[92:95], v[124:127]
  v_mfma_f32_16x16x32_bf16 v[32:35], a[32:35], a[64:67], v[32:35]
  ds_read_b128 a[88:91], v1 offset:1792
  v_mfma_f32_16x16x32_bf16 v[32:35], a[36:39], a[68:71], v[32:35]
  ds_read_b128 a[92:95], v1 offset:9984
  v_mfma_f32_16x16x32_bf16 v[64:67], a[40:43], a[64:67], v[64:67]
  v_mfma_f32_16x16x32_bf16 v[64:67], a[44:47], a[68:71], v[64:67]
  v_mfma_f32_16x16x32_bf16 v[96:99], a[48:51], a[64:67], v[96:99]
  v_mfma_f32_16x16x32_bf16 v[96:99], a[52:55], a[68:71], v[96:99]
  v_mfma_f32_16x16x32_bf16 v[128:131], a[56:59], a[64:67], v[128:131]
  v_mfma_f32_16x16x32_bf16 v[128:131], a[60:63], a[68:71], v[128:131]
  s_waitcnt lgkmcnt(0)
  s_barrier
  v_mfma_f32_16x16x32_bf16 v[36:39], a[32:35], a[72:75], v[36:39]
  ds_read_b128 a[64:67], v7 offset:0
  v_mfma_f32_16x16x32_bf16 v[36:39], a[36:39], a[76:79], v[36:39]
  ds_read_b128 a[68:71], v7 offset:8192
  v_mfma_f32_16x16x32_bf16 v[68:71], a[40:43], a[72:75], v[68:71]
  ds_read_b128 a[0:3], v5 offset:0
  v_mfma_f32_16x16x32_bf16 v[68:71], a[44:47], a[76:79], v[68:71]
  ds_read_b128 a[4:7], v6 offset:0
  v_mfma_f32_16x16x32_bf16 v[100:103], a[48:51], a[72:75], v[100:103]
  ds_read_b128 a[8:11], v5 offset:2048
  v_mfma_f32_16x16x32_bf16 v[100:103], a[52:55], a[76:79], v[100:103]
  ds_read_b128 a[12:15], v6 offset:2048
  v_mfma_f32_16x16x32_bf16 v[132:135], a[56:59], a[72:75], v[132:135]
  v_mfma_f32_16x16x32_bf16 v[132:135], a[60:63], a[76:79], v[132:135]
  ds_read_b128 a[16:19], v5 offset:4096
  v_mfma_f32_16x16x32_bf16 v[40:43], a[32:35], a[80:83], v[40:43]
  ds_read_b128 a[72:75], v7 offset:256
  v_mfma_f32_16x16x32_bf16 v[40:43], a[36:39], a[84:87], v[40:43]
  ds_read_b128 a[76:79], v7 offset:8448
  v_mfma_f32_16x16x32_bf16 v[72:75], a[40:43], a[80:83], v[72:75]
  v_mfma_f32_16x16x32_bf16 v[72:75], a[44:47], a[84:87], v[72:75]
  ds_read_b128 a[20:23], v6 offset:4096
  v_mfma_f32_16x16x32_bf16 v[104:107], a[48:51], a[80:83], v[104:107]
  v_mfma_f32_16x16x32_bf16 v[104:107], a[52:55], a[84:87], v[104:107]
  ds_read_b128 a[24:27], v5 offset:6144
  v_mfma_f32_16x16x32_bf16 v[136:139], a[56:59], a[80:83], v[136:139]
  v_mfma_f32_16x16x32_bf16 v[136:139], a[60:63], a[84:87], v[136:139]
  ds_read_b128 a[28:31], v6 offset:6144
  v_mfma_f32_16x16x32_bf16 v[44:47], a[32:35], a[88:91], v[44:47]
  ds_read_b128 a[80:83], v7 offset:512
  v_mfma_f32_16x16x32_bf16 v[44:47], a[36:39], a[92:95], v[44:47]
  ds_read_b128 a[84:87], v7 offset:8704
  v_mfma_f32_16x16x32_bf16 v[76:79], a[40:43], a[88:91], v[76:79]
  v_mfma_f32_16x16x32_bf16 v[76:79], a[44:47], a[92:95], v[76:79]
  v_mfma_f32_16x16x32_bf16 v[108:111], a[48:51], a[88:91], v[108:111]
  v_mfma_f32_16x16x32_bf16 v[108:111], a[52:55], a[92:95], v[108:111]
  v_mfma_f32_16x16x32_bf16 v[140:143], a[56:59], a[88:91], v[140:143]
  s_add_u32 s60, s60, s62
  s_sub_u32 s61, s61, 1
  v_mfma_f32_16x16x32_bf16 v[140:143], a[60:63], a[92:95], v[140:143]
  s_waitcnt lgkmcnt(0)
  s_cbranch_scc0 L_c
  v_mfma_f32_16x16x32_bf16 v[16:19], a[0:3], a[64:67], v[16:19]
  ds_read_b128 a[88:91], v7 offset:768
  v_mfma_f32_16x16x32_bf16 v[16:19], a[4:7], a[68:71], v[16:19]
  ds_read_b128 a[92:95], v7 offset:8960
  v_mfma_f32_16x16x32_bf16 v[48:51], a[8:11], a[64:67], v[48:51]
  v_mfma_f32_16x16x32_bf16 v[48:51], a[12:15], a[68:71], v[48:51]
  v_mfma_f32_16x16x32_bf16 v[80:83], a[16:19], a[64:67], v[80:83]
  v_mfma_f32_16x16x32_bf16 v[80:83], a[20:23], a[68:71], v[80:83]
  v_add_u32 v8, 49152, v144
  v_mfma_f32_16x16x32_bf16 v[112:115], a[24:27], a[64:67], v[112:115]
  v_mfma_f32_16x16x32_bf16 v[112:115], a[28:31], a[68:71], v[112:115]
  v_add_u32 v9, 49152, v145
  v_mfma_f32_16x16x32_bf16 v[20:23], a[0:3], a[72:75], v[20:23]
  ds_read_b128 a[64:67], v7 offset:1024
  v_mfma_f32_16x16x32_bf16 v[20:23], a[4:7], a[76:79], v[20:23]
  ds_read_b128 a[68:71], v7 offset:9216
  v_mfma_f32_16x16x32_bf16 v[52:55], a[8:11], a[72:75], v[52:55]
  v_mfma_f32_16x16x32_bf16 v[52:55], a[12:15], a[76:79], v[52:55]
  v_mfma_f32_16x16x32_bf16 v[84:87], a[16:19], a[72:75], v[84:87]
  v_mfma_f32_16x16x32_bf16 v[84:87], a[20:23], a[76:79], v[84:87]
  v_add_u32 v10, 49152, v146
  v_mfma_f32_16x16x32_bf16 v[116:119], a[24:27], a[72:75], v[116:119]
  v_mfma_f32_16x16x32_bf16 v[116:119], a[28:31], a[76:79], v[116:119]
  v_mfma_f32_16x16x32_bf16 v[24:27], a[0:3], a[80:83], v[24:27]
  v_add_u32 v11, 98304, v144
  v_mfma_f32_16x16x32_bf16 v[24:27], a[4:7], a[84:87], v[24:27]
  ds_read_b128 a[72:75], v7 offset:1280
  ds_read_b128 a[76:79], v7 offset:9472
  v_mfma_f32_16x16x32_bf16 v[56:59], a[8:11], a[80:83], v[56:59]
  v_mfma_f32_16x16x32_bf16 v[56:59], a[12:15], a[84:87], v[56:59]
  v_add_u32 v12, 98304, v145
  v_mfma_f32_16x16x32_bf16 v[88:91], a[16:19], a[80:83], v[88:91]
  v_mfma_f32_16x16x32_bf16 v[88:91], a[20:23], a[84:87], v[88:91]
  v_mfma_f32_16x16x32_bf16 v[120:123], a[24:27], a[80:83], v[120:123]
  v_mfma_f32_16x16x32_bf16 v[120:123], a[28:31], a[84:87], v[120:123]
  s_waitcnt lgkmcnt(0)
  s_nop 0
  v_mfma_f32_16x16x32_bf16 v[28:31], a[0:3], a[88:91], v[28:31]
  v_add_u32 v13, 98304, v146
  v_mfma_f32_16x16x32_bf16 v[28:31], a[4:7], a[92:95], v[28:31]
  ds_read_b128 a[80:83], v7 offset:1536
  ds_read_b128 a[84:87], v7 offset:9728
  v_mfma_f32_16x16x32_bf16 v[60:63], a[8:11], a[88:91], v[60:63]
  v_mfma_f32_16x16x32_bf16 v[60:63], a[12:15], a[92:95], v[60:63]
  v_mfma_f32_16x16x32_bf16 v[92:95], a[16:19], a[88:91], v[92:95]
  v_mfma_f32_16x16x32_bf16 v[92:95], a[20:23], a[92:95], v[92:95]
  v_add_u32_e64 v14, s63, v144
  v_mfma_f32_16x16x32_bf16 v[124:127], a[24:27], a[88:91], v[124:127]
  v_mfma_f32_16x16x32_bf16 v[124:127], a[28:31], a[92:95], v[124:127]
  v_add_u32_e64 v15, s63, v145
  v_mfma_f32_16x16x32_bf16 v[32:35], a[0:3], a[64:67], v[32:35]
  ds_read_b128 a[88:91], v7 offset:1792
  v_mfma_f32_16x16x32_bf16 v[32:35], a[4:7], a[68:71], v[32:35]
  ds_read_b128 a[92:95], v7 offset:9984
  v_mfma_f32_16x16x32_bf16 v[64:67], a[8:11], a[64:67], v[64:67]
  v_mfma_f32_16x16x32_bf16 v[64:67], a[12:15], a[68:71], v[64:67]
  v_mfma_f32_16x16x32_bf16 v[96:99], a[16:19], a[64:67], v[96:99]
  v_mfma_f32_16x16x32_bf16 v[96:99], a[20:23], a[68:71], v[96:99]
  v_mfma_f32_16x16x32_bf16 v[128:131], a[24:27], a[64:67], v[128:131]
  v_mfma_f32_16x16x32_bf16 v[128:131], a[28:31], a[68:71], v[128:131]
  s_waitcnt lgkmcnt(0)
  s_barrier
  v_mfma_f32_16x16x32_bf16 v[36:39], a[0:3], a[72:75], v[36:39]
  v_mfma_f32_16x16x32_bf16 v[36:39], a[4:7], a[76:79], v[36:39]
  v_mfma_f32_16x16x32_bf16 v[68:71], a[8:11], a[72:75], v[68:71]
  v_mfma_f32_16x16x32_bf16 v[68:71], a[12:15], a[76:79], v[68:71]
  v_mfma_f32_16x16x32_bf16 v[100:103], a[16:19], a[72:75], v[100:103]
  v_mfma_f32_16x16x32_bf16 v[100:103], a[20:23], a[76:79], v[100:103]
  v_mfma_f32_16x16x32_bf16 v[132:135], a[24:27], a[72:75], v[132:135]
  v_mfma_f32_16x16x32_bf16 v[132:135], a[28:31], a[76:79], v[132:135]
  v_mfma_f32_16x16x32_bf16 v[40:43], a[0:3], a[80:83], v[40:43]
  ds_read_b128 a[32:35], v10 offset:0
  v_mfma_f32_16x16x32_bf16 v[40:43], a[4:7], a[84:87], v[40:43]
  ds_read_b128 a[36:39], v8 offset:0
  v_mfma_f32_16x16x32_bf16 v[72:75], a[8:11], a[80:83], v[72:75]
  ds_read_b128 a[40:43], v8 offset:2048
  v_mfma_f32_16x16x32_bf16 v[72:75], a[12:15], a[84:87], v[72:75]
  ds_read_b128 a[44:47], v10 offset:256
  v_mfma_f32_16x16x32_bf16 v[104:107], a[16:19], a[80:83], v[104:107]
  ds_read_b128 a[48:51], v10 offset:512
  v_mfma_f32_16x16x32_bf16 v[104:107], a[20:23], a[84:87], v[104:107]
  ds_read_b128 a[52:55], v10 offset:768
  v_mfma_f32_16x16x32_bf16 v[136:139], a[24:27], a[80:83], v[136:139]
  v_mfma_f32_16x16x32_bf16 v[136:139], a[28:31], a[84:87], v[136:139]
  v_mfma_f32_16x16x32_bf16 v[44:47], a[0:3], a[88:91], v[44:47]
  ds_read_b128 a[56:59], v10 offset:8192
  v_mfma_f32_16x16x32_bf16 v[44:47], a[4:7], a[92:95], v[44:47]
  ds_read_b128 a[60:63], v9 offset:0
  v_mfma_f32_16x16x32_bf16 v[76:79], a[8:11], a[88:91], v[76:79]
  ds_read_b128 a[64:67], v9 offset:2048
  v_mfma_f32_16x16x32_bf16 v[76:79], a[12:15], a[92:95], v[76:79]
  ds_read_b128 a[68:71], v10 offset:8448
  v_mfma_f32_16x16x32_bf16 v[108:111], a[16:19], a[88:91], v[108:111]
  ds_read_b128 a[72:75], v10 offset:8704
  v_mfma_f32_16x16x32_bf16 v[108:111], a[20:23], a[92:95], v[108:111]
  ds_read_b128 a[76:79], v10 offset:8960
  v_mfma_f32_16x16x32_bf16 v[140:143], a[24:27], a[88:91], v[140:143]
  v_mfma_f32_16x16x32_bf16 v[140:143], a[28:31], a[92:95], v[140:143]
  s_waitcnt lgkmcnt(4)
  s_nop 0
  v_mfma_f32_16x16x32_bf16 v[16:19], a[36:39], a[32:35], v[16:19]
  s_barrier
  ds_read_b128 a[80:83], v13 offset:0
  ds_read_b128 a[84:87], v11 offset:0
  s_nop 0
  v_mfma_f32_16x16x32_bf16 v[48:51], a[40:43], a[32:35], v[48:51]
  ds_read_b128 a[0:3], v11 offset:2048
  ds_read_b128 a[4:7], v13 offset:256
  v_mfma_f32_16x16x32_bf16 v[20:23], a[36:39], a[44:47], v[20:23]
  ds_read_b128 a[8:11], v13 offset:512
  ds_read_b128 a[12:15], v13 offset:768
  v_mfma_f32_16x16x32_bf16 v[52:55], a[40:43], a[44:47], v[52:55]
  v_mfma_f32_16x16x32_bf16 v[24:27], a[36:39], a[48:51], v[24:27]
  v_mfma_f32_16x16x32_bf16 v[56:59], a[40:43], a[48:51], v[56:59]
  v_mfma_f32_16x16x32_bf16 v[28:31], a[36:39], a[52:55], v[28:31]
  v_mfma_f32_16x16x32_bf16 v[60:63], a[40:43], a[52:55], v[60:63]
  v_mfma_f32_16x16x32_bf16 v[16:19], a[60:63], a[56:59], v[16:19]
  ds_read_b128 a[16:19], v13 offset:8192
  ds_read_b128 a[20:23], v12 offset:0
  s_waitcnt lgkmcnt(2)
  s_nop 0
  v_mfma_f32_16x16x32_bf16 v[48:51], a[64:67], a[56:59], v[48:51]
  ds_read_b128 a[24:27], v12 offset:2048
  ds_read_b128 a[28:31], v13 offset:8448
  v_mfma_f32_16x16x32_bf16 v[20:23], a[60:63], a[68:71], v[20:23]
  ds_read_b128 a[88:91], v13 offset:8704
  ds_read_b128 a[92:95], v13 offset:8960
  v_mfma_f32_16x16x32_bf16 v[52:55], a[64:67], a[68:71], v[52:55]
  v_mfma_f32_16x16x32_bf16 v[24:27], a[60:63], a[72:75], v[24:27]
  v_mfma_f32_16x16x32_bf16 v[56:59], a[64:67], a[72:75], v[56:59]
  v_mfma_f32_16x16x32_bf16 v[28:31], a[60:63], a[76:79], v[28:31]
  v_mfma_f32_16x16x32_bf16 v[60:63], a[64:67], a[76:79], v[60:63]
  v_mfma_f32_16x16x32_bf16 v[16:19], a[84:87], a[80:83], v[16:19]
  s_barrier
  ds_read_b128 a[32:35], v146 offset:0
  ds_read_b128 a[44:47], v14 offset:0
  s_nop 0
  v_mfma_f32_16x16x32_bf16 v[48:51], a[0:3], a[80:83], v[48:51]
  ds_read_b128 a[48:51], v14 offset:2048
  ds_read_b128 a[36:39], v146 offset:256
  v_mfma_f32_16x16x32_bf16 v[20:23], a[84:87], a[4:7], v[20:23]
  ds_read_b128 a[40:43], v146 offset:512
  ds_read_b128 a[52:55], v146 offset:768
  v_mfma_f32_16x16x32_bf16 v[52:55], a[0:3], a[4:7], v[52:55]
  v_mfma_f32_16x16x32_bf16 v[24:27], a[84:87], a[8:11], v[24:27]
  v_mfma_f32_16x16x32_bf16 v[56:59], a[0:3], a[8:11], v[56:59]
  v_mfma_f32_16x16x32_bf16 v[28:31], a[84:87], a[12:15], v[28:31]
  v_mfma_f32_16x16x32_bf16 v[60:63], a[0:3], a[12:15], v[60:63]
  s_waitcnt lgkmcnt(0)
  s_nop 0
  v_mfma_f32_16x16x32_bf16 v[16:19], a[20:23], a[16:19], v[16:19]
  ds_read_b128 a[56:59], v146 offset:8192
  ds_read_b128 a[68:71], v15 offset:0
  v_mfma_f32_16x16x32_bf16 v[48:51], a[24:27], a[16:19], v[48:51]
  ds_read_b128 a[72:75], v15 offset:2048
  ds_read_b128 a[60:63], v146 offset:8448
  v_mfma_f32_16x16x32_bf16 v[20:23], a[20:23], a[28:31], v[20:23]
  ds_read_b128 a[64:67], v146 offset:8704
  ds_read_b128 a[76:79], v146 offset:8960
  v_mfma_f32_16x16x32_bf16 v[52:55], a[24:27], a[28:31], v[52:55]
  v_mfma_f32_16x16x32_bf16 v[24:27], a[20:23], a[88:91], v[24:27]
  v_mfma_f32_16x16x32_bf16 v[56:59], a[24:27], a[88:91], v[56:59]
  v_mfma_f32_16x16x32_bf16 v[28:31], a[20:23], a[92:95], v[28:31]
  v_mfma_f32_16x16x32_bf16 v[60:63], a[24:27], a[92:95], v[60:63]
  v_mfma_f32_16x16x32_bf16 v[16:19], a[44:47], a[32:35], v[16:19]
  ds_read_b128 a[80:83], v10 offset:1024
  ds_read_b128 a[4:7], v8 offset:0
  v_mfma_f32_16x16x32_bf16 v[48:51], a[48:51], a[32:35], v[48:51]
  ds_read_b128 a[8:11], v8 offset:2048
  ds_read_b128 a[84:87], v10 offset:1280
  v_mfma_f32_16x16x32_bf16 v[20:23], a[44:47], a[36:39], v[20:23]
  ds_read_b128 a[0:3], v10 offset:1536
  ds_read_b128 a[12:15], v10 offset:1792
  v_mfma_f32_16x16x32_bf16 v[52:55], a[48:51], a[36:39], v[52:55]
  v_mfma_f32_16x16x32_bf16 v[24:27], a[44:47], a[40:43], v[24:27]
  v_mfma_f32_16x16x32_bf16 v[56:59], a[48:51], a[40:43], v[56:59]
  v_mfma_f32_16x16x32_bf16 v[28:31], a[44:47], a[52:55], v[28:31]
  v_mfma_f32_16x16x32_bf16 v[60:63], a[48:51], a[52:55], v[60:63]
  s_waitcnt lgkmcnt(0)
  s_nop 0
  v_mfma_f32_16x16x32_bf16 v[16:19], a[68:71], a[56:59], v[16:19]
  ds_read_b128 a[16:19], v10 offset:9216
  ds_read_b128 a[28:31], v9 offset:0
  v_mfma_f32_16x16x32_bf16 v[48:51], a[72:75], a[56:59], v[48:51]
  ds_read_b128 a[88:91], v9 offset:2048
  ds_read_b128 a[20:23], v10 offset:9472
  v_mfma_f32_16x16x32_bf16 v[20:23], a[68:71], a[60:63], v[20:23]
  ds_read_b128 a[24:27], v10 offset:9728
  ds_read_b128 a[92:95], v10 offset:9984
  v_mfma_f32_16x16x32_bf16 v[52:55], a[72:75], a[60:63], v[52:55]
  v_mfma_f32_16x16x32_bf16 v[24:27], a[68:71], a[64:67], v[24:27]
  v_mfma_f32_16x16x32_bf16 v[56:59], a[72:75], a[64:67], v[56:59]
  v_mfma_f32_16x16x32_bf16 v[28:31], a[68:71], a[76:79], v[28:31]
  v_mfma_f32_16x16x32_bf16 v[60:63], a[72:75], a[76:79], v[60:63]
  v_mfma_f32_16x16x32_bf16 v[32:35], a[4:7], a[80:83], v[32:35]
  ds_read_b128 a[32:35], v13 offset:1024
  ds_read_b128 a[36:39], v11 offset:0
  v_mfma_f32_16x16x32_bf16 v[64:67], a[8:11], a[80:83], v[64:67]
  ds_read_b128 a[40:43], v11 offset:2048
  ds_read_b128 a[44:47], v13 offset:1280
  v_mfma_f32_16x16x32_bf16 v[36:39], a[4:7], a[84:87], v[36:39]
  ds_read_b128 a[48:51], v13 offset:1536
  ds_read_b128 a[52:55], v13 offset:1792
  v_mfma_f32_16x16x32_bf16 v[68:71], a[8:11], a[84:87], v[68:71]
  v_cvt_pk_bf16_f32 v150, v17, v21
  v_cvt_pk_bf16_f32 v151, v25, v29
  v_mfma_f32_16x16x32_bf16 v[40:43], a[4:7], a[0:3], v[40:43]
  v_cvt_pk_bf16_f32 v148, v16, v20
  v_cvt_pk_bf16_f32 v149, v24, v28
  v_mfma_f32_16x16x32_bf16 v[72:75], a[8:11], a[0:3], v[72:75]
  v_cndmask_b32_dpp v152, v150, v148, vcc quad_perm:[1,0,3,2] row_mask:0xf bank_mask:0xf
  v_cndmask_b32_dpp v153, v151, v149, vcc quad_perm:[1,0,3,2] row_mask:0xf bank_mask:0xf
  v_mfma_f32_16x16x32_bf16 v[44:47], a[4:7], a[12:15], v[44:47]
  s_not_b64 vcc, vcc
  v_cndmask_b32_dpp v154, v148, v150, vcc quad_perm:[1,0,3,2] row_mask:0xf bank_mask:0xf
  s_nop 0
  v_mfma_f32_16x16x32_bf16 v[76:79], a[8:11], a[12:15], v[76:79]
  v_cndmask_b32_dpp v155, v149, v151, vcc quad_perm:[1,0,3,2] row_mask:0xf bank_mask:0xf
  buffer_store_dwordx4 v[152:155], v147, s[32:35], s44 offen offset:0 sc0 sc1
  s_waitcnt lgkmcnt(0)
  s_nop 0
  v_mfma_f32_16x16x32_bf16 v[32:35], a[28:31], a[16:19], v[32:35]
  ds_read_b128 a[56:59], v13 offset:9216
  ds_read_b128 a[60:63], v12 offset:0
  v_mfma_f32_16x16x32_bf16 v[64:67], a[88:91], a[16:19], v[64:67]
  ds_read_b128 a[64:67], v12 offset:2048
  ds_read_b128 a[68:71], v13 offset:9472
  v_mfma_f32_16x16x32_bf16 v[36:39], a[28:31], a[20:23], v[36:39]
  ds_read_b128 a[72:75], v13 offset:9728
  ds_read_b128 a[76:79], v13 offset:9984
  v_mfma_f32_16x16x32_bf16 v[68:71], a[88:91], a[20:23], v[68:71]
  v_cvt_pk_bf16_f32 v148, v18, v22
  v_cvt_pk_bf16_f32 v149, v26, v30
  v_mfma_f32_16x16x32_bf16 v[40:43], a[28:31], a[24:27], v[40:43]
  v_cvt_pk_bf16_f32 v150, v19, v23
  v_cvt_pk_bf16_f32 v151, v27, v31
  v_mfma_f32_16x16x32_bf16 v[72:75], a[88:91], a[24:27], v[72:75]
  v_cndmask_b32_dpp v158, v148, v150, vcc quad_perm:[1,0,3,2] row_mask:0xf bank_mask:0xf
  v_cndmask_b32_dpp v159, v149, v151, vcc quad_perm:[1,0,3,2] row_mask:0xf bank_mask:0xf
  v_mfma_f32_16x16x32_bf16 v[44:47], a[28:31], a[92:95], v[44:47]
  s_not_b64 vcc, vcc
  v_cndmask_b32_dpp v156, v150, v148, vcc quad_perm:[1,0,3,2] row_mask:0xf bank_mask:0xf
  s_nop 0
  v_mfma_f32_16x16x32_bf16 v[76:79], a[88:91], a[92:95], v[76:79]
  v_cndmask_b32_dpp v157, v151, v149, vcc quad_perm:[1,0,3,2] row_mask:0xf bank_mask:0xf
  buffer_store_dwordx4 v[156:159], v147, s[32:35], s46 offen offset:0 sc0 sc1
  v_mfma_f32_16x16x32_bf16 v[32:35], a[36:39], a[32:35], v[32:35]
  s_barrier
  ds_read_b128 a[80:83], v146 offset:1024
  ds_read_b128 a[84:87], v14 offset:0
  s_nop 0
  v_mfma_f32_16x16x32_bf16 v[64:67], a[40:43], a[32:35], v[64:67]
  ds_read_b128 a[0:3], v14 offset:2048
  ds_read_b128 a[4:7], v146 offset:1280
  v_mfma_f32_16x16x32_bf16 v[36:39], a[36:39], a[44:47], v[36:39]
  ds_read_b128 a[8:11], v146 offset:1536
  ds_read_b128 a[12:15], v146 offset:1792
  v_mfma_f32_16x16x32_bf16 v[68:71], a[40:43], a[44:47], v[68:71]
  v_cvt_pk_bf16_f32 v150, v49, v53
  v_cvt_pk_bf16_f32 v151, v57, v61
  v_mfma_f32_16x16x32_bf16 v[40:43], a[36:39], a[48:51], v[40:43]
  v_cvt_pk_bf16_f32 v148, v48, v52
  v_cvt_pk_bf16_f32 v149, v56, v60
  v_mfma_f32_16x16x32_bf16 v[72:75], a[40:43], a[48:51], v[72:75]
  v_cndmask_b32_dpp v152, v150, v148, vcc quad_perm:[1,0,3,2] row_mask:0xf bank_mask:0xf
  v_cndmask_b32_dpp v153, v151, v149, vcc quad_perm:[1,0,3,2] row_mask:0xf bank_mask:0xf
  v_mfma_f32_16x16x32_bf16 v[44:47], a[36:39], a[52:55], v[44:47]
  s_not_b64 vcc, vcc
  v_cndmask_b32_dpp v154, v148, v150, vcc quad_perm:[1,0,3,2] row_mask:0xf bank_mask:0xf
  s_nop 0
  v_mfma_f32_16x16x32_bf16 v[76:79], a[40:43], a[52:55], v[76:79]
  v_cndmask_b32_dpp v155, v149, v151, vcc quad_perm:[1,0,3,2] row_mask:0xf bank_mask:0xf
  buffer_store_dwordx4 v[152:155], v147, s[32:35], s48 offen offset:0 sc0 sc1
  s_waitcnt lgkmcnt(0)
  s_nop 0
  v_mfma_f32_16x16x32_bf16 v[32:35], a[60:63], a[56:59], v[32:35]
  ds_read_b128 a[16:19], v146 offset:9216
  ds_read_b128 a[20:23], v15 offset:0
  v_mfma_f32_16x16x32_bf16 v[64:67], a[64:67], a[56:59], v[64:67]
  ds_read_b128 a[24:27], v15 offset:2048
  ds_read_b128 a[28:31], v146 offset:9472
  v_mfma_f32_16x16x32_bf16 v[36:39], a[60:63], a[68:71], v[36:39]
  ds_read_b128 a[88:91], v146 offset:9728
  ds_read_b128 a[92:95], v146 offset:9984
  v_mfma_f32_16x16x32_bf16 v[68:71], a[64:67], a[68:71], v[68:71]
  v_cvt_pk_bf16_f32 v148, v50, v54
  v_cvt_pk_bf16_f32 v149, v58, v62
  v_mfma_f32_16x16x32_bf16 v[40:43], a[60:63], a[72:75], v[40:43]
  v_cvt_pk_bf16_f32 v150, v51, v55
  v_cvt_pk_bf16_f32 v151, v59, v63
  v_mfma_f32_16x16x32_bf16 v[72:75], a[64:67], a[72:75], v[72:75]
  v_cndmask_b32_dpp v158, v148, v150, vcc quad_perm:[1,0,3,2] row_mask:0xf bank_mask:0xf
  v_cndmask_b32_dpp v159, v149, v151, vcc quad_perm:[1,0,3,2] row_mask:0xf bank_mask:0xf
  v_mfma_f32_16x16x32_bf16 v[44:47], a[60:63], a[76:79], v[44:47]
  s_not_b64 vcc, vcc
  v_cndmask_b32_dpp v156, v150, v148, vcc quad_perm:[1,0,3,2] row_mask:0xf bank_mask:0xf
  s_nop 0
  v_mfma_f32_16x16x32_bf16 v[76:79], a[64:67], a[76:79], v[76:79]
  v_cndmask_b32_dpp v157, v151, v149, vcc quad_perm:[1,0,3,2] row_mask:0xf bank_mask:0xf
  buffer_store_dwordx4 v[156:159], v147, s[32:35], s50 offen offset:0 sc0 sc1
  v_mfma_f32_16x16x32_bf16 v[32:35], a[84:87], a[80:83], v[32:35]
  ds_read_b128 a[32:35], v10 offset:0
  ds_read_b128 a[44:47], v8 offset:4096
  v_mfma_f32_16x16x32_bf16 v[64:67], a[0:3], a[80:83], v[64:67]
  ds_read_b128 a[48:51], v8 offset:6144
  ds_read_b128 a[36:39], v10 offset:256
  v_mfma_f32_16x16x32_bf16 v[36:39], a[84:87], a[4:7], v[36:39]
  ds_read_b128 a[40:43], v10 offset:512
  ds_read_b128 a[52:55], v10 offset:768
  v_mfma_f32_16x16x32_bf16 v[68:71], a[0:3], a[4:7], v[68:71]
  v_mfma_f32_16x16x32_bf16 v[40:43], a[84:87], a[8:11], v[40:43]
  v_mfma_f32_16x16x32_bf16 v[72:75], a[0:3], a[8:11], v[72:75]
  v_mfma_f32_16x16x32_bf16 v[44:47], a[84:87], a[12:15], v[44:47]
  v_mfma_f32_16x16x32_bf16 v[76:79], a[0:3], a[12:15], v[76:79]
  s_waitcnt lgkmcnt(0)
  s_nop 0
  v_mfma_f32_16x16x32_bf16 v[32:35], a[20:23], a[16:19], v[32:35]
  ds_read_b128 a[56:59], v10 offset:8192
  ds_read_b128 a[68:71], v9 offset:4096
  v_mfma_f32_16x16x32_bf16 v[64:67], a[24:27], a[16:19], v[64:67]
  ds_read_b128 a[72:75], v9 offset:6144
  ds_read_b128 a[60:63], v10 offset:8448
  v_mfma_f32_16x16x32_bf16 v[36:39], a[20:23], a[28:31], v[36:39]
  ds_read_b128 a[64:67], v10 offset:8704
  ds_read_b128 a[76:79], v10 offset:8960
  v_mfma_f32_16x16x32_bf16 v[68:71], a[24:27], a[28:31], v[68:71]
  v_mfma_f32_16x16x32_bf16 v[40:43], a[20:23], a[88:91], v[40:43]
  v_mfma_f32_16x16x32_bf16 v[72:75], a[24:27], a[88:91], v[72:75]
  v_mfma_f32_16x16x32_bf16 v[44:47], a[20:23], a[92:95], v[44:47]
  v_mfma_f32_16x16x32_bf16 v[76:79], a[24:27], a[92:95], v[76:79]
  v_mfma_f32_16x16x32_bf16 v[80:83], a[44:47], a[32:35], v[80:83]
  ds_read_b128 a[80:83], v13 offset:0
  ds_read_b128 a[4:7], v11 offset:4096
  v_mfma_f32_16x16x32_bf16 v[112:115], a[48:51], a[32:35], v[112:115]
  ds_read_b128 a[8:11], v11 offset:6144
  ds_read_b128 a[84:87], v13 offset:256
  v_mfma_f32_16x16x32_bf16 v[84:87], a[44:47], a[36:39], v[84:87]
  ds_read_b128 a[0:3], v13 offset:512
  ds_read_b128 a[12:15], v13 offset:768
  v_mfma_f32_16x16x32_bf16 v[116:119], a[48:51], a[36:39], v[116:119]
  v_cvt_pk_bf16_f32 v150, v33, v37
  v_cvt_pk_bf16_f32 v151, v41, v45
  v_mfma_f32_16x16x32_bf16 v[88:91], a[44:47], a[40:43], v[88:91]
  v_cvt_pk_bf16_f32 v148, v32, v36
  v_cvt_pk_bf16_f32 v149, v40, v44
  v_mfma_f32_16x16x32_bf16 v[120:123], a[48:51], a[40:43], v[120:123]
  v_cndmask_b32_dpp v152, v150, v148, vcc quad_perm:[1,0,3,2] row_mask:0xf bank_mask:0xf
  v_cndmask_b32_dpp v153, v151, v149, vcc quad_perm:[1,0,3,2] row_mask:0xf bank_mask:0xf
  v_mfma_f32_16x16x32_bf16 v[92:95], a[44:47], a[52:55], v[92:95]
  s_not_b64 vcc, vcc
  v_cndmask_b32_dpp v154, v148, v150, vcc quad_perm:[1,0,3,2] row_mask:0xf bank_mask:0xf
  s_nop 0
  v_mfma_f32_16x16x32_bf16 v[124:127], a[48:51], a[52:55], v[124:127]
  v_cndmask_b32_dpp v155, v149, v151, vcc quad_perm:[1,0,3,2] row_mask:0xf bank_mask:0xf
  buffer_store_dwordx4 v[152:155], v147, s[32:35], s44 offen offset:128 sc0 sc1
  s_waitcnt lgkmcnt(0)
  s_nop 0
  v_mfma_f32_16x16x32_bf16 v[80:83], a[68:71], a[56:59], v[80:83]
  ds_read_b128 a[16:19], v13 offset:8192
  ds_read_b128 a[28:31], v12 offset:4096
  v_mfma_f32_16x16x32_bf16 v[112:115], a[72:75], a[56:59], v[112:115]
  ds_read_b128 a[88:91], v12 offset:6144
  ds_read_b128 a[20:23], v13 offset:8448
  v_mfma_f32_16x16x32_bf16 v[84:87], a[68:71], a[60:63], v[84:87]
  ds_read_b128 a[24:27], v13 offset:8704
  ds_read_b128 a[92:95], v13 offset:8960
  v_mfma_f32_16x16x32_bf16 v[116:119], a[72:75], a[60:63], v[116:119]
  v_cvt_pk_bf16_f32 v148, v34, v38
  v_cvt_pk_bf16_f32 v149, v42, v46
  v_mfma_f32_16x16x32_bf16 v[88:91], a[68:71], a[64:67], v[88:91]
  v_cvt_pk_bf16_f32 v150, v35, v39
  v_cvt_pk_bf16_f32 v151, v43, v47
  v_mfma_f32_16x16x32_bf16 v[120:123], a[72:75], a[64:67], v[120:123]
  v_cndmask_b32_dpp v158, v148, v150, vcc quad_perm:[1,0,3,2] row_mask:0xf bank_mask:0xf
  v_cndmask_b32_dpp v159, v149, v151, vcc quad_perm:[1,0,3,2] row_mask:0xf bank_mask:0xf
  v_mfma_f32_16x16x32_bf16 v[92:95], a[68:71], a[76:79], v[92:95]
  s_not_b64 vcc, vcc
  v_cndmask_b32_dpp v156, v150, v148, vcc quad_perm:[1,0,3,2] row_mask:0xf bank_mask:0xf
  s_nop 0
  v_mfma_f32_16x16x32_bf16 v[124:127], a[72:75], a[76:79], v[124:127]
  v_cndmask_b32_dpp v157, v151, v149, vcc quad_perm:[1,0,3,2] row_mask:0xf bank_mask:0xf
  buffer_store_dwordx4 v[156:159], v147, s[32:35], s46 offen offset:128 sc0 sc1
  v_mfma_f32_16x16x32_bf16 v[80:83], a[4:7], a[80:83], v[80:83]
  ds_read_b128 a[32:35], v146 offset:0
  ds_read_b128 a[36:39], v144 offset:4096
  v_mfma_f32_16x16x32_bf16 v[112:115], a[8:11], a[80:83], v[112:115]
  ds_read_b128 a[40:43], v144 offset:6144
  ds_read_b128 a[44:47], v146 offset:256
  v_mfma_f32_16x16x32_bf16 v[84:87], a[4:7], a[84:87], v[84:87]
  ds_read_b128 a[48:51], v146 offset:512
  ds_read_b128 a[52:55], v146 offset:768
  v_mfma_f32_16x16x32_bf16 v[116:119], a[8:11], a[84:87], v[116:119]
  v_cvt_pk_bf16_f32 v150, v65, v69
  v_cvt_pk_bf16_f32 v151, v73, v77
  v_mfma_f32_16x16x32_bf16 v[88:91], a[4:7], a[0:3], v[88:91]
  v_cvt_pk_bf16_f32 v148, v64, v68
  v_cvt_pk_bf16_f32 v149, v72, v76
  v_mfma_f32_16x16x32_bf16 v[120:123], a[8:11], a[0:3], v[120:123]
  v_cndmask_b32_dpp v152, v150, v148, vcc quad_perm:[1,0,3,2] row_mask:0xf bank_mask:0xf
  v_cndmask_b32_dpp v153, v151, v149, vcc quad_perm:[1,0,3,2] row_mask:0xf bank_mask:0xf
  v_mfma_f32_16x16x32_bf16 v[92:95], a[4:7], a[12:15], v[92:95]
  s_not_b64 vcc, vcc
  v_cndmask_b32_dpp v154, v148, v150, vcc quad_perm:[1,0,3,2] row_mask:0xf bank_mask:0xf
  s_nop 0
  v_mfma_f32_16x16x32_bf16 v[124:127], a[8:11], a[12:15], v[124:127]
  v_cndmask_b32_dpp v155, v149, v151, vcc quad_perm:[1,0,3,2] row_mask:0xf bank_mask:0xf
  buffer_store_dwordx4 v[152:155], v147, s[32:35], s48 offen offset:128 sc0 sc1
  s_waitcnt lgkmcnt(0)
  s_nop 0
  v_mfma_f32_16x16x32_bf16 v[80:83], a[28:31], a[16:19], v[80:83]
  ds_read_b128 a[56:59], v146 offset:8192
  ds_read_b128 a[60:63], v145 offset:4096
  v_mfma_f32_16x16x32_bf16 v[112:115], a[88:91], a[16:19], v[112:115]
  ds_read_b128 a[64:67], v145 offset:6144
  ds_read_b128 a[68:71], v146 offset:8448
  v_mfma_f32_16x16x32_bf16 v[84:87], a[28:31], a[20:23], v[84:87]
  ds_read_b128 a[72:75], v146 offset:8704
  ds_read_b128 a[76:79], v146 offset:8960
  v_mfma_f32_16x16x32_bf16 v[116:119], a[88:91], a[20:23], v[116:119]
  v_cvt_pk_bf16_f32 v148, v66, v70
  v_cvt_pk_bf16_f32 v149, v74, v78
  v_mfma_f32_16x16x32_bf16 v[88:91], a[28:31], a[24:27], v[88:91]
  v_cvt_pk_bf16_f32 v150, v67, v71
  v_cvt_pk_bf16_f32 v151, v75, v79
  v_mfma_f32_16x16x32_bf16 v[120:123], a[88:91], a[24:27], v[120:123]
  v_cndmask_b32_dpp v158, v148, v150, vcc quad_perm:[1,0,3,2] row_mask:0xf bank_mask:0xf
  v_cndmask_b32_dpp v159, v149, v151, vcc quad_perm:[1,0,3,2] row_mask:0xf bank_mask:0xf
  v_mfma_f32_16x16x32_bf16 v[92:95], a[28:31], a[92:95], v[92:95]
  s_not_b64 vcc, vcc
  v_cndmask_b32_dpp v156, v150, v148, vcc quad_perm:[1,0,3,2] row_mask:0xf bank_mask:0xf
  s_nop 0
  v_mfma_f32_16x16x32_bf16 v[124:127], a[88:91], a[92:95], v[124:127]
  v_cndmask_b32_dpp v157, v151, v149, vcc quad_perm:[1,0,3,2] row_mask:0xf bank_mask:0xf
  buffer_store_dwordx4 v[156:159], v147, s[32:35], s50 offen offset:128 sc0 sc1
  v_mfma_f32_16x16x32_bf16 v[80:83], a[36:39], a[32:35], v[80:83]
  ds_read_b128 a[80:83], v10 offset:1024
  ds_read_b128 a[84:87], v8 offset:4096
  v_mfma_f32_16x16x32_bf16 v[112:115], a[40:43], a[32:35], v[112:115]
  ds_read_b128 a[0:3], v8 offset:6144
  ds_read_b128 a[4:7], v10 offset:1280
  v_mfma_f32_16x16x32_bf16 v[84:87], a[36:39], a[44:47], v[84:87]
  ds_read_b128 a[8:11], v10 offset:1536
  ds_read_b128 a[12:15], v10 offset:1792
  v_mfma_f32_16x16x32_bf16 v[116:119], a[40:43], a[44:47], v[116:119]
  v_mfma_f32_16x16x32_bf16 v[88:91], a[36:39], a[48:51], v[88:91]
  v_mfma_f32_16x16x32_bf16 v[120:123], a[40:43], a[48:51], v[120:123]
  v_mfma_f32_16x16x32_bf16 v[92:95], a[36:39], a[52:55], v[92:95]
  v_mfma_f32_16x16x32_bf16 v[124:127], a[40:43], a[52:55], v[124:127]
  s_waitcnt lgkmcnt(0)
  s_nop 0
  v_mfma_f32_16x16x32_bf16 v[80:83], a[60:63], a[56:59], v[80:83]
  ds_read_b128 a[16:19], v10 offset:9216
  ds_read_b128 a[20:23], v9 offset:4096
  v_mfma_f32_16x16x32_bf16 v[112:115], a[64:67], a[56:59], v[112:115]
  ds_read_b128 a[24:27], v9 offset:6144
  ds_read_b128 a[28:31], v10 offset:9472
  v_mfma_f32_16x16x32_bf16 v[84:87], a[60:63], a[68:71], v[84:87]
  ds_read_b128 a[88:91], v10 offset:9728
  ds_read_b128 a[92:95], v10 offset:9984
  v_mfma_f32_16x16x32_bf16 v[116:119], a[64:67], a[68:71], v[116:119]
  v_mfma_f32_16x16x32_bf16 v[88:91], a[60:63], a[72:75], v[88:91]
  v_mfma_f32_16x16x32_bf16 v[120:123], a[64:67], a[72:75], v[120:123]
  v_mfma_f32_16x16x32_bf16 v[92:95], a[60:63], a[76:79], v[92:95]
  v_mfma_f32_16x16x32_bf16 v[124:127], a[64:67], a[76:79], v[124:127]
  v_mfma_f32_16x16x32_bf16 v[96:99], a[84:87], a[80:83], v[96:99]
  ds_read_b128 a[32:35], v13 offset:1024
  ds_read_b128 a[44:47], v11 offset:4096
  v_mfma_f32_16x16x32_bf16 v[128:131], a[0:3], a[80:83], v[128:131]
  ds_read_b128 a[48:51], v11 offset:6144
  ds_read_b128 a[36:39], v13 offset:1280
  v_mfma_f32_16x16x32_bf16 v[100:103], a[84:87], a[4:7], v[100:103]
  ds_read_b128 a[40:43], v13 offset:1536
  ds_read_b128 a[52:55], v13 offset:1792
  v_mfma_f32_16x16x32_bf16 v[132:135], a[0:3], a[4:7], v[132:135]
  v_cvt_pk_bf16_f32 v150, v81, v85
  v_cvt_pk_bf16_f32 v151, v89, v93
  v_mfma_f32_16x16x32_bf16 v[104:107], a[84:87], a[8:11], v[104:107]
  v_cvt_pk_bf16_f32 v148, v80, v84
  v_cvt_pk_bf16_f32 v149, v88, v92
  v_mfma_f32_16x16x32_bf16 v[136:139], a[0:3], a[8:11], v[136:139]
  v_cndmask_b32_dpp v152, v150, v148, vcc quad_perm:[1,0,3,2] row_mask:0xf bank_mask:0xf
  v_cndmask_b32_dpp v153, v151, v149, vcc quad_perm:[1,0,3,2] row_mask:0xf bank_mask:0xf
  v_mfma_f32_16x16x32_bf16 v[108:111], a[84:87], a[12:15], v[108:111]
  s_not_b64 vcc, vcc
  v_cndmask_b32_dpp v154, v148, v150, vcc quad_perm:[1,0,3,2] row_mask:0xf bank_mask:0xf
  s_nop 0
  v_mfma_f32_16x16x32_bf16 v[140:143], a[0:3], a[12:15], v[140:143]
  v_cndmask_b32_dpp v155, v149, v151, vcc quad_perm:[1,0,3,2] row_mask:0xf bank_mask:0xf
  buffer_store_dwordx4 v[152:155], v147, s[32:35], s52 offen offset:0 sc0 sc1
  s_waitcnt lgkmcnt(0)
  s_nop 0
  v_mfma_f32_16x16x32_bf16 v[96:99], a[20:23], a[16:19], v[96:99]
  ds_read_b128 a[56:59], v13 offset:9216
  ds_read_b128 a[68:71], v12 offset:4096
  v_mfma_f32_16x16x32_bf16 v[128:131], a[24:27], a[16:19], v[128:131]
  ds_read_b128 a[72:75], v12 offset:6144
  ds_read_b128 a[60:63], v13 offset:9472
  v_mfma_f32_16x16x32_bf16 v[100:103], a[20:23], a[28:31], v[100:103]
  ds_read_b128 a[64:67], v13 offset:9728
  ds_read_b128 a[76:79], v13 offset:9984
  v_mfma_f32_16x16x32_bf16 v[132:135], a[24:27], a[28:31], v[132:135]
  v_cvt_pk_bf16_f32 v148, v82, v86
  v_cvt_pk_bf16_f32 v149, v90, v94
  v_mfma_f32_16x16x32_bf16 v[104:107], a[20:23], a[88:91], v[104:107]
  v_cvt_pk_bf16_f32 v150, v83, v87
  v_cvt_pk_bf16_f32 v151, v91, v95
  v_mfma_f32_16x16x32_bf16 v[136:139], a[24:27], a[88:91], v[136:139]
  v_cndmask_b32_dpp v158, v148, v150, vcc quad_perm:[1,0,3,2] row_mask:0xf bank_mask:0xf
  v_cndmask_b32_dpp v159, v149, v151, vcc quad_perm:[1,0,3,2] row_mask:0xf bank_mask:0xf
  v_mfma_f32_16x16x32_bf16 v[108:111], a[20:23], a[92:95], v[108:111]
  s_not_b64 vcc, vcc
  v_cndmask_b32_dpp v156, v150, v148, vcc quad_perm:[1,0,3,2] row_mask:0xf bank_mask:0xf
  s_nop 0
  v_mfma_f32_16x16x32_bf16 v[140:143], a[24:27], a[92:95], v[140:143]
  v_cndmask_b32_dpp v157, v151, v149, vcc quad_perm:[1,0,3,2] row_mask:0xf bank_mask:0xf
  buffer_store_dwordx4 v[156:159], v147, s[32:35], s54 offen offset:0 sc0 sc1
  v_mfma_f32_16x16x32_bf16 v[96:99], a[44:47], a[32:35], v[96:99]
  ds_read_b128 a[80:83], v146 offset:1024
  ds_read_b128 a[4:7], v144 offset:4096
  v_mfma_f32_16x16x32_bf16 v[128:131], a[48:51], a[32:35], v[128:131]
  ds_read_b128 a[8:11], v146 offset:1280
  ds_read_b128 a[84:87], v144 offset:6144
  v_mfma_f32_16x16x32_bf16 v[100:103], a[44:47], a[36:39], v[100:103]
  ds_read_b128 a[0:3], v146 offset:1536
  ds_read_b128 a[12:15], v146 offset:1792
  v_mfma_f32_16x16x32_bf16 v[132:135], a[48:51], a[36:39], v[132:135]
  v_cvt_pk_bf16_f32 v150, v113, v117
  v_cvt_pk_bf16_f32 v151, v121, v125
  v_mfma_f32_16x16x32_bf16 v[104:107], a[44:47], a[40:43], v[104:107]
  v_cvt_pk_bf16_f32 v148, v112, v116
  v_cvt_pk_bf16_f32 v149, v120, v124
  ds_read_b128 a[16:19], v146 offset:9216
  ds_read_b128 a[28:31], v145 offset:4096
  v_mfma_f32_16x16x32_bf16 v[136:139], a[48:51], a[40:43], v[136:139]
  v_cndmask_b32_dpp v152, v150, v148, vcc quad_perm:[1,0,3,2] row_mask:0xf bank_mask:0xf
  v_cndmask_b32_dpp v153, v151, v149, vcc quad_perm:[1,0,3,2] row_mask:0xf bank_mask:0xf
  ds_read_b128 a[88:91], v146 offset:9472
  ds_read_b128 a[20:23], v145 offset:6144
  v_mfma_f32_16x16x32_bf16 v[108:111], a[44:47], a[52:55], v[108:111]
  s_not_b64 vcc, vcc
  v_cndmask_b32_dpp v154, v148, v150, vcc quad_perm:[1,0,3,2] row_mask:0xf bank_mask:0xf
  ds_read_b128 a[24:27], v146 offset:9728
  ds_read_b128 a[92:95], v146 offset:9984
  s_nop 0
  v_mfma_f32_16x16x32_bf16 v[140:143], a[48:51], a[52:55], v[140:143]
  v_cndmask_b32_dpp v155, v149, v151, vcc quad_perm:[1,0,3,2] row_mask:0xf bank_mask:0xf
  buffer_store_dwordx4 v[152:155], v147, s[32:35], s56 offen offset:0 sc0 sc1
  s_waitcnt lgkmcnt(6)
  s_nop 0
  v_mfma_f32_16x16x32_bf16 v[96:99], a[68:71], a[56:59], v[96:99]
  v_mfma_f32_16x16x32_bf16 v[128:131], a[72:75], a[56:59], v[128:131]
  v_mfma_f32_16x16x32_bf16 v[100:103], a[68:71], a[60:63], v[100:103]
  v_mfma_f32_16x16x32_bf16 v[132:135], a[72:75], a[60:63], v[132:135]
  v_cvt_pk_bf16_f32 v148, v114, v118
  v_cvt_pk_bf16_f32 v149, v122, v126
  v_mfma_f32_16x16x32_bf16 v[104:107], a[68:71], a[64:67], v[104:107]
  v_cvt_pk_bf16_f32 v150, v115, v119
  v_cvt_pk_bf16_f32 v151, v123, v127
  v_mfma_f32_16x16x32_bf16 v[136:139], a[72:75], a[64:67], v[136:139]
  v_cndmask_b32_dpp v158, v148, v150, vcc quad_perm:[1,0,3,2] row_mask:0xf bank_mask:0xf
  v_cndmask_b32_dpp v159, v149, v151, vcc quad_perm:[1,0,3,2] row_mask:0xf bank_mask:0xf
  v_mfma_f32_16x16x32_bf16 v[108:111], a[68:71], a[76:79], v[108:111]
  s_not_b64 vcc, vcc
  v_cndmask_b32_dpp v156, v150, v148, vcc quad_perm:[1,0,3,2] row_mask:0xf bank_mask:0xf
  s_nop 0
  v_mfma_f32_16x16x32_bf16 v[140:143], a[72:75], a[76:79], v[140:143]
  v_cndmask_b32_dpp v157, v151, v149, vcc quad_perm:[1,0,3,2] row_mask:0xf bank_mask:0xf
  buffer_store_dwordx4 v[156:159], v147, s[32:35], s58 offen offset:0 sc0 sc1
  v_mfma_f32_16x16x32_bf16 v[96:99], a[4:7], a[80:83], v[96:99]
  v_mfma_f32_16x16x32_bf16 v[100:103], a[4:7], a[8:11], v[100:103]
  v_mfma_f32_16x16x32_bf16 v[104:107], a[4:7], a[0:3], v[104:107]
  v_mfma_f32_16x16x32_bf16 v[108:111], a[4:7], a[12:15], v[108:111]
  s_waitcnt lgkmcnt(0)
  s_nop 0
  v_mfma_f32_16x16x32_bf16 v[96:99], a[28:31], a[16:19], v[96:99]
  v_mfma_f32_16x16x32_bf16 v[100:103], a[28:31], a[88:91], v[100:103]
  v_mfma_f32_16x16x32_bf16 v[104:107], a[28:31], a[24:27], v[104:107]
  v_mfma_f32_16x16x32_bf16 v[108:111], a[28:31], a[92:95], v[108:111]
  v_mfma_f32_16x16x32_bf16 v[128:131], a[84:87], a[80:83], v[128:131]
  v_mfma_f32_16x16x32_bf16 v[132:135], a[84:87], a[8:11], v[132:135]
  v_mfma_f32_16x16x32_bf16 v[136:139], a[84:87], a[0:3], v[136:139]
  v_mfma_f32_16x16x32_bf16 v[140:143], a[84:87], a[12:15], v[140:143]
  v_cvt_pk_bf16_f32 v150, v97, v101
  v_cvt_pk_bf16_f32 v151, v105, v109
  v_mfma_f32_16x16x32_bf16 v[128:131], a[20:23], a[16:19], v[128:131]
  v_cvt_pk_bf16_f32 v148, v96, v100
  v_cvt_pk_bf16_f32 v149, v104, v108
  v_mfma_f32_16x16x32_bf16 v[132:135], a[20:23], a[88:91], v[132:135]
  v_cndmask_b32_dpp v152, v150, v148, vcc quad_perm:[1,0,3,2] row_mask:0xf bank_mask:0xf
  v_cndmask_b32_dpp v153, v151, v149, vcc quad_perm:[1,0,3,2] row_mask:0xf bank_mask:0xf
  v_mfma_f32_16x16x32_bf16 v[136:139], a[20:23], a[24:27], v[136:139]
  s_not_b64 vcc, vcc
  v_cndmask_b32_dpp v154, v148, v150, vcc quad_perm:[1,0,3,2] row_mask:0xf bank_mask:0xf
  s_nop 0
  v_mfma_f32_16x16x32_bf16 v[140:143], a[20:23], a[92:95], v[140:143]
  v_cndmask_b32_dpp v155, v149, v151, vcc quad_perm:[1,0,3,2] row_mask:0xf bank_mask:0xf
  buffer_store_dwordx4 v[152:155], v147, s[32:35], s52 offen offset:128 sc0 sc1
  s_nop 7
L_fin:
  v_cvt_pk_bf16_f32 v148, v98, v102
  v_cvt_pk_bf16_f32 v149, v106, v110
  v_cvt_pk_bf16_f32 v150, v99, v103
  v_cvt_pk_bf16_f32 v151, v107, v111
  v_cndmask_b32_dpp v158, v148, v150, vcc quad_perm:[1,0,3,2] row_mask:0xf bank_mask:0xf
  v_cndmask_b32_dpp v159, v149, v151, vcc quad_perm:[1,0,3,2] row_mask:0xf bank_mask:0xf
  s_not_b64 vcc, vcc
  v_cndmask_b32_dpp v156, v150, v148, vcc quad_perm:[1,0,3,2] row_mask:0xf bank_mask:0xf
  v_cndmask_b32_dpp v157, v151, v149, vcc quad_perm:[1,0,3,2] row_mask:0xf bank_mask:0xf
  buffer_store_dwordx4 v[156:159], v147, s[32:35], s54 offen offset:128 sc0 sc1
  v_cvt_pk_bf16_f32 v150, v129, v133
  v_cvt_pk_bf16_f32 v151, v137, v141
  v_cvt_pk_bf16_f32 v148, v128, v132
  v_cvt_pk_bf16_f32 v149, v136, v140
  v_cndmask_b32_dpp v152, v150, v148, vcc quad_perm:[1,0,3,2] row_mask:0xf bank_mask:0xf
  v_cndmask_b32_dpp v153, v151, v149, vcc quad_perm:[1,0,3,2] row_mask:0xf bank_mask:0xf
  s_not_b64 vcc, vcc
  v_cndmask_b32_dpp v154, v148, v150, vcc quad_perm:[1,0,3,2] row_mask:0xf bank_mask:0xf
  v_cndmask_b32_dpp v155, v149, v151, vcc quad_perm:[1,0,3,2] row_mask:0xf bank_mask:0xf
  buffer_store_dwordx4 v[152:155], v147, s[32:35], s56 offen offset:128 sc0 sc1
  v_cvt_pk_bf16_f32 v148, v130, v134
  v_cvt_pk_bf16_f32 v149, v138, v142
  v_cvt_pk_bf16_f32 v150, v131, v135
  v_cvt_pk_bf16_f32 v151, v139, v143
  v_cndmask_b32_dpp v158, v148, v150, vcc quad_perm:[1,0,3,2] row_mask:0xf bank_mask:0xf
  v_cndmask_b32_dpp v159, v149, v151, vcc quad_perm:[1,0,3,2] row_mask:0xf bank_mask:0xf
  s_not_b64 vcc, vcc
  v_cndmask_b32_dpp v156, v150, v148, vcc quad_perm:[1,0,3,2] row_mask:0xf bank_mask:0xf
  v_cndmask_b32_dpp v157, v151, v149, vcc quad_perm:[1,0,3,2] row_mask:0xf bank_mask:0xf
  buffer_store_dwordx4 v[156:159], v147, s[32:35], s58 offen offset:128 sc0 sc1
  s_endpgm
L_loader:
  s_add_u32 s58, s40, 2
  s_lshl_b32 s58, s58, 7
  s_load_dword s68, s[12:13], s58 offset:0
  s_load_dword s69, s[12:13], s58 offset:64
  s_load_dword s70, s[12:13], s58 offset:2048
  s_load_dword s71, s[12:13], s58 offset:2112
  s_load_dword s72, s[12:13], s58 offset:4096
  s_load_dword s73, s[12:13], s58 offset:4160
  s_waitcnt vmcnt(0)
  s_mov_b64 exec, 1
  buffer_store_dwordx2 v[10:11], v14, s[28:31], 0 offen sc1
  s_mov_b64 exec, -1
  s_barrier
  s_add_u32 s43, s40, 0
  s_lshl_b32 s43, s43, 9
  s_load_dwordx4 s[64:67], s[4:5], s43 glc
  s_add_u32 s41, s40, 0
  s_lshl_b32 s41, s41, 7
  s_add_u32 m0, s60, 49152
  s_nop 0
  buffer_load_dwordx4 v16, s[16:19], s41 offen offset:0  lds
  buffer_load_dwordx4 v17, s[16:19], s41 offen offset:1024  lds
  buffer_load_dwordx4 v18, s[16:19], s41 offen offset:2048  lds
  buffer_load_dwordx4 v19, s[16:19], s41 offen offset:3072  lds
  s_add_u32 m0, s60, 53248
  s_add_u32 s41, s41, 65536
  buffer_load_dwordx4 v16, s[16:19], s41 offen offset:0  lds
  buffer_load_dwordx4 v17, s[16:19], s41 offen offset:1024  lds
  buffer_load_dwordx4 v18, s[16:19], s41 offen offset:2048  lds
  buffer_load_dwordx4 v19, s[16:19], s41 offen offset:3072  lds
  s_mov_b32 s63, 0
L_sp1:
  s_waitcnt lgkmcnt(0)
  s_xor_b64 s[10:11], s[64:65], s[8:9]
  s_xor_b64 s[14:15], s[66:67], s[8:9]
  s_or_b64 s[10:11], s[10:11], s[14:15]
  s_cbranch_scc0 L_ok1
  s_load_dwordx4 s[64:67], s[4:5], s43 glc
  s_add_u32 s63, s63, 1
  s_cmp_lt_u32 s63, 20000
  s_cbranch_scc1 L_sp1
  s_waitcnt lgkmcnt(0)
L_ok1:
  s_add_u32 s43, s40, 1
  s_lshl_b32 s43, s43, 9
  s_load_dwordx4 s[64:67], s[4:5], s43 glc
  s_add_u32 m0, s61, 49152
  s_add_u32 s62, s40, 0
  s_lshl_b32 s62, s62, 14
  buffer_load_dwordx4 v20, s[28:31], s62 offen offset:0 sc1 lds
  buffer_load_dwordx4 v20, s[28:31], s62 offen offset:1024 sc1 lds
  buffer_load_dwordx4 v20, s[28:31], s62 offen offset:2048 sc1 lds
  buffer_load_dwordx4 v20, s[28:31], s62 offen offset:3072 sc1 lds
  s_add_u32 s41, s40, 1
  s_lshl_b32 s41, s41, 7
  s_add_u32 m0, s60, 98304
  s_nop 0
  buffer_load_dwordx4 v16, s[16:19], s41 offen offset:0  lds
  buffer_load_dwordx4 v17, s[16:19], s41 offen offset:1024  lds
  buffer_load_dwordx4 v18, s[16:19], s41 offen offset:2048  lds
  buffer_load_dwordx4 v19, s[16:19], s41 offen offset:3072  lds
  s_add_u32 m0, s60, 102400
  s_add_u32 s41, s41, 65536
  buffer_load_dwordx4 v16, s[16:19], s41 offen offset:0  lds
  buffer_load_dwordx4 v17, s[16:19], s41 offen offset:1024  lds
  buffer_load_dwordx4 v18, s[16:19], s41 offen offset:2048  lds
  buffer_load_dwordx4 v19, s[16:19], s41 offen offset:3072  lds
  s_mov_b32 s63, 0
L_sp2:
  s_waitcnt lgkmcnt(0)
  s_xor_b64 s[10:11], s[64:65], s[8:9]
  s_xor_b64 s[14:15], s[66:67], s[8:9]
  s_or_b64 s[10:11], s[10:11], s[14:15]
  s_cbranch_scc0 L_ok2
  s_load_dwordx4 s[64:67], s[4:5], s43 glc
  s_add_u32 s63, s63, 1
  s_cmp_lt_u32 s63, 20000
  s_cbranch_scc1 L_sp2
  s_waitcnt lgkmcnt(0)
L_ok2:
  s_add_u32 s43, s40, 2
  s_lshl_b32 s43, s43, 9
  s_load_dwordx4 s[64:67], s[4:5], s43 glc
  s_add_u32 s58, s40, 3
  s_lshl_b32 s58, s58, 7
  s_load_dword s68, s[12:13], s58 offset:0
  s_load_dword s69, s[12:13], s58 offset:64
  s_load_dword s70, s[12:13], s58 offset:2048
  s_load_dword s71, s[12:13], s58 offset:2112
  s_load_dword s72, s[12:13], s58 offset:4096
  s_load_dword s73, s[12:13], s58 offset:4160
  s_add_u32 m0, s61, 98304
  s_add_u32 s62, s40, 1
  s_lshl_b32 s62, s62, 14
  buffer_load_dwordx4 v20, s[28:31], s62 offen offset:0 sc1 lds
  buffer_load_dwordx4 v20, s[28:31], s62 offen offset:1024 sc1 lds
  buffer_load_dwordx4 v20, s[28:31], s62 offen offset:2048 sc1 lds
  buffer_load_dwordx4 v20, s[28:31], s62 offen offset:3072 sc1 lds
  s_waitcnt vmcnt(12)
  s_barrier
  s_add_u32 s41, s40, 2
  s_lshl_b32 s41, s41, 7
  s_add_u32 m0, s60, 0
  s_nop 0
  buffer_load_dwordx4 v16, s[16:19], s41 offen offset:0  lds
  buffer_load_dwordx4 v17, s[16:19], s41 offen offset:1024  lds
  buffer_load_dwordx4 v18, s[16:19], s41 offen offset:2048  lds
  buffer_load_dwordx4 v19, s[16:19], s41 offen offset:3072  lds
  s_add_u32 m0, s60, 4096
  s_add_u32 s41, s41, 65536
  buffer_load_dwordx4 v16, s[16:19], s41 offen offset:0  lds
  buffer_load_dwordx4 v17, s[16:19], s41 offen offset:1024  lds
  buffer_load_dwordx4 v18, s[16:19], s41 offen offset:2048  lds
  buffer_load_dwordx4 v19, s[16:19], s41 offen offset:3072  lds
  s_mov_b32 s63, 0
L_sp3:
  s_waitcnt lgkmcnt(0)
  s_xor_b64 s[10:11], s[64:65], s[8:9]
  s_xor_b64 s[14:15], s[66:67], s[8:9]
  s_or_b64 s[10:11], s[10:11], s[14:15]
  s_cbranch_scc0 L_ok3
  s_load_dwordx4 s[64:67], s[4:5], s43 glc
  s_add_u32 s63, s63, 1
  s_cmp_lt_u32 s63, 20000
  s_cbranch_scc1 L_sp3
  s_waitcnt lgkmcnt(0)
L_ok3:
  s_add_u32 s43, s40, 3
  s_lshl_b32 s43, s43, 9
  s_load_dwordx4 s[64:67], s[4:5], s43 glc
  s_xor_b32 s58, s40, 4
  s_cmp_ge_u32 s58, s36
  s_addc_u32 s58, s58, 0
  s_lshl_b32 s58, s58, 7
  s_load_dword s68, s[12:13], s58 offset:0
  s_load_dword s69, s[12:13], s58 offset:64
  s_load_dword s70, s[12:13], s58 offset:2048
  s_load_dword s71, s[12:13], s58 offset:2112
  s_load_dword s72, s[12:13], s58 offset:4096
  s_load_dword s73, s[12:13], s58 offset:4160
  s_add_u32 m0, s61, 0
  s_add_u32 s62, s40, 2
  s_lshl_b32 s62, s62, 14
  buffer_load_dwordx4 v20, s[28:31], s62 offen offset:0 sc1 lds
  buffer_load_dwordx4 v20, s[28:31], s62 offen offset:1024 sc1 lds
  buffer_load_dwordx4 v20, s[28:31], s62 offen offset:2048 sc1 lds
  buffer_load_dwordx4 v20, s[28:31], s62 offen offset:3072 sc1 lds
  s_waitcnt vmcnt(12)
  s_barrier
  s_add_u32 s41, s40, 3
  s_lshl_b32 s41, s41, 7
  s_add_u32 m0, s60, 49152
  s_nop 0
  buffer_load_dwordx4 v16, s[16:19], s41 offen offset:0  lds
  buffer_load_dwordx4 v17, s[16:19], s41 offen offset:1024  lds
  buffer_load_dwordx4 v18, s[16:19], s41 offen offset:2048  lds
  buffer_load_dwordx4 v19, s[16:19], s41 offen offset:3072  lds
  s_add_u32 m0, s60, 53248
  s_add_u32 s41, s41, 65536
  buffer_load_dwordx4 v16, s[16:19], s41 offen offset:0  lds
  buffer_load_dwordx4 v17, s[16:19], s41 offen offset:1024  lds
  buffer_load_dwordx4 v18, s[16:19], s41 offen offset:2048  lds
  buffer_load_dwordx4 v19, s[16:19], s41 offen offset:3072  lds
  s_mov_b32 s63, 0
L_sp4:
  s_waitcnt lgkmcnt(0)
  s_xor_b64 s[10:11], s[64:65], s[8:9]
  s_xor_b64 s[14:15], s[66:67], s[8:9]
  s_or_b64 s[10:11], s[10:11], s[14:15]
  s_cbranch_scc0 L_ok4
  s_load_dwordx4 s[64:67], s[4:5], s43 glc
  s_add_u32 s63, s63, 1
  s_cmp_lt_u32 s63, 20000
  s_cbranch_scc1 L_sp4
  s_waitcnt lgkmcnt(0)
L_ok4:
  s_xor_b32 s43, s40, 4
  s_cmp_ge_u32 s43, s36
  s_addc_u32 s43, s43, 0
  s_lshl_b32 s43, s43, 9
  s_load_dwordx4 s[64:67], s[4:5], s43 glc
  s_xor_b32 s58, s40, 5
  s_cmp_ge_u32 s58, s36
  s_addc_u32 s58, s58, 0
  s_lshl_b32 s58, s58, 7
  s_load_dword s68, s[12:13], s58 offset:0
  s_load_dword s69, s[12:13], s58 offset:64
  s_load_dword s70, s[12:13], s58 offset:2048
  s_load_dword s71, s[12:13], s58 offset:2112
  s_load_dword s72, s[12:13], s58 offset:4096
  s_load_dword s73, s[12:13], s58 offset:4160
  s_xor_b32 s58, s40, 6
  s_cmp_ge_u32 s58, s36
  s_addc_u32 s58, s58, 0
  s_lshl_b32 s58, s58, 7
  s_load_dword s68, s[12:13], s58 offset:0
  s_load_dword s69, s[12:13], s58 offset:64
  s_load_dword s70, s[12:13], s58 offset:2048
  s_load_dword s71, s[12:13], s58 offset:2112
  s_load_dword s72, s[12:13], s58 offset:4096
  s_load_dword s73, s[12:13], s58 offset:4160
  s_add_u32 m0, s61, 49152
  s_add_u32 s62, s40, 3
  s_lshl_b32 s62, s62, 14
  buffer_load_dwordx4 v20, s[28:31], s62 offen offset:0 sc1 lds
  buffer_load_dwordx4 v20, s[28:31], s62 offen offset:1024 sc1 lds
  buffer_load_dwordx4 v20, s[28:31], s62 offen offset:2048 sc1 lds
  buffer_load_dwordx4 v20, s[28:31], s62 offen offset:3072 sc1 lds
  s_waitcnt vmcnt(12)
  s_barrier
  s_xor_b32 s41, s40, 4
  s_cmp_ge_u32 s41, s36
  s_addc_u32 s41, s41, 0
  s_lshl_b32 s41, s41, 7
  s_add_u32 m0, s60, 98304
  s_nop 0
  buffer_load_dwordx4 v16, s[16:19], s41 offen offset:0  lds
  buffer_load_dwordx4 v17, s[16:19], s41 offen offset:1024  lds
  buffer_load_dwordx4 v18, s[16:19], s41 offen offset:2048  lds
  buffer_load_dwordx4 v19, s[16:19], s41 offen offset:3072  lds
  s_add_u32 m0, s60, 102400
  s_add_u32 s41, s41, 65536
  buffer_load_dwordx4 v16, s[16:19], s41 offen offset:0  lds
  buffer_load_dwordx4 v17, s[16:19], s41 offen offset:1024  lds
  buffer_load_dwordx4 v18, s[16:19], s41 offen offset:2048  lds
  buffer_load_dwordx4 v19, s[16:19], s41 offen offset:3072  lds
  s_mov_b32 s63, 0
L_sp5:
  s_waitcnt lgkmcnt(0)
  s_xor_b64 s[10:11], s[64:65], s[8:9]
  s_xor_b64 s[14:15], s[66:67], s[8:9]
  s_or_b64 s[10:11], s[10:11], s[14:15]
  s_cbranch_scc0 L_ok5
  s_load_dwordx4 s[64:67], s[4:5], s43 glc
  s_add_u32 s63, s63, 1
  s_cmp_lt_u32 s63, 20000
  s_cbranch_scc1 L_sp5
  s_waitcnt lgkmcnt(0)
L_ok5:
  s_xor_b32 s43, s40, 5
  s_cmp_ge_u32 s43, s36
  s_addc_u32 s43, s43, 0
  s_lshl_b32 s43, s43, 9
  s_load_dwordx4 s[64:67], s[4:5], s43 glc
  s_mov_b32 s58, 1024
  s_load_dword s68, s[12:13], s58 offset:0
  s_load_dword s69, s[12:13], s58 offset:64
  s_load_dword s70, s[12:13], s58 offset:2048
  s_load_dword s71, s[12:13], s58 offset:2112
  s_load_dword s72, s[12:13], s58 offset:4096
  s_load_dword s73, s[12:13], s58 offset:4160
  s_mov_b32 s58, 1152
  s_load_dword s68, s[12:13], s58 offset:0
  s_load_dword s69, s[12:13], s58 offset:64
  s_load_dword s70, s[12:13], s58 offset:2048
  s_load_dword s71, s[12:13], s58 offset:2112
  s_load_dword s72, s[12:13], s58 offset:4096
  s_load_dword s73, s[12:13], s58 offset:4160
  s_add_u32 m0, s61, 98304
  s_xor_b32 s62, s40, 4
  s_cmp_ge_u32 s62, s36
  s_addc_u32 s62, s62, 0
  s_lshl_b32 s62, s62, 14
  buffer_load_dwordx4 v20, s[28:31], s62 offen offset:0 sc1 lds
  buffer_load_dwordx4 v20, s[28:31], s62 offen offset:1024 sc1 lds
  buffer_load_dwordx4 v20, s[28:31], s62 offen offset:2048 sc1 lds
  buffer_load_dwordx4 v20, s[28:31], s62 offen offset:3072 sc1 lds
  s_waitcnt vmcnt(12)
  s_barrier
  s_xor_b32 s41, s40, 5
  s_cmp_ge_u32 s41, s36
  s_addc_u32 s41, s41, 0
  s_lshl_b32 s41, s41, 7
  s_add_u32 m0, s60, 0
  s_nop 0
  buffer_load_dwordx4 v16, s[16:19], s41 offen offset:0  lds
  buffer_load_dwordx4 v17, s[16:19], s41 offen offset:1024  lds
  buffer_load_dwordx4 v18, s[16:19], s41 offen offset:2048  lds
  buffer_load_dwordx4 v19, s[16:19], s41 offen offset:3072  lds
  s_add_u32 m0, s60, 4096
  s_add_u32 s41, s41, 65536
  buffer_load_dwordx4 v16, s[16:19], s41 offen offset:0  lds
  buffer_load_dwordx4 v17, s[16:19], s41 offen offset:1024  lds
  buffer_load_dwordx4 v18, s[16:19], s41 offen offset:2048  lds
  buffer_load_dwordx4 v19, s[16:19], s41 offen offset:3072  lds
  s_mov_b32 s63, 0
L_sp6:
  s_waitcnt lgkmcnt(0)
  s_xor_b64 s[10:11], s[64:65], s[8:9]
  s_xor_b64 s[14:15], s[66:67], s[8:9]
  s_or_b64 s[10:11], s[10:11], s[14:15]
  s_cbranch_scc0 L_ok6
  s_load_dwordx4 s[64:67], s[4:5], s43 glc
  s_add_u32 s63, s63, 1
  s_cmp_lt_u32 s63, 20000
  s_cbranch_scc1 L_sp6
  s_waitcnt lgkmcnt(0)
L_ok6:
  s_xor_b32 s43, s40, 6
  s_cmp_ge_u32 s43, s36
  s_addc_u32 s43, s43, 0
  s_lshl_b32 s43, s43, 9
  s_load_dwordx4 s[64:67], s[4:5], s43 glc
  s_mov_b32 s58, 1280
  s_load_dword s68, s[12:13], s58 offset:0
  s_load_dword s69, s[12:13], s58 offset:64
  s_load_dword s70, s[12:13], s58 offset:2048
  s_load_dword s71, s[12:13], s58 offset:2112
  s_load_dword s72, s[12:13], s58 offset:4096
  s_load_dword s73, s[12:13], s58 offset:4160
  s_add_u32 m0, s61, 0
  s_xor_b32 s62, s40, 5
  s_cmp_ge_u32 s62, s36
  s_addc_u32 s62, s62, 0
  s_lshl_b32 s62, s62, 14
  buffer_load_dwordx4 v20, s[28:31], s62 offen offset:0 sc1 lds
  buffer_load_dwordx4 v20, s[28:31], s62 offen offset:1024 sc1 lds
  buffer_load_dwordx4 v20, s[28:31], s62 offen offset:2048 sc1 lds
  buffer_load_dwordx4 v20, s[28:31], s62 offen offset:3072 sc1 lds
  s_waitcnt vmcnt(12)
  s_barrier
  s_xor_b32 s41, s40, 6
  s_cmp_ge_u32 s41, s36
  s_addc_u32 s41, s41, 0
  s_lshl_b32 s41, s41, 7
  s_add_u32 m0, s60, 49152
  s_nop 0
  buffer_load_dwordx4 v16, s[16:19], s41 offen offset:0  lds
  buffer_load_dwordx4 v17, s[16:19], s41 offen offset:1024  lds
  buffer_load_dwordx4 v18, s[16:19], s41 offen offset:2048  lds
  buffer_load_dwordx4 v19, s[16:19], s41 offen offset:3072  lds
  s_add_u32 m0, s60, 53248
  s_add_u32 s41, s41, 65536
  buffer_load_dwordx4 v16, s[16:19], s41 offen offset:0  lds
  buffer_load_dwordx4 v17, s[16:19], s41 offen offset:1024  lds
  buffer_load_dwordx4 v18, s[16:19], s41 offen offset:2048  lds
  buffer_load_dwordx4 v19, s[16:19], s41 offen offset:3072  lds
  s_mov_b32 s63, 0
L_sp7:
  s_waitcnt lgkmcnt(0)
  s_xor_b64 s[10:11], s[64:65], s[8:9]
  s_xor_b64 s[14:15], s[66:67], s[8:9]
  s_or_b64 s[10:11], s[10:11], s[14:15]
  s_cbranch_scc0 L_ok7
  s_load_dwordx4 s[64:67], s[4:5], s43 glc
  s_add_u32 s63, s63, 1
  s_cmp_lt_u32 s63, 20000
  s_cbranch_scc1 L_sp7
  s_waitcnt lgkmcnt(0)
L_ok7:
  s_mov_b32 s43, 4096
  s_load_dwordx4 s[64:67], s[4:5], s43 glc
  s_mov_b32 s58, 1408
  s_load_dword s68, s[12:13], s58 offset:0
  s_load_dword s69, s[12:13], s58 offset:64
  s_load_dword s70, s[12:13], s58 offset:2048
  s_load_dword s71, s[12:13], s58 offset:2112
  s_load_dword s72, s[12:13], s58 offset:4096
  s_load_dword s73, s[12:13], s58 offset:4160
  s_add_u32 m0, s61, 49152
  s_xor_b32 s62, s40, 6
  s_cmp_ge_u32 s62, s36
  s_addc_u32 s62, s62, 0
  s_lshl_b32 s62, s62, 14
  buffer_load_dwordx4 v20, s[28:31], s62 offen offset:0 sc1 lds
  buffer_load_dwordx4 v20, s[28:31], s62 offen offset:1024 sc1 lds
  buffer_load_dwordx4 v20, s[28:31], s62 offen offset:2048 sc1 lds
  buffer_load_dwordx4 v20, s[28:31], s62 offen offset:3072 sc1 lds
  s_waitcnt vmcnt(12)
  s_barrier
  s_mov_b32 s41, 1024
  s_add_u32 m0, s60, 98304
  s_nop 0
  buffer_load_dwordx4 v16, s[16:19], s41 offen offset:0  lds
  buffer_load_dwordx4 v17, s[16:19], s41 offen offset:1024  lds
  buffer_load_dwordx4 v18, s[16:19], s41 offen offset:2048  lds
  buffer_load_dwordx4 v19, s[16:19], s41 offen offset:3072  lds
  s_add_u32 m0, s60, 102400
  s_add_u32 s41, s41, 65536
  buffer_load_dwordx4 v16, s[16:19], s41 offen offset:0  lds
  buffer_load_dwordx4 v17, s[16:19], s41 offen offset:1024  lds
  buffer_load_dwordx4 v18, s[16:19], s41 offen offset:2048  lds
  buffer_load_dwordx4 v19, s[16:19], s41 offen offset:3072  lds
  s_mov_b32 s63, 0
L_sp8:
  s_waitcnt lgkmcnt(0)
  s_xor_b64 s[10:11], s[64:65], s[8:9]
  s_xor_b64 s[14:15], s[66:67], s[8:9]
  s_or_b64 s[10:11], s[10:11], s[14:15]
  s_cbranch_scc0 L_ok8
  s_load_dwordx4 s[64:67], s[4:5], s43 glc
  s_add_u32 s63, s63, 1
  s_cmp_lt_u32 s63, 20000
  s_cbranch_scc1 L_sp8
  s_waitcnt lgkmcnt(0)
L_ok8:
  s_mov_b32 s43, 4608
  s_load_dwordx4 s[64:67], s[4:5], s43 glc
  s_mov_b32 s58, 1536
  s_load_dword s68, s[12:13], s58 offset:0
  s_load_dword s69, s[12:13], s58 offset:64
  s_load_dword s70, s[12:13], s58 offset:2048
  s_load_dword s71, s[12:13], s58 offset:2112
  s_load_dword s72, s[12:13], s58 offset:4096
  s_load_dword s73, s[12:13], s58 offset:4160
  s_add_u32 m0, s61, 98304
  s_mov_b32 s62, 131072
  buffer_load_dwordx4 v20, s[28:31], s62 offen offset:0 sc1 lds
  buffer_load_dwordx4 v20, s[28:31], s62 offen offset:1024 sc1 lds
  buffer_load_dwordx4 v20, s[28:31], s62 offen offset:2048 sc1 lds
  buffer_load_dwordx4 v20, s[28:31], s62 offen offset:3072 sc1 lds
  s_waitcnt vmcnt(12)
  s_barrier
  s_mov_b32 s41, 1152
  s_add_u32 m0, s60, 0
  s_nop 0
  buffer_load_dwordx4 v16, s[16:19], s41 offen offset:0  lds
  buffer_load_dwordx4 v17, s[16:19], s41 offen offset:1024  lds
  buffer_load_dwordx4 v18, s[16:19], s41 offen offset:2048  lds
  buffer_load_dwordx4 v19, s[16:19], s41 offen offset:3072  lds
  s_add_u32 m0, s60, 4096
  s_add_u32 s41, s41, 65536
  buffer_load_dwordx4 v16, s[16:19], s41 offen offset:0  lds
  buffer_load_dwordx4 v17, s[16:19], s41 offen offset:1024  lds
  buffer_load_dwordx4 v18, s[16:19], s41 offen offset:2048  lds
  buffer_load_dwordx4 v19, s[16:19], s41 offen offset:3072  lds
  s_mov_b32 s63, 0
L_sp9:
  s_waitcnt lgkmcnt(0)
  s_xor_b64 s[10:11], s[64:65], s[8:9]
  s_xor_b64 s[14:15], s[66:67], s[8:9]
  s_or_b64 s[10:11], s[10:11], s[14:15]
  s_cbranch_scc0 L_ok9
  s_load_dwordx4 s[64:67], s[4:5], s43 glc
  s_add_u32 s63, s63, 1
  s_cmp_lt_u32 s63, 20000
  s_cbranch_scc1 L_sp9
  s_waitcnt lgkmcnt(0)
L_ok9:
  s_mov_b32 s43, 5120
  s_load_dwordx4 s[64:67], s[4:5], s43 glc
  s_mov_b32 s58, 1664
  s_load_dword s68, s[12:13], s58 offset:0
  s_load_dword s69, s[12:13], s58 offset:64
  s_load_dword s70, s[12:13], s58 offset:2048
  s_load_dword s71, s[12:13], s58 offset:2112
  s_load_dword s72, s[12:13], s58 offset:4096
  s_load_dword s73, s[12:13], s58 offset:4160
  s_add_u32 m0, s61, 0
  s_mov_b32 s62, 147456
  buffer_load_dwordx4 v20, s[28:31], s62 offen offset:0 sc1 lds
  buffer_load_dwordx4 v20, s[28:31], s62 offen offset:1024 sc1 lds
  buffer_load_dwordx4 v20, s[28:31], s62 offen offset:2048 sc1 lds
  buffer_load_dwordx4 v20, s[28:31], s62 offen offset:3072 sc1 lds
  s_waitcnt vmcnt(12)
  s_barrier
  s_mov_b32 s41, 1280
  s_add_u32 m0, s60, 49152
  s_nop 0
  buffer_load_dwordx4 v16, s[16:19], s41 offen offset:0  lds
  buffer_load_dwordx4 v17, s[16:19], s41 offen offset:1024  lds
  buffer_load_dwordx4 v18, s[16:19], s41 offen offset:2048  lds
  buffer_load_dwordx4 v19, s[16:19], s41 offen offset:3072  lds
  s_add_u32 m0, s60, 53248
  s_add_u32 s41, s41, 65536
  buffer_load_dwordx4 v16, s[16:19], s41 offen offset:0  lds
  buffer_load_dwordx4 v17, s[16:19], s41 offen offset:1024  lds
  buffer_load_dwordx4 v18, s[16:19], s41 offen offset:2048  lds
  buffer_load_dwordx4 v19, s[16:19], s41 offen offset:3072  lds
  s_mov_b32 s63, 0
L_sp10:
  s_waitcnt lgkmcnt(0)
  s_xor_b64 s[10:11], s[64:65], s[8:9]
  s_xor_b64 s[14:15], s[66:67], s[8:9]
  s_or_b64 s[10:11], s[10:11], s[14:15]
  s_cbranch_scc0 L_ok10
  s_load_dwordx4 s[64:67], s[4:5], s43 glc
  s_add_u32 s63, s63, 1
  s_cmp_lt_u32 s63, 20000
  s_cbranch_scc1 L_sp10
  s_waitcnt lgkmcnt(0)
L_ok10:
  s_mov_b32 s43, 5632
  s_load_dwordx4 s[64:67], s[4:5], s43 glc
  s_mov_b32 s58, 1792
  s_load_dword s68, s[12:13], s58 offset:0
  s_load_dword s69, s[12:13], s58 offset:64
  s_load_dword s70, s[12:13], s58 offset:2048
  s_load_dword s71, s[12:13], s58 offset:2112
  s_load_dword s72, s[12:13], s58 offset:4096
  s_load_dword s73, s[12:13], s58 offset:4160
  s_add_u32 m0, s61, 49152
  s_mov_b32 s62, 163840
  buffer_load_dwordx4 v20, s[28:31], s62 offen offset:0 sc1 lds
  buffer_load_dwordx4 v20, s[28:31], s62 offen offset:1024 sc1 lds
  buffer_load_dwordx4 v20, s[28:31], s62 offen offset:2048 sc1 lds
  buffer_load_dwordx4 v20, s[28:31], s62 offen offset:3072 sc1 lds
  s_waitcnt vmcnt(12)
  s_barrier
  s_mov_b32 s41, 1408
  s_add_u32 m0, s60, 98304
  s_nop 0
  buffer_load_dwordx4 v16, s[16:19], s41 offen offset:0  lds
  buffer_load_dwordx4 v17, s[16:19], s41 offen offset:1024  lds
  buffer_load_dwordx4 v18, s[16:19], s41 offen offset:2048  lds
  buffer_load_dwordx4 v19, s[16:19], s41 offen offset:3072  lds
  s_add_u32 m0, s60, 102400
  s_add_u32 s41, s41, 65536
  buffer_load_dwordx4 v16, s[16:19], s41 offen offset:0  lds
  buffer_load_dwordx4 v17, s[16:19], s41 offen offset:1024  lds
  buffer_load_dwordx4 v18, s[16:19], s41 offen offset:2048  lds
  buffer_load_dwordx4 v19, s[16:19], s41 offen offset:3072  lds
  s_mov_b32 s63, 0
L_sp11:
  s_waitcnt lgkmcnt(0)
  s_xor_b64 s[10:11], s[64:65], s[8:9]
  s_xor_b64 s[14:15], s[66:67], s[8:9]
  s_or_b64 s[10:11], s[10:11], s[14:15]
  s_cbranch_scc0 L_ok11
  s_load_dwordx4 s[64:67], s[4:5], s43 glc
  s_add_u32 s63, s63, 1
  s_cmp_lt_u32 s63, 20000
  s_cbranch_scc1 L_sp11
  s_waitcnt lgkmcnt(0)
L_ok11:
  s_mov_b32 s43, 6144
  s_load_dwordx4 s[64:67], s[4:5], s43 glc
  s_mov_b32 s58, 1920
  s_load_dword s68, s[12:13], s58 offset:0
  s_load_dword s69, s[12:13], s58 offset:64
  s_load_dword s70, s[12:13], s58 offset:2048
  s_load_dword s71, s[12:13], s58 offset:2112
  s_load_dword s72, s[12:13], s58 offset:4096
  s_load_dword s73, s[12:13], s58 offset:4160
  s_add_u32 m0, s61, 98304
  s_mov_b32 s62, 180224
  buffer_load_dwordx4 v20, s[28:31], s62 offen offset:0 sc1 lds
  buffer_load_dwordx4 v20, s[28:31], s62 offen offset:1024 sc1 lds
  buffer_load_dwordx4 v20, s[28:31], s62 offen offset:2048 sc1 lds
  buffer_load_dwordx4 v20, s[28:31], s62 offen offset:3072 sc1 lds
  s_waitcnt vmcnt(12)
  s_barrier
  s_mov_b32 s41, 1536
  s_add_u32 m0, s60, 0
  s_nop 0
  buffer_load_dwordx4 v16, s[16:19], s41 offen offset:0  lds
  buffer_load_dwordx4 v17, s[16:19], s41 offen offset:1024  lds
  buffer_load_dwordx4 v18, s[16:19], s41 offen offset:2048  lds
  buffer_load_dwordx4 v19, s[16:19], s41 offen offset:3072  lds
  s_add_u32 m0, s60, 4096
  s_add_u32 s41, s41, 65536
  buffer_load_dwordx4 v16, s[16:19], s41 offen offset:0  lds
  buffer_load_dwordx4 v17, s[16:19], s41 offen offset:1024  lds
  buffer_load_dwordx4 v18, s[16:19], s41 offen offset:2048  lds
  buffer_load_dwordx4 v19, s[16:19], s41 offen offset:3072  lds
  s_mov_b32 s63, 0
L_sp12:
  s_waitcnt lgkmcnt(0)
  s_xor_b64 s[10:11], s[64:65], s[8:9]
  s_xor_b64 s[14:15], s[66:67], s[8:9]
  s_or_b64 s[10:11], s[10:11], s[14:15]
  s_cbranch_scc0 L_ok12
  s_load_dwordx4 s[64:67], s[4:5], s43 glc
  s_add_u32 s63, s63, 1
  s_cmp_lt_u32 s63, 20000
  s_cbranch_scc1 L_sp12
  s_waitcnt lgkmcnt(0)
L_ok12:
  s_mov_b32 s43, 6656
  s_load_dwordx4 s[64:67], s[4:5], s43 glc
  s_add_u32 m0, s61, 0
  s_mov_b32 s62, 196608
  buffer_load_dwordx4 v20, s[28:31], s62 offen offset:0 sc1 lds
  buffer_load_dwordx4 v20, s[28:31], s62 offen offset:1024 sc1 lds
  buffer_load_dwordx4 v20, s[28:31], s62 offen offset:2048 sc1 lds
  buffer_load_dwordx4 v20, s[28:31], s62 offen offset:3072 sc1 lds
  s_waitcnt vmcnt(12)
  s_barrier
  s_mov_b32 s41, 1664
  s_add_u32 m0, s60, 49152
  s_nop 0
  buffer_load_dwordx4 v16, s[16:19], s41 offen offset:0  lds
  buffer_load_dwordx4 v17, s[16:19], s41 offen offset:1024  lds
  buffer_load_dwordx4 v18, s[16:19], s41 offen offset:2048  lds
  buffer_load_dwordx4 v19, s[16:19], s41 offen offset:3072  lds
  s_add_u32 m0, s60, 53248
  s_add_u32 s41, s41, 65536
  buffer_load_dwordx4 v16, s[16:19], s41 offen offset:0  lds
  buffer_load_dwordx4 v17, s[16:19], s41 offen offset:1024  lds
  buffer_load_dwordx4 v18, s[16:19], s41 offen offset:2048  lds
  buffer_load_dwordx4 v19, s[16:19], s41 offen offset:3072  lds
  s_mov_b32 s63, 0
L_sp13:
  s_waitcnt lgkmcnt(0)
  s_xor_b64 s[10:11], s[64:65], s[8:9]
  s_xor_b64 s[14:15], s[66:67], s[8:9]
  s_or_b64 s[10:11], s[10:11], s[14:15]
  s_cbranch_scc0 L_ok13
  s_load_dwordx4 s[64:67], s[4:5], s43 glc
  s_add_u32 s63, s63, 1
  s_cmp_lt_u32 s63, 20000
  s_cbranch_scc1 L_sp13
  s_waitcnt lgkmcnt(0)
L_ok13:
  s_mov_b32 s43, 7168
  s_load_dwordx4 s[64:67], s[4:5], s43 glc
  s_add_u32 m0, s61, 49152
  s_mov_b32 s62, 212992
  buffer_load_dwordx4 v20, s[28:31], s62 offen offset:0 sc1 lds
  buffer_load_dwordx4 v20, s[28:31], s62 offen offset:1024 sc1 lds
  buffer_load_dwordx4 v20, s[28:31], s62 offen offset:2048 sc1 lds
  buffer_load_dwordx4 v20, s[28:31], s62 offen offset:3072 sc1 lds
  s_waitcnt vmcnt(12)
  s_barrier
  s_mov_b32 s41, 1792
  s_add_u32 m0, s60, 98304
  s_nop 0
  buffer_load_dwordx4 v16, s[16:19], s41 offen offset:0  lds
  buffer_load_dwordx4 v17, s[16:19], s41 offen offset:1024  lds
  buffer_load_dwordx4 v18, s[16:19], s41 offen offset:2048  lds
  buffer_load_dwordx4 v19, s[16:19], s41 offen offset:3072  lds
  s_add_u32 m0, s60, 102400
  s_add_u32 s41, s41, 65536
  buffer_load_dwordx4 v16, s[16:19], s41 offen offset:0  lds
  buffer_load_dwordx4 v17, s[16:19], s41 offen offset:1024  lds
  buffer_load_dwordx4 v18, s[16:19], s41 offen offset:2048  lds
  buffer_load_dwordx4 v19, s[16:19], s41 offen offset:3072  lds
  s_mov_b32 s63, 0
L_sp14:
  s_waitcnt lgkmcnt(0)
  s_xor_b64 s[10:11], s[64:65], s[8:9]
  s_xor_b64 s[14:15], s[66:67], s[8:9]
  s_or_b64 s[10:11], s[10:11], s[14:15]
  s_cbranch_scc0 L_ok14
  s_load_dwordx4 s[64:67], s[4:5], s43 glc
  s_add_u32 s63, s63, 1
  s_cmp_lt_u32 s63, 20000
  s_cbranch_scc1 L_sp14
  s_waitcnt lgkmcnt(0)
L_ok14:
  s_mov_b32 s43, 7680
  s_load_dwordx4 s[64:67], s[4:5], s43 glc
  s_add_u32 m0, s61, 98304
  s_mov_b32 s62, 229376
  buffer_load_dwordx4 v20, s[28:31], s62 offen offset:0 sc1 lds
  buffer_load_dwordx4 v20, s[28:31], s62 offen offset:1024 sc1 lds
  buffer_load_dwordx4 v20, s[28:31], s62 offen offset:2048 sc1 lds
  buffer_load_dwordx4 v20, s[28:31], s62 offen offset:3072 sc1 lds
  s_mov_b32 s41, 1920
  s_lshr_b32 s53, s60, 1
  s_add_u32 m0, s53, 147456
  s_nop 0
  buffer_load_dwordx4 v16, s[16:19], s41 offen offset:0  lds
  buffer_load_dwordx4 v17, s[16:19], s41 offen offset:1024  lds
  buffer_load_dwordx4 v18, s[16:19], s41 offen offset:2048  lds
  buffer_load_dwordx4 v19, s[16:19], s41 offen offset:3072  lds
  s_waitcnt vmcnt(16)
  s_barrier
  s_mov_b32 s63, 0
L_sp15:
  s_waitcnt lgkmcnt(0)
  s_xor_b64 s[10:11], s[64:65], s[8:9]
  s_xor_b64 s[14:15], s[66:67], s[8:9]
  s_or_b64 s[10:11], s[10:11], s[14:15]
  s_cbranch_scc0 L_ok15
  s_load_dwordx4 s[64:67], s[4:5], s43 glc
  s_add_u32 s63, s63, 1
  s_cmp_lt_u32 s63, 20000
  s_cbranch_scc1 L_sp15
  s_waitcnt lgkmcnt(0)
L_ok15:
  s_add_u32 m0, s61, 0
  s_mov_b32 s62, 245760
  buffer_load_dwordx4 v20, s[28:31], s62 offen offset:0 sc1 lds
  buffer_load_dwordx4 v20, s[28:31], s62 offen offset:2048 sc1 lds
  s_waitcnt vmcnt(6)
  s_barrier
  s_add_u32 m0, s61, 0
  s_mov_b32 s62, 245760
  buffer_load_dwordx4 v20, s[28:31], s62 offen offset:1024 sc1 lds
  buffer_load_dwordx4 v20, s[28:31], s62 offen offset:3072 sc1 lds
  s_add_u32 m0, s60, 4096
  s_add_u32 s41, s41, 65536
  buffer_load_dwordx4 v16, s[16:19], s41 offen offset:0  lds
  buffer_load_dwordx4 v17, s[16:19], s41 offen offset:1024  lds
  buffer_load_dwordx4 v18, s[16:19], s41 offen offset:2048  lds
  buffer_load_dwordx4 v19, s[16:19], s41 offen offset:3072  lds
  s_waitcnt vmcnt(6)
  s_barrier
  s_waitcnt vmcnt(0)
  s_barrier
  s_endpgm
L_prod:
  s_mov_b32 s30, 9457664
  s_mov_b32 s31, 0x20000
  s_mov_b32 s18, 4194304
  s_mov_b32 s19, 0x20000
  s_mov_b32 s34, 14680064
  s_mov_b32 s35, 0x20000
  v_and_b32 v2, 63, v0
  v_lshlrev_b32 v5, 2, v3
  s_and_b32 s39, s38, 3
  s_mov_b32 s56, 917504
  s_mov_b32 s57, 16384
  s_mov_b32 s58, 512
  s_mov_b32 s59, 0
  s_mov_b32 s55, 7
  v_mov_b32 v15, 0x7ff00000
  s_cmp_lt_u32 s2, 28
  s_cbranch_scc1 L_pp
  s_mov_b32 s56, 512
  s_mov_b32 s57, 262144
  s_mov_b32 s58, 8192
  s_mov_b32 s59, 4096
  s_mov_b32 s51, 6
L_pl:
  s_add_u32 m0, m0, 4096
  v_add_u32 v16, 256, v16
  s_sub_u32 s51, s51, 1
  buffer_load_dword v16, s[24:27], 0 offen lds
  buffer_load_dword v16, s[24:27], s50 offen offset:256 lds
  s_cmp_lg_u32 s51, 0
  s_cbranch_scc1 L_pl
  s_waitcnt vmcnt(0)
  s_branch L_pq
L_pp:
  s_mov_b32 s22, 13762560
L_pq:
  s_add_u32 s10, s28, 9437184
  s_addc_u32 s11, s29, 0
  s_load_dwordx2 s[6:7], s[10:11], 0
  s_lshl_b32 s53, s38, 11
  s_add_u32 s53, s53, 32768
  v_lshrrev_b32 v1, 4, v3
  v_lshlrev_b32 v1, 10, v1
  v_lshl_add_u32 v1, v9, 3, v1
  v_and_b32 v6, 15, v3
  v_lshl_add_u32 v6, v6, 4, v1
  v_add_u32 v6, s53, v6
  v_lshl_add_u32 v7, v2, 4, s53
  s_lshl_b32 s53, s37, 18
  s_lshl_b32 s54, s52, 11
  s_add_u32 s53, s53, s54
  v_lshl_add_u32 v8, v2, 4, s53
  s_lshl_b32 s53, s37, 6
  s_lshr_b32 s54, s52, 1
  s_add_u32 s53, s53, s54
  s_lshl_b32 s53, s53, 7
  s_and_b32 s54, s52, 1
  s_lshl_b32 s54, s54, 3
  s_add_u32 s53, s53, s54
  s_add_u32 s53, s53, 7340032
  v_lshl_add_u32 v14, v2, 7, s53
  s_waitcnt vmcnt(0)
  buffer_load_dwordx4 v[32:35], v4, s[20:23], 0 offen nt
  buffer_load_dwordx4 v[36:39], v4, s[20:23], s45 offen nt
  buffer_load_dwordx4 v[40:43], v4, s[20:23], s46 offen nt
  buffer_load_dwordx4 v[44:47], v4, s[20:23], s47 offen nt
  v_add_u32 v4, s56, v4
  buffer_load_dword v17, v15, s[20:23], 0 offen
  buffer_load_dword v17, v15, s[20:23], 0 offen
  buffer_load_dwordx4 v[48:51], v4, s[20:23], 0 offen nt
  buffer_load_dwordx4 v[52:55], v4, s[20:23], s45 offen nt
  buffer_load_dwordx4 v[56:59], v4, s[20:23], s46 offen nt
  buffer_load_dwordx4 v[60:63], v4, s[20:23], s47 offen nt
  v_add_u32 v4, s56, v4
  s_waitcnt lgkmcnt(0)
  s_mul_i32 s8, s6, 1664525
  s_mul_i32 s9, s7, 22695477
  s_add_u32 s8, s8, 1013904223
  s_add_u32 s9, s9, 1
  v_mov_b32 v10, s8
  v_mov_b32 v11, s9
  s_mov_b32 s60, 0
  s_mov_b32 s61, 0
  s_mov_b32 s62, 0
  s_waitcnt vmcnt(10)
  s_barrier
L_p:
  s_waitcnt vmcnt(9)
  v_lshl_add_u32 v32, v32, 8, v5
  v_lshl_add_u32 v33, v33, 8, v5
  v_lshl_add_u32 v34, v34, 8, v5
  v_lshl_add_u32 v35, v35, 8, v5
  ds_read_u16 v96, v32 offset:0
  ds_read_u16 v97, v33 offset:2
  ds_read_u16 v98, v34 offset:128
  ds_read_u16 v99, v35 offset:130
  s_waitcnt vmcnt(8)
  v_lshl_add_u32 v36, v36, 8, v5
  v_lshl_add_u32 v37, v37, 8, v5
  v_lshl_add_u32 v38, v38, 8, v5
  v_lshl_add_u32 v39, v39, 8, v5
  ds_read_u16 v100, v36 offset:0
  ds_read_u16 v101, v37 offset:2
  ds_read_u16 v102, v38 offset:128
  ds_read_u16 v103, v39 offset:130
  s_waitcnt vmcnt(7)
  v_lshl_add_u32 v40, v40, 8, v5
  v_lshl_add_u32 v41, v41, 8, v5
  v_lshl_add_u32 v42, v42, 8, v5
  v_lshl_add_u32 v43, v43, 8, v5
  ds_read_u16 v104, v40 offset:0
  ds_read_u16 v105, v41 offset:2
  ds_read_u16 v106, v42 offset:128
  ds_read_u16 v107, v43 offset:130
  s_waitcnt vmcnt(6)
  v_lshl_add_u32 v44, v44, 8, v5
  v_lshl_add_u32 v45, v45, 8, v5
  v_lshl_add_u32 v46, v46, 8, v5
  v_lshl_add_u32 v47, v47, 8, v5
  ds_read_u16 v108, v44 offset:0
  ds_read_u16 v109, v45 offset:2
  ds_read_u16 v110, v46 offset:128
  ds_read_u16 v111, v47 offset:130
  s_cmp_eq_u32 s62, 0
  s_cbranch_scc1 L_pa0
  s_waitcnt vmcnt(4)
  s_mov_b64 exec, 1
  buffer_store_dwordx2 v[10:11], v14, s[28:31], s61 offen sc1
  s_mov_b64 exec, -1
  s_add_u32 s61, s61, s58
L_pa0:
  s_waitcnt lgkmcnt(8)
  v_lshl_or_b32 v112, v100, 16, v96
  v_lshl_or_b32 v114, v101, 16, v97
  v_lshl_or_b32 v116, v102, 16, v98
  v_lshl_or_b32 v118, v103, 16, v99
  s_waitcnt lgkmcnt(3)
  v_lshl_or_b32 v113, v108, 16, v104
  ds_write_b64 v6, v[112:113] offset:0
  s_waitcnt lgkmcnt(3)
  v_lshl_or_b32 v115, v109, 16, v105
  ds_write_b64 v6, v[114:115] offset:256
  s_waitcnt lgkmcnt(3)
  v_lshl_or_b32 v117, v110, 16, v106
  ds_write_b64 v6, v[116:117] offset:512
  s_waitcnt lgkmcnt(3)
  v_lshl_or_b32 v119, v111, 16, v107
  ds_write_b64 v6, v[118:119] offset:768
  s_waitcnt lgkmcnt(0)
  ds_read_b128 v[120:123], v7 offset:0
  ds_read_b128 v[124:127], v7 offset:1024
  s_waitcnt lgkmcnt(1)
  buffer_store_dwordx4 v[120:123], v8, s[28:31], s60 offen offset:0 sc1
  s_waitcnt lgkmcnt(0)
  buffer_store_dwordx4 v[124:127], v8, s[28:31], s60 offen offset:1024 sc1
  buffer_load_dwordx4 v[32:35], v4, s[20:23], 0 offen nt
  buffer_load_dwordx4 v[36:39], v4, s[20:23], s45 offen nt
  buffer_load_dwordx4 v[40:43], v4, s[20:23], s46 offen nt
  buffer_load_dwordx4 v[44:47], v4, s[20:23], s47 offen nt
  v_add_u32 v4, s56, v4
  v_add_u32 v5, s59, v5
  s_add_u32 s62, s62, 1
  s_add_u32 s60, s60, s57
  s_cmp_lt_u32 s62, s55
  s_cbranch_scc0 L_pe
  s_waitcnt vmcnt(9)
  v_lshl_add_u32 v48, v48, 8, v5
  v_lshl_add_u32 v49, v49, 8, v5
  v_lshl_add_u32 v50, v50, 8, v5
  v_lshl_add_u32 v51, v51, 8, v5
  ds_read_u16 v96, v48 offset:0
  ds_read_u16 v97, v49 offset:2
  ds_read_u16 v98, v50 offset:128
  ds_read_u16 v99, v51 offset:130
  s_waitcnt vmcnt(8)
  v_lshl_add_u32 v52, v52, 8, v5
  v_lshl_add_u32 v53, v53, 8, v5
  v_lshl_add_u32 v54, v54, 8, v5
  v_lshl_add_u32 v55, v55, 8, v5
  ds_read_u16 v100, v52 offset:0
  ds_read_u16 v101, v53 offset:2
  ds_read_u16 v102, v54 offset:128
  ds_read_u16 v103, v55 offset:130
  s_waitcnt vmcnt(7)
  v_lshl_add_u32 v56, v56, 8, v5
  v_lshl_add_u32 v57, v57, 8, v5
  v_lshl_add_u32 v58, v58, 8, v5
  v_lshl_add_u32 v59, v59, 8, v5
  ds_read_u16 v104, v56 offset:0
  ds_read_u16 v105, v57 offset:2
  ds_read_u16 v106, v58 offset:128
  ds_read_u16 v107, v59 offset:130
  s_waitcnt vmcnt(6)
  v_lshl_add_u32 v60, v60, 8, v5
  v_lshl_add_u32 v61, v61, 8, v5
  v_lshl_add_u32 v62, v62, 8, v5
  v_lshl_add_u32 v63, v63, 8, v5
  ds_read_u16 v108, v60 offset:0
  ds_read_u16 v109, v61 offset:2
  ds_read_u16 v110, v62 offset:128
  ds_read_u16 v111, v63 offset:130
  s_cmp_eq_u32 s62, 0
  s_cbranch_scc1 L_pa1
  s_waitcnt vmcnt(4)
  s_mov_b64 exec, 1
  buffer_store_dwordx2 v[10:11], v14, s[28:31], s61 offen sc1
  s_mov_b64 exec, -1
  s_add_u32 s61, s61, s58
L_pa1:
  s_waitcnt lgkmcnt(8)
  v_lshl_or_b32 v112, v100, 16, v96
  v_lshl_or_b32 v114, v101, 16, v97
  v_lshl_or_b32 v116, v102, 16, v98
  v_lshl_or_b32 v118, v103, 16, v99
  s_waitcnt lgkmcnt(3)
  v_lshl_or_b32 v113, v108, 16, v104
  ds_write_b64 v6, v[112:113] offset:0
  s_waitcnt lgkmcnt(3)
  v_lshl_or_b32 v115, v109, 16, v105
  ds_write_b64 v6, v[114:115] offset:256
  s_waitcnt lgkmcnt(3)
  v_lshl_or_b32 v117, v110, 16, v106
  ds_write_b64 v6, v[116:117] offset:512
  s_waitcnt lgkmcnt(3)
  v_lshl_or_b32 v119, v111, 16, v107
  ds_write_b64 v6, v[118:119] offset:768
  s_waitcnt lgkmcnt(0)
  ds_read_b128 v[128:131], v7 offset:0
  ds_read_b128 v[132:135], v7 offset:1024
  s_waitcnt lgkmcnt(1)
  buffer_store_dwordx4 v[128:131], v8, s[28:31], s60 offen offset:0 sc1
  s_waitcnt lgkmcnt(0)
  buffer_store_dwordx4 v[132:135], v8, s[28:31], s60 offen offset:1024 sc1
  buffer_load_dwordx4 v[48:51], v4, s[20:23], 0 offen nt
  buffer_load_dwordx4 v[52:55], v4, s[20:23], s45 offen nt
  buffer_load_dwordx4 v[56:59], v4, s[20:23], s46 offen nt
  buffer_load_dwordx4 v[60:63], v4, s[20:23], s47 offen nt
  v_add_u32 v4, s56, v4
  v_add_u32 v5, s59, v5
  s_add_u32 s62, s62, 1
  s_add_u32 s60, s60, s57
  s_cmp_lt_u32 s62, s55
  s_cbranch_scc1 L_p
L_pe:
  s_waitcnt vmcnt(4)
  s_mov_b64 exec, 1
  buffer_store_dwordx2 v[10:11], v14, s[28:31], s61 offen sc1
  s_mov_b64 exec, -1
  s_cmp_eq_u32 s38, 0
  s_cbranch_scc0 L_pz
  s_lshl_b32 s3, s2, 6
  s_add_u32 s3, s3, 9441280
  v_mov_b32 v12, s3
  s_mov_b64 exec, 1
  buffer_store_dwordx2 v[10:11], v12, s[28:31], 0 offen sc1
  s_mov_b64 exec, -1
  s_cmp_eq_u32 s2, 0
  s_cbranch_scc0 L_pz
  s_mov_b32 s63, 0
  v_lshlrev_b32 v12, 6, v2
  v_add_u32 v12, 9441280, v12
L_pw:
  s_mov_b32 s53, 0
  buffer_load_dwordx2 v[20:21], v12, s[28:31], s53 offen sc1
  s_mov_b32 s53, 4096
  buffer_load_dwordx2 v[22:23], v12, s[28:31], s53 offen sc1
  s_mov_b32 s53, 8192
  buffer_load_dwordx2 v[24:25], v12, s[28:31], s53 offen sc1
  s_mov_b32 s53, 12288
  buffer_load_dwordx2 v[26:27], v12, s[28:31], s53 offen sc1
  s_add_u32 s63, s63, 1
  s_waitcnt vmcnt(0)
  v_cmp_ne_u64 s[52:53], v[20:21], v[10:11]
  v_cmp_ne_u64 vcc, v[22:23], v[10:11]
  s_or_b64 s[52:53], s[52:53], vcc
  v_cmp_ne_u64 vcc, v[24:25], v[10:11]
  s_or_b64 s[52:53], s[52:53], vcc
  v_cmp_ne_u64 vcc, v[26:27], v[10:11]
  s_or_b64 s[52:53], s[52:53], vcc
  s_cbranch_scc0 L_pv
  s_cmp_lt_u32 s63, 20000
  s_cbranch_scc1 L_pw
L_pv:
  v_mov_b32 v12, 9437184
  s_mov_b64 exec, 1
  buffer_store_dwordx2 v[10:11], v12, s[28:31], 0 offen sc1
  s_mov_b64 exec, -1
L_pz:
L_drain:
  s_waitcnt vmcnt(0)
L_done:
  s_endpgm
L_end:
.section .rodata,"a"
.p2align 6
.amdhsa_kernel standalone__weight_only_int_squeezellm__prompt_kernel
  .amdhsa_next_free_vgpr 256
  .amdhsa_next_free_sgpr 102
  .amdhsa_accum_offset 160
  .amdhsa_group_segment_fixed_size 0
  .amdhsa_kernarg_size 48
  .amdhsa_user_sgpr_count 2
  .amdhsa_user_sgpr_kernarg_segment_ptr 1
  .amdhsa_system_sgpr_workgroup_id_x 1
.end_amdhsa_kernel
```
